```python
import torch

def _softmax(x, axis=-1):
    return torch.softmax(x, dim=axis)

def _gelu(x):
    return torch.nn.functional.gelu(x, approximate='tanh')

def _silu(x):
    return torch.nn.functional.silu(x)

def _sigmoid(x):
    return torch.sigmoid(x)

def _layernorm(x, axis=-1, eps=1e-05):
    m = x.mean(dim=axis, keepdim=True)
    v = x.var(dim=axis, keepdim=True, unbiased=False)
    return (x - m) / torch.sqrt(v + eps)

def _scatter_add(tgt, idx, src, axis=0):
    return tgt.clone().index_add_(axis, idx, src)

def _segment_sum(src, seg, n):
    out = torch.zeros((n,) + src.shape[1:], dtype=src.dtype)
    return out.index_add_(0, seg, src)

def _pad(x, pw):
    flat = tuple((v for pair in reversed(pw) for v in pair))
    return torch.nn.functional.pad(x, flat)
kernel_name = 'standalone__kv_cache_quant_pre_rope_vs_post_rope__decode'

def setup_inputs():

    _w = lambda a: (lambda t: t.to(torch.bfloat16) if t.is_floating_point() else t)(torch.as_tensor(a))
    B, Sq, Skv = (1, 1, 16384)
    H, Dh0 = (32, 192)
    G = -1 if -1 > 0 else Dh0
    G = max(2, G // 2 * 2)
    Dh = max(G, Dh0 // G * G)
    Skv = max(Skv, Sq)
    ng = Dh // G
    bits = 3 if 3 > 1 else 4
    bits = max(2, min(8, bits))
    qmax = (1 << bits) - 1
    half = Dh // 2
    inv = 1.0 / 10000.0 ** (torch.arange(half) / max(1, half))
    ang_k = torch.arange(Skv)[:, None] * inv[None, :]
    ang_q = torch.arange(Skv - Sq, Skv)[:, None] * inv[None, :]
    kc = torch.cat([torch.cos(ang_k), torch.cos(ang_k)], dim=-1)
    ks = torch.cat([torch.sin(ang_k), torch.sin(ang_k)], dim=-1)
    qc = torch.cat([torch.cos(ang_q), torch.cos(ang_q)], dim=-1)
    qs = torch.cat([torch.sin(ang_q), torch.sin(ang_q)], dim=-1)
    qk_i = torch.randint(0, qmax + 1, (B, H, Skv, Dh)).to(torch.int32)
    qv_i = torch.randint(0, qmax + 1, (B, H, Skv, Dh)).to(torch.int32)
    ksc = torch.abs((lambda *s: torch.randn(*s, dtype=torch.bfloat16) * 0.4)(B, H, Skv, ng)) * 0.1 + 0.01
    kzp = torch.full((B, H, Skv, ng), qmax / 2.0)
    vsc = torch.abs((lambda *s: torch.randn(*s, dtype=torch.bfloat16) * 0.4)(B, H, Skv, ng)) * 0.1 + 0.01
    vzp = torch.full((B, H, Skv, ng), qmax / 2.0)
    return {'q': _w((lambda *s: torch.randn(*s, dtype=torch.bfloat16) * 6.4)(B, H, Sq, Dh) * 0.5), 'qk': _w(qk_i), 'k_scales': _w(ksc), 'k_zeros': _w(kzp), 'qv': _w(qv_i), 'v_scales': _w(vsc), 'v_zeros': _w(vzp), 'q_cos': _w(qc), 'q_sin': _w(qs), 'k_cos': _w(kc), 'k_sin': _w(ks)}

def reference(q, qk, k_scales, k_zeros, qv, v_scales, v_zeros, q_cos, q_sin, k_cos, k_sin):
    B, H, Sq, Dh = q.shape
    ng = k_scales.shape[-1]
    G = Dh // ng
    half = Dh // 2
    ks = (lambda x, n, axis: torch.repeat_interleave(x, n, dim=axis))(k_scales, G, axis=-1)
    kz = (lambda x, n, axis: torch.repeat_interleave(x, n, dim=axis))(k_zeros, G, axis=-1)
    k = ((lambda x, dt: x.to(dt))(qk, q.dtype) - kz) * ks
    vs = (lambda x, n, axis: torch.repeat_interleave(x, n, dim=axis))(v_scales, G, axis=-1)
    vz = (lambda x, n, axis: torch.repeat_interleave(x, n, dim=axis))(v_zeros, G, axis=-1)
    v = ((lambda x, dt: x.to(dt))(qv, q.dtype) - vz) * vs
    k1 = k[..., :half].clone()
    k2 = k[..., half:].clone()
    krh = torch.concatenate([-k2, k1], axis=-1)
    kr = k * k_cos[None, None, :, :] + krh * k_sin[None, None, :, :]
    q1 = q[..., :half].clone()
    q2 = q[..., half:].clone()
    qrh = torch.concatenate([-q2, q1], axis=-1)
    qr = q * q_cos[None, None, :, :] + qrh * q_sin[None, None, :, :]
    logits = torch.einsum('bhqd,bhkd->bhqk', qr, kr) * float(Dh) ** (-0.5)
    attn = _softmax(logits, axis=-1)
    out = torch.einsum('bhqk,bhkd->bhqd', attn, v)
    return out
```

```asm
; @launch grid=(256,1,1) block=(384,1,1) lds=78336
.amdgcn_target "amdgcn-amd-amdhsa--gfx950"
.text
.globl standalone__kv_cache_quant_pre_rope_vs_post_rope__decode_kernel
.p2align 8
.type standalone__kv_cache_quant_pre_rope_vs_post_rope__decode_kernel,@function
standalone__kv_cache_quant_pre_rope_vs_post_rope__decode_kernel:
    s_load_dwordx16 s[48:63], s[0:1], 0
    s_load_dwordx8 s[64:71], s[0:1], 64
    s_load_dwordx4 s[72:75], s[0:1], 96
    s_cmp_ge_u32 s2, 256
    s_cbranch_scc1 L_end
    v_lshrrev_b32 v18, 6, v0
    v_and_b32 v1, 63, v0
    v_readfirstlane_b32 s76, v18
    v_cmp_eq_u32 vcc, 4, v1
    v_lshlrev_b32 v7, 2, v1
    v_add_u32 v7, 77824, v7
    v_cndmask_b32 v19, 0, 22, vcc
    ds_write_b32 v7, v19
    s_and_b32 s92, s2, 7
    s_lshl_b32 s77, s92, 6
    s_and_b32 s92, s2, 0x60
    s_lshl4_add_u32 s77, s92, s77
    s_and_b32 s92, s2, 0x10
    s_lshl1_add_u32 s77, s92, s77
    s_lshr_b32 s92, s2, 7
    s_lshl4_add_u32 s77, s92, s77
    s_bfe_u32 s3, s2, 0x10003
    s_lshl_b32 s92, s3, 13
    s_add_u32 s77, s77, s92
    s_cmp_lg_u32 s76, 0
    s_cbranch_scc1 L_other
    s_setprio 3
    v_lshlrev_b32 v2, 4, v1
    s_mul_i32 s79, s3, 25165824
    s_mul_i32 s78, s77, 768
    s_add_u32 s78, s78, s79
    s_mov_b32 s6, 402653184
    s_mov_b32 s7, 0x20000
    s_mov_b32 m0, 0
    s_movk_i32 s85, 4096
    s_mov_b32 s86, 12574720
    s_waitcnt lgkmcnt(0)
    s_mov_b32 s4, s50
    s_mov_b32 s5, s51
L_i0:
    buffer_load_dwordx4 v2, s[4:7], s78 offen offset:0 nt lds
    buffer_load_dwordx4 v2, s[4:7], s78 offen offset:1024 nt lds
    buffer_load_dwordx4 v2, s[4:7], s78 offen offset:2048 nt lds
    buffer_load_dwordx4 v2, s[4:7], s78 offen offset:3072 nt lds
    s_add_u32 m0, m0, s85
    s_cmpk_eq_u32 m0, 12288
    s_cselect_b32 s92, s86, s85
    s_add_u32 s78, s78, s92
    s_cmpk_lt_u32 m0, 24576
    s_cbranch_scc1 L_i0
    s_movk_i32 s85, 3072
    s_mov_b32 s86, 12570624
    s_mov_b32 s87, s79
    s_mov_b32 s80, s77
    s_mov_b32 s81, 0
    s_mov_b32 s82, -1
    v_mov_b32 v6, 77844
    s_barrier
    ds_read_b32 v3, v7
L_next:
    s_add_u32 s81, s81, 1
    s_add_u32 s80, s80, 2048
    s_and_b32 s80, s80, 16383
    s_and_b32 s92, s81, 7
    s_cselect_b32 s92, 0, 50331648
    s_add_u32 s79, s79, s92
    s_and_b32 s92, s81, 63
    s_cbranch_scc1 L_nsw
    s_cmp_eq_u32 s81, 128
    s_cbranch_scc1 L_drain
    s_mov_b32 s4, s56
    s_mov_b32 s5, s57
    s_mov_b32 s79, s87
L_nsw:
    s_mul_i32 s78, s80, 768
    s_add_u32 s78, s78, s79
    s_bitcmp1_b32 s81, 0
    s_cselect_b32 m0, 24576, 0
    v_readlane_b32 s83, v3, 4
    s_mul_i32 s92, s81, 24
    s_cmp_eq_u32 s81, 1
    s_cselect_b32 s83, 22, s83
    s_max_i32 s83, s83, 17
    s_min_i32 s83, s83, 26
    s_sub_u32 s92, s92, s83
    v_mov_b32 v5, s92
    s_cmp_lg_u32 s83, 22
    s_nop 0
    s_cbranch_scc1 L_disp
L_D22:
L_c22_0:
    s_waitcnt lgkmcnt(0)
    v_readlane_b32 s84, v3, 0
    ds_read_b32 v3, v7
    s_cmp_lt_i32 s84, s82
    s_cbranch_scc1 L_c22_0
    s_waitcnt vmcnt(21)
    buffer_load_dwordx4 v2, s[4:7], s78 offen offset:0 nt lds
    s_waitcnt vmcnt(21)
    buffer_load_dwordx4 v2, s[4:7], s78 offen offset:1024 nt lds
    s_waitcnt vmcnt(21)
    buffer_load_dwordx4 v2, s[4:7], s78 offen offset:2048 nt lds
    v_add_u32 v5, 3, v5
    s_add_u32 m0, m0, s85
    s_add_u32 s78, s78, s85
    ds_write_b32 v6, v5
L_c22_1:
    s_waitcnt lgkmcnt(0)
    v_readlane_b32 s84, v3, 1
    ds_read_b32 v3, v7
    s_cmp_lt_i32 s84, s82
    s_cbranch_scc1 L_c22_1
    s_waitcnt vmcnt(21)
    buffer_load_dwordx4 v2, s[4:7], s78 offen offset:0 nt lds
    s_waitcnt vmcnt(21)
    buffer_load_dwordx4 v2, s[4:7], s78 offen offset:1024 nt lds
    s_waitcnt vmcnt(21)
    buffer_load_dwordx4 v2, s[4:7], s78 offen offset:2048 nt lds
    v_add_u32 v5, 3, v5
    s_add_u32 m0, m0, s85
    s_add_u32 s78, s78, s85
    ds_write_b32 v6, v5
L_c22_2:
    s_waitcnt lgkmcnt(0)
    v_readlane_b32 s84, v3, 2
    ds_read_b32 v3, v7
    s_cmp_lt_i32 s84, s82
    s_cbranch_scc1 L_c22_2
    s_waitcnt vmcnt(21)
    buffer_load_dwordx4 v2, s[4:7], s78 offen offset:0 nt lds
    s_waitcnt vmcnt(21)
    buffer_load_dwordx4 v2, s[4:7], s78 offen offset:1024 nt lds
    s_waitcnt vmcnt(21)
    buffer_load_dwordx4 v2, s[4:7], s78 offen offset:2048 nt lds
    v_add_u32 v5, 3, v5
    s_add_u32 m0, m0, s85
    s_add_u32 s78, s78, s85
    ds_write_b32 v6, v5
L_c22_3:
    s_waitcnt lgkmcnt(0)
    v_readlane_b32 s84, v3, 3
    ds_read_b32 v3, v7
    s_cmp_lt_i32 s84, s82
    s_cbranch_scc1 L_c22_3
    s_waitcnt vmcnt(21)
    buffer_load_dwordx4 v2, s[4:7], s78 offen offset:0 nt lds
    s_waitcnt vmcnt(21)
    buffer_load_dwordx4 v2, s[4:7], s78 offen offset:1024 nt lds
    s_waitcnt vmcnt(21)
    buffer_load_dwordx4 v2, s[4:7], s78 offen offset:2048 nt lds
    v_add_u32 v5, 3, v5
    s_add_u32 m0, m0, s85
    s_add_u32 s78, s78, s85
    ds_write_b32 v6, v5
    s_add_u32 s78, s78, s86
    s_add_u32 s82, s82, 1
    s_bitcmp0_b32 s82, 0
    s_cbranch_scc1 L_D22
    s_branch L_next
L_disp:
    s_cmp_eq_u32 s83, 23
    s_cbranch_scc1 L_D23
    s_cmp_eq_u32 s83, 21
    s_cbranch_scc1 L_D21
    s_cmp_eq_u32 s83, 24
    s_cbranch_scc1 L_D24
    s_cmp_eq_u32 s83, 20
    s_cbranch_scc1 L_D20
    s_cmp_eq_u32 s83, 25
    s_cbranch_scc1 L_D25
    s_cmp_eq_u32 s83, 19
    s_cbranch_scc1 L_D19
    s_cmp_eq_u32 s83, 26
    s_cbranch_scc1 L_D26
    s_cmp_eq_u32 s83, 18
    s_cbranch_scc1 L_D18
L_D17:
L_c17_0:
    s_waitcnt lgkmcnt(0)
    v_readlane_b32 s84, v3, 0
    ds_read_b32 v3, v7
    s_cmp_lt_i32 s84, s82
    s_cbranch_scc1 L_c17_0
    s_waitcnt vmcnt(16)
    buffer_load_dwordx4 v2, s[4:7], s78 offen offset:0 nt lds
    s_waitcnt vmcnt(16)
    buffer_load_dwordx4 v2, s[4:7], s78 offen offset:1024 nt lds
    s_waitcnt vmcnt(16)
    buffer_load_dwordx4 v2, s[4:7], s78 offen offset:2048 nt lds
    v_add_u32 v5, 3, v5
    s_add_u32 m0, m0, s85
    s_add_u32 s78, s78, s85
    ds_write_b32 v6, v5
L_c17_1:
    s_waitcnt lgkmcnt(0)
    v_readlane_b32 s84, v3, 1
    ds_read_b32 v3, v7
    s_cmp_lt_i32 s84, s82
    s_cbranch_scc1 L_c17_1
    s_waitcnt vmcnt(16)
    buffer_load_dwordx4 v2, s[4:7], s78 offen offset:0 nt lds
    s_waitcnt vmcnt(16)
    buffer_load_dwordx4 v2, s[4:7], s78 offen offset:1024 nt lds
    s_waitcnt vmcnt(16)
    buffer_load_dwordx4 v2, s[4:7], s78 offen offset:2048 nt lds
    v_add_u32 v5, 3, v5
    s_add_u32 m0, m0, s85
    s_add_u32 s78, s78, s85
    ds_write_b32 v6, v5
L_c17_2:
    s_waitcnt lgkmcnt(0)
    v_readlane_b32 s84, v3, 2
    ds_read_b32 v3, v7
    s_cmp_lt_i32 s84, s82
    s_cbranch_scc1 L_c17_2
    s_waitcnt vmcnt(16)
    buffer_load_dwordx4 v2, s[4:7], s78 offen offset:0 nt lds
    s_waitcnt vmcnt(16)
    buffer_load_dwordx4 v2, s[4:7], s78 offen offset:1024 nt lds
    s_waitcnt vmcnt(16)
    buffer_load_dwordx4 v2, s[4:7], s78 offen offset:2048 nt lds
    v_add_u32 v5, 3, v5
    s_add_u32 m0, m0, s85
    s_add_u32 s78, s78, s85
    ds_write_b32 v6, v5
L_c17_3:
    s_waitcnt lgkmcnt(0)
    v_readlane_b32 s84, v3, 3
    ds_read_b32 v3, v7
    s_cmp_lt_i32 s84, s82
    s_cbranch_scc1 L_c17_3
    s_waitcnt vmcnt(16)
    buffer_load_dwordx4 v2, s[4:7], s78 offen offset:0 nt lds
    s_waitcnt vmcnt(16)
    buffer_load_dwordx4 v2, s[4:7], s78 offen offset:1024 nt lds
    s_waitcnt vmcnt(16)
    buffer_load_dwordx4 v2, s[4:7], s78 offen offset:2048 nt lds
    v_add_u32 v5, 3, v5
    s_add_u32 m0, m0, s85
    s_add_u32 s78, s78, s85
    ds_write_b32 v6, v5
    s_add_u32 s78, s78, s86
    s_add_u32 s82, s82, 1
    s_bitcmp0_b32 s82, 0
    s_cbranch_scc1 L_D17
    s_branch L_next
L_D23:
L_c23_0:
    s_waitcnt lgkmcnt(0)
    v_readlane_b32 s84, v3, 0
    ds_read_b32 v3, v7
    s_cmp_lt_i32 s84, s82
    s_cbranch_scc1 L_c23_0
    s_waitcnt vmcnt(22)
    buffer_load_dwordx4 v2, s[4:7], s78 offen offset:0 nt lds
    s_waitcnt vmcnt(22)
    buffer_load_dwordx4 v2, s[4:7], s78 offen offset:1024 nt lds
    s_waitcnt vmcnt(22)
    buffer_load_dwordx4 v2, s[4:7], s78 offen offset:2048 nt lds
    v_add_u32 v5, 3, v5
    s_add_u32 m0, m0, s85
    s_add_u32 s78, s78, s85
    ds_write_b32 v6, v5
L_c23_1:
    s_waitcnt lgkmcnt(0)
    v_readlane_b32 s84, v3, 1
    ds_read_b32 v3, v7
    s_cmp_lt_i32 s84, s82
    s_cbranch_scc1 L_c23_1
    s_waitcnt vmcnt(22)
    buffer_load_dwordx4 v2, s[4:7], s78 offen offset:0 nt lds
    s_waitcnt vmcnt(22)
    buffer_load_dwordx4 v2, s[4:7], s78 offen offset:1024 nt lds
    s_waitcnt vmcnt(22)
    buffer_load_dwordx4 v2, s[4:7], s78 offen offset:2048 nt lds
    v_add_u32 v5, 3, v5
    s_add_u32 m0, m0, s85
    s_add_u32 s78, s78, s85
    ds_write_b32 v6, v5
L_c23_2:
    s_waitcnt lgkmcnt(0)
    v_readlane_b32 s84, v3, 2
    ds_read_b32 v3, v7
    s_cmp_lt_i32 s84, s82
    s_cbranch_scc1 L_c23_2
    s_waitcnt vmcnt(22)
    buffer_load_dwordx4 v2, s[4:7], s78 offen offset:0 nt lds
    s_waitcnt vmcnt(22)
    buffer_load_dwordx4 v2, s[4:7], s78 offen offset:1024 nt lds
    s_waitcnt vmcnt(22)
    buffer_load_dwordx4 v2, s[4:7], s78 offen offset:2048 nt lds
    v_add_u32 v5, 3, v5
    s_add_u32 m0, m0, s85
    s_add_u32 s78, s78, s85
    ds_write_b32 v6, v5
L_c23_3:
    s_waitcnt lgkmcnt(0)
    v_readlane_b32 s84, v3, 3
    ds_read_b32 v3, v7
    s_cmp_lt_i32 s84, s82
    s_cbranch_scc1 L_c23_3
    s_waitcnt vmcnt(22)
    buffer_load_dwordx4 v2, s[4:7], s78 offen offset:0 nt lds
    s_waitcnt vmcnt(22)
    buffer_load_dwordx4 v2, s[4:7], s78 offen offset:1024 nt lds
    s_waitcnt vmcnt(22)
    buffer_load_dwordx4 v2, s[4:7], s78 offen offset:2048 nt lds
    v_add_u32 v5, 3, v5
    s_add_u32 m0, m0, s85
    s_add_u32 s78, s78, s85
    ds_write_b32 v6, v5
    s_add_u32 s78, s78, s86
    s_add_u32 s82, s82, 1
    s_bitcmp0_b32 s82, 0
    s_cbranch_scc1 L_D23
    s_branch L_next
L_D21:
L_c21_0:
    s_waitcnt lgkmcnt(0)
    v_readlane_b32 s84, v3, 0
    ds_read_b32 v3, v7
    s_cmp_lt_i32 s84, s82
    s_cbranch_scc1 L_c21_0
    s_waitcnt vmcnt(20)
    buffer_load_dwordx4 v2, s[4:7], s78 offen offset:0 nt lds
    s_waitcnt vmcnt(20)
    buffer_load_dwordx4 v2, s[4:7], s78 offen offset:1024 nt lds
    s_waitcnt vmcnt(20)
    buffer_load_dwordx4 v2, s[4:7], s78 offen offset:2048 nt lds
    v_add_u32 v5, 3, v5
    s_add_u32 m0, m0, s85
    s_add_u32 s78, s78, s85
    ds_write_b32 v6, v5
L_c21_1:
    s_waitcnt lgkmcnt(0)
    v_readlane_b32 s84, v3, 1
    ds_read_b32 v3, v7
    s_cmp_lt_i32 s84, s82
    s_cbranch_scc1 L_c21_1
    s_waitcnt vmcnt(20)
    buffer_load_dwordx4 v2, s[4:7], s78 offen offset:0 nt lds
    s_waitcnt vmcnt(20)
    buffer_load_dwordx4 v2, s[4:7], s78 offen offset:1024 nt lds
    s_waitcnt vmcnt(20)
    buffer_load_dwordx4 v2, s[4:7], s78 offen offset:2048 nt lds
    v_add_u32 v5, 3, v5
    s_add_u32 m0, m0, s85
    s_add_u32 s78, s78, s85
    ds_write_b32 v6, v5
L_c21_2:
    s_waitcnt lgkmcnt(0)
    v_readlane_b32 s84, v3, 2
    ds_read_b32 v3, v7
    s_cmp_lt_i32 s84, s82
    s_cbranch_scc1 L_c21_2
    s_waitcnt vmcnt(20)
    buffer_load_dwordx4 v2, s[4:7], s78 offen offset:0 nt lds
    s_waitcnt vmcnt(20)
    buffer_load_dwordx4 v2, s[4:7], s78 offen offset:1024 nt lds
    s_waitcnt vmcnt(20)
    buffer_load_dwordx4 v2, s[4:7], s78 offen offset:2048 nt lds
    v_add_u32 v5, 3, v5
    s_add_u32 m0, m0, s85
    s_add_u32 s78, s78, s85
    ds_write_b32 v6, v5
L_c21_3:
    s_waitcnt lgkmcnt(0)
    v_readlane_b32 s84, v3, 3
    ds_read_b32 v3, v7
    s_cmp_lt_i32 s84, s82
    s_cbranch_scc1 L_c21_3
    s_waitcnt vmcnt(20)
    buffer_load_dwordx4 v2, s[4:7], s78 offen offset:0 nt lds
    s_waitcnt vmcnt(20)
    buffer_load_dwordx4 v2, s[4:7], s78 offen offset:1024 nt lds
    s_waitcnt vmcnt(20)
    buffer_load_dwordx4 v2, s[4:7], s78 offen offset:2048 nt lds
    v_add_u32 v5, 3, v5
    s_add_u32 m0, m0, s85
    s_add_u32 s78, s78, s85
    ds_write_b32 v6, v5
    s_add_u32 s78, s78, s86
    s_add_u32 s82, s82, 1
    s_bitcmp0_b32 s82, 0
    s_cbranch_scc1 L_D21
    s_branch L_next
L_D24:
L_c24_0:
    s_waitcnt lgkmcnt(0)
    v_readlane_b32 s84, v3, 0
    ds_read_b32 v3, v7
    s_cmp_lt_i32 s84, s82
    s_cbranch_scc1 L_c24_0
    s_waitcnt vmcnt(23)
    buffer_load_dwordx4 v2, s[4:7], s78 offen offset:0 nt lds
    s_waitcnt vmcnt(23)
    buffer_load_dwordx4 v2, s[4:7], s78 offen offset:1024 nt lds
    s_waitcnt vmcnt(23)
    buffer_load_dwordx4 v2, s[4:7], s78 offen offset:2048 nt lds
    v_add_u32 v5, 3, v5
    s_add_u32 m0, m0, s85
    s_add_u32 s78, s78, s85
    ds_write_b32 v6, v5
L_c24_1:
    s_waitcnt lgkmcnt(0)
    v_readlane_b32 s84, v3, 1
    ds_read_b32 v3, v7
    s_cmp_lt_i32 s84, s82
    s_cbranch_scc1 L_c24_1
    s_waitcnt vmcnt(23)
    buffer_load_dwordx4 v2, s[4:7], s78 offen offset:0 nt lds
    s_waitcnt vmcnt(23)
    buffer_load_dwordx4 v2, s[4:7], s78 offen offset:1024 nt lds
    s_waitcnt vmcnt(23)
    buffer_load_dwordx4 v2, s[4:7], s78 offen offset:2048 nt lds
    v_add_u32 v5, 3, v5
    s_add_u32 m0, m0, s85
    s_add_u32 s78, s78, s85
    ds_write_b32 v6, v5
L_c24_2:
    s_waitcnt lgkmcnt(0)
    v_readlane_b32 s84, v3, 2
    ds_read_b32 v3, v7
    s_cmp_lt_i32 s84, s82
    s_cbranch_scc1 L_c24_2
    s_waitcnt vmcnt(23)
    buffer_load_dwordx4 v2, s[4:7], s78 offen offset:0 nt lds
    s_waitcnt vmcnt(23)
    buffer_load_dwordx4 v2, s[4:7], s78 offen offset:1024 nt lds
    s_waitcnt vmcnt(23)
    buffer_load_dwordx4 v2, s[4:7], s78 offen offset:2048 nt lds
    v_add_u32 v5, 3, v5
    s_add_u32 m0, m0, s85
    s_add_u32 s78, s78, s85
    ds_write_b32 v6, v5
L_c24_3:
    s_waitcnt lgkmcnt(0)
    v_readlane_b32 s84, v3, 3
    ds_read_b32 v3, v7
    s_cmp_lt_i32 s84, s82
    s_cbranch_scc1 L_c24_3
    s_waitcnt vmcnt(23)
    buffer_load_dwordx4 v2, s[4:7], s78 offen offset:0 nt lds
    s_waitcnt vmcnt(23)
    buffer_load_dwordx4 v2, s[4:7], s78 offen offset:1024 nt lds
    s_waitcnt vmcnt(23)
    buffer_load_dwordx4 v2, s[4:7], s78 offen offset:2048 nt lds
    v_add_u32 v5, 3, v5
    s_add_u32 m0, m0, s85
    s_add_u32 s78, s78, s85
    ds_write_b32 v6, v5
    s_add_u32 s78, s78, s86
    s_add_u32 s82, s82, 1
    s_bitcmp0_b32 s82, 0
    s_cbranch_scc1 L_D24
    s_branch L_next
L_D20:
L_c20_0:
    s_waitcnt lgkmcnt(0)
    v_readlane_b32 s84, v3, 0
    ds_read_b32 v3, v7
    s_cmp_lt_i32 s84, s82
    s_cbranch_scc1 L_c20_0
    s_waitcnt vmcnt(19)
    buffer_load_dwordx4 v2, s[4:7], s78 offen offset:0 nt lds
    s_waitcnt vmcnt(19)
    buffer_load_dwordx4 v2, s[4:7], s78 offen offset:1024 nt lds
    s_waitcnt vmcnt(19)
    buffer_load_dwordx4 v2, s[4:7], s78 offen offset:2048 nt lds
    v_add_u32 v5, 3, v5
    s_add_u32 m0, m0, s85
    s_add_u32 s78, s78, s85
    ds_write_b32 v6, v5
L_c20_1:
    s_waitcnt lgkmcnt(0)
    v_readlane_b32 s84, v3, 1
    ds_read_b32 v3, v7
    s_cmp_lt_i32 s84, s82
    s_cbranch_scc1 L_c20_1
    s_waitcnt vmcnt(19)
    buffer_load_dwordx4 v2, s[4:7], s78 offen offset:0 nt lds
    s_waitcnt vmcnt(19)
    buffer_load_dwordx4 v2, s[4:7], s78 offen offset:1024 nt lds
    s_waitcnt vmcnt(19)
    buffer_load_dwordx4 v2, s[4:7], s78 offen offset:2048 nt lds
    v_add_u32 v5, 3, v5
    s_add_u32 m0, m0, s85
    s_add_u32 s78, s78, s85
    ds_write_b32 v6, v5
L_c20_2:
    s_waitcnt lgkmcnt(0)
    v_readlane_b32 s84, v3, 2
    ds_read_b32 v3, v7
    s_cmp_lt_i32 s84, s82
    s_cbranch_scc1 L_c20_2
    s_waitcnt vmcnt(19)
    buffer_load_dwordx4 v2, s[4:7], s78 offen offset:0 nt lds
    s_waitcnt vmcnt(19)
    buffer_load_dwordx4 v2, s[4:7], s78 offen offset:1024 nt lds
    s_waitcnt vmcnt(19)
    buffer_load_dwordx4 v2, s[4:7], s78 offen offset:2048 nt lds
    v_add_u32 v5, 3, v5
    s_add_u32 m0, m0, s85
    s_add_u32 s78, s78, s85
    ds_write_b32 v6, v5
L_c20_3:
    s_waitcnt lgkmcnt(0)
    v_readlane_b32 s84, v3, 3
    ds_read_b32 v3, v7
    s_cmp_lt_i32 s84, s82
    s_cbranch_scc1 L_c20_3
    s_waitcnt vmcnt(19)
    buffer_load_dwordx4 v2, s[4:7], s78 offen offset:0 nt lds
    s_waitcnt vmcnt(19)
    buffer_load_dwordx4 v2, s[4:7], s78 offen offset:1024 nt lds
    s_waitcnt vmcnt(19)
    buffer_load_dwordx4 v2, s[4:7], s78 offen offset:2048 nt lds
    v_add_u32 v5, 3, v5
    s_add_u32 m0, m0, s85
    s_add_u32 s78, s78, s85
    ds_write_b32 v6, v5
    s_add_u32 s78, s78, s86
    s_add_u32 s82, s82, 1
    s_bitcmp0_b32 s82, 0
    s_cbranch_scc1 L_D20
    s_branch L_next
L_D25:
L_c25_0:
    s_waitcnt lgkmcnt(0)
    v_readlane_b32 s84, v3, 0
    ds_read_b32 v3, v7
    s_cmp_lt_i32 s84, s82
    s_cbranch_scc1 L_c25_0
    s_waitcnt vmcnt(24)
    buffer_load_dwordx4 v2, s[4:7], s78 offen offset:0 nt lds
    s_waitcnt vmcnt(24)
    buffer_load_dwordx4 v2, s[4:7], s78 offen offset:1024 nt lds
    s_waitcnt vmcnt(24)
    buffer_load_dwordx4 v2, s[4:7], s78 offen offset:2048 nt lds
    v_add_u32 v5, 3, v5
    s_add_u32 m0, m0, s85
    s_add_u32 s78, s78, s85
    ds_write_b32 v6, v5
L_c25_1:
    s_waitcnt lgkmcnt(0)
    v_readlane_b32 s84, v3, 1
    ds_read_b32 v3, v7
    s_cmp_lt_i32 s84, s82
    s_cbranch_scc1 L_c25_1
    s_waitcnt vmcnt(24)
    buffer_load_dwordx4 v2, s[4:7], s78 offen offset:0 nt lds
    s_waitcnt vmcnt(24)
    buffer_load_dwordx4 v2, s[4:7], s78 offen offset:1024 nt lds
    s_waitcnt vmcnt(24)
    buffer_load_dwordx4 v2, s[4:7], s78 offen offset:2048 nt lds
    v_add_u32 v5, 3, v5
    s_add_u32 m0, m0, s85
    s_add_u32 s78, s78, s85
    ds_write_b32 v6, v5
L_c25_2:
    s_waitcnt lgkmcnt(0)
    v_readlane_b32 s84, v3, 2
    ds_read_b32 v3, v7
    s_cmp_lt_i32 s84, s82
    s_cbranch_scc1 L_c25_2
    s_waitcnt vmcnt(24)
    buffer_load_dwordx4 v2, s[4:7], s78 offen offset:0 nt lds
    s_waitcnt vmcnt(24)
    buffer_load_dwordx4 v2, s[4:7], s78 offen offset:1024 nt lds
    s_waitcnt vmcnt(24)
    buffer_load_dwordx4 v2, s[4:7], s78 offen offset:2048 nt lds
    v_add_u32 v5, 3, v5
    s_add_u32 m0, m0, s85
    s_add_u32 s78, s78, s85
    ds_write_b32 v6, v5
L_c25_3:
    s_waitcnt lgkmcnt(0)
    v_readlane_b32 s84, v3, 3
    ds_read_b32 v3, v7
    s_cmp_lt_i32 s84, s82
    s_cbranch_scc1 L_c25_3
    s_waitcnt vmcnt(24)
    buffer_load_dwordx4 v2, s[4:7], s78 offen offset:0 nt lds
    s_waitcnt vmcnt(24)
    buffer_load_dwordx4 v2, s[4:7], s78 offen offset:1024 nt lds
    s_waitcnt vmcnt(24)
    buffer_load_dwordx4 v2, s[4:7], s78 offen offset:2048 nt lds
    v_add_u32 v5, 3, v5
    s_add_u32 m0, m0, s85
    s_add_u32 s78, s78, s85
    ds_write_b32 v6, v5
    s_add_u32 s78, s78, s86
    s_add_u32 s82, s82, 1
    s_bitcmp0_b32 s82, 0
    s_cbranch_scc1 L_D25
    s_branch L_next
L_D19:
L_c19_0:
    s_waitcnt lgkmcnt(0)
    v_readlane_b32 s84, v3, 0
    ds_read_b32 v3, v7
    s_cmp_lt_i32 s84, s82
    s_cbranch_scc1 L_c19_0
    s_waitcnt vmcnt(18)
    buffer_load_dwordx4 v2, s[4:7], s78 offen offset:0 nt lds
    s_waitcnt vmcnt(18)
    buffer_load_dwordx4 v2, s[4:7], s78 offen offset:1024 nt lds
    s_waitcnt vmcnt(18)
    buffer_load_dwordx4 v2, s[4:7], s78 offen offset:2048 nt lds
    v_add_u32 v5, 3, v5
    s_add_u32 m0, m0, s85
    s_add_u32 s78, s78, s85
    ds_write_b32 v6, v5
L_c19_1:
    s_waitcnt lgkmcnt(0)
    v_readlane_b32 s84, v3, 1
    ds_read_b32 v3, v7
    s_cmp_lt_i32 s84, s82
    s_cbranch_scc1 L_c19_1
    s_waitcnt vmcnt(18)
    buffer_load_dwordx4 v2, s[4:7], s78 offen offset:0 nt lds
    s_waitcnt vmcnt(18)
    buffer_load_dwordx4 v2, s[4:7], s78 offen offset:1024 nt lds
    s_waitcnt vmcnt(18)
    buffer_load_dwordx4 v2, s[4:7], s78 offen offset:2048 nt lds
    v_add_u32 v5, 3, v5
    s_add_u32 m0, m0, s85
    s_add_u32 s78, s78, s85
    ds_write_b32 v6, v5
L_c19_2:
    s_waitcnt lgkmcnt(0)
    v_readlane_b32 s84, v3, 2
    ds_read_b32 v3, v7
    s_cmp_lt_i32 s84, s82
    s_cbranch_scc1 L_c19_2
    s_waitcnt vmcnt(18)
    buffer_load_dwordx4 v2, s[4:7], s78 offen offset:0 nt lds
    s_waitcnt vmcnt(18)
    buffer_load_dwordx4 v2, s[4:7], s78 offen offset:1024 nt lds
    s_waitcnt vmcnt(18)
    buffer_load_dwordx4 v2, s[4:7], s78 offen offset:2048 nt lds
    v_add_u32 v5, 3, v5
    s_add_u32 m0, m0, s85
    s_add_u32 s78, s78, s85
    ds_write_b32 v6, v5
L_c19_3:
    s_waitcnt lgkmcnt(0)
    v_readlane_b32 s84, v3, 3
    ds_read_b32 v3, v7
    s_cmp_lt_i32 s84, s82
    s_cbranch_scc1 L_c19_3
    s_waitcnt vmcnt(18)
    buffer_load_dwordx4 v2, s[4:7], s78 offen offset:0 nt lds
    s_waitcnt vmcnt(18)
    buffer_load_dwordx4 v2, s[4:7], s78 offen offset:1024 nt lds
    s_waitcnt vmcnt(18)
    buffer_load_dwordx4 v2, s[4:7], s78 offen offset:2048 nt lds
    v_add_u32 v5, 3, v5
    s_add_u32 m0, m0, s85
    s_add_u32 s78, s78, s85
    ds_write_b32 v6, v5
    s_add_u32 s78, s78, s86
    s_add_u32 s82, s82, 1
    s_bitcmp0_b32 s82, 0
    s_cbranch_scc1 L_D19
    s_branch L_next
L_D26:
L_c26_0:
    s_waitcnt lgkmcnt(0)
    v_readlane_b32 s84, v3, 0
    ds_read_b32 v3, v7
    s_cmp_lt_i32 s84, s82
    s_cbranch_scc1 L_c26_0
    s_waitcnt vmcnt(25)
    buffer_load_dwordx4 v2, s[4:7], s78 offen offset:0 nt lds
    s_waitcnt vmcnt(25)
    buffer_load_dwordx4 v2, s[4:7], s78 offen offset:1024 nt lds
    s_waitcnt vmcnt(25)
    buffer_load_dwordx4 v2, s[4:7], s78 offen offset:2048 nt lds
    v_add_u32 v5, 3, v5
    s_add_u32 m0, m0, s85
    s_add_u32 s78, s78, s85
    ds_write_b32 v6, v5
L_c26_1:
    s_waitcnt lgkmcnt(0)
    v_readlane_b32 s84, v3, 1
    ds_read_b32 v3, v7
    s_cmp_lt_i32 s84, s82
    s_cbranch_scc1 L_c26_1
    s_waitcnt vmcnt(25)
    buffer_load_dwordx4 v2, s[4:7], s78 offen offset:0 nt lds
    s_waitcnt vmcnt(25)
    buffer_load_dwordx4 v2, s[4:7], s78 offen offset:1024 nt lds
    s_waitcnt vmcnt(25)
    buffer_load_dwordx4 v2, s[4:7], s78 offen offset:2048 nt lds
    v_add_u32 v5, 3, v5
    s_add_u32 m0, m0, s85
    s_add_u32 s78, s78, s85
    ds_write_b32 v6, v5
L_c26_2:
    s_waitcnt lgkmcnt(0)
    v_readlane_b32 s84, v3, 2
    ds_read_b32 v3, v7
    s_cmp_lt_i32 s84, s82
    s_cbranch_scc1 L_c26_2
    s_waitcnt vmcnt(25)
    buffer_load_dwordx4 v2, s[4:7], s78 offen offset:0 nt lds
    s_waitcnt vmcnt(25)
    buffer_load_dwordx4 v2, s[4:7], s78 offen offset:1024 nt lds
    s_waitcnt vmcnt(25)
    buffer_load_dwordx4 v2, s[4:7], s78 offen offset:2048 nt lds
    v_add_u32 v5, 3, v5
    s_add_u32 m0, m0, s85
    s_add_u32 s78, s78, s85
    ds_write_b32 v6, v5
L_c26_3:
    s_waitcnt lgkmcnt(0)
    v_readlane_b32 s84, v3, 3
    ds_read_b32 v3, v7
    s_cmp_lt_i32 s84, s82
    s_cbranch_scc1 L_c26_3
    s_waitcnt vmcnt(25)
    buffer_load_dwordx4 v2, s[4:7], s78 offen offset:0 nt lds
    s_waitcnt vmcnt(25)
    buffer_load_dwordx4 v2, s[4:7], s78 offen offset:1024 nt lds
    s_waitcnt vmcnt(25)
    buffer_load_dwordx4 v2, s[4:7], s78 offen offset:2048 nt lds
    v_add_u32 v5, 3, v5
    s_add_u32 m0, m0, s85
    s_add_u32 s78, s78, s85
    ds_write_b32 v6, v5
    s_add_u32 s78, s78, s86
    s_add_u32 s82, s82, 1
    s_bitcmp0_b32 s82, 0
    s_cbranch_scc1 L_D26
    s_branch L_next
L_D18:
L_c18_0:
    s_waitcnt lgkmcnt(0)
    v_readlane_b32 s84, v3, 0
    ds_read_b32 v3, v7
    s_cmp_lt_i32 s84, s82
    s_cbranch_scc1 L_c18_0
    s_waitcnt vmcnt(17)
    buffer_load_dwordx4 v2, s[4:7], s78 offen offset:0 nt lds
    s_waitcnt vmcnt(17)
    buffer_load_dwordx4 v2, s[4:7], s78 offen offset:1024 nt lds
    s_waitcnt vmcnt(17)
    buffer_load_dwordx4 v2, s[4:7], s78 offen offset:2048 nt lds
    v_add_u32 v5, 3, v5
    s_add_u32 m0, m0, s85
    s_add_u32 s78, s78, s85
    ds_write_b32 v6, v5
L_c18_1:
    s_waitcnt lgkmcnt(0)
    v_readlane_b32 s84, v3, 1
    ds_read_b32 v3, v7
    s_cmp_lt_i32 s84, s82
    s_cbranch_scc1 L_c18_1
    s_waitcnt vmcnt(17)
    buffer_load_dwordx4 v2, s[4:7], s78 offen offset:0 nt lds
    s_waitcnt vmcnt(17)
    buffer_load_dwordx4 v2, s[4:7], s78 offen offset:1024 nt lds
    s_waitcnt vmcnt(17)
    buffer_load_dwordx4 v2, s[4:7], s78 offen offset:2048 nt lds
    v_add_u32 v5, 3, v5
    s_add_u32 m0, m0, s85
    s_add_u32 s78, s78, s85
    ds_write_b32 v6, v5
L_c18_2:
    s_waitcnt lgkmcnt(0)
    v_readlane_b32 s84, v3, 2
    ds_read_b32 v3, v7
    s_cmp_lt_i32 s84, s82
    s_cbranch_scc1 L_c18_2
    s_waitcnt vmcnt(17)
    buffer_load_dwordx4 v2, s[4:7], s78 offen offset:0 nt lds
    s_waitcnt vmcnt(17)
    buffer_load_dwordx4 v2, s[4:7], s78 offen offset:1024 nt lds
    s_waitcnt vmcnt(17)
    buffer_load_dwordx4 v2, s[4:7], s78 offen offset:2048 nt lds
    v_add_u32 v5, 3, v5
    s_add_u32 m0, m0, s85
    s_add_u32 s78, s78, s85
    ds_write_b32 v6, v5
L_c18_3:
    s_waitcnt lgkmcnt(0)
    v_readlane_b32 s84, v3, 3
    ds_read_b32 v3, v7
    s_cmp_lt_i32 s84, s82
    s_cbranch_scc1 L_c18_3
    s_waitcnt vmcnt(17)
    buffer_load_dwordx4 v2, s[4:7], s78 offen offset:0 nt lds
    s_waitcnt vmcnt(17)
    buffer_load_dwordx4 v2, s[4:7], s78 offen offset:1024 nt lds
    s_waitcnt vmcnt(17)
    buffer_load_dwordx4 v2, s[4:7], s78 offen offset:2048 nt lds
    v_add_u32 v5, 3, v5
    s_add_u32 m0, m0, s85
    s_add_u32 s78, s78, s85
    ds_write_b32 v6, v5
    s_add_u32 s78, s78, s86
    s_add_u32 s82, s82, 1
    s_bitcmp0_b32 s82, 0
    s_cbranch_scc1 L_D18
    s_branch L_next
L_drain:
    v_mov_b32 v18, 3048
    s_waitcnt vmcnt(24)
    ds_write_b32 v6, v18
    v_mov_b32 v18, 3051
    s_waitcnt vmcnt(21)
    ds_write_b32 v6, v18
    v_mov_b32 v18, 3054
    s_waitcnt vmcnt(18)
    ds_write_b32 v6, v18
    v_mov_b32 v18, 3057
    s_waitcnt vmcnt(15)
    ds_write_b32 v6, v18
    v_mov_b32 v18, 3060
    s_waitcnt vmcnt(12)
    ds_write_b32 v6, v18
    v_mov_b32 v18, 3063
    s_waitcnt vmcnt(9)
    ds_write_b32 v6, v18
    v_mov_b32 v18, 3066
    s_waitcnt vmcnt(6)
    ds_write_b32 v6, v18
    v_mov_b32 v18, 3069
    s_waitcnt vmcnt(3)
    ds_write_b32 v6, v18
    v_mov_b32 v18, 3072
    s_waitcnt vmcnt(0)
    ds_write_b32 v6, v18
    s_waitcnt lgkmcnt(0)
    s_endpgm
L_other:
    s_cmp_eq_u32 s76, 5
    s_cbranch_scc1 L_helper
    s_sub_u32 s78, s76, 1
    v_lshlrev_b32 v44, 3, v1
    v_cmp_gt_u32 vcc, 24, v1
    v_mov_b32 v23, 0xffffff40
    v_mov_b32 v18, 192
    v_cndmask_b32 v23, v23, v18, vcc
    v_add_u32 v45, v44, v23
    v_mov_b32 v18, 0x80008000
    v_cndmask_b32 v46, 0, v18, vcc
    v_lshrrev_b32 v19, 4, v1
    v_and_b32 v23, 15, v1
    v_mul_u32_u24 v20, 384, v19
    v_lshl_add_u32 v20, v23, 3, v20
    v_cmp_lt_u32 s[86:87], 7, v23
    v_mov_b32 v21, -64
    v_mov_b32 v18, 320
    v_cndmask_b32 v21, v18, v21, s[86:87]
    v_add_u32 v21, v20, v21
    s_lshl1_add_u32 s95, s78, s3
    s_mul_i32 s95, s95, 768
    s_lshl2_add_u32 s89, s78, s77
    s_mov_b32 s34, 12288
    s_mov_b32 s35, 0x20000
    s_mov_b32 s38, 384
    s_mov_b32 s39, 0x20000
    s_mov_b32 s42, 384
    s_mov_b32 s43, 0x20000
    s_mov_b32 s14, 6291456
    s_mov_b32 s15, 0x20000
    s_mov_b32 s18, 6291456
    s_mov_b32 s19, 0x20000
    s_waitcnt lgkmcnt(0)
    s_mov_b64 s[32:33], s[48:49]
    s_mov_b64 s[36:37], s[62:63]
    s_mov_b64 s[40:41], s[64:65]
    buffer_load_dwordx2 v[24:25], v44, s[32:35], s95 offen
    buffer_load_dwordx2 v[26:27], v45, s[32:35], s95 offen
    buffer_load_dwordx2 v[28:29], v44, s[32:35], s95 offen offset:384
    buffer_load_dwordx2 v[30:31], v45, s[32:35], s95 offen offset:384
    buffer_load_dwordx2 v[40:41], v44, s[36:39], 0 offen
    buffer_load_dwordx2 v[42:43], v44, s[40:43], 0 offen
    s_mov_b64 s[12:13], s[66:67]
    s_mov_b64 s[16:17], s[68:69]
    s_mul_i32 s82, s89, 384
    s_add_u32 s89, s89, 2048
    s_and_b32 s89, s89, 16383
    buffer_load_dwordx2 v[72:73], v20, s[12:15], s82 offen offset:0
    buffer_load_dwordx2 v[74:75], v20, s[16:19], s82 offen offset:192
    buffer_load_dwordx2 v[76:77], v20, s[12:15], s82 offen offset:128
    buffer_load_dwordx2 v[78:79], v21, s[16:19], s82 offen
    buffer_load_dwordx2 v[80:81], v20, s[12:15], s82 offen offset:256
    buffer_load_dwordx2 v[82:83], v20, s[16:19], s82 offen offset:64
    s_barrier
    s_mov_b32 s83, 0x05040100
    s_mov_b32 s84, 0x07060302
    s_mul_i32 s92, s78, 3072
    v_lshl_add_u32 v2, v20, 1, s92
    s_lshl_b32 s92, s78, 5
    s_add_u32 s92, s92, 49152
    v_lshl_add_u32 v3, v19, 3, s92
    v_lshrrev_b32 v18, 3, v23
    v_lshl_add_u32 v4, v18, 10, v3
    v_lshlrev_b32 v9, 4, v23
    v_add_u32 v9, 65536, v9
    s_lshl2_add_u32 s92, s78, 77824
    v_mov_b32 v5, s92
    v_mov_b32 v6, 0
    v_mov_b32 v8, 1
    v_mov_b32 v22, 77888
    s_mul_i32 s79, s78, 3
    s_sub_u32 s79, s79, 9
    s_mov_b32 s80, 0
    s_mov_b32 s81, 0
    s_mul_i32 s92, s78, 1536
    s_add_u32 s92, s92, 65536
    v_lshl_add_u32 v18, v44, 1, s92
    v_lshl_add_u32 v19, v45, 1, s92
    s_waitcnt vmcnt(6)
    v_xor_b32 v42, v42, v46
    v_xor_b32 v43, v43, v46
    v_lshlrev_b32 v48, 16, v40
    v_and_b32 v49, 0xffff0000, v40
    v_lshlrev_b32 v50, 16, v41
    v_and_b32 v51, 0xffff0000, v41
    v_lshlrev_b32 v52, 16, v42
    v_and_b32 v53, 0xffff0000, v42
    v_lshlrev_b32 v54, 16, v43
    v_and_b32 v55, 0xffff0000, v43
    v_and_b32 v46, 0x80000000, v46
    s_mov_b32 exec_hi, 0xffff
    v_lshlrev_b32 v56, 16, v24
    v_and_b32 v57, 0xffff0000, v24
    v_lshlrev_b32 v58, 16, v25
    v_and_b32 v59, 0xffff0000, v25
    v_lshlrev_b32 v60, 16, v26
    v_and_b32 v61, 0xffff0000, v26
    v_lshlrev_b32 v62, 16, v27
    v_and_b32 v63, 0xffff0000, v27
    v_pk_mul_f32 v[56:57], v[56:57], v[48:49]
    v_pk_mul_f32 v[60:61], v[60:61], v[52:53]
    v_pk_mul_f32 v[58:59], v[58:59], v[50:51]
    v_pk_mul_f32 v[62:63], v[62:63], v[54:55]
    v_cvt_pk_bf16_f32 v56, v56, v60
    v_cvt_pk_bf16_f32 v57, v57, v61
    v_cvt_pk_bf16_f32 v58, v58, v62
    v_cvt_pk_bf16_f32 v59, v59, v63
    v_and_b32 v60, 0xffff0000, v56
    v_lshlrev_b32 v56, 16, v56
    v_and_b32 v61, 0xffff0000, v57
    v_lshlrev_b32 v57, 16, v57
    v_and_b32 v62, 0xffff0000, v58
    v_lshlrev_b32 v58, 16, v58
    v_and_b32 v63, 0xffff0000, v59
    v_lshlrev_b32 v59, 16, v59
    v_pk_add_f32 v[56:57], v[56:57], v[60:61]
    v_pk_add_f32 v[58:59], v[58:59], v[62:63]
    v_cvt_pk_bf16_f32 v64, v56, v56
    v_cvt_pk_bf16_f32 v65, v57, v57
    v_cvt_pk_bf16_f32 v66, v58, v58
    v_cvt_pk_bf16_f32 v67, v59, v59
    v_xor_b32 v64, v64, v46
    v_xor_b32 v65, v65, v46
    v_xor_b32 v66, v66, v46
    v_xor_b32 v67, v67, v46
    ds_write_b16 v18, v64 offset:0
    ds_write_b16_d16_hi v19, v64 offset:2
    ds_write_b16 v18, v65 offset:4
    ds_write_b16_d16_hi v19, v65 offset:6
    ds_write_b16 v18, v66 offset:8
    ds_write_b16_d16_hi v19, v66 offset:10
    ds_write_b16 v18, v67 offset:12
    ds_write_b16_d16_hi v19, v67 offset:14
    v_lshlrev_b32 v56, 16, v28
    v_and_b32 v57, 0xffff0000, v28
    v_lshlrev_b32 v58, 16, v29
    v_and_b32 v59, 0xffff0000, v29
    v_lshlrev_b32 v60, 16, v30
    v_and_b32 v61, 0xffff0000, v30
    v_lshlrev_b32 v62, 16, v31
    v_and_b32 v63, 0xffff0000, v31
    v_pk_mul_f32 v[56:57], v[56:57], v[48:49]
    v_pk_mul_f32 v[60:61], v[60:61], v[52:53]
    v_pk_mul_f32 v[58:59], v[58:59], v[50:51]
    v_pk_mul_f32 v[62:63], v[62:63], v[54:55]
    v_cvt_pk_bf16_f32 v56, v56, v60
    v_cvt_pk_bf16_f32 v57, v57, v61
    v_cvt_pk_bf16_f32 v58, v58, v62
    v_cvt_pk_bf16_f32 v59, v59, v63
    v_and_b32 v60, 0xffff0000, v56
    v_lshlrev_b32 v56, 16, v56
    v_and_b32 v61, 0xffff0000, v57
    v_lshlrev_b32 v57, 16, v57
    v_and_b32 v62, 0xffff0000, v58
    v_lshlrev_b32 v58, 16, v58
    v_and_b32 v63, 0xffff0000, v59
    v_lshlrev_b32 v59, 16, v59
    v_pk_add_f32 v[56:57], v[56:57], v[60:61]
    v_pk_add_f32 v[58:59], v[58:59], v[62:63]
    v_cvt_pk_bf16_f32 v68, v56, v56
    v_cvt_pk_bf16_f32 v69, v57, v57
    v_cvt_pk_bf16_f32 v70, v58, v58
    v_cvt_pk_bf16_f32 v71, v59, v59
    v_xor_b32 v68, v68, v46
    v_xor_b32 v69, v69, v46
    v_xor_b32 v70, v70, v46
    v_xor_b32 v71, v71, v46
    ds_write_b16 v18, v68 offset:768
    ds_write_b16_d16_hi v19, v68 offset:770
    ds_write_b16 v18, v69 offset:772
    ds_write_b16_d16_hi v19, v69 offset:774
    ds_write_b16 v18, v70 offset:776
    ds_write_b16_d16_hi v19, v70 offset:778
    ds_write_b16 v18, v71 offset:780
    ds_write_b16_d16_hi v19, v71 offset:782
    s_mov_b32 exec_hi, -1
    ds_write_b32 v5, v8 offset:128
    s_mul_i32 s82, s89, 384
    s_add_u32 s89, s89, 2048
    s_and_b32 s89, s89, 16383
    buffer_load_dwordx2 v[84:85], v20, s[12:15], s82 offen offset:0
    buffer_load_dwordx2 v[86:87], v20, s[16:19], s82 offen offset:192
    buffer_load_dwordx2 v[88:89], v20, s[12:15], s82 offen offset:128
    buffer_load_dwordx2 v[90:91], v21, s[16:19], s82 offen
    buffer_load_dwordx2 v[92:93], v20, s[12:15], s82 offen offset:256
    buffer_load_dwordx2 v[94:95], v20, s[16:19], s82 offen offset:64
L_kph:
    s_add_u32 s88, s81, 32
L_kw:
    ds_read_b32 v19, v7
    s_waitcnt lgkmcnt(0)
    v_readlane_b32 s92, v19, s88
    v_readlane_b32 s93, v19, 12
    s_cmp_eq_u32 s92, 0
    s_nop 3
    s_cbranch_scc1 L_kw
    s_cmp_le_u32 s93, s81
    s_cbranch_scc1 L_kw
    ds_read_b128 v[48:51], v9 offset:0
    ds_read_b128 v[52:55], v9 offset:256
    ds_read_b128 v[56:59], v9 offset:512
    ds_read_b128 v[60:63], v9 offset:768
    ds_read_b128 v[64:67], v9 offset:1024
    ds_read_b128 v[68:71], v9 offset:1280
    v_add_u32 v9, 1536, v9
    s_waitcnt lgkmcnt(0)
    s_cmp_lg_u32 s81, 0
    s_cbranch_scc1 L_ncs0
    s_waitcnt vmcnt(6)
    v_perm_b32 v36, v74, v72, s83
    v_perm_b32 v74, v74, v72, s84
    v_perm_b32 v37, v75, v73, s83
    v_perm_b32 v75, v75, v73, s84
    v_perm_b32 v38, v78, v76, s83
    v_perm_b32 v78, v78, v76, s84
    v_perm_b32 v39, v79, v77, s83
    v_perm_b32 v79, v79, v77, s84
    v_perm_b32 v40, v82, v80, s83
    v_perm_b32 v82, v82, v80, s84
    v_perm_b32 v41, v83, v81, s83
    v_perm_b32 v83, v83, v81, s84
    v_mov_b64 v[72:73], v[36:37]
    v_mov_b64 v[76:77], v[38:39]
    v_mov_b64 v[80:81], v[40:41]
    s_mul_i32 s82, s89, 384
    s_add_u32 s89, s89, 2048
    s_and_b32 s89, s89, 16383
    buffer_load_dwordx2 v[96:97], v20, s[12:15], s82 offen offset:0
    buffer_load_dwordx2 v[98:99], v20, s[16:19], s82 offen offset:192
    buffer_load_dwordx2 v[100:101], v20, s[12:15], s82 offen offset:128
    buffer_load_dwordx2 v[102:103], v21, s[16:19], s82 offen
    buffer_load_dwordx2 v[104:105], v20, s[12:15], s82 offen offset:256
    buffer_load_dwordx2 v[106:107], v20, s[16:19], s82 offen offset:64
L_ncs0:
    v_dot2_f32_bf16 v36, v72, v48, 0
    v_dot2_f32_bf16 v37, v74, v49, 0
    v_dot2_f32_bf16 v38, v73, v50, 0
    v_dot2_f32_bf16 v39, v75, v51, 0
    v_dot2_f32_bf16 v40, v76, v52, 0
    v_dot2_f32_bf16 v41, v78, v53, 0
    v_dot2_f32_bf16 v42, v77, v54, 0
    v_dot2_f32_bf16 v43, v79, v55, 0
    v_dot2_f32_bf16 v44, v80, v56, 0
    v_dot2_f32_bf16 v45, v82, v57, 0
    v_dot2_f32_bf16 v46, v81, v58, 0
    v_dot2_f32_bf16 v47, v83, v59, 0
    s_add_u32 s79, s79, 12
    s_cmp_ge_i32 s80, s79
    s_cbranch_scc1 L_kr00g
L_kr00:
    ds_read_b32 v19, v7
    s_sleep 1
    s_waitcnt lgkmcnt(0)
    v_readlane_b32 s80, v19, 5
    s_nop 0
    s_cmp_lt_i32 s80, s79
    s_cbranch_scc1 L_kr00
L_kr00g:
    ds_read_b32 v10, v3 offset:0
    ds_read_b128 v[24:27], v2 offset:0
    ds_read_b128 v[28:31], v2 offset:256
    ds_read_b128 v[32:35], v2 offset:512
    v_add_u32 v6, 1, v6
    ds_write_b32 v5, v6
    s_waitcnt lgkmcnt(3)
    v_and_b32 v12, 0xffff0000, v10
    v_cvt_f32_i32 v24, v24
    v_cvt_f32_i32 v25, v25
    v_cvt_f32_i32 v26, v26
    v_cvt_f32_i32 v27, v27
    v_pk_add_f32 v[24:25], v[24:25], v[12:13] op_sel:[0,0] op_sel_hi:[1,0] neg_lo:[0,1] neg_hi:[0,1]
    v_pk_add_f32 v[26:27], v[26:27], v[12:13] op_sel:[0,0] op_sel_hi:[1,0] neg_lo:[0,1] neg_hi:[0,1]
    v_pk_mul_f32 v[14:15], v[24:25], v[36:37]
    v_pk_fma_f32 v[14:15], v[26:27], v[38:39], v[14:15]
    s_waitcnt lgkmcnt(2)
    v_cvt_f32_i32 v28, v28
    v_cvt_f32_i32 v29, v29
    v_cvt_f32_i32 v30, v30
    v_cvt_f32_i32 v31, v31
    v_pk_add_f32 v[28:29], v[28:29], v[12:13] op_sel:[0,0] op_sel_hi:[1,0] neg_lo:[0,1] neg_hi:[0,1]
    v_pk_add_f32 v[30:31], v[30:31], v[12:13] op_sel:[0,0] op_sel_hi:[1,0] neg_lo:[0,1] neg_hi:[0,1]
    v_pk_fma_f32 v[14:15], v[28:29], v[40:41], v[14:15]
    v_pk_fma_f32 v[14:15], v[30:31], v[42:43], v[14:15]
    s_waitcnt lgkmcnt(1)
    v_cvt_f32_i32 v32, v32
    v_cvt_f32_i32 v33, v33
    v_cvt_f32_i32 v34, v34
    v_cvt_f32_i32 v35, v35
    v_pk_add_f32 v[32:33], v[32:33], v[12:13] op_sel:[0,0] op_sel_hi:[1,0] neg_lo:[0,1] neg_hi:[0,1]
    v_pk_add_f32 v[34:35], v[34:35], v[12:13] op_sel:[0,0] op_sel_hi:[1,0] neg_lo:[0,1] neg_hi:[0,1]
    v_pk_fma_f32 v[14:15], v[32:33], v[44:45], v[14:15]
    v_pk_fma_f32 v[14:15], v[34:35], v[46:47], v[14:15]
    v_add_f32 v14, v14, v15
    s_nop 1
    v_add_f32_dpp v18, v14, v14 row_ror:8 row_mask:0xf bank_mask:0x3
    v_dot2_f32_bf16 v36, v72, v60, 0
    v_dot2_f32_bf16 v37, v74, v61, 0
    v_dot2_f32_bf16 v38, v73, v62, 0
    v_dot2_f32_bf16 v39, v75, v63, 0
    v_dot2_f32_bf16 v40, v76, v64, 0
    v_dot2_f32_bf16 v41, v78, v65, 0
    v_dot2_f32_bf16 v42, v77, v66, 0
    v_dot2_f32_bf16 v43, v79, v67, 0
    v_dot2_f32_bf16 v44, v80, v68, 0
    v_dot2_f32_bf16 v45, v82, v69, 0
    v_dot2_f32_bf16 v46, v81, v70, 0
    v_dot2_f32_bf16 v47, v83, v71, 0
    s_add_u32 s79, s79, 12
    s_cmp_ge_i32 s80, s79
    s_cbranch_scc1 L_kr01g
L_kr01:
    ds_read_b32 v19, v7
    s_sleep 1
    s_waitcnt lgkmcnt(0)
    v_readlane_b32 s80, v19, 5
    s_nop 0
    s_cmp_lt_i32 s80, s79
    s_cbranch_scc1 L_kr01
L_kr01g:
    ds_read_b32 v11, v3 offset:1024
    ds_read_b128 v[24:27], v2 offset:12288
    ds_read_b128 v[28:31], v2 offset:12544
    ds_read_b128 v[32:35], v2 offset:12800
    v_add_u32 v6, 1, v6
    ds_write_b32 v5, v6
    s_waitcnt lgkmcnt(3)
    v_and_b32 v12, 0xffff0000, v11
    v_cvt_f32_i32 v24, v24
    v_cvt_f32_i32 v25, v25
    v_cvt_f32_i32 v26, v26
    v_cvt_f32_i32 v27, v27
    v_pk_add_f32 v[24:25], v[24:25], v[12:13] op_sel:[0,0] op_sel_hi:[1,0] neg_lo:[0,1] neg_hi:[0,1]
    v_pk_add_f32 v[26:27], v[26:27], v[12:13] op_sel:[0,0] op_sel_hi:[1,0] neg_lo:[0,1] neg_hi:[0,1]
    v_pk_mul_f32 v[16:17], v[24:25], v[36:37]
    v_pk_fma_f32 v[16:17], v[26:27], v[38:39], v[16:17]
    s_waitcnt lgkmcnt(2)
    v_cvt_f32_i32 v28, v28
    v_cvt_f32_i32 v29, v29
    v_cvt_f32_i32 v30, v30
    v_cvt_f32_i32 v31, v31
    v_pk_add_f32 v[28:29], v[28:29], v[12:13] op_sel:[0,0] op_sel_hi:[1,0] neg_lo:[0,1] neg_hi:[0,1]
    v_pk_add_f32 v[30:31], v[30:31], v[12:13] op_sel:[0,0] op_sel_hi:[1,0] neg_lo:[0,1] neg_hi:[0,1]
    v_pk_fma_f32 v[16:17], v[28:29], v[40:41], v[16:17]
    v_pk_fma_f32 v[16:17], v[30:31], v[42:43], v[16:17]
    s_waitcnt lgkmcnt(1)
    v_cvt_f32_i32 v32, v32
    v_cvt_f32_i32 v33, v33
    v_cvt_f32_i32 v34, v34
    v_cvt_f32_i32 v35, v35
    v_pk_add_f32 v[32:33], v[32:33], v[12:13] op_sel:[0,0] op_sel_hi:[1,0] neg_lo:[0,1] neg_hi:[0,1]
    v_pk_add_f32 v[34:35], v[34:35], v[12:13] op_sel:[0,0] op_sel_hi:[1,0] neg_lo:[0,1] neg_hi:[0,1]
    v_pk_fma_f32 v[16:17], v[32:33], v[44:45], v[16:17]
    v_pk_fma_f32 v[16:17], v[34:35], v[46:47], v[16:17]
    v_add_f32 v16, v16, v17
    v_cndmask_b32 v23, v10, v11, s[86:87]
    v_lshlrev_b32 v23, 16, v23
    v_add_f32_dpp v18, v16, v16 row_ror:8 row_mask:0xf bank_mask:0xc
    v_mul_f32 v23, 0x3dd53b95, v23
    s_nop 0
    v_add_f32_dpp v18, v18, v18 row_half_mirror row_mask:0xf bank_mask:0xf
    s_nop 1
    v_add_f32_dpp v18, v18, v18 quad_perm:[2,3,0,1] row_mask:0xf bank_mask:0xf
    s_nop 1
    v_add_f32_dpp v18, v18, v18 quad_perm:[1,0,3,2] row_mask:0xf bank_mask:0xf
    v_mul_f32 v18, v23, v18
    ds_write_b32 v4, v18 offset:0
    s_cmp_lg_u32 s81, 0
    s_cbranch_scc1 L_ncs1
    s_waitcnt vmcnt(6)
    v_perm_b32 v36, v86, v84, s83
    v_perm_b32 v86, v86, v84, s84
    v_perm_b32 v37, v87, v85, s83
    v_perm_b32 v87, v87, v85, s84
    v_perm_b32 v38, v90, v88, s83
    v_perm_b32 v90, v90, v88, s84
    v_perm_b32 v39, v91, v89, s83
    v_perm_b32 v91, v91, v89, s84
    v_perm_b32 v40, v94, v92, s83
    v_perm_b32 v94, v94, v92, s84
    v_perm_b32 v41, v95, v93, s83
    v_perm_b32 v95, v95, v93, s84
    v_mov_b64 v[84:85], v[36:37]
    v_mov_b64 v[88:89], v[38:39]
    v_mov_b64 v[92:93], v[40:41]
    s_mul_i32 s82, s89, 384
    s_add_u32 s89, s89, 2048
    s_and_b32 s89, s89, 16383
    buffer_load_dwordx2 v[108:109], v20, s[12:15], s82 offen offset:0
    buffer_load_dwordx2 v[110:111], v20, s[16:19], s82 offen offset:192
    buffer_load_dwordx2 v[112:113], v20, s[12:15], s82 offen offset:128
    buffer_load_dwordx2 v[114:115], v21, s[16:19], s82 offen
    buffer_load_dwordx2 v[116:117], v20, s[12:15], s82 offen offset:256
    buffer_load_dwordx2 v[118:119], v20, s[16:19], s82 offen offset:64
L_ncs1:
    v_dot2_f32_bf16 v36, v84, v48, 0
    v_dot2_f32_bf16 v37, v86, v49, 0
    v_dot2_f32_bf16 v38, v85, v50, 0
    v_dot2_f32_bf16 v39, v87, v51, 0
    v_dot2_f32_bf16 v40, v88, v52, 0
    v_dot2_f32_bf16 v41, v90, v53, 0
    v_dot2_f32_bf16 v42, v89, v54, 0
    v_dot2_f32_bf16 v43, v91, v55, 0
    v_dot2_f32_bf16 v44, v92, v56, 0
    v_dot2_f32_bf16 v45, v94, v57, 0
    v_dot2_f32_bf16 v46, v93, v58, 0
    v_dot2_f32_bf16 v47, v95, v59, 0
    s_add_u32 s79, s79, 12
    s_cmp_ge_i32 s80, s79
    s_cbranch_scc1 L_kr10g
L_kr10:
    ds_read_b32 v19, v7
    s_sleep 1
    s_waitcnt lgkmcnt(0)
    v_readlane_b32 s80, v19, 5
    s_nop 0
    s_cmp_lt_i32 s80, s79
    s_cbranch_scc1 L_kr10
L_kr10g:
    ds_read_b32 v10, v3 offset:128
    ds_read_b128 v[24:27], v2 offset:24576
    ds_read_b128 v[28:31], v2 offset:24832
    ds_read_b128 v[32:35], v2 offset:25088
    v_add_u32 v6, 1, v6
    ds_write_b32 v5, v6
    s_waitcnt lgkmcnt(3)
    v_and_b32 v12, 0xffff0000, v10
    v_cvt_f32_i32 v24, v24
    v_cvt_f32_i32 v25, v25
    v_cvt_f32_i32 v26, v26
    v_cvt_f32_i32 v27, v27
    v_pk_add_f32 v[24:25], v[24:25], v[12:13] op_sel:[0,0] op_sel_hi:[1,0] neg_lo:[0,1] neg_hi:[0,1]
    v_pk_add_f32 v[26:27], v[26:27], v[12:13] op_sel:[0,0] op_sel_hi:[1,0] neg_lo:[0,1] neg_hi:[0,1]
    v_pk_mul_f32 v[14:15], v[24:25], v[36:37]
    v_pk_fma_f32 v[14:15], v[26:27], v[38:39], v[14:15]
    s_waitcnt lgkmcnt(2)
    v_cvt_f32_i32 v28, v28
    v_cvt_f32_i32 v29, v29
    v_cvt_f32_i32 v30, v30
    v_cvt_f32_i32 v31, v31
    v_pk_add_f32 v[28:29], v[28:29], v[12:13] op_sel:[0,0] op_sel_hi:[1,0] neg_lo:[0,1] neg_hi:[0,1]
    v_pk_add_f32 v[30:31], v[30:31], v[12:13] op_sel:[0,0] op_sel_hi:[1,0] neg_lo:[0,1] neg_hi:[0,1]
    v_pk_fma_f32 v[14:15], v[28:29], v[40:41], v[14:15]
    v_pk_fma_f32 v[14:15], v[30:31], v[42:43], v[14:15]
    s_waitcnt lgkmcnt(1)
    v_cvt_f32_i32 v32, v32
    v_cvt_f32_i32 v33, v33
    v_cvt_f32_i32 v34, v34
    v_cvt_f32_i32 v35, v35
    v_pk_add_f32 v[32:33], v[32:33], v[12:13] op_sel:[0,0] op_sel_hi:[1,0] neg_lo:[0,1] neg_hi:[0,1]
    v_pk_add_f32 v[34:35], v[34:35], v[12:13] op_sel:[0,0] op_sel_hi:[1,0] neg_lo:[0,1] neg_hi:[0,1]
    v_pk_fma_f32 v[14:15], v[32:33], v[44:45], v[14:15]
    v_pk_fma_f32 v[14:15], v[34:35], v[46:47], v[14:15]
    v_add_f32 v14, v14, v15
    s_nop 1
    v_add_f32_dpp v18, v14, v14 row_ror:8 row_mask:0xf bank_mask:0x3
    v_dot2_f32_bf16 v36, v84, v60, 0
    v_dot2_f32_bf16 v37, v86, v61, 0
    v_dot2_f32_bf16 v38, v85, v62, 0
    v_dot2_f32_bf16 v39, v87, v63, 0
    v_dot2_f32_bf16 v40, v88, v64, 0
    v_dot2_f32_bf16 v41, v90, v65, 0
    v_dot2_f32_bf16 v42, v89, v66, 0
    v_dot2_f32_bf16 v43, v91, v67, 0
    v_dot2_f32_bf16 v44, v92, v68, 0
    v_dot2_f32_bf16 v45, v94, v69, 0
    v_dot2_f32_bf16 v46, v93, v70, 0
    v_dot2_f32_bf16 v47, v95, v71, 0
    s_add_u32 s79, s79, 12
    s_cmp_ge_i32 s80, s79
    s_cbranch_scc1 L_kr11g
L_kr11:
    ds_read_b32 v19, v7
    s_sleep 1
    s_waitcnt lgkmcnt(0)
    v_readlane_b32 s80, v19, 5
    s_nop 0
    s_cmp_lt_i32 s80, s79
    s_cbranch_scc1 L_kr11
L_kr11g:
    ds_read_b32 v11, v3 offset:1152
    ds_read_b128 v[24:27], v2 offset:36864
    ds_read_b128 v[28:31], v2 offset:37120
    ds_read_b128 v[32:35], v2 offset:37376
    v_add_u32 v6, 1, v6
    ds_write_b32 v5, v6
    s_waitcnt lgkmcnt(3)
    v_and_b32 v12, 0xffff0000, v11
    v_cvt_f32_i32 v24, v24
    v_cvt_f32_i32 v25, v25
    v_cvt_f32_i32 v26, v26
    v_cvt_f32_i32 v27, v27
    v_pk_add_f32 v[24:25], v[24:25], v[12:13] op_sel:[0,0] op_sel_hi:[1,0] neg_lo:[0,1] neg_hi:[0,1]
    v_pk_add_f32 v[26:27], v[26:27], v[12:13] op_sel:[0,0] op_sel_hi:[1,0] neg_lo:[0,1] neg_hi:[0,1]
    v_pk_mul_f32 v[16:17], v[24:25], v[36:37]
    v_pk_fma_f32 v[16:17], v[26:27], v[38:39], v[16:17]
    s_waitcnt lgkmcnt(2)
    v_cvt_f32_i32 v28, v28
    v_cvt_f32_i32 v29, v29
    v_cvt_f32_i32 v30, v30
    v_cvt_f32_i32 v31, v31
    v_pk_add_f32 v[28:29], v[28:29], v[12:13] op_sel:[0,0] op_sel_hi:[1,0] neg_lo:[0,1] neg_hi:[0,1]
    v_pk_add_f32 v[30:31], v[30:31], v[12:13] op_sel:[0,0] op_sel_hi:[1,0] neg_lo:[0,1] neg_hi:[0,1]
    v_pk_fma_f32 v[16:17], v[28:29], v[40:41], v[16:17]
    v_pk_fma_f32 v[16:17], v[30:31], v[42:43], v[16:17]
    s_waitcnt lgkmcnt(1)
    v_cvt_f32_i32 v32, v32
    v_cvt_f32_i32 v33, v33
    v_cvt_f32_i32 v34, v34
    v_cvt_f32_i32 v35, v35
    v_pk_add_f32 v[32:33], v[32:33], v[12:13] op_sel:[0,0] op_sel_hi:[1,0] neg_lo:[0,1] neg_hi:[0,1]
    v_pk_add_f32 v[34:35], v[34:35], v[12:13] op_sel:[0,0] op_sel_hi:[1,0] neg_lo:[0,1] neg_hi:[0,1]
    v_pk_fma_f32 v[16:17], v[32:33], v[44:45], v[16:17]
    v_pk_fma_f32 v[16:17], v[34:35], v[46:47], v[16:17]
    v_add_f32 v16, v16, v17
    v_cndmask_b32 v23, v10, v11, s[86:87]
    v_lshlrev_b32 v23, 16, v23
    v_add_f32_dpp v18, v16, v16 row_ror:8 row_mask:0xf bank_mask:0xc
    v_mul_f32 v23, 0x3dd53b95, v23
    s_nop 0
    v_add_f32_dpp v18, v18, v18 row_half_mirror row_mask:0xf bank_mask:0xf
    s_nop 1
    v_add_f32_dpp v18, v18, v18 quad_perm:[2,3,0,1] row_mask:0xf bank_mask:0xf
    s_nop 1
    v_add_f32_dpp v18, v18, v18 quad_perm:[1,0,3,2] row_mask:0xf bank_mask:0xf
    v_mul_f32 v18, v23, v18
    ds_write_b32 v4, v18 offset:128
    s_cmp_lg_u32 s81, 0
    s_cbranch_scc1 L_ncs2
    s_waitcnt vmcnt(6)
    v_perm_b32 v36, v98, v96, s83
    v_perm_b32 v98, v98, v96, s84
    v_perm_b32 v37, v99, v97, s83
    v_perm_b32 v99, v99, v97, s84
    v_perm_b32 v38, v102, v100, s83
    v_perm_b32 v102, v102, v100, s84
    v_perm_b32 v39, v103, v101, s83
    v_perm_b32 v103, v103, v101, s84
    v_perm_b32 v40, v106, v104, s83
    v_perm_b32 v106, v106, v104, s84
    v_perm_b32 v41, v107, v105, s83
    v_perm_b32 v107, v107, v105, s84
    v_mov_b64 v[96:97], v[36:37]
    v_mov_b64 v[100:101], v[38:39]
    v_mov_b64 v[104:105], v[40:41]
    s_mul_i32 s82, s89, 384
    s_add_u32 s89, s89, 2048
    s_and_b32 s89, s89, 16383
    buffer_load_dwordx2 v[120:121], v20, s[12:15], s82 offen offset:0
    buffer_load_dwordx2 v[122:123], v20, s[16:19], s82 offen offset:192
    buffer_load_dwordx2 v[124:125], v20, s[12:15], s82 offen offset:128
    buffer_load_dwordx2 v[126:127], v21, s[16:19], s82 offen
    buffer_load_dwordx2 v[128:129], v20, s[12:15], s82 offen offset:256
    buffer_load_dwordx2 v[130:131], v20, s[16:19], s82 offen offset:64
L_ncs2:
    v_dot2_f32_bf16 v36, v96, v48, 0
    v_dot2_f32_bf16 v37, v98, v49, 0
    v_dot2_f32_bf16 v38, v97, v50, 0
    v_dot2_f32_bf16 v39, v99, v51, 0
    v_dot2_f32_bf16 v40, v100, v52, 0
    v_dot2_f32_bf16 v41, v102, v53, 0
    v_dot2_f32_bf16 v42, v101, v54, 0
    v_dot2_f32_bf16 v43, v103, v55, 0
    v_dot2_f32_bf16 v44, v104, v56, 0
    v_dot2_f32_bf16 v45, v106, v57, 0
    v_dot2_f32_bf16 v46, v105, v58, 0
    v_dot2_f32_bf16 v47, v107, v59, 0
    s_add_u32 s79, s79, 12
    s_cmp_ge_i32 s80, s79
    s_cbranch_scc1 L_kr20g
L_kr20:
    ds_read_b32 v19, v7
    s_sleep 1
    s_waitcnt lgkmcnt(0)
    v_readlane_b32 s80, v19, 5
    s_nop 0
    s_cmp_lt_i32 s80, s79
    s_cbranch_scc1 L_kr20
L_kr20g:
    ds_read_b32 v10, v3 offset:256
    ds_read_b128 v[24:27], v2 offset:0
    ds_read_b128 v[28:31], v2 offset:256
    ds_read_b128 v[32:35], v2 offset:512
    v_add_u32 v6, 1, v6
    ds_write_b32 v5, v6
    s_waitcnt lgkmcnt(3)
    v_and_b32 v12, 0xffff0000, v10
    v_cvt_f32_i32 v24, v24
    v_cvt_f32_i32 v25, v25
    v_cvt_f32_i32 v26, v26
    v_cvt_f32_i32 v27, v27
    v_pk_add_f32 v[24:25], v[24:25], v[12:13] op_sel:[0,0] op_sel_hi:[1,0] neg_lo:[0,1] neg_hi:[0,1]
    v_pk_add_f32 v[26:27], v[26:27], v[12:13] op_sel:[0,0] op_sel_hi:[1,0] neg_lo:[0,1] neg_hi:[0,1]
    v_pk_mul_f32 v[14:15], v[24:25], v[36:37]
    v_pk_fma_f32 v[14:15], v[26:27], v[38:39], v[14:15]
    s_waitcnt lgkmcnt(2)
    v_cvt_f32_i32 v28, v28
    v_cvt_f32_i32 v29, v29
    v_cvt_f32_i32 v30, v30
    v_cvt_f32_i32 v31, v31
    v_pk_add_f32 v[28:29], v[28:29], v[12:13] op_sel:[0,0] op_sel_hi:[1,0] neg_lo:[0,1] neg_hi:[0,1]
    v_pk_add_f32 v[30:31], v[30:31], v[12:13] op_sel:[0,0] op_sel_hi:[1,0] neg_lo:[0,1] neg_hi:[0,1]
    v_pk_fma_f32 v[14:15], v[28:29], v[40:41], v[14:15]
    v_pk_fma_f32 v[14:15], v[30:31], v[42:43], v[14:15]
    s_waitcnt lgkmcnt(1)
    v_cvt_f32_i32 v32, v32
    v_cvt_f32_i32 v33, v33
    v_cvt_f32_i32 v34, v34
    v_cvt_f32_i32 v35, v35
    v_pk_add_f32 v[32:33], v[32:33], v[12:13] op_sel:[0,0] op_sel_hi:[1,0] neg_lo:[0,1] neg_hi:[0,1]
    v_pk_add_f32 v[34:35], v[34:35], v[12:13] op_sel:[0,0] op_sel_hi:[1,0] neg_lo:[0,1] neg_hi:[0,1]
    v_pk_fma_f32 v[14:15], v[32:33], v[44:45], v[14:15]
    v_pk_fma_f32 v[14:15], v[34:35], v[46:47], v[14:15]
    v_add_f32 v14, v14, v15
    s_nop 1
    v_add_f32_dpp v18, v14, v14 row_ror:8 row_mask:0xf bank_mask:0x3
    v_dot2_f32_bf16 v36, v96, v60, 0
    v_dot2_f32_bf16 v37, v98, v61, 0
    v_dot2_f32_bf16 v38, v97, v62, 0
    v_dot2_f32_bf16 v39, v99, v63, 0
    v_dot2_f32_bf16 v40, v100, v64, 0
    v_dot2_f32_bf16 v41, v102, v65, 0
    v_dot2_f32_bf16 v42, v101, v66, 0
    v_dot2_f32_bf16 v43, v103, v67, 0
    v_dot2_f32_bf16 v44, v104, v68, 0
    v_dot2_f32_bf16 v45, v106, v69, 0
    v_dot2_f32_bf16 v46, v105, v70, 0
    v_dot2_f32_bf16 v47, v107, v71, 0
    s_add_u32 s79, s79, 12
    s_cmp_ge_i32 s80, s79
    s_cbranch_scc1 L_kr21g
L_kr21:
    ds_read_b32 v19, v7
    s_sleep 1
    s_waitcnt lgkmcnt(0)
    v_readlane_b32 s80, v19, 5
    s_nop 0
    s_cmp_lt_i32 s80, s79
    s_cbranch_scc1 L_kr21
L_kr21g:
    ds_read_b32 v11, v3 offset:1280
    ds_read_b128 v[24:27], v2 offset:12288
    ds_read_b128 v[28:31], v2 offset:12544
    ds_read_b128 v[32:35], v2 offset:12800
    v_add_u32 v6, 1, v6
    ds_write_b32 v5, v6
    s_waitcnt lgkmcnt(3)
    v_and_b32 v12, 0xffff0000, v11
    v_cvt_f32_i32 v24, v24
    v_cvt_f32_i32 v25, v25
    v_cvt_f32_i32 v26, v26
    v_cvt_f32_i32 v27, v27
    v_pk_add_f32 v[24:25], v[24:25], v[12:13] op_sel:[0,0] op_sel_hi:[1,0] neg_lo:[0,1] neg_hi:[0,1]
    v_pk_add_f32 v[26:27], v[26:27], v[12:13] op_sel:[0,0] op_sel_hi:[1,0] neg_lo:[0,1] neg_hi:[0,1]
    v_pk_mul_f32 v[16:17], v[24:25], v[36:37]
    v_pk_fma_f32 v[16:17], v[26:27], v[38:39], v[16:17]
    s_waitcnt lgkmcnt(2)
    v_cvt_f32_i32 v28, v28
    v_cvt_f32_i32 v29, v29
    v_cvt_f32_i32 v30, v30
    v_cvt_f32_i32 v31, v31
    v_pk_add_f32 v[28:29], v[28:29], v[12:13] op_sel:[0,0] op_sel_hi:[1,0] neg_lo:[0,1] neg_hi:[0,1]
    v_pk_add_f32 v[30:31], v[30:31], v[12:13] op_sel:[0,0] op_sel_hi:[1,0] neg_lo:[0,1] neg_hi:[0,1]
    v_pk_fma_f32 v[16:17], v[28:29], v[40:41], v[16:17]
    v_pk_fma_f32 v[16:17], v[30:31], v[42:43], v[16:17]
    s_waitcnt lgkmcnt(1)
    v_cvt_f32_i32 v32, v32
    v_cvt_f32_i32 v33, v33
    v_cvt_f32_i32 v34, v34
    v_cvt_f32_i32 v35, v35
    v_pk_add_f32 v[32:33], v[32:33], v[12:13] op_sel:[0,0] op_sel_hi:[1,0] neg_lo:[0,1] neg_hi:[0,1]
    v_pk_add_f32 v[34:35], v[34:35], v[12:13] op_sel:[0,0] op_sel_hi:[1,0] neg_lo:[0,1] neg_hi:[0,1]
    v_pk_fma_f32 v[16:17], v[32:33], v[44:45], v[16:17]
    v_pk_fma_f32 v[16:17], v[34:35], v[46:47], v[16:17]
    v_add_f32 v16, v16, v17
    v_cndmask_b32 v23, v10, v11, s[86:87]
    v_lshlrev_b32 v23, 16, v23
    v_add_f32_dpp v18, v16, v16 row_ror:8 row_mask:0xf bank_mask:0xc
    v_mul_f32 v23, 0x3dd53b95, v23
    s_nop 0
    v_add_f32_dpp v18, v18, v18 row_half_mirror row_mask:0xf bank_mask:0xf
    s_nop 1
    v_add_f32_dpp v18, v18, v18 quad_perm:[2,3,0,1] row_mask:0xf bank_mask:0xf
    s_nop 1
    v_add_f32_dpp v18, v18, v18 quad_perm:[1,0,3,2] row_mask:0xf bank_mask:0xf
    v_mul_f32 v18, v23, v18
    ds_write_b32 v4, v18 offset:256
    s_cmp_lg_u32 s81, 0
    s_cbranch_scc1 L_ncs3
    s_waitcnt vmcnt(6)
    v_perm_b32 v36, v110, v108, s83
    v_perm_b32 v110, v110, v108, s84
    v_perm_b32 v37, v111, v109, s83
    v_perm_b32 v111, v111, v109, s84
    v_perm_b32 v38, v114, v112, s83
    v_perm_b32 v114, v114, v112, s84
    v_perm_b32 v39, v115, v113, s83
    v_perm_b32 v115, v115, v113, s84
    v_perm_b32 v40, v118, v116, s83
    v_perm_b32 v118, v118, v116, s84
    v_perm_b32 v41, v119, v117, s83
    v_perm_b32 v119, v119, v117, s84
    v_mov_b64 v[108:109], v[36:37]
    v_mov_b64 v[112:113], v[38:39]
    v_mov_b64 v[116:117], v[40:41]
    s_mul_i32 s82, s89, 384
    s_add_u32 s89, s89, 2048
    s_and_b32 s89, s89, 16383
    buffer_load_dwordx2 v[132:133], v20, s[12:15], s82 offen offset:0
    buffer_load_dwordx2 v[134:135], v20, s[16:19], s82 offen offset:192
    buffer_load_dwordx2 v[136:137], v20, s[12:15], s82 offen offset:128
    buffer_load_dwordx2 v[138:139], v21, s[16:19], s82 offen
    buffer_load_dwordx2 v[140:141], v20, s[12:15], s82 offen offset:256
    buffer_load_dwordx2 v[142:143], v20, s[16:19], s82 offen offset:64
L_ncs3:
    v_dot2_f32_bf16 v36, v108, v48, 0
    v_dot2_f32_bf16 v37, v110, v49, 0
    v_dot2_f32_bf16 v38, v109, v50, 0
    v_dot2_f32_bf16 v39, v111, v51, 0
    v_dot2_f32_bf16 v40, v112, v52, 0
    v_dot2_f32_bf16 v41, v114, v53, 0
    v_dot2_f32_bf16 v42, v113, v54, 0
    v_dot2_f32_bf16 v43, v115, v55, 0
    v_dot2_f32_bf16 v44, v116, v56, 0
    v_dot2_f32_bf16 v45, v118, v57, 0
    v_dot2_f32_bf16 v46, v117, v58, 0
    v_dot2_f32_bf16 v47, v119, v59, 0
    s_add_u32 s79, s79, 12
    s_cmp_ge_i32 s80, s79
    s_cbranch_scc1 L_kr30g
L_kr30:
    ds_read_b32 v19, v7
    s_sleep 1
    s_waitcnt lgkmcnt(0)
    v_readlane_b32 s80, v19, 5
    s_nop 0
    s_cmp_lt_i32 s80, s79
    s_cbranch_scc1 L_kr30
L_kr30g:
    ds_read_b32 v10, v3 offset:384
    ds_read_b128 v[24:27], v2 offset:24576
    ds_read_b128 v[28:31], v2 offset:24832
    ds_read_b128 v[32:35], v2 offset:25088
    v_add_u32 v6, 1, v6
    ds_write_b32 v5, v6
    s_waitcnt lgkmcnt(3)
    v_and_b32 v12, 0xffff0000, v10
    v_cvt_f32_i32 v24, v24
    v_cvt_f32_i32 v25, v25
    v_cvt_f32_i32 v26, v26
    v_cvt_f32_i32 v27, v27
    v_pk_add_f32 v[24:25], v[24:25], v[12:13] op_sel:[0,0] op_sel_hi:[1,0] neg_lo:[0,1] neg_hi:[0,1]
    v_pk_add_f32 v[26:27], v[26:27], v[12:13] op_sel:[0,0] op_sel_hi:[1,0] neg_lo:[0,1] neg_hi:[0,1]
    v_pk_mul_f32 v[14:15], v[24:25], v[36:37]
    v_pk_fma_f32 v[14:15], v[26:27], v[38:39], v[14:15]
    s_waitcnt lgkmcnt(2)
    v_cvt_f32_i32 v28, v28
    v_cvt_f32_i32 v29, v29
    v_cvt_f32_i32 v30, v30
    v_cvt_f32_i32 v31, v31
    v_pk_add_f32 v[28:29], v[28:29], v[12:13] op_sel:[0,0] op_sel_hi:[1,0] neg_lo:[0,1] neg_hi:[0,1]
    v_pk_add_f32 v[30:31], v[30:31], v[12:13] op_sel:[0,0] op_sel_hi:[1,0] neg_lo:[0,1] neg_hi:[0,1]
    v_pk_fma_f32 v[14:15], v[28:29], v[40:41], v[14:15]
    v_pk_fma_f32 v[14:15], v[30:31], v[42:43], v[14:15]
    s_waitcnt lgkmcnt(1)
    v_cvt_f32_i32 v32, v32
    v_cvt_f32_i32 v33, v33
    v_cvt_f32_i32 v34, v34
    v_cvt_f32_i32 v35, v35
    v_pk_add_f32 v[32:33], v[32:33], v[12:13] op_sel:[0,0] op_sel_hi:[1,0] neg_lo:[0,1] neg_hi:[0,1]
    v_pk_add_f32 v[34:35], v[34:35], v[12:13] op_sel:[0,0] op_sel_hi:[1,0] neg_lo:[0,1] neg_hi:[0,1]
    v_pk_fma_f32 v[14:15], v[32:33], v[44:45], v[14:15]
    v_pk_fma_f32 v[14:15], v[34:35], v[46:47], v[14:15]
    v_add_f32 v14, v14, v15
    s_nop 1
    v_add_f32_dpp v18, v14, v14 row_ror:8 row_mask:0xf bank_mask:0x3
    v_dot2_f32_bf16 v36, v108, v60, 0
    v_dot2_f32_bf16 v37, v110, v61, 0
    v_dot2_f32_bf16 v38, v109, v62, 0
    v_dot2_f32_bf16 v39, v111, v63, 0
    v_dot2_f32_bf16 v40, v112, v64, 0
    v_dot2_f32_bf16 v41, v114, v65, 0
    v_dot2_f32_bf16 v42, v113, v66, 0
    v_dot2_f32_bf16 v43, v115, v67, 0
    v_dot2_f32_bf16 v44, v116, v68, 0
    v_dot2_f32_bf16 v45, v118, v69, 0
    v_dot2_f32_bf16 v46, v117, v70, 0
    v_dot2_f32_bf16 v47, v119, v71, 0
    s_add_u32 s79, s79, 12
    s_cmp_ge_i32 s80, s79
    s_cbranch_scc1 L_kr31g
L_kr31:
    ds_read_b32 v19, v7
    s_sleep 1
    s_waitcnt lgkmcnt(0)
    v_readlane_b32 s80, v19, 5
    s_nop 0
    s_cmp_lt_i32 s80, s79
    s_cbranch_scc1 L_kr31
L_kr31g:
    ds_read_b32 v11, v3 offset:1408
    ds_read_b128 v[24:27], v2 offset:36864
    ds_read_b128 v[28:31], v2 offset:37120
    ds_read_b128 v[32:35], v2 offset:37376
    v_add_u32 v6, 1, v6
    ds_write_b32 v5, v6
    s_waitcnt lgkmcnt(3)
    v_and_b32 v12, 0xffff0000, v11
    v_cvt_f32_i32 v24, v24
    v_cvt_f32_i32 v25, v25
    v_cvt_f32_i32 v26, v26
    v_cvt_f32_i32 v27, v27
    v_pk_add_f32 v[24:25], v[24:25], v[12:13] op_sel:[0,0] op_sel_hi:[1,0] neg_lo:[0,1] neg_hi:[0,1]
    v_pk_add_f32 v[26:27], v[26:27], v[12:13] op_sel:[0,0] op_sel_hi:[1,0] neg_lo:[0,1] neg_hi:[0,1]
    v_pk_mul_f32 v[16:17], v[24:25], v[36:37]
    v_pk_fma_f32 v[16:17], v[26:27], v[38:39], v[16:17]
    s_waitcnt lgkmcnt(2)
    v_cvt_f32_i32 v28, v28
    v_cvt_f32_i32 v29, v29
    v_cvt_f32_i32 v30, v30
    v_cvt_f32_i32 v31, v31
    v_pk_add_f32 v[28:29], v[28:29], v[12:13] op_sel:[0,0] op_sel_hi:[1,0] neg_lo:[0,1] neg_hi:[0,1]
    v_pk_add_f32 v[30:31], v[30:31], v[12:13] op_sel:[0,0] op_sel_hi:[1,0] neg_lo:[0,1] neg_hi:[0,1]
    v_pk_fma_f32 v[16:17], v[28:29], v[40:41], v[16:17]
    v_pk_fma_f32 v[16:17], v[30:31], v[42:43], v[16:17]
    s_waitcnt lgkmcnt(1)
    v_cvt_f32_i32 v32, v32
    v_cvt_f32_i32 v33, v33
    v_cvt_f32_i32 v34, v34
    v_cvt_f32_i32 v35, v35
    v_pk_add_f32 v[32:33], v[32:33], v[12:13] op_sel:[0,0] op_sel_hi:[1,0] neg_lo:[0,1] neg_hi:[0,1]
    v_pk_add_f32 v[34:35], v[34:35], v[12:13] op_sel:[0,0] op_sel_hi:[1,0] neg_lo:[0,1] neg_hi:[0,1]
    v_pk_fma_f32 v[16:17], v[32:33], v[44:45], v[16:17]
    v_pk_fma_f32 v[16:17], v[34:35], v[46:47], v[16:17]
    v_add_f32 v16, v16, v17
    v_cndmask_b32 v23, v10, v11, s[86:87]
    v_lshlrev_b32 v23, 16, v23
    v_add_f32_dpp v18, v16, v16 row_ror:8 row_mask:0xf bank_mask:0xc
    v_mul_f32 v23, 0x3dd53b95, v23
    s_nop 0
    v_add_f32_dpp v18, v18, v18 row_half_mirror row_mask:0xf bank_mask:0xf
    s_nop 1
    v_add_f32_dpp v18, v18, v18 quad_perm:[2,3,0,1] row_mask:0xf bank_mask:0xf
    s_nop 1
    v_add_f32_dpp v18, v18, v18 quad_perm:[1,0,3,2] row_mask:0xf bank_mask:0xf
    v_mul_f32 v18, v23, v18
    ds_write_b32 v4, v18 offset:384
    s_cmp_lg_u32 s81, 0
    s_cbranch_scc1 L_ncs4
    s_waitcnt vmcnt(6)
    v_perm_b32 v36, v122, v120, s83
    v_perm_b32 v122, v122, v120, s84
    v_perm_b32 v37, v123, v121, s83
    v_perm_b32 v123, v123, v121, s84
    v_perm_b32 v38, v126, v124, s83
    v_perm_b32 v126, v126, v124, s84
    v_perm_b32 v39, v127, v125, s83
    v_perm_b32 v127, v127, v125, s84
    v_perm_b32 v40, v130, v128, s83
    v_perm_b32 v130, v130, v128, s84
    v_perm_b32 v41, v131, v129, s83
    v_perm_b32 v131, v131, v129, s84
    v_mov_b64 v[120:121], v[36:37]
    v_mov_b64 v[124:125], v[38:39]
    v_mov_b64 v[128:129], v[40:41]
    s_mul_i32 s82, s89, 384
    s_add_u32 s89, s89, 2048
    s_and_b32 s89, s89, 16383
    buffer_load_dwordx2 v[144:145], v20, s[12:15], s82 offen offset:0
    buffer_load_dwordx2 v[146:147], v20, s[16:19], s82 offen offset:192
    buffer_load_dwordx2 v[148:149], v20, s[12:15], s82 offen offset:128
    buffer_load_dwordx2 v[150:151], v21, s[16:19], s82 offen
    buffer_load_dwordx2 v[152:153], v20, s[12:15], s82 offen offset:256
    buffer_load_dwordx2 v[154:155], v20, s[16:19], s82 offen offset:64
L_ncs4:
    v_dot2_f32_bf16 v36, v120, v48, 0
    v_dot2_f32_bf16 v37, v122, v49, 0
    v_dot2_f32_bf16 v38, v121, v50, 0
    v_dot2_f32_bf16 v39, v123, v51, 0
    v_dot2_f32_bf16 v40, v124, v52, 0
    v_dot2_f32_bf16 v41, v126, v53, 0
    v_dot2_f32_bf16 v42, v125, v54, 0
    v_dot2_f32_bf16 v43, v127, v55, 0
    v_dot2_f32_bf16 v44, v128, v56, 0
    v_dot2_f32_bf16 v45, v130, v57, 0
    v_dot2_f32_bf16 v46, v129, v58, 0
    v_dot2_f32_bf16 v47, v131, v59, 0
    s_add_u32 s79, s79, 12
    s_cmp_ge_i32 s80, s79
    s_cbranch_scc1 L_kr40g
L_kr40:
    ds_read_b32 v19, v7
    s_sleep 1
    s_waitcnt lgkmcnt(0)
    v_readlane_b32 s80, v19, 5
    s_nop 0
    s_cmp_lt_i32 s80, s79
    s_cbranch_scc1 L_kr40
L_kr40g:
    ds_read_b32 v10, v3 offset:512
    ds_read_b128 v[24:27], v2 offset:0
    ds_read_b128 v[28:31], v2 offset:256
    ds_read_b128 v[32:35], v2 offset:512
    v_add_u32 v6, 1, v6
    ds_write_b32 v5, v6
    s_waitcnt lgkmcnt(3)
    v_and_b32 v12, 0xffff0000, v10
    v_cvt_f32_i32 v24, v24
    v_cvt_f32_i32 v25, v25
    v_cvt_f32_i32 v26, v26
    v_cvt_f32_i32 v27, v27
    v_pk_add_f32 v[24:25], v[24:25], v[12:13] op_sel:[0,0] op_sel_hi:[1,0] neg_lo:[0,1] neg_hi:[0,1]
    v_pk_add_f32 v[26:27], v[26:27], v[12:13] op_sel:[0,0] op_sel_hi:[1,0] neg_lo:[0,1] neg_hi:[0,1]
    v_pk_mul_f32 v[14:15], v[24:25], v[36:37]
    v_pk_fma_f32 v[14:15], v[26:27], v[38:39], v[14:15]
    s_waitcnt lgkmcnt(2)
    v_cvt_f32_i32 v28, v28
    v_cvt_f32_i32 v29, v29
    v_cvt_f32_i32 v30, v30
    v_cvt_f32_i32 v31, v31
    v_pk_add_f32 v[28:29], v[28:29], v[12:13] op_sel:[0,0] op_sel_hi:[1,0] neg_lo:[0,1] neg_hi:[0,1]
    v_pk_add_f32 v[30:31], v[30:31], v[12:13] op_sel:[0,0] op_sel_hi:[1,0] neg_lo:[0,1] neg_hi:[0,1]
    v_pk_fma_f32 v[14:15], v[28:29], v[40:41], v[14:15]
    v_pk_fma_f32 v[14:15], v[30:31], v[42:43], v[14:15]
    s_waitcnt lgkmcnt(1)
    v_cvt_f32_i32 v32, v32
    v_cvt_f32_i32 v33, v33
    v_cvt_f32_i32 v34, v34
    v_cvt_f32_i32 v35, v35
    v_pk_add_f32 v[32:33], v[32:33], v[12:13] op_sel:[0,0] op_sel_hi:[1,0] neg_lo:[0,1] neg_hi:[0,1]
    v_pk_add_f32 v[34:35], v[34:35], v[12:13] op_sel:[0,0] op_sel_hi:[1,0] neg_lo:[0,1] neg_hi:[0,1]
    v_pk_fma_f32 v[14:15], v[32:33], v[44:45], v[14:15]
    v_pk_fma_f32 v[14:15], v[34:35], v[46:47], v[14:15]
    v_add_f32 v14, v14, v15
    s_nop 1
    v_add_f32_dpp v18, v14, v14 row_ror:8 row_mask:0xf bank_mask:0x3
    v_dot2_f32_bf16 v36, v120, v60, 0
    v_dot2_f32_bf16 v37, v122, v61, 0
    v_dot2_f32_bf16 v38, v121, v62, 0
    v_dot2_f32_bf16 v39, v123, v63, 0
    v_dot2_f32_bf16 v40, v124, v64, 0
    v_dot2_f32_bf16 v41, v126, v65, 0
    v_dot2_f32_bf16 v42, v125, v66, 0
    v_dot2_f32_bf16 v43, v127, v67, 0
    v_dot2_f32_bf16 v44, v128, v68, 0
    v_dot2_f32_bf16 v45, v130, v69, 0
    v_dot2_f32_bf16 v46, v129, v70, 0
    v_dot2_f32_bf16 v47, v131, v71, 0
    s_add_u32 s79, s79, 12
    s_cmp_ge_i32 s80, s79
    s_cbranch_scc1 L_kr41g
L_kr41:
    ds_read_b32 v19, v7
    s_sleep 1
    s_waitcnt lgkmcnt(0)
    v_readlane_b32 s80, v19, 5
    s_nop 0
    s_cmp_lt_i32 s80, s79
    s_cbranch_scc1 L_kr41
L_kr41g:
    ds_read_b32 v11, v3 offset:1536
    ds_read_b128 v[24:27], v2 offset:12288
    ds_read_b128 v[28:31], v2 offset:12544
    ds_read_b128 v[32:35], v2 offset:12800
    v_add_u32 v6, 1, v6
    ds_write_b32 v5, v6
    s_waitcnt lgkmcnt(3)
    v_and_b32 v12, 0xffff0000, v11
    v_cvt_f32_i32 v24, v24
    v_cvt_f32_i32 v25, v25
    v_cvt_f32_i32 v26, v26
    v_cvt_f32_i32 v27, v27
    v_pk_add_f32 v[24:25], v[24:25], v[12:13] op_sel:[0,0] op_sel_hi:[1,0] neg_lo:[0,1] neg_hi:[0,1]
    v_pk_add_f32 v[26:27], v[26:27], v[12:13] op_sel:[0,0] op_sel_hi:[1,0] neg_lo:[0,1] neg_hi:[0,1]
    v_pk_mul_f32 v[16:17], v[24:25], v[36:37]
    v_pk_fma_f32 v[16:17], v[26:27], v[38:39], v[16:17]
    s_waitcnt lgkmcnt(2)
    v_cvt_f32_i32 v28, v28
    v_cvt_f32_i32 v29, v29
    v_cvt_f32_i32 v30, v30
    v_cvt_f32_i32 v31, v31
    v_pk_add_f32 v[28:29], v[28:29], v[12:13] op_sel:[0,0] op_sel_hi:[1,0] neg_lo:[0,1] neg_hi:[0,1]
    v_pk_add_f32 v[30:31], v[30:31], v[12:13] op_sel:[0,0] op_sel_hi:[1,0] neg_lo:[0,1] neg_hi:[0,1]
    v_pk_fma_f32 v[16:17], v[28:29], v[40:41], v[16:17]
    v_pk_fma_f32 v[16:17], v[30:31], v[42:43], v[16:17]
    s_waitcnt lgkmcnt(1)
    v_cvt_f32_i32 v32, v32
    v_cvt_f32_i32 v33, v33
    v_cvt_f32_i32 v34, v34
    v_cvt_f32_i32 v35, v35
    v_pk_add_f32 v[32:33], v[32:33], v[12:13] op_sel:[0,0] op_sel_hi:[1,0] neg_lo:[0,1] neg_hi:[0,1]
    v_pk_add_f32 v[34:35], v[34:35], v[12:13] op_sel:[0,0] op_sel_hi:[1,0] neg_lo:[0,1] neg_hi:[0,1]
    v_pk_fma_f32 v[16:17], v[32:33], v[44:45], v[16:17]
    v_pk_fma_f32 v[16:17], v[34:35], v[46:47], v[16:17]
    v_add_f32 v16, v16, v17
    v_cndmask_b32 v23, v10, v11, s[86:87]
    v_lshlrev_b32 v23, 16, v23
    v_add_f32_dpp v18, v16, v16 row_ror:8 row_mask:0xf bank_mask:0xc
    v_mul_f32 v23, 0x3dd53b95, v23
    s_nop 0
    v_add_f32_dpp v18, v18, v18 row_half_mirror row_mask:0xf bank_mask:0xf
    s_nop 1
    v_add_f32_dpp v18, v18, v18 quad_perm:[2,3,0,1] row_mask:0xf bank_mask:0xf
    s_nop 1
    v_add_f32_dpp v18, v18, v18 quad_perm:[1,0,3,2] row_mask:0xf bank_mask:0xf
    v_mul_f32 v18, v23, v18
    ds_write_b32 v4, v18 offset:512
    s_cmp_lg_u32 s81, 0
    s_cbranch_scc1 L_ncs5
    s_waitcnt vmcnt(6)
    v_perm_b32 v36, v134, v132, s83
    v_perm_b32 v134, v134, v132, s84
    v_perm_b32 v37, v135, v133, s83
    v_perm_b32 v135, v135, v133, s84
    v_perm_b32 v38, v138, v136, s83
    v_perm_b32 v138, v138, v136, s84
    v_perm_b32 v39, v139, v137, s83
    v_perm_b32 v139, v139, v137, s84
    v_perm_b32 v40, v142, v140, s83
    v_perm_b32 v142, v142, v140, s84
    v_perm_b32 v41, v143, v141, s83
    v_perm_b32 v143, v143, v141, s84
    v_mov_b64 v[132:133], v[36:37]
    v_mov_b64 v[136:137], v[38:39]
    v_mov_b64 v[140:141], v[40:41]
    s_mul_i32 s82, s89, 384
    s_add_u32 s89, s89, 2048
    s_and_b32 s89, s89, 16383
    buffer_load_dwordx2 v[156:157], v20, s[12:15], s82 offen offset:0
    buffer_load_dwordx2 v[158:159], v20, s[16:19], s82 offen offset:192
    buffer_load_dwordx2 v[160:161], v20, s[12:15], s82 offen offset:128
    buffer_load_dwordx2 v[162:163], v21, s[16:19], s82 offen
    buffer_load_dwordx2 v[164:165], v20, s[12:15], s82 offen offset:256
    buffer_load_dwordx2 v[166:167], v20, s[16:19], s82 offen offset:64
L_ncs5:
    v_dot2_f32_bf16 v36, v132, v48, 0
    v_dot2_f32_bf16 v37, v134, v49, 0
    v_dot2_f32_bf16 v38, v133, v50, 0
    v_dot2_f32_bf16 v39, v135, v51, 0
    v_dot2_f32_bf16 v40, v136, v52, 0
    v_dot2_f32_bf16 v41, v138, v53, 0
    v_dot2_f32_bf16 v42, v137, v54, 0
    v_dot2_f32_bf16 v43, v139, v55, 0
    v_dot2_f32_bf16 v44, v140, v56, 0
    v_dot2_f32_bf16 v45, v142, v57, 0
    v_dot2_f32_bf16 v46, v141, v58, 0
    v_dot2_f32_bf16 v47, v143, v59, 0
    s_add_u32 s79, s79, 12
    s_cmp_ge_i32 s80, s79
    s_cbranch_scc1 L_kr50g
L_kr50:
    ds_read_b32 v19, v7
    s_sleep 1
    s_waitcnt lgkmcnt(0)
    v_readlane_b32 s80, v19, 5
    s_nop 0
    s_cmp_lt_i32 s80, s79
    s_cbranch_scc1 L_kr50
L_kr50g:
    ds_read_b32 v10, v3 offset:640
    ds_read_b128 v[24:27], v2 offset:24576
    ds_read_b128 v[28:31], v2 offset:24832
    ds_read_b128 v[32:35], v2 offset:25088
    v_add_u32 v6, 1, v6
    ds_write_b32 v5, v6
    s_waitcnt lgkmcnt(3)
    v_and_b32 v12, 0xffff0000, v10
    v_cvt_f32_i32 v24, v24
    v_cvt_f32_i32 v25, v25
    v_cvt_f32_i32 v26, v26
    v_cvt_f32_i32 v27, v27
    v_pk_add_f32 v[24:25], v[24:25], v[12:13] op_sel:[0,0] op_sel_hi:[1,0] neg_lo:[0,1] neg_hi:[0,1]
    v_pk_add_f32 v[26:27], v[26:27], v[12:13] op_sel:[0,0] op_sel_hi:[1,0] neg_lo:[0,1] neg_hi:[0,1]
    v_pk_mul_f32 v[14:15], v[24:25], v[36:37]
    v_pk_fma_f32 v[14:15], v[26:27], v[38:39], v[14:15]
    s_waitcnt lgkmcnt(2)
    v_cvt_f32_i32 v28, v28
    v_cvt_f32_i32 v29, v29
    v_cvt_f32_i32 v30, v30
    v_cvt_f32_i32 v31, v31
    v_pk_add_f32 v[28:29], v[28:29], v[12:13] op_sel:[0,0] op_sel_hi:[1,0] neg_lo:[0,1] neg_hi:[0,1]
    v_pk_add_f32 v[30:31], v[30:31], v[12:13] op_sel:[0,0] op_sel_hi:[1,0] neg_lo:[0,1] neg_hi:[0,1]
    v_pk_fma_f32 v[14:15], v[28:29], v[40:41], v[14:15]
    v_pk_fma_f32 v[14:15], v[30:31], v[42:43], v[14:15]
    s_waitcnt lgkmcnt(1)
    v_cvt_f32_i32 v32, v32
    v_cvt_f32_i32 v33, v33
    v_cvt_f32_i32 v34, v34
    v_cvt_f32_i32 v35, v35
    v_pk_add_f32 v[32:33], v[32:33], v[12:13] op_sel:[0,0] op_sel_hi:[1,0] neg_lo:[0,1] neg_hi:[0,1]
    v_pk_add_f32 v[34:35], v[34:35], v[12:13] op_sel:[0,0] op_sel_hi:[1,0] neg_lo:[0,1] neg_hi:[0,1]
    v_pk_fma_f32 v[14:15], v[32:33], v[44:45], v[14:15]
    v_pk_fma_f32 v[14:15], v[34:35], v[46:47], v[14:15]
    v_add_f32 v14, v14, v15
    s_nop 1
    v_add_f32_dpp v18, v14, v14 row_ror:8 row_mask:0xf bank_mask:0x3
    v_dot2_f32_bf16 v36, v132, v60, 0
    v_dot2_f32_bf16 v37, v134, v61, 0
    v_dot2_f32_bf16 v38, v133, v62, 0
    v_dot2_f32_bf16 v39, v135, v63, 0
    v_dot2_f32_bf16 v40, v136, v64, 0
    v_dot2_f32_bf16 v41, v138, v65, 0
    v_dot2_f32_bf16 v42, v137, v66, 0
    v_dot2_f32_bf16 v43, v139, v67, 0
    v_dot2_f32_bf16 v44, v140, v68, 0
    v_dot2_f32_bf16 v45, v142, v69, 0
    v_dot2_f32_bf16 v46, v141, v70, 0
    v_dot2_f32_bf16 v47, v143, v71, 0
    s_add_u32 s79, s79, 12
    s_cmp_ge_i32 s80, s79
    s_cbranch_scc1 L_kr51g
L_kr51:
    ds_read_b32 v19, v7
    s_sleep 1
    s_waitcnt lgkmcnt(0)
    v_readlane_b32 s80, v19, 5
    s_nop 0
    s_cmp_lt_i32 s80, s79
    s_cbranch_scc1 L_kr51
L_kr51g:
    ds_read_b32 v11, v3 offset:1664
    ds_read_b128 v[24:27], v2 offset:36864
    ds_read_b128 v[28:31], v2 offset:37120
    ds_read_b128 v[32:35], v2 offset:37376
    v_add_u32 v6, 1, v6
    ds_write_b32 v5, v6
    s_waitcnt lgkmcnt(3)
    v_and_b32 v12, 0xffff0000, v11
    v_cvt_f32_i32 v24, v24
    v_cvt_f32_i32 v25, v25
    v_cvt_f32_i32 v26, v26
    v_cvt_f32_i32 v27, v27
    v_pk_add_f32 v[24:25], v[24:25], v[12:13] op_sel:[0,0] op_sel_hi:[1,0] neg_lo:[0,1] neg_hi:[0,1]
    v_pk_add_f32 v[26:27], v[26:27], v[12:13] op_sel:[0,0] op_sel_hi:[1,0] neg_lo:[0,1] neg_hi:[0,1]
    v_pk_mul_f32 v[16:17], v[24:25], v[36:37]
    v_pk_fma_f32 v[16:17], v[26:27], v[38:39], v[16:17]
    s_waitcnt lgkmcnt(2)
    v_cvt_f32_i32 v28, v28
    v_cvt_f32_i32 v29, v29
    v_cvt_f32_i32 v30, v30
    v_cvt_f32_i32 v31, v31
    v_pk_add_f32 v[28:29], v[28:29], v[12:13] op_sel:[0,0] op_sel_hi:[1,0] neg_lo:[0,1] neg_hi:[0,1]
    v_pk_add_f32 v[30:31], v[30:31], v[12:13] op_sel:[0,0] op_sel_hi:[1,0] neg_lo:[0,1] neg_hi:[0,1]
    v_pk_fma_f32 v[16:17], v[28:29], v[40:41], v[16:17]
    v_pk_fma_f32 v[16:17], v[30:31], v[42:43], v[16:17]
    s_waitcnt lgkmcnt(1)
    v_cvt_f32_i32 v32, v32
    v_cvt_f32_i32 v33, v33
    v_cvt_f32_i32 v34, v34
    v_cvt_f32_i32 v35, v35
    v_pk_add_f32 v[32:33], v[32:33], v[12:13] op_sel:[0,0] op_sel_hi:[1,0] neg_lo:[0,1] neg_hi:[0,1]
    v_pk_add_f32 v[34:35], v[34:35], v[12:13] op_sel:[0,0] op_sel_hi:[1,0] neg_lo:[0,1] neg_hi:[0,1]
    v_pk_fma_f32 v[16:17], v[32:33], v[44:45], v[16:17]
    v_pk_fma_f32 v[16:17], v[34:35], v[46:47], v[16:17]
    v_add_f32 v16, v16, v17
    v_cndmask_b32 v23, v10, v11, s[86:87]
    v_lshlrev_b32 v23, 16, v23
    v_add_f32_dpp v18, v16, v16 row_ror:8 row_mask:0xf bank_mask:0xc
    v_mul_f32 v23, 0x3dd53b95, v23
    s_nop 0
    v_add_f32_dpp v18, v18, v18 row_half_mirror row_mask:0xf bank_mask:0xf
    s_nop 1
    v_add_f32_dpp v18, v18, v18 quad_perm:[2,3,0,1] row_mask:0xf bank_mask:0xf
    s_nop 1
    v_add_f32_dpp v18, v18, v18 quad_perm:[1,0,3,2] row_mask:0xf bank_mask:0xf
    v_mul_f32 v18, v23, v18
    ds_write_b32 v4, v18 offset:640
    s_cmp_lg_u32 s81, 0
    s_cbranch_scc1 L_ncs6
    s_waitcnt vmcnt(6)
    v_perm_b32 v36, v146, v144, s83
    v_perm_b32 v146, v146, v144, s84
    v_perm_b32 v37, v147, v145, s83
    v_perm_b32 v147, v147, v145, s84
    v_perm_b32 v38, v150, v148, s83
    v_perm_b32 v150, v150, v148, s84
    v_perm_b32 v39, v151, v149, s83
    v_perm_b32 v151, v151, v149, s84
    v_perm_b32 v40, v154, v152, s83
    v_perm_b32 v154, v154, v152, s84
    v_perm_b32 v41, v155, v153, s83
    v_perm_b32 v155, v155, v153, s84
    v_mov_b64 v[144:145], v[36:37]
    v_mov_b64 v[148:149], v[38:39]
    v_mov_b64 v[152:153], v[40:41]
    s_nop 1
L_ncs6:
    v_dot2_f32_bf16 v36, v144, v48, 0
    v_dot2_f32_bf16 v37, v146, v49, 0
    v_dot2_f32_bf16 v38, v145, v50, 0
    v_dot2_f32_bf16 v39, v147, v51, 0
    v_dot2_f32_bf16 v40, v148, v52, 0
    v_dot2_f32_bf16 v41, v150, v53, 0
    v_dot2_f32_bf16 v42, v149, v54, 0
    v_dot2_f32_bf16 v43, v151, v55, 0
    v_dot2_f32_bf16 v44, v152, v56, 0
    v_dot2_f32_bf16 v45, v154, v57, 0
    v_dot2_f32_bf16 v46, v153, v58, 0
    v_dot2_f32_bf16 v47, v155, v59, 0
    s_add_u32 s79, s79, 12
    s_cmp_ge_i32 s80, s79
    s_cbranch_scc1 L_kr60g
L_kr60:
    ds_read_b32 v19, v7
    s_sleep 1
    s_waitcnt lgkmcnt(0)
    v_readlane_b32 s80, v19, 5
    s_nop 0
    s_cmp_lt_i32 s80, s79
    s_cbranch_scc1 L_kr60
L_kr60g:
    ds_read_b32 v10, v3 offset:768
    ds_read_b128 v[24:27], v2 offset:0
    ds_read_b128 v[28:31], v2 offset:256
    ds_read_b128 v[32:35], v2 offset:512
    v_add_u32 v6, 1, v6
    ds_write_b32 v5, v6
    s_waitcnt lgkmcnt(3)
    v_and_b32 v12, 0xffff0000, v10
    v_cvt_f32_i32 v24, v24
    v_cvt_f32_i32 v25, v25
    v_cvt_f32_i32 v26, v26
    v_cvt_f32_i32 v27, v27
    v_pk_add_f32 v[24:25], v[24:25], v[12:13] op_sel:[0,0] op_sel_hi:[1,0] neg_lo:[0,1] neg_hi:[0,1]
    v_pk_add_f32 v[26:27], v[26:27], v[12:13] op_sel:[0,0] op_sel_hi:[1,0] neg_lo:[0,1] neg_hi:[0,1]
    v_pk_mul_f32 v[14:15], v[24:25], v[36:37]
    v_pk_fma_f32 v[14:15], v[26:27], v[38:39], v[14:15]
    s_waitcnt lgkmcnt(2)
    v_cvt_f32_i32 v28, v28
    v_cvt_f32_i32 v29, v29
    v_cvt_f32_i32 v30, v30
    v_cvt_f32_i32 v31, v31
    v_pk_add_f32 v[28:29], v[28:29], v[12:13] op_sel:[0,0] op_sel_hi:[1,0] neg_lo:[0,1] neg_hi:[0,1]
    v_pk_add_f32 v[30:31], v[30:31], v[12:13] op_sel:[0,0] op_sel_hi:[1,0] neg_lo:[0,1] neg_hi:[0,1]
    v_pk_fma_f32 v[14:15], v[28:29], v[40:41], v[14:15]
    v_pk_fma_f32 v[14:15], v[30:31], v[42:43], v[14:15]
    s_waitcnt lgkmcnt(1)
    v_cvt_f32_i32 v32, v32
    v_cvt_f32_i32 v33, v33
    v_cvt_f32_i32 v34, v34
    v_cvt_f32_i32 v35, v35
    v_pk_add_f32 v[32:33], v[32:33], v[12:13] op_sel:[0,0] op_sel_hi:[1,0] neg_lo:[0,1] neg_hi:[0,1]
    v_pk_add_f32 v[34:35], v[34:35], v[12:13] op_sel:[0,0] op_sel_hi:[1,0] neg_lo:[0,1] neg_hi:[0,1]
    v_pk_fma_f32 v[14:15], v[32:33], v[44:45], v[14:15]
    v_pk_fma_f32 v[14:15], v[34:35], v[46:47], v[14:15]
    v_add_f32 v14, v14, v15
    s_nop 1
    v_add_f32_dpp v18, v14, v14 row_ror:8 row_mask:0xf bank_mask:0x3
    v_dot2_f32_bf16 v36, v144, v60, 0
    v_dot2_f32_bf16 v37, v146, v61, 0
    v_dot2_f32_bf16 v38, v145, v62, 0
    v_dot2_f32_bf16 v39, v147, v63, 0
    v_dot2_f32_bf16 v40, v148, v64, 0
    v_dot2_f32_bf16 v41, v150, v65, 0
    v_dot2_f32_bf16 v42, v149, v66, 0
    v_dot2_f32_bf16 v43, v151, v67, 0
    v_dot2_f32_bf16 v44, v152, v68, 0
    v_dot2_f32_bf16 v45, v154, v69, 0
    v_dot2_f32_bf16 v46, v153, v70, 0
    v_dot2_f32_bf16 v47, v155, v71, 0
    s_add_u32 s79, s79, 12
    s_cmp_ge_i32 s80, s79
    s_cbranch_scc1 L_kr61g
L_kr61:
    ds_read_b32 v19, v7
    s_sleep 1
    s_waitcnt lgkmcnt(0)
    v_readlane_b32 s80, v19, 5
    s_nop 0
    s_cmp_lt_i32 s80, s79
    s_cbranch_scc1 L_kr61
L_kr61g:
    ds_read_b32 v11, v3 offset:1792
    ds_read_b128 v[24:27], v2 offset:12288
    ds_read_b128 v[28:31], v2 offset:12544
    ds_read_b128 v[32:35], v2 offset:12800
    v_add_u32 v6, 1, v6
    ds_write_b32 v5, v6
    s_waitcnt lgkmcnt(3)
    v_and_b32 v12, 0xffff0000, v11
    v_cvt_f32_i32 v24, v24
    v_cvt_f32_i32 v25, v25
    v_cvt_f32_i32 v26, v26
    v_cvt_f32_i32 v27, v27
    v_pk_add_f32 v[24:25], v[24:25], v[12:13] op_sel:[0,0] op_sel_hi:[1,0] neg_lo:[0,1] neg_hi:[0,1]
    v_pk_add_f32 v[26:27], v[26:27], v[12:13] op_sel:[0,0] op_sel_hi:[1,0] neg_lo:[0,1] neg_hi:[0,1]
    v_pk_mul_f32 v[16:17], v[24:25], v[36:37]
    v_pk_fma_f32 v[16:17], v[26:27], v[38:39], v[16:17]
    s_waitcnt lgkmcnt(2)
    v_cvt_f32_i32 v28, v28
    v_cvt_f32_i32 v29, v29
    v_cvt_f32_i32 v30, v30
    v_cvt_f32_i32 v31, v31
    v_pk_add_f32 v[28:29], v[28:29], v[12:13] op_sel:[0,0] op_sel_hi:[1,0] neg_lo:[0,1] neg_hi:[0,1]
    v_pk_add_f32 v[30:31], v[30:31], v[12:13] op_sel:[0,0] op_sel_hi:[1,0] neg_lo:[0,1] neg_hi:[0,1]
    v_pk_fma_f32 v[16:17], v[28:29], v[40:41], v[16:17]
    v_pk_fma_f32 v[16:17], v[30:31], v[42:43], v[16:17]
    s_waitcnt lgkmcnt(1)
    v_cvt_f32_i32 v32, v32
    v_cvt_f32_i32 v33, v33
    v_cvt_f32_i32 v34, v34
    v_cvt_f32_i32 v35, v35
    v_pk_add_f32 v[32:33], v[32:33], v[12:13] op_sel:[0,0] op_sel_hi:[1,0] neg_lo:[0,1] neg_hi:[0,1]
    v_pk_add_f32 v[34:35], v[34:35], v[12:13] op_sel:[0,0] op_sel_hi:[1,0] neg_lo:[0,1] neg_hi:[0,1]
    v_pk_fma_f32 v[16:17], v[32:33], v[44:45], v[16:17]
    v_pk_fma_f32 v[16:17], v[34:35], v[46:47], v[16:17]
    v_add_f32 v16, v16, v17
    v_cndmask_b32 v23, v10, v11, s[86:87]
    v_lshlrev_b32 v23, 16, v23
    v_add_f32_dpp v18, v16, v16 row_ror:8 row_mask:0xf bank_mask:0xc
    v_mul_f32 v23, 0x3dd53b95, v23
    s_nop 0
    v_add_f32_dpp v18, v18, v18 row_half_mirror row_mask:0xf bank_mask:0xf
    s_nop 1
    v_add_f32_dpp v18, v18, v18 quad_perm:[2,3,0,1] row_mask:0xf bank_mask:0xf
    s_nop 1
    v_add_f32_dpp v18, v18, v18 quad_perm:[1,0,3,2] row_mask:0xf bank_mask:0xf
    v_mul_f32 v18, v23, v18
    ds_write_b32 v4, v18 offset:768
    s_cmp_lg_u32 s81, 0
    s_cbranch_scc1 L_ncs7
    s_waitcnt vmcnt(0)
    v_perm_b32 v36, v158, v156, s83
    v_perm_b32 v158, v158, v156, s84
    v_perm_b32 v37, v159, v157, s83
    v_perm_b32 v159, v159, v157, s84
    v_perm_b32 v38, v162, v160, s83
    v_perm_b32 v162, v162, v160, s84
    v_perm_b32 v39, v163, v161, s83
    v_perm_b32 v163, v163, v161, s84
    v_perm_b32 v40, v166, v164, s83
    v_perm_b32 v166, v166, v164, s84
    v_perm_b32 v41, v167, v165, s83
    v_perm_b32 v167, v167, v165, s84
    v_mov_b64 v[156:157], v[36:37]
    v_mov_b64 v[160:161], v[38:39]
    v_mov_b64 v[164:165], v[40:41]
    s_nop 1
L_ncs7:
    v_dot2_f32_bf16 v36, v156, v48, 0
    v_dot2_f32_bf16 v37, v158, v49, 0
    v_dot2_f32_bf16 v38, v157, v50, 0
    v_dot2_f32_bf16 v39, v159, v51, 0
    v_dot2_f32_bf16 v40, v160, v52, 0
    v_dot2_f32_bf16 v41, v162, v53, 0
    v_dot2_f32_bf16 v42, v161, v54, 0
    v_dot2_f32_bf16 v43, v163, v55, 0
    v_dot2_f32_bf16 v44, v164, v56, 0
    v_dot2_f32_bf16 v45, v166, v57, 0
    v_dot2_f32_bf16 v46, v165, v58, 0
    v_dot2_f32_bf16 v47, v167, v59, 0
    s_add_u32 s79, s79, 12
    s_cmp_ge_i32 s80, s79
    s_cbranch_scc1 L_kr70g
L_kr70:
    ds_read_b32 v19, v7
    s_sleep 1
    s_waitcnt lgkmcnt(0)
    v_readlane_b32 s80, v19, 5
    s_nop 0
    s_cmp_lt_i32 s80, s79
    s_cbranch_scc1 L_kr70
L_kr70g:
    ds_read_b32 v10, v3 offset:896
    ds_read_b128 v[24:27], v2 offset:24576
    ds_read_b128 v[28:31], v2 offset:24832
    ds_read_b128 v[32:35], v2 offset:25088
    v_add_u32 v6, 1, v6
    ds_write_b32 v5, v6
    s_waitcnt lgkmcnt(3)
    v_and_b32 v12, 0xffff0000, v10
    v_cvt_f32_i32 v24, v24
    v_cvt_f32_i32 v25, v25
    v_cvt_f32_i32 v26, v26
    v_cvt_f32_i32 v27, v27
    v_pk_add_f32 v[24:25], v[24:25], v[12:13] op_sel:[0,0] op_sel_hi:[1,0] neg_lo:[0,1] neg_hi:[0,1]
    v_pk_add_f32 v[26:27], v[26:27], v[12:13] op_sel:[0,0] op_sel_hi:[1,0] neg_lo:[0,1] neg_hi:[0,1]
    v_pk_mul_f32 v[14:15], v[24:25], v[36:37]
    v_pk_fma_f32 v[14:15], v[26:27], v[38:39], v[14:15]
    s_waitcnt lgkmcnt(2)
    v_cvt_f32_i32 v28, v28
    v_cvt_f32_i32 v29, v29
    v_cvt_f32_i32 v30, v30
    v_cvt_f32_i32 v31, v31
    v_pk_add_f32 v[28:29], v[28:29], v[12:13] op_sel:[0,0] op_sel_hi:[1,0] neg_lo:[0,1] neg_hi:[0,1]
    v_pk_add_f32 v[30:31], v[30:31], v[12:13] op_sel:[0,0] op_sel_hi:[1,0] neg_lo:[0,1] neg_hi:[0,1]
    v_pk_fma_f32 v[14:15], v[28:29], v[40:41], v[14:15]
    v_pk_fma_f32 v[14:15], v[30:31], v[42:43], v[14:15]
    s_waitcnt lgkmcnt(1)
    v_cvt_f32_i32 v32, v32
    v_cvt_f32_i32 v33, v33
    v_cvt_f32_i32 v34, v34
    v_cvt_f32_i32 v35, v35
    v_pk_add_f32 v[32:33], v[32:33], v[12:13] op_sel:[0,0] op_sel_hi:[1,0] neg_lo:[0,1] neg_hi:[0,1]
    v_pk_add_f32 v[34:35], v[34:35], v[12:13] op_sel:[0,0] op_sel_hi:[1,0] neg_lo:[0,1] neg_hi:[0,1]
    v_pk_fma_f32 v[14:15], v[32:33], v[44:45], v[14:15]
    v_pk_fma_f32 v[14:15], v[34:35], v[46:47], v[14:15]
    v_add_f32 v14, v14, v15
    s_nop 1
    v_add_f32_dpp v18, v14, v14 row_ror:8 row_mask:0xf bank_mask:0x3
    v_dot2_f32_bf16 v36, v156, v60, 0
    v_dot2_f32_bf16 v37, v158, v61, 0
    v_dot2_f32_bf16 v38, v157, v62, 0
    v_dot2_f32_bf16 v39, v159, v63, 0
    v_dot2_f32_bf16 v40, v160, v64, 0
    v_dot2_f32_bf16 v41, v162, v65, 0
    v_dot2_f32_bf16 v42, v161, v66, 0
    v_dot2_f32_bf16 v43, v163, v67, 0
    v_dot2_f32_bf16 v44, v164, v68, 0
    v_dot2_f32_bf16 v45, v166, v69, 0
    v_dot2_f32_bf16 v46, v165, v70, 0
    v_dot2_f32_bf16 v47, v167, v71, 0
    s_add_u32 s79, s79, 12
    s_cmp_ge_i32 s80, s79
    s_cbranch_scc1 L_kr71g
L_kr71:
    ds_read_b32 v19, v7
    s_sleep 1
    s_waitcnt lgkmcnt(0)
    v_readlane_b32 s80, v19, 5
    s_nop 0
    s_cmp_lt_i32 s80, s79
    s_cbranch_scc1 L_kr71
L_kr71g:
    ds_read_b32 v11, v3 offset:1920
    ds_read_b128 v[24:27], v2 offset:36864
    ds_read_b128 v[28:31], v2 offset:37120
    ds_read_b128 v[32:35], v2 offset:37376
    v_add_u32 v6, 1, v6
    ds_write_b32 v5, v6
    s_waitcnt lgkmcnt(3)
    v_and_b32 v12, 0xffff0000, v11
    v_cvt_f32_i32 v24, v24
    v_cvt_f32_i32 v25, v25
    v_cvt_f32_i32 v26, v26
    v_cvt_f32_i32 v27, v27
    v_pk_add_f32 v[24:25], v[24:25], v[12:13] op_sel:[0,0] op_sel_hi:[1,0] neg_lo:[0,1] neg_hi:[0,1]
    v_pk_add_f32 v[26:27], v[26:27], v[12:13] op_sel:[0,0] op_sel_hi:[1,0] neg_lo:[0,1] neg_hi:[0,1]
    v_pk_mul_f32 v[16:17], v[24:25], v[36:37]
    v_pk_fma_f32 v[16:17], v[26:27], v[38:39], v[16:17]
    s_waitcnt lgkmcnt(2)
    v_cvt_f32_i32 v28, v28
    v_cvt_f32_i32 v29, v29
    v_cvt_f32_i32 v30, v30
    v_cvt_f32_i32 v31, v31
    v_pk_add_f32 v[28:29], v[28:29], v[12:13] op_sel:[0,0] op_sel_hi:[1,0] neg_lo:[0,1] neg_hi:[0,1]
    v_pk_add_f32 v[30:31], v[30:31], v[12:13] op_sel:[0,0] op_sel_hi:[1,0] neg_lo:[0,1] neg_hi:[0,1]
    v_pk_fma_f32 v[16:17], v[28:29], v[40:41], v[16:17]
    v_pk_fma_f32 v[16:17], v[30:31], v[42:43], v[16:17]
    s_waitcnt lgkmcnt(1)
    v_cvt_f32_i32 v32, v32
    v_cvt_f32_i32 v33, v33
    v_cvt_f32_i32 v34, v34
    v_cvt_f32_i32 v35, v35
    v_pk_add_f32 v[32:33], v[32:33], v[12:13] op_sel:[0,0] op_sel_hi:[1,0] neg_lo:[0,1] neg_hi:[0,1]
    v_pk_add_f32 v[34:35], v[34:35], v[12:13] op_sel:[0,0] op_sel_hi:[1,0] neg_lo:[0,1] neg_hi:[0,1]
    v_pk_fma_f32 v[16:17], v[32:33], v[44:45], v[16:17]
    v_pk_fma_f32 v[16:17], v[34:35], v[46:47], v[16:17]
    v_add_f32 v16, v16, v17
    v_cndmask_b32 v23, v10, v11, s[86:87]
    v_lshlrev_b32 v23, 16, v23
    v_add_f32_dpp v18, v16, v16 row_ror:8 row_mask:0xf bank_mask:0xc
    v_mul_f32 v23, 0x3dd53b95, v23
    s_nop 0
    v_add_f32_dpp v18, v18, v18 row_half_mirror row_mask:0xf bank_mask:0xf
    s_nop 1
    v_add_f32_dpp v18, v18, v18 quad_perm:[2,3,0,1] row_mask:0xf bank_mask:0xf
    s_nop 1
    v_add_f32_dpp v18, v18, v18 quad_perm:[1,0,3,2] row_mask:0xf bank_mask:0xf
    v_mul_f32 v18, v23, v18
    ds_write_b32 v4, v18 offset:896
    s_mov_b64 exec, 1
    ds_add_u32 v22, v8
    s_mov_b64 exec, -1
    v_add_u32 v22, 4, v22
    v_add_u32 v3, 2048, v3
    v_add_u32 v4, 2048, v4
    s_add_u32 s81, s81, 1
    s_cmp_lt_u32 s81, 8
    s_cbranch_scc1 L_kph
    v_subrev_u32 v3, 16384, v3
    s_mul_i32 s92, s78, 1536
    s_add_u32 s92, s92, 65536
    v_lshl_add_u32 v9, v1, 3, s92
    s_mov_b32 s81, 0
    s_nop 0
L_vph:
    v_mov_b64 v[72:73], 0
    v_mov_b64 v[74:75], 0
    v_mov_b64 v[76:77], 0
    v_mov_b64 v[78:79], 0
    v_mov_b64 v[80:81], 0
    v_mov_b64 v[82:83], 0
    v_mov_b64 v[84:85], 0
    v_mov_b64 v[86:87], 0
    v_mov_b64 v[88:89], 0
    v_mov_b64 v[90:91], 0
    v_mov_b64 v[92:93], 0
    v_mov_b64 v[94:95], 0
    s_mov_b32 s88, 0
    s_nop 0
L_vw:
    ds_read_b32 v19, v7
    s_waitcnt lgkmcnt(0)
    v_readlane_b32 s92, v19, 15
    v_readlane_b32 s93, v19, 13
    s_add_u32 s92, s92, 2
    s_min_u32 s93, s93, s92
    s_cmp_le_u32 s93, s81
    s_nop 1
    s_cbranch_scc1 L_vw
L_vit:
    s_add_u32 s79, s79, 12
    s_cmp_ge_i32 s80, s79
    s_cbranch_scc1 L_vr00g
L_vr00:
    ds_read_b32 v19, v7
    s_sleep 1
    s_waitcnt lgkmcnt(0)
    v_readlane_b32 s80, v19, 5
    s_nop 0
    s_cmp_lt_i32 s80, s79
    s_cbranch_scc1 L_vr00
L_vr00g:
    ds_read_b32 v10, v3 offset:0
    ds_read_b128 v[24:27], v2 offset:0
    ds_read_b128 v[28:31], v2 offset:256
    ds_read_b128 v[32:35], v2 offset:512
    v_add_u32 v6, 1, v6
    ds_write_b32 v5, v6
    s_waitcnt lgkmcnt(3)
    v_cvt_f32_i32 v24, v24
    v_cvt_f32_i32 v25, v25
    v_cvt_f32_i32 v26, v26
    v_cvt_f32_i32 v27, v27
    v_pk_fma_f32 v[72:73], v[24:25], v[10:11], v[72:73] op_sel:[0,0,0] op_sel_hi:[1,0,1]
    v_pk_fma_f32 v[74:75], v[26:27], v[10:11], v[74:75] op_sel:[0,0,0] op_sel_hi:[1,0,1]
    s_waitcnt lgkmcnt(2)
    v_cvt_f32_i32 v28, v28
    v_cvt_f32_i32 v29, v29
    v_cvt_f32_i32 v30, v30
    v_cvt_f32_i32 v31, v31
    v_pk_fma_f32 v[76:77], v[28:29], v[10:11], v[76:77] op_sel:[0,0,0] op_sel_hi:[1,0,1]
    v_pk_fma_f32 v[78:79], v[30:31], v[10:11], v[78:79] op_sel:[0,0,0] op_sel_hi:[1,0,1]
    s_waitcnt lgkmcnt(1)
    v_cvt_f32_i32 v32, v32
    v_cvt_f32_i32 v33, v33
    v_cvt_f32_i32 v34, v34
    v_cvt_f32_i32 v35, v35
    v_pk_fma_f32 v[80:81], v[32:33], v[10:11], v[80:81] op_sel:[0,0,0] op_sel_hi:[1,0,1]
    v_pk_fma_f32 v[82:83], v[34:35], v[10:11], v[82:83] op_sel:[0,0,0] op_sel_hi:[1,0,1]
    s_add_u32 s79, s79, 12
    s_cmp_ge_i32 s80, s79
    s_cbranch_scc1 L_vr01g
L_vr01:
    ds_read_b32 v19, v7
    s_sleep 1
    s_waitcnt lgkmcnt(0)
    v_readlane_b32 s80, v19, 5
    s_nop 0
    s_cmp_lt_i32 s80, s79
    s_cbranch_scc1 L_vr01
L_vr01g:
    ds_read_b32 v10, v3 offset:1024
    ds_read_b128 v[24:27], v2 offset:12288
    ds_read_b128 v[28:31], v2 offset:12544
    ds_read_b128 v[32:35], v2 offset:12800
    v_add_u32 v6, 1, v6
    ds_write_b32 v5, v6
    s_waitcnt lgkmcnt(3)
    v_cvt_f32_i32 v24, v24
    v_cvt_f32_i32 v25, v25
    v_cvt_f32_i32 v26, v26
    v_cvt_f32_i32 v27, v27
    v_pk_fma_f32 v[84:85], v[24:25], v[10:11], v[84:85] op_sel:[0,0,0] op_sel_hi:[1,0,1]
    v_pk_fma_f32 v[86:87], v[26:27], v[10:11], v[86:87] op_sel:[0,0,0] op_sel_hi:[1,0,1]
    s_waitcnt lgkmcnt(2)
    v_cvt_f32_i32 v28, v28
    v_cvt_f32_i32 v29, v29
    v_cvt_f32_i32 v30, v30
    v_cvt_f32_i32 v31, v31
    v_pk_fma_f32 v[88:89], v[28:29], v[10:11], v[88:89] op_sel:[0,0,0] op_sel_hi:[1,0,1]
    v_pk_fma_f32 v[90:91], v[30:31], v[10:11], v[90:91] op_sel:[0,0,0] op_sel_hi:[1,0,1]
    s_waitcnt lgkmcnt(1)
    v_cvt_f32_i32 v32, v32
    v_cvt_f32_i32 v33, v33
    v_cvt_f32_i32 v34, v34
    v_cvt_f32_i32 v35, v35
    v_pk_fma_f32 v[92:93], v[32:33], v[10:11], v[92:93] op_sel:[0,0,0] op_sel_hi:[1,0,1]
    v_pk_fma_f32 v[94:95], v[34:35], v[10:11], v[94:95] op_sel:[0,0,0] op_sel_hi:[1,0,1]
    s_add_u32 s79, s79, 12
    s_cmp_ge_i32 s80, s79
    s_cbranch_scc1 L_vr10g
L_vr10:
    ds_read_b32 v19, v7
    s_sleep 1
    s_waitcnt lgkmcnt(0)
    v_readlane_b32 s80, v19, 5
    s_nop 0
    s_cmp_lt_i32 s80, s79
    s_cbranch_scc1 L_vr10
L_vr10g:
    ds_read_b32 v10, v3 offset:128
    ds_read_b128 v[24:27], v2 offset:24576
    ds_read_b128 v[28:31], v2 offset:24832
    ds_read_b128 v[32:35], v2 offset:25088
    v_add_u32 v6, 1, v6
    ds_write_b32 v5, v6
    s_waitcnt lgkmcnt(3)
    v_cvt_f32_i32 v24, v24
    v_cvt_f32_i32 v25, v25
    v_cvt_f32_i32 v26, v26
    v_cvt_f32_i32 v27, v27
    v_pk_fma_f32 v[72:73], v[24:25], v[10:11], v[72:73] op_sel:[0,0,0] op_sel_hi:[1,0,1]
    v_pk_fma_f32 v[74:75], v[26:27], v[10:11], v[74:75] op_sel:[0,0,0] op_sel_hi:[1,0,1]
    s_waitcnt lgkmcnt(2)
    v_cvt_f32_i32 v28, v28
    v_cvt_f32_i32 v29, v29
    v_cvt_f32_i32 v30, v30
    v_cvt_f32_i32 v31, v31
    v_pk_fma_f32 v[76:77], v[28:29], v[10:11], v[76:77] op_sel:[0,0,0] op_sel_hi:[1,0,1]
    v_pk_fma_f32 v[78:79], v[30:31], v[10:11], v[78:79] op_sel:[0,0,0] op_sel_hi:[1,0,1]
    s_waitcnt lgkmcnt(1)
    v_cvt_f32_i32 v32, v32
    v_cvt_f32_i32 v33, v33
    v_cvt_f32_i32 v34, v34
    v_cvt_f32_i32 v35, v35
    v_pk_fma_f32 v[80:81], v[32:33], v[10:11], v[80:81] op_sel:[0,0,0] op_sel_hi:[1,0,1]
    v_pk_fma_f32 v[82:83], v[34:35], v[10:11], v[82:83] op_sel:[0,0,0] op_sel_hi:[1,0,1]
    s_add_u32 s79, s79, 12
    s_cmp_ge_i32 s80, s79
    s_cbranch_scc1 L_vr11g
L_vr11:
    ds_read_b32 v19, v7
    s_sleep 1
    s_waitcnt lgkmcnt(0)
    v_readlane_b32 s80, v19, 5
    s_nop 0
    s_cmp_lt_i32 s80, s79
    s_cbranch_scc1 L_vr11
L_vr11g:
    ds_read_b32 v10, v3 offset:1152
    ds_read_b128 v[24:27], v2 offset:36864
    ds_read_b128 v[28:31], v2 offset:37120
    ds_read_b128 v[32:35], v2 offset:37376
    v_add_u32 v6, 1, v6
    ds_write_b32 v5, v6
    s_waitcnt lgkmcnt(3)
    v_cvt_f32_i32 v24, v24
    v_cvt_f32_i32 v25, v25
    v_cvt_f32_i32 v26, v26
    v_cvt_f32_i32 v27, v27
    v_pk_fma_f32 v[84:85], v[24:25], v[10:11], v[84:85] op_sel:[0,0,0] op_sel_hi:[1,0,1]
    v_pk_fma_f32 v[86:87], v[26:27], v[10:11], v[86:87] op_sel:[0,0,0] op_sel_hi:[1,0,1]
    s_waitcnt lgkmcnt(2)
    v_cvt_f32_i32 v28, v28
    v_cvt_f32_i32 v29, v29
    v_cvt_f32_i32 v30, v30
    v_cvt_f32_i32 v31, v31
    v_pk_fma_f32 v[88:89], v[28:29], v[10:11], v[88:89] op_sel:[0,0,0] op_sel_hi:[1,0,1]
    v_pk_fma_f32 v[90:91], v[30:31], v[10:11], v[90:91] op_sel:[0,0,0] op_sel_hi:[1,0,1]
    s_waitcnt lgkmcnt(1)
    v_cvt_f32_i32 v32, v32
    v_cvt_f32_i32 v33, v33
    v_cvt_f32_i32 v34, v34
    v_cvt_f32_i32 v35, v35
    v_pk_fma_f32 v[92:93], v[32:33], v[10:11], v[92:93] op_sel:[0,0,0] op_sel_hi:[1,0,1]
    v_pk_fma_f32 v[94:95], v[34:35], v[10:11], v[94:95] op_sel:[0,0,0] op_sel_hi:[1,0,1]
    v_add_u32 v3, 256, v3
    s_add_u32 s88, s88, 1
    s_cmp_lt_u32 s88, 4
    s_cbranch_scc1 L_vit
    v_permlane32_swap_b32 v72, v74
    v_permlane32_swap_b32 v73, v75
    v_permlane32_swap_b32 v76, v78
    v_permlane32_swap_b32 v77, v79
    v_permlane32_swap_b32 v80, v82
    v_permlane32_swap_b32 v81, v83
    v_pk_add_f32 v[72:73], v[72:73], v[74:75]
    v_pk_add_f32 v[76:77], v[76:77], v[78:79]
    v_pk_add_f32 v[80:81], v[80:81], v[82:83]
    v_permlane32_swap_b32 v84, v86
    v_permlane32_swap_b32 v85, v87
    v_permlane32_swap_b32 v88, v90
    v_permlane32_swap_b32 v89, v91
    v_permlane32_swap_b32 v92, v94
    v_permlane32_swap_b32 v93, v95
    v_pk_add_f32 v[84:85], v[84:85], v[86:87]
    v_pk_add_f32 v[88:89], v[88:89], v[90:91]
    v_pk_add_f32 v[92:93], v[92:93], v[94:95]
    v_permlane16_swap_b32 v72, v73
    v_permlane16_swap_b32 v76, v77
    v_permlane16_swap_b32 v80, v81
    v_add_f32 v24, v72, v73
    v_add_f32 v25, v76, v77
    v_add_f32 v26, v80, v81
    v_permlane16_swap_b32 v84, v85
    v_permlane16_swap_b32 v88, v89
    v_permlane16_swap_b32 v92, v93
    v_add_f32 v27, v84, v85
    v_add_f32 v28, v88, v89
    v_add_f32 v29, v92, v93
    ds_write_b64 v9, v[24:25] offset:0
    ds_write_b64 v9, v[26:27] offset:512
    ds_write_b64 v9, v[28:29] offset:1024
    s_mov_b64 exec, 1
    ds_add_u32 v22, v8
    s_mov_b64 exec, -1
    v_add_u32 v22, 4, v22
    v_add_u32 v3, 1024, v3
    s_bitcmp0_b32 s81, 0
    s_cselect_b32 s92, 1, -1
    s_mul_i32 s92, s92, 6144
    v_add_u32 v9, s92, v9
    s_add_u32 s81, s81, 1
    s_cmp_lt_u32 s81, 8
    s_waitcnt lgkmcnt(0)
    s_cbranch_scc1 L_vph
    s_endpgm
L_helper:
    s_memrealtime s[96:97]
    v_bfe_u32 v22, v1, 2, 3
    v_lshl_add_u32 v22, v22, 11, s77
    v_and_b32 v22, 16383, v22
    v_lshrrev_b32 v19, 5, v1
    v_lshl_add_u32 v22, v19, 14, v22
    v_and_b32 v19, 3, v1
    v_lshlrev_b32 v19, 3, v19
    v_lshl_add_u32 v22, v22, 1, v19
    s_lshl_b32 s89, s3, 16
    v_lshlrev_b32 v2, 4, v1
    s_mov_b32 s6, 1048576
    s_mov_b32 s7, 0x20000
    s_mov_b32 s10, 1048576
    s_mov_b32 s11, 0x20000
    s_mov_b32 s14, 1048576
    s_mov_b32 s15, 0x20000
    s_mov_b32 s18, 1048576
    s_mov_b32 s19, 0x20000
    s_waitcnt lgkmcnt(0)
    s_mov_b64 s[4:5], s[52:53]
    s_mov_b64 s[8:9], s[54:55]
    s_mov_b64 s[12:13], s[58:59]
    s_mov_b64 s[16:17], s[60:61]
    buffer_load_dwordx2 v[72:73], v22, s[4:7], s89 offen
    buffer_load_dwordx2 v[74:75], v22, s[8:11], s89 offen
    buffer_load_dwordx2 v[76:77], v22, s[12:15], s89 offen
    buffer_load_dwordx2 v[78:79], v22, s[16:19], s89 offen
    s_add_u32 s89, s89, 131072
    s_barrier
    s_mov_b32 s20, s74
    s_mov_b32 s21, s75
    s_mov_b32 s22, 1610612736
    s_mov_b32 s23, 0x20000
    s_mov_b32 s24, s72
    s_mov_b32 s25, s73
    s_mov_b32 s26, 256
    s_mov_b32 s27, 0x20000
    s_mov_b32 s28, s70
    s_mov_b32 s29, s71
    s_mov_b32 s30, 12288
    s_mov_b32 s31, 0x20000
    s_mov_b32 s32, s48
    s_mov_b32 s33, s49
    s_mov_b32 s34, 12288
    s_mov_b32 s35, 0x20000
    s_mov_b32 s36, s62
    s_mov_b32 s37, s63
    s_mov_b32 s38, 384
    s_mov_b32 s39, 0x20000
    s_mov_b32 s40, s64
    s_mov_b32 s41, s65
    s_mov_b32 s42, 384
    s_mov_b32 s43, 0x20000
    v_lshlrev_b32 v44, 3, v1
    v_cmp_gt_u32 vcc, 24, v1
    v_mov_b32 v23, 0xffffff40
    v_mov_b32 v18, 192
    v_cndmask_b32 v23, v23, v18, vcc
    v_add_u32 v45, v44, v23
    v_mov_b32 v18, 0x80008000
    v_cndmask_b32 v46, 0, v18, vcc
    s_mov_b32 s78, s96
    s_mov_b32 s94, 0x05040100
    s_mov_b32 s95, 0x07060302
    v_lshlrev_b32 v9, 1, v2
    v_add_u32 v9, 49152, v9
    v_mov_b32 v3, 77824
    v_mov_b32 v4, 0
    v_mov_b32 v5, 0xff
    s_waitcnt vmcnt(0)
    v_perm_b32 v48, v74, v72, s94
    v_perm_b32 v49, v78, v76, s94
    v_perm_b32 v50, v74, v72, s95
    v_perm_b32 v51, v78, v76, s95
    v_perm_b32 v52, v75, v73, s94
    v_perm_b32 v53, v79, v77, s94
    v_perm_b32 v54, v75, v73, s95
    v_perm_b32 v55, v79, v77, s95
    v_mov_b32 v19, 1
    ds_write_b128 v9, v[48:51] offset:0
    ds_write_b128 v9, v[52:55] offset:16
    ds_write_b32 v3, v19 offset:48
    s_waitcnt lgkmcnt(3)
    s_mov_b32 s48, 0
    s_cmp_lg_u32 s2, 0
    s_cbranch_scc1 L_ne0
    s_mul_i32 s49, s78, 0x9e3779b1
    s_lshr_b32 s93, s49, 15
    s_xor_b32 s49, s49, s93
    s_mul_i32 s49, s49, 0x85ebca6b
    s_lshr_b32 s93, s49, 13
    s_xor_b32 s49, s49, s93
    s_max_u32 s49, s49, 1
    v_mov_b32 v14, s49
    v_mov_b32 v15, 0
    s_mov_b64 exec, 1
    buffer_atomic_cmpswap v[14:15], v4, s[24:27], 0 offen sc0 sc1
    s_waitcnt vmcnt(0)
    v_readfirstlane_b32 s48, v14
    s_mov_b64 exec, -1
    s_cmp_eq_u32 s48, 0
    s_cselect_b32 s48, s49, s48
    s_nop 1
L_ne0:
    buffer_load_dwordx2 v[40:41], v44, s[36:39], 0 offen
    buffer_load_dwordx2 v[42:43], v44, s[40:43], 0 offen
    s_mul_i32 s92, s3, 768
    s_add_u32 s92, s92, 6144
    buffer_load_dwordx2 v[136:137], v44, s[32:35], s92 offen
    buffer_load_dwordx2 v[138:139], v45, s[32:35], s92 offen
    buffer_load_dwordx2 v[140:141], v44, s[32:35], s92 offen offset:384
    buffer_load_dwordx2 v[142:143], v45, s[32:35], s92 offen offset:384
    s_add_u32 s92, s92, 1536
    buffer_load_dwordx2 v[144:145], v44, s[32:35], s92 offen
    buffer_load_dwordx2 v[146:147], v45, s[32:35], s92 offen
    buffer_load_dwordx2 v[148:149], v44, s[32:35], s92 offen offset:384
    buffer_load_dwordx2 v[150:151], v45, s[32:35], s92 offen offset:384
    s_add_u32 s92, s92, 1536
    buffer_load_dwordx2 v[152:153], v44, s[32:35], s92 offen
    buffer_load_dwordx2 v[154:155], v45, s[32:35], s92 offen
    buffer_load_dwordx2 v[156:157], v44, s[32:35], s92 offen offset:384
    buffer_load_dwordx2 v[158:159], v45, s[32:35], s92 offen offset:384
    s_add_u32 s92, s92, 1536
    buffer_load_dwordx2 v[160:161], v44, s[32:35], s92 offen
    buffer_load_dwordx2 v[162:163], v45, s[32:35], s92 offen
    buffer_load_dwordx2 v[164:165], v44, s[32:35], s92 offen offset:384
    buffer_load_dwordx2 v[166:167], v45, s[32:35], s92 offen offset:384
    buffer_load_dwordx2 v[80:81], v22, s[4:7], s89 offen
    buffer_load_dwordx2 v[82:83], v22, s[8:11], s89 offen
    buffer_load_dwordx2 v[84:85], v22, s[12:15], s89 offen
    buffer_load_dwordx2 v[86:87], v22, s[16:19], s89 offen
    s_add_u32 s89, s89, 131072
    buffer_load_dwordx2 v[88:89], v22, s[4:7], s89 offen
    buffer_load_dwordx2 v[90:91], v22, s[8:11], s89 offen
    buffer_load_dwordx2 v[92:93], v22, s[12:15], s89 offen
    buffer_load_dwordx2 v[94:95], v22, s[16:19], s89 offen
    s_add_u32 s89, s89, 131072
    buffer_load_dwordx2 v[96:97], v22, s[4:7], s89 offen
    buffer_load_dwordx2 v[98:99], v22, s[8:11], s89 offen
    buffer_load_dwordx2 v[100:101], v22, s[12:15], s89 offen
    buffer_load_dwordx2 v[102:103], v22, s[16:19], s89 offen
    s_add_u32 s89, s89, 131072
    s_waitcnt vmcnt(8)
    buffer_load_dwordx2 v[104:105], v22, s[4:7], s89 offen
    buffer_load_dwordx2 v[106:107], v22, s[8:11], s89 offen
    buffer_load_dwordx2 v[108:109], v22, s[12:15], s89 offen
    buffer_load_dwordx2 v[110:111], v22, s[16:19], s89 offen
    s_add_u32 s89, s89, 131072
    v_perm_b32 v56, v82, v80, s94
    v_perm_b32 v57, v86, v84, s94
    v_perm_b32 v58, v82, v80, s95
    v_perm_b32 v59, v86, v84, s95
    v_perm_b32 v60, v83, v81, s94
    v_perm_b32 v61, v87, v85, s94
    v_perm_b32 v62, v83, v81, s95
    v_perm_b32 v63, v87, v85, s95
    v_mov_b32 v19, 2
    ds_write_b128 v9, v[56:59] offset:2048
    ds_write_b128 v9, v[60:63] offset:2064
    ds_write_b32 v3, v19 offset:48
    s_waitcnt lgkmcnt(3)
    s_waitcnt vmcnt(8)
    buffer_load_dwordx2 v[112:113], v22, s[4:7], s89 offen
    buffer_load_dwordx2 v[114:115], v22, s[8:11], s89 offen
    buffer_load_dwordx2 v[116:117], v22, s[12:15], s89 offen
    buffer_load_dwordx2 v[118:119], v22, s[16:19], s89 offen
    s_add_u32 s89, s89, 131072
    v_perm_b32 v48, v90, v88, s94
    v_perm_b32 v49, v94, v92, s94
    v_perm_b32 v50, v90, v88, s95
    v_perm_b32 v51, v94, v92, s95
    v_perm_b32 v52, v91, v89, s94
    v_perm_b32 v53, v95, v93, s94
    v_perm_b32 v54, v91, v89, s95
    v_perm_b32 v55, v95, v93, s95
    v_mov_b32 v19, 3
    ds_write_b128 v9, v[48:51] offset:4096
    ds_write_b128 v9, v[52:55] offset:4112
    ds_write_b32 v3, v19 offset:48
    s_waitcnt lgkmcnt(3)
    s_waitcnt vmcnt(8)
    buffer_load_dwordx2 v[120:121], v22, s[4:7], s89 offen
    buffer_load_dwordx2 v[122:123], v22, s[8:11], s89 offen
    buffer_load_dwordx2 v[124:125], v22, s[12:15], s89 offen
    buffer_load_dwordx2 v[126:127], v22, s[16:19], s89 offen
    s_add_u32 s89, s89, 131072
    v_perm_b32 v56, v98, v96, s94
    v_perm_b32 v57, v102, v100, s94
    v_perm_b32 v58, v98, v96, s95
    v_perm_b32 v59, v102, v100, s95
    v_perm_b32 v60, v99, v97, s94
    v_perm_b32 v61, v103, v101, s94
    v_perm_b32 v62, v99, v97, s95
    v_perm_b32 v63, v103, v101, s95
    v_mov_b32 v19, 4
    ds_write_b128 v9, v[56:59] offset:6144
    ds_write_b128 v9, v[60:63] offset:6160
    ds_write_b32 v3, v19 offset:48
    s_waitcnt lgkmcnt(3)
    s_waitcnt vmcnt(8)
    buffer_load_dwordx2 v[128:129], v22, s[4:7], s89 offen
    buffer_load_dwordx2 v[130:131], v22, s[8:11], s89 offen
    buffer_load_dwordx2 v[132:133], v22, s[12:15], s89 offen
    buffer_load_dwordx2 v[134:135], v22, s[16:19], s89 offen
    s_add_u32 s89, s89, 131072
    v_perm_b32 v48, v106, v104, s94
    v_perm_b32 v49, v110, v108, s94
    v_perm_b32 v50, v106, v104, s95
    v_perm_b32 v51, v110, v108, s95
    v_perm_b32 v52, v107, v105, s94
    v_perm_b32 v53, v111, v109, s94
    v_perm_b32 v54, v107, v105, s95
    v_perm_b32 v55, v111, v109, s95
    v_mov_b32 v19, 5
    ds_write_b128 v9, v[48:51] offset:8192
    ds_write_b128 v9, v[52:55] offset:8208
    ds_write_b32 v3, v19 offset:48
    s_waitcnt lgkmcnt(3)
    s_waitcnt vmcnt(8)
    v_perm_b32 v56, v114, v112, s94
    v_perm_b32 v57, v118, v116, s94
    v_perm_b32 v58, v114, v112, s95
    v_perm_b32 v59, v118, v116, s95
    v_perm_b32 v60, v115, v113, s94
    v_perm_b32 v61, v119, v117, s94
    v_perm_b32 v62, v115, v113, s95
    v_perm_b32 v63, v119, v117, s95
    v_mov_b32 v19, 6
    ds_write_b128 v9, v[56:59] offset:10240
    ds_write_b128 v9, v[60:63] offset:10256
    ds_write_b32 v3, v19 offset:48
    s_waitcnt lgkmcnt(3)
    s_waitcnt vmcnt(4)
    v_perm_b32 v48, v122, v120, s94
    v_perm_b32 v49, v126, v124, s94
    v_perm_b32 v50, v122, v120, s95
    v_perm_b32 v51, v126, v124, s95
    v_perm_b32 v52, v123, v121, s94
    v_perm_b32 v53, v127, v125, s94
    v_perm_b32 v54, v123, v121, s95
    v_perm_b32 v55, v127, v125, s95
    v_mov_b32 v19, 7
    ds_write_b128 v9, v[48:51] offset:12288
    ds_write_b128 v9, v[52:55] offset:12304
    ds_write_b32 v3, v19 offset:48
    s_waitcnt lgkmcnt(3)
    s_waitcnt vmcnt(0)
    v_perm_b32 v56, v130, v128, s94
    v_perm_b32 v57, v134, v132, s94
    v_perm_b32 v58, v130, v128, s95
    v_perm_b32 v59, v134, v132, s95
    v_perm_b32 v60, v131, v129, s94
    v_perm_b32 v61, v135, v133, s94
    v_perm_b32 v62, v131, v129, s95
    v_perm_b32 v63, v135, v133, s95
    v_mov_b32 v19, 8
    ds_write_b128 v9, v[56:59] offset:14336
    ds_write_b128 v9, v[60:63] offset:14352
    ds_write_b32 v3, v19 offset:48
    s_waitcnt lgkmcnt(3)
    s_getpc_b64 s[92:93]
L_pc:
    s_sub_u32 s92, s92, L_pc-standalone__kv_cache_quant_pre_rope_vs_post_rope__decode_kernel
    s_subb_u32 s93, s93, 0
    s_lshr_b32 s94, s2, 3
    v_lshl_add_u32 v19, v1, 5, s94
    v_lshlrev_b32 v19, 7, v19
    v_min_u32 v19, L_end-standalone__kv_cache_quant_pre_rope_vs_post_rope__decode_kernel, v19
    s_mov_b64 exec, 0x7f
    global_load_dword v6, v19, s[92:93]
    s_mov_b64 exec, -1
    v_lshlrev_b32 v18, 1, v44
    v_lshlrev_b32 v19, 1, v45
    v_add_u32 v18, 71680, v18
    v_add_u32 v19, 71680, v19
    v_mov_b32 v23, 77968
    s_mov_b32 s89, 0
    s_waitcnt vmcnt(1) lgkmcnt(0)
    v_xor_b32 v42, v42, v46
    v_xor_b32 v43, v43, v46
    v_lshlrev_b32 v48, 16, v40
    v_and_b32 v49, 0xffff0000, v40
    v_lshlrev_b32 v50, 16, v41
    v_and_b32 v51, 0xffff0000, v41
    v_lshlrev_b32 v52, 16, v42
    v_and_b32 v53, 0xffff0000, v42
    v_lshlrev_b32 v54, 16, v43
    v_and_b32 v55, 0xffff0000, v43
    v_and_b32 v46, 0x80000000, v46
    s_nop 1
L_hq:
    v_mov_b64 v[24:25], v[136:137]
    v_mov_b64 v[26:27], v[138:139]
    v_mov_b64 v[28:29], v[140:141]
    v_mov_b64 v[30:31], v[142:143]
    v_mov_b64 v[136:137], v[144:145]
    v_mov_b64 v[138:139], v[146:147]
    v_mov_b64 v[140:141], v[148:149]
    v_mov_b64 v[142:143], v[150:151]
    v_mov_b64 v[144:145], v[152:153]
    v_mov_b64 v[146:147], v[154:155]
    v_mov_b64 v[148:149], v[156:157]
    v_mov_b64 v[150:151], v[158:159]
    v_mov_b64 v[152:153], v[160:161]
    v_mov_b64 v[154:155], v[162:163]
    v_mov_b64 v[156:157], v[164:165]
    v_mov_b64 v[158:159], v[166:167]
    s_mov_b32 exec_hi, 0xffff
    v_lshlrev_b32 v56, 16, v24
    v_and_b32 v57, 0xffff0000, v24
    v_lshlrev_b32 v58, 16, v25
    v_and_b32 v59, 0xffff0000, v25
    v_lshlrev_b32 v60, 16, v26
    v_and_b32 v61, 0xffff0000, v26
    v_lshlrev_b32 v62, 16, v27
    v_and_b32 v63, 0xffff0000, v27
    v_pk_mul_f32 v[56:57], v[56:57], v[48:49]
    v_pk_mul_f32 v[60:61], v[60:61], v[52:53]
    v_pk_mul_f32 v[58:59], v[58:59], v[50:51]
    v_pk_mul_f32 v[62:63], v[62:63], v[54:55]
    v_cvt_pk_bf16_f32 v56, v56, v60
    v_cvt_pk_bf16_f32 v57, v57, v61
    v_cvt_pk_bf16_f32 v58, v58, v62
    v_cvt_pk_bf16_f32 v59, v59, v63
    v_and_b32 v60, 0xffff0000, v56
    v_lshlrev_b32 v56, 16, v56
    v_and_b32 v61, 0xffff0000, v57
    v_lshlrev_b32 v57, 16, v57
    v_and_b32 v62, 0xffff0000, v58
    v_lshlrev_b32 v58, 16, v58
    v_and_b32 v63, 0xffff0000, v59
    v_lshlrev_b32 v59, 16, v59
    v_pk_add_f32 v[56:57], v[56:57], v[60:61]
    v_pk_add_f32 v[58:59], v[58:59], v[62:63]
    v_cvt_pk_bf16_f32 v64, v56, v56
    v_cvt_pk_bf16_f32 v65, v57, v57
    v_cvt_pk_bf16_f32 v66, v58, v58
    v_cvt_pk_bf16_f32 v67, v59, v59
    v_xor_b32 v64, v64, v46
    v_xor_b32 v65, v65, v46
    v_xor_b32 v66, v66, v46
    v_xor_b32 v67, v67, v46
    ds_write_b16 v18, v64 offset:0
    ds_write_b16_d16_hi v19, v64 offset:2
    ds_write_b16 v18, v65 offset:4
    ds_write_b16_d16_hi v19, v65 offset:6
    ds_write_b16 v18, v66 offset:8
    ds_write_b16_d16_hi v19, v66 offset:10
    ds_write_b16 v18, v67 offset:12
    ds_write_b16_d16_hi v19, v67 offset:14
    v_lshlrev_b32 v56, 16, v28
    v_and_b32 v57, 0xffff0000, v28
    v_lshlrev_b32 v58, 16, v29
    v_and_b32 v59, 0xffff0000, v29
    v_lshlrev_b32 v60, 16, v30
    v_and_b32 v61, 0xffff0000, v30
    v_lshlrev_b32 v62, 16, v31
    v_and_b32 v63, 0xffff0000, v31
    v_pk_mul_f32 v[56:57], v[56:57], v[48:49]
    v_pk_mul_f32 v[60:61], v[60:61], v[52:53]
    v_pk_mul_f32 v[58:59], v[58:59], v[50:51]
    v_pk_mul_f32 v[62:63], v[62:63], v[54:55]
    v_cvt_pk_bf16_f32 v56, v56, v60
    v_cvt_pk_bf16_f32 v57, v57, v61
    v_cvt_pk_bf16_f32 v58, v58, v62
    v_cvt_pk_bf16_f32 v59, v59, v63
    v_and_b32 v60, 0xffff0000, v56
    v_lshlrev_b32 v56, 16, v56
    v_and_b32 v61, 0xffff0000, v57
    v_lshlrev_b32 v57, 16, v57
    v_and_b32 v62, 0xffff0000, v58
    v_lshlrev_b32 v58, 16, v58
    v_and_b32 v63, 0xffff0000, v59
    v_lshlrev_b32 v59, 16, v59
    v_pk_add_f32 v[56:57], v[56:57], v[60:61]
    v_pk_add_f32 v[58:59], v[58:59], v[62:63]
    v_cvt_pk_bf16_f32 v68, v56, v56
    v_cvt_pk_bf16_f32 v69, v57, v57
    v_cvt_pk_bf16_f32 v70, v58, v58
    v_cvt_pk_bf16_f32 v71, v59, v59
    v_xor_b32 v68, v68, v46
    v_xor_b32 v69, v69, v46
    v_xor_b32 v70, v70, v46
    v_xor_b32 v71, v71, v46
    ds_write_b16 v18, v68 offset:768
    ds_write_b16_d16_hi v19, v68 offset:770
    ds_write_b16 v18, v69 offset:772
    ds_write_b16_d16_hi v19, v69 offset:774
    ds_write_b16 v18, v70 offset:776
    ds_write_b16_d16_hi v19, v70 offset:778
    ds_write_b16 v18, v71 offset:780
    ds_write_b16_d16_hi v19, v71 offset:782
    s_mov_b32 exec_hi, -1
    ds_write_b32 v23, v5
    s_add_u32 s89, s89, 1
    v_add_u32 v18, 1536, v18
    v_add_u32 v19, 1536, v19
    v_add_u32 v23, 4, v23
    s_cmp_lt_u32 s89, 4
    s_waitcnt lgkmcnt(0)
    s_cbranch_scc1 L_hq
    s_cmp_lg_u32 s48, 0
    s_cbranch_scc1 L_epd
L_epw:
    s_sleep 4
    ds_read_b32 v19, v7
    s_waitcnt lgkmcnt(0)
    v_readlane_b32 s89, v19, 5
    s_nop 0
    s_cmp_lt_i32 s89, 72
    s_nop 2
    s_cbranch_scc1 L_epw
    s_mov_b64 exec, 1
    buffer_load_dword v19, v4, s[24:27], 0 offen
    s_waitcnt vmcnt(0)
    v_readfirstlane_b32 s48, v19
    s_mov_b64 exec, -1
    s_cmp_lg_u32 s48, 0
    s_nop 2
    s_cbranch_scc1 L_epd
    s_mul_i32 s49, s78, 0x9e3779b1
    s_lshr_b32 s93, s49, 15
    s_xor_b32 s49, s49, s93
    s_mul_i32 s49, s49, 0x85ebca6b
    s_lshr_b32 s93, s49, 13
    s_xor_b32 s49, s49, s93
    s_max_u32 s49, s49, 1
    v_mov_b32 v14, s49
    v_mov_b32 v15, 0
    s_mov_b64 exec, 1
    buffer_atomic_cmpswap v[14:15], v4, s[24:27], 0 offen sc0 sc1
    s_waitcnt vmcnt(0)
    v_readfirstlane_b32 s48, v14
    s_mov_b64 exec, -1
    s_cmp_eq_u32 s48, 0
    s_cselect_b32 s48, s49, s48
    s_nop 1
L_epd:
    s_waitcnt vmcnt(0)
    s_lshr_b32 s49, s48, 8
    s_lshr_b32 s50, s48, 16
    s_lshr_b32 s51, s48, 24
    s_mov_b32 s79, 0
    s_mov_b32 s80, 0
    s_mov_b32 s85, 0
    s_mov_b32 s84, 0
    s_mov_b32 s83, 0
    s_movk_i32 s81, 192
    s_movk_i32 s82, 264
    s_mov_b32 s86, 16
    s_lshr_b32 s92, s2, 4
    s_and_b32 s93, s2, 15
    s_cmp_eq_u32 s92, s93
    s_cselect_b32 s38, s92, 255
    s_mul_i32 s87, s38, 4352
    s_add_u32 s87, s87, 33554432
    s_mov_b32 s88, 33554432
    v_mul_u32_u24 v8, 4352, v1
    v_cmp_gt_u32 s[36:37], 16, v1
    v_and_b32 v6, 1, v1
    v_cmp_eq_u32 s[98:99], 0, v6
    v_lshrrev_b32 v18, 5, v1
    v_lshlrev_b32 v11, 4, v18
    v_add_u32 v11, 78080, v11
    v_lshlrev_b32 v10, 3, v1
    v_add_u32 v10, 65536, v10
    v_lshlrev_b32 v20, 3, v6
    v_add_u32 v20, 78080, v20
    v_cndmask_b32 v21, v5, 0, s[98:99]
    s_nop 1
L_hl:
    s_sleep 4
    ds_read_b32 v19, v7
    s_memrealtime s[96:97]
    s_waitcnt lgkmcnt(0)
    v_readlane_b32 s89, v19, 5
    v_readlane_b32 s90, v19, s86
    s_sub_u32 s96, s96, s78
    s_lshl_b32 s96, s96, 8
    s_mul_i32 s92, s80, s89
    s_add_u32 s92, s92, s79
    s_sub_u32 s92, s96, s92
    s_cmp_eq_u32 s80, 0
    s_cselect_b32 s92, 0, s92
    s_mul_i32 s92, s92, 200
    s_add_u32 s92, s92, 23592960
    s_ashr_i32 s92, s92, 20
    s_max_i32 s92, s92, 17
    s_min_i32 s92, s92, 26
    v_mov_b32 v18, s92
    ds_write_b32 v3, v18 offset:16
    s_cmp_ge_i32 s89, s81
    s_cbranch_scc1 L_pub
    s_cmp_ge_i32 s89, s82
    s_cbranch_scc1 L_rd
    s_cmp_eq_u32 s90, 4
    s_cbranch_scc1 L_prep
    s_cmp_lt_i32 s89, 2928
    s_cbranch_scc1 L_hl
    s_cmp_eq_u32 s86, 14
    s_cbranch_scc0 L_hl
    s_branch L_late
L_pub:
    s_cmp_eq_u32 s80, 0
    s_cselect_b32 s92, 850, s80
    s_sub_u32 s93, s89, s81
    s_mul_i32 s92, s92, s93
    s_sub_u32 s83, s96, s92
    s_addk_i32 s81, 384
    s_cmp_ge_u32 s38, 16
    s_cbranch_scc1 L_hl
    s_lshl_b32 s92, s78, 8
    s_add_u32 s92, s92, s83
    v_mov_b32 v14, s92
    v_mov_b32 v15, s48
    s_mov_b64 exec, 1
    buffer_store_dwordx2 v[14:15], v4, s[20:23], s87 offen sc0 sc1
    s_mov_b64 exec, -1
    s_add_u32 s87, s87, 69632
    s_branch L_hl
L_rd:
    s_mov_b64 exec, s[36:37]
    buffer_load_dwordx2 v[14:15], v8, s[20:23], s88 offen
    s_mov_b64 exec, -1
    s_add_u32 s88, s88, 69632
    s_lshl_b32 s92, s78, 8
    s_add_u32 s92, s92, s83
    s_waitcnt vmcnt(0)
    v_cmp_eq_u32 vcc, s48, v15
    v_subrev_u32 v14, s92, v14
    s_and_b64 vcc, vcc, s[36:37]
    v_cvt_f32_i32 v14, v14
    s_bcnt1_i32_b64 s93, vcc
    v_cndmask_b32 v14, 0, v14, vcc
    v_cvt_f32_u32 v15, s93
    s_nop 0
    v_add_f32_dpp v14, v14, v14 quad_perm:[1,0,3,2] row_mask:0xf bank_mask:0xf
    s_nop 1
    v_add_f32_dpp v14, v14, v14 quad_perm:[2,3,0,1] row_mask:0xf bank_mask:0xf
    s_nop 1
    v_add_f32_dpp v14, v14, v14 row_half_mirror row_mask:0xf bank_mask:0xf
    s_nop 1
    v_add_f32_dpp v14, v14, v14 row_mirror row_mask:0xf bank_mask:0xf
    v_rcp_f32 v15, v15
    s_nop 0
    v_mul_f32 v14, v14, v15
    v_cvt_i32_f32 v14, v14
    s_sub_u32 s94, s82, 72
    s_addk_i32 s82, 384
    v_readfirstlane_b32 s92, v14
    s_mov_b32 s95, s85
    s_min_u32 s85, s93, 1
    s_cmp_eq_u32 s93, 0
    s_nop 1
    s_cbranch_scc1 L_hl
    s_add_u32 s92, s92, s83
    s_sub_u32 s93, s92, s84
    s_mov_b32 s84, s92
    s_mul_hi_u32 s93, s93, 11184811
    s_cmp_eq_u32 s95, 0
    s_cselect_b32 s80, 850, s93
    s_max_u32 s80, s80, 1
    s_mul_i32 s93, s80, s94
    s_sub_u32 s79, s92, s93
    s_branch L_hl
L_prep:
    s_cmp_ge_u32 s86, 24
    s_cbranch_scc1 L_mrg
    ds_read_b128 v[24:27], v9
    ds_read_b128 v[28:31], v9 offset:16
    s_add_u32 s86, s86, 1
    s_sub_u32 s92, s86, 16
    v_mov_b32 v23, s92
    s_waitcnt lgkmcnt(0)
    v_max_f32 v40, v24, v26
    v_max3_f32 v40, v40, v28, v30
    v_lshlrev_b32 v32, 16, v25
    v_lshlrev_b32 v33, 16, v27
    v_lshlrev_b32 v34, 16, v29
    v_lshlrev_b32 v35, 16, v31
    v_max_f32_dpp v40, v40, v40 quad_perm:[1,0,3,2] row_mask:0xf bank_mask:0xf
    s_nop 1
    v_max_f32_dpp v40, v40, v40 quad_perm:[2,3,0,1] row_mask:0xf bank_mask:0xf
    s_nop 1
    v_max_f32_dpp v40, v40, v40 row_half_mirror row_mask:0xf bank_mask:0xf
    s_nop 1
    v_max_f32_dpp v40, v40, v40 row_mirror row_mask:0xf bank_mask:0xf
    v_and_b32 v36, 0xffff0000, v25
    v_and_b32 v37, 0xffff0000, v27
    v_and_b32 v38, 0xffff0000, v29
    v_and_b32 v39, 0xffff0000, v31
    v_mov_b32 v6, v40
    s_nop 1
    v_permlane16_swap_b32 v40, v6
    v_max_f32 v40, v40, v6
    v_sub_f32 v24, v24, v40
    v_sub_f32 v26, v26, v40
    v_sub_f32 v28, v28, v40
    v_sub_f32 v30, v30, v40
    v_exp_f32 v24, v24
    v_exp_f32 v26, v26
    v_exp_f32 v28, v28
    v_exp_f32 v30, v30
    v_add_f32 v42, v24, v26
    v_add_f32 v6, v28, v30
    v_add_f32 v42, v42, v6
    v_mul_f32 v24, v24, v32
    v_mul_f32 v26, v26, v33
    v_mul_f32 v28, v28, v34
    v_mul_f32 v30, v30, v35
    ds_write_b128 v9, v[24:27]
    ds_write_b128 v9, v[28:31] offset:16
    v_mul_f32 v41, v24, v36
    v_fmac_f32 v41, v26, v37
    v_fmac_f32 v41, v28, v38
    v_fmac_f32 v41, v30, v39
    v_add_f32_dpp v42, v42, v42 quad_perm:[1,0,3,2] row_mask:0xf bank_mask:0xf
    s_nop 0
    v_add_f32_dpp v41, v41, v41 quad_perm:[1,0,3,2] row_mask:0xf bank_mask:0xf
    v_add_f32_dpp v42, v42, v42 quad_perm:[2,3,0,1] row_mask:0xf bank_mask:0xf
    s_nop 0
    v_add_f32_dpp v41, v41, v41 quad_perm:[2,3,0,1] row_mask:0xf bank_mask:0xf
    v_add_f32_dpp v42, v42, v42 row_half_mirror row_mask:0xf bank_mask:0xf
    s_nop 0
    v_add_f32_dpp v41, v41, v41 row_half_mirror row_mask:0xf bank_mask:0xf
    v_add_f32_dpp v42, v42, v42 row_mirror row_mask:0xf bank_mask:0xf
    s_nop 0
    v_add_f32_dpp v41, v41, v41 row_mirror row_mask:0xf bank_mask:0xf
    v_mov_b32 v6, v42
    s_nop 1
    v_permlane16_swap_b32 v42, v6
    v_add_f32 v42, v42, v6
    v_mov_b32 v6, v41
    s_nop 1
    v_permlane16_swap_b32 v41, v6
    v_add_f32 v41, v41, v6
    v_sub_f32 v41, 0, v41
    v_mov_b32 v43, v41
    ds_write_b128 v11, v[40:43]
    ds_write_b32 v3, v23 offset:52
    v_add_u32 v9, 2048, v9
    v_add_u32 v11, 32, v11
    s_cmp_eq_u32 s86, 24
    s_waitcnt lgkmcnt(0)
    s_cbranch_scc0 L_hl
    v_add_u32 v9, 49152, v2
    s_nop 1
    s_branch L_hl
L_mrg:
    ds_read_b64 v[112:113], v20 offset:0
    ds_read_b64 v[114:115], v20 offset:16
    ds_read2st64_b64 v[88:91], v10 offset0:0 offset1:1
    ds_read2st64_b64 v[92:95], v10 offset0:2 offset1:3
    ds_read2st64_b64 v[96:99], v10 offset0:4 offset1:5
    ds_read2st64_b64 v[100:103], v10 offset0:6 offset1:7
    ds_read2st64_b64 v[104:107], v10 offset0:8 offset1:9
    ds_read2st64_b64 v[108:111], v10 offset0:10 offset1:11
    s_add_u32 s86, s86, 1
    s_sub_u32 s92, s86, 24
    v_mov_b32 v23, s92
    ds_write_b32 v3, v23 offset:60
    s_bitcmp1_b32 s92, 0
    s_cselect_b32 s92, 1, -1
    s_mul_i32 s92, s92, 6144
    v_add_u32 v10, s92, v10
    v_add_u32 v20, 32, v20
    s_cmp_eq_u32 s86, 31
    s_cselect_b32 s86, 14, s86
    s_waitcnt lgkmcnt(0)
    v_bfi_b32 v83, v21, s51, v112
    v_bfi_b32 v87, v21, s51, v114
    v_mov_b32 v112, v115
    v_pk_add_f32 v[88:89], v[88:89], v[94:95]
    v_pk_add_f32 v[100:101], v[100:101], v[106:107]
    v_pk_add_f32 v[90:91], v[90:91], v[96:97]
    v_pk_add_f32 v[102:103], v[102:103], v[108:109]
    v_pk_add_f32 v[92:93], v[92:93], v[98:99]
    v_pk_add_f32 v[104:105], v[104:105], v[110:111]
    v_pk_add_f32 v[88:89], v[88:89], v[112:113] op_sel:[0,1] op_sel_hi:[1,1]
    v_pk_add_f32 v[90:91], v[90:91], v[112:113] op_sel:[0,1] op_sel_hi:[1,0]
    v_pk_add_f32 v[92:93], v[92:93], v[112:113] op_sel:[0,0] op_sel_hi:[1,0]
    v_pk_add_f32 v[88:89], v[88:89], v[100:101]
    v_pk_add_f32 v[90:91], v[90:91], v[102:103]
    v_pk_add_f32 v[92:93], v[92:93], v[104:105]
    v_bfi_b32 v80, v5, s48, v88
    v_bfi_b32 v81, v5, s49, v89
    v_bfi_b32 v82, v5, s50, v90
    v_bfi_b32 v84, v5, s48, v91
    v_bfi_b32 v85, v5, s49, v92
    v_bfi_b32 v86, v5, s50, v93
    ds_write_b128 v9, v[80:83]
    ds_write_b128 v9, v[84:87] offset:1024
    v_add_u32 v9, 2048, v9
    s_waitcnt lgkmcnt(0)
    s_nop 0
    s_branch L_hl
L_late:
    s_getpc_b64 s[92:93]
L_pc2:
    s_sub_u32 s92, s92, L_pc2-L_late
    s_subb_u32 s93, s93, 0
    v_lshlrev_b32 v19, 7, v1
    v_min_u32 v23, L_end-L_late, v19
    global_load_dword v6, v23, s[92:93]
    s_and_b32 s32, s2, 0x70
    s_and_b32 s92, s2, 7
    s_lshl1_add_u32 s32, s92, s32
    s_lshr_b32 s92, s2, 7
    s_add_u32 s32, s32, s92
    s_lshl_b32 s92, s3, 8
    s_add_u32 s32, s32, s92
    s_lshl_b32 s32, s32, 10
    s_add_u32 s94, s32, 131072
    s_lshr_b32 s34, s2, 3
    s_and_b32 s35, s2, 7
    v_lshrrev_b32 v18, 3, v1
    v_and_b32 v13, 7, v1
    v_lshlrev_b32 v18, 10, v18
    v_lshl_add_u32 v12, v13, 4, v18
    v_lshlrev_b32 v13, 3, v13
    s_mov_b32 s33, 0
    v_add_u32 v9, 49152, v2
    ds_read_b128 v[24:27], v9 offset:0
    ds_read_b128 v[28:31], v9 offset:1024
    ds_read_b128 v[32:35], v9 offset:2048
    ds_read_b128 v[36:39], v9 offset:3072
    ds_read_b128 v[40:43], v9 offset:4096
    ds_read_b128 v[44:47], v9 offset:5120
    ds_read_b128 v[48:51], v9 offset:6144
    ds_read_b128 v[52:55], v9 offset:7168
    ds_read_b128 v[56:59], v9 offset:8192
    ds_read_b128 v[60:63], v9 offset:9216
    s_waitcnt lgkmcnt(0)
    ds_read_b128 v[64:67], v9 offset:10240
    ds_read_b128 v[68:71], v9 offset:11264
    ds_read_b128 v[72:75], v9 offset:12288
    ds_read_b128 v[76:79], v9 offset:13312
    ds_read_b64 v[112:113], v20 offset:0
    ds_read_b64 v[114:115], v20 offset:16
    s_waitcnt lgkmcnt(0)
    v_bfi_b32 v83, v21, s51, v112
    v_bfi_b32 v87, v21, s51, v114
    v_mov_b32 v112, v115
    s_nop 1
L_hl2:
    ds_read_b32 v19, v7
    s_memrealtime s[96:97]
    s_waitcnt lgkmcnt(0)
    v_readlane_b32 s89, v19, 5
    s_sub_u32 s96, s96, s78
    s_lshl_b32 s96, s96, 8
    s_mul_i32 s92, s80, s89
    s_add_u32 s92, s92, s79
    s_sub_u32 s92, s96, s92
    s_cmp_eq_u32 s80, 0
    s_cselect_b32 s92, 0, s92
    s_mul_i32 s92, s92, 200
    s_add_u32 s92, s92, 23592960
    s_ashr_i32 s92, s92, 20
    s_max_i32 s92, s92, 17
    s_min_i32 s92, s92, 26
    v_mov_b32 v18, s92
    ds_write_b32 v3, v18 offset:16
    s_cmp_lt_i32 s89, 3045
    s_cbranch_scc1 L_hl2
    buffer_store_dwordx4 v[24:27], v2, s[20:23], s32 offen sc0 sc1
    buffer_store_dwordx4 v[28:31], v2, s[20:23], s94 offen sc0 sc1
    s_add_u32 s32, s32, 524288
    s_add_u32 s94, s94, 524288
    buffer_store_dwordx4 v[32:35], v2, s[20:23], s32 offen sc0 sc1
    buffer_store_dwordx4 v[36:39], v2, s[20:23], s94 offen sc0 sc1
    s_add_u32 s32, s32, 524288
    s_add_u32 s94, s94, 524288
    buffer_store_dwordx4 v[40:43], v2, s[20:23], s32 offen sc0 sc1
    buffer_store_dwordx4 v[44:47], v2, s[20:23], s94 offen sc0 sc1
    s_add_u32 s32, s32, 524288
    s_add_u32 s94, s94, 524288
    buffer_store_dwordx4 v[48:51], v2, s[20:23], s32 offen sc0 sc1
    buffer_store_dwordx4 v[52:55], v2, s[20:23], s94 offen sc0 sc1
    s_add_u32 s32, s32, 524288
    s_add_u32 s94, s94, 524288
    buffer_store_dwordx4 v[56:59], v2, s[20:23], s32 offen sc0 sc1
    buffer_store_dwordx4 v[60:63], v2, s[20:23], s94 offen sc0 sc1
    s_add_u32 s32, s32, 524288
    s_add_u32 s94, s94, 524288
    buffer_store_dwordx4 v[64:67], v2, s[20:23], s32 offen sc0 sc1
    buffer_store_dwordx4 v[68:71], v2, s[20:23], s94 offen sc0 sc1
    s_add_u32 s32, s32, 524288
    s_add_u32 s94, s94, 524288
    buffer_store_dwordx4 v[72:75], v2, s[20:23], s32 offen sc0 sc1
    buffer_store_dwordx4 v[76:79], v2, s[20:23], s94 offen sc0 sc1
    s_add_u32 s32, s32, 524288
    s_add_u32 s94, s94, 524288
L_w7:
    ds_read_b32 v19, v7
    ds_read2st64_b64 v[88:91], v10 offset0:0 offset1:1
    ds_read2st64_b64 v[92:95], v10 offset0:2 offset1:3
    ds_read2st64_b64 v[96:99], v10 offset0:4 offset1:5
    ds_read2st64_b64 v[100:103], v10 offset0:6 offset1:7
    ds_read2st64_b64 v[104:107], v10 offset0:8 offset1:9
    ds_read2st64_b64 v[108:111], v10 offset0:10 offset1:11
    s_waitcnt lgkmcnt(6)
    v_readlane_b32 s92, v19, 31
    s_nop 0
    s_cmp_lt_u32 s92, 4
    s_waitcnt lgkmcnt(0)
    s_nop 1
    s_cbranch_scc1 L_w7
    v_pk_add_f32 v[88:89], v[88:89], v[94:95]
    v_pk_add_f32 v[100:101], v[100:101], v[106:107]
    v_pk_add_f32 v[90:91], v[90:91], v[96:97]
    v_pk_add_f32 v[102:103], v[102:103], v[108:109]
    v_pk_add_f32 v[92:93], v[92:93], v[98:99]
    v_pk_add_f32 v[104:105], v[104:105], v[110:111]
    v_pk_add_f32 v[88:89], v[88:89], v[112:113] op_sel:[0,1] op_sel_hi:[1,1]
    v_pk_add_f32 v[90:91], v[90:91], v[112:113] op_sel:[0,1] op_sel_hi:[1,0]
    v_pk_add_f32 v[92:93], v[92:93], v[112:113] op_sel:[0,0] op_sel_hi:[1,0]
    v_pk_add_f32 v[88:89], v[88:89], v[100:101]
    v_pk_add_f32 v[90:91], v[90:91], v[102:103]
    v_pk_add_f32 v[92:93], v[92:93], v[104:105]
    v_bfi_b32 v80, v5, s48, v88
    v_bfi_b32 v81, v5, s49, v89
    v_bfi_b32 v82, v5, s50, v90
    buffer_store_dwordx4 v[80:83], v2, s[20:23], s32 offen sc0 sc1
    v_bfi_b32 v84, v5, s48, v91
    v_bfi_b32 v85, v5, s49, v92
    v_bfi_b32 v86, v5, s50, v93
    buffer_store_dwordx4 v[84:87], v2, s[20:23], s94 offen sc0 sc1
    s_nop 1
L_try:
    s_mul_i32 s92, s34, 131072
    s_lshl_b32 s95, s35, 7
    s_add_u32 s92, s92, s95
    buffer_load_dwordx4 v[88:91], v12, s[20:23], s92 offen sc0 sc1
    s_add_u32 s92, s92, 8192
    buffer_load_dwordx4 v[92:95], v12, s[20:23], s92 offen sc0 sc1
    s_add_u32 s92, s92, 8192
    buffer_load_dwordx4 v[96:99], v12, s[20:23], s92 offen sc0 sc1
    s_add_u32 s92, s92, 8192
    buffer_load_dwordx4 v[100:103], v12, s[20:23], s92 offen sc0 sc1
    s_add_u32 s92, s92, 8192
    buffer_load_dwordx4 v[104:107], v12, s[20:23], s92 offen sc0 sc1
    s_add_u32 s92, s92, 8192
    buffer_load_dwordx4 v[108:111], v12, s[20:23], s92 offen sc0 sc1
    s_add_u32 s92, s92, 8192
    buffer_load_dwordx4 v[112:115], v12, s[20:23], s92 offen sc0 sc1
    s_add_u32 s92, s92, 8192
    buffer_load_dwordx4 v[116:119], v12, s[20:23], s92 offen sc0 sc1
    s_add_u32 s92, s92, 8192
    buffer_load_dwordx4 v[120:123], v12, s[20:23], s92 offen sc0 sc1
    s_add_u32 s92, s92, 8192
    buffer_load_dwordx4 v[124:127], v12, s[20:23], s92 offen sc0 sc1
    s_add_u32 s92, s92, 8192
    buffer_load_dwordx4 v[128:131], v12, s[20:23], s92 offen sc0 sc1
    s_add_u32 s92, s92, 8192
    buffer_load_dwordx4 v[132:135], v12, s[20:23], s92 offen sc0 sc1
    s_add_u32 s92, s92, 8192
    buffer_load_dwordx4 v[136:139], v12, s[20:23], s92 offen sc0 sc1
    s_add_u32 s92, s92, 8192
    buffer_load_dwordx4 v[140:143], v12, s[20:23], s92 offen sc0 sc1
    s_add_u32 s92, s92, 8192
    buffer_load_dwordx4 v[144:147], v12, s[20:23], s92 offen sc0 sc1
    s_add_u32 s92, s92, 8192
    buffer_load_dwordx4 v[148:151], v12, s[20:23], s92 offen sc0 sc1
    s_waitcnt vmcnt(15)
    v_xor_b32 v23, s48, v88
    v_bitop3_b32 v23, v23, v89, s49 bitop3:0xf6
    v_bitop3_b32 v23, v23, v90, s50 bitop3:0xf6
    v_xor_b32 v6, s51, v91
    s_waitcnt vmcnt(14)
    v_bitop3_b32 v23, v23, v92, s48 bitop3:0xf6
    v_bitop3_b32 v23, v23, v93, s49 bitop3:0xf6
    v_bitop3_b32 v23, v23, v94, s50 bitop3:0xf6
    v_bitop3_b32 v6, v6, v95, s51 bitop3:0xf6
    s_waitcnt vmcnt(13)
    v_bitop3_b32 v23, v23, v96, s48 bitop3:0xf6
    v_bitop3_b32 v23, v23, v97, s49 bitop3:0xf6
    v_bitop3_b32 v23, v23, v98, s50 bitop3:0xf6
    v_bitop3_b32 v6, v6, v99, s51 bitop3:0xf6
    s_waitcnt vmcnt(12)
    v_bitop3_b32 v23, v23, v100, s48 bitop3:0xf6
    v_bitop3_b32 v23, v23, v101, s49 bitop3:0xf6
    v_bitop3_b32 v23, v23, v102, s50 bitop3:0xf6
    v_bitop3_b32 v6, v6, v103, s51 bitop3:0xf6
    s_waitcnt vmcnt(11)
    v_bitop3_b32 v23, v23, v104, s48 bitop3:0xf6
    v_bitop3_b32 v23, v23, v105, s49 bitop3:0xf6
    v_bitop3_b32 v23, v23, v106, s50 bitop3:0xf6
    v_bitop3_b32 v6, v6, v107, s51 bitop3:0xf6
    s_waitcnt vmcnt(10)
    v_bitop3_b32 v23, v23, v108, s48 bitop3:0xf6
    v_bitop3_b32 v23, v23, v109, s49 bitop3:0xf6
    v_bitop3_b32 v23, v23, v110, s50 bitop3:0xf6
    v_bitop3_b32 v6, v6, v111, s51 bitop3:0xf6
    s_waitcnt vmcnt(9)
    v_bitop3_b32 v23, v23, v112, s48 bitop3:0xf6
    v_bitop3_b32 v23, v23, v113, s49 bitop3:0xf6
    v_bitop3_b32 v23, v23, v114, s50 bitop3:0xf6
    v_bitop3_b32 v6, v6, v115, s51 bitop3:0xf6
    s_waitcnt vmcnt(8)
    v_bitop3_b32 v23, v23, v116, s48 bitop3:0xf6
    v_bitop3_b32 v23, v23, v117, s49 bitop3:0xf6
    v_bitop3_b32 v23, v23, v118, s50 bitop3:0xf6
    v_bitop3_b32 v6, v6, v119, s51 bitop3:0xf6
    s_waitcnt vmcnt(7)
    v_bitop3_b32 v23, v23, v120, s48 bitop3:0xf6
    v_bitop3_b32 v23, v23, v121, s49 bitop3:0xf6
    v_bitop3_b32 v23, v23, v122, s50 bitop3:0xf6
    v_bitop3_b32 v6, v6, v123, s51 bitop3:0xf6
    s_waitcnt vmcnt(6)
    v_bitop3_b32 v23, v23, v124, s48 bitop3:0xf6
    v_bitop3_b32 v23, v23, v125, s49 bitop3:0xf6
    v_bitop3_b32 v23, v23, v126, s50 bitop3:0xf6
    v_bitop3_b32 v6, v6, v127, s51 bitop3:0xf6
    s_waitcnt vmcnt(5)
    v_bitop3_b32 v23, v23, v128, s48 bitop3:0xf6
    v_bitop3_b32 v23, v23, v129, s49 bitop3:0xf6
    v_bitop3_b32 v23, v23, v130, s50 bitop3:0xf6
    v_bitop3_b32 v6, v6, v131, s51 bitop3:0xf6
    s_waitcnt vmcnt(4)
    v_bitop3_b32 v23, v23, v132, s48 bitop3:0xf6
    v_bitop3_b32 v23, v23, v133, s49 bitop3:0xf6
    v_bitop3_b32 v23, v23, v134, s50 bitop3:0xf6
    v_bitop3_b32 v6, v6, v135, s51 bitop3:0xf6
    s_waitcnt vmcnt(3)
    v_bitop3_b32 v23, v23, v136, s48 bitop3:0xf6
    v_bitop3_b32 v23, v23, v137, s49 bitop3:0xf6
    v_bitop3_b32 v23, v23, v138, s50 bitop3:0xf6
    v_bitop3_b32 v6, v6, v139, s51 bitop3:0xf6
    s_waitcnt vmcnt(2)
    v_bitop3_b32 v23, v23, v140, s48 bitop3:0xf6
    v_bitop3_b32 v23, v23, v141, s49 bitop3:0xf6
    v_bitop3_b32 v23, v23, v142, s50 bitop3:0xf6
    v_bitop3_b32 v6, v6, v143, s51 bitop3:0xf6
    s_waitcnt vmcnt(1)
    v_bitop3_b32 v23, v23, v144, s48 bitop3:0xf6
    v_bitop3_b32 v23, v23, v145, s49 bitop3:0xf6
    v_bitop3_b32 v23, v23, v146, s50 bitop3:0xf6
    v_bitop3_b32 v6, v6, v147, s51 bitop3:0xf6
    s_waitcnt vmcnt(0)
    v_bitop3_b32 v23, v23, v148, s48 bitop3:0xf6
    v_bitop3_b32 v23, v23, v149, s49 bitop3:0xf6
    v_bitop3_b32 v23, v23, v150, s50 bitop3:0xf6
    v_bitop3_b32 v6, v6, v151, s51 bitop3:0xf6
    v_and_b32 v6, v6, v21
    v_and_or_b32 v23, v23, v5, v6
    v_cmp_ne_u32 vcc, 0, v23
    s_nop 4
    s_cbranch_vccz L_cok
    s_sleep 1
    s_add_u32 s33, s33, 1
    s_cmp_lt_u32 s33, 200000
    s_cbranch_scc1 L_try
L_cok:
    s_mul_i32 s93, s34, 384
    s_and_b32 s95, s35, 1
    s_lshl_b32 s95, s95, 6
    s_add_u32 s93, s93, s95
    s_andn2_b32 s95, s35, 1
    s_add_u32 s93, s93, s95
    v_max_f32 v19, v91, v95
    v_max3_f32 v19, v19, v99, v103
    v_max3_f32 v19, v19, v107, v111
    v_max3_f32 v19, v19, v115, v119
    v_max3_f32 v19, v19, v123, v127
    v_max3_f32 v19, v19, v131, v135
    v_max3_f32 v19, v19, v139, v143
    v_max3_f32 v19, v19, v147, v151
    s_nop 1
    v_max_f32_dpp v19, v19, v19 row_ror:8 row_mask:0xf bank_mask:0xf
    v_mov_b32 v6, v19
    s_nop 1
    v_permlane32_swap_b32 v19, v6
    v_max_f32 v19, v19, v6
    v_mov_b32 v6, v19
    s_nop 1
    v_permlane16_swap_b32 v19, v6
    v_max_f32 v19, v19, v6
    s_nop 1
    v_mov_b32_dpp v19, v19 quad_perm:[0,0,2,2] row_mask:0xf bank_mask:0xf
    s_nop 1
    v_sub_f32_dpp v152, v91, v19 quad_perm:[0,0,2,2] row_mask:0xf bank_mask:0xf
    v_sub_f32_dpp v153, v95, v19 quad_perm:[0,0,2,2] row_mask:0xf bank_mask:0xf
    v_sub_f32_dpp v154, v99, v19 quad_perm:[0,0,2,2] row_mask:0xf bank_mask:0xf
    v_sub_f32_dpp v155, v103, v19 quad_perm:[0,0,2,2] row_mask:0xf bank_mask:0xf
    v_sub_f32_dpp v156, v107, v19 quad_perm:[0,0,2,2] row_mask:0xf bank_mask:0xf
    v_sub_f32_dpp v157, v111, v19 quad_perm:[0,0,2,2] row_mask:0xf bank_mask:0xf
    v_sub_f32_dpp v158, v115, v19 quad_perm:[0,0,2,2] row_mask:0xf bank_mask:0xf
    v_sub_f32_dpp v159, v119, v19 quad_perm:[0,0,2,2] row_mask:0xf bank_mask:0xf
    v_sub_f32_dpp v160, v123, v19 quad_perm:[0,0,2,2] row_mask:0xf bank_mask:0xf
    v_sub_f32_dpp v161, v127, v19 quad_perm:[0,0,2,2] row_mask:0xf bank_mask:0xf
    v_sub_f32_dpp v162, v131, v19 quad_perm:[0,0,2,2] row_mask:0xf bank_mask:0xf
    v_sub_f32_dpp v163, v135, v19 quad_perm:[0,0,2,2] row_mask:0xf bank_mask:0xf
    v_sub_f32_dpp v164, v139, v19 quad_perm:[0,0,2,2] row_mask:0xf bank_mask:0xf
    v_sub_f32_dpp v165, v143, v19 quad_perm:[0,0,2,2] row_mask:0xf bank_mask:0xf
    v_sub_f32_dpp v166, v147, v19 quad_perm:[0,0,2,2] row_mask:0xf bank_mask:0xf
    v_sub_f32_dpp v167, v151, v19 quad_perm:[0,0,2,2] row_mask:0xf bank_mask:0xf
    v_exp_f32 v152, v152
    v_exp_f32 v153, v153
    v_exp_f32 v154, v154
    v_exp_f32 v155, v155
    v_exp_f32 v156, v156
    v_exp_f32 v157, v157
    v_exp_f32 v158, v158
    v_exp_f32 v159, v159
    v_exp_f32 v160, v160
    v_exp_f32 v161, v161
    v_exp_f32 v162, v162
    v_exp_f32 v163, v163
    v_exp_f32 v164, v164
    v_exp_f32 v165, v165
    v_exp_f32 v166, v166
    v_exp_f32 v167, v167
    v_mul_f32 v14, v88, v152
    v_mul_f32 v15, v89, v152
    v_mul_f32 v16, v90, v152
    v_mul_f32_dpp v17, v91, v152 quad_perm:[1,1,3,3] row_mask:0xf bank_mask:0xf
    v_fmac_f32 v14, v92, v153
    v_fmac_f32 v15, v93, v153
    v_fmac_f32 v16, v94, v153
    v_fmac_f32_dpp v17, v95, v153 quad_perm:[1,1,3,3] row_mask:0xf bank_mask:0xf
    v_fmac_f32 v14, v96, v154
    v_fmac_f32 v15, v97, v154
    v_fmac_f32 v16, v98, v154
    v_fmac_f32_dpp v17, v99, v154 quad_perm:[1,1,3,3] row_mask:0xf bank_mask:0xf
    v_fmac_f32 v14, v100, v155
    v_fmac_f32 v15, v101, v155
    v_fmac_f32 v16, v102, v155
    v_fmac_f32_dpp v17, v103, v155 quad_perm:[1,1,3,3] row_mask:0xf bank_mask:0xf
    v_fmac_f32 v14, v104, v156
    v_fmac_f32 v15, v105, v156
    v_fmac_f32 v16, v106, v156
    v_fmac_f32_dpp v17, v107, v156 quad_perm:[1,1,3,3] row_mask:0xf bank_mask:0xf
    v_fmac_f32 v14, v108, v157
    v_fmac_f32 v15, v109, v157
    v_fmac_f32 v16, v110, v157
    v_fmac_f32_dpp v17, v111, v157 quad_perm:[1,1,3,3] row_mask:0xf bank_mask:0xf
    v_fmac_f32 v14, v112, v158
    v_fmac_f32 v15, v113, v158
    v_fmac_f32 v16, v114, v158
    v_fmac_f32_dpp v17, v115, v158 quad_perm:[1,1,3,3] row_mask:0xf bank_mask:0xf
    v_fmac_f32 v14, v116, v159
    v_fmac_f32 v15, v117, v159
    v_fmac_f32 v16, v118, v159
    v_fmac_f32_dpp v17, v119, v159 quad_perm:[1,1,3,3] row_mask:0xf bank_mask:0xf
    v_fmac_f32 v14, v120, v160
    v_fmac_f32 v15, v121, v160
    v_fmac_f32 v16, v122, v160
    v_fmac_f32_dpp v17, v123, v160 quad_perm:[1,1,3,3] row_mask:0xf bank_mask:0xf
    v_fmac_f32 v14, v124, v161
    v_fmac_f32 v15, v125, v161
    v_fmac_f32 v16, v126, v161
    v_fmac_f32_dpp v17, v127, v161 quad_perm:[1,1,3,3] row_mask:0xf bank_mask:0xf
    v_fmac_f32 v14, v128, v162
    v_fmac_f32 v15, v129, v162
    v_fmac_f32 v16, v130, v162
    v_fmac_f32_dpp v17, v131, v162 quad_perm:[1,1,3,3] row_mask:0xf bank_mask:0xf
    v_fmac_f32 v14, v132, v163
    v_fmac_f32 v15, v133, v163
    v_fmac_f32 v16, v134, v163
    v_fmac_f32_dpp v17, v135, v163 quad_perm:[1,1,3,3] row_mask:0xf bank_mask:0xf
    v_fmac_f32 v14, v136, v164
    v_fmac_f32 v15, v137, v164
    v_fmac_f32 v16, v138, v164
    v_fmac_f32_dpp v17, v139, v164 quad_perm:[1,1,3,3] row_mask:0xf bank_mask:0xf
    v_fmac_f32 v14, v140, v165
    v_fmac_f32 v15, v141, v165
    v_fmac_f32 v16, v142, v165
    v_fmac_f32_dpp v17, v143, v165 quad_perm:[1,1,3,3] row_mask:0xf bank_mask:0xf
    v_fmac_f32 v14, v144, v166
    v_fmac_f32 v15, v145, v166
    v_fmac_f32 v16, v146, v166
    v_fmac_f32_dpp v17, v147, v166 quad_perm:[1,1,3,3] row_mask:0xf bank_mask:0xf
    v_fmac_f32 v14, v148, v167
    v_fmac_f32 v15, v149, v167
    v_fmac_f32 v16, v150, v167
    v_fmac_f32_dpp v17, v151, v167 quad_perm:[1,1,3,3] row_mask:0xf bank_mask:0xf
    v_add_f32_dpp v14, v14, v14 row_ror:8 row_mask:0xf bank_mask:0xf
    v_add_f32_dpp v15, v15, v15 row_ror:8 row_mask:0xf bank_mask:0xf
    v_add_f32_dpp v16, v16, v16 row_ror:8 row_mask:0xf bank_mask:0xf
    v_add_f32_dpp v17, v17, v17 row_ror:8 row_mask:0xf bank_mask:0xf
    v_mov_b32 v24, v14
    v_mov_b32 v25, v15
    v_mov_b32 v26, v16
    v_mov_b32 v27, v17
    v_permlane32_swap_b32 v14, v24
    v_permlane32_swap_b32 v15, v25
    v_permlane32_swap_b32 v16, v26
    v_permlane32_swap_b32 v17, v27
    v_add_f32 v14, v14, v24
    v_add_f32 v15, v15, v25
    v_add_f32 v16, v16, v26
    v_add_f32 v17, v17, v27
    v_mov_b32 v24, v14
    v_mov_b32 v25, v15
    v_mov_b32 v26, v16
    v_mov_b32 v27, v17
    v_permlane16_swap_b32 v14, v24
    v_permlane16_swap_b32 v15, v25
    v_permlane16_swap_b32 v16, v26
    v_permlane16_swap_b32 v17, v27
    v_add_f32 v17, v17, v27
    v_add_f32 v14, v14, v24
    v_add_f32 v15, v15, v25
    v_add_f32 v16, v16, v26
    v_rcp_f32 v18, v17
    s_nop 0
    v_mul_f32 v14, v14, v18
    v_mul_f32 v15, v15, v18
    v_mul_f32 v16, v16, v18
    v_cvt_pk_bf16_f32 v14, v14, v14
    v_cvt_pk_bf16_f32 v15, v15, v15
    v_cvt_pk_bf16_f32 v16, v16, v16
    s_mov_b64 exec, 0xff
    buffer_store_short v14, v13, s[28:31], s93 offen offset:0
    buffer_store_short v15, v13, s[28:31], s93 offen offset:128
    buffer_store_short v16, v13, s[28:31], s93 offen offset:256
L_end:
    s_endpgm
.section .rodata,"a"
.p2align 6
.amdhsa_kernel standalone__kv_cache_quant_pre_rope_vs_post_rope__decode_kernel
  .amdhsa_next_free_vgpr 168
  .amdhsa_next_free_sgpr 102
  .amdhsa_accum_offset 168
  .amdhsa_group_segment_fixed_size 0
  .amdhsa_kernarg_size 112
  .amdhsa_user_sgpr_count 2
  .amdhsa_user_sgpr_kernarg_segment_ptr 1
  .amdhsa_system_sgpr_workgroup_id_x 1
.end_amdhsa_kernel
```

```asm
; @launch grid=(256,1,1) block=(384,1,1) lds=79872
.amdgcn_target "amdgcn-amd-amdhsa--gfx950"
.text
.globl standalone__kv_cache_quant_pre_rope_vs_post_rope__decode_kernel
.p2align 8
.type standalone__kv_cache_quant_pre_rope_vs_post_rope__decode_kernel,@function
standalone__kv_cache_quant_pre_rope_vs_post_rope__decode_kernel:
    s_load_dwordx16 s[48:63], s[0:1], 0
    s_load_dwordx8 s[64:71], s[0:1], 64
    s_load_dwordx4 s[72:75], s[0:1], 96
    s_cmp_ge_u32 s2, 256
    s_cbranch_scc1 L_end
    v_lshrrev_b32 v18, 6, v0
    v_and_b32 v1, 63, v0
    v_readfirstlane_b32 s76, v18
    v_cmp_eq_u32 vcc, 4, v1
    v_lshlrev_b32 v7, 2, v1
    v_add_u32 v7, 77824, v7
    v_cndmask_b32 v19, 0, 20, vcc
    ds_write_b32 v7, v19
    s_and_b32 s92, s2, 7
    s_lshl_b32 s77, s92, 6
    s_and_b32 s92, s2, 0x60
    s_lshl4_add_u32 s77, s92, s77
    s_and_b32 s92, s2, 0x10
    s_lshl1_add_u32 s77, s92, s77
    s_lshr_b32 s92, s2, 7
    s_lshl4_add_u32 s77, s92, s77
    s_bfe_u32 s3, s2, 0x10003
    s_lshl_b32 s92, s3, 13
    s_add_u32 s77, s77, s92
    s_cmp_lg_u32 s76, 0
    s_cbranch_scc1 L_other
    s_setprio 3
    v_lshlrev_b32 v2, 4, v1
    s_mul_i32 s79, s3, 25165824
    s_mul_i32 s78, s77, 768
    s_add_u32 s78, s78, s79
    s_mov_b32 s6, 402653184
    s_mov_b32 s7, 0x20000
    s_mov_b32 m0, 0
    s_movk_i32 s85, 4096
    s_mov_b32 s86, 12574720
    s_waitcnt lgkmcnt(0)
    s_mov_b32 s4, s50
    s_mov_b32 s5, s51
L_i0:
    buffer_load_dwordx4 v2, s[4:7], s78 offen offset:0 nt lds
    buffer_load_dwordx4 v2, s[4:7], s78 offen offset:1024 nt lds
    buffer_load_dwordx4 v2, s[4:7], s78 offen offset:2048 nt lds
    buffer_load_dwordx4 v2, s[4:7], s78 offen offset:3072 nt lds
    s_add_u32 m0, m0, s85
    s_cmpk_eq_u32 m0, 12288
    s_cselect_b32 s92, s86, s85
    s_add_u32 s78, s78, s92
    s_cmpk_lt_u32 m0, 24576
    s_cbranch_scc1 L_i0
    s_mov_b32 s81, 2
    s_and_b32 s92, s81, 14
    s_lshl_b32 s92, s92, 10
    s_add_u32 s92, s92, s77
    s_and_b32 s92, s92, 16383
    s_mul_i32 s80, s92, 768
    s_bfe_u32 s92, s81, 0x30004
    s_and_b32 s93, s81, 1
    s_lshl2_add_u32 s92, s92, s93
    s_mul_i32 s92, s92, 12582912
    s_add_u32 s80, s80, s79
    s_add_u32 s80, s80, s92
    s_and_b32 s86, s81, 3
    s_mul_i32 s86, s86, 12288
    s_mov_b32 s78, s80
    s_mov_b32 s82, -1
    s_mov_b32 s84, 0
    v_mov_b32 v6, 77844
    v_mov_b32 v3, 0
    v_writelane_b32 v3, 20, 4
    s_barrier
    s_nop 0
L_D20:
    s_mul_i32 s92, s81, 12
    s_sub_u32 s92, s92, 20
    v_mov_b32 v5, s92
    s_nop 1
L_B20:
L_B20_0:
    s_cmp_lt_i32 s84, s82
    s_cbranch_scc1 L_B20_0w
    s_waitcnt vmcnt(19)
    buffer_load_dwordx4 v2, s[4:7], s78 offen offset:0 nt lds
    v_add_u32 v5, 3, v5
    s_add_u32 s81, s81, 1
    s_and_b32 s92, s81, 14
    s_waitcnt vmcnt(19)
    buffer_load_dwordx4 v2, s[4:7], s78 offen offset:1024 nt lds
    v_readlane_b32 s84, v3, 1
    ds_read_b32 v3, v7
    s_lshl_b32 s92, s92, 10
    s_add_u32 s92, s92, s77
    s_waitcnt vmcnt(19)
    buffer_load_dwordx4 v2, s[4:7], s78 offen offset:2048 nt lds
    ds_write_b32 v6, v5
    s_and_b32 s92, s92, 16383
    s_mul_i32 s80, s92, 768
L_B20_1:
    s_cmp_lt_i32 s84, s82
    s_cbranch_scc1 L_B20_1w
    s_waitcnt vmcnt(19)
    buffer_load_dwordx4 v2, s[4:7], s78 offen offset:3072 nt lds
    v_add_u32 v5, 3, v5
    s_add_u32 m0, m0, s85
    s_add_u32 s78, s78, s85
    s_waitcnt vmcnt(19)
    buffer_load_dwordx4 v2, s[4:7], s78 offen offset:0 nt lds
    v_readlane_b32 s84, v3, 2
    ds_read_b32 v3, v7
    s_bfe_u32 s92, s81, 0x30004
    s_and_b32 s93, s81, 1
    s_waitcnt vmcnt(19)
    buffer_load_dwordx4 v2, s[4:7], s78 offen offset:1024 nt lds
    ds_write_b32 v6, v5
    s_lshl2_add_u32 s92, s92, s93
    s_mul_i32 s92, s92, 12582912
L_B20_2:
    s_cmp_lt_i32 s84, s82
    s_cbranch_scc1 L_B20_2w
    s_waitcnt vmcnt(19)
    buffer_load_dwordx4 v2, s[4:7], s78 offen offset:2048 nt lds
    v_add_u32 v5, 3, v5
    s_add_u32 s80, s80, s79
    s_add_u32 s80, s80, s92
    s_waitcnt vmcnt(19)
    buffer_load_dwordx4 v2, s[4:7], s78 offen offset:3072 nt lds
    v_readlane_b32 s84, v3, 3
    ds_read_b32 v3, v7
    s_add_u32 m0, m0, s85
    s_add_u32 s78, s78, s85
    s_waitcnt vmcnt(19)
    buffer_load_dwordx4 v2, s[4:7], s78 offen offset:0 nt lds
    ds_write_b32 v6, v5
    s_and_b32 s86, s81, 3
    s_mul_i32 s86, s86, 12288
L_B20_3:
    s_cmp_lt_i32 s84, s82
    s_cbranch_scc1 L_B20_3w
    s_waitcnt vmcnt(19)
    buffer_load_dwordx4 v2, s[4:7], s78 offen offset:1024 nt lds
    v_add_u32 v5, 3, v5
    v_readlane_b32 s83, v3, 4
    s_waitcnt vmcnt(19)
    buffer_load_dwordx4 v2, s[4:7], s78 offen offset:2048 nt lds
    v_readlane_b32 s84, v3, 0
    ds_read_b32 v3, v7
    s_add_u32 s82, s82, 1
    s_cmp_eq_u32 s81, 256
    s_cselect_b32 s83, -1, s83
    s_cmp_ge_u32 s81, 128
    s_waitcnt vmcnt(19)
    buffer_load_dwordx4 v2, s[4:7], s78 offen offset:3072 nt lds
    ds_write_b32 v6, v5
    s_cselect_b64 s[4:5], s[56:57], s[50:51]
    s_mov_b32 m0, s86
    s_mov_b32 s78, s80
    s_cmp_eq_u32 s83, 20
    s_cbranch_scc1 L_B20
L_disp:
    s_cmp_eq_u32 s83, 20
    s_cbranch_scc1 L_D20
    s_cmp_eq_u32 s83, 21
    s_cbranch_scc1 L_D21
    s_cmp_eq_u32 s83, 19
    s_cbranch_scc1 L_D19
    s_cmp_eq_u32 s83, 22
    s_cbranch_scc1 L_D22
    s_cmp_eq_u32 s83, 18
    s_cbranch_scc1 L_D18
    s_cmp_eq_u32 s83, 23
    s_cbranch_scc1 L_D23
    s_cmp_eq_u32 s83, 17
    s_cbranch_scc1 L_D17
    s_cmp_eq_u32 s83, 24
    s_cbranch_scc1 L_D24
    s_cmp_eq_u32 s83, 16
    s_cbranch_scc1 L_D16
    s_cmp_eq_u32 s83, 25
    s_cbranch_scc1 L_D25
    s_cmp_eq_u32 s81, 256
    s_cbranch_scc1 L_drain
    s_cmp_ge_i32 s83, 26
    s_cbranch_scc1 L_D26
    s_branch L_D15
L_D19:
    s_mul_i32 s92, s81, 12
    s_sub_u32 s92, s92, 19
    v_mov_b32 v5, s92
    s_nop 1
L_B19:
L_B19_0:
    s_cmp_lt_i32 s84, s82
    s_cbranch_scc1 L_B19_0w
    s_waitcnt vmcnt(18)
    buffer_load_dwordx4 v2, s[4:7], s78 offen offset:0 nt lds
    v_add_u32 v5, 3, v5
    s_add_u32 s81, s81, 1
    s_and_b32 s92, s81, 14
    s_waitcnt vmcnt(18)
    buffer_load_dwordx4 v2, s[4:7], s78 offen offset:1024 nt lds
    v_readlane_b32 s84, v3, 1
    ds_read_b32 v3, v7
    s_lshl_b32 s92, s92, 10
    s_add_u32 s92, s92, s77
    s_waitcnt vmcnt(18)
    buffer_load_dwordx4 v2, s[4:7], s78 offen offset:2048 nt lds
    ds_write_b32 v6, v5
    s_and_b32 s92, s92, 16383
    s_mul_i32 s80, s92, 768
L_B19_1:
    s_cmp_lt_i32 s84, s82
    s_cbranch_scc1 L_B19_1w
    s_waitcnt vmcnt(18)
    buffer_load_dwordx4 v2, s[4:7], s78 offen offset:3072 nt lds
    v_add_u32 v5, 3, v5
    s_add_u32 m0, m0, s85
    s_add_u32 s78, s78, s85
    s_waitcnt vmcnt(18)
    buffer_load_dwordx4 v2, s[4:7], s78 offen offset:0 nt lds
    v_readlane_b32 s84, v3, 2
    ds_read_b32 v3, v7
    s_bfe_u32 s92, s81, 0x30004
    s_and_b32 s93, s81, 1
    s_waitcnt vmcnt(18)
    buffer_load_dwordx4 v2, s[4:7], s78 offen offset:1024 nt lds
    ds_write_b32 v6, v5
    s_lshl2_add_u32 s92, s92, s93
    s_mul_i32 s92, s92, 12582912
L_B19_2:
    s_cmp_lt_i32 s84, s82
    s_cbranch_scc1 L_B19_2w
    s_waitcnt vmcnt(18)
    buffer_load_dwordx4 v2, s[4:7], s78 offen offset:2048 nt lds
    v_add_u32 v5, 3, v5
    s_add_u32 s80, s80, s79
    s_add_u32 s80, s80, s92
    s_waitcnt vmcnt(18)
    buffer_load_dwordx4 v2, s[4:7], s78 offen offset:3072 nt lds
    v_readlane_b32 s84, v3, 3
    ds_read_b32 v3, v7
    s_add_u32 m0, m0, s85
    s_add_u32 s78, s78, s85
    s_waitcnt vmcnt(18)
    buffer_load_dwordx4 v2, s[4:7], s78 offen offset:0 nt lds
    ds_write_b32 v6, v5
    s_and_b32 s86, s81, 3
    s_mul_i32 s86, s86, 12288
L_B19_3:
    s_cmp_lt_i32 s84, s82
    s_cbranch_scc1 L_B19_3w
    s_waitcnt vmcnt(18)
    buffer_load_dwordx4 v2, s[4:7], s78 offen offset:1024 nt lds
    v_add_u32 v5, 3, v5
    v_readlane_b32 s83, v3, 4
    s_waitcnt vmcnt(18)
    buffer_load_dwordx4 v2, s[4:7], s78 offen offset:2048 nt lds
    v_readlane_b32 s84, v3, 0
    ds_read_b32 v3, v7
    s_add_u32 s82, s82, 1
    s_cmp_eq_u32 s81, 256
    s_cselect_b32 s83, -1, s83
    s_cmp_ge_u32 s81, 128
    s_waitcnt vmcnt(18)
    buffer_load_dwordx4 v2, s[4:7], s78 offen offset:3072 nt lds
    ds_write_b32 v6, v5
    s_cselect_b64 s[4:5], s[56:57], s[50:51]
    s_mov_b32 m0, s86
    s_mov_b32 s78, s80
    s_cmp_eq_u32 s83, 19
    s_cbranch_scc1 L_B19
    s_cmp_eq_u32 s83, 20
    s_cbranch_scc1 L_D20
    s_cmp_eq_u32 s83, 18
    s_cbranch_scc1 L_D18
    s_branch L_disp
L_D21:
    s_mul_i32 s92, s81, 12
    s_sub_u32 s92, s92, 21
    v_mov_b32 v5, s92
    s_nop 1
L_B21:
L_B21_0:
    s_cmp_lt_i32 s84, s82
    s_cbranch_scc1 L_B21_0w
    s_waitcnt vmcnt(20)
    buffer_load_dwordx4 v2, s[4:7], s78 offen offset:0 nt lds
    v_add_u32 v5, 3, v5
    s_add_u32 s81, s81, 1
    s_and_b32 s92, s81, 14
    s_waitcnt vmcnt(20)
    buffer_load_dwordx4 v2, s[4:7], s78 offen offset:1024 nt lds
    v_readlane_b32 s84, v3, 1
    ds_read_b32 v3, v7
    s_lshl_b32 s92, s92, 10
    s_add_u32 s92, s92, s77
    s_waitcnt vmcnt(20)
    buffer_load_dwordx4 v2, s[4:7], s78 offen offset:2048 nt lds
    ds_write_b32 v6, v5
    s_and_b32 s92, s92, 16383
    s_mul_i32 s80, s92, 768
L_B21_1:
    s_cmp_lt_i32 s84, s82
    s_cbranch_scc1 L_B21_1w
    s_waitcnt vmcnt(20)
    buffer_load_dwordx4 v2, s[4:7], s78 offen offset:3072 nt lds
    v_add_u32 v5, 3, v5
    s_add_u32 m0, m0, s85
    s_add_u32 s78, s78, s85
    s_waitcnt vmcnt(20)
    buffer_load_dwordx4 v2, s[4:7], s78 offen offset:0 nt lds
    v_readlane_b32 s84, v3, 2
    ds_read_b32 v3, v7
    s_bfe_u32 s92, s81, 0x30004
    s_and_b32 s93, s81, 1
    s_waitcnt vmcnt(20)
    buffer_load_dwordx4 v2, s[4:7], s78 offen offset:1024 nt lds
    ds_write_b32 v6, v5
    s_lshl2_add_u32 s92, s92, s93
    s_mul_i32 s92, s92, 12582912
L_B21_2:
    s_cmp_lt_i32 s84, s82
    s_cbranch_scc1 L_B21_2w
    s_waitcnt vmcnt(20)
    buffer_load_dwordx4 v2, s[4:7], s78 offen offset:2048 nt lds
    v_add_u32 v5, 3, v5
    s_add_u32 s80, s80, s79
    s_add_u32 s80, s80, s92
    s_waitcnt vmcnt(20)
    buffer_load_dwordx4 v2, s[4:7], s78 offen offset:3072 nt lds
    v_readlane_b32 s84, v3, 3
    ds_read_b32 v3, v7
    s_add_u32 m0, m0, s85
    s_add_u32 s78, s78, s85
    s_waitcnt vmcnt(20)
    buffer_load_dwordx4 v2, s[4:7], s78 offen offset:0 nt lds
    ds_write_b32 v6, v5
    s_and_b32 s86, s81, 3
    s_mul_i32 s86, s86, 12288
L_B21_3:
    s_cmp_lt_i32 s84, s82
    s_cbranch_scc1 L_B21_3w
    s_waitcnt vmcnt(20)
    buffer_load_dwordx4 v2, s[4:7], s78 offen offset:1024 nt lds
    v_add_u32 v5, 3, v5
    v_readlane_b32 s83, v3, 4
    s_waitcnt vmcnt(20)
    buffer_load_dwordx4 v2, s[4:7], s78 offen offset:2048 nt lds
    v_readlane_b32 s84, v3, 0
    ds_read_b32 v3, v7
    s_add_u32 s82, s82, 1
    s_cmp_eq_u32 s81, 256
    s_cselect_b32 s83, -1, s83
    s_cmp_ge_u32 s81, 128
    s_waitcnt vmcnt(20)
    buffer_load_dwordx4 v2, s[4:7], s78 offen offset:3072 nt lds
    ds_write_b32 v6, v5
    s_cselect_b64 s[4:5], s[56:57], s[50:51]
    s_mov_b32 m0, s86
    s_mov_b32 s78, s80
    s_cmp_eq_u32 s83, 21
    s_cbranch_scc1 L_B21
    s_cmp_eq_u32 s83, 20
    s_cbranch_scc1 L_D20
    s_cmp_eq_u32 s83, 22
    s_cbranch_scc1 L_D22
    s_branch L_disp
L_D18:
    s_mul_i32 s92, s81, 12
    s_sub_u32 s92, s92, 18
    v_mov_b32 v5, s92
    s_nop 1
L_B18:
L_B18_0:
    s_cmp_lt_i32 s84, s82
    s_cbranch_scc1 L_B18_0w
    s_waitcnt vmcnt(17)
    buffer_load_dwordx4 v2, s[4:7], s78 offen offset:0 nt lds
    v_add_u32 v5, 3, v5
    s_add_u32 s81, s81, 1
    s_and_b32 s92, s81, 14
    s_waitcnt vmcnt(17)
    buffer_load_dwordx4 v2, s[4:7], s78 offen offset:1024 nt lds
    v_readlane_b32 s84, v3, 1
    ds_read_b32 v3, v7
    s_lshl_b32 s92, s92, 10
    s_add_u32 s92, s92, s77
    s_waitcnt vmcnt(17)
    buffer_load_dwordx4 v2, s[4:7], s78 offen offset:2048 nt lds
    ds_write_b32 v6, v5
    s_and_b32 s92, s92, 16383
    s_mul_i32 s80, s92, 768
L_B18_1:
    s_cmp_lt_i32 s84, s82
    s_cbranch_scc1 L_B18_1w
    s_waitcnt vmcnt(17)
    buffer_load_dwordx4 v2, s[4:7], s78 offen offset:3072 nt lds
    v_add_u32 v5, 3, v5
    s_add_u32 m0, m0, s85
    s_add_u32 s78, s78, s85
    s_waitcnt vmcnt(17)
    buffer_load_dwordx4 v2, s[4:7], s78 offen offset:0 nt lds
    v_readlane_b32 s84, v3, 2
    ds_read_b32 v3, v7
    s_bfe_u32 s92, s81, 0x30004
    s_and_b32 s93, s81, 1
    s_waitcnt vmcnt(17)
    buffer_load_dwordx4 v2, s[4:7], s78 offen offset:1024 nt lds
    ds_write_b32 v6, v5
    s_lshl2_add_u32 s92, s92, s93
    s_mul_i32 s92, s92, 12582912
L_B18_2:
    s_cmp_lt_i32 s84, s82
    s_cbranch_scc1 L_B18_2w
    s_waitcnt vmcnt(17)
    buffer_load_dwordx4 v2, s[4:7], s78 offen offset:2048 nt lds
    v_add_u32 v5, 3, v5
    s_add_u32 s80, s80, s79
    s_add_u32 s80, s80, s92
    s_waitcnt vmcnt(17)
    buffer_load_dwordx4 v2, s[4:7], s78 offen offset:3072 nt lds
    v_readlane_b32 s84, v3, 3
    ds_read_b32 v3, v7
    s_add_u32 m0, m0, s85
    s_add_u32 s78, s78, s85
    s_waitcnt vmcnt(17)
    buffer_load_dwordx4 v2, s[4:7], s78 offen offset:0 nt lds
    ds_write_b32 v6, v5
    s_and_b32 s86, s81, 3
    s_mul_i32 s86, s86, 12288
L_B18_3:
    s_cmp_lt_i32 s84, s82
    s_cbranch_scc1 L_B18_3w
    s_waitcnt vmcnt(17)
    buffer_load_dwordx4 v2, s[4:7], s78 offen offset:1024 nt lds
    v_add_u32 v5, 3, v5
    v_readlane_b32 s83, v3, 4
    s_waitcnt vmcnt(17)
    buffer_load_dwordx4 v2, s[4:7], s78 offen offset:2048 nt lds
    v_readlane_b32 s84, v3, 0
    ds_read_b32 v3, v7
    s_add_u32 s82, s82, 1
    s_cmp_eq_u32 s81, 256
    s_cselect_b32 s83, -1, s83
    s_cmp_ge_u32 s81, 128
    s_waitcnt vmcnt(17)
    buffer_load_dwordx4 v2, s[4:7], s78 offen offset:3072 nt lds
    ds_write_b32 v6, v5
    s_cselect_b64 s[4:5], s[56:57], s[50:51]
    s_mov_b32 m0, s86
    s_mov_b32 s78, s80
    s_cmp_eq_u32 s83, 18
    s_cbranch_scc1 L_B18
    s_cmp_eq_u32 s83, 19
    s_cbranch_scc1 L_D19
    s_cmp_eq_u32 s83, 17
    s_cbranch_scc1 L_D17
    s_branch L_disp
L_D22:
    s_mul_i32 s92, s81, 12
    s_sub_u32 s92, s92, 22
    v_mov_b32 v5, s92
    s_nop 1
L_B22:
L_B22_0:
    s_cmp_lt_i32 s84, s82
    s_cbranch_scc1 L_B22_0w
    s_waitcnt vmcnt(21)
    buffer_load_dwordx4 v2, s[4:7], s78 offen offset:0 nt lds
    v_add_u32 v5, 3, v5
    s_add_u32 s81, s81, 1
    s_and_b32 s92, s81, 14
    s_waitcnt vmcnt(21)
    buffer_load_dwordx4 v2, s[4:7], s78 offen offset:1024 nt lds
    v_readlane_b32 s84, v3, 1
    ds_read_b32 v3, v7
    s_lshl_b32 s92, s92, 10
    s_add_u32 s92, s92, s77
    s_waitcnt vmcnt(21)
    buffer_load_dwordx4 v2, s[4:7], s78 offen offset:2048 nt lds
    ds_write_b32 v6, v5
    s_and_b32 s92, s92, 16383
    s_mul_i32 s80, s92, 768
L_B22_1:
    s_cmp_lt_i32 s84, s82
    s_cbranch_scc1 L_B22_1w
    s_waitcnt vmcnt(21)
    buffer_load_dwordx4 v2, s[4:7], s78 offen offset:3072 nt lds
    v_add_u32 v5, 3, v5
    s_add_u32 m0, m0, s85
    s_add_u32 s78, s78, s85
    s_waitcnt vmcnt(21)
    buffer_load_dwordx4 v2, s[4:7], s78 offen offset:0 nt lds
    v_readlane_b32 s84, v3, 2
    ds_read_b32 v3, v7
    s_bfe_u32 s92, s81, 0x30004
    s_and_b32 s93, s81, 1
    s_waitcnt vmcnt(21)
    buffer_load_dwordx4 v2, s[4:7], s78 offen offset:1024 nt lds
    ds_write_b32 v6, v5
    s_lshl2_add_u32 s92, s92, s93
    s_mul_i32 s92, s92, 12582912
L_B22_2:
    s_cmp_lt_i32 s84, s82
    s_cbranch_scc1 L_B22_2w
    s_waitcnt vmcnt(21)
    buffer_load_dwordx4 v2, s[4:7], s78 offen offset:2048 nt lds
    v_add_u32 v5, 3, v5
    s_add_u32 s80, s80, s79
    s_add_u32 s80, s80, s92
    s_waitcnt vmcnt(21)
    buffer_load_dwordx4 v2, s[4:7], s78 offen offset:3072 nt lds
    v_readlane_b32 s84, v3, 3
    ds_read_b32 v3, v7
    s_add_u32 m0, m0, s85
    s_add_u32 s78, s78, s85
    s_waitcnt vmcnt(21)
    buffer_load_dwordx4 v2, s[4:7], s78 offen offset:0 nt lds
    ds_write_b32 v6, v5
    s_and_b32 s86, s81, 3
    s_mul_i32 s86, s86, 12288
L_B22_3:
    s_cmp_lt_i32 s84, s82
    s_cbranch_scc1 L_B22_3w
    s_waitcnt vmcnt(21)
    buffer_load_dwordx4 v2, s[4:7], s78 offen offset:1024 nt lds
    v_add_u32 v5, 3, v5
    v_readlane_b32 s83, v3, 4
    s_waitcnt vmcnt(21)
    buffer_load_dwordx4 v2, s[4:7], s78 offen offset:2048 nt lds
    v_readlane_b32 s84, v3, 0
    ds_read_b32 v3, v7
    s_add_u32 s82, s82, 1
    s_cmp_eq_u32 s81, 256
    s_cselect_b32 s83, -1, s83
    s_cmp_ge_u32 s81, 128
    s_waitcnt vmcnt(21)
    buffer_load_dwordx4 v2, s[4:7], s78 offen offset:3072 nt lds
    ds_write_b32 v6, v5
    s_cselect_b64 s[4:5], s[56:57], s[50:51]
    s_mov_b32 m0, s86
    s_mov_b32 s78, s80
    s_cmp_eq_u32 s83, 22
    s_cbranch_scc1 L_B22
    s_cmp_eq_u32 s83, 21
    s_cbranch_scc1 L_D21
    s_cmp_eq_u32 s83, 23
    s_cbranch_scc1 L_D23
    s_branch L_disp
L_D17:
    s_mul_i32 s92, s81, 12
    s_sub_u32 s92, s92, 17
    v_mov_b32 v5, s92
    s_nop 1
L_B17:
L_B17_0:
    s_cmp_lt_i32 s84, s82
    s_cbranch_scc1 L_B17_0w
    s_waitcnt vmcnt(16)
    buffer_load_dwordx4 v2, s[4:7], s78 offen offset:0 nt lds
    v_add_u32 v5, 3, v5
    s_add_u32 s81, s81, 1
    s_and_b32 s92, s81, 14
    s_waitcnt vmcnt(16)
    buffer_load_dwordx4 v2, s[4:7], s78 offen offset:1024 nt lds
    v_readlane_b32 s84, v3, 1
    ds_read_b32 v3, v7
    s_lshl_b32 s92, s92, 10
    s_add_u32 s92, s92, s77
    s_waitcnt vmcnt(16)
    buffer_load_dwordx4 v2, s[4:7], s78 offen offset:2048 nt lds
    ds_write_b32 v6, v5
    s_and_b32 s92, s92, 16383
    s_mul_i32 s80, s92, 768
L_B17_1:
    s_cmp_lt_i32 s84, s82
    s_cbranch_scc1 L_B17_1w
    s_waitcnt vmcnt(16)
    buffer_load_dwordx4 v2, s[4:7], s78 offen offset:3072 nt lds
    v_add_u32 v5, 3, v5
    s_add_u32 m0, m0, s85
    s_add_u32 s78, s78, s85
    s_waitcnt vmcnt(16)
    buffer_load_dwordx4 v2, s[4:7], s78 offen offset:0 nt lds
    v_readlane_b32 s84, v3, 2
    ds_read_b32 v3, v7
    s_bfe_u32 s92, s81, 0x30004
    s_and_b32 s93, s81, 1
    s_waitcnt vmcnt(16)
    buffer_load_dwordx4 v2, s[4:7], s78 offen offset:1024 nt lds
    ds_write_b32 v6, v5
    s_lshl2_add_u32 s92, s92, s93
    s_mul_i32 s92, s92, 12582912
L_B17_2:
    s_cmp_lt_i32 s84, s82
    s_cbranch_scc1 L_B17_2w
    s_waitcnt vmcnt(16)
    buffer_load_dwordx4 v2, s[4:7], s78 offen offset:2048 nt lds
    v_add_u32 v5, 3, v5
    s_add_u32 s80, s80, s79
    s_add_u32 s80, s80, s92
    s_waitcnt vmcnt(16)
    buffer_load_dwordx4 v2, s[4:7], s78 offen offset:3072 nt lds
    v_readlane_b32 s84, v3, 3
    ds_read_b32 v3, v7
    s_add_u32 m0, m0, s85
    s_add_u32 s78, s78, s85
    s_waitcnt vmcnt(16)
    buffer_load_dwordx4 v2, s[4:7], s78 offen offset:0 nt lds
    ds_write_b32 v6, v5
    s_and_b32 s86, s81, 3
    s_mul_i32 s86, s86, 12288
L_B17_3:
    s_cmp_lt_i32 s84, s82
    s_cbranch_scc1 L_B17_3w
    s_waitcnt vmcnt(16)
    buffer_load_dwordx4 v2, s[4:7], s78 offen offset:1024 nt lds
    v_add_u32 v5, 3, v5
    v_readlane_b32 s83, v3, 4
    s_waitcnt vmcnt(16)
    buffer_load_dwordx4 v2, s[4:7], s78 offen offset:2048 nt lds
    v_readlane_b32 s84, v3, 0
    ds_read_b32 v3, v7
    s_add_u32 s82, s82, 1
    s_cmp_eq_u32 s81, 256
    s_cselect_b32 s83, -1, s83
    s_cmp_ge_u32 s81, 128
    s_waitcnt vmcnt(16)
    buffer_load_dwordx4 v2, s[4:7], s78 offen offset:3072 nt lds
    ds_write_b32 v6, v5
    s_cselect_b64 s[4:5], s[56:57], s[50:51]
    s_mov_b32 m0, s86
    s_mov_b32 s78, s80
    s_cmp_eq_u32 s83, 17
    s_cbranch_scc1 L_B17
    s_cmp_eq_u32 s83, 18
    s_cbranch_scc1 L_D18
    s_cmp_eq_u32 s83, 16
    s_cbranch_scc1 L_D16
    s_branch L_disp
L_D23:
    s_mul_i32 s92, s81, 12
    s_sub_u32 s92, s92, 23
    v_mov_b32 v5, s92
    s_nop 1
L_B23:
L_B23_0:
    s_cmp_lt_i32 s84, s82
    s_cbranch_scc1 L_B23_0w
    s_waitcnt vmcnt(22)
    buffer_load_dwordx4 v2, s[4:7], s78 offen offset:0 nt lds
    v_add_u32 v5, 3, v5
    s_add_u32 s81, s81, 1
    s_and_b32 s92, s81, 14
    s_waitcnt vmcnt(22)
    buffer_load_dwordx4 v2, s[4:7], s78 offen offset:1024 nt lds
    v_readlane_b32 s84, v3, 1
    ds_read_b32 v3, v7
    s_lshl_b32 s92, s92, 10
    s_add_u32 s92, s92, s77
    s_waitcnt vmcnt(22)
    buffer_load_dwordx4 v2, s[4:7], s78 offen offset:2048 nt lds
    ds_write_b32 v6, v5
    s_and_b32 s92, s92, 16383
    s_mul_i32 s80, s92, 768
L_B23_1:
    s_cmp_lt_i32 s84, s82
    s_cbranch_scc1 L_B23_1w
    s_waitcnt vmcnt(22)
    buffer_load_dwordx4 v2, s[4:7], s78 offen offset:3072 nt lds
    v_add_u32 v5, 3, v5
    s_add_u32 m0, m0, s85
    s_add_u32 s78, s78, s85
    s_waitcnt vmcnt(22)
    buffer_load_dwordx4 v2, s[4:7], s78 offen offset:0 nt lds
    v_readlane_b32 s84, v3, 2
    ds_read_b32 v3, v7
    s_bfe_u32 s92, s81, 0x30004
    s_and_b32 s93, s81, 1
    s_waitcnt vmcnt(22)
    buffer_load_dwordx4 v2, s[4:7], s78 offen offset:1024 nt lds
    ds_write_b32 v6, v5
    s_lshl2_add_u32 s92, s92, s93
    s_mul_i32 s92, s92, 12582912
L_B23_2:
    s_cmp_lt_i32 s84, s82
    s_cbranch_scc1 L_B23_2w
    s_waitcnt vmcnt(22)
    buffer_load_dwordx4 v2, s[4:7], s78 offen offset:2048 nt lds
    v_add_u32 v5, 3, v5
    s_add_u32 s80, s80, s79
    s_add_u32 s80, s80, s92
    s_waitcnt vmcnt(22)
    buffer_load_dwordx4 v2, s[4:7], s78 offen offset:3072 nt lds
    v_readlane_b32 s84, v3, 3
    ds_read_b32 v3, v7
    s_add_u32 m0, m0, s85
    s_add_u32 s78, s78, s85
    s_waitcnt vmcnt(22)
    buffer_load_dwordx4 v2, s[4:7], s78 offen offset:0 nt lds
    ds_write_b32 v6, v5
    s_and_b32 s86, s81, 3
    s_mul_i32 s86, s86, 12288
L_B23_3:
    s_cmp_lt_i32 s84, s82
    s_cbranch_scc1 L_B23_3w
    s_waitcnt vmcnt(22)
    buffer_load_dwordx4 v2, s[4:7], s78 offen offset:1024 nt lds
    v_add_u32 v5, 3, v5
    v_readlane_b32 s83, v3, 4
    s_waitcnt vmcnt(22)
    buffer_load_dwordx4 v2, s[4:7], s78 offen offset:2048 nt lds
    v_readlane_b32 s84, v3, 0
    ds_read_b32 v3, v7
    s_add_u32 s82, s82, 1
    s_cmp_eq_u32 s81, 256
    s_cselect_b32 s83, -1, s83
    s_cmp_ge_u32 s81, 128
    s_waitcnt vmcnt(22)
    buffer_load_dwordx4 v2, s[4:7], s78 offen offset:3072 nt lds
    ds_write_b32 v6, v5
    s_cselect_b64 s[4:5], s[56:57], s[50:51]
    s_mov_b32 m0, s86
    s_mov_b32 s78, s80
    s_cmp_eq_u32 s83, 23
    s_cbranch_scc1 L_B23
    s_cmp_eq_u32 s83, 22
    s_cbranch_scc1 L_D22
    s_cmp_eq_u32 s83, 24
    s_cbranch_scc1 L_D24
    s_branch L_disp
L_D16:
    s_mul_i32 s92, s81, 12
    s_sub_u32 s92, s92, 16
    v_mov_b32 v5, s92
    s_nop 1
L_B16:
L_B16_0:
    s_cmp_lt_i32 s84, s82
    s_cbranch_scc1 L_B16_0w
    s_waitcnt vmcnt(15)
    buffer_load_dwordx4 v2, s[4:7], s78 offen offset:0 nt lds
    v_add_u32 v5, 3, v5
    s_add_u32 s81, s81, 1
    s_and_b32 s92, s81, 14
    s_waitcnt vmcnt(15)
    buffer_load_dwordx4 v2, s[4:7], s78 offen offset:1024 nt lds
    v_readlane_b32 s84, v3, 1
    ds_read_b32 v3, v7
    s_lshl_b32 s92, s92, 10
    s_add_u32 s92, s92, s77
    s_waitcnt vmcnt(15)
    buffer_load_dwordx4 v2, s[4:7], s78 offen offset:2048 nt lds
    ds_write_b32 v6, v5
    s_and_b32 s92, s92, 16383
    s_mul_i32 s80, s92, 768
L_B16_1:
    s_cmp_lt_i32 s84, s82
    s_cbranch_scc1 L_B16_1w
    s_waitcnt vmcnt(15)
    buffer_load_dwordx4 v2, s[4:7], s78 offen offset:3072 nt lds
    v_add_u32 v5, 3, v5
    s_add_u32 m0, m0, s85
    s_add_u32 s78, s78, s85
    s_waitcnt vmcnt(15)
    buffer_load_dwordx4 v2, s[4:7], s78 offen offset:0 nt lds
    v_readlane_b32 s84, v3, 2
    ds_read_b32 v3, v7
    s_bfe_u32 s92, s81, 0x30004
    s_and_b32 s93, s81, 1
    s_waitcnt vmcnt(15)
    buffer_load_dwordx4 v2, s[4:7], s78 offen offset:1024 nt lds
    ds_write_b32 v6, v5
    s_lshl2_add_u32 s92, s92, s93
    s_mul_i32 s92, s92, 12582912
L_B16_2:
    s_cmp_lt_i32 s84, s82
    s_cbranch_scc1 L_B16_2w
    s_waitcnt vmcnt(15)
    buffer_load_dwordx4 v2, s[4:7], s78 offen offset:2048 nt lds
    v_add_u32 v5, 3, v5
    s_add_u32 s80, s80, s79
    s_add_u32 s80, s80, s92
    s_waitcnt vmcnt(15)
    buffer_load_dwordx4 v2, s[4:7], s78 offen offset:3072 nt lds
    v_readlane_b32 s84, v3, 3
    ds_read_b32 v3, v7
    s_add_u32 m0, m0, s85
    s_add_u32 s78, s78, s85
    s_waitcnt vmcnt(15)
    buffer_load_dwordx4 v2, s[4:7], s78 offen offset:0 nt lds
    ds_write_b32 v6, v5
    s_and_b32 s86, s81, 3
    s_mul_i32 s86, s86, 12288
L_B16_3:
    s_cmp_lt_i32 s84, s82
    s_cbranch_scc1 L_B16_3w
    s_waitcnt vmcnt(15)
    buffer_load_dwordx4 v2, s[4:7], s78 offen offset:1024 nt lds
    v_add_u32 v5, 3, v5
    v_readlane_b32 s83, v3, 4
    s_waitcnt vmcnt(15)
    buffer_load_dwordx4 v2, s[4:7], s78 offen offset:2048 nt lds
    v_readlane_b32 s84, v3, 0
    ds_read_b32 v3, v7
    s_add_u32 s82, s82, 1
    s_cmp_eq_u32 s81, 256
    s_cselect_b32 s83, -1, s83
    s_cmp_ge_u32 s81, 128
    s_waitcnt vmcnt(15)
    buffer_load_dwordx4 v2, s[4:7], s78 offen offset:3072 nt lds
    ds_write_b32 v6, v5
    s_cselect_b64 s[4:5], s[56:57], s[50:51]
    s_mov_b32 m0, s86
    s_mov_b32 s78, s80
    s_cmp_eq_u32 s83, 16
    s_cbranch_scc1 L_B16
    s_cmp_eq_u32 s83, 17
    s_cbranch_scc1 L_D17
    s_cmp_eq_u32 s83, 15
    s_cbranch_scc1 L_D15
    s_branch L_disp
L_D24:
    s_mul_i32 s92, s81, 12
    s_sub_u32 s92, s92, 24
    v_mov_b32 v5, s92
    s_nop 1
L_B24:
L_B24_0:
    s_cmp_lt_i32 s84, s82
    s_cbranch_scc1 L_B24_0w
    s_waitcnt vmcnt(23)
    buffer_load_dwordx4 v2, s[4:7], s78 offen offset:0 nt lds
    v_add_u32 v5, 3, v5
    s_add_u32 s81, s81, 1
    s_and_b32 s92, s81, 14
    s_waitcnt vmcnt(23)
    buffer_load_dwordx4 v2, s[4:7], s78 offen offset:1024 nt lds
    v_readlane_b32 s84, v3, 1
    ds_read_b32 v3, v7
    s_lshl_b32 s92, s92, 10
    s_add_u32 s92, s92, s77
    s_waitcnt vmcnt(23)
    buffer_load_dwordx4 v2, s[4:7], s78 offen offset:2048 nt lds
    ds_write_b32 v6, v5
    s_and_b32 s92, s92, 16383
    s_mul_i32 s80, s92, 768
L_B24_1:
    s_cmp_lt_i32 s84, s82
    s_cbranch_scc1 L_B24_1w
    s_waitcnt vmcnt(23)
    buffer_load_dwordx4 v2, s[4:7], s78 offen offset:3072 nt lds
    v_add_u32 v5, 3, v5
    s_add_u32 m0, m0, s85
    s_add_u32 s78, s78, s85
    s_waitcnt vmcnt(23)
    buffer_load_dwordx4 v2, s[4:7], s78 offen offset:0 nt lds
    v_readlane_b32 s84, v3, 2
    ds_read_b32 v3, v7
    s_bfe_u32 s92, s81, 0x30004
    s_and_b32 s93, s81, 1
    s_waitcnt vmcnt(23)
    buffer_load_dwordx4 v2, s[4:7], s78 offen offset:1024 nt lds
    ds_write_b32 v6, v5
    s_lshl2_add_u32 s92, s92, s93
    s_mul_i32 s92, s92, 12582912
L_B24_2:
    s_cmp_lt_i32 s84, s82
    s_cbranch_scc1 L_B24_2w
    s_waitcnt vmcnt(23)
    buffer_load_dwordx4 v2, s[4:7], s78 offen offset:2048 nt lds
    v_add_u32 v5, 3, v5
    s_add_u32 s80, s80, s79
    s_add_u32 s80, s80, s92
    s_waitcnt vmcnt(23)
    buffer_load_dwordx4 v2, s[4:7], s78 offen offset:3072 nt lds
    v_readlane_b32 s84, v3, 3
    ds_read_b32 v3, v7
    s_add_u32 m0, m0, s85
    s_add_u32 s78, s78, s85
    s_waitcnt vmcnt(23)
    buffer_load_dwordx4 v2, s[4:7], s78 offen offset:0 nt lds
    ds_write_b32 v6, v5
    s_and_b32 s86, s81, 3
    s_mul_i32 s86, s86, 12288
L_B24_3:
    s_cmp_lt_i32 s84, s82
    s_cbranch_scc1 L_B24_3w
    s_waitcnt vmcnt(23)
    buffer_load_dwordx4 v2, s[4:7], s78 offen offset:1024 nt lds
    v_add_u32 v5, 3, v5
    v_readlane_b32 s83, v3, 4
    s_waitcnt vmcnt(23)
    buffer_load_dwordx4 v2, s[4:7], s78 offen offset:2048 nt lds
    v_readlane_b32 s84, v3, 0
    ds_read_b32 v3, v7
    s_add_u32 s82, s82, 1
    s_cmp_eq_u32 s81, 256
    s_cselect_b32 s83, -1, s83
    s_cmp_ge_u32 s81, 128
    s_waitcnt vmcnt(23)
    buffer_load_dwordx4 v2, s[4:7], s78 offen offset:3072 nt lds
    ds_write_b32 v6, v5
    s_cselect_b64 s[4:5], s[56:57], s[50:51]
    s_mov_b32 m0, s86
    s_mov_b32 s78, s80
    s_cmp_eq_u32 s83, 24
    s_cbranch_scc1 L_B24
    s_cmp_eq_u32 s83, 23
    s_cbranch_scc1 L_D23
    s_cmp_eq_u32 s83, 25
    s_cbranch_scc1 L_D25
    s_branch L_disp
L_D15:
    s_mul_i32 s92, s81, 12
    s_sub_u32 s92, s92, 15
    v_mov_b32 v5, s92
    s_nop 1
L_B15:
L_B15_0:
    s_cmp_lt_i32 s84, s82
    s_cbranch_scc1 L_B15_0w
    s_waitcnt vmcnt(14)
    buffer_load_dwordx4 v2, s[4:7], s78 offen offset:0 nt lds
    v_add_u32 v5, 3, v5
    s_add_u32 s81, s81, 1
    s_and_b32 s92, s81, 14
    s_waitcnt vmcnt(14)
    buffer_load_dwordx4 v2, s[4:7], s78 offen offset:1024 nt lds
    v_readlane_b32 s84, v3, 1
    ds_read_b32 v3, v7
    s_lshl_b32 s92, s92, 10
    s_add_u32 s92, s92, s77
    s_waitcnt vmcnt(14)
    buffer_load_dwordx4 v2, s[4:7], s78 offen offset:2048 nt lds
    ds_write_b32 v6, v5
    s_and_b32 s92, s92, 16383
    s_mul_i32 s80, s92, 768
L_B15_1:
    s_cmp_lt_i32 s84, s82
    s_cbranch_scc1 L_B15_1w
    s_waitcnt vmcnt(14)
    buffer_load_dwordx4 v2, s[4:7], s78 offen offset:3072 nt lds
    v_add_u32 v5, 3, v5
    s_add_u32 m0, m0, s85
    s_add_u32 s78, s78, s85
    s_waitcnt vmcnt(14)
    buffer_load_dwordx4 v2, s[4:7], s78 offen offset:0 nt lds
    v_readlane_b32 s84, v3, 2
    ds_read_b32 v3, v7
    s_bfe_u32 s92, s81, 0x30004
    s_and_b32 s93, s81, 1
    s_waitcnt vmcnt(14)
    buffer_load_dwordx4 v2, s[4:7], s78 offen offset:1024 nt lds
    ds_write_b32 v6, v5
    s_lshl2_add_u32 s92, s92, s93
    s_mul_i32 s92, s92, 12582912
L_B15_2:
    s_cmp_lt_i32 s84, s82
    s_cbranch_scc1 L_B15_2w
    s_waitcnt vmcnt(14)
    buffer_load_dwordx4 v2, s[4:7], s78 offen offset:2048 nt lds
    v_add_u32 v5, 3, v5
    s_add_u32 s80, s80, s79
    s_add_u32 s80, s80, s92
    s_waitcnt vmcnt(14)
    buffer_load_dwordx4 v2, s[4:7], s78 offen offset:3072 nt lds
    v_readlane_b32 s84, v3, 3
    ds_read_b32 v3, v7
    s_add_u32 m0, m0, s85
    s_add_u32 s78, s78, s85
    s_waitcnt vmcnt(14)
    buffer_load_dwordx4 v2, s[4:7], s78 offen offset:0 nt lds
    ds_write_b32 v6, v5
    s_and_b32 s86, s81, 3
    s_mul_i32 s86, s86, 12288
L_B15_3:
    s_cmp_lt_i32 s84, s82
    s_cbranch_scc1 L_B15_3w
    s_waitcnt vmcnt(14)
    buffer_load_dwordx4 v2, s[4:7], s78 offen offset:1024 nt lds
    v_add_u32 v5, 3, v5
    v_readlane_b32 s83, v3, 4
    s_waitcnt vmcnt(14)
    buffer_load_dwordx4 v2, s[4:7], s78 offen offset:2048 nt lds
    v_readlane_b32 s84, v3, 0
    ds_read_b32 v3, v7
    s_add_u32 s82, s82, 1
    s_cmp_eq_u32 s81, 256
    s_cselect_b32 s83, -1, s83
    s_cmp_ge_u32 s81, 128
    s_waitcnt vmcnt(14)
    buffer_load_dwordx4 v2, s[4:7], s78 offen offset:3072 nt lds
    ds_write_b32 v6, v5
    s_cselect_b64 s[4:5], s[56:57], s[50:51]
    s_mov_b32 m0, s86
    s_mov_b32 s78, s80
    s_cmp_eq_u32 s83, 15
    s_cbranch_scc1 L_B15
    s_cmp_eq_u32 s83, 16
    s_cbranch_scc1 L_D16
    s_branch L_disp
L_D25:
    s_mul_i32 s92, s81, 12
    s_sub_u32 s92, s92, 25
    v_mov_b32 v5, s92
    s_nop 1
L_B25:
L_B25_0:
    s_cmp_lt_i32 s84, s82
    s_cbranch_scc1 L_B25_0w
    s_waitcnt vmcnt(24)
    buffer_load_dwordx4 v2, s[4:7], s78 offen offset:0 nt lds
    v_add_u32 v5, 3, v5
    s_add_u32 s81, s81, 1
    s_and_b32 s92, s81, 14
    s_waitcnt vmcnt(24)
    buffer_load_dwordx4 v2, s[4:7], s78 offen offset:1024 nt lds
    v_readlane_b32 s84, v3, 1
    ds_read_b32 v3, v7
    s_lshl_b32 s92, s92, 10
    s_add_u32 s92, s92, s77
    s_waitcnt vmcnt(24)
    buffer_load_dwordx4 v2, s[4:7], s78 offen offset:2048 nt lds
    ds_write_b32 v6, v5
    s_and_b32 s92, s92, 16383
    s_mul_i32 s80, s92, 768
L_B25_1:
    s_cmp_lt_i32 s84, s82
    s_cbranch_scc1 L_B25_1w
    s_waitcnt vmcnt(24)
    buffer_load_dwordx4 v2, s[4:7], s78 offen offset:3072 nt lds
    v_add_u32 v5, 3, v5
    s_add_u32 m0, m0, s85
    s_add_u32 s78, s78, s85
    s_waitcnt vmcnt(24)
    buffer_load_dwordx4 v2, s[4:7], s78 offen offset:0 nt lds
    v_readlane_b32 s84, v3, 2
    ds_read_b32 v3, v7
    s_bfe_u32 s92, s81, 0x30004
    s_and_b32 s93, s81, 1
    s_waitcnt vmcnt(24)
    buffer_load_dwordx4 v2, s[4:7], s78 offen offset:1024 nt lds
    ds_write_b32 v6, v5
    s_lshl2_add_u32 s92, s92, s93
    s_mul_i32 s92, s92, 12582912
L_B25_2:
    s_cmp_lt_i32 s84, s82
    s_cbranch_scc1 L_B25_2w
    s_waitcnt vmcnt(24)
    buffer_load_dwordx4 v2, s[4:7], s78 offen offset:2048 nt lds
    v_add_u32 v5, 3, v5
    s_add_u32 s80, s80, s79
    s_add_u32 s80, s80, s92
    s_waitcnt vmcnt(24)
    buffer_load_dwordx4 v2, s[4:7], s78 offen offset:3072 nt lds
    v_readlane_b32 s84, v3, 3
    ds_read_b32 v3, v7
    s_add_u32 m0, m0, s85
    s_add_u32 s78, s78, s85
    s_waitcnt vmcnt(24)
    buffer_load_dwordx4 v2, s[4:7], s78 offen offset:0 nt lds
    ds_write_b32 v6, v5
    s_and_b32 s86, s81, 3
    s_mul_i32 s86, s86, 12288
L_B25_3:
    s_cmp_lt_i32 s84, s82
    s_cbranch_scc1 L_B25_3w
    s_waitcnt vmcnt(24)
    buffer_load_dwordx4 v2, s[4:7], s78 offen offset:1024 nt lds
    v_add_u32 v5, 3, v5
    v_readlane_b32 s83, v3, 4
    s_waitcnt vmcnt(24)
    buffer_load_dwordx4 v2, s[4:7], s78 offen offset:2048 nt lds
    v_readlane_b32 s84, v3, 0
    ds_read_b32 v3, v7
    s_add_u32 s82, s82, 1
    s_cmp_eq_u32 s81, 256
    s_cselect_b32 s83, -1, s83
    s_cmp_ge_u32 s81, 128
    s_waitcnt vmcnt(24)
    buffer_load_dwordx4 v2, s[4:7], s78 offen offset:3072 nt lds
    ds_write_b32 v6, v5
    s_cselect_b64 s[4:5], s[56:57], s[50:51]
    s_mov_b32 m0, s86
    s_mov_b32 s78, s80
    s_cmp_eq_u32 s83, 25
    s_cbranch_scc1 L_B25
    s_cmp_eq_u32 s83, 24
    s_cbranch_scc1 L_D24
    s_cmp_eq_u32 s83, 26
    s_cbranch_scc1 L_D26
    s_branch L_disp
L_D26:
    s_mul_i32 s92, s81, 12
    s_sub_u32 s92, s92, 26
    v_mov_b32 v5, s92
    s_nop 1
L_B26:
L_B26_0:
    s_cmp_lt_i32 s84, s82
    s_cbranch_scc1 L_B26_0w
    s_waitcnt vmcnt(25)
    buffer_load_dwordx4 v2, s[4:7], s78 offen offset:0 nt lds
    v_add_u32 v5, 3, v5
    s_add_u32 s81, s81, 1
    s_and_b32 s92, s81, 14
    s_waitcnt vmcnt(25)
    buffer_load_dwordx4 v2, s[4:7], s78 offen offset:1024 nt lds
    v_readlane_b32 s84, v3, 1
    ds_read_b32 v3, v7
    s_lshl_b32 s92, s92, 10
    s_add_u32 s92, s92, s77
    s_waitcnt vmcnt(25)
    buffer_load_dwordx4 v2, s[4:7], s78 offen offset:2048 nt lds
    ds_write_b32 v6, v5
    s_and_b32 s92, s92, 16383
    s_mul_i32 s80, s92, 768
L_B26_1:
    s_cmp_lt_i32 s84, s82
    s_cbranch_scc1 L_B26_1w
    s_waitcnt vmcnt(25)
    buffer_load_dwordx4 v2, s[4:7], s78 offen offset:3072 nt lds
    v_add_u32 v5, 3, v5
    s_add_u32 m0, m0, s85
    s_add_u32 s78, s78, s85
    s_waitcnt vmcnt(25)
    buffer_load_dwordx4 v2, s[4:7], s78 offen offset:0 nt lds
    v_readlane_b32 s84, v3, 2
    ds_read_b32 v3, v7
    s_bfe_u32 s92, s81, 0x30004
    s_and_b32 s93, s81, 1
    s_waitcnt vmcnt(25)
    buffer_load_dwordx4 v2, s[4:7], s78 offen offset:1024 nt lds
    ds_write_b32 v6, v5
    s_lshl2_add_u32 s92, s92, s93
    s_mul_i32 s92, s92, 12582912
L_B26_2:
    s_cmp_lt_i32 s84, s82
    s_cbranch_scc1 L_B26_2w
    s_waitcnt vmcnt(25)
    buffer_load_dwordx4 v2, s[4:7], s78 offen offset:2048 nt lds
    v_add_u32 v5, 3, v5
    s_add_u32 s80, s80, s79
    s_add_u32 s80, s80, s92
    s_waitcnt vmcnt(25)
    buffer_load_dwordx4 v2, s[4:7], s78 offen offset:3072 nt lds
    v_readlane_b32 s84, v3, 3
    ds_read_b32 v3, v7
    s_add_u32 m0, m0, s85
    s_add_u32 s78, s78, s85
    s_waitcnt vmcnt(25)
    buffer_load_dwordx4 v2, s[4:7], s78 offen offset:0 nt lds
    ds_write_b32 v6, v5
    s_and_b32 s86, s81, 3
    s_mul_i32 s86, s86, 12288
L_B26_3:
    s_cmp_lt_i32 s84, s82
    s_cbranch_scc1 L_B26_3w
    s_waitcnt vmcnt(25)
    buffer_load_dwordx4 v2, s[4:7], s78 offen offset:1024 nt lds
    v_add_u32 v5, 3, v5
    v_readlane_b32 s83, v3, 4
    s_waitcnt vmcnt(25)
    buffer_load_dwordx4 v2, s[4:7], s78 offen offset:2048 nt lds
    v_readlane_b32 s84, v3, 0
    ds_read_b32 v3, v7
    s_add_u32 s82, s82, 1
    s_cmp_eq_u32 s81, 256
    s_cselect_b32 s83, -1, s83
    s_cmp_ge_u32 s81, 128
    s_waitcnt vmcnt(25)
    buffer_load_dwordx4 v2, s[4:7], s78 offen offset:3072 nt lds
    ds_write_b32 v6, v5
    s_cselect_b64 s[4:5], s[56:57], s[50:51]
    s_mov_b32 m0, s86
    s_mov_b32 s78, s80
    s_cmp_eq_u32 s83, 26
    s_cbranch_scc1 L_B26
    s_cmp_eq_u32 s83, 25
    s_cbranch_scc1 L_D25
    s_branch L_disp
L_B20_0w:
    ds_read_b32 v3, v7
    s_waitcnt lgkmcnt(0)
    v_readlane_b32 s84, v3, 0
    s_nop 0
    s_branch L_B20_0
L_B20_1w:
    ds_read_b32 v3, v7
    s_waitcnt lgkmcnt(0)
    v_readlane_b32 s84, v3, 1
    s_nop 0
    s_branch L_B20_1
L_B20_2w:
    ds_read_b32 v3, v7
    s_waitcnt lgkmcnt(0)
    v_readlane_b32 s84, v3, 2
    s_nop 0
    s_branch L_B20_2
L_B20_3w:
    ds_read_b32 v3, v7
    s_waitcnt lgkmcnt(0)
    v_readlane_b32 s84, v3, 3
    s_nop 0
    s_branch L_B20_3
L_B19_0w:
    ds_read_b32 v3, v7
    s_waitcnt lgkmcnt(0)
    v_readlane_b32 s84, v3, 0
    s_nop 0
    s_branch L_B19_0
L_B19_1w:
    ds_read_b32 v3, v7
    s_waitcnt lgkmcnt(0)
    v_readlane_b32 s84, v3, 1
    s_nop 0
    s_branch L_B19_1
L_B19_2w:
    ds_read_b32 v3, v7
    s_waitcnt lgkmcnt(0)
    v_readlane_b32 s84, v3, 2
    s_nop 0
    s_branch L_B19_2
L_B19_3w:
    ds_read_b32 v3, v7
    s_waitcnt lgkmcnt(0)
    v_readlane_b32 s84, v3, 3
    s_nop 0
    s_branch L_B19_3
L_B21_0w:
    ds_read_b32 v3, v7
    s_waitcnt lgkmcnt(0)
    v_readlane_b32 s84, v3, 0
    s_nop 0
    s_branch L_B21_0
L_B21_1w:
    ds_read_b32 v3, v7
    s_waitcnt lgkmcnt(0)
    v_readlane_b32 s84, v3, 1
    s_nop 0
    s_branch L_B21_1
L_B21_2w:
    ds_read_b32 v3, v7
    s_waitcnt lgkmcnt(0)
    v_readlane_b32 s84, v3, 2
    s_nop 0
    s_branch L_B21_2
L_B21_3w:
    ds_read_b32 v3, v7
    s_waitcnt lgkmcnt(0)
    v_readlane_b32 s84, v3, 3
    s_nop 0
    s_branch L_B21_3
L_B18_0w:
    ds_read_b32 v3, v7
    s_waitcnt lgkmcnt(0)
    v_readlane_b32 s84, v3, 0
    s_nop 0
    s_branch L_B18_0
L_B18_1w:
    ds_read_b32 v3, v7
    s_waitcnt lgkmcnt(0)
    v_readlane_b32 s84, v3, 1
    s_nop 0
    s_branch L_B18_1
L_B18_2w:
    ds_read_b32 v3, v7
    s_waitcnt lgkmcnt(0)
    v_readlane_b32 s84, v3, 2
    s_nop 0
    s_branch L_B18_2
L_B18_3w:
    ds_read_b32 v3, v7
    s_waitcnt lgkmcnt(0)
    v_readlane_b32 s84, v3, 3
    s_nop 0
    s_branch L_B18_3
L_B22_0w:
    ds_read_b32 v3, v7
    s_waitcnt lgkmcnt(0)
    v_readlane_b32 s84, v3, 0
    s_nop 0
    s_branch L_B22_0
L_B22_1w:
    ds_read_b32 v3, v7
    s_waitcnt lgkmcnt(0)
    v_readlane_b32 s84, v3, 1
    s_nop 0
    s_branch L_B22_1
L_B22_2w:
    ds_read_b32 v3, v7
    s_waitcnt lgkmcnt(0)
    v_readlane_b32 s84, v3, 2
    s_nop 0
    s_branch L_B22_2
L_B22_3w:
    ds_read_b32 v3, v7
    s_waitcnt lgkmcnt(0)
    v_readlane_b32 s84, v3, 3
    s_nop 0
    s_branch L_B22_3
L_B17_0w:
    ds_read_b32 v3, v7
    s_waitcnt lgkmcnt(0)
    v_readlane_b32 s84, v3, 0
    s_nop 0
    s_branch L_B17_0
L_B17_1w:
    ds_read_b32 v3, v7
    s_waitcnt lgkmcnt(0)
    v_readlane_b32 s84, v3, 1
    s_nop 0
    s_branch L_B17_1
L_B17_2w:
    ds_read_b32 v3, v7
    s_waitcnt lgkmcnt(0)
    v_readlane_b32 s84, v3, 2
    s_nop 0
    s_branch L_B17_2
L_B17_3w:
    ds_read_b32 v3, v7
    s_waitcnt lgkmcnt(0)
    v_readlane_b32 s84, v3, 3
    s_nop 0
    s_branch L_B17_3
L_B23_0w:
    ds_read_b32 v3, v7
    s_waitcnt lgkmcnt(0)
    v_readlane_b32 s84, v3, 0
    s_nop 0
    s_branch L_B23_0
L_B23_1w:
    ds_read_b32 v3, v7
    s_waitcnt lgkmcnt(0)
    v_readlane_b32 s84, v3, 1
    s_nop 0
    s_branch L_B23_1
L_B23_2w:
    ds_read_b32 v3, v7
    s_waitcnt lgkmcnt(0)
    v_readlane_b32 s84, v3, 2
    s_nop 0
    s_branch L_B23_2
L_B23_3w:
    ds_read_b32 v3, v7
    s_waitcnt lgkmcnt(0)
    v_readlane_b32 s84, v3, 3
    s_nop 0
    s_branch L_B23_3
L_B16_0w:
    ds_read_b32 v3, v7
    s_waitcnt lgkmcnt(0)
    v_readlane_b32 s84, v3, 0
    s_nop 0
    s_branch L_B16_0
L_B16_1w:
    ds_read_b32 v3, v7
    s_waitcnt lgkmcnt(0)
    v_readlane_b32 s84, v3, 1
    s_nop 0
    s_branch L_B16_1
L_B16_2w:
    ds_read_b32 v3, v7
    s_waitcnt lgkmcnt(0)
    v_readlane_b32 s84, v3, 2
    s_nop 0
    s_branch L_B16_2
L_B16_3w:
    ds_read_b32 v3, v7
    s_waitcnt lgkmcnt(0)
    v_readlane_b32 s84, v3, 3
    s_nop 0
    s_branch L_B16_3
L_B24_0w:
    ds_read_b32 v3, v7
    s_waitcnt lgkmcnt(0)
    v_readlane_b32 s84, v3, 0
    s_nop 0
    s_branch L_B24_0
L_B24_1w:
    ds_read_b32 v3, v7
    s_waitcnt lgkmcnt(0)
    v_readlane_b32 s84, v3, 1
    s_nop 0
    s_branch L_B24_1
L_B24_2w:
    ds_read_b32 v3, v7
    s_waitcnt lgkmcnt(0)
    v_readlane_b32 s84, v3, 2
    s_nop 0
    s_branch L_B24_2
L_B24_3w:
    ds_read_b32 v3, v7
    s_waitcnt lgkmcnt(0)
    v_readlane_b32 s84, v3, 3
    s_nop 0
    s_branch L_B24_3
L_B15_0w:
    ds_read_b32 v3, v7
    s_waitcnt lgkmcnt(0)
    v_readlane_b32 s84, v3, 0
    s_nop 0
    s_branch L_B15_0
L_B15_1w:
    ds_read_b32 v3, v7
    s_waitcnt lgkmcnt(0)
    v_readlane_b32 s84, v3, 1
    s_nop 0
    s_branch L_B15_1
L_B15_2w:
    ds_read_b32 v3, v7
    s_waitcnt lgkmcnt(0)
    v_readlane_b32 s84, v3, 2
    s_nop 0
    s_branch L_B15_2
L_B15_3w:
    ds_read_b32 v3, v7
    s_waitcnt lgkmcnt(0)
    v_readlane_b32 s84, v3, 3
    s_nop 0
    s_branch L_B15_3
L_B25_0w:
    ds_read_b32 v3, v7
    s_waitcnt lgkmcnt(0)
    v_readlane_b32 s84, v3, 0
    s_nop 0
    s_branch L_B25_0
L_B25_1w:
    ds_read_b32 v3, v7
    s_waitcnt lgkmcnt(0)
    v_readlane_b32 s84, v3, 1
    s_nop 0
    s_branch L_B25_1
L_B25_2w:
    ds_read_b32 v3, v7
    s_waitcnt lgkmcnt(0)
    v_readlane_b32 s84, v3, 2
    s_nop 0
    s_branch L_B25_2
L_B25_3w:
    ds_read_b32 v3, v7
    s_waitcnt lgkmcnt(0)
    v_readlane_b32 s84, v3, 3
    s_nop 0
    s_branch L_B25_3
L_B26_0w:
    ds_read_b32 v3, v7
    s_waitcnt lgkmcnt(0)
    v_readlane_b32 s84, v3, 0
    s_nop 0
    s_branch L_B26_0
L_B26_1w:
    ds_read_b32 v3, v7
    s_waitcnt lgkmcnt(0)
    v_readlane_b32 s84, v3, 1
    s_nop 0
    s_branch L_B26_1
L_B26_2w:
    ds_read_b32 v3, v7
    s_waitcnt lgkmcnt(0)
    v_readlane_b32 s84, v3, 2
    s_nop 0
    s_branch L_B26_2
L_B26_3w:
    ds_read_b32 v3, v7
    s_waitcnt lgkmcnt(0)
    v_readlane_b32 s84, v3, 3
    s_nop 0
    s_branch L_B26_3
L_drain:
    v_mov_b32 v18, 3048
    s_waitcnt vmcnt(24)
    ds_write_b32 v6, v18
    v_mov_b32 v18, 3051
    s_waitcnt vmcnt(21)
    ds_write_b32 v6, v18
    v_mov_b32 v18, 3054
    s_waitcnt vmcnt(18)
    ds_write_b32 v6, v18
    v_mov_b32 v18, 3057
    s_waitcnt vmcnt(15)
    ds_write_b32 v6, v18
    v_mov_b32 v18, 3060
    s_waitcnt vmcnt(12)
    ds_write_b32 v6, v18
    v_mov_b32 v18, 3063
    s_waitcnt vmcnt(9)
    ds_write_b32 v6, v18
    v_mov_b32 v18, 3066
    s_waitcnt vmcnt(6)
    ds_write_b32 v6, v18
    v_mov_b32 v18, 3069
    s_waitcnt vmcnt(3)
    ds_write_b32 v6, v18
    v_mov_b32 v18, 3072
    s_waitcnt vmcnt(0)
    ds_write_b32 v6, v18
    s_waitcnt lgkmcnt(0)
    s_endpgm
L_other:
    s_cmp_eq_u32 s76, 5
    s_cbranch_scc1 L_helper
    s_sub_u32 s78, s76, 1
    v_lshlrev_b32 v44, 3, v1
    v_cmp_gt_u32 vcc, 24, v1
    v_mov_b32 v23, 0xffffff40
    v_mov_b32 v18, 192
    v_cndmask_b32 v23, v23, v18, vcc
    v_add_u32 v45, v44, v23
    v_mov_b32 v18, 0x80008000
    v_cndmask_b32 v46, 0, v18, vcc
    v_lshrrev_b32 v19, 4, v1
    v_and_b32 v23, 15, v1
    v_mul_u32_u24 v20, 384, v19
    v_lshl_add_u32 v20, v23, 3, v20
    v_cmp_lt_u32 s[86:87], 7, v23
    v_mov_b32 v21, -64
    v_mov_b32 v18, 320
    v_cndmask_b32 v21, v18, v21, s[86:87]
    v_add_u32 v21, v20, v21
    s_lshl1_add_u32 s95, s78, s3
    s_mul_i32 s95, s95, 768
    s_lshl2_add_u32 s89, s78, s77
    s_mov_b32 s34, 12288
    s_mov_b32 s35, 0x20000
    s_mov_b32 s38, 384
    s_mov_b32 s39, 0x20000
    s_mov_b32 s42, 384
    s_mov_b32 s43, 0x20000
    s_mov_b32 s14, 6291456
    s_mov_b32 s15, 0x20000
    s_mov_b32 s18, 6291456
    s_mov_b32 s19, 0x20000
    s_waitcnt lgkmcnt(0)
    s_mov_b64 s[32:33], s[48:49]
    s_mov_b64 s[36:37], s[62:63]
    s_mov_b64 s[40:41], s[64:65]
    buffer_load_dwordx2 v[24:25], v44, s[32:35], s95 offen
    buffer_load_dwordx2 v[26:27], v45, s[32:35], s95 offen
    buffer_load_dwordx2 v[28:29], v44, s[32:35], s95 offen offset:384
    buffer_load_dwordx2 v[30:31], v45, s[32:35], s95 offen offset:384
    buffer_load_dwordx2 v[40:41], v44, s[36:39], 0 offen
    buffer_load_dwordx2 v[42:43], v44, s[40:43], 0 offen
    s_mov_b64 s[12:13], s[66:67]
    s_mov_b64 s[16:17], s[68:69]
    s_mul_i32 s82, s89, 384
    s_add_u32 s89, s89, 2048
    s_and_b32 s89, s89, 16383
    buffer_load_dwordx2 v[72:73], v20, s[12:15], s82 offen offset:0
    buffer_load_dwordx2 v[74:75], v20, s[16:19], s82 offen offset:192
    buffer_load_dwordx2 v[76:77], v20, s[12:15], s82 offen offset:128
    buffer_load_dwordx2 v[78:79], v21, s[16:19], s82 offen
    buffer_load_dwordx2 v[80:81], v20, s[12:15], s82 offen offset:256
    buffer_load_dwordx2 v[82:83], v20, s[16:19], s82 offen offset:64
    s_barrier
    s_mov_b32 s83, 0x05040100
    s_mov_b32 s84, 0x07060302
    s_mul_i32 s92, s78, 3072
    v_lshl_add_u32 v2, v20, 1, s92
    s_lshl_b32 s92, s78, 5
    s_add_u32 s92, s92, 49152
    v_lshl_add_u32 v3, v19, 3, s92
    v_lshrrev_b32 v18, 3, v23
    v_lshl_add_u32 v4, v18, 10, v3
    v_lshlrev_b32 v9, 4, v23
    v_add_u32 v9, 65536, v9
    s_lshl2_add_u32 s92, s78, 77824
    v_mov_b32 v5, s92
    v_mov_b32 v6, 0
    v_mov_b32 v8, 1
    v_mov_b32 v22, 77888
    s_mul_i32 s79, s78, 3
    s_sub_u32 s79, s79, 9
    s_mov_b32 s80, 0
    s_mov_b32 s81, 0
    s_mul_i32 s92, s78, 1536
    s_add_u32 s92, s92, 65536
    v_lshl_add_u32 v18, v44, 1, s92
    v_lshl_add_u32 v19, v45, 1, s92
    s_waitcnt vmcnt(6)
    v_xor_b32 v42, v42, v46
    v_xor_b32 v43, v43, v46
    v_lshlrev_b32 v48, 16, v40
    v_and_b32 v49, 0xffff0000, v40
    v_lshlrev_b32 v50, 16, v41
    v_and_b32 v51, 0xffff0000, v41
    v_lshlrev_b32 v52, 16, v42
    v_and_b32 v53, 0xffff0000, v42
    v_lshlrev_b32 v54, 16, v43
    v_and_b32 v55, 0xffff0000, v43
    v_and_b32 v46, 0x80000000, v46
    s_mov_b32 exec_hi, 0xffff
    v_lshlrev_b32 v56, 16, v24
    v_and_b32 v57, 0xffff0000, v24
    v_lshlrev_b32 v58, 16, v25
    v_and_b32 v59, 0xffff0000, v25
    v_lshlrev_b32 v60, 16, v26
    v_and_b32 v61, 0xffff0000, v26
    v_lshlrev_b32 v62, 16, v27
    v_and_b32 v63, 0xffff0000, v27
    v_pk_mul_f32 v[56:57], v[56:57], v[48:49]
    v_pk_mul_f32 v[60:61], v[60:61], v[52:53]
    v_pk_mul_f32 v[58:59], v[58:59], v[50:51]
    v_pk_mul_f32 v[62:63], v[62:63], v[54:55]
    v_cvt_pk_bf16_f32 v56, v56, v60
    v_cvt_pk_bf16_f32 v57, v57, v61
    v_cvt_pk_bf16_f32 v58, v58, v62
    v_cvt_pk_bf16_f32 v59, v59, v63
    v_and_b32 v60, 0xffff0000, v56
    v_lshlrev_b32 v56, 16, v56
    v_and_b32 v61, 0xffff0000, v57
    v_lshlrev_b32 v57, 16, v57
    v_and_b32 v62, 0xffff0000, v58
    v_lshlrev_b32 v58, 16, v58
    v_and_b32 v63, 0xffff0000, v59
    v_lshlrev_b32 v59, 16, v59
    v_pk_add_f32 v[56:57], v[56:57], v[60:61]
    v_pk_add_f32 v[58:59], v[58:59], v[62:63]
    v_cvt_pk_bf16_f32 v64, v56, v56
    v_cvt_pk_bf16_f32 v65, v57, v57
    v_cvt_pk_bf16_f32 v66, v58, v58
    v_cvt_pk_bf16_f32 v67, v59, v59
    v_xor_b32 v64, v64, v46
    v_xor_b32 v65, v65, v46
    v_xor_b32 v66, v66, v46
    v_xor_b32 v67, v67, v46
    ds_write_b16 v18, v64 offset:0
    ds_write_b16_d16_hi v19, v64 offset:2
    ds_write_b16 v18, v65 offset:4
    ds_write_b16_d16_hi v19, v65 offset:6
    ds_write_b16 v18, v66 offset:8
    ds_write_b16_d16_hi v19, v66 offset:10
    ds_write_b16 v18, v67 offset:12
    ds_write_b16_d16_hi v19, v67 offset:14
    v_lshlrev_b32 v56, 16, v28
    v_and_b32 v57, 0xffff0000, v28
    v_lshlrev_b32 v58, 16, v29
    v_and_b32 v59, 0xffff0000, v29
    v_lshlrev_b32 v60, 16, v30
    v_and_b32 v61, 0xffff0000, v30
    v_lshlrev_b32 v62, 16, v31
    v_and_b32 v63, 0xffff0000, v31
    v_pk_mul_f32 v[56:57], v[56:57], v[48:49]
    v_pk_mul_f32 v[60:61], v[60:61], v[52:53]
    v_pk_mul_f32 v[58:59], v[58:59], v[50:51]
    v_pk_mul_f32 v[62:63], v[62:63], v[54:55]
    v_cvt_pk_bf16_f32 v56, v56, v60
    v_cvt_pk_bf16_f32 v57, v57, v61
    v_cvt_pk_bf16_f32 v58, v58, v62
    v_cvt_pk_bf16_f32 v59, v59, v63
    v_and_b32 v60, 0xffff0000, v56
    v_lshlrev_b32 v56, 16, v56
    v_and_b32 v61, 0xffff0000, v57
    v_lshlrev_b32 v57, 16, v57
    v_and_b32 v62, 0xffff0000, v58
    v_lshlrev_b32 v58, 16, v58
    v_and_b32 v63, 0xffff0000, v59
    v_lshlrev_b32 v59, 16, v59
    v_pk_add_f32 v[56:57], v[56:57], v[60:61]
    v_pk_add_f32 v[58:59], v[58:59], v[62:63]
    v_cvt_pk_bf16_f32 v68, v56, v56
    v_cvt_pk_bf16_f32 v69, v57, v57
    v_cvt_pk_bf16_f32 v70, v58, v58
    v_cvt_pk_bf16_f32 v71, v59, v59
    v_xor_b32 v68, v68, v46
    v_xor_b32 v69, v69, v46
    v_xor_b32 v70, v70, v46
    v_xor_b32 v71, v71, v46
    ds_write_b16 v18, v68 offset:768
    ds_write_b16_d16_hi v19, v68 offset:770
    ds_write_b16 v18, v69 offset:772
    ds_write_b16_d16_hi v19, v69 offset:774
    ds_write_b16 v18, v70 offset:776
    ds_write_b16_d16_hi v19, v70 offset:778
    ds_write_b16 v18, v71 offset:780
    ds_write_b16_d16_hi v19, v71 offset:782
    s_mov_b32 exec_hi, -1
    ds_write_b32 v5, v8 offset:128
    s_mul_i32 s82, s89, 384
    s_add_u32 s89, s89, 2048
    s_and_b32 s89, s89, 16383
    buffer_load_dwordx2 v[84:85], v20, s[12:15], s82 offen offset:0
    buffer_load_dwordx2 v[86:87], v20, s[16:19], s82 offen offset:192
    buffer_load_dwordx2 v[88:89], v20, s[12:15], s82 offen offset:128
    buffer_load_dwordx2 v[90:91], v21, s[16:19], s82 offen
    buffer_load_dwordx2 v[92:93], v20, s[12:15], s82 offen offset:256
    buffer_load_dwordx2 v[94:95], v20, s[16:19], s82 offen offset:64
L_kph:
    s_add_u32 s88, s81, 32
L_kw:
    ds_read_b32 v19, v7
    s_waitcnt lgkmcnt(0)
    v_readlane_b32 s92, v19, s88
    v_readlane_b32 s93, v19, 12
    s_cmp_eq_u32 s92, 0
    s_nop 3
    s_cbranch_scc1 L_kw
    s_cmp_le_u32 s93, s81
    s_cbranch_scc1 L_kw
    ds_read_b128 v[48:51], v9 offset:0
    ds_read_b128 v[52:55], v9 offset:256
    ds_read_b128 v[56:59], v9 offset:512
    ds_read_b128 v[60:63], v9 offset:768
    ds_read_b128 v[64:67], v9 offset:1024
    ds_read_b128 v[68:71], v9 offset:1280
    v_add_u32 v9, 1536, v9
    s_waitcnt lgkmcnt(0)
    s_cmp_lg_u32 s81, 0
    s_cbranch_scc1 L_ncs0
    s_waitcnt vmcnt(6)
    v_perm_b32 v36, v74, v72, s83
    v_perm_b32 v74, v74, v72, s84
    v_perm_b32 v37, v75, v73, s83
    v_perm_b32 v75, v75, v73, s84
    v_perm_b32 v38, v78, v76, s83
    v_perm_b32 v78, v78, v76, s84
    v_perm_b32 v39, v79, v77, s83
    v_perm_b32 v79, v79, v77, s84
    v_perm_b32 v40, v82, v80, s83
    v_perm_b32 v82, v82, v80, s84
    v_perm_b32 v41, v83, v81, s83
    v_perm_b32 v83, v83, v81, s84
    v_mov_b64 v[72:73], v[36:37]
    v_mov_b64 v[76:77], v[38:39]
    v_mov_b64 v[80:81], v[40:41]
    s_mul_i32 s82, s89, 384
    s_add_u32 s89, s89, 2048
    s_and_b32 s89, s89, 16383
    buffer_load_dwordx2 v[96:97], v20, s[12:15], s82 offen offset:0
    buffer_load_dwordx2 v[98:99], v20, s[16:19], s82 offen offset:192
    buffer_load_dwordx2 v[100:101], v20, s[12:15], s82 offen offset:128
    buffer_load_dwordx2 v[102:103], v21, s[16:19], s82 offen
    buffer_load_dwordx2 v[104:105], v20, s[12:15], s82 offen offset:256
    buffer_load_dwordx2 v[106:107], v20, s[16:19], s82 offen offset:64
L_ncs0:
    v_dot2_f32_bf16 v36, v72, v48, 0
    v_dot2_f32_bf16 v37, v74, v49, 0
    v_dot2_f32_bf16 v38, v73, v50, 0
    v_dot2_f32_bf16 v39, v75, v51, 0
    v_dot2_f32_bf16 v40, v76, v52, 0
    v_dot2_f32_bf16 v41, v78, v53, 0
    v_dot2_f32_bf16 v42, v77, v54, 0
    v_dot2_f32_bf16 v43, v79, v55, 0
    v_dot2_f32_bf16 v44, v80, v56, 0
    v_dot2_f32_bf16 v45, v82, v57, 0
    v_dot2_f32_bf16 v46, v81, v58, 0
    v_dot2_f32_bf16 v47, v83, v59, 0
    s_add_u32 s79, s79, 12
    s_cmp_ge_i32 s80, s79
    s_cbranch_scc1 L_kr00g
L_kr00:
    ds_read_b32 v19, v7
    s_sleep 1
    s_waitcnt lgkmcnt(0)
    v_readlane_b32 s80, v19, 5
    s_nop 0
    s_cmp_lt_i32 s80, s79
    s_cbranch_scc1 L_kr00
L_kr00g:
    ds_read_b32 v10, v3 offset:0
    ds_read_b128 v[24:27], v2 offset:0
    ds_read_b128 v[28:31], v2 offset:256
    ds_read_b128 v[32:35], v2 offset:512
    v_add_u32 v6, 1, v6
    ds_write_b32 v5, v6
    s_waitcnt lgkmcnt(3)
    v_and_b32 v12, 0xffff0000, v10
    v_cvt_f32_i32 v24, v24
    v_cvt_f32_i32 v25, v25
    v_cvt_f32_i32 v26, v26
    v_cvt_f32_i32 v27, v27
    v_pk_add_f32 v[24:25], v[24:25], v[12:13] op_sel:[0,0] op_sel_hi:[1,0] neg_lo:[0,1] neg_hi:[0,1]
    v_pk_add_f32 v[26:27], v[26:27], v[12:13] op_sel:[0,0] op_sel_hi:[1,0] neg_lo:[0,1] neg_hi:[0,1]
    v_pk_mul_f32 v[14:15], v[24:25], v[36:37]
    v_pk_fma_f32 v[14:15], v[26:27], v[38:39], v[14:15]
    s_waitcnt lgkmcnt(2)
    v_cvt_f32_i32 v28, v28
    v_cvt_f32_i32 v29, v29
    v_cvt_f32_i32 v30, v30
    v_cvt_f32_i32 v31, v31
    v_pk_add_f32 v[28:29], v[28:29], v[12:13] op_sel:[0,0] op_sel_hi:[1,0] neg_lo:[0,1] neg_hi:[0,1]
    v_pk_add_f32 v[30:31], v[30:31], v[12:13] op_sel:[0,0] op_sel_hi:[1,0] neg_lo:[0,1] neg_hi:[0,1]
    v_pk_fma_f32 v[14:15], v[28:29], v[40:41], v[14:15]
    v_pk_fma_f32 v[14:15], v[30:31], v[42:43], v[14:15]
    s_waitcnt lgkmcnt(1)
    v_cvt_f32_i32 v32, v32
    v_cvt_f32_i32 v33, v33
    v_cvt_f32_i32 v34, v34
    v_cvt_f32_i32 v35, v35
    v_pk_add_f32 v[32:33], v[32:33], v[12:13] op_sel:[0,0] op_sel_hi:[1,0] neg_lo:[0,1] neg_hi:[0,1]
    v_pk_add_f32 v[34:35], v[34:35], v[12:13] op_sel:[0,0] op_sel_hi:[1,0] neg_lo:[0,1] neg_hi:[0,1]
    v_pk_fma_f32 v[14:15], v[32:33], v[44:45], v[14:15]
    v_pk_fma_f32 v[14:15], v[34:35], v[46:47], v[14:15]
    v_add_f32 v14, v14, v15
    s_nop 1
    v_add_f32_dpp v18, v14, v14 row_ror:8 row_mask:0xf bank_mask:0x3
    v_dot2_f32_bf16 v36, v72, v60, 0
    v_dot2_f32_bf16 v37, v74, v61, 0
    v_dot2_f32_bf16 v38, v73, v62, 0
    v_dot2_f32_bf16 v39, v75, v63, 0
    v_dot2_f32_bf16 v40, v76, v64, 0
    v_dot2_f32_bf16 v41, v78, v65, 0
    v_dot2_f32_bf16 v42, v77, v66, 0
    v_dot2_f32_bf16 v43, v79, v67, 0
    v_dot2_f32_bf16 v44, v80, v68, 0
    v_dot2_f32_bf16 v45, v82, v69, 0
    v_dot2_f32_bf16 v46, v81, v70, 0
    v_dot2_f32_bf16 v47, v83, v71, 0
    s_add_u32 s79, s79, 12
    s_cmp_ge_i32 s80, s79
    s_cbranch_scc1 L_kr01g
L_kr01:
    ds_read_b32 v19, v7
    s_sleep 1
    s_waitcnt lgkmcnt(0)
    v_readlane_b32 s80, v19, 5
    s_nop 0
    s_cmp_lt_i32 s80, s79
    s_cbranch_scc1 L_kr01
L_kr01g:
    ds_read_b32 v11, v3 offset:1024
    ds_read_b128 v[24:27], v2 offset:12288
    ds_read_b128 v[28:31], v2 offset:12544
    ds_read_b128 v[32:35], v2 offset:12800
    v_add_u32 v6, 1, v6
    ds_write_b32 v5, v6
    s_waitcnt lgkmcnt(3)
    v_and_b32 v12, 0xffff0000, v11
    v_cvt_f32_i32 v24, v24
    v_cvt_f32_i32 v25, v25
    v_cvt_f32_i32 v26, v26
    v_cvt_f32_i32 v27, v27
    v_pk_add_f32 v[24:25], v[24:25], v[12:13] op_sel:[0,0] op_sel_hi:[1,0] neg_lo:[0,1] neg_hi:[0,1]
    v_pk_add_f32 v[26:27], v[26:27], v[12:13] op_sel:[0,0] op_sel_hi:[1,0] neg_lo:[0,1] neg_hi:[0,1]
    v_pk_mul_f32 v[16:17], v[24:25], v[36:37]
    v_pk_fma_f32 v[16:17], v[26:27], v[38:39], v[16:17]
    s_waitcnt lgkmcnt(2)
    v_cvt_f32_i32 v28, v28
    v_cvt_f32_i32 v29, v29
    v_cvt_f32_i32 v30, v30
    v_cvt_f32_i32 v31, v31
    v_pk_add_f32 v[28:29], v[28:29], v[12:13] op_sel:[0,0] op_sel_hi:[1,0] neg_lo:[0,1] neg_hi:[0,1]
    v_pk_add_f32 v[30:31], v[30:31], v[12:13] op_sel:[0,0] op_sel_hi:[1,0] neg_lo:[0,1] neg_hi:[0,1]
    v_pk_fma_f32 v[16:17], v[28:29], v[40:41], v[16:17]
    v_pk_fma_f32 v[16:17], v[30:31], v[42:43], v[16:17]
    s_waitcnt lgkmcnt(1)
    v_cvt_f32_i32 v32, v32
    v_cvt_f32_i32 v33, v33
    v_cvt_f32_i32 v34, v34
    v_cvt_f32_i32 v35, v35
    v_pk_add_f32 v[32:33], v[32:33], v[12:13] op_sel:[0,0] op_sel_hi:[1,0] neg_lo:[0,1] neg_hi:[0,1]
    v_pk_add_f32 v[34:35], v[34:35], v[12:13] op_sel:[0,0] op_sel_hi:[1,0] neg_lo:[0,1] neg_hi:[0,1]
    v_pk_fma_f32 v[16:17], v[32:33], v[44:45], v[16:17]
    v_pk_fma_f32 v[16:17], v[34:35], v[46:47], v[16:17]
    v_add_f32 v16, v16, v17
    v_cndmask_b32 v23, v10, v11, s[86:87]
    v_lshlrev_b32 v23, 16, v23
    v_add_f32_dpp v18, v16, v16 row_ror:8 row_mask:0xf bank_mask:0xc
    v_mul_f32 v23, 0x3dd53b95, v23
    s_nop 0
    v_add_f32_dpp v18, v18, v18 row_half_mirror row_mask:0xf bank_mask:0xf
    s_nop 1
    v_add_f32_dpp v18, v18, v18 quad_perm:[2,3,0,1] row_mask:0xf bank_mask:0xf
    s_nop 1
    v_add_f32_dpp v18, v18, v18 quad_perm:[1,0,3,2] row_mask:0xf bank_mask:0xf
    v_mul_f32 v18, v23, v18
    ds_write_b32 v4, v18 offset:0
    s_cmp_lg_u32 s81, 0
    s_cbranch_scc1 L_ncs1
    s_waitcnt vmcnt(6)
    v_perm_b32 v36, v86, v84, s83
    v_perm_b32 v86, v86, v84, s84
    v_perm_b32 v37, v87, v85, s83
    v_perm_b32 v87, v87, v85, s84
    v_perm_b32 v38, v90, v88, s83
    v_perm_b32 v90, v90, v88, s84
    v_perm_b32 v39, v91, v89, s83
    v_perm_b32 v91, v91, v89, s84
    v_perm_b32 v40, v94, v92, s83
    v_perm_b32 v94, v94, v92, s84
    v_perm_b32 v41, v95, v93, s83
    v_perm_b32 v95, v95, v93, s84
    v_mov_b64 v[84:85], v[36:37]
    v_mov_b64 v[88:89], v[38:39]
    v_mov_b64 v[92:93], v[40:41]
    s_mul_i32 s82, s89, 384
    s_add_u32 s89, s89, 2048
    s_and_b32 s89, s89, 16383
    buffer_load_dwordx2 v[108:109], v20, s[12:15], s82 offen offset:0
    buffer_load_dwordx2 v[110:111], v20, s[16:19], s82 offen offset:192
    buffer_load_dwordx2 v[112:113], v20, s[12:15], s82 offen offset:128
    buffer_load_dwordx2 v[114:115], v21, s[16:19], s82 offen
    buffer_load_dwordx2 v[116:117], v20, s[12:15], s82 offen offset:256
    buffer_load_dwordx2 v[118:119], v20, s[16:19], s82 offen offset:64
L_ncs1:
    v_dot2_f32_bf16 v36, v84, v48, 0
    v_dot2_f32_bf16 v37, v86, v49, 0
    v_dot2_f32_bf16 v38, v85, v50, 0
    v_dot2_f32_bf16 v39, v87, v51, 0
    v_dot2_f32_bf16 v40, v88, v52, 0
    v_dot2_f32_bf16 v41, v90, v53, 0
    v_dot2_f32_bf16 v42, v89, v54, 0
    v_dot2_f32_bf16 v43, v91, v55, 0
    v_dot2_f32_bf16 v44, v92, v56, 0
    v_dot2_f32_bf16 v45, v94, v57, 0
    v_dot2_f32_bf16 v46, v93, v58, 0
    v_dot2_f32_bf16 v47, v95, v59, 0
    s_add_u32 s79, s79, 12
    s_cmp_ge_i32 s80, s79
    s_cbranch_scc1 L_kr10g
L_kr10:
    ds_read_b32 v19, v7
    s_sleep 1
    s_waitcnt lgkmcnt(0)
    v_readlane_b32 s80, v19, 5
    s_nop 0
    s_cmp_lt_i32 s80, s79
    s_cbranch_scc1 L_kr10
L_kr10g:
    ds_read_b32 v10, v3 offset:128
    ds_read_b128 v[24:27], v2 offset:24576
    ds_read_b128 v[28:31], v2 offset:24832
    ds_read_b128 v[32:35], v2 offset:25088
    v_add_u32 v6, 1, v6
    ds_write_b32 v5, v6
    s_waitcnt lgkmcnt(3)
    v_and_b32 v12, 0xffff0000, v10
    v_cvt_f32_i32 v24, v24
    v_cvt_f32_i32 v25, v25
    v_cvt_f32_i32 v26, v26
    v_cvt_f32_i32 v27, v27
    v_pk_add_f32 v[24:25], v[24:25], v[12:13] op_sel:[0,0] op_sel_hi:[1,0] neg_lo:[0,1] neg_hi:[0,1]
    v_pk_add_f32 v[26:27], v[26:27], v[12:13] op_sel:[0,0] op_sel_hi:[1,0] neg_lo:[0,1] neg_hi:[0,1]
    v_pk_mul_f32 v[14:15], v[24:25], v[36:37]
    v_pk_fma_f32 v[14:15], v[26:27], v[38:39], v[14:15]
    s_waitcnt lgkmcnt(2)
    v_cvt_f32_i32 v28, v28
    v_cvt_f32_i32 v29, v29
    v_cvt_f32_i32 v30, v30
    v_cvt_f32_i32 v31, v31
    v_pk_add_f32 v[28:29], v[28:29], v[12:13] op_sel:[0,0] op_sel_hi:[1,0] neg_lo:[0,1] neg_hi:[0,1]
    v_pk_add_f32 v[30:31], v[30:31], v[12:13] op_sel:[0,0] op_sel_hi:[1,0] neg_lo:[0,1] neg_hi:[0,1]
    v_pk_fma_f32 v[14:15], v[28:29], v[40:41], v[14:15]
    v_pk_fma_f32 v[14:15], v[30:31], v[42:43], v[14:15]
    s_waitcnt lgkmcnt(1)
    v_cvt_f32_i32 v32, v32
    v_cvt_f32_i32 v33, v33
    v_cvt_f32_i32 v34, v34
    v_cvt_f32_i32 v35, v35
    v_pk_add_f32 v[32:33], v[32:33], v[12:13] op_sel:[0,0] op_sel_hi:[1,0] neg_lo:[0,1] neg_hi:[0,1]
    v_pk_add_f32 v[34:35], v[34:35], v[12:13] op_sel:[0,0] op_sel_hi:[1,0] neg_lo:[0,1] neg_hi:[0,1]
    v_pk_fma_f32 v[14:15], v[32:33], v[44:45], v[14:15]
    v_pk_fma_f32 v[14:15], v[34:35], v[46:47], v[14:15]
    v_add_f32 v14, v14, v15
    s_nop 1
    v_add_f32_dpp v18, v14, v14 row_ror:8 row_mask:0xf bank_mask:0x3
    v_dot2_f32_bf16 v36, v84, v60, 0
    v_dot2_f32_bf16 v37, v86, v61, 0
    v_dot2_f32_bf16 v38, v85, v62, 0
    v_dot2_f32_bf16 v39, v87, v63, 0
    v_dot2_f32_bf16 v40, v88, v64, 0
    v_dot2_f32_bf16 v41, v90, v65, 0
    v_dot2_f32_bf16 v42, v89, v66, 0
    v_dot2_f32_bf16 v43, v91, v67, 0
    v_dot2_f32_bf16 v44, v92, v68, 0
    v_dot2_f32_bf16 v45, v94, v69, 0
    v_dot2_f32_bf16 v46, v93, v70, 0
    v_dot2_f32_bf16 v47, v95, v71, 0
    s_add_u32 s79, s79, 12
    s_cmp_ge_i32 s80, s79
    s_cbranch_scc1 L_kr11g
L_kr11:
    ds_read_b32 v19, v7
    s_sleep 1
    s_waitcnt lgkmcnt(0)
    v_readlane_b32 s80, v19, 5
    s_nop 0
    s_cmp_lt_i32 s80, s79
    s_cbranch_scc1 L_kr11
L_kr11g:
    ds_read_b32 v11, v3 offset:1152
    ds_read_b128 v[24:27], v2 offset:36864
    ds_read_b128 v[28:31], v2 offset:37120
    ds_read_b128 v[32:35], v2 offset:37376
    v_add_u32 v6, 1, v6
    ds_write_b32 v5, v6
    s_waitcnt lgkmcnt(3)
    v_and_b32 v12, 0xffff0000, v11
    v_cvt_f32_i32 v24, v24
    v_cvt_f32_i32 v25, v25
    v_cvt_f32_i32 v26, v26
    v_cvt_f32_i32 v27, v27
    v_pk_add_f32 v[24:25], v[24:25], v[12:13] op_sel:[0,0] op_sel_hi:[1,0] neg_lo:[0,1] neg_hi:[0,1]
    v_pk_add_f32 v[26:27], v[26:27], v[12:13] op_sel:[0,0] op_sel_hi:[1,0] neg_lo:[0,1] neg_hi:[0,1]
    v_pk_mul_f32 v[16:17], v[24:25], v[36:37]
    v_pk_fma_f32 v[16:17], v[26:27], v[38:39], v[16:17]
    s_waitcnt lgkmcnt(2)
    v_cvt_f32_i32 v28, v28
    v_cvt_f32_i32 v29, v29
    v_cvt_f32_i32 v30, v30
    v_cvt_f32_i32 v31, v31
    v_pk_add_f32 v[28:29], v[28:29], v[12:13] op_sel:[0,0] op_sel_hi:[1,0] neg_lo:[0,1] neg_hi:[0,1]
    v_pk_add_f32 v[30:31], v[30:31], v[12:13] op_sel:[0,0] op_sel_hi:[1,0] neg_lo:[0,1] neg_hi:[0,1]
    v_pk_fma_f32 v[16:17], v[28:29], v[40:41], v[16:17]
    v_pk_fma_f32 v[16:17], v[30:31], v[42:43], v[16:17]
    s_waitcnt lgkmcnt(1)
    v_cvt_f32_i32 v32, v32
    v_cvt_f32_i32 v33, v33
    v_cvt_f32_i32 v34, v34
    v_cvt_f32_i32 v35, v35
    v_pk_add_f32 v[32:33], v[32:33], v[12:13] op_sel:[0,0] op_sel_hi:[1,0] neg_lo:[0,1] neg_hi:[0,1]
    v_pk_add_f32 v[34:35], v[34:35], v[12:13] op_sel:[0,0] op_sel_hi:[1,0] neg_lo:[0,1] neg_hi:[0,1]
    v_pk_fma_f32 v[16:17], v[32:33], v[44:45], v[16:17]
    v_pk_fma_f32 v[16:17], v[34:35], v[46:47], v[16:17]
    v_add_f32 v16, v16, v17
    v_cndmask_b32 v23, v10, v11, s[86:87]
    v_lshlrev_b32 v23, 16, v23
    v_add_f32_dpp v18, v16, v16 row_ror:8 row_mask:0xf bank_mask:0xc
    v_mul_f32 v23, 0x3dd53b95, v23
    s_nop 0
    v_add_f32_dpp v18, v18, v18 row_half_mirror row_mask:0xf bank_mask:0xf
    s_nop 1
    v_add_f32_dpp v18, v18, v18 quad_perm:[2,3,0,1] row_mask:0xf bank_mask:0xf
    s_nop 1
    v_add_f32_dpp v18, v18, v18 quad_perm:[1,0,3,2] row_mask:0xf bank_mask:0xf
    v_mul_f32 v18, v23, v18
    ds_write_b32 v4, v18 offset:128
    s_cmp_lg_u32 s81, 0
    s_cbranch_scc1 L_ncs2
    s_waitcnt vmcnt(6)
    v_perm_b32 v36, v98, v96, s83
    v_perm_b32 v98, v98, v96, s84
    v_perm_b32 v37, v99, v97, s83
    v_perm_b32 v99, v99, v97, s84
    v_perm_b32 v38, v102, v100, s83
    v_perm_b32 v102, v102, v100, s84
    v_perm_b32 v39, v103, v101, s83
    v_perm_b32 v103, v103, v101, s84
    v_perm_b32 v40, v106, v104, s83
    v_perm_b32 v106, v106, v104, s84
    v_perm_b32 v41, v107, v105, s83
    v_perm_b32 v107, v107, v105, s84
    v_mov_b64 v[96:97], v[36:37]
    v_mov_b64 v[100:101], v[38:39]
    v_mov_b64 v[104:105], v[40:41]
    s_mul_i32 s82, s89, 384
    s_add_u32 s89, s89, 2048
    s_and_b32 s89, s89, 16383
    buffer_load_dwordx2 v[120:121], v20, s[12:15], s82 offen offset:0
    buffer_load_dwordx2 v[122:123], v20, s[16:19], s82 offen offset:192
    buffer_load_dwordx2 v[124:125], v20, s[12:15], s82 offen offset:128
    buffer_load_dwordx2 v[126:127], v21, s[16:19], s82 offen
    buffer_load_dwordx2 v[128:129], v20, s[12:15], s82 offen offset:256
    buffer_load_dwordx2 v[130:131], v20, s[16:19], s82 offen offset:64
L_ncs2:
    v_dot2_f32_bf16 v36, v96, v48, 0
    v_dot2_f32_bf16 v37, v98, v49, 0
    v_dot2_f32_bf16 v38, v97, v50, 0
    v_dot2_f32_bf16 v39, v99, v51, 0
    v_dot2_f32_bf16 v40, v100, v52, 0
    v_dot2_f32_bf16 v41, v102, v53, 0
    v_dot2_f32_bf16 v42, v101, v54, 0
    v_dot2_f32_bf16 v43, v103, v55, 0
    v_dot2_f32_bf16 v44, v104, v56, 0
    v_dot2_f32_bf16 v45, v106, v57, 0
    v_dot2_f32_bf16 v46, v105, v58, 0
    v_dot2_f32_bf16 v47, v107, v59, 0
    s_add_u32 s79, s79, 12
    s_cmp_ge_i32 s80, s79
    s_cbranch_scc1 L_kr20g
L_kr20:
    ds_read_b32 v19, v7
    s_sleep 1
    s_waitcnt lgkmcnt(0)
    v_readlane_b32 s80, v19, 5
    s_nop 0
    s_cmp_lt_i32 s80, s79
    s_cbranch_scc1 L_kr20
L_kr20g:
    ds_read_b32 v10, v3 offset:256
    ds_read_b128 v[24:27], v2 offset:0
    ds_read_b128 v[28:31], v2 offset:256
    ds_read_b128 v[32:35], v2 offset:512
    v_add_u32 v6, 1, v6
    ds_write_b32 v5, v6
    s_waitcnt lgkmcnt(3)
    v_and_b32 v12, 0xffff0000, v10
    v_cvt_f32_i32 v24, v24
    v_cvt_f32_i32 v25, v25
    v_cvt_f32_i32 v26, v26
    v_cvt_f32_i32 v27, v27
    v_pk_add_f32 v[24:25], v[24:25], v[12:13] op_sel:[0,0] op_sel_hi:[1,0] neg_lo:[0,1] neg_hi:[0,1]
    v_pk_add_f32 v[26:27], v[26:27], v[12:13] op_sel:[0,0] op_sel_hi:[1,0] neg_lo:[0,1] neg_hi:[0,1]
    v_pk_mul_f32 v[14:15], v[24:25], v[36:37]
    v_pk_fma_f32 v[14:15], v[26:27], v[38:39], v[14:15]
    s_waitcnt lgkmcnt(2)
    v_cvt_f32_i32 v28, v28
    v_cvt_f32_i32 v29, v29
    v_cvt_f32_i32 v30, v30
    v_cvt_f32_i32 v31, v31
    v_pk_add_f32 v[28:29], v[28:29], v[12:13] op_sel:[0,0] op_sel_hi:[1,0] neg_lo:[0,1] neg_hi:[0,1]
    v_pk_add_f32 v[30:31], v[30:31], v[12:13] op_sel:[0,0] op_sel_hi:[1,0] neg_lo:[0,1] neg_hi:[0,1]
    v_pk_fma_f32 v[14:15], v[28:29], v[40:41], v[14:15]
    v_pk_fma_f32 v[14:15], v[30:31], v[42:43], v[14:15]
    s_waitcnt lgkmcnt(1)
    v_cvt_f32_i32 v32, v32
    v_cvt_f32_i32 v33, v33
    v_cvt_f32_i32 v34, v34
    v_cvt_f32_i32 v35, v35
    v_pk_add_f32 v[32:33], v[32:33], v[12:13] op_sel:[0,0] op_sel_hi:[1,0] neg_lo:[0,1] neg_hi:[0,1]
    v_pk_add_f32 v[34:35], v[34:35], v[12:13] op_sel:[0,0] op_sel_hi:[1,0] neg_lo:[0,1] neg_hi:[0,1]
    v_pk_fma_f32 v[14:15], v[32:33], v[44:45], v[14:15]
    v_pk_fma_f32 v[14:15], v[34:35], v[46:47], v[14:15]
    v_add_f32 v14, v14, v15
    s_nop 1
    v_add_f32_dpp v18, v14, v14 row_ror:8 row_mask:0xf bank_mask:0x3
    v_dot2_f32_bf16 v36, v96, v60, 0
    v_dot2_f32_bf16 v37, v98, v61, 0
    v_dot2_f32_bf16 v38, v97, v62, 0
    v_dot2_f32_bf16 v39, v99, v63, 0
    v_dot2_f32_bf16 v40, v100, v64, 0
    v_dot2_f32_bf16 v41, v102, v65, 0
    v_dot2_f32_bf16 v42, v101, v66, 0
    v_dot2_f32_bf16 v43, v103, v67, 0
    v_dot2_f32_bf16 v44, v104, v68, 0
    v_dot2_f32_bf16 v45, v106, v69, 0
    v_dot2_f32_bf16 v46, v105, v70, 0
    v_dot2_f32_bf16 v47, v107, v71, 0
    s_add_u32 s79, s79, 12
    s_cmp_ge_i32 s80, s79
    s_cbranch_scc1 L_kr21g
L_kr21:
    ds_read_b32 v19, v7
    s_sleep 1
    s_waitcnt lgkmcnt(0)
    v_readlane_b32 s80, v19, 5
    s_nop 0
    s_cmp_lt_i32 s80, s79
    s_cbranch_scc1 L_kr21
L_kr21g:
    ds_read_b32 v11, v3 offset:1280
    ds_read_b128 v[24:27], v2 offset:12288
    ds_read_b128 v[28:31], v2 offset:12544
    ds_read_b128 v[32:35], v2 offset:12800
    v_add_u32 v6, 1, v6
    ds_write_b32 v5, v6
    s_waitcnt lgkmcnt(3)
    v_and_b32 v12, 0xffff0000, v11
    v_cvt_f32_i32 v24, v24
    v_cvt_f32_i32 v25, v25
    v_cvt_f32_i32 v26, v26
    v_cvt_f32_i32 v27, v27
    v_pk_add_f32 v[24:25], v[24:25], v[12:13] op_sel:[0,0] op_sel_hi:[1,0] neg_lo:[0,1] neg_hi:[0,1]
    v_pk_add_f32 v[26:27], v[26:27], v[12:13] op_sel:[0,0] op_sel_hi:[1,0] neg_lo:[0,1] neg_hi:[0,1]
    v_pk_mul_f32 v[16:17], v[24:25], v[36:37]
    v_pk_fma_f32 v[16:17], v[26:27], v[38:39], v[16:17]
    s_waitcnt lgkmcnt(2)
    v_cvt_f32_i32 v28, v28
    v_cvt_f32_i32 v29, v29
    v_cvt_f32_i32 v30, v30
    v_cvt_f32_i32 v31, v31
    v_pk_add_f32 v[28:29], v[28:29], v[12:13] op_sel:[0,0] op_sel_hi:[1,0] neg_lo:[0,1] neg_hi:[0,1]
    v_pk_add_f32 v[30:31], v[30:31], v[12:13] op_sel:[0,0] op_sel_hi:[1,0] neg_lo:[0,1] neg_hi:[0,1]
    v_pk_fma_f32 v[16:17], v[28:29], v[40:41], v[16:17]
    v_pk_fma_f32 v[16:17], v[30:31], v[42:43], v[16:17]
    s_waitcnt lgkmcnt(1)
    v_cvt_f32_i32 v32, v32
    v_cvt_f32_i32 v33, v33
    v_cvt_f32_i32 v34, v34
    v_cvt_f32_i32 v35, v35
    v_pk_add_f32 v[32:33], v[32:33], v[12:13] op_sel:[0,0] op_sel_hi:[1,0] neg_lo:[0,1] neg_hi:[0,1]
    v_pk_add_f32 v[34:35], v[34:35], v[12:13] op_sel:[0,0] op_sel_hi:[1,0] neg_lo:[0,1] neg_hi:[0,1]
    v_pk_fma_f32 v[16:17], v[32:33], v[44:45], v[16:17]
    v_pk_fma_f32 v[16:17], v[34:35], v[46:47], v[16:17]
    v_add_f32 v16, v16, v17
    v_cndmask_b32 v23, v10, v11, s[86:87]
    v_lshlrev_b32 v23, 16, v23
    v_add_f32_dpp v18, v16, v16 row_ror:8 row_mask:0xf bank_mask:0xc
    v_mul_f32 v23, 0x3dd53b95, v23
    s_nop 0
    v_add_f32_dpp v18, v18, v18 row_half_mirror row_mask:0xf bank_mask:0xf
    s_nop 1
    v_add_f32_dpp v18, v18, v18 quad_perm:[2,3,0,1] row_mask:0xf bank_mask:0xf
    s_nop 1
    v_add_f32_dpp v18, v18, v18 quad_perm:[1,0,3,2] row_mask:0xf bank_mask:0xf
    v_mul_f32 v18, v23, v18
    ds_write_b32 v4, v18 offset:256
    s_cmp_lg_u32 s81, 0
    s_cbranch_scc1 L_ncs3
    s_waitcnt vmcnt(6)
    v_perm_b32 v36, v110, v108, s83
    v_perm_b32 v110, v110, v108, s84
    v_perm_b32 v37, v111, v109, s83
    v_perm_b32 v111, v111, v109, s84
    v_perm_b32 v38, v114, v112, s83
    v_perm_b32 v114, v114, v112, s84
    v_perm_b32 v39, v115, v113, s83
    v_perm_b32 v115, v115, v113, s84
    v_perm_b32 v40, v118, v116, s83
    v_perm_b32 v118, v118, v116, s84
    v_perm_b32 v41, v119, v117, s83
    v_perm_b32 v119, v119, v117, s84
    v_mov_b64 v[108:109], v[36:37]
    v_mov_b64 v[112:113], v[38:39]
    v_mov_b64 v[116:117], v[40:41]
    s_mul_i32 s82, s89, 384
    s_add_u32 s89, s89, 2048
    s_and_b32 s89, s89, 16383
    buffer_load_dwordx2 v[132:133], v20, s[12:15], s82 offen offset:0
    buffer_load_dwordx2 v[134:135], v20, s[16:19], s82 offen offset:192
    buffer_load_dwordx2 v[136:137], v20, s[12:15], s82 offen offset:128
    buffer_load_dwordx2 v[138:139], v21, s[16:19], s82 offen
    buffer_load_dwordx2 v[140:141], v20, s[12:15], s82 offen offset:256
    buffer_load_dwordx2 v[142:143], v20, s[16:19], s82 offen offset:64
L_ncs3:
    v_dot2_f32_bf16 v36, v108, v48, 0
    v_dot2_f32_bf16 v37, v110, v49, 0
    v_dot2_f32_bf16 v38, v109, v50, 0
    v_dot2_f32_bf16 v39, v111, v51, 0
    v_dot2_f32_bf16 v40, v112, v52, 0
    v_dot2_f32_bf16 v41, v114, v53, 0
    v_dot2_f32_bf16 v42, v113, v54, 0
    v_dot2_f32_bf16 v43, v115, v55, 0
    v_dot2_f32_bf16 v44, v116, v56, 0
    v_dot2_f32_bf16 v45, v118, v57, 0
    v_dot2_f32_bf16 v46, v117, v58, 0
    v_dot2_f32_bf16 v47, v119, v59, 0
    s_add_u32 s79, s79, 12
    s_cmp_ge_i32 s80, s79
    s_cbranch_scc1 L_kr30g
L_kr30:
    ds_read_b32 v19, v7
    s_sleep 1
    s_waitcnt lgkmcnt(0)
    v_readlane_b32 s80, v19, 5
    s_nop 0
    s_cmp_lt_i32 s80, s79
    s_cbranch_scc1 L_kr30
L_kr30g:
    ds_read_b32 v10, v3 offset:384
    ds_read_b128 v[24:27], v2 offset:24576
    ds_read_b128 v[28:31], v2 offset:24832
    ds_read_b128 v[32:35], v2 offset:25088
    v_add_u32 v6, 1, v6
    ds_write_b32 v5, v6
    s_waitcnt lgkmcnt(3)
    v_and_b32 v12, 0xffff0000, v10
    v_cvt_f32_i32 v24, v24
    v_cvt_f32_i32 v25, v25
    v_cvt_f32_i32 v26, v26
    v_cvt_f32_i32 v27, v27
    v_pk_add_f32 v[24:25], v[24:25], v[12:13] op_sel:[0,0] op_sel_hi:[1,0] neg_lo:[0,1] neg_hi:[0,1]
    v_pk_add_f32 v[26:27], v[26:27], v[12:13] op_sel:[0,0] op_sel_hi:[1,0] neg_lo:[0,1] neg_hi:[0,1]
    v_pk_mul_f32 v[14:15], v[24:25], v[36:37]
    v_pk_fma_f32 v[14:15], v[26:27], v[38:39], v[14:15]
    s_waitcnt lgkmcnt(2)
    v_cvt_f32_i32 v28, v28
    v_cvt_f32_i32 v29, v29
    v_cvt_f32_i32 v30, v30
    v_cvt_f32_i32 v31, v31
    v_pk_add_f32 v[28:29], v[28:29], v[12:13] op_sel:[0,0] op_sel_hi:[1,0] neg_lo:[0,1] neg_hi:[0,1]
    v_pk_add_f32 v[30:31], v[30:31], v[12:13] op_sel:[0,0] op_sel_hi:[1,0] neg_lo:[0,1] neg_hi:[0,1]
    v_pk_fma_f32 v[14:15], v[28:29], v[40:41], v[14:15]
    v_pk_fma_f32 v[14:15], v[30:31], v[42:43], v[14:15]
    s_waitcnt lgkmcnt(1)
    v_cvt_f32_i32 v32, v32
    v_cvt_f32_i32 v33, v33
    v_cvt_f32_i32 v34, v34
    v_cvt_f32_i32 v35, v35
    v_pk_add_f32 v[32:33], v[32:33], v[12:13] op_sel:[0,0] op_sel_hi:[1,0] neg_lo:[0,1] neg_hi:[0,1]
    v_pk_add_f32 v[34:35], v[34:35], v[12:13] op_sel:[0,0] op_sel_hi:[1,0] neg_lo:[0,1] neg_hi:[0,1]
    v_pk_fma_f32 v[14:15], v[32:33], v[44:45], v[14:15]
    v_pk_fma_f32 v[14:15], v[34:35], v[46:47], v[14:15]
    v_add_f32 v14, v14, v15
    s_nop 1
    v_add_f32_dpp v18, v14, v14 row_ror:8 row_mask:0xf bank_mask:0x3
    v_dot2_f32_bf16 v36, v108, v60, 0
    v_dot2_f32_bf16 v37, v110, v61, 0
    v_dot2_f32_bf16 v38, v109, v62, 0
    v_dot2_f32_bf16 v39, v111, v63, 0
    v_dot2_f32_bf16 v40, v112, v64, 0
    v_dot2_f32_bf16 v41, v114, v65, 0
    v_dot2_f32_bf16 v42, v113, v66, 0
    v_dot2_f32_bf16 v43, v115, v67, 0
    v_dot2_f32_bf16 v44, v116, v68, 0
    v_dot2_f32_bf16 v45, v118, v69, 0
    v_dot2_f32_bf16 v46, v117, v70, 0
    v_dot2_f32_bf16 v47, v119, v71, 0
    s_add_u32 s79, s79, 12
    s_cmp_ge_i32 s80, s79
    s_cbranch_scc1 L_kr31g
L_kr31:
    ds_read_b32 v19, v7
    s_sleep 1
    s_waitcnt lgkmcnt(0)
    v_readlane_b32 s80, v19, 5
    s_nop 0
    s_cmp_lt_i32 s80, s79
    s_cbranch_scc1 L_kr31
L_kr31g:
    ds_read_b32 v11, v3 offset:1408
    ds_read_b128 v[24:27], v2 offset:36864
    ds_read_b128 v[28:31], v2 offset:37120
    ds_read_b128 v[32:35], v2 offset:37376
    v_add_u32 v6, 1, v6
    ds_write_b32 v5, v6
    s_waitcnt lgkmcnt(3)
    v_and_b32 v12, 0xffff0000, v11
    v_cvt_f32_i32 v24, v24
    v_cvt_f32_i32 v25, v25
    v_cvt_f32_i32 v26, v26
    v_cvt_f32_i32 v27, v27
    v_pk_add_f32 v[24:25], v[24:25], v[12:13] op_sel:[0,0] op_sel_hi:[1,0] neg_lo:[0,1] neg_hi:[0,1]
    v_pk_add_f32 v[26:27], v[26:27], v[12:13] op_sel:[0,0] op_sel_hi:[1,0] neg_lo:[0,1] neg_hi:[0,1]
    v_pk_mul_f32 v[16:17], v[24:25], v[36:37]
    v_pk_fma_f32 v[16:17], v[26:27], v[38:39], v[16:17]
    s_waitcnt lgkmcnt(2)
    v_cvt_f32_i32 v28, v28
    v_cvt_f32_i32 v29, v29
    v_cvt_f32_i32 v30, v30
    v_cvt_f32_i32 v31, v31
    v_pk_add_f32 v[28:29], v[28:29], v[12:13] op_sel:[0,0] op_sel_hi:[1,0] neg_lo:[0,1] neg_hi:[0,1]
    v_pk_add_f32 v[30:31], v[30:31], v[12:13] op_sel:[0,0] op_sel_hi:[1,0] neg_lo:[0,1] neg_hi:[0,1]
    v_pk_fma_f32 v[16:17], v[28:29], v[40:41], v[16:17]
    v_pk_fma_f32 v[16:17], v[30:31], v[42:43], v[16:17]
    s_waitcnt lgkmcnt(1)
    v_cvt_f32_i32 v32, v32
    v_cvt_f32_i32 v33, v33
    v_cvt_f32_i32 v34, v34
    v_cvt_f32_i32 v35, v35
    v_pk_add_f32 v[32:33], v[32:33], v[12:13] op_sel:[0,0] op_sel_hi:[1,0] neg_lo:[0,1] neg_hi:[0,1]
    v_pk_add_f32 v[34:35], v[34:35], v[12:13] op_sel:[0,0] op_sel_hi:[1,0] neg_lo:[0,1] neg_hi:[0,1]
    v_pk_fma_f32 v[16:17], v[32:33], v[44:45], v[16:17]
    v_pk_fma_f32 v[16:17], v[34:35], v[46:47], v[16:17]
    v_add_f32 v16, v16, v17
    v_cndmask_b32 v23, v10, v11, s[86:87]
    v_lshlrev_b32 v23, 16, v23
    v_add_f32_dpp v18, v16, v16 row_ror:8 row_mask:0xf bank_mask:0xc
    v_mul_f32 v23, 0x3dd53b95, v23
    s_nop 0
    v_add_f32_dpp v18, v18, v18 row_half_mirror row_mask:0xf bank_mask:0xf
    s_nop 1
    v_add_f32_dpp v18, v18, v18 quad_perm:[2,3,0,1] row_mask:0xf bank_mask:0xf
    s_nop 1
    v_add_f32_dpp v18, v18, v18 quad_perm:[1,0,3,2] row_mask:0xf bank_mask:0xf
    v_mul_f32 v18, v23, v18
    ds_write_b32 v4, v18 offset:384
    s_cmp_lg_u32 s81, 0
    s_cbranch_scc1 L_ncs4
    s_waitcnt vmcnt(6)
    v_perm_b32 v36, v122, v120, s83
    v_perm_b32 v122, v122, v120, s84
    v_perm_b32 v37, v123, v121, s83
    v_perm_b32 v123, v123, v121, s84
    v_perm_b32 v38, v126, v124, s83
    v_perm_b32 v126, v126, v124, s84
    v_perm_b32 v39, v127, v125, s83
    v_perm_b32 v127, v127, v125, s84
    v_perm_b32 v40, v130, v128, s83
    v_perm_b32 v130, v130, v128, s84
    v_perm_b32 v41, v131, v129, s83
    v_perm_b32 v131, v131, v129, s84
    v_mov_b64 v[120:121], v[36:37]
    v_mov_b64 v[124:125], v[38:39]
    v_mov_b64 v[128:129], v[40:41]
    s_mul_i32 s82, s89, 384
    s_add_u32 s89, s89, 2048
    s_and_b32 s89, s89, 16383
    buffer_load_dwordx2 v[144:145], v20, s[12:15], s82 offen offset:0
    buffer_load_dwordx2 v[146:147], v20, s[16:19], s82 offen offset:192
    buffer_load_dwordx2 v[148:149], v20, s[12:15], s82 offen offset:128
    buffer_load_dwordx2 v[150:151], v21, s[16:19], s82 offen
    buffer_load_dwordx2 v[152:153], v20, s[12:15], s82 offen offset:256
    buffer_load_dwordx2 v[154:155], v20, s[16:19], s82 offen offset:64
L_ncs4:
    v_dot2_f32_bf16 v36, v120, v48, 0
    v_dot2_f32_bf16 v37, v122, v49, 0
    v_dot2_f32_bf16 v38, v121, v50, 0
    v_dot2_f32_bf16 v39, v123, v51, 0
    v_dot2_f32_bf16 v40, v124, v52, 0
    v_dot2_f32_bf16 v41, v126, v53, 0
    v_dot2_f32_bf16 v42, v125, v54, 0
    v_dot2_f32_bf16 v43, v127, v55, 0
    v_dot2_f32_bf16 v44, v128, v56, 0
    v_dot2_f32_bf16 v45, v130, v57, 0
    v_dot2_f32_bf16 v46, v129, v58, 0
    v_dot2_f32_bf16 v47, v131, v59, 0
    s_add_u32 s79, s79, 12
    s_cmp_ge_i32 s80, s79
    s_cbranch_scc1 L_kr40g
L_kr40:
    ds_read_b32 v19, v7
    s_sleep 1
    s_waitcnt lgkmcnt(0)
    v_readlane_b32 s80, v19, 5
    s_nop 0
    s_cmp_lt_i32 s80, s79
    s_cbranch_scc1 L_kr40
L_kr40g:
    ds_read_b32 v10, v3 offset:512
    ds_read_b128 v[24:27], v2 offset:0
    ds_read_b128 v[28:31], v2 offset:256
    ds_read_b128 v[32:35], v2 offset:512
    v_add_u32 v6, 1, v6
    ds_write_b32 v5, v6
    s_waitcnt lgkmcnt(3)
    v_and_b32 v12, 0xffff0000, v10
    v_cvt_f32_i32 v24, v24
    v_cvt_f32_i32 v25, v25
    v_cvt_f32_i32 v26, v26
    v_cvt_f32_i32 v27, v27
    v_pk_add_f32 v[24:25], v[24:25], v[12:13] op_sel:[0,0] op_sel_hi:[1,0] neg_lo:[0,1] neg_hi:[0,1]
    v_pk_add_f32 v[26:27], v[26:27], v[12:13] op_sel:[0,0] op_sel_hi:[1,0] neg_lo:[0,1] neg_hi:[0,1]
    v_pk_mul_f32 v[14:15], v[24:25], v[36:37]
    v_pk_fma_f32 v[14:15], v[26:27], v[38:39], v[14:15]
    s_waitcnt lgkmcnt(2)
    v_cvt_f32_i32 v28, v28
    v_cvt_f32_i32 v29, v29
    v_cvt_f32_i32 v30, v30
    v_cvt_f32_i32 v31, v31
    v_pk_add_f32 v[28:29], v[28:29], v[12:13] op_sel:[0,0] op_sel_hi:[1,0] neg_lo:[0,1] neg_hi:[0,1]
    v_pk_add_f32 v[30:31], v[30:31], v[12:13] op_sel:[0,0] op_sel_hi:[1,0] neg_lo:[0,1] neg_hi:[0,1]
    v_pk_fma_f32 v[14:15], v[28:29], v[40:41], v[14:15]
    v_pk_fma_f32 v[14:15], v[30:31], v[42:43], v[14:15]
    s_waitcnt lgkmcnt(1)
    v_cvt_f32_i32 v32, v32
    v_cvt_f32_i32 v33, v33
    v_cvt_f32_i32 v34, v34
    v_cvt_f32_i32 v35, v35
    v_pk_add_f32 v[32:33], v[32:33], v[12:13] op_sel:[0,0] op_sel_hi:[1,0] neg_lo:[0,1] neg_hi:[0,1]
    v_pk_add_f32 v[34:35], v[34:35], v[12:13] op_sel:[0,0] op_sel_hi:[1,0] neg_lo:[0,1] neg_hi:[0,1]
    v_pk_fma_f32 v[14:15], v[32:33], v[44:45], v[14:15]
    v_pk_fma_f32 v[14:15], v[34:35], v[46:47], v[14:15]
    v_add_f32 v14, v14, v15
    s_nop 1
    v_add_f32_dpp v18, v14, v14 row_ror:8 row_mask:0xf bank_mask:0x3
    v_dot2_f32_bf16 v36, v120, v60, 0
    v_dot2_f32_bf16 v37, v122, v61, 0
    v_dot2_f32_bf16 v38, v121, v62, 0
    v_dot2_f32_bf16 v39, v123, v63, 0
    v_dot2_f32_bf16 v40, v124, v64, 0
    v_dot2_f32_bf16 v41, v126, v65, 0
    v_dot2_f32_bf16 v42, v125, v66, 0
    v_dot2_f32_bf16 v43, v127, v67, 0
    v_dot2_f32_bf16 v44, v128, v68, 0
    v_dot2_f32_bf16 v45, v130, v69, 0
    v_dot2_f32_bf16 v46, v129, v70, 0
    v_dot2_f32_bf16 v47, v131, v71, 0
    s_add_u32 s79, s79, 12
    s_cmp_ge_i32 s80, s79
    s_cbranch_scc1 L_kr41g
L_kr41:
    ds_read_b32 v19, v7
    s_sleep 1
    s_waitcnt lgkmcnt(0)
    v_readlane_b32 s80, v19, 5
    s_nop 0
    s_cmp_lt_i32 s80, s79
    s_cbranch_scc1 L_kr41
L_kr41g:
    ds_read_b32 v11, v3 offset:1536
    ds_read_b128 v[24:27], v2 offset:12288
    ds_read_b128 v[28:31], v2 offset:12544
    ds_read_b128 v[32:35], v2 offset:12800
    v_add_u32 v6, 1, v6
    ds_write_b32 v5, v6
    s_waitcnt lgkmcnt(3)
    v_and_b32 v12, 0xffff0000, v11
    v_cvt_f32_i32 v24, v24
    v_cvt_f32_i32 v25, v25
    v_cvt_f32_i32 v26, v26
    v_cvt_f32_i32 v27, v27
    v_pk_add_f32 v[24:25], v[24:25], v[12:13] op_sel:[0,0] op_sel_hi:[1,0] neg_lo:[0,1] neg_hi:[0,1]
    v_pk_add_f32 v[26:27], v[26:27], v[12:13] op_sel:[0,0] op_sel_hi:[1,0] neg_lo:[0,1] neg_hi:[0,1]
    v_pk_mul_f32 v[16:17], v[24:25], v[36:37]
    v_pk_fma_f32 v[16:17], v[26:27], v[38:39], v[16:17]
    s_waitcnt lgkmcnt(2)
    v_cvt_f32_i32 v28, v28
    v_cvt_f32_i32 v29, v29
    v_cvt_f32_i32 v30, v30
    v_cvt_f32_i32 v31, v31
    v_pk_add_f32 v[28:29], v[28:29], v[12:13] op_sel:[0,0] op_sel_hi:[1,0] neg_lo:[0,1] neg_hi:[0,1]
    v_pk_add_f32 v[30:31], v[30:31], v[12:13] op_sel:[0,0] op_sel_hi:[1,0] neg_lo:[0,1] neg_hi:[0,1]
    v_pk_fma_f32 v[16:17], v[28:29], v[40:41], v[16:17]
    v_pk_fma_f32 v[16:17], v[30:31], v[42:43], v[16:17]
    s_waitcnt lgkmcnt(1)
    v_cvt_f32_i32 v32, v32
    v_cvt_f32_i32 v33, v33
    v_cvt_f32_i32 v34, v34
    v_cvt_f32_i32 v35, v35
    v_pk_add_f32 v[32:33], v[32:33], v[12:13] op_sel:[0,0] op_sel_hi:[1,0] neg_lo:[0,1] neg_hi:[0,1]
    v_pk_add_f32 v[34:35], v[34:35], v[12:13] op_sel:[0,0] op_sel_hi:[1,0] neg_lo:[0,1] neg_hi:[0,1]
    v_pk_fma_f32 v[16:17], v[32:33], v[44:45], v[16:17]
    v_pk_fma_f32 v[16:17], v[34:35], v[46:47], v[16:17]
    v_add_f32 v16, v16, v17
    v_cndmask_b32 v23, v10, v11, s[86:87]
    v_lshlrev_b32 v23, 16, v23
    v_add_f32_dpp v18, v16, v16 row_ror:8 row_mask:0xf bank_mask:0xc
    v_mul_f32 v23, 0x3dd53b95, v23
    s_nop 0
    v_add_f32_dpp v18, v18, v18 row_half_mirror row_mask:0xf bank_mask:0xf
    s_nop 1
    v_add_f32_dpp v18, v18, v18 quad_perm:[2,3,0,1] row_mask:0xf bank_mask:0xf
    s_nop 1
    v_add_f32_dpp v18, v18, v18 quad_perm:[1,0,3,2] row_mask:0xf bank_mask:0xf
    v_mul_f32 v18, v23, v18
    ds_write_b32 v4, v18 offset:512
    s_cmp_lg_u32 s81, 0
    s_cbranch_scc1 L_ncs5
    s_waitcnt vmcnt(6)
    v_perm_b32 v36, v134, v132, s83
    v_perm_b32 v134, v134, v132, s84
    v_perm_b32 v37, v135, v133, s83
    v_perm_b32 v135, v135, v133, s84
    v_perm_b32 v38, v138, v136, s83
    v_perm_b32 v138, v138, v136, s84
    v_perm_b32 v39, v139, v137, s83
    v_perm_b32 v139, v139, v137, s84
    v_perm_b32 v40, v142, v140, s83
    v_perm_b32 v142, v142, v140, s84
    v_perm_b32 v41, v143, v141, s83
    v_perm_b32 v143, v143, v141, s84
    v_mov_b64 v[132:133], v[36:37]
    v_mov_b64 v[136:137], v[38:39]
    v_mov_b64 v[140:141], v[40:41]
    s_mul_i32 s82, s89, 384
    s_add_u32 s89, s89, 2048
    s_and_b32 s89, s89, 16383
    buffer_load_dwordx2 v[156:157], v20, s[12:15], s82 offen offset:0
    buffer_load_dwordx2 v[158:159], v20, s[16:19], s82 offen offset:192
    buffer_load_dwordx2 v[160:161], v20, s[12:15], s82 offen offset:128
    buffer_load_dwordx2 v[162:163], v21, s[16:19], s82 offen
    buffer_load_dwordx2 v[164:165], v20, s[12:15], s82 offen offset:256
    buffer_load_dwordx2 v[166:167], v20, s[16:19], s82 offen offset:64
L_ncs5:
    v_dot2_f32_bf16 v36, v132, v48, 0
    v_dot2_f32_bf16 v37, v134, v49, 0
    v_dot2_f32_bf16 v38, v133, v50, 0
    v_dot2_f32_bf16 v39, v135, v51, 0
    v_dot2_f32_bf16 v40, v136, v52, 0
    v_dot2_f32_bf16 v41, v138, v53, 0
    v_dot2_f32_bf16 v42, v137, v54, 0
    v_dot2_f32_bf16 v43, v139, v55, 0
    v_dot2_f32_bf16 v44, v140, v56, 0
    v_dot2_f32_bf16 v45, v142, v57, 0
    v_dot2_f32_bf16 v46, v141, v58, 0
    v_dot2_f32_bf16 v47, v143, v59, 0
    s_add_u32 s79, s79, 12
    s_cmp_ge_i32 s80, s79
    s_cbranch_scc1 L_kr50g
L_kr50:
    ds_read_b32 v19, v7
    s_sleep 1
    s_waitcnt lgkmcnt(0)
    v_readlane_b32 s80, v19, 5
    s_nop 0
    s_cmp_lt_i32 s80, s79
    s_cbranch_scc1 L_kr50
L_kr50g:
    ds_read_b32 v10, v3 offset:640
    ds_read_b128 v[24:27], v2 offset:24576
    ds_read_b128 v[28:31], v2 offset:24832
    ds_read_b128 v[32:35], v2 offset:25088
    v_add_u32 v6, 1, v6
    ds_write_b32 v5, v6
    s_waitcnt lgkmcnt(3)
    v_and_b32 v12, 0xffff0000, v10
    v_cvt_f32_i32 v24, v24
    v_cvt_f32_i32 v25, v25
    v_cvt_f32_i32 v26, v26
    v_cvt_f32_i32 v27, v27
    v_pk_add_f32 v[24:25], v[24:25], v[12:13] op_sel:[0,0] op_sel_hi:[1,0] neg_lo:[0,1] neg_hi:[0,1]
    v_pk_add_f32 v[26:27], v[26:27], v[12:13] op_sel:[0,0] op_sel_hi:[1,0] neg_lo:[0,1] neg_hi:[0,1]
    v_pk_mul_f32 v[14:15], v[24:25], v[36:37]
    v_pk_fma_f32 v[14:15], v[26:27], v[38:39], v[14:15]
    s_waitcnt lgkmcnt(2)
    v_cvt_f32_i32 v28, v28
    v_cvt_f32_i32 v29, v29
    v_cvt_f32_i32 v30, v30
    v_cvt_f32_i32 v31, v31
    v_pk_add_f32 v[28:29], v[28:29], v[12:13] op_sel:[0,0] op_sel_hi:[1,0] neg_lo:[0,1] neg_hi:[0,1]
    v_pk_add_f32 v[30:31], v[30:31], v[12:13] op_sel:[0,0] op_sel_hi:[1,0] neg_lo:[0,1] neg_hi:[0,1]
    v_pk_fma_f32 v[14:15], v[28:29], v[40:41], v[14:15]
    v_pk_fma_f32 v[14:15], v[30:31], v[42:43], v[14:15]
    s_waitcnt lgkmcnt(1)
    v_cvt_f32_i32 v32, v32
    v_cvt_f32_i32 v33, v33
    v_cvt_f32_i32 v34, v34
    v_cvt_f32_i32 v35, v35
    v_pk_add_f32 v[32:33], v[32:33], v[12:13] op_sel:[0,0] op_sel_hi:[1,0] neg_lo:[0,1] neg_hi:[0,1]
    v_pk_add_f32 v[34:35], v[34:35], v[12:13] op_sel:[0,0] op_sel_hi:[1,0] neg_lo:[0,1] neg_hi:[0,1]
    v_pk_fma_f32 v[14:15], v[32:33], v[44:45], v[14:15]
    v_pk_fma_f32 v[14:15], v[34:35], v[46:47], v[14:15]
    v_add_f32 v14, v14, v15
    s_nop 1
    v_add_f32_dpp v18, v14, v14 row_ror:8 row_mask:0xf bank_mask:0x3
    v_dot2_f32_bf16 v36, v132, v60, 0
    v_dot2_f32_bf16 v37, v134, v61, 0
    v_dot2_f32_bf16 v38, v133, v62, 0
    v_dot2_f32_bf16 v39, v135, v63, 0
    v_dot2_f32_bf16 v40, v136, v64, 0
    v_dot2_f32_bf16 v41, v138, v65, 0
    v_dot2_f32_bf16 v42, v137, v66, 0
    v_dot2_f32_bf16 v43, v139, v67, 0
    v_dot2_f32_bf16 v44, v140, v68, 0
    v_dot2_f32_bf16 v45, v142, v69, 0
    v_dot2_f32_bf16 v46, v141, v70, 0
    v_dot2_f32_bf16 v47, v143, v71, 0
    s_add_u32 s79, s79, 12
    s_cmp_ge_i32 s80, s79
    s_cbranch_scc1 L_kr51g
L_kr51:
    ds_read_b32 v19, v7
    s_sleep 1
    s_waitcnt lgkmcnt(0)
    v_readlane_b32 s80, v19, 5
    s_nop 0
    s_cmp_lt_i32 s80, s79
    s_cbranch_scc1 L_kr51
L_kr51g:
    ds_read_b32 v11, v3 offset:1664
    ds_read_b128 v[24:27], v2 offset:36864
    ds_read_b128 v[28:31], v2 offset:37120
    ds_read_b128 v[32:35], v2 offset:37376
    v_add_u32 v6, 1, v6
    ds_write_b32 v5, v6
    s_waitcnt lgkmcnt(3)
    v_and_b32 v12, 0xffff0000, v11
    v_cvt_f32_i32 v24, v24
    v_cvt_f32_i32 v25, v25
    v_cvt_f32_i32 v26, v26
    v_cvt_f32_i32 v27, v27
    v_pk_add_f32 v[24:25], v[24:25], v[12:13] op_sel:[0,0] op_sel_hi:[1,0] neg_lo:[0,1] neg_hi:[0,1]
    v_pk_add_f32 v[26:27], v[26:27], v[12:13] op_sel:[0,0] op_sel_hi:[1,0] neg_lo:[0,1] neg_hi:[0,1]
    v_pk_mul_f32 v[16:17], v[24:25], v[36:37]
    v_pk_fma_f32 v[16:17], v[26:27], v[38:39], v[16:17]
    s_waitcnt lgkmcnt(2)
    v_cvt_f32_i32 v28, v28
    v_cvt_f32_i32 v29, v29
    v_cvt_f32_i32 v30, v30
    v_cvt_f32_i32 v31, v31
    v_pk_add_f32 v[28:29], v[28:29], v[12:13] op_sel:[0,0] op_sel_hi:[1,0] neg_lo:[0,1] neg_hi:[0,1]
    v_pk_add_f32 v[30:31], v[30:31], v[12:13] op_sel:[0,0] op_sel_hi:[1,0] neg_lo:[0,1] neg_hi:[0,1]
    v_pk_fma_f32 v[16:17], v[28:29], v[40:41], v[16:17]
    v_pk_fma_f32 v[16:17], v[30:31], v[42:43], v[16:17]
    s_waitcnt lgkmcnt(1)
    v_cvt_f32_i32 v32, v32
    v_cvt_f32_i32 v33, v33
    v_cvt_f32_i32 v34, v34
    v_cvt_f32_i32 v35, v35
    v_pk_add_f32 v[32:33], v[32:33], v[12:13] op_sel:[0,0] op_sel_hi:[1,0] neg_lo:[0,1] neg_hi:[0,1]
    v_pk_add_f32 v[34:35], v[34:35], v[12:13] op_sel:[0,0] op_sel_hi:[1,0] neg_lo:[0,1] neg_hi:[0,1]
    v_pk_fma_f32 v[16:17], v[32:33], v[44:45], v[16:17]
    v_pk_fma_f32 v[16:17], v[34:35], v[46:47], v[16:17]
    v_add_f32 v16, v16, v17
    v_cndmask_b32 v23, v10, v11, s[86:87]
    v_lshlrev_b32 v23, 16, v23
    v_add_f32_dpp v18, v16, v16 row_ror:8 row_mask:0xf bank_mask:0xc
    v_mul_f32 v23, 0x3dd53b95, v23
    s_nop 0
    v_add_f32_dpp v18, v18, v18 row_half_mirror row_mask:0xf bank_mask:0xf
    s_nop 1
    v_add_f32_dpp v18, v18, v18 quad_perm:[2,3,0,1] row_mask:0xf bank_mask:0xf
    s_nop 1
    v_add_f32_dpp v18, v18, v18 quad_perm:[1,0,3,2] row_mask:0xf bank_mask:0xf
    v_mul_f32 v18, v23, v18
    ds_write_b32 v4, v18 offset:640
    s_cmp_lg_u32 s81, 0
    s_cbranch_scc1 L_ncs6
    s_waitcnt vmcnt(6)
    v_perm_b32 v36, v146, v144, s83
    v_perm_b32 v146, v146, v144, s84
    v_perm_b32 v37, v147, v145, s83
    v_perm_b32 v147, v147, v145, s84
    v_perm_b32 v38, v150, v148, s83
    v_perm_b32 v150, v150, v148, s84
    v_perm_b32 v39, v151, v149, s83
    v_perm_b32 v151, v151, v149, s84
    v_perm_b32 v40, v154, v152, s83
    v_perm_b32 v154, v154, v152, s84
    v_perm_b32 v41, v155, v153, s83
    v_perm_b32 v155, v155, v153, s84
    v_mov_b64 v[144:145], v[36:37]
    v_mov_b64 v[148:149], v[38:39]
    v_mov_b64 v[152:153], v[40:41]
    s_nop 1
L_ncs6:
    v_dot2_f32_bf16 v36, v144, v48, 0
    v_dot2_f32_bf16 v37, v146, v49, 0
    v_dot2_f32_bf16 v38, v145, v50, 0
    v_dot2_f32_bf16 v39, v147, v51, 0
    v_dot2_f32_bf16 v40, v148, v52, 0
    v_dot2_f32_bf16 v41, v150, v53, 0
    v_dot2_f32_bf16 v42, v149, v54, 0
    v_dot2_f32_bf16 v43, v151, v55, 0
    v_dot2_f32_bf16 v44, v152, v56, 0
    v_dot2_f32_bf16 v45, v154, v57, 0
    v_dot2_f32_bf16 v46, v153, v58, 0
    v_dot2_f32_bf16 v47, v155, v59, 0
    s_add_u32 s79, s79, 12
    s_cmp_ge_i32 s80, s79
    s_cbranch_scc1 L_kr60g
L_kr60:
    ds_read_b32 v19, v7
    s_sleep 1
    s_waitcnt lgkmcnt(0)
    v_readlane_b32 s80, v19, 5
    s_nop 0
    s_cmp_lt_i32 s80, s79
    s_cbranch_scc1 L_kr60
L_kr60g:
    ds_read_b32 v10, v3 offset:768
    ds_read_b128 v[24:27], v2 offset:0
    ds_read_b128 v[28:31], v2 offset:256
    ds_read_b128 v[32:35], v2 offset:512
    v_add_u32 v6, 1, v6
    ds_write_b32 v5, v6
    s_waitcnt lgkmcnt(3)
    v_and_b32 v12, 0xffff0000, v10
    v_cvt_f32_i32 v24, v24
    v_cvt_f32_i32 v25, v25
    v_cvt_f32_i32 v26, v26
    v_cvt_f32_i32 v27, v27
    v_pk_add_f32 v[24:25], v[24:25], v[12:13] op_sel:[0,0] op_sel_hi:[1,0] neg_lo:[0,1] neg_hi:[0,1]
    v_pk_add_f32 v[26:27], v[26:27], v[12:13] op_sel:[0,0] op_sel_hi:[1,0] neg_lo:[0,1] neg_hi:[0,1]
    v_pk_mul_f32 v[14:15], v[24:25], v[36:37]
    v_pk_fma_f32 v[14:15], v[26:27], v[38:39], v[14:15]
    s_waitcnt lgkmcnt(2)
    v_cvt_f32_i32 v28, v28
    v_cvt_f32_i32 v29, v29
    v_cvt_f32_i32 v30, v30
    v_cvt_f32_i32 v31, v31
    v_pk_add_f32 v[28:29], v[28:29], v[12:13] op_sel:[0,0] op_sel_hi:[1,0] neg_lo:[0,1] neg_hi:[0,1]
    v_pk_add_f32 v[30:31], v[30:31], v[12:13] op_sel:[0,0] op_sel_hi:[1,0] neg_lo:[0,1] neg_hi:[0,1]
    v_pk_fma_f32 v[14:15], v[28:29], v[40:41], v[14:15]
    v_pk_fma_f32 v[14:15], v[30:31], v[42:43], v[14:15]
    s_waitcnt lgkmcnt(1)
    v_cvt_f32_i32 v32, v32
    v_cvt_f32_i32 v33, v33
    v_cvt_f32_i32 v34, v34
    v_cvt_f32_i32 v35, v35
    v_pk_add_f32 v[32:33], v[32:33], v[12:13] op_sel:[0,0] op_sel_hi:[1,0] neg_lo:[0,1] neg_hi:[0,1]
    v_pk_add_f32 v[34:35], v[34:35], v[12:13] op_sel:[0,0] op_sel_hi:[1,0] neg_lo:[0,1] neg_hi:[0,1]
    v_pk_fma_f32 v[14:15], v[32:33], v[44:45], v[14:15]
    v_pk_fma_f32 v[14:15], v[34:35], v[46:47], v[14:15]
    v_add_f32 v14, v14, v15
    s_nop 1
    v_add_f32_dpp v18, v14, v14 row_ror:8 row_mask:0xf bank_mask:0x3
    v_dot2_f32_bf16 v36, v144, v60, 0
    v_dot2_f32_bf16 v37, v146, v61, 0
    v_dot2_f32_bf16 v38, v145, v62, 0
    v_dot2_f32_bf16 v39, v147, v63, 0
    v_dot2_f32_bf16 v40, v148, v64, 0
    v_dot2_f32_bf16 v41, v150, v65, 0
    v_dot2_f32_bf16 v42, v149, v66, 0
    v_dot2_f32_bf16 v43, v151, v67, 0
    v_dot2_f32_bf16 v44, v152, v68, 0
    v_dot2_f32_bf16 v45, v154, v69, 0
    v_dot2_f32_bf16 v46, v153, v70, 0
    v_dot2_f32_bf16 v47, v155, v71, 0
    s_add_u32 s79, s79, 12
    s_cmp_ge_i32 s80, s79
    s_cbranch_scc1 L_kr61g
L_kr61:
    ds_read_b32 v19, v7
    s_sleep 1
    s_waitcnt lgkmcnt(0)
    v_readlane_b32 s80, v19, 5
    s_nop 0
    s_cmp_lt_i32 s80, s79
    s_cbranch_scc1 L_kr61
L_kr61g:
    ds_read_b32 v11, v3 offset:1792
    ds_read_b128 v[24:27], v2 offset:12288
    ds_read_b128 v[28:31], v2 offset:12544
    ds_read_b128 v[32:35], v2 offset:12800
    v_add_u32 v6, 1, v6
    ds_write_b32 v5, v6
    s_waitcnt lgkmcnt(3)
    v_and_b32 v12, 0xffff0000, v11
    v_cvt_f32_i32 v24, v24
    v_cvt_f32_i32 v25, v25
    v_cvt_f32_i32 v26, v26
    v_cvt_f32_i32 v27, v27
    v_pk_add_f32 v[24:25], v[24:25], v[12:13] op_sel:[0,0] op_sel_hi:[1,0] neg_lo:[0,1] neg_hi:[0,1]
    v_pk_add_f32 v[26:27], v[26:27], v[12:13] op_sel:[0,0] op_sel_hi:[1,0] neg_lo:[0,1] neg_hi:[0,1]
    v_pk_mul_f32 v[16:17], v[24:25], v[36:37]
    v_pk_fma_f32 v[16:17], v[26:27], v[38:39], v[16:17]
    s_waitcnt lgkmcnt(2)
    v_cvt_f32_i32 v28, v28
    v_cvt_f32_i32 v29, v29
    v_cvt_f32_i32 v30, v30
    v_cvt_f32_i32 v31, v31
    v_pk_add_f32 v[28:29], v[28:29], v[12:13] op_sel:[0,0] op_sel_hi:[1,0] neg_lo:[0,1] neg_hi:[0,1]
    v_pk_add_f32 v[30:31], v[30:31], v[12:13] op_sel:[0,0] op_sel_hi:[1,0] neg_lo:[0,1] neg_hi:[0,1]
    v_pk_fma_f32 v[16:17], v[28:29], v[40:41], v[16:17]
    v_pk_fma_f32 v[16:17], v[30:31], v[42:43], v[16:17]
    s_waitcnt lgkmcnt(1)
    v_cvt_f32_i32 v32, v32
    v_cvt_f32_i32 v33, v33
    v_cvt_f32_i32 v34, v34
    v_cvt_f32_i32 v35, v35
    v_pk_add_f32 v[32:33], v[32:33], v[12:13] op_sel:[0,0] op_sel_hi:[1,0] neg_lo:[0,1] neg_hi:[0,1]
    v_pk_add_f32 v[34:35], v[34:35], v[12:13] op_sel:[0,0] op_sel_hi:[1,0] neg_lo:[0,1] neg_hi:[0,1]
    v_pk_fma_f32 v[16:17], v[32:33], v[44:45], v[16:17]
    v_pk_fma_f32 v[16:17], v[34:35], v[46:47], v[16:17]
    v_add_f32 v16, v16, v17
    v_cndmask_b32 v23, v10, v11, s[86:87]
    v_lshlrev_b32 v23, 16, v23
    v_add_f32_dpp v18, v16, v16 row_ror:8 row_mask:0xf bank_mask:0xc
    v_mul_f32 v23, 0x3dd53b95, v23
    s_nop 0
    v_add_f32_dpp v18, v18, v18 row_half_mirror row_mask:0xf bank_mask:0xf
    s_nop 1
    v_add_f32_dpp v18, v18, v18 quad_perm:[2,3,0,1] row_mask:0xf bank_mask:0xf
    s_nop 1
    v_add_f32_dpp v18, v18, v18 quad_perm:[1,0,3,2] row_mask:0xf bank_mask:0xf
    v_mul_f32 v18, v23, v18
    ds_write_b32 v4, v18 offset:768
    s_cmp_lg_u32 s81, 0
    s_cbranch_scc1 L_ncs7
    s_waitcnt vmcnt(0)
    v_perm_b32 v36, v158, v156, s83
    v_perm_b32 v158, v158, v156, s84
    v_perm_b32 v37, v159, v157, s83
    v_perm_b32 v159, v159, v157, s84
    v_perm_b32 v38, v162, v160, s83
    v_perm_b32 v162, v162, v160, s84
    v_perm_b32 v39, v163, v161, s83
    v_perm_b32 v163, v163, v161, s84
    v_perm_b32 v40, v166, v164, s83
    v_perm_b32 v166, v166, v164, s84
    v_perm_b32 v41, v167, v165, s83
    v_perm_b32 v167, v167, v165, s84
    v_mov_b64 v[156:157], v[36:37]
    v_mov_b64 v[160:161], v[38:39]
    v_mov_b64 v[164:165], v[40:41]
    s_nop 1
L_ncs7:
    v_dot2_f32_bf16 v36, v156, v48, 0
    v_dot2_f32_bf16 v37, v158, v49, 0
    v_dot2_f32_bf16 v38, v157, v50, 0
    v_dot2_f32_bf16 v39, v159, v51, 0
    v_dot2_f32_bf16 v40, v160, v52, 0
    v_dot2_f32_bf16 v41, v162, v53, 0
    v_dot2_f32_bf16 v42, v161, v54, 0
    v_dot2_f32_bf16 v43, v163, v55, 0
    v_dot2_f32_bf16 v44, v164, v56, 0
    v_dot2_f32_bf16 v45, v166, v57, 0
    v_dot2_f32_bf16 v46, v165, v58, 0
    v_dot2_f32_bf16 v47, v167, v59, 0
    s_add_u32 s79, s79, 12
    s_cmp_ge_i32 s80, s79
    s_cbranch_scc1 L_kr70g
L_kr70:
    ds_read_b32 v19, v7
    s_sleep 1
    s_waitcnt lgkmcnt(0)
    v_readlane_b32 s80, v19, 5
    s_nop 0
    s_cmp_lt_i32 s80, s79
    s_cbranch_scc1 L_kr70
L_kr70g:
    ds_read_b32 v10, v3 offset:896
    ds_read_b128 v[24:27], v2 offset:24576
    ds_read_b128 v[28:31], v2 offset:24832
    ds_read_b128 v[32:35], v2 offset:25088
    v_add_u32 v6, 1, v6
    ds_write_b32 v5, v6
    s_waitcnt lgkmcnt(3)
    v_and_b32 v12, 0xffff0000, v10
    v_cvt_f32_i32 v24, v24
    v_cvt_f32_i32 v25, v25
    v_cvt_f32_i32 v26, v26
    v_cvt_f32_i32 v27, v27
    v_pk_add_f32 v[24:25], v[24:25], v[12:13] op_sel:[0,0] op_sel_hi:[1,0] neg_lo:[0,1] neg_hi:[0,1]
    v_pk_add_f32 v[26:27], v[26:27], v[12:13] op_sel:[0,0] op_sel_hi:[1,0] neg_lo:[0,1] neg_hi:[0,1]
    v_pk_mul_f32 v[14:15], v[24:25], v[36:37]
    v_pk_fma_f32 v[14:15], v[26:27], v[38:39], v[14:15]
    s_waitcnt lgkmcnt(2)
    v_cvt_f32_i32 v28, v28
    v_cvt_f32_i32 v29, v29
    v_cvt_f32_i32 v30, v30
    v_cvt_f32_i32 v31, v31
    v_pk_add_f32 v[28:29], v[28:29], v[12:13] op_sel:[0,0] op_sel_hi:[1,0] neg_lo:[0,1] neg_hi:[0,1]
    v_pk_add_f32 v[30:31], v[30:31], v[12:13] op_sel:[0,0] op_sel_hi:[1,0] neg_lo:[0,1] neg_hi:[0,1]
    v_pk_fma_f32 v[14:15], v[28:29], v[40:41], v[14:15]
    v_pk_fma_f32 v[14:15], v[30:31], v[42:43], v[14:15]
    s_waitcnt lgkmcnt(1)
    v_cvt_f32_i32 v32, v32
    v_cvt_f32_i32 v33, v33
    v_cvt_f32_i32 v34, v34
    v_cvt_f32_i32 v35, v35
    v_pk_add_f32 v[32:33], v[32:33], v[12:13] op_sel:[0,0] op_sel_hi:[1,0] neg_lo:[0,1] neg_hi:[0,1]
    v_pk_add_f32 v[34:35], v[34:35], v[12:13] op_sel:[0,0] op_sel_hi:[1,0] neg_lo:[0,1] neg_hi:[0,1]
    v_pk_fma_f32 v[14:15], v[32:33], v[44:45], v[14:15]
    v_pk_fma_f32 v[14:15], v[34:35], v[46:47], v[14:15]
    v_add_f32 v14, v14, v15
    s_nop 1
    v_add_f32_dpp v18, v14, v14 row_ror:8 row_mask:0xf bank_mask:0x3
    v_dot2_f32_bf16 v36, v156, v60, 0
    v_dot2_f32_bf16 v37, v158, v61, 0
    v_dot2_f32_bf16 v38, v157, v62, 0
    v_dot2_f32_bf16 v39, v159, v63, 0
    v_dot2_f32_bf16 v40, v160, v64, 0
    v_dot2_f32_bf16 v41, v162, v65, 0
    v_dot2_f32_bf16 v42, v161, v66, 0
    v_dot2_f32_bf16 v43, v163, v67, 0
    v_dot2_f32_bf16 v44, v164, v68, 0
    v_dot2_f32_bf16 v45, v166, v69, 0
    v_dot2_f32_bf16 v46, v165, v70, 0
    v_dot2_f32_bf16 v47, v167, v71, 0
    s_add_u32 s79, s79, 12
    s_cmp_ge_i32 s80, s79
    s_cbranch_scc1 L_kr71g
L_kr71:
    ds_read_b32 v19, v7
    s_sleep 1
    s_waitcnt lgkmcnt(0)
    v_readlane_b32 s80, v19, 5
    s_nop 0
    s_cmp_lt_i32 s80, s79
    s_cbranch_scc1 L_kr71
L_kr71g:
    ds_read_b32 v11, v3 offset:1920
    ds_read_b128 v[24:27], v2 offset:36864
    ds_read_b128 v[28:31], v2 offset:37120
    ds_read_b128 v[32:35], v2 offset:37376
    v_add_u32 v6, 1, v6
    ds_write_b32 v5, v6
    s_waitcnt lgkmcnt(3)
    v_and_b32 v12, 0xffff0000, v11
    v_cvt_f32_i32 v24, v24
    v_cvt_f32_i32 v25, v25
    v_cvt_f32_i32 v26, v26
    v_cvt_f32_i32 v27, v27
    v_pk_add_f32 v[24:25], v[24:25], v[12:13] op_sel:[0,0] op_sel_hi:[1,0] neg_lo:[0,1] neg_hi:[0,1]
    v_pk_add_f32 v[26:27], v[26:27], v[12:13] op_sel:[0,0] op_sel_hi:[1,0] neg_lo:[0,1] neg_hi:[0,1]
    v_pk_mul_f32 v[16:17], v[24:25], v[36:37]
    v_pk_fma_f32 v[16:17], v[26:27], v[38:39], v[16:17]
    s_waitcnt lgkmcnt(2)
    v_cvt_f32_i32 v28, v28
    v_cvt_f32_i32 v29, v29
    v_cvt_f32_i32 v30, v30
    v_cvt_f32_i32 v31, v31
    v_pk_add_f32 v[28:29], v[28:29], v[12:13] op_sel:[0,0] op_sel_hi:[1,0] neg_lo:[0,1] neg_hi:[0,1]
    v_pk_add_f32 v[30:31], v[30:31], v[12:13] op_sel:[0,0] op_sel_hi:[1,0] neg_lo:[0,1] neg_hi:[0,1]
    v_pk_fma_f32 v[16:17], v[28:29], v[40:41], v[16:17]
    v_pk_fma_f32 v[16:17], v[30:31], v[42:43], v[16:17]
    s_waitcnt lgkmcnt(1)
    v_cvt_f32_i32 v32, v32
    v_cvt_f32_i32 v33, v33
    v_cvt_f32_i32 v34, v34
    v_cvt_f32_i32 v35, v35
    v_pk_add_f32 v[32:33], v[32:33], v[12:13] op_sel:[0,0] op_sel_hi:[1,0] neg_lo:[0,1] neg_hi:[0,1]
    v_pk_add_f32 v[34:35], v[34:35], v[12:13] op_sel:[0,0] op_sel_hi:[1,0] neg_lo:[0,1] neg_hi:[0,1]
    v_pk_fma_f32 v[16:17], v[32:33], v[44:45], v[16:17]
    v_pk_fma_f32 v[16:17], v[34:35], v[46:47], v[16:17]
    v_add_f32 v16, v16, v17
    v_cndmask_b32 v23, v10, v11, s[86:87]
    v_lshlrev_b32 v23, 16, v23
    v_add_f32_dpp v18, v16, v16 row_ror:8 row_mask:0xf bank_mask:0xc
    v_mul_f32 v23, 0x3dd53b95, v23
    s_nop 0
    v_add_f32_dpp v18, v18, v18 row_half_mirror row_mask:0xf bank_mask:0xf
    s_nop 1
    v_add_f32_dpp v18, v18, v18 quad_perm:[2,3,0,1] row_mask:0xf bank_mask:0xf
    s_nop 1
    v_add_f32_dpp v18, v18, v18 quad_perm:[1,0,3,2] row_mask:0xf bank_mask:0xf
    v_mul_f32 v18, v23, v18
    ds_write_b32 v4, v18 offset:896
    s_mov_b64 exec, 1
    ds_add_u32 v22, v8
    s_mov_b64 exec, -1
    v_add_u32 v22, 4, v22
    v_add_u32 v3, 2048, v3
    v_add_u32 v4, 2048, v4
    s_add_u32 s81, s81, 1
    s_cmp_lt_u32 s81, 8
    s_cbranch_scc1 L_kph
    v_subrev_u32 v3, 16384, v3
    s_mul_i32 s92, s78, 1536
    s_add_u32 s92, s92, 65536
    v_and_b32 v18, 15, v1
    v_lshl_add_u32 v9, v18, 4, s92
    v_lshrrev_b32 v18, 4, v1
    v_lshl_add_u32 v9, v18, 2, v9
    v_mov_b32 v12, 16
    s_mov_b32 s20, s74
    s_mov_b32 s21, s75
    s_mov_b32 s22, 1610612736
    s_mov_b32 s23, 0x20000
    s_mov_b32 s28, s70
    s_mov_b32 s29, s71
    s_mov_b32 s30, 12288
    s_mov_b32 s31, 0x20000
    s_mul_i32 s92, s2, 43691
    s_lshr_b32 s92, s92, 18
    s_mul_i32 s93, s92, 6
    s_sub_u32 s93, s2, s93
    s_lshl2_add_u32 s94, s92, s78
    s_mul_i32 s32, s94, 24576
    s_lshl_b32 s94, s93, 7
    s_add_u32 s32, s32, s94
    s_add_u32 s33, s32, 6144
    s_add_u32 s34, s33, 6144
    s_add_u32 s35, s34, 6144
    s_lshl_b32 s36, s2, 6
    v_lshrrev_b32 v19, 3, v1
    v_and_b32 v69, 7, v1
    v_mul_u32_u24 v68, 768, v19
    v_lshl_add_u32 v68, v69, 4, v68
    v_lshlrev_b32 v69, 3, v69
    v_lshl_add_u32 v69, v18, 1, v69
    s_lshl4_add_u32 s92, s78, 78336
    v_lshl_add_u32 v70, v19, 6, s92
    s_lshl_b32 s92, s78, 8
    s_add_u32 s92, s92, 1024
    v_add_u32 v4, s92, v7
    s_mov_b32 s81, 0
    s_nop 0
L_vph:
    v_mov_b64 v[72:73], 0
    v_mov_b64 v[74:75], 0
    v_mov_b64 v[76:77], 0
    v_mov_b64 v[78:79], 0
    v_mov_b64 v[80:81], 0
    v_mov_b64 v[82:83], 0
    v_mov_b64 v[84:85], 0
    v_mov_b64 v[86:87], 0
    v_mov_b64 v[88:89], 0
    v_mov_b64 v[90:91], 0
    v_mov_b64 v[92:93], 0
    v_mov_b64 v[94:95], 0
    s_mov_b32 s88, 0
    s_nop 0
L_vw:
    ds_read_b32 v19, v7
    s_waitcnt lgkmcnt(0)
    v_readlane_b32 s92, v19, 15
    v_readlane_b32 s93, v19, 13
    s_add_u32 s92, s92, 2
    s_min_u32 s93, s93, s92
    s_cmp_le_u32 s93, s81
    s_nop 1
    s_cbranch_scc1 L_vw
    s_cmp_lg_u32 s81, 7
    s_cbranch_scc1 L_vit
    v_readlane_b32 s4, v19, 6
    s_cmp_ge_u32 s2, 192
    s_nop 3
    s_cbranch_scc1 L_vit
    s_cmp_eq_u32 s4, 0
    s_cbranch_scc1 L_vw
    ds_read_b128 v[64:67], v70
    s_lshr_b32 s5, s4, 8
    s_lshr_b32 s6, s4, 16
    s_lshr_b32 s7, s4, 24
L_vit:
    s_add_u32 s79, s79, 12
    s_cmp_ge_i32 s80, s79
    s_cbranch_scc1 L_vr00g
L_vr00:
    ds_read_b32 v19, v7
    s_sleep 1
    s_waitcnt lgkmcnt(0)
    v_readlane_b32 s80, v19, 5
    s_nop 0
    s_cmp_lt_i32 s80, s79
    s_cbranch_scc1 L_vr00
L_vr00g:
    ds_read_b32 v10, v3 offset:0
    ds_read_b128 v[24:27], v2 offset:0
    ds_read_b128 v[28:31], v2 offset:256
    ds_read_b128 v[32:35], v2 offset:512
    v_add_u32 v6, 1, v6
    ds_write_b32 v5, v6
    s_waitcnt lgkmcnt(3)
    v_cvt_f32_i32 v24, v24
    v_cvt_f32_i32 v25, v25
    v_cvt_f32_i32 v26, v26
    v_cvt_f32_i32 v27, v27
    v_pk_fma_f32 v[72:73], v[24:25], v[10:11], v[72:73] op_sel:[0,0,0] op_sel_hi:[1,0,1]
    v_pk_fma_f32 v[74:75], v[26:27], v[10:11], v[74:75] op_sel:[0,0,0] op_sel_hi:[1,0,1]
    s_waitcnt lgkmcnt(2)
    v_cvt_f32_i32 v28, v28
    v_cvt_f32_i32 v29, v29
    v_cvt_f32_i32 v30, v30
    v_cvt_f32_i32 v31, v31
    v_pk_fma_f32 v[76:77], v[28:29], v[10:11], v[76:77] op_sel:[0,0,0] op_sel_hi:[1,0,1]
    v_pk_fma_f32 v[78:79], v[30:31], v[10:11], v[78:79] op_sel:[0,0,0] op_sel_hi:[1,0,1]
    s_waitcnt lgkmcnt(1)
    v_cvt_f32_i32 v32, v32
    v_cvt_f32_i32 v33, v33
    v_cvt_f32_i32 v34, v34
    v_cvt_f32_i32 v35, v35
    v_pk_fma_f32 v[80:81], v[32:33], v[10:11], v[80:81] op_sel:[0,0,0] op_sel_hi:[1,0,1]
    v_pk_fma_f32 v[82:83], v[34:35], v[10:11], v[82:83] op_sel:[0,0,0] op_sel_hi:[1,0,1]
    s_add_u32 s79, s79, 12
    s_cmp_ge_i32 s80, s79
    s_cbranch_scc1 L_vr01g
L_vr01:
    ds_read_b32 v19, v7
    s_sleep 1
    s_waitcnt lgkmcnt(0)
    v_readlane_b32 s80, v19, 5
    s_nop 0
    s_cmp_lt_i32 s80, s79
    s_cbranch_scc1 L_vr01
L_vr01g:
    ds_read_b32 v10, v3 offset:1024
    ds_read_b128 v[24:27], v2 offset:12288
    ds_read_b128 v[28:31], v2 offset:12544
    ds_read_b128 v[32:35], v2 offset:12800
    v_add_u32 v6, 1, v6
    ds_write_b32 v5, v6
    s_waitcnt lgkmcnt(3)
    v_cvt_f32_i32 v24, v24
    v_cvt_f32_i32 v25, v25
    v_cvt_f32_i32 v26, v26
    v_cvt_f32_i32 v27, v27
    v_pk_fma_f32 v[84:85], v[24:25], v[10:11], v[84:85] op_sel:[0,0,0] op_sel_hi:[1,0,1]
    v_pk_fma_f32 v[86:87], v[26:27], v[10:11], v[86:87] op_sel:[0,0,0] op_sel_hi:[1,0,1]
    s_waitcnt lgkmcnt(2)
    v_cvt_f32_i32 v28, v28
    v_cvt_f32_i32 v29, v29
    v_cvt_f32_i32 v30, v30
    v_cvt_f32_i32 v31, v31
    v_pk_fma_f32 v[88:89], v[28:29], v[10:11], v[88:89] op_sel:[0,0,0] op_sel_hi:[1,0,1]
    v_pk_fma_f32 v[90:91], v[30:31], v[10:11], v[90:91] op_sel:[0,0,0] op_sel_hi:[1,0,1]
    s_waitcnt lgkmcnt(1)
    v_cvt_f32_i32 v32, v32
    v_cvt_f32_i32 v33, v33
    v_cvt_f32_i32 v34, v34
    v_cvt_f32_i32 v35, v35
    v_pk_fma_f32 v[92:93], v[32:33], v[10:11], v[92:93] op_sel:[0,0,0] op_sel_hi:[1,0,1]
    v_pk_fma_f32 v[94:95], v[34:35], v[10:11], v[94:95] op_sel:[0,0,0] op_sel_hi:[1,0,1]
    s_add_u32 s79, s79, 12
    s_cmp_ge_i32 s80, s79
    s_cbranch_scc1 L_vr10g
L_vr10:
    ds_read_b32 v19, v7
    s_sleep 1
    s_waitcnt lgkmcnt(0)
    v_readlane_b32 s80, v19, 5
    s_nop 0
    s_cmp_lt_i32 s80, s79
    s_cbranch_scc1 L_vr10
L_vr10g:
    ds_read_b32 v10, v3 offset:128
    ds_read_b128 v[24:27], v2 offset:24576
    ds_read_b128 v[28:31], v2 offset:24832
    ds_read_b128 v[32:35], v2 offset:25088
    v_add_u32 v6, 1, v6
    ds_write_b32 v5, v6
    s_waitcnt lgkmcnt(3)
    v_cvt_f32_i32 v24, v24
    v_cvt_f32_i32 v25, v25
    v_cvt_f32_i32 v26, v26
    v_cvt_f32_i32 v27, v27
    v_pk_fma_f32 v[72:73], v[24:25], v[10:11], v[72:73] op_sel:[0,0,0] op_sel_hi:[1,0,1]
    v_pk_fma_f32 v[74:75], v[26:27], v[10:11], v[74:75] op_sel:[0,0,0] op_sel_hi:[1,0,1]
    s_waitcnt lgkmcnt(2)
    v_cvt_f32_i32 v28, v28
    v_cvt_f32_i32 v29, v29
    v_cvt_f32_i32 v30, v30
    v_cvt_f32_i32 v31, v31
    v_pk_fma_f32 v[76:77], v[28:29], v[10:11], v[76:77] op_sel:[0,0,0] op_sel_hi:[1,0,1]
    v_pk_fma_f32 v[78:79], v[30:31], v[10:11], v[78:79] op_sel:[0,0,0] op_sel_hi:[1,0,1]
    s_waitcnt lgkmcnt(1)
    v_cvt_f32_i32 v32, v32
    v_cvt_f32_i32 v33, v33
    v_cvt_f32_i32 v34, v34
    v_cvt_f32_i32 v35, v35
    v_pk_fma_f32 v[80:81], v[32:33], v[10:11], v[80:81] op_sel:[0,0,0] op_sel_hi:[1,0,1]
    v_pk_fma_f32 v[82:83], v[34:35], v[10:11], v[82:83] op_sel:[0,0,0] op_sel_hi:[1,0,1]
    s_cmp_lg_u32 s88, 3
    s_nop 0
    s_cbranch_scc1 L_nda
    v_permlane32_swap_b32 v72, v74
    v_permlane32_swap_b32 v73, v75
    v_permlane32_swap_b32 v76, v78
    v_permlane32_swap_b32 v77, v79
    v_permlane32_swap_b32 v80, v82
    v_permlane32_swap_b32 v81, v83
    v_pk_add_f32 v[72:73], v[72:73], v[74:75]
    v_pk_add_f32 v[76:77], v[76:77], v[78:79]
    v_pk_add_f32 v[80:81], v[80:81], v[82:83]
    v_permlane16_swap_b32 v72, v73
    v_permlane16_swap_b32 v76, v77
    v_permlane16_swap_b32 v80, v81
    v_add_f32 v36, v72, v73
    v_add_f32 v37, v76, v77
    v_add_f32 v38, v80, v81
    ds_write2st64_b32 v9, v36, v37 offset0:0 offset1:1
    ds_write_b32 v9, v38 offset:512
    s_mov_b64 exec, 1
    ds_add_u32 v22, v8
    s_mov_b64 exec, -1
L_nda:
    s_add_u32 s79, s79, 12
    s_cmp_ge_i32 s80, s79
    s_cbranch_scc1 L_vr11g
L_vr11:
    ds_read_b32 v19, v7
    s_sleep 1
    s_waitcnt lgkmcnt(0)
    v_readlane_b32 s80, v19, 5
    s_nop 0
    s_cmp_lt_i32 s80, s79
    s_cbranch_scc1 L_vr11
L_vr11g:
    ds_read_b32 v10, v3 offset:1152
    ds_read_b128 v[24:27], v2 offset:36864
    ds_read_b128 v[28:31], v2 offset:37120
    ds_read_b128 v[32:35], v2 offset:37376
    v_add_u32 v6, 1, v6
    ds_write_b32 v5, v6
    s_waitcnt lgkmcnt(3)
    v_cvt_f32_i32 v24, v24
    v_cvt_f32_i32 v25, v25
    v_cvt_f32_i32 v26, v26
    v_cvt_f32_i32 v27, v27
    v_pk_fma_f32 v[84:85], v[24:25], v[10:11], v[84:85] op_sel:[0,0,0] op_sel_hi:[1,0,1]
    v_pk_fma_f32 v[86:87], v[26:27], v[10:11], v[86:87] op_sel:[0,0,0] op_sel_hi:[1,0,1]
    s_waitcnt lgkmcnt(2)
    v_cvt_f32_i32 v28, v28
    v_cvt_f32_i32 v29, v29
    v_cvt_f32_i32 v30, v30
    v_cvt_f32_i32 v31, v31
    v_pk_fma_f32 v[88:89], v[28:29], v[10:11], v[88:89] op_sel:[0,0,0] op_sel_hi:[1,0,1]
    v_pk_fma_f32 v[90:91], v[30:31], v[10:11], v[90:91] op_sel:[0,0,0] op_sel_hi:[1,0,1]
    s_waitcnt lgkmcnt(1)
    v_cvt_f32_i32 v32, v32
    v_cvt_f32_i32 v33, v33
    v_cvt_f32_i32 v34, v34
    v_cvt_f32_i32 v35, v35
    v_pk_fma_f32 v[92:93], v[32:33], v[10:11], v[92:93] op_sel:[0,0,0] op_sel_hi:[1,0,1]
    v_pk_fma_f32 v[94:95], v[34:35], v[10:11], v[94:95] op_sel:[0,0,0] op_sel_hi:[1,0,1]
    v_add_u32 v3, 256, v3
    s_add_u32 s88, s88, 1
    s_cmp_lt_u32 s88, 4
    s_cbranch_scc1 L_vit
    v_permlane32_swap_b32 v84, v86
    v_permlane32_swap_b32 v85, v87
    v_permlane32_swap_b32 v88, v90
    v_permlane32_swap_b32 v89, v91
    v_permlane32_swap_b32 v92, v94
    v_permlane32_swap_b32 v93, v95
    v_pk_add_f32 v[84:85], v[84:85], v[86:87]
    v_pk_add_f32 v[88:89], v[88:89], v[90:91]
    v_pk_add_f32 v[92:93], v[92:93], v[94:95]
    v_permlane16_swap_b32 v84, v85
    v_permlane16_swap_b32 v88, v89
    v_permlane16_swap_b32 v92, v93
    v_add_f32 v39, v84, v85
    v_add_f32 v40, v88, v89
    v_add_f32 v41, v92, v93
    ds_write2st64_b32 v9, v39, v40 offset0:3 offset1:4
    ds_write_b32 v9, v41 offset:1280
    s_mov_b64 exec, 1
    ds_add_u32 v22, v12
    s_mov_b64 exec, -1
    v_add_u32 v22, 4, v22
    v_add_u32 v3, 1024, v3
    s_bitcmp0_b32 s81, 0
    s_cselect_b32 s92, 1, -1
    s_mul_i32 s92, s92, 6144
    v_add_u32 v9, s92, v9
    s_add_u32 s81, s81, 1
    s_cmp_lt_u32 s81, 8
    s_waitcnt lgkmcnt(0)
    s_cbranch_scc1 L_vph
    s_cmp_ge_u32 s2, 192
    s_cbranch_scc1 L_cend
L_gw:
    ds_read_b32 v19, v7
    s_waitcnt lgkmcnt(0)
    v_readlane_b32 s92, v19, 8
    s_nop 0
    s_cmp_eq_u32 s92, 0
    s_nop 2
    s_cbranch_scc1 L_gw
L_try:
    buffer_load_dwordx4 v[48:51], v68, s[20:23], s32 offen sc0 sc1
    buffer_load_dwordx4 v[52:55], v68, s[20:23], s33 offen sc0 sc1
    buffer_load_dwordx4 v[56:59], v68, s[20:23], s34 offen sc0 sc1
    buffer_load_dwordx4 v[60:63], v68, s[20:23], s35 offen sc0 sc1
    s_waitcnt vmcnt(3)
    v_xor_b32 v23, s4, v48
    v_bitop3_b32 v23, v23, v49, s5 bitop3:0xf6
    v_pk_mul_f32 v[14:15], v[48:49], v[64:65] op_sel:[0,0] op_sel_hi:[1,0]
    v_bitop3_b32 v23, v23, v50, s6 bitop3:0xf6
    v_bitop3_b32 v23, v23, v51, s7 bitop3:0xf6
    v_pk_mul_f32 v[16:17], v[50:51], v[64:65] op_sel:[0,0] op_sel_hi:[1,0]
    s_waitcnt vmcnt(2)
    v_bitop3_b32 v23, v23, v52, s4 bitop3:0xf6
    v_bitop3_b32 v23, v23, v53, s5 bitop3:0xf6
    v_pk_fma_f32 v[14:15], v[52:53], v[64:65], v[14:15] op_sel:[0,1,0] op_sel_hi:[1,1,1]
    v_bitop3_b32 v23, v23, v54, s6 bitop3:0xf6
    v_bitop3_b32 v23, v23, v55, s7 bitop3:0xf6
    v_pk_fma_f32 v[16:17], v[54:55], v[64:65], v[16:17] op_sel:[0,1,0] op_sel_hi:[1,1,1]
    s_waitcnt vmcnt(1)
    v_bitop3_b32 v23, v23, v56, s4 bitop3:0xf6
    v_bitop3_b32 v23, v23, v57, s5 bitop3:0xf6
    v_pk_fma_f32 v[14:15], v[56:57], v[66:67], v[14:15] op_sel:[0,0,0] op_sel_hi:[1,0,1]
    v_bitop3_b32 v23, v23, v58, s6 bitop3:0xf6
    v_bitop3_b32 v23, v23, v59, s7 bitop3:0xf6
    v_pk_fma_f32 v[16:17], v[58:59], v[66:67], v[16:17] op_sel:[0,0,0] op_sel_hi:[1,0,1]
    s_waitcnt vmcnt(0)
    v_bitop3_b32 v23, v23, v60, s4 bitop3:0xf6
    v_bitop3_b32 v23, v23, v61, s5 bitop3:0xf6
    v_pk_fma_f32 v[14:15], v[60:61], v[66:67], v[14:15] op_sel:[0,1,0] op_sel_hi:[1,1,1]
    v_bitop3_b32 v23, v23, v62, s6 bitop3:0xf6
    v_bitop3_b32 v23, v23, v63, s7 bitop3:0xf6
    v_pk_fma_f32 v[16:17], v[62:63], v[66:67], v[16:17] op_sel:[0,1,0] op_sel_hi:[1,1,1]
    v_and_b32 v23, 0xff, v23
    v_cmp_ne_u32 vcc, 0, v23
    s_nop 4
    s_cbranch_vccz L_cok
    s_mov_b64 exec, vcc
    s_sleep 1
    s_add_u32 s88, s88, 1
    s_cmp_lt_u32 s88, 400000
    s_cbranch_scc1 L_try
L_cok:
    s_mov_b64 exec, -1
    v_permlane32_swap_b32 v14, v16
    v_permlane32_swap_b32 v15, v17
    v_pk_add_f32 v[14:15], v[14:15], v[16:17]
    s_nop 1
    v_permlane16_swap_b32 v14, v15
    v_add_f32 v14, v14, v15
    ds_write_b32 v4, v14
    s_mov_b64 exec, 1
    ds_add_rtn_u32 v18, v7, v8 offset:28
    s_mov_b64 exec, -1
    ds_read2st64_b32 v[14:15], v7 offset0:4 offset1:5
    ds_read2st64_b32 v[16:17], v7 offset0:6 offset1:7
    s_waitcnt lgkmcnt(0)
    v_readfirstlane_b32 s92, v18
    v_pk_add_f32 v[14:15], v[14:15], v[16:17]
    v_add_f32 v14, v14, v15
    s_cmp_lg_u32 s92, 3
    s_nop 1
    s_cbranch_scc1 L_cend
    v_add_f32_dpp v14, v14, v14 row_ror:8 row_mask:0xf bank_mask:0xf
    s_mov_b32 exec_lo, 0x00ff00ff
    s_mov_b32 exec_hi, 0x00ff00ff
    v_cvt_pk_bf16_f32 v14, v14, v14
    buffer_store_short v14, v69, s[28:31], s36 offen
    s_nop 0
L_cend:
    s_endpgm
L_helper:
    s_memrealtime s[96:97]
    v_bfe_u32 v22, v1, 2, 3
    v_lshl_add_u32 v22, v22, 11, s77
    v_and_b32 v22, 16383, v22
    v_lshrrev_b32 v19, 5, v1
    v_lshl_add_u32 v22, v19, 14, v22
    v_and_b32 v19, 3, v1
    v_lshlrev_b32 v19, 3, v19
    v_lshl_add_u32 v22, v22, 1, v19
    s_lshl_b32 s89, s3, 16
    v_lshlrev_b32 v2, 4, v1
    s_mov_b32 s6, 1048576
    s_mov_b32 s7, 0x20000
    s_mov_b32 s10, 1048576
    s_mov_b32 s11, 0x20000
    s_mov_b32 s14, 1048576
    s_mov_b32 s15, 0x20000
    s_mov_b32 s18, 1048576
    s_mov_b32 s19, 0x20000
    s_waitcnt lgkmcnt(0)
    s_mov_b64 s[4:5], s[52:53]
    s_mov_b64 s[8:9], s[54:55]
    s_mov_b64 s[12:13], s[58:59]
    s_mov_b64 s[16:17], s[60:61]
    buffer_load_dwordx2 v[72:73], v22, s[4:7], s89 offen
    buffer_load_dwordx2 v[74:75], v22, s[8:11], s89 offen
    buffer_load_dwordx2 v[76:77], v22, s[12:15], s89 offen
    buffer_load_dwordx2 v[78:79], v22, s[16:19], s89 offen
    s_add_u32 s89, s89, 131072
    s_barrier
    s_mov_b32 s20, s74
    s_mov_b32 s21, s75
    s_mov_b32 s22, 1610612736
    s_mov_b32 s23, 0x20000
    s_mov_b32 s24, s72
    s_mov_b32 s25, s73
    s_mov_b32 s26, 256
    s_mov_b32 s27, 0x20000
    s_mov_b32 s28, s70
    s_mov_b32 s29, s71
    s_mov_b32 s30, 12288
    s_mov_b32 s31, 0x20000
    s_mov_b32 s32, s48
    s_mov_b32 s33, s49
    s_mov_b32 s34, 12288
    s_mov_b32 s35, 0x20000
    s_mov_b32 s36, s62
    s_mov_b32 s37, s63
    s_mov_b32 s38, 384
    s_mov_b32 s39, 0x20000
    s_mov_b32 s40, s64
    s_mov_b32 s41, s65
    s_mov_b32 s42, 384
    s_mov_b32 s43, 0x20000
    v_lshlrev_b32 v44, 3, v1
    v_cmp_gt_u32 vcc, 24, v1
    v_mov_b32 v23, 0xffffff40
    v_mov_b32 v18, 192
    v_cndmask_b32 v23, v23, v18, vcc
    v_add_u32 v45, v44, v23
    v_mov_b32 v18, 0x80008000
    v_cndmask_b32 v46, 0, v18, vcc
    s_mov_b32 s78, s96
    s_mov_b32 s94, 0x05040100
    s_mov_b32 s95, 0x07060302
    v_lshlrev_b32 v9, 1, v2
    v_add_u32 v9, 49152, v9
    v_mov_b32 v3, 77824
    v_mov_b32 v4, 0
    v_mov_b32 v5, 0xff
    s_waitcnt vmcnt(0)
    v_perm_b32 v48, v74, v72, s94
    v_perm_b32 v49, v78, v76, s94
    v_perm_b32 v50, v74, v72, s95
    v_perm_b32 v51, v78, v76, s95
    v_perm_b32 v52, v75, v73, s94
    v_perm_b32 v53, v79, v77, s94
    v_perm_b32 v54, v75, v73, s95
    v_perm_b32 v55, v79, v77, s95
    v_mov_b32 v19, 1
    ds_write_b128 v9, v[48:51] offset:0
    ds_write_b128 v9, v[52:55] offset:16
    ds_write_b32 v3, v19 offset:48
    s_waitcnt lgkmcnt(3)
    s_mov_b32 s48, 0
    s_cmp_lg_u32 s2, 0
    s_cbranch_scc1 L_ne0
    s_mul_i32 s49, s78, 0x9e3779b1
    s_lshr_b32 s93, s49, 15
    s_xor_b32 s49, s49, s93
    s_mul_i32 s49, s49, 0x85ebca6b
    s_lshr_b32 s93, s49, 13
    s_xor_b32 s49, s49, s93
    s_max_u32 s49, s49, 1
    v_mov_b32 v14, s49
    v_mov_b32 v15, 0
    s_mov_b64 exec, 1
    buffer_atomic_cmpswap v[14:15], v4, s[24:27], 0 offen sc0 sc1
    s_waitcnt vmcnt(0)
    v_readfirstlane_b32 s48, v14
    s_mov_b64 exec, -1
    s_cmp_eq_u32 s48, 0
    s_cselect_b32 s48, s49, s48
    s_nop 1
L_ne0:
    buffer_load_dwordx2 v[40:41], v44, s[36:39], 0 offen
    buffer_load_dwordx2 v[42:43], v44, s[40:43], 0 offen
    s_mul_i32 s92, s3, 768
    s_add_u32 s92, s92, 6144
    buffer_load_dwordx2 v[136:137], v44, s[32:35], s92 offen
    buffer_load_dwordx2 v[138:139], v45, s[32:35], s92 offen
    buffer_load_dwordx2 v[140:141], v44, s[32:35], s92 offen offset:384
    buffer_load_dwordx2 v[142:143], v45, s[32:35], s92 offen offset:384
    s_add_u32 s92, s92, 1536
    buffer_load_dwordx2 v[144:145], v44, s[32:35], s92 offen
    buffer_load_dwordx2 v[146:147], v45, s[32:35], s92 offen
    buffer_load_dwordx2 v[148:149], v44, s[32:35], s92 offen offset:384
    buffer_load_dwordx2 v[150:151], v45, s[32:35], s92 offen offset:384
    s_add_u32 s92, s92, 1536
    buffer_load_dwordx2 v[152:153], v44, s[32:35], s92 offen
    buffer_load_dwordx2 v[154:155], v45, s[32:35], s92 offen
    buffer_load_dwordx2 v[156:157], v44, s[32:35], s92 offen offset:384
    buffer_load_dwordx2 v[158:159], v45, s[32:35], s92 offen offset:384
    s_add_u32 s92, s92, 1536
    buffer_load_dwordx2 v[160:161], v44, s[32:35], s92 offen
    buffer_load_dwordx2 v[162:163], v45, s[32:35], s92 offen
    buffer_load_dwordx2 v[164:165], v44, s[32:35], s92 offen offset:384
    buffer_load_dwordx2 v[166:167], v45, s[32:35], s92 offen offset:384
    buffer_load_dwordx2 v[80:81], v22, s[4:7], s89 offen
    buffer_load_dwordx2 v[82:83], v22, s[8:11], s89 offen
    buffer_load_dwordx2 v[84:85], v22, s[12:15], s89 offen
    buffer_load_dwordx2 v[86:87], v22, s[16:19], s89 offen
    s_add_u32 s89, s89, 131072
    buffer_load_dwordx2 v[88:89], v22, s[4:7], s89 offen
    buffer_load_dwordx2 v[90:91], v22, s[8:11], s89 offen
    buffer_load_dwordx2 v[92:93], v22, s[12:15], s89 offen
    buffer_load_dwordx2 v[94:95], v22, s[16:19], s89 offen
    s_add_u32 s89, s89, 131072
    buffer_load_dwordx2 v[96:97], v22, s[4:7], s89 offen
    buffer_load_dwordx2 v[98:99], v22, s[8:11], s89 offen
    buffer_load_dwordx2 v[100:101], v22, s[12:15], s89 offen
    buffer_load_dwordx2 v[102:103], v22, s[16:19], s89 offen
    s_add_u32 s89, s89, 131072
    s_waitcnt vmcnt(8)
    buffer_load_dwordx2 v[104:105], v22, s[4:7], s89 offen
    buffer_load_dwordx2 v[106:107], v22, s[8:11], s89 offen
    buffer_load_dwordx2 v[108:109], v22, s[12:15], s89 offen
    buffer_load_dwordx2 v[110:111], v22, s[16:19], s89 offen
    s_add_u32 s89, s89, 131072
    v_perm_b32 v56, v82, v80, s94
    v_perm_b32 v57, v86, v84, s94
    v_perm_b32 v58, v82, v80, s95
    v_perm_b32 v59, v86, v84, s95
    v_perm_b32 v60, v83, v81, s94
    v_perm_b32 v61, v87, v85, s94
    v_perm_b32 v62, v83, v81, s95
    v_perm_b32 v63, v87, v85, s95
    v_mov_b32 v19, 2
    ds_write_b128 v9, v[56:59] offset:2048
    ds_write_b128 v9, v[60:63] offset:2064
    ds_write_b32 v3, v19 offset:48
    s_waitcnt lgkmcnt(3)
    s_waitcnt vmcnt(8)
    buffer_load_dwordx2 v[112:113], v22, s[4:7], s89 offen
    buffer_load_dwordx2 v[114:115], v22, s[8:11], s89 offen
    buffer_load_dwordx2 v[116:117], v22, s[12:15], s89 offen
    buffer_load_dwordx2 v[118:119], v22, s[16:19], s89 offen
    s_add_u32 s89, s89, 131072
    v_perm_b32 v48, v90, v88, s94
    v_perm_b32 v49, v94, v92, s94
    v_perm_b32 v50, v90, v88, s95
    v_perm_b32 v51, v94, v92, s95
    v_perm_b32 v52, v91, v89, s94
    v_perm_b32 v53, v95, v93, s94
    v_perm_b32 v54, v91, v89, s95
    v_perm_b32 v55, v95, v93, s95
    v_mov_b32 v19, 3
    ds_write_b128 v9, v[48:51] offset:4096
    ds_write_b128 v9, v[52:55] offset:4112
    ds_write_b32 v3, v19 offset:48
    s_waitcnt lgkmcnt(3)
    s_waitcnt vmcnt(8)
    buffer_load_dwordx2 v[120:121], v22, s[4:7], s89 offen
    buffer_load_dwordx2 v[122:123], v22, s[8:11], s89 offen
    buffer_load_dwordx2 v[124:125], v22, s[12:15], s89 offen
    buffer_load_dwordx2 v[126:127], v22, s[16:19], s89 offen
    s_add_u32 s89, s89, 131072
    v_perm_b32 v56, v98, v96, s94
    v_perm_b32 v57, v102, v100, s94
    v_perm_b32 v58, v98, v96, s95
    v_perm_b32 v59, v102, v100, s95
    v_perm_b32 v60, v99, v97, s94
    v_perm_b32 v61, v103, v101, s94
    v_perm_b32 v62, v99, v97, s95
    v_perm_b32 v63, v103, v101, s95
    v_mov_b32 v19, 4
    ds_write_b128 v9, v[56:59] offset:6144
    ds_write_b128 v9, v[60:63] offset:6160
    ds_write_b32 v3, v19 offset:48
    s_waitcnt lgkmcnt(3)
    s_waitcnt vmcnt(8)
    buffer_load_dwordx2 v[128:129], v22, s[4:7], s89 offen
    buffer_load_dwordx2 v[130:131], v22, s[8:11], s89 offen
    buffer_load_dwordx2 v[132:133], v22, s[12:15], s89 offen
    buffer_load_dwordx2 v[134:135], v22, s[16:19], s89 offen
    s_add_u32 s89, s89, 131072
    v_perm_b32 v48, v106, v104, s94
    v_perm_b32 v49, v110, v108, s94
    v_perm_b32 v50, v106, v104, s95
    v_perm_b32 v51, v110, v108, s95
    v_perm_b32 v52, v107, v105, s94
    v_perm_b32 v53, v111, v109, s94
    v_perm_b32 v54, v107, v105, s95
    v_perm_b32 v55, v111, v109, s95
    v_mov_b32 v19, 5
    ds_write_b128 v9, v[48:51] offset:8192
    ds_write_b128 v9, v[52:55] offset:8208
    ds_write_b32 v3, v19 offset:48
    s_waitcnt lgkmcnt(3)
    s_waitcnt vmcnt(8)
    v_perm_b32 v56, v114, v112, s94
    v_perm_b32 v57, v118, v116, s94
    v_perm_b32 v58, v114, v112, s95
    v_perm_b32 v59, v118, v116, s95
    v_perm_b32 v60, v115, v113, s94
    v_perm_b32 v61, v119, v117, s94
    v_perm_b32 v62, v115, v113, s95
    v_perm_b32 v63, v119, v117, s95
    v_mov_b32 v19, 6
    ds_write_b128 v9, v[56:59] offset:10240
    ds_write_b128 v9, v[60:63] offset:10256
    ds_write_b32 v3, v19 offset:48
    s_waitcnt lgkmcnt(3)
    s_waitcnt vmcnt(4)
    v_perm_b32 v48, v122, v120, s94
    v_perm_b32 v49, v126, v124, s94
    v_perm_b32 v50, v122, v120, s95
    v_perm_b32 v51, v126, v124, s95
    v_perm_b32 v52, v123, v121, s94
    v_perm_b32 v53, v127, v125, s94
    v_perm_b32 v54, v123, v121, s95
    v_perm_b32 v55, v127, v125, s95
    v_mov_b32 v19, 7
    ds_write_b128 v9, v[48:51] offset:12288
    ds_write_b128 v9, v[52:55] offset:12304
    ds_write_b32 v3, v19 offset:48
    s_waitcnt lgkmcnt(3)
    s_waitcnt vmcnt(0)
    v_perm_b32 v56, v130, v128, s94
    v_perm_b32 v57, v134, v132, s94
    v_perm_b32 v58, v130, v128, s95
    v_perm_b32 v59, v134, v132, s95
    v_perm_b32 v60, v131, v129, s94
    v_perm_b32 v61, v135, v133, s94
    v_perm_b32 v62, v131, v129, s95
    v_perm_b32 v63, v135, v133, s95
    v_mov_b32 v19, 8
    ds_write_b128 v9, v[56:59] offset:14336
    ds_write_b128 v9, v[60:63] offset:14352
    ds_write_b32 v3, v19 offset:48
    s_waitcnt lgkmcnt(3)
    s_getpc_b64 s[92:93]
L_pc:
    s_sub_u32 s92, s92, L_pc-standalone__kv_cache_quant_pre_rope_vs_post_rope__decode_kernel
    s_subb_u32 s93, s93, 0
    s_lshr_b32 s94, s2, 3
    v_lshl_add_u32 v19, v1, 5, s94
    v_lshlrev_b32 v19, 7, v19
    v_min_u32 v19, L_end-standalone__kv_cache_quant_pre_rope_vs_post_rope__decode_kernel, v19
    s_mov_b64 exec, 0x7f
    global_load_dword v6, v19, s[92:93]
    s_mov_b64 exec, -1
    v_lshlrev_b32 v18, 1, v44
    v_lshlrev_b32 v19, 1, v45
    v_add_u32 v18, 71680, v18
    v_add_u32 v19, 71680, v19
    v_mov_b32 v23, 77968
    s_mov_b32 s89, 0
    s_waitcnt vmcnt(1) lgkmcnt(0)
    v_xor_b32 v42, v42, v46
    v_xor_b32 v43, v43, v46
    v_lshlrev_b32 v48, 16, v40
    v_and_b32 v49, 0xffff0000, v40
    v_lshlrev_b32 v50, 16, v41
    v_and_b32 v51, 0xffff0000, v41
    v_lshlrev_b32 v52, 16, v42
    v_and_b32 v53, 0xffff0000, v42
    v_lshlrev_b32 v54, 16, v43
    v_and_b32 v55, 0xffff0000, v43
    v_and_b32 v46, 0x80000000, v46
    s_nop 1
L_hq:
    v_mov_b64 v[24:25], v[136:137]
    v_mov_b64 v[26:27], v[138:139]
    v_mov_b64 v[28:29], v[140:141]
    v_mov_b64 v[30:31], v[142:143]
    v_mov_b64 v[136:137], v[144:145]
    v_mov_b64 v[138:139], v[146:147]
    v_mov_b64 v[140:141], v[148:149]
    v_mov_b64 v[142:143], v[150:151]
    v_mov_b64 v[144:145], v[152:153]
    v_mov_b64 v[146:147], v[154:155]
    v_mov_b64 v[148:149], v[156:157]
    v_mov_b64 v[150:151], v[158:159]
    v_mov_b64 v[152:153], v[160:161]
    v_mov_b64 v[154:155], v[162:163]
    v_mov_b64 v[156:157], v[164:165]
    v_mov_b64 v[158:159], v[166:167]
    s_mov_b32 exec_hi, 0xffff
    v_lshlrev_b32 v56, 16, v24
    v_and_b32 v57, 0xffff0000, v24
    v_lshlrev_b32 v58, 16, v25
    v_and_b32 v59, 0xffff0000, v25
    v_lshlrev_b32 v60, 16, v26
    v_and_b32 v61, 0xffff0000, v26
    v_lshlrev_b32 v62, 16, v27
    v_and_b32 v63, 0xffff0000, v27
    v_pk_mul_f32 v[56:57], v[56:57], v[48:49]
    v_pk_mul_f32 v[60:61], v[60:61], v[52:53]
    v_pk_mul_f32 v[58:59], v[58:59], v[50:51]
    v_pk_mul_f32 v[62:63], v[62:63], v[54:55]
    v_cvt_pk_bf16_f32 v56, v56, v60
    v_cvt_pk_bf16_f32 v57, v57, v61
    v_cvt_pk_bf16_f32 v58, v58, v62
    v_cvt_pk_bf16_f32 v59, v59, v63
    v_and_b32 v60, 0xffff0000, v56
    v_lshlrev_b32 v56, 16, v56
    v_and_b32 v61, 0xffff0000, v57
    v_lshlrev_b32 v57, 16, v57
    v_and_b32 v62, 0xffff0000, v58
    v_lshlrev_b32 v58, 16, v58
    v_and_b32 v63, 0xffff0000, v59
    v_lshlrev_b32 v59, 16, v59
    v_pk_add_f32 v[56:57], v[56:57], v[60:61]
    v_pk_add_f32 v[58:59], v[58:59], v[62:63]
    v_cvt_pk_bf16_f32 v64, v56, v56
    v_cvt_pk_bf16_f32 v65, v57, v57
    v_cvt_pk_bf16_f32 v66, v58, v58
    v_cvt_pk_bf16_f32 v67, v59, v59
    v_xor_b32 v64, v64, v46
    v_xor_b32 v65, v65, v46
    v_xor_b32 v66, v66, v46
    v_xor_b32 v67, v67, v46
    ds_write_b16 v18, v64 offset:0
    ds_write_b16_d16_hi v19, v64 offset:2
    ds_write_b16 v18, v65 offset:4
    ds_write_b16_d16_hi v19, v65 offset:6
    ds_write_b16 v18, v66 offset:8
    ds_write_b16_d16_hi v19, v66 offset:10
    ds_write_b16 v18, v67 offset:12
    ds_write_b16_d16_hi v19, v67 offset:14
    v_lshlrev_b32 v56, 16, v28
    v_and_b32 v57, 0xffff0000, v28
    v_lshlrev_b32 v58, 16, v29
    v_and_b32 v59, 0xffff0000, v29
    v_lshlrev_b32 v60, 16, v30
    v_and_b32 v61, 0xffff0000, v30
    v_lshlrev_b32 v62, 16, v31
    v_and_b32 v63, 0xffff0000, v31
    v_pk_mul_f32 v[56:57], v[56:57], v[48:49]
    v_pk_mul_f32 v[60:61], v[60:61], v[52:53]
    v_pk_mul_f32 v[58:59], v[58:59], v[50:51]
    v_pk_mul_f32 v[62:63], v[62:63], v[54:55]
    v_cvt_pk_bf16_f32 v56, v56, v60
    v_cvt_pk_bf16_f32 v57, v57, v61
    v_cvt_pk_bf16_f32 v58, v58, v62
    v_cvt_pk_bf16_f32 v59, v59, v63
    v_and_b32 v60, 0xffff0000, v56
    v_lshlrev_b32 v56, 16, v56
    v_and_b32 v61, 0xffff0000, v57
    v_lshlrev_b32 v57, 16, v57
    v_and_b32 v62, 0xffff0000, v58
    v_lshlrev_b32 v58, 16, v58
    v_and_b32 v63, 0xffff0000, v59
    v_lshlrev_b32 v59, 16, v59
    v_pk_add_f32 v[56:57], v[56:57], v[60:61]
    v_pk_add_f32 v[58:59], v[58:59], v[62:63]
    v_cvt_pk_bf16_f32 v68, v56, v56
    v_cvt_pk_bf16_f32 v69, v57, v57
    v_cvt_pk_bf16_f32 v70, v58, v58
    v_cvt_pk_bf16_f32 v71, v59, v59
    v_xor_b32 v68, v68, v46
    v_xor_b32 v69, v69, v46
    v_xor_b32 v70, v70, v46
    v_xor_b32 v71, v71, v46
    ds_write_b16 v18, v68 offset:768
    ds_write_b16_d16_hi v19, v68 offset:770
    ds_write_b16 v18, v69 offset:772
    ds_write_b16_d16_hi v19, v69 offset:774
    ds_write_b16 v18, v70 offset:776
    ds_write_b16_d16_hi v19, v70 offset:778
    ds_write_b16 v18, v71 offset:780
    ds_write_b16_d16_hi v19, v71 offset:782
    s_mov_b32 exec_hi, -1
    ds_write_b32 v23, v5
    s_add_u32 s89, s89, 1
    v_add_u32 v18, 1536, v18
    v_add_u32 v19, 1536, v19
    v_add_u32 v23, 4, v23
    s_cmp_lt_u32 s89, 4
    s_waitcnt lgkmcnt(0)
    s_cbranch_scc1 L_hq
    s_cmp_lg_u32 s48, 0
    s_cbranch_scc1 L_epd
L_epw:
    s_sleep 4
    ds_read_b32 v19, v7
    s_waitcnt lgkmcnt(0)
    v_readlane_b32 s89, v19, 5
    s_nop 0
    s_cmp_lt_i32 s89, 72
    s_nop 2
    s_cbranch_scc1 L_epw
    s_buffer_load_dword s48, s[24:27], 0
    s_waitcnt lgkmcnt(0)
    s_cmp_lg_u32 s48, 0
    s_cbranch_scc1 L_epd
    s_mul_i32 s49, s78, 0x9e3779b1
    s_lshr_b32 s93, s49, 15
    s_xor_b32 s49, s49, s93
    s_mul_i32 s49, s49, 0x85ebca6b
    s_lshr_b32 s93, s49, 13
    s_xor_b32 s49, s49, s93
    s_max_u32 s49, s49, 1
    v_mov_b32 v14, s49
    v_mov_b32 v15, 0
    s_mov_b64 exec, 1
    buffer_atomic_cmpswap v[14:15], v4, s[24:27], 0 offen sc0 sc1
    s_waitcnt vmcnt(0)
    v_readfirstlane_b32 s48, v14
    s_mov_b64 exec, -1
    s_cmp_eq_u32 s48, 0
    s_cselect_b32 s48, s49, s48
    s_nop 1
L_epd:
    s_waitcnt vmcnt(0)
    s_lshr_b32 s49, s48, 8
    s_lshr_b32 s50, s48, 16
    s_lshr_b32 s51, s48, 24
    s_mov_b32 s79, 0
    s_mov_b32 s80, 0
    s_mov_b32 s85, 0
    s_mov_b32 s84, 0
    s_mov_b32 s83, 0
    s_movk_i32 s81, 192
    s_movk_i32 s82, 264
    s_mov_b32 s98, 0
    s_mov_b32 s99, 0
    s_mov_b32 s86, 16
    s_lshr_b32 s92, s2, 4
    s_and_b32 s93, s2, 15
    s_cmp_eq_u32 s92, s93
    s_cselect_b32 s38, s92, 255
    s_mul_i32 s87, s38, 4352
    s_add_u32 s87, s87, 33554432
    s_mov_b32 s88, 33554432
    v_mul_u32_u24 v8, 4352, v1
    v_cmp_gt_u32 s[36:37], 16, v1
    v_lshrrev_b32 v18, 5, v1
    v_lshlrev_b32 v11, 4, v18
    v_add_u32 v11, 78080, v11
    v_add_u32 v10, 65536, v2
    v_mov_b32 v20, 78080
    s_mov_b32 s39, 4
    s_and_b32 s41, s2, 0x70
    s_and_b32 s92, s2, 7
    s_lshl1_add_u32 s41, s92, s41
    s_lshr_b32 s92, s2, 7
    s_add_u32 s41, s41, s92
    s_mul_i32 s34, s2, 43691
    s_lshr_b32 s34, s34, 18
    s_mul_i32 s92, s34, 6
    s_sub_u32 s35, s2, s92
    s_lshr_b32 s40, s2, 3
    s_and_b32 s40, s40, 31
    s_mul_i32 s40, s40, 24
    s_addk_i32 s40, 1680
    s_cmp_lt_u32 s2, 192
    s_cselect_b32 s40, s40, 0x7fffffff
    s_mov_b32 s33, 0
L_hl:
    s_sleep 4
    ds_read_b32 v19, v7
    s_memrealtime s[96:97]
    s_waitcnt lgkmcnt(0)
    v_readlane_b32 s89, v19, 5
    v_readlane_b32 s90, v19, s86
    s_sub_u32 s96, s96, s78
    s_lshl_b32 s96, s96, 8
    s_mul_i32 s92, s80, s89
    s_add_u32 s92, s92, s79
    s_sub_u32 s92, s96, s92
    s_max_i32 s92, s92, s98
    s_min_i32 s92, s92, s99
    s_mul_i32 s92, s92, 250
    s_add_u32 s92, s92, 21495808
    s_ashr_i32 s92, s92, 20
    s_max_i32 s92, s92, 15
    s_min_i32 s92, s92, 26
    v_mov_b32 v18, s92
    ds_write_b32 v3, v18 offset:16
    s_cmp_ge_i32 s89, s81
    s_cbranch_scc1 L_pub
    s_cmp_ge_i32 s89, s82
    s_cbranch_scc1 L_rd
    s_cmp_eq_u32 s90, s39
    s_cbranch_scc1 L_prep
    s_cmp_ge_i32 s89, s40
    s_cbranch_scc1 L_wts
    s_cmp_lt_i32 s89, 2952
    s_cbranch_scc1 L_hl
    s_cmp_eq_u32 s86, 14
    s_cbranch_scc0 L_hl
    s_branch L_late
L_pub:
    s_cmp_eq_u32 s80, 0
    s_cselect_b32 s92, 850, s80
    s_sub_u32 s93, s89, s81
    s_mul_i32 s92, s92, s93
    s_sub_u32 s83, s96, s92
    s_addk_i32 s81, 96
    s_cmp_ge_u32 s38, 16
    s_cbranch_scc1 L_hl
    s_lshl_b32 s92, s78, 8
    s_add_u32 s92, s92, s83
    v_mov_b32 v14, s92
    v_mov_b32 v15, s48
    s_mov_b64 exec, 1
    buffer_store_dwordx2 v[14:15], v4, s[20:23], s87 offen sc0 sc1
    s_mov_b64 exec, -1
    s_add_u32 s87, s87, 69632
    s_branch L_hl
L_rd:
    s_lshl_b32 s92, s78, 8
    s_add_u32 s92, s92, s83
    s_mov_b32 s93, 0
    s_mov_b32 s94, 0
    s_buffer_load_dwordx2 s[4:5], s[20:23], s88
    s_add_u32 s88, s88, 4352
    s_buffer_load_dwordx2 s[6:7], s[20:23], s88
    s_add_u32 s88, s88, 4352
    s_buffer_load_dwordx2 s[8:9], s[20:23], s88
    s_add_u32 s88, s88, 4352
    s_buffer_load_dwordx2 s[10:11], s[20:23], s88
    s_add_u32 s88, s88, 4352
    s_buffer_load_dwordx2 s[12:13], s[20:23], s88
    s_add_u32 s88, s88, 4352
    s_buffer_load_dwordx2 s[14:15], s[20:23], s88
    s_add_u32 s88, s88, 4352
    s_buffer_load_dwordx2 s[16:17], s[20:23], s88
    s_add_u32 s88, s88, 4352
    s_buffer_load_dwordx2 s[18:19], s[20:23], s88
    s_add_u32 s88, s88, 4352
    s_waitcnt lgkmcnt(0)
    s_sub_u32 s4, s4, s92
    s_cmp_eq_u32 s5, s48
    s_cselect_b32 s4, s4, 0
    s_addc_u32 s93, s93, 0
    s_add_u32 s94, s94, s4
    s_sub_u32 s6, s6, s92
    s_cmp_eq_u32 s7, s48
    s_cselect_b32 s6, s6, 0
    s_addc_u32 s93, s93, 0
    s_add_u32 s94, s94, s6
    s_sub_u32 s8, s8, s92
    s_cmp_eq_u32 s9, s48
    s_cselect_b32 s8, s8, 0
    s_addc_u32 s93, s93, 0
    s_add_u32 s94, s94, s8
    s_sub_u32 s10, s10, s92
    s_cmp_eq_u32 s11, s48
    s_cselect_b32 s10, s10, 0
    s_addc_u32 s93, s93, 0
    s_add_u32 s94, s94, s10
    s_sub_u32 s12, s12, s92
    s_cmp_eq_u32 s13, s48
    s_cselect_b32 s12, s12, 0
    s_addc_u32 s93, s93, 0
    s_add_u32 s94, s94, s12
    s_sub_u32 s14, s14, s92
    s_cmp_eq_u32 s15, s48
    s_cselect_b32 s14, s14, 0
    s_addc_u32 s93, s93, 0
    s_add_u32 s94, s94, s14
    s_sub_u32 s16, s16, s92
    s_cmp_eq_u32 s17, s48
    s_cselect_b32 s16, s16, 0
    s_addc_u32 s93, s93, 0
    s_add_u32 s94, s94, s16
    s_sub_u32 s18, s18, s92
    s_cmp_eq_u32 s19, s48
    s_cselect_b32 s18, s18, 0
    s_addc_u32 s93, s93, 0
    s_add_u32 s94, s94, s18
    s_buffer_load_dwordx2 s[4:5], s[20:23], s88
    s_add_u32 s88, s88, 4352
    s_buffer_load_dwordx2 s[6:7], s[20:23], s88
    s_add_u32 s88, s88, 4352
    s_buffer_load_dwordx2 s[8:9], s[20:23], s88
    s_add_u32 s88, s88, 4352
    s_buffer_load_dwordx2 s[10:11], s[20:23], s88
    s_add_u32 s88, s88, 4352
    s_buffer_load_dwordx2 s[12:13], s[20:23], s88
    s_add_u32 s88, s88, 4352
    s_buffer_load_dwordx2 s[14:15], s[20:23], s88
    s_add_u32 s88, s88, 4352
    s_buffer_load_dwordx2 s[16:17], s[20:23], s88
    s_add_u32 s88, s88, 4352
    s_buffer_load_dwordx2 s[18:19], s[20:23], s88
    s_add_u32 s88, s88, 4352
    s_waitcnt lgkmcnt(0)
    s_sub_u32 s4, s4, s92
    s_cmp_eq_u32 s5, s48
    s_cselect_b32 s4, s4, 0
    s_addc_u32 s93, s93, 0
    s_add_u32 s94, s94, s4
    s_sub_u32 s6, s6, s92
    s_cmp_eq_u32 s7, s48
    s_cselect_b32 s6, s6, 0
    s_addc_u32 s93, s93, 0
    s_add_u32 s94, s94, s6
    s_sub_u32 s8, s8, s92
    s_cmp_eq_u32 s9, s48
    s_cselect_b32 s8, s8, 0
    s_addc_u32 s93, s93, 0
    s_add_u32 s94, s94, s8
    s_sub_u32 s10, s10, s92
    s_cmp_eq_u32 s11, s48
    s_cselect_b32 s10, s10, 0
    s_addc_u32 s93, s93, 0
    s_add_u32 s94, s94, s10
    s_sub_u32 s12, s12, s92
    s_cmp_eq_u32 s13, s48
    s_cselect_b32 s12, s12, 0
    s_addc_u32 s93, s93, 0
    s_add_u32 s94, s94, s12
    s_sub_u32 s14, s14, s92
    s_cmp_eq_u32 s15, s48
    s_cselect_b32 s14, s14, 0
    s_addc_u32 s93, s93, 0
    s_add_u32 s94, s94, s14
    s_sub_u32 s16, s16, s92
    s_cmp_eq_u32 s17, s48
    s_cselect_b32 s16, s16, 0
    s_addc_u32 s93, s93, 0
    s_add_u32 s94, s94, s16
    s_sub_u32 s18, s18, s92
    s_cmp_eq_u32 s19, s48
    s_cselect_b32 s18, s18, 0
    s_addc_u32 s93, s93, 0
    s_add_u32 s94, s94, s18
    v_cvt_f32_u32 v15, s93
    v_cvt_f32_i32 v14, s94
    v_rcp_f32 v15, v15
    s_nop 0
    v_mul_f32 v14, v14, v15
    v_cvt_i32_f32 v14, v14
    s_sub_u32 s94, s82, 72
    s_addk_i32 s82, 96
    v_readfirstlane_b32 s92, v14
    s_mov_b32 s95, s85
    s_min_u32 s85, s93, 1
    s_cmp_eq_u32 s93, 0
    s_nop 1
    s_cbranch_scc1 L_hl
    s_sub_u32 s98, 0, s92
    s_max_i32 s99, s98, 0
    s_min_i32 s98, s98, 0
    s_add_u32 s99, s99, 6400
    s_sub_u32 s98, s98, 6400
    s_min_i32 s99, s99, 1048576
    s_max_i32 s98, s98, -1048576
    s_add_u32 s92, s92, s83
    s_sub_u32 s93, s92, s84
    s_mov_b32 s84, s92
    s_mul_hi_u32 s93, s93, 44739243
    s_cmp_eq_u32 s95, 0
    s_cselect_b32 s80, 850, s93
    s_max_u32 s80, s80, 1
    s_mul_i32 s93, s80, s94
    s_sub_u32 s79, s92, s93
    s_branch L_hl
L_prep:
    s_cmp_ge_u32 s86, 24
    s_cbranch_scc1 L_mrg
    ds_read_b128 v[24:27], v9
    ds_read_b128 v[28:31], v9 offset:16
    s_add_u32 s86, s86, 1
    s_sub_u32 s92, s86, 16
    v_mov_b32 v23, s92
    s_waitcnt lgkmcnt(0)
    v_max_f32 v40, v24, v26
    v_max3_f32 v40, v40, v28, v30
    v_lshlrev_b32 v32, 16, v25
    v_lshlrev_b32 v33, 16, v27
    v_lshlrev_b32 v34, 16, v29
    v_lshlrev_b32 v35, 16, v31
    v_max_f32_dpp v40, v40, v40 quad_perm:[1,0,3,2] row_mask:0xf bank_mask:0xf
    s_nop 1
    v_max_f32_dpp v40, v40, v40 quad_perm:[2,3,0,1] row_mask:0xf bank_mask:0xf
    s_nop 1
    v_max_f32_dpp v40, v40, v40 row_half_mirror row_mask:0xf bank_mask:0xf
    s_nop 1
    v_max_f32_dpp v40, v40, v40 row_mirror row_mask:0xf bank_mask:0xf
    v_and_b32 v36, 0xffff0000, v25
    v_and_b32 v37, 0xffff0000, v27
    v_and_b32 v38, 0xffff0000, v29
    v_and_b32 v39, 0xffff0000, v31
    v_mov_b32 v6, v40
    s_nop 1
    v_permlane16_swap_b32 v40, v6
    v_max_f32 v40, v40, v6
    v_sub_f32 v24, v24, v40
    v_sub_f32 v26, v26, v40
    v_sub_f32 v28, v28, v40
    v_sub_f32 v30, v30, v40
    v_exp_f32 v24, v24
    v_exp_f32 v26, v26
    v_exp_f32 v28, v28
    v_exp_f32 v30, v30
    v_add_f32 v42, v24, v26
    v_add_f32 v6, v28, v30
    v_add_f32 v42, v42, v6
    v_mul_f32 v24, v24, v32
    v_mul_f32 v26, v26, v33
    v_mul_f32 v28, v28, v34
    v_mul_f32 v30, v30, v35
    ds_write_b128 v9, v[24:27]
    ds_write_b128 v9, v[28:31] offset:16
    v_mul_f32 v41, v24, v36
    v_fmac_f32 v41, v26, v37
    v_fmac_f32 v41, v28, v38
    v_fmac_f32 v41, v30, v39
    v_add_f32_dpp v42, v42, v42 quad_perm:[1,0,3,2] row_mask:0xf bank_mask:0xf
    s_nop 0
    v_add_f32_dpp v41, v41, v41 quad_perm:[1,0,3,2] row_mask:0xf bank_mask:0xf
    v_add_f32_dpp v42, v42, v42 quad_perm:[2,3,0,1] row_mask:0xf bank_mask:0xf
    s_nop 0
    v_add_f32_dpp v41, v41, v41 quad_perm:[2,3,0,1] row_mask:0xf bank_mask:0xf
    v_add_f32_dpp v42, v42, v42 row_half_mirror row_mask:0xf bank_mask:0xf
    s_nop 0
    v_add_f32_dpp v41, v41, v41 row_half_mirror row_mask:0xf bank_mask:0xf
    v_add_f32_dpp v42, v42, v42 row_mirror row_mask:0xf bank_mask:0xf
    s_nop 0
    v_add_f32_dpp v41, v41, v41 row_mirror row_mask:0xf bank_mask:0xf
    v_mov_b32 v6, v42
    s_nop 1
    v_permlane16_swap_b32 v42, v6
    v_add_f32 v42, v42, v6
    v_mov_b32 v6, v41
    s_nop 1
    v_permlane16_swap_b32 v41, v6
    v_add_f32 v41, v41, v6
    v_sub_f32 v41, 0, v41
    v_mov_b32 v43, v41
    ds_write_b128 v11, v[40:43]
    ds_write_b32 v3, v23 offset:52
    v_add_u32 v9, 2048, v9
    v_add_u32 v11, 32, v11
    s_cmp_eq_u32 s86, 24
    s_waitcnt lgkmcnt(0)
    s_cbranch_scc0 L_hl
    v_add_u32 v9, 49152, v2
    s_movk_i32 s39, 68
    v_add_u32 v18, 78080, v2
    s_mov_b64 exec, 0xffff
    ds_read_b128 v[24:27], v18
    s_lshl_b32 s92, s3, 7
    s_add_u32 s92, s92, s41
    s_lshl_b32 s92, s92, 8
    s_add_u32 s92, s92, 8388608
    s_waitcnt lgkmcnt(0)
    v_mov_b32 v25, s48
    v_mov_b32 v27, s48
    buffer_store_dwordx4 v[24:27], v2, s[20:23], s92 offen sc0 sc1
    s_mov_b64 exec, -1
    s_waitcnt vmcnt(0)
    s_branch L_hl
L_wts:
    s_bfe_u32 s92, s34, 0x10001
    s_lshl_b32 s92, s92, 15
    s_lshr_b32 s93, s34, 2
    s_lshl_b32 s93, s93, 5
    s_add_u32 s92, s92, s93
    s_and_b32 s93, s34, 1
    s_lshl4_add_u32 s92, s93, s92
    s_add_u32 s92, s92, 8388608
    s_add_u32 s93, s92, 16384
    v_lshlrev_b32 v18, 8, v1
    s_cmp_eq_u32 s33, 0
    s_nop 0
    s_cbranch_scc0 L_wt1
    buffer_load_dwordx4 v[24:27], v18, s[20:23], s92 offen
    buffer_load_dwordx4 v[28:31], v18, s[20:23], s93 offen
    s_branch L_wt2
L_wt1:
    buffer_load_dwordx4 v[24:27], v18, s[20:23], s92 offen sc0 sc1
    buffer_load_dwordx4 v[28:31], v18, s[20:23], s93 offen sc0 sc1
L_wt2:
    s_add_u32 s33, s33, 1
    s_add_u32 s40, s89, 24
    s_min_i32 s40, s40, 2856
    v_and_b32 v18, 7, v1
    v_lshlrev_b32 v18, 6, v18
    v_lshrrev_b32 v19, 3, v1
    v_lshl_add_u32 v18, v19, 2, v18
    s_waitcnt vmcnt(0)
    v_xor_b32 v23, s48, v25
    v_bitop3_b32 v23, v23, v27, s48 bitop3:0xf6
    v_bitop3_b32 v23, v23, v29, s48 bitop3:0xf6
    v_bitop3_b32 v23, v23, v31, s48 bitop3:0xf6
    v_cmp_ne_u32 vcc, 0, v23
    s_cmp_gt_u32 s33, 200000
    s_nop 3
    s_cbranch_scc1 L_wt3
    s_cbranch_vccnz L_hl
L_wt3:
    s_mov_b32 s40, 0x7fffffff
    v_max_f32 v23, v24, v28
    s_nop 1
    v_max_f32_dpp v23, v23, v23 quad_perm:[1,0,3,2] row_mask:0xf bank_mask:0xf
    s_nop 1
    v_max_f32_dpp v23, v23, v23 quad_perm:[2,3,0,1] row_mask:0xf bank_mask:0xf
    s_nop 1
    v_max_f32_dpp v23, v23, v23 row_half_mirror row_mask:0xf bank_mask:0xf
    s_nop 1
    v_max_f32_dpp v23, v23, v23 row_mirror row_mask:0xf bank_mask:0xf
    v_mov_b32 v6, v23
    s_nop 1
    v_permlane32_swap_b32 v23, v6
    v_max_f32 v23, v23, v6
    v_mov_b32 v6, v23
    s_nop 1
    v_permlane16_swap_b32 v23, v6
    v_max_f32 v23, v23, v6
    v_sub_f32 v24, v24, v23
    v_sub_f32 v28, v28, v23
    v_exp_f32 v24, v24
    v_exp_f32 v28, v28
    v_mul_f32 v23, v24, v26
    v_fmac_f32 v23, v28, v30
    s_nop 1
    v_add_f32_dpp v23, v23, v23 quad_perm:[1,0,3,2] row_mask:0xf bank_mask:0xf
    s_nop 1
    v_add_f32_dpp v23, v23, v23 quad_perm:[2,3,0,1] row_mask:0xf bank_mask:0xf
    s_nop 1
    v_add_f32_dpp v23, v23, v23 row_half_mirror row_mask:0xf bank_mask:0xf
    s_nop 1
    v_add_f32_dpp v23, v23, v23 row_mirror row_mask:0xf bank_mask:0xf
    v_mov_b32 v6, v23
    s_nop 1
    v_permlane32_swap_b32 v23, v6
    v_add_f32 v23, v23, v6
    v_mov_b32 v6, v23
    s_nop 1
    v_permlane16_swap_b32 v23, v6
    v_add_f32 v23, v23, v6
    v_rcp_f32 v23, v23
    s_nop 0
    v_mul_f32 v24, v24, v23
    v_mul_f32 v28, v28, v23
    v_add_u32 v18, 78336, v18
    ds_write2_b32 v18, v24, v28 offset0:0 offset1:8
    v_mov_b32 v19, s48
    ds_write_b32 v3, v19 offset:24
    s_waitcnt lgkmcnt(0)
    s_branch L_hl
L_mrg:
    ds_read2_b32 v[120:121], v20 offset0:1 offset1:5
    ds_read_b128 v[88:91], v10 offset:0
    ds_read_b128 v[92:95], v10 offset:1536
    ds_read_b128 v[96:99], v10 offset:3072
    ds_read_b128 v[100:103], v10 offset:4608
    ds_read_b128 v[104:107], v10 offset:768
    ds_read_b128 v[108:111], v10 offset:2304
    ds_read_b128 v[112:115], v10 offset:3840
    ds_read_b128 v[116:119], v10 offset:5376
    s_add_u32 s86, s86, 1
    s_sub_u32 s92, s86, 24
    v_mov_b32 v23, s92
    ds_write_b32 v3, v23 offset:60
    s_bitcmp1_b32 s92, 0
    s_cselect_b32 s92, 1, -1
    s_mul_i32 s92, s92, 6144
    v_add_u32 v10, s92, v10
    v_add_u32 v20, 32, v20
    s_cmp_eq_u32 s86, 31
    s_cselect_b32 s86, 14, s86
    s_waitcnt lgkmcnt(0)
    v_pk_add_f32 v[88:89], v[88:89], v[120:121] op_sel:[0,0] op_sel_hi:[1,0]
    v_pk_add_f32 v[90:91], v[90:91], v[120:121] op_sel:[0,0] op_sel_hi:[1,0]
    v_pk_add_f32 v[92:93], v[92:93], v[96:97]
    v_pk_add_f32 v[94:95], v[94:95], v[98:99]
    v_pk_add_f32 v[88:89], v[88:89], v[100:101]
    v_pk_add_f32 v[90:91], v[90:91], v[102:103]
    v_pk_add_f32 v[88:89], v[88:89], v[92:93]
    v_pk_add_f32 v[90:91], v[90:91], v[94:95]
    v_bfi_b32 v80, v5, s48, v88
    v_bfi_b32 v81, v5, s49, v89
    v_bfi_b32 v82, v5, s50, v90
    v_bfi_b32 v83, v5, s51, v91
    v_pk_add_f32 v[104:105], v[104:105], v[120:121] op_sel:[0,1] op_sel_hi:[1,1]
    v_pk_add_f32 v[106:107], v[106:107], v[120:121] op_sel:[0,1] op_sel_hi:[1,1]
    v_pk_add_f32 v[108:109], v[108:109], v[112:113]
    v_pk_add_f32 v[110:111], v[110:111], v[114:115]
    v_pk_add_f32 v[104:105], v[104:105], v[116:117]
    v_pk_add_f32 v[106:107], v[106:107], v[118:119]
    v_pk_add_f32 v[104:105], v[104:105], v[108:109]
    v_pk_add_f32 v[106:107], v[106:107], v[110:111]
    v_bfi_b32 v84, v5, s48, v104
    v_bfi_b32 v85, v5, s49, v105
    v_bfi_b32 v86, v5, s50, v106
    v_bfi_b32 v87, v5, s51, v107
    ds_write_b128 v9, v[80:83]
    ds_write_b128 v9, v[84:87] offset:1024
    v_add_u32 v9, 2048, v9
    s_waitcnt lgkmcnt(0)
    s_nop 0
    s_branch L_hl
L_late:
    s_getpc_b64 s[92:93]
L_pc2:
    s_sub_u32 s92, s92, L_pc2-L_late
    s_subb_u32 s93, s93, 0
    v_lshlrev_b32 v19, 7, v1
    v_min_u32 v23, L_end-L_late, v19
    global_load_dword v6, v23, s[92:93]
    s_lshl_b32 s92, s3, 8
    s_add_u32 s32, s41, s92
    s_mul_i32 s32, s32, 768
    s_add_u32 s94, s32, 98304
    s_add_u32 s39, s32, 2752512
    s_add_u32 s40, s94, 2752512
    s_mul_i32 s42, s80, 3072
    s_add_u32 s42, s42, s79
    s_cmp_eq_u32 s80, 0
    s_cselect_b32 s42, -2, s42
    s_min_u32 s42, s42, -2
    v_add_u32 v9, 49152, v2
    ds_read_b128 v[24:27], v9 offset:0
    ds_read_b128 v[28:31], v9 offset:1024
    ds_read_b128 v[32:35], v9 offset:2048
    ds_read_b128 v[36:39], v9 offset:3072
    ds_read_b128 v[40:43], v9 offset:4096
    ds_read_b128 v[44:47], v9 offset:5120
    ds_read_b128 v[48:51], v9 offset:6144
    ds_read_b128 v[52:55], v9 offset:7168
    ds_read_b128 v[56:59], v9 offset:8192
    ds_read_b128 v[60:63], v9 offset:9216
    s_waitcnt lgkmcnt(0)
    ds_read_b128 v[64:67], v9 offset:10240
    ds_read_b128 v[68:71], v9 offset:11264
    ds_read_b128 v[72:75], v9 offset:12288
    ds_read_b128 v[76:79], v9 offset:13312
    ds_read2_b32 v[120:121], v20 offset0:1 offset1:5
    s_mov_b32 exec_hi, 0xffff
L_w70:
    ds_read_b32 v19, v7
    ds_read_b128 v[88:91], v10 offset:0
    ds_read_b128 v[92:95], v10 offset:1536
    ds_read_b128 v[96:99], v10 offset:3072
    ds_read_b128 v[100:103], v10 offset:4608
    s_memrealtime s[96:97]
    s_waitcnt lgkmcnt(0)
    v_readlane_b32 s92, v19, 31
    v_readlane_b32 s89, v19, 5
    s_bitcmp1_b32 s92, 2
    s_nop 3
    s_cbranch_scc1 L_g70
    s_sub_u32 s96, s96, s78
    s_lshl_b32 s96, s96, 8
    s_mul_i32 s92, s80, s89
    s_add_u32 s92, s92, s79
    s_sub_u32 s92, s96, s92
    s_max_i32 s92, s92, s98
    s_min_i32 s92, s92, s99
    s_mul_i32 s92, s92, 250
    s_add_u32 s92, s92, 21495808
    s_ashr_i32 s92, s92, 20
    s_max_i32 s92, s92, 15
    s_min_i32 s92, s92, 26
    v_mov_b32 v18, s92
    ds_write_b32 v3, v18 offset:16
    s_cmp_lt_u32 s96, s42
    s_cbranch_scc1 L_w70
    buffer_store_dwordx4 v[24:27], v2, s[20:23], s32 offen sc0 sc1
    buffer_store_dwordx4 v[28:31], v2, s[20:23], s94 offen sc0 sc1
    s_add_u32 s32, s32, 393216
    s_add_u32 s94, s94, 393216
    buffer_store_dwordx4 v[32:35], v2, s[20:23], s32 offen sc0 sc1
    buffer_store_dwordx4 v[36:39], v2, s[20:23], s94 offen sc0 sc1
    s_add_u32 s32, s32, 393216
    s_add_u32 s94, s94, 393216
    buffer_store_dwordx4 v[40:43], v2, s[20:23], s32 offen sc0 sc1
    buffer_store_dwordx4 v[44:47], v2, s[20:23], s94 offen sc0 sc1
    s_add_u32 s32, s32, 393216
    s_add_u32 s94, s94, 393216
    buffer_store_dwordx4 v[48:51], v2, s[20:23], s32 offen sc0 sc1
    buffer_store_dwordx4 v[52:55], v2, s[20:23], s94 offen sc0 sc1
    s_add_u32 s32, s32, 393216
    s_add_u32 s94, s94, 393216
    buffer_store_dwordx4 v[56:59], v2, s[20:23], s32 offen sc0 sc1
    buffer_store_dwordx4 v[60:63], v2, s[20:23], s94 offen sc0 sc1
    s_add_u32 s32, s32, 393216
    s_add_u32 s94, s94, 393216
    buffer_store_dwordx4 v[64:67], v2, s[20:23], s32 offen sc0 sc1
    buffer_store_dwordx4 v[68:71], v2, s[20:23], s94 offen sc0 sc1
    s_add_u32 s32, s32, 393216
    s_add_u32 s94, s94, 393216
    buffer_store_dwordx4 v[72:75], v2, s[20:23], s32 offen sc0 sc1
    buffer_store_dwordx4 v[76:79], v2, s[20:23], s94 offen sc0 sc1
    s_mov_b32 s42, -1
    s_nop 0
    s_branch L_w70
L_g70:
    v_pk_add_f32 v[88:89], v[88:89], v[120:121] op_sel:[0,0] op_sel_hi:[1,0]
    v_pk_add_f32 v[90:91], v[90:91], v[120:121] op_sel:[0,0] op_sel_hi:[1,0]
    v_pk_add_f32 v[92:93], v[92:93], v[96:97]
    v_pk_add_f32 v[94:95], v[94:95], v[98:99]
    v_pk_add_f32 v[88:89], v[88:89], v[100:101]
    v_pk_add_f32 v[90:91], v[90:91], v[102:103]
    v_pk_add_f32 v[88:89], v[88:89], v[92:93]
    v_pk_add_f32 v[90:91], v[90:91], v[94:95]
    v_bfi_b32 v80, v5, s48, v88
    v_bfi_b32 v81, v5, s49, v89
    v_bfi_b32 v82, v5, s50, v90
    v_bfi_b32 v83, v5, s51, v91
    buffer_store_dwordx4 v[80:83], v2, s[20:23], s39 offen sc0 sc1
    s_nop 1
L_w71:
    ds_read_b32 v19, v7
    ds_read_b128 v[104:107], v10 offset:768
    ds_read_b128 v[108:111], v10 offset:2304
    ds_read_b128 v[112:115], v10 offset:3840
    ds_read_b128 v[116:119], v10 offset:5376
    s_memrealtime s[96:97]
    s_waitcnt lgkmcnt(0)
    v_readlane_b32 s92, v19, 31
    v_readlane_b32 s89, v19, 5
    s_bitcmp1_b32 s92, 6
    s_nop 3
    s_cbranch_scc1 L_g71
    s_sub_u32 s96, s96, s78
    s_lshl_b32 s96, s96, 8
    s_cmp_lt_u32 s96, s42
    s_cbranch_scc1 L_w71
    buffer_store_dwordx4 v[24:27], v2, s[20:23], s32 offen sc0 sc1
    buffer_store_dwordx4 v[28:31], v2, s[20:23], s94 offen sc0 sc1
    s_add_u32 s32, s32, 393216
    s_add_u32 s94, s94, 393216
    buffer_store_dwordx4 v[32:35], v2, s[20:23], s32 offen sc0 sc1
    buffer_store_dwordx4 v[36:39], v2, s[20:23], s94 offen sc0 sc1
    s_add_u32 s32, s32, 393216
    s_add_u32 s94, s94, 393216
    buffer_store_dwordx4 v[40:43], v2, s[20:23], s32 offen sc0 sc1
    buffer_store_dwordx4 v[44:47], v2, s[20:23], s94 offen sc0 sc1
    s_add_u32 s32, s32, 393216
    s_add_u32 s94, s94, 393216
    buffer_store_dwordx4 v[48:51], v2, s[20:23], s32 offen sc0 sc1
    buffer_store_dwordx4 v[52:55], v2, s[20:23], s94 offen sc0 sc1
    s_add_u32 s32, s32, 393216
    s_add_u32 s94, s94, 393216
    buffer_store_dwordx4 v[56:59], v2, s[20:23], s32 offen sc0 sc1
    buffer_store_dwordx4 v[60:63], v2, s[20:23], s94 offen sc0 sc1
    s_add_u32 s32, s32, 393216
    s_add_u32 s94, s94, 393216
    buffer_store_dwordx4 v[64:67], v2, s[20:23], s32 offen sc0 sc1
    buffer_store_dwordx4 v[68:71], v2, s[20:23], s94 offen sc0 sc1
    s_add_u32 s32, s32, 393216
    s_add_u32 s94, s94, 393216
    buffer_store_dwordx4 v[72:75], v2, s[20:23], s32 offen sc0 sc1
    buffer_store_dwordx4 v[76:79], v2, s[20:23], s94 offen sc0 sc1
    s_mov_b32 s42, -1
    s_nop 0
    s_branch L_w71
L_g71:
    v_pk_add_f32 v[104:105], v[104:105], v[120:121] op_sel:[0,1] op_sel_hi:[1,1]
    v_pk_add_f32 v[106:107], v[106:107], v[120:121] op_sel:[0,1] op_sel_hi:[1,1]
    v_pk_add_f32 v[108:109], v[108:109], v[112:113]
    v_pk_add_f32 v[110:111], v[110:111], v[114:115]
    v_pk_add_f32 v[104:105], v[104:105], v[116:117]
    v_pk_add_f32 v[106:107], v[106:107], v[118:119]
    v_pk_add_f32 v[104:105], v[104:105], v[108:109]
    v_pk_add_f32 v[106:107], v[106:107], v[110:111]
    v_bfi_b32 v84, v5, s48, v104
    v_bfi_b32 v85, v5, s49, v105
    v_bfi_b32 v86, v5, s50, v106
    v_bfi_b32 v87, v5, s51, v107
    buffer_store_dwordx4 v[84:87], v2, s[20:23], s40 offen sc0 sc1
    s_cmp_eq_u32 s42, -1
    s_nop 0
    s_cbranch_scc1 L_hend
    buffer_store_dwordx4 v[24:27], v2, s[20:23], s32 offen sc0 sc1
    buffer_store_dwordx4 v[28:31], v2, s[20:23], s94 offen sc0 sc1
    s_add_u32 s32, s32, 393216
    s_add_u32 s94, s94, 393216
    buffer_store_dwordx4 v[32:35], v2, s[20:23], s32 offen sc0 sc1
    buffer_store_dwordx4 v[36:39], v2, s[20:23], s94 offen sc0 sc1
    s_add_u32 s32, s32, 393216
    s_add_u32 s94, s94, 393216
    buffer_store_dwordx4 v[40:43], v2, s[20:23], s32 offen sc0 sc1
    buffer_store_dwordx4 v[44:47], v2, s[20:23], s94 offen sc0 sc1
    s_add_u32 s32, s32, 393216
    s_add_u32 s94, s94, 393216
    buffer_store_dwordx4 v[48:51], v2, s[20:23], s32 offen sc0 sc1
    buffer_store_dwordx4 v[52:55], v2, s[20:23], s94 offen sc0 sc1
    s_add_u32 s32, s32, 393216
    s_add_u32 s94, s94, 393216
    buffer_store_dwordx4 v[56:59], v2, s[20:23], s32 offen sc0 sc1
    buffer_store_dwordx4 v[60:63], v2, s[20:23], s94 offen sc0 sc1
    s_add_u32 s32, s32, 393216
    s_add_u32 s94, s94, 393216
    buffer_store_dwordx4 v[64:67], v2, s[20:23], s32 offen sc0 sc1
    buffer_store_dwordx4 v[68:71], v2, s[20:23], s94 offen sc0 sc1
    s_add_u32 s32, s32, 393216
    s_add_u32 s94, s94, 393216
    buffer_store_dwordx4 v[72:75], v2, s[20:23], s32 offen sc0 sc1
    buffer_store_dwordx4 v[76:79], v2, s[20:23], s94 offen sc0 sc1
    s_mov_b32 s42, -1
    s_nop 0
L_hend:
    s_waitcnt vmcnt(0)
    ds_write_b32 v3, v5 offset:32
    s_waitcnt lgkmcnt(0)
L_end:
    s_endpgm
.section .rodata,"a"
.p2align 6
.amdhsa_kernel standalone__kv_cache_quant_pre_rope_vs_post_rope__decode_kernel
  .amdhsa_next_free_vgpr 168
  .amdhsa_next_free_sgpr 102
  .amdhsa_accum_offset 168
  .amdhsa_group_segment_fixed_size 0
  .amdhsa_kernarg_size 112
  .amdhsa_user_sgpr_count 2
  .amdhsa_user_sgpr_kernarg_segment_ptr 1
  .amdhsa_system_sgpr_workgroup_id_x 1
.end_amdhsa_kernel
```

```asm
; @launch grid=(256,1,1) block=(384,1,1) lds=79872
.amdgcn_target "amdgcn-amd-amdhsa--gfx950"
.text
.globl standalone__kv_cache_quant_pre_rope_vs_post_rope__decode_kernel
.p2align 8
.type standalone__kv_cache_quant_pre_rope_vs_post_rope__decode_kernel,@function
standalone__kv_cache_quant_pre_rope_vs_post_rope__decode_kernel:
    s_load_dwordx16 s[48:63], s[0:1], 0
    s_load_dwordx8 s[64:71], s[0:1], 64
    s_load_dwordx4 s[72:75], s[0:1], 96
    s_cmp_ge_u32 s2, 256
    s_cbranch_scc1 L_end
    v_lshrrev_b32 v18, 6, v0
    v_and_b32 v1, 63, v0
    v_readfirstlane_b32 s76, v18
    v_cmp_eq_u32 vcc, 4, v1
    v_lshlrev_b32 v7, 2, v1
    v_add_u32 v7, 77824, v7
    v_cndmask_b32 v19, 0, 20, vcc
    ds_write_b32 v7, v19
    s_and_b32 s92, s2, 7
    s_lshl_b32 s77, s92, 6
    s_and_b32 s92, s2, 0x60
    s_lshl4_add_u32 s77, s92, s77
    s_and_b32 s92, s2, 0x10
    s_lshl1_add_u32 s77, s92, s77
    s_lshr_b32 s92, s2, 7
    s_lshl4_add_u32 s77, s92, s77
    s_bfe_u32 s3, s2, 0x10003
    s_mul_i32 s92, s3, 8192
    s_add_u32 s77, s77, s92
    s_cmp_lg_u32 s76, 0
    s_cbranch_scc1 L_other
    s_setprio 3
    v_lshlrev_b32 v2, 4, v1
    v_add_u32 v8, 784896, v2
    v_cmp_gt_u32 vcc, 32, v1
    s_mul_i32 s78, s77, 384
    s_mov_b32 s6, 6291456
    s_mov_b32 s7, 0x20000
    v_cndmask_b32 v4, v8, v2, vcc
    s_mov_b32 m0, 0
    s_mov_b32 s81, 0
    v_mov_b32 v6, 77844
    v_mov_b32 v5, -20
    s_waitcnt lgkmcnt(0)
    s_mov_b64 s[4:5], s[66:67]
L_i0:
    s_waitcnt vmcnt(19)
    buffer_load_dwordx4 v2, s[4:7], s78 offen offset:0  lds
    v_add_u32 v5, 3, v5
    s_add_u32 s81, s81, 1
    s_waitcnt vmcnt(19)
    buffer_load_dwordx4 v4, s[4:7], s78 offen offset:1024  lds
    s_and_b32 s92, s81, 3
    s_cselect_b32 s92, 0, -6144
    s_cmp_eq_u32 s81, 8
    s_cselect_b32 s93, 1572864, 0
    s_add_u32 s92, s92, s93
    s_bitcmp1_b32 s81, 2
    s_waitcnt vmcnt(19)
    buffer_load_dwordx4 v8, s[4:7], s78 offen offset:2048  lds
    ds_write_b32 v6, v5
    s_cselect_b64 s[4:5], s[68:69], s[66:67]
    s_addk_i32 m0, 3072
    s_addk_i32 s92, 1536
    s_add_u32 s78, s78, s92
    s_cmp_lg_u32 s81, 6
    s_cbranch_scc1 L_i1
    s_barrier
L_i1:
    s_cmp_lt_u32 s81, 16
    s_cbranch_scc1 L_i0
    ds_read_b32 v3, v7
    s_mul_i32 s79, s3, 12582912
    s_mov_b64 s[4:5], s[50:51]
    s_mov_b32 s6, 402653184
    s_mov_b32 s7, 0x20000
    s_mov_b32 m0, 0
    s_movk_i32 s85, 4096
    s_mov_b32 s81, 0
    s_mul_i32 s78, s77, 768
    s_add_u32 s78, s78, s79
    s_mov_b32 s82, 1
    s_waitcnt lgkmcnt(0)
    v_readlane_b32 s84, v3, 0
    s_nop 4
L_D20:
    s_mul_i32 s92, s81, 12
    s_add_u32 s92, s92, 28
    v_mov_b32 v5, s92
L_B20:
L_B20_0:
    s_cmp_lt_i32 s84, s82
    s_cbranch_scc1 L_B20_0w
    s_waitcnt vmcnt(19)
    buffer_load_dwordx4 v2, s[4:7], s78 offen offset:0 nt lds
    v_add_u32 v5, 3, v5
    s_add_u32 s81, s81, 1
    s_and_b32 s92, s81, 7
    s_waitcnt vmcnt(19)
    buffer_load_dwordx4 v2, s[4:7], s78 offen offset:1024 nt lds
    v_readlane_b32 s84, v3, 1
    ds_read_b32 v3, v7
    s_lshl_b32 s92, s92, 11
    s_waitcnt vmcnt(19)
    buffer_load_dwordx4 v2, s[4:7], s78 offen offset:2048 nt lds
    ds_write_b32 v6, v5
    s_add_u32 s92, s92, s77
    s_and_b32 s92, s92, 16383
L_B20_1:
    s_cmp_lt_i32 s84, s82
    s_cbranch_scc1 L_B20_1w
    s_waitcnt vmcnt(19)
    buffer_load_dwordx4 v2, s[4:7], s78 offen offset:3072 nt lds
    v_add_u32 v5, 3, v5
    s_add_u32 m0, m0, s85
    s_add_u32 s78, s78, s85
    s_waitcnt vmcnt(19)
    buffer_load_dwordx4 v2, s[4:7], s78 offen offset:0 nt lds
    v_readlane_b32 s84, v3, 2
    ds_read_b32 v3, v7
    s_mul_i32 s80, s92, 768
    s_waitcnt vmcnt(19)
    buffer_load_dwordx4 v2, s[4:7], s78 offen offset:1024 nt lds
    ds_write_b32 v6, v5
    s_bfe_u32 s92, s81, 0x40003
    s_mul_i32 s92, s92, 25165824
L_B20_2:
    s_cmp_lt_i32 s84, s82
    s_cbranch_scc1 L_B20_2w
    s_waitcnt vmcnt(19)
    buffer_load_dwordx4 v2, s[4:7], s78 offen offset:2048 nt lds
    v_add_u32 v5, 3, v5
    s_add_u32 s80, s80, s79
    s_add_u32 s80, s80, s92
    s_waitcnt vmcnt(19)
    buffer_load_dwordx4 v2, s[4:7], s78 offen offset:3072 nt lds
    v_readlane_b32 s84, v3, 3
    ds_read_b32 v3, v7
    s_add_u32 m0, m0, s85
    s_add_u32 s78, s78, s85
    s_waitcnt vmcnt(19)
    buffer_load_dwordx4 v2, s[4:7], s78 offen offset:0 nt lds
    ds_write_b32 v6, v5
    s_and_b32 s86, s81, 3
    s_mul_i32 s86, s86, 12288
L_B20_3:
    s_cmp_lt_i32 s84, s82
    s_cbranch_scc1 L_B20_3w
    s_waitcnt vmcnt(19)
    buffer_load_dwordx4 v2, s[4:7], s78 offen offset:1024 nt lds
    v_add_u32 v5, 3, v5
    v_readlane_b32 s83, v3, 4
    s_waitcnt vmcnt(19)
    buffer_load_dwordx4 v2, s[4:7], s78 offen offset:2048 nt lds
    v_readlane_b32 s84, v3, 0
    ds_read_b32 v3, v7
    s_add_u32 s82, s82, 1
    s_cmp_ge_u32 s81, 255
    s_cselect_b32 s83, -1, s83
    s_cmp_ge_u32 s81, 128
    s_waitcnt vmcnt(19)
    buffer_load_dwordx4 v2, s[4:7], s78 offen offset:3072 nt lds
    ds_write_b32 v6, v5
    s_cselect_b64 s[4:5], s[56:57], s[50:51]
    s_mov_b32 m0, s86
    s_mov_b32 s78, s80
    s_cmp_eq_u32 s83, 20
    s_cbranch_scc1 L_B20
L_disp:
    s_cmp_eq_u32 s83, 20
    s_cbranch_scc1 L_D20
    s_cmp_eq_u32 s83, 21
    s_cbranch_scc1 L_D21
    s_cmp_eq_u32 s83, 19
    s_cbranch_scc1 L_D19
    s_cmp_eq_u32 s83, 22
    s_cbranch_scc1 L_D22
    s_cmp_eq_u32 s83, 18
    s_cbranch_scc1 L_D18
    s_cmp_eq_u32 s83, 23
    s_cbranch_scc1 L_D23
    s_cmp_eq_u32 s83, 17
    s_cbranch_scc1 L_D17
    s_cmp_eq_u32 s83, 24
    s_cbranch_scc1 L_D24
    s_cmp_eq_u32 s83, 16
    s_cbranch_scc1 L_D16
    s_cmp_eq_u32 s83, 25
    s_cbranch_scc1 L_D25
    s_cmp_eq_u32 s81, 256
    s_cbranch_scc1 L_drain
    s_cmp_ge_u32 s81, 255
    s_cbranch_scc1 L_D32
    s_cmp_ge_i32 s83, 26
    s_cbranch_scc1 L_D26
    s_branch L_D15
L_D19:
    s_mul_i32 s92, s81, 12
    s_add_u32 s92, s92, 29
    v_mov_b32 v5, s92
L_B19:
L_B19_0:
    s_cmp_lt_i32 s84, s82
    s_cbranch_scc1 L_B19_0w
    s_waitcnt vmcnt(18)
    buffer_load_dwordx4 v2, s[4:7], s78 offen offset:0 nt lds
    v_add_u32 v5, 3, v5
    s_add_u32 s81, s81, 1
    s_and_b32 s92, s81, 7
    s_waitcnt vmcnt(18)
    buffer_load_dwordx4 v2, s[4:7], s78 offen offset:1024 nt lds
    v_readlane_b32 s84, v3, 1
    ds_read_b32 v3, v7
    s_lshl_b32 s92, s92, 11
    s_waitcnt vmcnt(18)
    buffer_load_dwordx4 v2, s[4:7], s78 offen offset:2048 nt lds
    ds_write_b32 v6, v5
    s_add_u32 s92, s92, s77
    s_and_b32 s92, s92, 16383
L_B19_1:
    s_cmp_lt_i32 s84, s82
    s_cbranch_scc1 L_B19_1w
    s_waitcnt vmcnt(18)
    buffer_load_dwordx4 v2, s[4:7], s78 offen offset:3072 nt lds
    v_add_u32 v5, 3, v5
    s_add_u32 m0, m0, s85
    s_add_u32 s78, s78, s85
    s_waitcnt vmcnt(18)
    buffer_load_dwordx4 v2, s[4:7], s78 offen offset:0 nt lds
    v_readlane_b32 s84, v3, 2
    ds_read_b32 v3, v7
    s_mul_i32 s80, s92, 768
    s_waitcnt vmcnt(18)
    buffer_load_dwordx4 v2, s[4:7], s78 offen offset:1024 nt lds
    ds_write_b32 v6, v5
    s_bfe_u32 s92, s81, 0x40003
    s_mul_i32 s92, s92, 25165824
L_B19_2:
    s_cmp_lt_i32 s84, s82
    s_cbranch_scc1 L_B19_2w
    s_waitcnt vmcnt(18)
    buffer_load_dwordx4 v2, s[4:7], s78 offen offset:2048 nt lds
    v_add_u32 v5, 3, v5
    s_add_u32 s80, s80, s79
    s_add_u32 s80, s80, s92
    s_waitcnt vmcnt(18)
    buffer_load_dwordx4 v2, s[4:7], s78 offen offset:3072 nt lds
    v_readlane_b32 s84, v3, 3
    ds_read_b32 v3, v7
    s_add_u32 m0, m0, s85
    s_add_u32 s78, s78, s85
    s_waitcnt vmcnt(18)
    buffer_load_dwordx4 v2, s[4:7], s78 offen offset:0 nt lds
    ds_write_b32 v6, v5
    s_and_b32 s86, s81, 3
    s_mul_i32 s86, s86, 12288
L_B19_3:
    s_cmp_lt_i32 s84, s82
    s_cbranch_scc1 L_B19_3w
    s_waitcnt vmcnt(18)
    buffer_load_dwordx4 v2, s[4:7], s78 offen offset:1024 nt lds
    v_add_u32 v5, 3, v5
    v_readlane_b32 s83, v3, 4
    s_waitcnt vmcnt(18)
    buffer_load_dwordx4 v2, s[4:7], s78 offen offset:2048 nt lds
    v_readlane_b32 s84, v3, 0
    ds_read_b32 v3, v7
    s_add_u32 s82, s82, 1
    s_cmp_ge_u32 s81, 255
    s_cselect_b32 s83, -1, s83
    s_cmp_ge_u32 s81, 128
    s_waitcnt vmcnt(18)
    buffer_load_dwordx4 v2, s[4:7], s78 offen offset:3072 nt lds
    ds_write_b32 v6, v5
    s_cselect_b64 s[4:5], s[56:57], s[50:51]
    s_mov_b32 m0, s86
    s_mov_b32 s78, s80
    s_cmp_eq_u32 s83, 19
    s_cbranch_scc1 L_B19
    s_cmp_eq_u32 s83, -1
    s_cbranch_scc1 L_D32
    s_cmp_eq_u32 s83, 20
    s_cbranch_scc1 L_D20
    s_cmp_eq_u32 s83, 18
    s_cbranch_scc1 L_D18
    s_branch L_disp
L_D21:
    s_mul_i32 s92, s81, 12
    s_add_u32 s92, s92, 27
    v_mov_b32 v5, s92
L_B21:
L_B21_0:
    s_cmp_lt_i32 s84, s82
    s_cbranch_scc1 L_B21_0w
    s_waitcnt vmcnt(20)
    buffer_load_dwordx4 v2, s[4:7], s78 offen offset:0 nt lds
    v_add_u32 v5, 3, v5
    s_add_u32 s81, s81, 1
    s_and_b32 s92, s81, 7
    s_waitcnt vmcnt(20)
    buffer_load_dwordx4 v2, s[4:7], s78 offen offset:1024 nt lds
    v_readlane_b32 s84, v3, 1
    ds_read_b32 v3, v7
    s_lshl_b32 s92, s92, 11
    s_waitcnt vmcnt(20)
    buffer_load_dwordx4 v2, s[4:7], s78 offen offset:2048 nt lds
    ds_write_b32 v6, v5
    s_add_u32 s92, s92, s77
    s_and_b32 s92, s92, 16383
L_B21_1:
    s_cmp_lt_i32 s84, s82
    s_cbranch_scc1 L_B21_1w
    s_waitcnt vmcnt(20)
    buffer_load_dwordx4 v2, s[4:7], s78 offen offset:3072 nt lds
    v_add_u32 v5, 3, v5
    s_add_u32 m0, m0, s85
    s_add_u32 s78, s78, s85
    s_waitcnt vmcnt(20)
    buffer_load_dwordx4 v2, s[4:7], s78 offen offset:0 nt lds
    v_readlane_b32 s84, v3, 2
    ds_read_b32 v3, v7
    s_mul_i32 s80, s92, 768
    s_waitcnt vmcnt(20)
    buffer_load_dwordx4 v2, s[4:7], s78 offen offset:1024 nt lds
    ds_write_b32 v6, v5
    s_bfe_u32 s92, s81, 0x40003
    s_mul_i32 s92, s92, 25165824
L_B21_2:
    s_cmp_lt_i32 s84, s82
    s_cbranch_scc1 L_B21_2w
    s_waitcnt vmcnt(20)
    buffer_load_dwordx4 v2, s[4:7], s78 offen offset:2048 nt lds
    v_add_u32 v5, 3, v5
    s_add_u32 s80, s80, s79
    s_add_u32 s80, s80, s92
    s_waitcnt vmcnt(20)
    buffer_load_dwordx4 v2, s[4:7], s78 offen offset:3072 nt lds
    v_readlane_b32 s84, v3, 3
    ds_read_b32 v3, v7
    s_add_u32 m0, m0, s85
    s_add_u32 s78, s78, s85
    s_waitcnt vmcnt(20)
    buffer_load_dwordx4 v2, s[4:7], s78 offen offset:0 nt lds
    ds_write_b32 v6, v5
    s_and_b32 s86, s81, 3
    s_mul_i32 s86, s86, 12288
L_B21_3:
    s_cmp_lt_i32 s84, s82
    s_cbranch_scc1 L_B21_3w
    s_waitcnt vmcnt(20)
    buffer_load_dwordx4 v2, s[4:7], s78 offen offset:1024 nt lds
    v_add_u32 v5, 3, v5
    v_readlane_b32 s83, v3, 4
    s_waitcnt vmcnt(20)
    buffer_load_dwordx4 v2, s[4:7], s78 offen offset:2048 nt lds
    v_readlane_b32 s84, v3, 0
    ds_read_b32 v3, v7
    s_add_u32 s82, s82, 1
    s_cmp_ge_u32 s81, 255
    s_cselect_b32 s83, -1, s83
    s_cmp_ge_u32 s81, 128
    s_waitcnt vmcnt(20)
    buffer_load_dwordx4 v2, s[4:7], s78 offen offset:3072 nt lds
    ds_write_b32 v6, v5
    s_cselect_b64 s[4:5], s[56:57], s[50:51]
    s_mov_b32 m0, s86
    s_mov_b32 s78, s80
    s_cmp_eq_u32 s83, 21
    s_cbranch_scc1 L_B21
    s_cmp_eq_u32 s83, -1
    s_cbranch_scc1 L_D32
    s_cmp_eq_u32 s83, 20
    s_cbranch_scc1 L_D20
    s_cmp_eq_u32 s83, 22
    s_cbranch_scc1 L_D22
    s_branch L_disp
L_D18:
    s_mul_i32 s92, s81, 12
    s_add_u32 s92, s92, 30
    v_mov_b32 v5, s92
L_B18:
L_B18_0:
    s_cmp_lt_i32 s84, s82
    s_cbranch_scc1 L_B18_0w
    s_waitcnt vmcnt(17)
    buffer_load_dwordx4 v2, s[4:7], s78 offen offset:0 nt lds
    v_add_u32 v5, 3, v5
    s_add_u32 s81, s81, 1
    s_and_b32 s92, s81, 7
    s_waitcnt vmcnt(17)
    buffer_load_dwordx4 v2, s[4:7], s78 offen offset:1024 nt lds
    v_readlane_b32 s84, v3, 1
    ds_read_b32 v3, v7
    s_lshl_b32 s92, s92, 11
    s_waitcnt vmcnt(17)
    buffer_load_dwordx4 v2, s[4:7], s78 offen offset:2048 nt lds
    ds_write_b32 v6, v5
    s_add_u32 s92, s92, s77
    s_and_b32 s92, s92, 16383
L_B18_1:
    s_cmp_lt_i32 s84, s82
    s_cbranch_scc1 L_B18_1w
    s_waitcnt vmcnt(17)
    buffer_load_dwordx4 v2, s[4:7], s78 offen offset:3072 nt lds
    v_add_u32 v5, 3, v5
    s_add_u32 m0, m0, s85
    s_add_u32 s78, s78, s85
    s_waitcnt vmcnt(17)
    buffer_load_dwordx4 v2, s[4:7], s78 offen offset:0 nt lds
    v_readlane_b32 s84, v3, 2
    ds_read_b32 v3, v7
    s_mul_i32 s80, s92, 768
    s_waitcnt vmcnt(17)
    buffer_load_dwordx4 v2, s[4:7], s78 offen offset:1024 nt lds
    ds_write_b32 v6, v5
    s_bfe_u32 s92, s81, 0x40003
    s_mul_i32 s92, s92, 25165824
L_B18_2:
    s_cmp_lt_i32 s84, s82
    s_cbranch_scc1 L_B18_2w
    s_waitcnt vmcnt(17)
    buffer_load_dwordx4 v2, s[4:7], s78 offen offset:2048 nt lds
    v_add_u32 v5, 3, v5
    s_add_u32 s80, s80, s79
    s_add_u32 s80, s80, s92
    s_waitcnt vmcnt(17)
    buffer_load_dwordx4 v2, s[4:7], s78 offen offset:3072 nt lds
    v_readlane_b32 s84, v3, 3
    ds_read_b32 v3, v7
    s_add_u32 m0, m0, s85
    s_add_u32 s78, s78, s85
    s_waitcnt vmcnt(17)
    buffer_load_dwordx4 v2, s[4:7], s78 offen offset:0 nt lds
    ds_write_b32 v6, v5
    s_and_b32 s86, s81, 3
    s_mul_i32 s86, s86, 12288
L_B18_3:
    s_cmp_lt_i32 s84, s82
    s_cbranch_scc1 L_B18_3w
    s_waitcnt vmcnt(17)
    buffer_load_dwordx4 v2, s[4:7], s78 offen offset:1024 nt lds
    v_add_u32 v5, 3, v5
    v_readlane_b32 s83, v3, 4
    s_waitcnt vmcnt(17)
    buffer_load_dwordx4 v2, s[4:7], s78 offen offset:2048 nt lds
    v_readlane_b32 s84, v3, 0
    ds_read_b32 v3, v7
    s_add_u32 s82, s82, 1
    s_cmp_ge_u32 s81, 255
    s_cselect_b32 s83, -1, s83
    s_cmp_ge_u32 s81, 128
    s_waitcnt vmcnt(17)
    buffer_load_dwordx4 v2, s[4:7], s78 offen offset:3072 nt lds
    ds_write_b32 v6, v5
    s_cselect_b64 s[4:5], s[56:57], s[50:51]
    s_mov_b32 m0, s86
    s_mov_b32 s78, s80
    s_cmp_eq_u32 s83, 18
    s_cbranch_scc1 L_B18
    s_cmp_eq_u32 s83, -1
    s_cbranch_scc1 L_D32
    s_cmp_eq_u32 s83, 19
    s_cbranch_scc1 L_D19
    s_cmp_eq_u32 s83, 17
    s_cbranch_scc1 L_D17
    s_branch L_disp
L_D22:
    s_mul_i32 s92, s81, 12
    s_add_u32 s92, s92, 26
    v_mov_b32 v5, s92
L_B22:
L_B22_0:
    s_cmp_lt_i32 s84, s82
    s_cbranch_scc1 L_B22_0w
    s_waitcnt vmcnt(21)
    buffer_load_dwordx4 v2, s[4:7], s78 offen offset:0 nt lds
    v_add_u32 v5, 3, v5
    s_add_u32 s81, s81, 1
    s_and_b32 s92, s81, 7
    s_waitcnt vmcnt(21)
    buffer_load_dwordx4 v2, s[4:7], s78 offen offset:1024 nt lds
    v_readlane_b32 s84, v3, 1
    ds_read_b32 v3, v7
    s_lshl_b32 s92, s92, 11
    s_waitcnt vmcnt(21)
    buffer_load_dwordx4 v2, s[4:7], s78 offen offset:2048 nt lds
    ds_write_b32 v6, v5
    s_add_u32 s92, s92, s77
    s_and_b32 s92, s92, 16383
L_B22_1:
    s_cmp_lt_i32 s84, s82
    s_cbranch_scc1 L_B22_1w
    s_waitcnt vmcnt(21)
    buffer_load_dwordx4 v2, s[4:7], s78 offen offset:3072 nt lds
    v_add_u32 v5, 3, v5
    s_add_u32 m0, m0, s85
    s_add_u32 s78, s78, s85
    s_waitcnt vmcnt(21)
    buffer_load_dwordx4 v2, s[4:7], s78 offen offset:0 nt lds
    v_readlane_b32 s84, v3, 2
    ds_read_b32 v3, v7
    s_mul_i32 s80, s92, 768
    s_waitcnt vmcnt(21)
    buffer_load_dwordx4 v2, s[4:7], s78 offen offset:1024 nt lds
    ds_write_b32 v6, v5
    s_bfe_u32 s92, s81, 0x40003
    s_mul_i32 s92, s92, 25165824
L_B22_2:
    s_cmp_lt_i32 s84, s82
    s_cbranch_scc1 L_B22_2w
    s_waitcnt vmcnt(21)
    buffer_load_dwordx4 v2, s[4:7], s78 offen offset:2048 nt lds
    v_add_u32 v5, 3, v5
    s_add_u32 s80, s80, s79
    s_add_u32 s80, s80, s92
    s_waitcnt vmcnt(21)
    buffer_load_dwordx4 v2, s[4:7], s78 offen offset:3072 nt lds
    v_readlane_b32 s84, v3, 3
    ds_read_b32 v3, v7
    s_add_u32 m0, m0, s85
    s_add_u32 s78, s78, s85
    s_waitcnt vmcnt(21)
    buffer_load_dwordx4 v2, s[4:7], s78 offen offset:0 nt lds
    ds_write_b32 v6, v5
    s_and_b32 s86, s81, 3
    s_mul_i32 s86, s86, 12288
L_B22_3:
    s_cmp_lt_i32 s84, s82
    s_cbranch_scc1 L_B22_3w
    s_waitcnt vmcnt(21)
    buffer_load_dwordx4 v2, s[4:7], s78 offen offset:1024 nt lds
    v_add_u32 v5, 3, v5
    v_readlane_b32 s83, v3, 4
    s_waitcnt vmcnt(21)
    buffer_load_dwordx4 v2, s[4:7], s78 offen offset:2048 nt lds
    v_readlane_b32 s84, v3, 0
    ds_read_b32 v3, v7
    s_add_u32 s82, s82, 1
    s_cmp_ge_u32 s81, 255
    s_cselect_b32 s83, -1, s83
    s_cmp_ge_u32 s81, 128
    s_waitcnt vmcnt(21)
    buffer_load_dwordx4 v2, s[4:7], s78 offen offset:3072 nt lds
    ds_write_b32 v6, v5
    s_cselect_b64 s[4:5], s[56:57], s[50:51]
    s_mov_b32 m0, s86
    s_mov_b32 s78, s80
    s_cmp_eq_u32 s83, 22
    s_cbranch_scc1 L_B22
    s_cmp_eq_u32 s83, -1
    s_cbranch_scc1 L_D32
    s_cmp_eq_u32 s83, 21
    s_cbranch_scc1 L_D21
    s_cmp_eq_u32 s83, 23
    s_cbranch_scc1 L_D23
    s_branch L_disp
L_D17:
    s_mul_i32 s92, s81, 12
    s_add_u32 s92, s92, 31
    v_mov_b32 v5, s92
L_B17:
L_B17_0:
    s_cmp_lt_i32 s84, s82
    s_cbranch_scc1 L_B17_0w
    s_waitcnt vmcnt(16)
    buffer_load_dwordx4 v2, s[4:7], s78 offen offset:0 nt lds
    v_add_u32 v5, 3, v5
    s_add_u32 s81, s81, 1
    s_and_b32 s92, s81, 7
    s_waitcnt vmcnt(16)
    buffer_load_dwordx4 v2, s[4:7], s78 offen offset:1024 nt lds
    v_readlane_b32 s84, v3, 1
    ds_read_b32 v3, v7
    s_lshl_b32 s92, s92, 11
    s_waitcnt vmcnt(16)
    buffer_load_dwordx4 v2, s[4:7], s78 offen offset:2048 nt lds
    ds_write_b32 v6, v5
    s_add_u32 s92, s92, s77
    s_and_b32 s92, s92, 16383
L_B17_1:
    s_cmp_lt_i32 s84, s82
    s_cbranch_scc1 L_B17_1w
    s_waitcnt vmcnt(16)
    buffer_load_dwordx4 v2, s[4:7], s78 offen offset:3072 nt lds
    v_add_u32 v5, 3, v5
    s_add_u32 m0, m0, s85
    s_add_u32 s78, s78, s85
    s_waitcnt vmcnt(16)
    buffer_load_dwordx4 v2, s[4:7], s78 offen offset:0 nt lds
    v_readlane_b32 s84, v3, 2
    ds_read_b32 v3, v7
    s_mul_i32 s80, s92, 768
    s_waitcnt vmcnt(16)
    buffer_load_dwordx4 v2, s[4:7], s78 offen offset:1024 nt lds
    ds_write_b32 v6, v5
    s_bfe_u32 s92, s81, 0x40003
    s_mul_i32 s92, s92, 25165824
L_B17_2:
    s_cmp_lt_i32 s84, s82
    s_cbranch_scc1 L_B17_2w
    s_waitcnt vmcnt(16)
    buffer_load_dwordx4 v2, s[4:7], s78 offen offset:2048 nt lds
    v_add_u32 v5, 3, v5
    s_add_u32 s80, s80, s79
    s_add_u32 s80, s80, s92
    s_waitcnt vmcnt(16)
    buffer_load_dwordx4 v2, s[4:7], s78 offen offset:3072 nt lds
    v_readlane_b32 s84, v3, 3
    ds_read_b32 v3, v7
    s_add_u32 m0, m0, s85
    s_add_u32 s78, s78, s85
    s_waitcnt vmcnt(16)
    buffer_load_dwordx4 v2, s[4:7], s78 offen offset:0 nt lds
    ds_write_b32 v6, v5
    s_and_b32 s86, s81, 3
    s_mul_i32 s86, s86, 12288
L_B17_3:
    s_cmp_lt_i32 s84, s82
    s_cbranch_scc1 L_B17_3w
    s_waitcnt vmcnt(16)
    buffer_load_dwordx4 v2, s[4:7], s78 offen offset:1024 nt lds
    v_add_u32 v5, 3, v5
    v_readlane_b32 s83, v3, 4
    s_waitcnt vmcnt(16)
    buffer_load_dwordx4 v2, s[4:7], s78 offen offset:2048 nt lds
    v_readlane_b32 s84, v3, 0
    ds_read_b32 v3, v7
    s_add_u32 s82, s82, 1
    s_cmp_ge_u32 s81, 255
    s_cselect_b32 s83, -1, s83
    s_cmp_ge_u32 s81, 128
    s_waitcnt vmcnt(16)
    buffer_load_dwordx4 v2, s[4:7], s78 offen offset:3072 nt lds
    ds_write_b32 v6, v5
    s_cselect_b64 s[4:5], s[56:57], s[50:51]
    s_mov_b32 m0, s86
    s_mov_b32 s78, s80
    s_cmp_eq_u32 s83, 17
    s_cbranch_scc1 L_B17
    s_cmp_eq_u32 s83, -1
    s_cbranch_scc1 L_D32
    s_cmp_eq_u32 s83, 18
    s_cbranch_scc1 L_D18
    s_cmp_eq_u32 s83, 16
    s_cbranch_scc1 L_D16
    s_branch L_disp
L_D23:
    s_mul_i32 s92, s81, 12
    s_add_u32 s92, s92, 25
    v_mov_b32 v5, s92
L_B23:
L_B23_0:
    s_cmp_lt_i32 s84, s82
    s_cbranch_scc1 L_B23_0w
    s_waitcnt vmcnt(22)
    buffer_load_dwordx4 v2, s[4:7], s78 offen offset:0 nt lds
    v_add_u32 v5, 3, v5
    s_add_u32 s81, s81, 1
    s_and_b32 s92, s81, 7
    s_waitcnt vmcnt(22)
    buffer_load_dwordx4 v2, s[4:7], s78 offen offset:1024 nt lds
    v_readlane_b32 s84, v3, 1
    ds_read_b32 v3, v7
    s_lshl_b32 s92, s92, 11
    s_waitcnt vmcnt(22)
    buffer_load_dwordx4 v2, s[4:7], s78 offen offset:2048 nt lds
    ds_write_b32 v6, v5
    s_add_u32 s92, s92, s77
    s_and_b32 s92, s92, 16383
L_B23_1:
    s_cmp_lt_i32 s84, s82
    s_cbranch_scc1 L_B23_1w
    s_waitcnt vmcnt(22)
    buffer_load_dwordx4 v2, s[4:7], s78 offen offset:3072 nt lds
    v_add_u32 v5, 3, v5
    s_add_u32 m0, m0, s85
    s_add_u32 s78, s78, s85
    s_waitcnt vmcnt(22)
    buffer_load_dwordx4 v2, s[4:7], s78 offen offset:0 nt lds
    v_readlane_b32 s84, v3, 2
    ds_read_b32 v3, v7
    s_mul_i32 s80, s92, 768
    s_waitcnt vmcnt(22)
    buffer_load_dwordx4 v2, s[4:7], s78 offen offset:1024 nt lds
    ds_write_b32 v6, v5
    s_bfe_u32 s92, s81, 0x40003
    s_mul_i32 s92, s92, 25165824
L_B23_2:
    s_cmp_lt_i32 s84, s82
    s_cbranch_scc1 L_B23_2w
    s_waitcnt vmcnt(22)
    buffer_load_dwordx4 v2, s[4:7], s78 offen offset:2048 nt lds
    v_add_u32 v5, 3, v5
    s_add_u32 s80, s80, s79
    s_add_u32 s80, s80, s92
    s_waitcnt vmcnt(22)
    buffer_load_dwordx4 v2, s[4:7], s78 offen offset:3072 nt lds
    v_readlane_b32 s84, v3, 3
    ds_read_b32 v3, v7
    s_add_u32 m0, m0, s85
    s_add_u32 s78, s78, s85
    s_waitcnt vmcnt(22)
    buffer_load_dwordx4 v2, s[4:7], s78 offen offset:0 nt lds
    ds_write_b32 v6, v5
    s_and_b32 s86, s81, 3
    s_mul_i32 s86, s86, 12288
L_B23_3:
    s_cmp_lt_i32 s84, s82
    s_cbranch_scc1 L_B23_3w
    s_waitcnt vmcnt(22)
    buffer_load_dwordx4 v2, s[4:7], s78 offen offset:1024 nt lds
    v_add_u32 v5, 3, v5
    v_readlane_b32 s83, v3, 4
    s_waitcnt vmcnt(22)
    buffer_load_dwordx4 v2, s[4:7], s78 offen offset:2048 nt lds
    v_readlane_b32 s84, v3, 0
    ds_read_b32 v3, v7
    s_add_u32 s82, s82, 1
    s_cmp_ge_u32 s81, 255
    s_cselect_b32 s83, -1, s83
    s_cmp_ge_u32 s81, 128
    s_waitcnt vmcnt(22)
    buffer_load_dwordx4 v2, s[4:7], s78 offen offset:3072 nt lds
    ds_write_b32 v6, v5
    s_cselect_b64 s[4:5], s[56:57], s[50:51]
    s_mov_b32 m0, s86
    s_mov_b32 s78, s80
    s_cmp_eq_u32 s83, 23
    s_cbranch_scc1 L_B23
    s_cmp_eq_u32 s83, -1
    s_cbranch_scc1 L_D32
    s_cmp_eq_u32 s83, 22
    s_cbranch_scc1 L_D22
    s_cmp_eq_u32 s83, 24
    s_cbranch_scc1 L_D24
    s_branch L_disp
L_D16:
    s_mul_i32 s92, s81, 12
    s_add_u32 s92, s92, 32
    v_mov_b32 v5, s92
L_B16:
L_B16_0:
    s_cmp_lt_i32 s84, s82
    s_cbranch_scc1 L_B16_0w
    s_waitcnt vmcnt(15)
    buffer_load_dwordx4 v2, s[4:7], s78 offen offset:0 nt lds
    v_add_u32 v5, 3, v5
    s_add_u32 s81, s81, 1
    s_and_b32 s92, s81, 7
    s_waitcnt vmcnt(15)
    buffer_load_dwordx4 v2, s[4:7], s78 offen offset:1024 nt lds
    v_readlane_b32 s84, v3, 1
    ds_read_b32 v3, v7
    s_lshl_b32 s92, s92, 11
    s_waitcnt vmcnt(15)
    buffer_load_dwordx4 v2, s[4:7], s78 offen offset:2048 nt lds
    ds_write_b32 v6, v5
    s_add_u32 s92, s92, s77
    s_and_b32 s92, s92, 16383
L_B16_1:
    s_cmp_lt_i32 s84, s82
    s_cbranch_scc1 L_B16_1w
    s_waitcnt vmcnt(15)
    buffer_load_dwordx4 v2, s[4:7], s78 offen offset:3072 nt lds
    v_add_u32 v5, 3, v5
    s_add_u32 m0, m0, s85
    s_add_u32 s78, s78, s85
    s_waitcnt vmcnt(15)
    buffer_load_dwordx4 v2, s[4:7], s78 offen offset:0 nt lds
    v_readlane_b32 s84, v3, 2
    ds_read_b32 v3, v7
    s_mul_i32 s80, s92, 768
    s_waitcnt vmcnt(15)
    buffer_load_dwordx4 v2, s[4:7], s78 offen offset:1024 nt lds
    ds_write_b32 v6, v5
    s_bfe_u32 s92, s81, 0x40003
    s_mul_i32 s92, s92, 25165824
L_B16_2:
    s_cmp_lt_i32 s84, s82
    s_cbranch_scc1 L_B16_2w
    s_waitcnt vmcnt(15)
    buffer_load_dwordx4 v2, s[4:7], s78 offen offset:2048 nt lds
    v_add_u32 v5, 3, v5
    s_add_u32 s80, s80, s79
    s_add_u32 s80, s80, s92
    s_waitcnt vmcnt(15)
    buffer_load_dwordx4 v2, s[4:7], s78 offen offset:3072 nt lds
    v_readlane_b32 s84, v3, 3
    ds_read_b32 v3, v7
    s_add_u32 m0, m0, s85
    s_add_u32 s78, s78, s85
    s_waitcnt vmcnt(15)
    buffer_load_dwordx4 v2, s[4:7], s78 offen offset:0 nt lds
    ds_write_b32 v6, v5
    s_and_b32 s86, s81, 3
    s_mul_i32 s86, s86, 12288
L_B16_3:
    s_cmp_lt_i32 s84, s82
    s_cbranch_scc1 L_B16_3w
    s_waitcnt vmcnt(15)
    buffer_load_dwordx4 v2, s[4:7], s78 offen offset:1024 nt lds
    v_add_u32 v5, 3, v5
    v_readlane_b32 s83, v3, 4
    s_waitcnt vmcnt(15)
    buffer_load_dwordx4 v2, s[4:7], s78 offen offset:2048 nt lds
    v_readlane_b32 s84, v3, 0
    ds_read_b32 v3, v7
    s_add_u32 s82, s82, 1
    s_cmp_ge_u32 s81, 255
    s_cselect_b32 s83, -1, s83
    s_cmp_ge_u32 s81, 128
    s_waitcnt vmcnt(15)
    buffer_load_dwordx4 v2, s[4:7], s78 offen offset:3072 nt lds
    ds_write_b32 v6, v5
    s_cselect_b64 s[4:5], s[56:57], s[50:51]
    s_mov_b32 m0, s86
    s_mov_b32 s78, s80
    s_cmp_eq_u32 s83, 16
    s_cbranch_scc1 L_B16
    s_cmp_eq_u32 s83, -1
    s_cbranch_scc1 L_D32
    s_cmp_eq_u32 s83, 17
    s_cbranch_scc1 L_D17
    s_cmp_eq_u32 s83, 15
    s_cbranch_scc1 L_D15
    s_branch L_disp
L_D24:
    s_mul_i32 s92, s81, 12
    s_add_u32 s92, s92, 24
    v_mov_b32 v5, s92
L_B24:
L_B24_0:
    s_cmp_lt_i32 s84, s82
    s_cbranch_scc1 L_B24_0w
    s_waitcnt vmcnt(23)
    buffer_load_dwordx4 v2, s[4:7], s78 offen offset:0 nt lds
    v_add_u32 v5, 3, v5
    s_add_u32 s81, s81, 1
    s_and_b32 s92, s81, 7
    s_waitcnt vmcnt(23)
    buffer_load_dwordx4 v2, s[4:7], s78 offen offset:1024 nt lds
    v_readlane_b32 s84, v3, 1
    ds_read_b32 v3, v7
    s_lshl_b32 s92, s92, 11
    s_waitcnt vmcnt(23)
    buffer_load_dwordx4 v2, s[4:7], s78 offen offset:2048 nt lds
    ds_write_b32 v6, v5
    s_add_u32 s92, s92, s77
    s_and_b32 s92, s92, 16383
L_B24_1:
    s_cmp_lt_i32 s84, s82
    s_cbranch_scc1 L_B24_1w
    s_waitcnt vmcnt(23)
    buffer_load_dwordx4 v2, s[4:7], s78 offen offset:3072 nt lds
    v_add_u32 v5, 3, v5
    s_add_u32 m0, m0, s85
    s_add_u32 s78, s78, s85
    s_waitcnt vmcnt(23)
    buffer_load_dwordx4 v2, s[4:7], s78 offen offset:0 nt lds
    v_readlane_b32 s84, v3, 2
    ds_read_b32 v3, v7
    s_mul_i32 s80, s92, 768
    s_waitcnt vmcnt(23)
    buffer_load_dwordx4 v2, s[4:7], s78 offen offset:1024 nt lds
    ds_write_b32 v6, v5
    s_bfe_u32 s92, s81, 0x40003
    s_mul_i32 s92, s92, 25165824
L_B24_2:
    s_cmp_lt_i32 s84, s82
    s_cbranch_scc1 L_B24_2w
    s_waitcnt vmcnt(23)
    buffer_load_dwordx4 v2, s[4:7], s78 offen offset:2048 nt lds
    v_add_u32 v5, 3, v5
    s_add_u32 s80, s80, s79
    s_add_u32 s80, s80, s92
    s_waitcnt vmcnt(23)
    buffer_load_dwordx4 v2, s[4:7], s78 offen offset:3072 nt lds
    v_readlane_b32 s84, v3, 3
    ds_read_b32 v3, v7
    s_add_u32 m0, m0, s85
    s_add_u32 s78, s78, s85
    s_waitcnt vmcnt(23)
    buffer_load_dwordx4 v2, s[4:7], s78 offen offset:0 nt lds
    ds_write_b32 v6, v5
    s_and_b32 s86, s81, 3
    s_mul_i32 s86, s86, 12288
L_B24_3:
    s_cmp_lt_i32 s84, s82
    s_cbranch_scc1 L_B24_3w
    s_waitcnt vmcnt(23)
    buffer_load_dwordx4 v2, s[4:7], s78 offen offset:1024 nt lds
    v_add_u32 v5, 3, v5
    v_readlane_b32 s83, v3, 4
    s_waitcnt vmcnt(23)
    buffer_load_dwordx4 v2, s[4:7], s78 offen offset:2048 nt lds
    v_readlane_b32 s84, v3, 0
    ds_read_b32 v3, v7
    s_add_u32 s82, s82, 1
    s_cmp_ge_u32 s81, 255
    s_cselect_b32 s83, -1, s83
    s_cmp_ge_u32 s81, 128
    s_waitcnt vmcnt(23)
    buffer_load_dwordx4 v2, s[4:7], s78 offen offset:3072 nt lds
    ds_write_b32 v6, v5
    s_cselect_b64 s[4:5], s[56:57], s[50:51]
    s_mov_b32 m0, s86
    s_mov_b32 s78, s80
    s_cmp_eq_u32 s83, 24
    s_cbranch_scc1 L_B24
    s_cmp_eq_u32 s83, -1
    s_cbranch_scc1 L_D32
    s_cmp_eq_u32 s83, 23
    s_cbranch_scc1 L_D23
    s_cmp_eq_u32 s83, 25
    s_cbranch_scc1 L_D25
    s_branch L_disp
L_D15:
    s_mul_i32 s92, s81, 12
    s_add_u32 s92, s92, 33
    v_mov_b32 v5, s92
L_B15:
L_B15_0:
    s_cmp_lt_i32 s84, s82
    s_cbranch_scc1 L_B15_0w
    s_waitcnt vmcnt(14)
    buffer_load_dwordx4 v2, s[4:7], s78 offen offset:0 nt lds
    v_add_u32 v5, 3, v5
    s_add_u32 s81, s81, 1
    s_and_b32 s92, s81, 7
    s_waitcnt vmcnt(14)
    buffer_load_dwordx4 v2, s[4:7], s78 offen offset:1024 nt lds
    v_readlane_b32 s84, v3, 1
    ds_read_b32 v3, v7
    s_lshl_b32 s92, s92, 11
    s_waitcnt vmcnt(14)
    buffer_load_dwordx4 v2, s[4:7], s78 offen offset:2048 nt lds
    ds_write_b32 v6, v5
    s_add_u32 s92, s92, s77
    s_and_b32 s92, s92, 16383
L_B15_1:
    s_cmp_lt_i32 s84, s82
    s_cbranch_scc1 L_B15_1w
    s_waitcnt vmcnt(14)
    buffer_load_dwordx4 v2, s[4:7], s78 offen offset:3072 nt lds
    v_add_u32 v5, 3, v5
    s_add_u32 m0, m0, s85
    s_add_u32 s78, s78, s85
    s_waitcnt vmcnt(14)
    buffer_load_dwordx4 v2, s[4:7], s78 offen offset:0 nt lds
    v_readlane_b32 s84, v3, 2
    ds_read_b32 v3, v7
    s_mul_i32 s80, s92, 768
    s_waitcnt vmcnt(14)
    buffer_load_dwordx4 v2, s[4:7], s78 offen offset:1024 nt lds
    ds_write_b32 v6, v5
    s_bfe_u32 s92, s81, 0x40003
    s_mul_i32 s92, s92, 25165824
L_B15_2:
    s_cmp_lt_i32 s84, s82
    s_cbranch_scc1 L_B15_2w
    s_waitcnt vmcnt(14)
    buffer_load_dwordx4 v2, s[4:7], s78 offen offset:2048 nt lds
    v_add_u32 v5, 3, v5
    s_add_u32 s80, s80, s79
    s_add_u32 s80, s80, s92
    s_waitcnt vmcnt(14)
    buffer_load_dwordx4 v2, s[4:7], s78 offen offset:3072 nt lds
    v_readlane_b32 s84, v3, 3
    ds_read_b32 v3, v7
    s_add_u32 m0, m0, s85
    s_add_u32 s78, s78, s85
    s_waitcnt vmcnt(14)
    buffer_load_dwordx4 v2, s[4:7], s78 offen offset:0 nt lds
    ds_write_b32 v6, v5
    s_and_b32 s86, s81, 3
    s_mul_i32 s86, s86, 12288
L_B15_3:
    s_cmp_lt_i32 s84, s82
    s_cbranch_scc1 L_B15_3w
    s_waitcnt vmcnt(14)
    buffer_load_dwordx4 v2, s[4:7], s78 offen offset:1024 nt lds
    v_add_u32 v5, 3, v5
    v_readlane_b32 s83, v3, 4
    s_waitcnt vmcnt(14)
    buffer_load_dwordx4 v2, s[4:7], s78 offen offset:2048 nt lds
    v_readlane_b32 s84, v3, 0
    ds_read_b32 v3, v7
    s_add_u32 s82, s82, 1
    s_cmp_ge_u32 s81, 255
    s_cselect_b32 s83, -1, s83
    s_cmp_ge_u32 s81, 128
    s_waitcnt vmcnt(14)
    buffer_load_dwordx4 v2, s[4:7], s78 offen offset:3072 nt lds
    ds_write_b32 v6, v5
    s_cselect_b64 s[4:5], s[56:57], s[50:51]
    s_mov_b32 m0, s86
    s_mov_b32 s78, s80
    s_cmp_eq_u32 s83, 15
    s_cbranch_scc1 L_B15
    s_cmp_eq_u32 s83, -1
    s_cbranch_scc1 L_D32
    s_cmp_eq_u32 s83, 16
    s_cbranch_scc1 L_D16
    s_branch L_disp
L_D25:
    s_mul_i32 s92, s81, 12
    s_add_u32 s92, s92, 23
    v_mov_b32 v5, s92
L_B25:
L_B25_0:
    s_cmp_lt_i32 s84, s82
    s_cbranch_scc1 L_B25_0w
    s_waitcnt vmcnt(24)
    buffer_load_dwordx4 v2, s[4:7], s78 offen offset:0 nt lds
    v_add_u32 v5, 3, v5
    s_add_u32 s81, s81, 1
    s_and_b32 s92, s81, 7
    s_waitcnt vmcnt(24)
    buffer_load_dwordx4 v2, s[4:7], s78 offen offset:1024 nt lds
    v_readlane_b32 s84, v3, 1
    ds_read_b32 v3, v7
    s_lshl_b32 s92, s92, 11
    s_waitcnt vmcnt(24)
    buffer_load_dwordx4 v2, s[4:7], s78 offen offset:2048 nt lds
    ds_write_b32 v6, v5
    s_add_u32 s92, s92, s77
    s_and_b32 s92, s92, 16383
L_B25_1:
    s_cmp_lt_i32 s84, s82
    s_cbranch_scc1 L_B25_1w
    s_waitcnt vmcnt(24)
    buffer_load_dwordx4 v2, s[4:7], s78 offen offset:3072 nt lds
    v_add_u32 v5, 3, v5
    s_add_u32 m0, m0, s85
    s_add_u32 s78, s78, s85
    s_waitcnt vmcnt(24)
    buffer_load_dwordx4 v2, s[4:7], s78 offen offset:0 nt lds
    v_readlane_b32 s84, v3, 2
    ds_read_b32 v3, v7
    s_mul_i32 s80, s92, 768
    s_waitcnt vmcnt(24)
    buffer_load_dwordx4 v2, s[4:7], s78 offen offset:1024 nt lds
    ds_write_b32 v6, v5
    s_bfe_u32 s92, s81, 0x40003
    s_mul_i32 s92, s92, 25165824
L_B25_2:
    s_cmp_lt_i32 s84, s82
    s_cbranch_scc1 L_B25_2w
    s_waitcnt vmcnt(24)
    buffer_load_dwordx4 v2, s[4:7], s78 offen offset:2048 nt lds
    v_add_u32 v5, 3, v5
    s_add_u32 s80, s80, s79
    s_add_u32 s80, s80, s92
    s_waitcnt vmcnt(24)
    buffer_load_dwordx4 v2, s[4:7], s78 offen offset:3072 nt lds
    v_readlane_b32 s84, v3, 3
    ds_read_b32 v3, v7
    s_add_u32 m0, m0, s85
    s_add_u32 s78, s78, s85
    s_waitcnt vmcnt(24)
    buffer_load_dwordx4 v2, s[4:7], s78 offen offset:0 nt lds
    ds_write_b32 v6, v5
    s_and_b32 s86, s81, 3
    s_mul_i32 s86, s86, 12288
L_B25_3:
    s_cmp_lt_i32 s84, s82
    s_cbranch_scc1 L_B25_3w
    s_waitcnt vmcnt(24)
    buffer_load_dwordx4 v2, s[4:7], s78 offen offset:1024 nt lds
    v_add_u32 v5, 3, v5
    v_readlane_b32 s83, v3, 4
    s_waitcnt vmcnt(24)
    buffer_load_dwordx4 v2, s[4:7], s78 offen offset:2048 nt lds
    v_readlane_b32 s84, v3, 0
    ds_read_b32 v3, v7
    s_add_u32 s82, s82, 1
    s_cmp_ge_u32 s81, 255
    s_cselect_b32 s83, -1, s83
    s_cmp_ge_u32 s81, 128
    s_waitcnt vmcnt(24)
    buffer_load_dwordx4 v2, s[4:7], s78 offen offset:3072 nt lds
    ds_write_b32 v6, v5
    s_cselect_b64 s[4:5], s[56:57], s[50:51]
    s_mov_b32 m0, s86
    s_mov_b32 s78, s80
    s_cmp_eq_u32 s83, 25
    s_cbranch_scc1 L_B25
    s_cmp_eq_u32 s83, -1
    s_cbranch_scc1 L_D32
    s_cmp_eq_u32 s83, 24
    s_cbranch_scc1 L_D24
    s_cmp_eq_u32 s83, 26
    s_cbranch_scc1 L_D26
    s_branch L_disp
L_D26:
    s_mul_i32 s92, s81, 12
    s_add_u32 s92, s92, 22
    v_mov_b32 v5, s92
L_B26:
L_B26_0:
    s_cmp_lt_i32 s84, s82
    s_cbranch_scc1 L_B26_0w
    s_waitcnt vmcnt(25)
    buffer_load_dwordx4 v2, s[4:7], s78 offen offset:0 nt lds
    v_add_u32 v5, 3, v5
    s_add_u32 s81, s81, 1
    s_and_b32 s92, s81, 7
    s_waitcnt vmcnt(25)
    buffer_load_dwordx4 v2, s[4:7], s78 offen offset:1024 nt lds
    v_readlane_b32 s84, v3, 1
    ds_read_b32 v3, v7
    s_lshl_b32 s92, s92, 11
    s_waitcnt vmcnt(25)
    buffer_load_dwordx4 v2, s[4:7], s78 offen offset:2048 nt lds
    ds_write_b32 v6, v5
    s_add_u32 s92, s92, s77
    s_and_b32 s92, s92, 16383
L_B26_1:
    s_cmp_lt_i32 s84, s82
    s_cbranch_scc1 L_B26_1w
    s_waitcnt vmcnt(25)
    buffer_load_dwordx4 v2, s[4:7], s78 offen offset:3072 nt lds
    v_add_u32 v5, 3, v5
    s_add_u32 m0, m0, s85
    s_add_u32 s78, s78, s85
    s_waitcnt vmcnt(25)
    buffer_load_dwordx4 v2, s[4:7], s78 offen offset:0 nt lds
    v_readlane_b32 s84, v3, 2
    ds_read_b32 v3, v7
    s_mul_i32 s80, s92, 768
    s_waitcnt vmcnt(25)
    buffer_load_dwordx4 v2, s[4:7], s78 offen offset:1024 nt lds
    ds_write_b32 v6, v5
    s_bfe_u32 s92, s81, 0x40003
    s_mul_i32 s92, s92, 25165824
L_B26_2:
    s_cmp_lt_i32 s84, s82
    s_cbranch_scc1 L_B26_2w
    s_waitcnt vmcnt(25)
    buffer_load_dwordx4 v2, s[4:7], s78 offen offset:2048 nt lds
    v_add_u32 v5, 3, v5
    s_add_u32 s80, s80, s79
    s_add_u32 s80, s80, s92
    s_waitcnt vmcnt(25)
    buffer_load_dwordx4 v2, s[4:7], s78 offen offset:3072 nt lds
    v_readlane_b32 s84, v3, 3
    ds_read_b32 v3, v7
    s_add_u32 m0, m0, s85
    s_add_u32 s78, s78, s85
    s_waitcnt vmcnt(25)
    buffer_load_dwordx4 v2, s[4:7], s78 offen offset:0 nt lds
    ds_write_b32 v6, v5
    s_and_b32 s86, s81, 3
    s_mul_i32 s86, s86, 12288
L_B26_3:
    s_cmp_lt_i32 s84, s82
    s_cbranch_scc1 L_B26_3w
    s_waitcnt vmcnt(25)
    buffer_load_dwordx4 v2, s[4:7], s78 offen offset:1024 nt lds
    v_add_u32 v5, 3, v5
    v_readlane_b32 s83, v3, 4
    s_waitcnt vmcnt(25)
    buffer_load_dwordx4 v2, s[4:7], s78 offen offset:2048 nt lds
    v_readlane_b32 s84, v3, 0
    ds_read_b32 v3, v7
    s_add_u32 s82, s82, 1
    s_cmp_ge_u32 s81, 255
    s_cselect_b32 s83, -1, s83
    s_cmp_ge_u32 s81, 128
    s_waitcnt vmcnt(25)
    buffer_load_dwordx4 v2, s[4:7], s78 offen offset:3072 nt lds
    ds_write_b32 v6, v5
    s_cselect_b64 s[4:5], s[56:57], s[50:51]
    s_mov_b32 m0, s86
    s_mov_b32 s78, s80
    s_cmp_eq_u32 s83, 26
    s_cbranch_scc1 L_B26
    s_cmp_eq_u32 s83, -1
    s_cbranch_scc1 L_D32
    s_cmp_eq_u32 s83, 25
    s_cbranch_scc1 L_D25
    s_branch L_disp
L_B20_0w:
    ds_read_b32 v3, v7
    s_waitcnt lgkmcnt(0)
    v_readlane_b32 s84, v3, 0
    s_nop 0
    s_branch L_B20_0
L_B20_1w:
    ds_read_b32 v3, v7
    s_waitcnt lgkmcnt(0)
    v_readlane_b32 s84, v3, 1
    s_nop 0
    s_branch L_B20_1
L_B20_2w:
    ds_read_b32 v3, v7
    s_waitcnt lgkmcnt(0)
    v_readlane_b32 s84, v3, 2
    s_nop 0
    s_branch L_B20_2
L_B20_3w:
    ds_read_b32 v3, v7
    s_waitcnt lgkmcnt(0)
    v_readlane_b32 s84, v3, 3
    s_nop 0
    s_branch L_B20_3
L_B19_0w:
    ds_read_b32 v3, v7
    s_waitcnt lgkmcnt(0)
    v_readlane_b32 s84, v3, 0
    s_nop 0
    s_branch L_B19_0
L_B19_1w:
    ds_read_b32 v3, v7
    s_waitcnt lgkmcnt(0)
    v_readlane_b32 s84, v3, 1
    s_nop 0
    s_branch L_B19_1
L_B19_2w:
    ds_read_b32 v3, v7
    s_waitcnt lgkmcnt(0)
    v_readlane_b32 s84, v3, 2
    s_nop 0
    s_branch L_B19_2
L_B19_3w:
    ds_read_b32 v3, v7
    s_waitcnt lgkmcnt(0)
    v_readlane_b32 s84, v3, 3
    s_nop 0
    s_branch L_B19_3
L_B21_0w:
    ds_read_b32 v3, v7
    s_waitcnt lgkmcnt(0)
    v_readlane_b32 s84, v3, 0
    s_nop 0
    s_branch L_B21_0
L_B21_1w:
    ds_read_b32 v3, v7
    s_waitcnt lgkmcnt(0)
    v_readlane_b32 s84, v3, 1
    s_nop 0
    s_branch L_B21_1
L_B21_2w:
    ds_read_b32 v3, v7
    s_waitcnt lgkmcnt(0)
    v_readlane_b32 s84, v3, 2
    s_nop 0
    s_branch L_B21_2
L_B21_3w:
    ds_read_b32 v3, v7
    s_waitcnt lgkmcnt(0)
    v_readlane_b32 s84, v3, 3
    s_nop 0
    s_branch L_B21_3
L_B18_0w:
    ds_read_b32 v3, v7
    s_waitcnt lgkmcnt(0)
    v_readlane_b32 s84, v3, 0
    s_nop 0
    s_branch L_B18_0
L_B18_1w:
    ds_read_b32 v3, v7
    s_waitcnt lgkmcnt(0)
    v_readlane_b32 s84, v3, 1
    s_nop 0
    s_branch L_B18_1
L_B18_2w:
    ds_read_b32 v3, v7
    s_waitcnt lgkmcnt(0)
    v_readlane_b32 s84, v3, 2
    s_nop 0
    s_branch L_B18_2
L_B18_3w:
    ds_read_b32 v3, v7
    s_waitcnt lgkmcnt(0)
    v_readlane_b32 s84, v3, 3
    s_nop 0
    s_branch L_B18_3
L_B22_0w:
    ds_read_b32 v3, v7
    s_waitcnt lgkmcnt(0)
    v_readlane_b32 s84, v3, 0
    s_nop 0
    s_branch L_B22_0
L_B22_1w:
    ds_read_b32 v3, v7
    s_waitcnt lgkmcnt(0)
    v_readlane_b32 s84, v3, 1
    s_nop 0
    s_branch L_B22_1
L_B22_2w:
    ds_read_b32 v3, v7
    s_waitcnt lgkmcnt(0)
    v_readlane_b32 s84, v3, 2
    s_nop 0
    s_branch L_B22_2
L_B22_3w:
    ds_read_b32 v3, v7
    s_waitcnt lgkmcnt(0)
    v_readlane_b32 s84, v3, 3
    s_nop 0
    s_branch L_B22_3
L_B17_0w:
    ds_read_b32 v3, v7
    s_waitcnt lgkmcnt(0)
    v_readlane_b32 s84, v3, 0
    s_nop 0
    s_branch L_B17_0
L_B17_1w:
    ds_read_b32 v3, v7
    s_waitcnt lgkmcnt(0)
    v_readlane_b32 s84, v3, 1
    s_nop 0
    s_branch L_B17_1
L_B17_2w:
    ds_read_b32 v3, v7
    s_waitcnt lgkmcnt(0)
    v_readlane_b32 s84, v3, 2
    s_nop 0
    s_branch L_B17_2
L_B17_3w:
    ds_read_b32 v3, v7
    s_waitcnt lgkmcnt(0)
    v_readlane_b32 s84, v3, 3
    s_nop 0
    s_branch L_B17_3
L_B23_0w:
    ds_read_b32 v3, v7
    s_waitcnt lgkmcnt(0)
    v_readlane_b32 s84, v3, 0
    s_nop 0
    s_branch L_B23_0
L_B23_1w:
    ds_read_b32 v3, v7
    s_waitcnt lgkmcnt(0)
    v_readlane_b32 s84, v3, 1
    s_nop 0
    s_branch L_B23_1
L_B23_2w:
    ds_read_b32 v3, v7
    s_waitcnt lgkmcnt(0)
    v_readlane_b32 s84, v3, 2
    s_nop 0
    s_branch L_B23_2
L_B23_3w:
    ds_read_b32 v3, v7
    s_waitcnt lgkmcnt(0)
    v_readlane_b32 s84, v3, 3
    s_nop 0
    s_branch L_B23_3
L_B16_0w:
    ds_read_b32 v3, v7
    s_waitcnt lgkmcnt(0)
    v_readlane_b32 s84, v3, 0
    s_nop 0
    s_branch L_B16_0
L_B16_1w:
    ds_read_b32 v3, v7
    s_waitcnt lgkmcnt(0)
    v_readlane_b32 s84, v3, 1
    s_nop 0
    s_branch L_B16_1
L_B16_2w:
    ds_read_b32 v3, v7
    s_waitcnt lgkmcnt(0)
    v_readlane_b32 s84, v3, 2
    s_nop 0
    s_branch L_B16_2
L_B16_3w:
    ds_read_b32 v3, v7
    s_waitcnt lgkmcnt(0)
    v_readlane_b32 s84, v3, 3
    s_nop 0
    s_branch L_B16_3
L_B24_0w:
    ds_read_b32 v3, v7
    s_waitcnt lgkmcnt(0)
    v_readlane_b32 s84, v3, 0
    s_nop 0
    s_branch L_B24_0
L_B24_1w:
    ds_read_b32 v3, v7
    s_waitcnt lgkmcnt(0)
    v_readlane_b32 s84, v3, 1
    s_nop 0
    s_branch L_B24_1
L_B24_2w:
    ds_read_b32 v3, v7
    s_waitcnt lgkmcnt(0)
    v_readlane_b32 s84, v3, 2
    s_nop 0
    s_branch L_B24_2
L_B24_3w:
    ds_read_b32 v3, v7
    s_waitcnt lgkmcnt(0)
    v_readlane_b32 s84, v3, 3
    s_nop 0
    s_branch L_B24_3
L_B15_0w:
    ds_read_b32 v3, v7
    s_waitcnt lgkmcnt(0)
    v_readlane_b32 s84, v3, 0
    s_nop 0
    s_branch L_B15_0
L_B15_1w:
    ds_read_b32 v3, v7
    s_waitcnt lgkmcnt(0)
    v_readlane_b32 s84, v3, 1
    s_nop 0
    s_branch L_B15_1
L_B15_2w:
    ds_read_b32 v3, v7
    s_waitcnt lgkmcnt(0)
    v_readlane_b32 s84, v3, 2
    s_nop 0
    s_branch L_B15_2
L_B15_3w:
    ds_read_b32 v3, v7
    s_waitcnt lgkmcnt(0)
    v_readlane_b32 s84, v3, 3
    s_nop 0
    s_branch L_B15_3
L_B25_0w:
    ds_read_b32 v3, v7
    s_waitcnt lgkmcnt(0)
    v_readlane_b32 s84, v3, 0
    s_nop 0
    s_branch L_B25_0
L_B25_1w:
    ds_read_b32 v3, v7
    s_waitcnt lgkmcnt(0)
    v_readlane_b32 s84, v3, 1
    s_nop 0
    s_branch L_B25_1
L_B25_2w:
    ds_read_b32 v3, v7
    s_waitcnt lgkmcnt(0)
    v_readlane_b32 s84, v3, 2
    s_nop 0
    s_branch L_B25_2
L_B25_3w:
    ds_read_b32 v3, v7
    s_waitcnt lgkmcnt(0)
    v_readlane_b32 s84, v3, 3
    s_nop 0
    s_branch L_B25_3
L_B26_0w:
    ds_read_b32 v3, v7
    s_waitcnt lgkmcnt(0)
    v_readlane_b32 s84, v3, 0
    s_nop 0
    s_branch L_B26_0
L_B26_1w:
    ds_read_b32 v3, v7
    s_waitcnt lgkmcnt(0)
    v_readlane_b32 s84, v3, 1
    s_nop 0
    s_branch L_B26_1
L_B26_2w:
    ds_read_b32 v3, v7
    s_waitcnt lgkmcnt(0)
    v_readlane_b32 s84, v3, 2
    s_nop 0
    s_branch L_B26_2
L_B26_3w:
    ds_read_b32 v3, v7
    s_waitcnt lgkmcnt(0)
    v_readlane_b32 s84, v3, 3
    s_nop 0
    s_branch L_B26_3
L_B32_0w:
    ds_read_b32 v3, v7
    s_waitcnt lgkmcnt(0)
    v_readlane_b32 s84, v3, 0
    s_nop 0
    s_branch L_B32_0
L_B32_1w:
    ds_read_b32 v3, v7
    s_waitcnt lgkmcnt(0)
    v_readlane_b32 s84, v3, 1
    s_nop 0
    s_branch L_B32_1
L_B32_2w:
    ds_read_b32 v3, v7
    s_waitcnt lgkmcnt(0)
    v_readlane_b32 s84, v3, 2
    s_nop 0
    s_branch L_B32_2
L_B32_3w:
    ds_read_b32 v3, v7
    s_waitcnt lgkmcnt(0)
    v_readlane_b32 s84, v3, 3
    s_nop 0
    s_branch L_B32_3
L_tail:
L_D32:
    s_mul_i32 s92, s81, 12
    s_add_u32 s92, s92, 16
    v_mov_b32 v5, s92
L_B32:
L_B32_0:
    s_cmp_lt_i32 s84, s82
    s_cbranch_scc1 L_B32_0w
    s_waitcnt vmcnt(31)
    buffer_load_dwordx4 v2, s[4:7], s78 offen offset:0 nt lds
    v_add_u32 v5, 3, v5
    s_add_u32 s81, s81, 1
    s_and_b32 s92, s81, 7
    s_waitcnt vmcnt(31)
    buffer_load_dwordx4 v2, s[4:7], s78 offen offset:1024 nt lds
    v_readlane_b32 s84, v3, 1
    ds_read_b32 v3, v7
    s_lshl_b32 s92, s92, 11
    s_waitcnt vmcnt(31)
    buffer_load_dwordx4 v2, s[4:7], s78 offen offset:2048 nt lds
    ds_write_b32 v6, v5
    s_add_u32 s92, s92, s77
    s_and_b32 s92, s92, 16383
L_B32_1:
    s_cmp_lt_i32 s84, s82
    s_cbranch_scc1 L_B32_1w
    s_waitcnt vmcnt(31)
    buffer_load_dwordx4 v2, s[4:7], s78 offen offset:3072 nt lds
    v_add_u32 v5, 3, v5
    s_add_u32 m0, m0, s85
    s_add_u32 s78, s78, s85
    s_waitcnt vmcnt(31)
    buffer_load_dwordx4 v2, s[4:7], s78 offen offset:0 nt lds
    v_readlane_b32 s84, v3, 2
    ds_read_b32 v3, v7
    s_mul_i32 s80, s92, 768
    s_waitcnt vmcnt(31)
    buffer_load_dwordx4 v2, s[4:7], s78 offen offset:1024 nt lds
    ds_write_b32 v6, v5
    s_bfe_u32 s92, s81, 0x40003
    s_mul_i32 s92, s92, 25165824
L_B32_2:
    s_cmp_lt_i32 s84, s82
    s_cbranch_scc1 L_B32_2w
    s_waitcnt vmcnt(31)
    buffer_load_dwordx4 v2, s[4:7], s78 offen offset:2048 nt lds
    v_add_u32 v5, 3, v5
    s_add_u32 s80, s80, s79
    s_add_u32 s80, s80, s92
    s_waitcnt vmcnt(31)
    buffer_load_dwordx4 v2, s[4:7], s78 offen offset:3072 nt lds
    v_readlane_b32 s84, v3, 3
    ds_read_b32 v3, v7
    s_add_u32 m0, m0, s85
    s_add_u32 s78, s78, s85
    s_waitcnt vmcnt(31)
    buffer_load_dwordx4 v2, s[4:7], s78 offen offset:0 nt lds
    ds_write_b32 v6, v5
    s_and_b32 s86, s81, 3
    s_mul_i32 s86, s86, 12288
L_B32_3:
    s_cmp_lt_i32 s84, s82
    s_cbranch_scc1 L_B32_3w
    s_waitcnt vmcnt(31)
    buffer_load_dwordx4 v2, s[4:7], s78 offen offset:1024 nt lds
    v_add_u32 v5, 3, v5
    v_readlane_b32 s83, v3, 4
    s_waitcnt vmcnt(31)
    buffer_load_dwordx4 v2, s[4:7], s78 offen offset:2048 nt lds
    v_readlane_b32 s84, v3, 0
    ds_read_b32 v3, v7
    s_add_u32 s82, s82, 1
    s_cmp_eq_u32 s81, 256
    s_cselect_b32 s83, -1, 32
    s_cmp_ge_u32 s81, 128
    s_waitcnt vmcnt(31)
    buffer_load_dwordx4 v2, s[4:7], s78 offen offset:3072 nt lds
    ds_write_b32 v6, v5
    s_cselect_b64 s[4:5], s[56:57], s[50:51]
    s_mov_b32 m0, s86
    s_mov_b32 s78, s80
    s_cmp_eq_u32 s83, 32
    s_cbranch_scc1 L_B32
L_drain:
    v_mov_b32 v18, 3090
    s_waitcnt vmcnt(30)
    ds_write_b32 v6, v18
    v_mov_b32 v18, 3093
    s_waitcnt vmcnt(27)
    ds_write_b32 v6, v18
    v_mov_b32 v18, 3096
    s_waitcnt vmcnt(24)
    ds_write_b32 v6, v18
    v_mov_b32 v18, 3099
    s_waitcnt vmcnt(21)
    ds_write_b32 v6, v18
    v_mov_b32 v18, 3102
    s_waitcnt vmcnt(18)
    ds_write_b32 v6, v18
    v_mov_b32 v18, 3105
    s_waitcnt vmcnt(15)
    ds_write_b32 v6, v18
    v_mov_b32 v18, 3108
    s_waitcnt vmcnt(12)
    ds_write_b32 v6, v18
    v_mov_b32 v18, 3111
    s_waitcnt vmcnt(9)
    ds_write_b32 v6, v18
    v_mov_b32 v18, 3114
    s_waitcnt vmcnt(6)
    ds_write_b32 v6, v18
    v_mov_b32 v18, 3117
    s_waitcnt vmcnt(3)
    ds_write_b32 v6, v18
    v_mov_b32 v18, 3120
    s_waitcnt vmcnt(0)
    ds_write_b32 v6, v18
    s_waitcnt lgkmcnt(0)
    s_endpgm
L_other:
    s_cmp_eq_u32 s76, 5
    s_cbranch_scc1 L_helper
    s_sub_u32 s78, s76, 1
    v_lshlrev_b32 v44, 3, v1
    v_cmp_gt_u32 vcc, 24, v1
    v_mov_b32 v23, 0xffffff40
    v_mov_b32 v18, 192
    v_cndmask_b32 v23, v23, v18, vcc
    v_add_u32 v45, v44, v23
    v_mov_b32 v18, 0x80008000
    v_cndmask_b32 v46, 0, v18, vcc
    v_lshrrev_b32 v19, 4, v1
    v_and_b32 v23, 15, v1
    v_mul_u32_u24 v20, 384, v19
    v_lshl_add_u32 v20, v23, 3, v20
    v_cmp_lt_u32 s[86:87], 7, v23
    v_mov_b32 v21, -64
    v_mov_b32 v18, 320
    v_cndmask_b32 v21, v18, v21, s[86:87]
    v_add_u32 v21, v20, v21
    s_lshl2_add_u32 s95, s78, s3
    s_mul_i32 s95, s95, 384
    s_lshl2_add_u32 s89, s78, s77
    s_xor_b32 s89, s89, 8192
    s_mov_b32 s34, 12288
    s_mov_b32 s35, 0x20000
    s_mov_b32 s38, 384
    s_mov_b32 s39, 0x20000
    s_mov_b32 s42, 384
    s_mov_b32 s43, 0x20000
    s_mov_b32 s14, 6291456
    s_mov_b32 s15, 0x20000
    s_mov_b32 s18, 6291456
    s_mov_b32 s19, 0x20000
    s_waitcnt lgkmcnt(0)
    s_mov_b64 s[32:33], s[48:49]
    s_mov_b64 s[36:37], s[62:63]
    s_mov_b64 s[40:41], s[64:65]
    buffer_load_dwordx2 v[24:25], v44, s[32:35], s95 offen
    buffer_load_dwordx2 v[26:27], v45, s[32:35], s95 offen
    buffer_load_dwordx2 v[28:29], v44, s[32:35], s95 offen offset:768
    buffer_load_dwordx2 v[30:31], v45, s[32:35], s95 offen offset:768
    buffer_load_dwordx2 v[40:41], v44, s[36:39], 0 offen
    buffer_load_dwordx2 v[42:43], v44, s[40:43], 0 offen
    s_mov_b64 s[12:13], s[66:67]
    s_mov_b64 s[16:17], s[68:69]
    s_barrier
    s_mov_b32 s83, 0x05040100
    s_mov_b32 s84, 0x07060302
    s_mul_i32 s92, s78, 3072
    v_lshl_add_u32 v2, v20, 1, s92
    v_add_u32 v12, s92, v20
    v_add_u32 v13, s92, v21
    s_lshl_b32 s92, s78, 5
    s_add_u32 s92, s92, 49152
    v_lshl_add_u32 v3, v19, 3, s92
    v_lshrrev_b32 v18, 3, v23
    v_lshl_add_u32 v4, v18, 7, v3
    v_lshlrev_b32 v9, 4, v23
    v_add_u32 v9, 65536, v9
    s_lshl2_add_u32 s92, s78, 77824
    v_mov_b32 v5, s92
    v_mov_b32 v6, 0
    v_mov_b32 v8, 1
    s_mul_i32 s79, s78, 3
    s_sub_u32 s79, s79, 9
    s_mov_b32 s80, 0
    s_mov_b32 s81, 0
    s_mul_i32 s92, s78, 1536
    s_add_u32 s92, s92, 65536
    v_lshl_add_u32 v14, v44, 1, s92
    v_lshl_add_u32 v16, v45, 1, s92
    s_waitcnt vmcnt(0)
    v_xor_b32 v42, v42, v46
    v_xor_b32 v43, v43, v46
    v_lshlrev_b32 v48, 16, v40
    v_and_b32 v49, 0xffff0000, v40
    v_lshlrev_b32 v50, 16, v41
    v_and_b32 v51, 0xffff0000, v41
    v_lshlrev_b32 v52, 16, v42
    v_and_b32 v53, 0xffff0000, v42
    v_lshlrev_b32 v54, 16, v43
    v_and_b32 v55, 0xffff0000, v43
    v_and_b32 v46, 0x80000000, v46
    s_mov_b32 exec_hi, 0xffff
    v_lshlrev_b32 v56, 16, v24
    v_and_b32 v57, 0xffff0000, v24
    v_lshlrev_b32 v58, 16, v25
    v_and_b32 v59, 0xffff0000, v25
    v_lshlrev_b32 v60, 16, v26
    v_and_b32 v61, 0xffff0000, v26
    v_lshlrev_b32 v62, 16, v27
    v_and_b32 v63, 0xffff0000, v27
    v_pk_mul_f32 v[56:57], v[56:57], v[48:49]
    v_pk_mul_f32 v[60:61], v[60:61], v[52:53]
    v_pk_mul_f32 v[58:59], v[58:59], v[50:51]
    v_pk_mul_f32 v[62:63], v[62:63], v[54:55]
    v_cvt_pk_bf16_f32 v56, v56, v60
    v_cvt_pk_bf16_f32 v57, v57, v61
    v_cvt_pk_bf16_f32 v58, v58, v62
    v_cvt_pk_bf16_f32 v59, v59, v63
    v_and_b32 v60, 0xffff0000, v56
    v_lshlrev_b32 v56, 16, v56
    v_and_b32 v61, 0xffff0000, v57
    v_lshlrev_b32 v57, 16, v57
    v_and_b32 v62, 0xffff0000, v58
    v_lshlrev_b32 v58, 16, v58
    v_and_b32 v63, 0xffff0000, v59
    v_lshlrev_b32 v59, 16, v59
    v_pk_add_f32 v[56:57], v[56:57], v[60:61]
    v_pk_add_f32 v[58:59], v[58:59], v[62:63]
    v_cvt_pk_bf16_f32 v64, v56, v56
    v_cvt_pk_bf16_f32 v65, v57, v57
    v_cvt_pk_bf16_f32 v66, v58, v58
    v_cvt_pk_bf16_f32 v67, v59, v59
    v_xor_b32 v64, v64, v46
    v_xor_b32 v65, v65, v46
    v_xor_b32 v66, v66, v46
    v_xor_b32 v67, v67, v46
    ds_write_b16 v14, v64 offset:0
    ds_write_b16_d16_hi v16, v64 offset:2
    ds_write_b16 v14, v65 offset:4
    ds_write_b16_d16_hi v16, v65 offset:6
    ds_write_b16 v14, v66 offset:8
    ds_write_b16_d16_hi v16, v66 offset:10
    ds_write_b16 v14, v67 offset:12
    ds_write_b16_d16_hi v16, v67 offset:14
    v_lshlrev_b32 v56, 16, v28
    v_and_b32 v57, 0xffff0000, v28
    v_lshlrev_b32 v58, 16, v29
    v_and_b32 v59, 0xffff0000, v29
    v_lshlrev_b32 v60, 16, v30
    v_and_b32 v61, 0xffff0000, v30
    v_lshlrev_b32 v62, 16, v31
    v_and_b32 v63, 0xffff0000, v31
    v_pk_mul_f32 v[56:57], v[56:57], v[48:49]
    v_pk_mul_f32 v[60:61], v[60:61], v[52:53]
    v_pk_mul_f32 v[58:59], v[58:59], v[50:51]
    v_pk_mul_f32 v[62:63], v[62:63], v[54:55]
    v_cvt_pk_bf16_f32 v56, v56, v60
    v_cvt_pk_bf16_f32 v57, v57, v61
    v_cvt_pk_bf16_f32 v58, v58, v62
    v_cvt_pk_bf16_f32 v59, v59, v63
    v_and_b32 v60, 0xffff0000, v56
    v_lshlrev_b32 v56, 16, v56
    v_and_b32 v61, 0xffff0000, v57
    v_lshlrev_b32 v57, 16, v57
    v_and_b32 v62, 0xffff0000, v58
    v_lshlrev_b32 v58, 16, v58
    v_and_b32 v63, 0xffff0000, v59
    v_lshlrev_b32 v59, 16, v59
    v_pk_add_f32 v[56:57], v[56:57], v[60:61]
    v_pk_add_f32 v[58:59], v[58:59], v[62:63]
    v_cvt_pk_bf16_f32 v68, v56, v56
    v_cvt_pk_bf16_f32 v69, v57, v57
    v_cvt_pk_bf16_f32 v70, v58, v58
    v_cvt_pk_bf16_f32 v71, v59, v59
    v_xor_b32 v68, v68, v46
    v_xor_b32 v69, v69, v46
    v_xor_b32 v70, v70, v46
    v_xor_b32 v71, v71, v46
    ds_write_b16 v14, v68 offset:768
    ds_write_b16_d16_hi v16, v68 offset:770
    ds_write_b16 v14, v69 offset:772
    ds_write_b16_d16_hi v16, v69 offset:774
    ds_write_b16 v14, v70 offset:776
    ds_write_b16_d16_hi v16, v70 offset:778
    ds_write_b16 v14, v71 offset:780
    ds_write_b16_d16_hi v16, v71 offset:782
    s_mov_b32 exec_hi, -1
    ds_write_b32 v5, v8 offset:160
    s_add_u32 s79, s79, 12
    s_cmp_ge_i32 s80, s79
    s_cbranch_scc1 L_cr0g
L_cr0:
    ds_read_b32 v19, v7
    s_sleep 1
    s_waitcnt lgkmcnt(0)
    v_readlane_b32 s80, v19, 5
    s_nop 0
    s_cmp_lt_i32 s80, s79
    s_cbranch_scc1 L_cr0
L_cr0g:
    ds_read_b64 v[72:73], v12 offset:0
    ds_read_b64 v[76:77], v12 offset:128
    ds_read_b64 v[80:81], v12 offset:256
    ds_read_b64 v[84:85], v12 offset:1536
    ds_read_b64 v[88:89], v12 offset:1664
    ds_read_b64 v[92:93], v12 offset:1792
    v_add_u32 v6, 1, v6
    ds_write_b32 v5, v6
    s_add_u32 s79, s79, 12
    s_cmp_ge_i32 s80, s79
    s_cbranch_scc1 L_cr1g
L_cr1:
    ds_read_b32 v19, v7
    s_sleep 1
    s_waitcnt lgkmcnt(0)
    v_readlane_b32 s80, v19, 5
    s_nop 0
    s_cmp_lt_i32 s80, s79
    s_cbranch_scc1 L_cr1
L_cr1g:
    ds_read_b64 v[74:75], v12 offset:12480
    ds_read_b64 v[78:79], v13 offset:12288
    ds_read_b64 v[82:83], v12 offset:12352
    ds_read_b64 v[86:87], v12 offset:14016
    ds_read_b64 v[90:91], v13 offset:13824
    ds_read_b64 v[94:95], v12 offset:13888
    v_add_u32 v6, 1, v6
    ds_write_b32 v5, v6
    s_mul_i32 s82, s89, 384
    s_add_u32 s89, s89, 2048
    s_and_b32 s89, s89, 16383
    buffer_load_dwordx2 v[120:121], v20, s[12:15], s82 offen offset:0
    buffer_load_dwordx2 v[122:123], v20, s[16:19], s82 offen offset:192
    buffer_load_dwordx2 v[124:125], v20, s[12:15], s82 offen offset:128
    buffer_load_dwordx2 v[126:127], v21, s[16:19], s82 offen
    buffer_load_dwordx2 v[128:129], v20, s[12:15], s82 offen offset:256
    buffer_load_dwordx2 v[130:131], v20, s[16:19], s82 offen offset:64
    s_add_u32 s79, s79, 12
    s_cmp_ge_i32 s80, s79
    s_cbranch_scc1 L_cr2g
L_cr2:
    ds_read_b32 v19, v7
    s_sleep 1
    s_waitcnt lgkmcnt(0)
    v_readlane_b32 s80, v19, 5
    s_nop 0
    s_cmp_lt_i32 s80, s79
    s_cbranch_scc1 L_cr2
L_cr2g:
    ds_read_b64 v[96:97], v12 offset:24576
    ds_read_b64 v[100:101], v12 offset:24704
    ds_read_b64 v[104:105], v12 offset:24832
    ds_read_b64 v[108:109], v12 offset:26112
    ds_read_b64 v[112:113], v12 offset:26240
    ds_read_b64 v[116:117], v12 offset:26368
    v_add_u32 v6, 1, v6
    ds_write_b32 v5, v6
    s_add_u32 s79, s79, 12
    s_cmp_ge_i32 s80, s79
    s_cbranch_scc1 L_cr3g
L_cr3:
    ds_read_b32 v19, v7
    s_sleep 1
    s_waitcnt lgkmcnt(0)
    v_readlane_b32 s80, v19, 5
    s_nop 0
    s_cmp_lt_i32 s80, s79
    s_cbranch_scc1 L_cr3
L_cr3g:
    ds_read_b64 v[98:99], v12 offset:37056
    ds_read_b64 v[102:103], v13 offset:36864
    ds_read_b64 v[106:107], v12 offset:36928
    ds_read_b64 v[110:111], v12 offset:38592
    ds_read_b64 v[114:115], v13 offset:38400
    ds_read_b64 v[118:119], v12 offset:38464
    v_add_u32 v6, 1, v6
    ds_write_b32 v5, v6
    s_mul_i32 s82, s89, 384
    s_add_u32 s89, s89, 2048
    s_and_b32 s89, s89, 16383
    buffer_load_dwordx2 v[132:133], v20, s[12:15], s82 offen offset:0
    buffer_load_dwordx2 v[134:135], v20, s[16:19], s82 offen offset:192
    buffer_load_dwordx2 v[136:137], v20, s[12:15], s82 offen offset:128
    buffer_load_dwordx2 v[138:139], v21, s[16:19], s82 offen
    buffer_load_dwordx2 v[140:141], v20, s[12:15], s82 offen offset:256
    buffer_load_dwordx2 v[142:143], v20, s[16:19], s82 offen offset:64
L_kph:
    s_lshr_b32 s94, s81, 1
    s_add_u32 s88, s94, 40
    s_lshl2_add_u32 s92, s94, 77888
    v_mov_b32 v22, s92
    s_nop 1
L_kw:
    ds_read_b32 v19, v7
    ds_read_b128 v[48:51], v9 offset:0
    ds_read_b128 v[52:55], v9 offset:256
    ds_read_b128 v[56:59], v9 offset:512
    s_waitcnt lgkmcnt(0)
    v_readlane_b32 s92, v19, s88
    v_readlane_b32 s93, v19, 12
    s_cmp_eq_u32 s92, 0
    s_nop 3
    s_cbranch_scc1 L_kw
    s_cmp_le_u32 s93, s94
    s_cbranch_scc1 L_kw
    v_add_u32 v9, 768, v9
    s_cmp_lg_u32 s81, 0
    s_nop 0
    s_cbranch_scc1 L_ncs0
    v_perm_b32 v36, v74, v72, s83
    v_perm_b32 v74, v74, v72, s84
    v_perm_b32 v37, v75, v73, s83
    v_perm_b32 v75, v75, v73, s84
    v_perm_b32 v38, v78, v76, s83
    v_perm_b32 v78, v78, v76, s84
    v_perm_b32 v39, v79, v77, s83
    v_perm_b32 v79, v79, v77, s84
    v_perm_b32 v40, v82, v80, s83
    v_perm_b32 v82, v82, v80, s84
    v_perm_b32 v41, v83, v81, s83
    v_perm_b32 v83, v83, v81, s84
    v_mov_b64 v[72:73], v[36:37]
    v_mov_b64 v[76:77], v[38:39]
    v_mov_b64 v[80:81], v[40:41]
    s_nop 1
L_ncs0:
    v_dot2_f32_bf16 v36, v72, v48, 0
    v_dot2_f32_bf16 v37, v74, v49, 0
    v_dot2_f32_bf16 v38, v73, v50, 0
    v_dot2_f32_bf16 v39, v75, v51, 0
    v_dot2_f32_bf16 v40, v76, v52, 0
    v_dot2_f32_bf16 v41, v78, v53, 0
    v_dot2_f32_bf16 v42, v77, v54, 0
    v_dot2_f32_bf16 v43, v79, v55, 0
    v_dot2_f32_bf16 v44, v80, v56, 0
    v_dot2_f32_bf16 v45, v82, v57, 0
    v_dot2_f32_bf16 v46, v81, v58, 0
    v_dot2_f32_bf16 v47, v83, v59, 0
    s_add_u32 s79, s79, 12
    s_cmp_ge_i32 s80, s79
    s_cbranch_scc1 L_kr0g
L_kr0:
    ds_read_b32 v19, v7
    s_sleep 1
    s_waitcnt lgkmcnt(0)
    v_readlane_b32 s80, v19, 5
    s_nop 0
    s_cmp_lt_i32 s80, s79
    s_cbranch_scc1 L_kr0
L_kr0g:
    ds_read_b32 v10, v3 offset:0
    ds_read_b128 v[24:27], v2 offset:0
    ds_read_b128 v[28:31], v2 offset:256
    ds_read_b128 v[32:35], v2 offset:512
    v_add_u32 v6, 1, v6
    ds_write_b32 v5, v6
    s_waitcnt lgkmcnt(3)
    v_and_b32 v12, 0xffff0000, v10
    v_cvt_f32_i32 v24, v24
    v_cvt_f32_i32 v25, v25
    v_cvt_f32_i32 v26, v26
    v_cvt_f32_i32 v27, v27
    v_pk_add_f32 v[24:25], v[24:25], v[12:13] op_sel:[0,0] op_sel_hi:[1,0] neg_lo:[0,1] neg_hi:[0,1]
    v_pk_add_f32 v[26:27], v[26:27], v[12:13] op_sel:[0,0] op_sel_hi:[1,0] neg_lo:[0,1] neg_hi:[0,1]
    v_pk_mul_f32 v[14:15], v[24:25], v[36:37]
    v_pk_fma_f32 v[14:15], v[26:27], v[38:39], v[14:15]
    s_waitcnt lgkmcnt(2)
    v_cvt_f32_i32 v28, v28
    v_cvt_f32_i32 v29, v29
    v_cvt_f32_i32 v30, v30
    v_cvt_f32_i32 v31, v31
    v_pk_add_f32 v[28:29], v[28:29], v[12:13] op_sel:[0,0] op_sel_hi:[1,0] neg_lo:[0,1] neg_hi:[0,1]
    v_pk_add_f32 v[30:31], v[30:31], v[12:13] op_sel:[0,0] op_sel_hi:[1,0] neg_lo:[0,1] neg_hi:[0,1]
    v_pk_fma_f32 v[14:15], v[28:29], v[40:41], v[14:15]
    v_pk_fma_f32 v[14:15], v[30:31], v[42:43], v[14:15]
    s_waitcnt lgkmcnt(1)
    v_cvt_f32_i32 v32, v32
    v_cvt_f32_i32 v33, v33
    v_cvt_f32_i32 v34, v34
    v_cvt_f32_i32 v35, v35
    v_pk_add_f32 v[32:33], v[32:33], v[12:13] op_sel:[0,0] op_sel_hi:[1,0] neg_lo:[0,1] neg_hi:[0,1]
    v_pk_add_f32 v[34:35], v[34:35], v[12:13] op_sel:[0,0] op_sel_hi:[1,0] neg_lo:[0,1] neg_hi:[0,1]
    v_pk_fma_f32 v[14:15], v[32:33], v[44:45], v[14:15]
    v_pk_fma_f32 v[14:15], v[34:35], v[46:47], v[14:15]
    v_add_f32 v14, v14, v15
    s_nop 1
    v_add_f32_dpp v18, v14, v14 row_ror:8 row_mask:0xf bank_mask:0x3
    s_cmp_lg_u32 s81, 0
    s_nop 0
    s_cbranch_scc1 L_ncs1
    s_mul_i32 s82, s89, 384
    s_add_u32 s89, s89, 2048
    s_and_b32 s89, s89, 16383
    buffer_load_dwordx2 v[144:145], v20, s[12:15], s82 offen offset:0
    buffer_load_dwordx2 v[146:147], v20, s[16:19], s82 offen offset:192
    buffer_load_dwordx2 v[148:149], v20, s[12:15], s82 offen offset:128
    buffer_load_dwordx2 v[150:151], v21, s[16:19], s82 offen
    buffer_load_dwordx2 v[152:153], v20, s[12:15], s82 offen offset:256
    buffer_load_dwordx2 v[154:155], v20, s[16:19], s82 offen offset:64
    v_perm_b32 v36, v86, v84, s83
    v_perm_b32 v86, v86, v84, s84
    v_perm_b32 v37, v87, v85, s83
    v_perm_b32 v87, v87, v85, s84
    v_perm_b32 v38, v90, v88, s83
    v_perm_b32 v90, v90, v88, s84
    v_perm_b32 v39, v91, v89, s83
    v_perm_b32 v91, v91, v89, s84
    v_perm_b32 v40, v94, v92, s83
    v_perm_b32 v94, v94, v92, s84
    v_perm_b32 v41, v95, v93, s83
    v_perm_b32 v95, v95, v93, s84
    v_mov_b64 v[84:85], v[36:37]
    v_mov_b64 v[88:89], v[38:39]
    v_mov_b64 v[92:93], v[40:41]
    s_nop 1
L_ncs1:
    v_dot2_f32_bf16 v36, v84, v48, 0
    v_dot2_f32_bf16 v37, v86, v49, 0
    v_dot2_f32_bf16 v38, v85, v50, 0
    v_dot2_f32_bf16 v39, v87, v51, 0
    v_dot2_f32_bf16 v40, v88, v52, 0
    v_dot2_f32_bf16 v41, v90, v53, 0
    v_dot2_f32_bf16 v42, v89, v54, 0
    v_dot2_f32_bf16 v43, v91, v55, 0
    v_dot2_f32_bf16 v44, v92, v56, 0
    v_dot2_f32_bf16 v45, v94, v57, 0
    v_dot2_f32_bf16 v46, v93, v58, 0
    v_dot2_f32_bf16 v47, v95, v59, 0
    s_add_u32 s79, s79, 12
    s_cmp_ge_i32 s80, s79
    s_cbranch_scc1 L_kr1g
L_kr1:
    ds_read_b32 v19, v7
    s_sleep 1
    s_waitcnt lgkmcnt(0)
    v_readlane_b32 s80, v19, 5
    s_nop 0
    s_cmp_lt_i32 s80, s79
    s_cbranch_scc1 L_kr1
L_kr1g:
    ds_read_b32 v11, v3 offset:128
    ds_read_b128 v[24:27], v2 offset:12288
    ds_read_b128 v[28:31], v2 offset:12544
    ds_read_b128 v[32:35], v2 offset:12800
    v_add_u32 v6, 1, v6
    ds_write_b32 v5, v6
    s_waitcnt lgkmcnt(3)
    v_and_b32 v12, 0xffff0000, v11
    v_cvt_f32_i32 v24, v24
    v_cvt_f32_i32 v25, v25
    v_cvt_f32_i32 v26, v26
    v_cvt_f32_i32 v27, v27
    v_pk_add_f32 v[24:25], v[24:25], v[12:13] op_sel:[0,0] op_sel_hi:[1,0] neg_lo:[0,1] neg_hi:[0,1]
    v_pk_add_f32 v[26:27], v[26:27], v[12:13] op_sel:[0,0] op_sel_hi:[1,0] neg_lo:[0,1] neg_hi:[0,1]
    v_pk_mul_f32 v[16:17], v[24:25], v[36:37]
    v_pk_fma_f32 v[16:17], v[26:27], v[38:39], v[16:17]
    s_waitcnt lgkmcnt(2)
    v_cvt_f32_i32 v28, v28
    v_cvt_f32_i32 v29, v29
    v_cvt_f32_i32 v30, v30
    v_cvt_f32_i32 v31, v31
    v_pk_add_f32 v[28:29], v[28:29], v[12:13] op_sel:[0,0] op_sel_hi:[1,0] neg_lo:[0,1] neg_hi:[0,1]
    v_pk_add_f32 v[30:31], v[30:31], v[12:13] op_sel:[0,0] op_sel_hi:[1,0] neg_lo:[0,1] neg_hi:[0,1]
    v_pk_fma_f32 v[16:17], v[28:29], v[40:41], v[16:17]
    v_pk_fma_f32 v[16:17], v[30:31], v[42:43], v[16:17]
    s_waitcnt lgkmcnt(1)
    v_cvt_f32_i32 v32, v32
    v_cvt_f32_i32 v33, v33
    v_cvt_f32_i32 v34, v34
    v_cvt_f32_i32 v35, v35
    v_pk_add_f32 v[32:33], v[32:33], v[12:13] op_sel:[0,0] op_sel_hi:[1,0] neg_lo:[0,1] neg_hi:[0,1]
    v_pk_add_f32 v[34:35], v[34:35], v[12:13] op_sel:[0,0] op_sel_hi:[1,0] neg_lo:[0,1] neg_hi:[0,1]
    v_pk_fma_f32 v[16:17], v[32:33], v[44:45], v[16:17]
    v_pk_fma_f32 v[16:17], v[34:35], v[46:47], v[16:17]
    v_add_f32 v16, v16, v17
    v_cndmask_b32 v23, v10, v11, s[86:87]
    v_lshlrev_b32 v23, 16, v23
    v_add_f32_dpp v18, v16, v16 row_ror:8 row_mask:0xf bank_mask:0xc
    v_mul_f32 v23, 0x3dd53b95, v23
    s_nop 0
    v_add_f32_dpp v18, v18, v18 row_half_mirror row_mask:0xf bank_mask:0xf
    s_nop 1
    v_add_f32_dpp v18, v18, v18 quad_perm:[2,3,0,1] row_mask:0xf bank_mask:0xf
    s_nop 1
    v_add_f32_dpp v18, v18, v18 quad_perm:[1,0,3,2] row_mask:0xf bank_mask:0xf
    v_mul_f32 v18, v23, v18
    ds_write_b32 v4, v18 offset:0
    s_cmp_lg_u32 s81, 0
    s_cbranch_scc1 L_ncs2
    v_perm_b32 v36, v98, v96, s83
    v_perm_b32 v98, v98, v96, s84
    v_perm_b32 v37, v99, v97, s83
    v_perm_b32 v99, v99, v97, s84
    v_perm_b32 v38, v102, v100, s83
    v_perm_b32 v102, v102, v100, s84
    v_perm_b32 v39, v103, v101, s83
    v_perm_b32 v103, v103, v101, s84
    v_perm_b32 v40, v106, v104, s83
    v_perm_b32 v106, v106, v104, s84
    v_perm_b32 v41, v107, v105, s83
    v_perm_b32 v107, v107, v105, s84
    v_mov_b64 v[96:97], v[36:37]
    v_mov_b64 v[100:101], v[38:39]
    v_mov_b64 v[104:105], v[40:41]
    s_nop 1
L_ncs2:
    v_dot2_f32_bf16 v36, v96, v48, 0
    v_dot2_f32_bf16 v37, v98, v49, 0
    v_dot2_f32_bf16 v38, v97, v50, 0
    v_dot2_f32_bf16 v39, v99, v51, 0
    v_dot2_f32_bf16 v40, v100, v52, 0
    v_dot2_f32_bf16 v41, v102, v53, 0
    v_dot2_f32_bf16 v42, v101, v54, 0
    v_dot2_f32_bf16 v43, v103, v55, 0
    v_dot2_f32_bf16 v44, v104, v56, 0
    v_dot2_f32_bf16 v45, v106, v57, 0
    v_dot2_f32_bf16 v46, v105, v58, 0
    v_dot2_f32_bf16 v47, v107, v59, 0
    s_add_u32 s79, s79, 12
    s_cmp_ge_i32 s80, s79
    s_cbranch_scc1 L_kr2g
L_kr2:
    ds_read_b32 v19, v7
    s_sleep 1
    s_waitcnt lgkmcnt(0)
    v_readlane_b32 s80, v19, 5
    s_nop 0
    s_cmp_lt_i32 s80, s79
    s_cbranch_scc1 L_kr2
L_kr2g:
    ds_read_b32 v10, v3 offset:256
    ds_read_b128 v[24:27], v2 offset:24576
    ds_read_b128 v[28:31], v2 offset:24832
    ds_read_b128 v[32:35], v2 offset:25088
    v_add_u32 v6, 1, v6
    ds_write_b32 v5, v6
    s_waitcnt lgkmcnt(3)
    v_and_b32 v12, 0xffff0000, v10
    v_cvt_f32_i32 v24, v24
    v_cvt_f32_i32 v25, v25
    v_cvt_f32_i32 v26, v26
    v_cvt_f32_i32 v27, v27
    v_pk_add_f32 v[24:25], v[24:25], v[12:13] op_sel:[0,0] op_sel_hi:[1,0] neg_lo:[0,1] neg_hi:[0,1]
    v_pk_add_f32 v[26:27], v[26:27], v[12:13] op_sel:[0,0] op_sel_hi:[1,0] neg_lo:[0,1] neg_hi:[0,1]
    v_pk_mul_f32 v[14:15], v[24:25], v[36:37]
    v_pk_fma_f32 v[14:15], v[26:27], v[38:39], v[14:15]
    s_waitcnt lgkmcnt(2)
    v_cvt_f32_i32 v28, v28
    v_cvt_f32_i32 v29, v29
    v_cvt_f32_i32 v30, v30
    v_cvt_f32_i32 v31, v31
    v_pk_add_f32 v[28:29], v[28:29], v[12:13] op_sel:[0,0] op_sel_hi:[1,0] neg_lo:[0,1] neg_hi:[0,1]
    v_pk_add_f32 v[30:31], v[30:31], v[12:13] op_sel:[0,0] op_sel_hi:[1,0] neg_lo:[0,1] neg_hi:[0,1]
    v_pk_fma_f32 v[14:15], v[28:29], v[40:41], v[14:15]
    v_pk_fma_f32 v[14:15], v[30:31], v[42:43], v[14:15]
    s_waitcnt lgkmcnt(1)
    v_cvt_f32_i32 v32, v32
    v_cvt_f32_i32 v33, v33
    v_cvt_f32_i32 v34, v34
    v_cvt_f32_i32 v35, v35
    v_pk_add_f32 v[32:33], v[32:33], v[12:13] op_sel:[0,0] op_sel_hi:[1,0] neg_lo:[0,1] neg_hi:[0,1]
    v_pk_add_f32 v[34:35], v[34:35], v[12:13] op_sel:[0,0] op_sel_hi:[1,0] neg_lo:[0,1] neg_hi:[0,1]
    v_pk_fma_f32 v[14:15], v[32:33], v[44:45], v[14:15]
    v_pk_fma_f32 v[14:15], v[34:35], v[46:47], v[14:15]
    v_add_f32 v14, v14, v15
    s_nop 1
    v_add_f32_dpp v18, v14, v14 row_ror:8 row_mask:0xf bank_mask:0x3
    s_cmp_lg_u32 s81, 0
    s_nop 0
    s_cbranch_scc1 L_ncs3
    s_mul_i32 s82, s89, 384
    s_add_u32 s89, s89, 2048
    s_and_b32 s89, s89, 16383
    buffer_load_dwordx2 v[156:157], v20, s[12:15], s82 offen offset:0
    buffer_load_dwordx2 v[158:159], v20, s[16:19], s82 offen offset:192
    buffer_load_dwordx2 v[160:161], v20, s[12:15], s82 offen offset:128
    buffer_load_dwordx2 v[162:163], v21, s[16:19], s82 offen
    buffer_load_dwordx2 v[164:165], v20, s[12:15], s82 offen offset:256
    buffer_load_dwordx2 v[166:167], v20, s[16:19], s82 offen offset:64
    v_perm_b32 v36, v110, v108, s83
    v_perm_b32 v110, v110, v108, s84
    v_perm_b32 v37, v111, v109, s83
    v_perm_b32 v111, v111, v109, s84
    v_perm_b32 v38, v114, v112, s83
    v_perm_b32 v114, v114, v112, s84
    v_perm_b32 v39, v115, v113, s83
    v_perm_b32 v115, v115, v113, s84
    v_perm_b32 v40, v118, v116, s83
    v_perm_b32 v118, v118, v116, s84
    v_perm_b32 v41, v119, v117, s83
    v_perm_b32 v119, v119, v117, s84
    v_mov_b64 v[108:109], v[36:37]
    v_mov_b64 v[112:113], v[38:39]
    v_mov_b64 v[116:117], v[40:41]
    s_nop 1
L_ncs3:
    v_dot2_f32_bf16 v36, v108, v48, 0
    v_dot2_f32_bf16 v37, v110, v49, 0
    v_dot2_f32_bf16 v38, v109, v50, 0
    v_dot2_f32_bf16 v39, v111, v51, 0
    v_dot2_f32_bf16 v40, v112, v52, 0
    v_dot2_f32_bf16 v41, v114, v53, 0
    v_dot2_f32_bf16 v42, v113, v54, 0
    v_dot2_f32_bf16 v43, v115, v55, 0
    v_dot2_f32_bf16 v44, v116, v56, 0
    v_dot2_f32_bf16 v45, v118, v57, 0
    v_dot2_f32_bf16 v46, v117, v58, 0
    v_dot2_f32_bf16 v47, v119, v59, 0
    s_add_u32 s79, s79, 12
    s_cmp_ge_i32 s80, s79
    s_cbranch_scc1 L_kr3g
L_kr3:
    ds_read_b32 v19, v7
    s_sleep 1
    s_waitcnt lgkmcnt(0)
    v_readlane_b32 s80, v19, 5
    s_nop 0
    s_cmp_lt_i32 s80, s79
    s_cbranch_scc1 L_kr3
L_kr3g:
    ds_read_b32 v11, v3 offset:384
    ds_read_b128 v[24:27], v2 offset:36864
    ds_read_b128 v[28:31], v2 offset:37120
    ds_read_b128 v[32:35], v2 offset:37376
    v_add_u32 v6, 1, v6
    ds_write_b32 v5, v6
    s_waitcnt lgkmcnt(3)
    v_and_b32 v12, 0xffff0000, v11
    v_cvt_f32_i32 v24, v24
    v_cvt_f32_i32 v25, v25
    v_cvt_f32_i32 v26, v26
    v_cvt_f32_i32 v27, v27
    v_pk_add_f32 v[24:25], v[24:25], v[12:13] op_sel:[0,0] op_sel_hi:[1,0] neg_lo:[0,1] neg_hi:[0,1]
    v_pk_add_f32 v[26:27], v[26:27], v[12:13] op_sel:[0,0] op_sel_hi:[1,0] neg_lo:[0,1] neg_hi:[0,1]
    v_pk_mul_f32 v[16:17], v[24:25], v[36:37]
    v_pk_fma_f32 v[16:17], v[26:27], v[38:39], v[16:17]
    s_waitcnt lgkmcnt(2)
    v_cvt_f32_i32 v28, v28
    v_cvt_f32_i32 v29, v29
    v_cvt_f32_i32 v30, v30
    v_cvt_f32_i32 v31, v31
    v_pk_add_f32 v[28:29], v[28:29], v[12:13] op_sel:[0,0] op_sel_hi:[1,0] neg_lo:[0,1] neg_hi:[0,1]
    v_pk_add_f32 v[30:31], v[30:31], v[12:13] op_sel:[0,0] op_sel_hi:[1,0] neg_lo:[0,1] neg_hi:[0,1]
    v_pk_fma_f32 v[16:17], v[28:29], v[40:41], v[16:17]
    v_pk_fma_f32 v[16:17], v[30:31], v[42:43], v[16:17]
    s_waitcnt lgkmcnt(1)
    v_cvt_f32_i32 v32, v32
    v_cvt_f32_i32 v33, v33
    v_cvt_f32_i32 v34, v34
    v_cvt_f32_i32 v35, v35
    v_pk_add_f32 v[32:33], v[32:33], v[12:13] op_sel:[0,0] op_sel_hi:[1,0] neg_lo:[0,1] neg_hi:[0,1]
    v_pk_add_f32 v[34:35], v[34:35], v[12:13] op_sel:[0,0] op_sel_hi:[1,0] neg_lo:[0,1] neg_hi:[0,1]
    v_pk_fma_f32 v[16:17], v[32:33], v[44:45], v[16:17]
    v_pk_fma_f32 v[16:17], v[34:35], v[46:47], v[16:17]
    v_add_f32 v16, v16, v17
    v_cndmask_b32 v23, v10, v11, s[86:87]
    v_lshlrev_b32 v23, 16, v23
    v_add_f32_dpp v18, v16, v16 row_ror:8 row_mask:0xf bank_mask:0xc
    v_mul_f32 v23, 0x3dd53b95, v23
    s_nop 0
    v_add_f32_dpp v18, v18, v18 row_half_mirror row_mask:0xf bank_mask:0xf
    s_nop 1
    v_add_f32_dpp v18, v18, v18 quad_perm:[2,3,0,1] row_mask:0xf bank_mask:0xf
    s_nop 1
    v_add_f32_dpp v18, v18, v18 quad_perm:[1,0,3,2] row_mask:0xf bank_mask:0xf
    v_mul_f32 v18, v23, v18
    ds_write_b32 v4, v18 offset:256
    s_cmp_lg_u32 s81, 0
    s_cbranch_scc1 L_ncs4
    s_waitcnt vmcnt(18)
    v_perm_b32 v36, v122, v120, s83
    v_perm_b32 v122, v122, v120, s84
    v_perm_b32 v37, v123, v121, s83
    v_perm_b32 v123, v123, v121, s84
    v_perm_b32 v38, v126, v124, s83
    v_perm_b32 v126, v126, v124, s84
    v_perm_b32 v39, v127, v125, s83
    v_perm_b32 v127, v127, v125, s84
    v_perm_b32 v40, v130, v128, s83
    v_perm_b32 v130, v130, v128, s84
    v_perm_b32 v41, v131, v129, s83
    v_perm_b32 v131, v131, v129, s84
    v_mov_b64 v[120:121], v[36:37]
    v_mov_b64 v[124:125], v[38:39]
    v_mov_b64 v[128:129], v[40:41]
    s_nop 1
L_ncs4:
    v_dot2_f32_bf16 v36, v120, v48, 0
    v_dot2_f32_bf16 v37, v122, v49, 0
    v_dot2_f32_bf16 v38, v121, v50, 0
    v_dot2_f32_bf16 v39, v123, v51, 0
    v_dot2_f32_bf16 v40, v124, v52, 0
    v_dot2_f32_bf16 v41, v126, v53, 0
    v_dot2_f32_bf16 v42, v125, v54, 0
    v_dot2_f32_bf16 v43, v127, v55, 0
    v_dot2_f32_bf16 v44, v128, v56, 0
    v_dot2_f32_bf16 v45, v130, v57, 0
    v_dot2_f32_bf16 v46, v129, v58, 0
    v_dot2_f32_bf16 v47, v131, v59, 0
    s_add_u32 s79, s79, 12
    s_cmp_ge_i32 s80, s79
    s_cbranch_scc1 L_kr4g
L_kr4:
    ds_read_b32 v19, v7
    s_sleep 1
    s_waitcnt lgkmcnt(0)
    v_readlane_b32 s80, v19, 5
    s_nop 0
    s_cmp_lt_i32 s80, s79
    s_cbranch_scc1 L_kr4
L_kr4g:
    ds_read_b32 v10, v3 offset:512
    ds_read_b128 v[24:27], v2 offset:0
    ds_read_b128 v[28:31], v2 offset:256
    ds_read_b128 v[32:35], v2 offset:512
    v_add_u32 v6, 1, v6
    ds_write_b32 v5, v6
    s_waitcnt lgkmcnt(3)
    v_and_b32 v12, 0xffff0000, v10
    v_cvt_f32_i32 v24, v24
    v_cvt_f32_i32 v25, v25
    v_cvt_f32_i32 v26, v26
    v_cvt_f32_i32 v27, v27
    v_pk_add_f32 v[24:25], v[24:25], v[12:13] op_sel:[0,0] op_sel_hi:[1,0] neg_lo:[0,1] neg_hi:[0,1]
    v_pk_add_f32 v[26:27], v[26:27], v[12:13] op_sel:[0,0] op_sel_hi:[1,0] neg_lo:[0,1] neg_hi:[0,1]
    v_pk_mul_f32 v[14:15], v[24:25], v[36:37]
    v_pk_fma_f32 v[14:15], v[26:27], v[38:39], v[14:15]
    s_waitcnt lgkmcnt(2)
    v_cvt_f32_i32 v28, v28
    v_cvt_f32_i32 v29, v29
    v_cvt_f32_i32 v30, v30
    v_cvt_f32_i32 v31, v31
    v_pk_add_f32 v[28:29], v[28:29], v[12:13] op_sel:[0,0] op_sel_hi:[1,0] neg_lo:[0,1] neg_hi:[0,1]
    v_pk_add_f32 v[30:31], v[30:31], v[12:13] op_sel:[0,0] op_sel_hi:[1,0] neg_lo:[0,1] neg_hi:[0,1]
    v_pk_fma_f32 v[14:15], v[28:29], v[40:41], v[14:15]
    v_pk_fma_f32 v[14:15], v[30:31], v[42:43], v[14:15]
    s_waitcnt lgkmcnt(1)
    v_cvt_f32_i32 v32, v32
    v_cvt_f32_i32 v33, v33
    v_cvt_f32_i32 v34, v34
    v_cvt_f32_i32 v35, v35
    v_pk_add_f32 v[32:33], v[32:33], v[12:13] op_sel:[0,0] op_sel_hi:[1,0] neg_lo:[0,1] neg_hi:[0,1]
    v_pk_add_f32 v[34:35], v[34:35], v[12:13] op_sel:[0,0] op_sel_hi:[1,0] neg_lo:[0,1] neg_hi:[0,1]
    v_pk_fma_f32 v[14:15], v[32:33], v[44:45], v[14:15]
    v_pk_fma_f32 v[14:15], v[34:35], v[46:47], v[14:15]
    v_add_f32 v14, v14, v15
    s_nop 1
    v_add_f32_dpp v18, v14, v14 row_ror:8 row_mask:0xf bank_mask:0x3
    s_cmp_lg_u32 s81, 0
    s_nop 0
    s_cbranch_scc1 L_ncs5
    s_waitcnt vmcnt(12)
    v_perm_b32 v36, v134, v132, s83
    v_perm_b32 v134, v134, v132, s84
    v_perm_b32 v37, v135, v133, s83
    v_perm_b32 v135, v135, v133, s84
    v_perm_b32 v38, v138, v136, s83
    v_perm_b32 v138, v138, v136, s84
    v_perm_b32 v39, v139, v137, s83
    v_perm_b32 v139, v139, v137, s84
    v_perm_b32 v40, v142, v140, s83
    v_perm_b32 v142, v142, v140, s84
    v_perm_b32 v41, v143, v141, s83
    v_perm_b32 v143, v143, v141, s84
    v_mov_b64 v[132:133], v[36:37]
    v_mov_b64 v[136:137], v[38:39]
    v_mov_b64 v[140:141], v[40:41]
    s_nop 1
L_ncs5:
    v_dot2_f32_bf16 v36, v132, v48, 0
    v_dot2_f32_bf16 v37, v134, v49, 0
    v_dot2_f32_bf16 v38, v133, v50, 0
    v_dot2_f32_bf16 v39, v135, v51, 0
    v_dot2_f32_bf16 v40, v136, v52, 0
    v_dot2_f32_bf16 v41, v138, v53, 0
    v_dot2_f32_bf16 v42, v137, v54, 0
    v_dot2_f32_bf16 v43, v139, v55, 0
    v_dot2_f32_bf16 v44, v140, v56, 0
    v_dot2_f32_bf16 v45, v142, v57, 0
    v_dot2_f32_bf16 v46, v141, v58, 0
    v_dot2_f32_bf16 v47, v143, v59, 0
    s_add_u32 s79, s79, 12
    s_cmp_ge_i32 s80, s79
    s_cbranch_scc1 L_kr5g
L_kr5:
    ds_read_b32 v19, v7
    s_sleep 1
    s_waitcnt lgkmcnt(0)
    v_readlane_b32 s80, v19, 5
    s_nop 0
    s_cmp_lt_i32 s80, s79
    s_cbranch_scc1 L_kr5
L_kr5g:
    ds_read_b32 v11, v3 offset:640
    ds_read_b128 v[24:27], v2 offset:12288
    ds_read_b128 v[28:31], v2 offset:12544
    ds_read_b128 v[32:35], v2 offset:12800
    v_add_u32 v6, 1, v6
    ds_write_b32 v5, v6
    s_waitcnt lgkmcnt(3)
    v_and_b32 v12, 0xffff0000, v11
    v_cvt_f32_i32 v24, v24
    v_cvt_f32_i32 v25, v25
    v_cvt_f32_i32 v26, v26
    v_cvt_f32_i32 v27, v27
    v_pk_add_f32 v[24:25], v[24:25], v[12:13] op_sel:[0,0] op_sel_hi:[1,0] neg_lo:[0,1] neg_hi:[0,1]
    v_pk_add_f32 v[26:27], v[26:27], v[12:13] op_sel:[0,0] op_sel_hi:[1,0] neg_lo:[0,1] neg_hi:[0,1]
    v_pk_mul_f32 v[16:17], v[24:25], v[36:37]
    v_pk_fma_f32 v[16:17], v[26:27], v[38:39], v[16:17]
    s_waitcnt lgkmcnt(2)
    v_cvt_f32_i32 v28, v28
    v_cvt_f32_i32 v29, v29
    v_cvt_f32_i32 v30, v30
    v_cvt_f32_i32 v31, v31
    v_pk_add_f32 v[28:29], v[28:29], v[12:13] op_sel:[0,0] op_sel_hi:[1,0] neg_lo:[0,1] neg_hi:[0,1]
    v_pk_add_f32 v[30:31], v[30:31], v[12:13] op_sel:[0,0] op_sel_hi:[1,0] neg_lo:[0,1] neg_hi:[0,1]
    v_pk_fma_f32 v[16:17], v[28:29], v[40:41], v[16:17]
    v_pk_fma_f32 v[16:17], v[30:31], v[42:43], v[16:17]
    s_waitcnt lgkmcnt(1)
    v_cvt_f32_i32 v32, v32
    v_cvt_f32_i32 v33, v33
    v_cvt_f32_i32 v34, v34
    v_cvt_f32_i32 v35, v35
    v_pk_add_f32 v[32:33], v[32:33], v[12:13] op_sel:[0,0] op_sel_hi:[1,0] neg_lo:[0,1] neg_hi:[0,1]
    v_pk_add_f32 v[34:35], v[34:35], v[12:13] op_sel:[0,0] op_sel_hi:[1,0] neg_lo:[0,1] neg_hi:[0,1]
    v_pk_fma_f32 v[16:17], v[32:33], v[44:45], v[16:17]
    v_pk_fma_f32 v[16:17], v[34:35], v[46:47], v[16:17]
    v_add_f32 v16, v16, v17
    v_cndmask_b32 v23, v10, v11, s[86:87]
    v_lshlrev_b32 v23, 16, v23
    v_add_f32_dpp v18, v16, v16 row_ror:8 row_mask:0xf bank_mask:0xc
    v_mul_f32 v23, 0x3dd53b95, v23
    s_nop 0
    v_add_f32_dpp v18, v18, v18 row_half_mirror row_mask:0xf bank_mask:0xf
    s_nop 1
    v_add_f32_dpp v18, v18, v18 quad_perm:[2,3,0,1] row_mask:0xf bank_mask:0xf
    s_nop 1
    v_add_f32_dpp v18, v18, v18 quad_perm:[1,0,3,2] row_mask:0xf bank_mask:0xf
    v_mul_f32 v18, v23, v18
    ds_write_b32 v4, v18 offset:512
    s_cmp_lg_u32 s81, 0
    s_cbranch_scc1 L_ncs6
    s_waitcnt vmcnt(6)
    v_perm_b32 v36, v146, v144, s83
    v_perm_b32 v146, v146, v144, s84
    v_perm_b32 v37, v147, v145, s83
    v_perm_b32 v147, v147, v145, s84
    v_perm_b32 v38, v150, v148, s83
    v_perm_b32 v150, v150, v148, s84
    v_perm_b32 v39, v151, v149, s83
    v_perm_b32 v151, v151, v149, s84
    v_perm_b32 v40, v154, v152, s83
    v_perm_b32 v154, v154, v152, s84
    v_perm_b32 v41, v155, v153, s83
    v_perm_b32 v155, v155, v153, s84
    v_mov_b64 v[144:145], v[36:37]
    v_mov_b64 v[148:149], v[38:39]
    v_mov_b64 v[152:153], v[40:41]
    s_nop 1
L_ncs6:
    v_dot2_f32_bf16 v36, v144, v48, 0
    v_dot2_f32_bf16 v37, v146, v49, 0
    v_dot2_f32_bf16 v38, v145, v50, 0
    v_dot2_f32_bf16 v39, v147, v51, 0
    v_dot2_f32_bf16 v40, v148, v52, 0
    v_dot2_f32_bf16 v41, v150, v53, 0
    v_dot2_f32_bf16 v42, v149, v54, 0
    v_dot2_f32_bf16 v43, v151, v55, 0
    v_dot2_f32_bf16 v44, v152, v56, 0
    v_dot2_f32_bf16 v45, v154, v57, 0
    v_dot2_f32_bf16 v46, v153, v58, 0
    v_dot2_f32_bf16 v47, v155, v59, 0
    s_add_u32 s79, s79, 12
    s_cmp_ge_i32 s80, s79
    s_cbranch_scc1 L_kr6g
L_kr6:
    ds_read_b32 v19, v7
    s_sleep 1
    s_waitcnt lgkmcnt(0)
    v_readlane_b32 s80, v19, 5
    s_nop 0
    s_cmp_lt_i32 s80, s79
    s_cbranch_scc1 L_kr6
L_kr6g:
    ds_read_b32 v10, v3 offset:768
    ds_read_b128 v[24:27], v2 offset:24576
    ds_read_b128 v[28:31], v2 offset:24832
    ds_read_b128 v[32:35], v2 offset:25088
    v_add_u32 v6, 1, v6
    ds_write_b32 v5, v6
    s_waitcnt lgkmcnt(3)
    v_and_b32 v12, 0xffff0000, v10
    v_cvt_f32_i32 v24, v24
    v_cvt_f32_i32 v25, v25
    v_cvt_f32_i32 v26, v26
    v_cvt_f32_i32 v27, v27
    v_pk_add_f32 v[24:25], v[24:25], v[12:13] op_sel:[0,0] op_sel_hi:[1,0] neg_lo:[0,1] neg_hi:[0,1]
    v_pk_add_f32 v[26:27], v[26:27], v[12:13] op_sel:[0,0] op_sel_hi:[1,0] neg_lo:[0,1] neg_hi:[0,1]
    v_pk_mul_f32 v[14:15], v[24:25], v[36:37]
    v_pk_fma_f32 v[14:15], v[26:27], v[38:39], v[14:15]
    s_waitcnt lgkmcnt(2)
    v_cvt_f32_i32 v28, v28
    v_cvt_f32_i32 v29, v29
    v_cvt_f32_i32 v30, v30
    v_cvt_f32_i32 v31, v31
    v_pk_add_f32 v[28:29], v[28:29], v[12:13] op_sel:[0,0] op_sel_hi:[1,0] neg_lo:[0,1] neg_hi:[0,1]
    v_pk_add_f32 v[30:31], v[30:31], v[12:13] op_sel:[0,0] op_sel_hi:[1,0] neg_lo:[0,1] neg_hi:[0,1]
    v_pk_fma_f32 v[14:15], v[28:29], v[40:41], v[14:15]
    v_pk_fma_f32 v[14:15], v[30:31], v[42:43], v[14:15]
    s_waitcnt lgkmcnt(1)
    v_cvt_f32_i32 v32, v32
    v_cvt_f32_i32 v33, v33
    v_cvt_f32_i32 v34, v34
    v_cvt_f32_i32 v35, v35
    v_pk_add_f32 v[32:33], v[32:33], v[12:13] op_sel:[0,0] op_sel_hi:[1,0] neg_lo:[0,1] neg_hi:[0,1]
    v_pk_add_f32 v[34:35], v[34:35], v[12:13] op_sel:[0,0] op_sel_hi:[1,0] neg_lo:[0,1] neg_hi:[0,1]
    v_pk_fma_f32 v[14:15], v[32:33], v[44:45], v[14:15]
    v_pk_fma_f32 v[14:15], v[34:35], v[46:47], v[14:15]
    v_add_f32 v14, v14, v15
    s_nop 1
    v_add_f32_dpp v18, v14, v14 row_ror:8 row_mask:0xf bank_mask:0x3
    s_cmp_lg_u32 s81, 0
    s_nop 0
    s_cbranch_scc1 L_ncs7
    s_waitcnt vmcnt(0)
    v_perm_b32 v36, v158, v156, s83
    v_perm_b32 v158, v158, v156, s84
    v_perm_b32 v37, v159, v157, s83
    v_perm_b32 v159, v159, v157, s84
    v_perm_b32 v38, v162, v160, s83
    v_perm_b32 v162, v162, v160, s84
    v_perm_b32 v39, v163, v161, s83
    v_perm_b32 v163, v163, v161, s84
    v_perm_b32 v40, v166, v164, s83
    v_perm_b32 v166, v166, v164, s84
    v_perm_b32 v41, v167, v165, s83
    v_perm_b32 v167, v167, v165, s84
    v_mov_b64 v[156:157], v[36:37]
    v_mov_b64 v[160:161], v[38:39]
    v_mov_b64 v[164:165], v[40:41]
    s_nop 1
L_ncs7:
    v_dot2_f32_bf16 v36, v156, v48, 0
    v_dot2_f32_bf16 v37, v158, v49, 0
    v_dot2_f32_bf16 v38, v157, v50, 0
    v_dot2_f32_bf16 v39, v159, v51, 0
    v_dot2_f32_bf16 v40, v160, v52, 0
    v_dot2_f32_bf16 v41, v162, v53, 0
    v_dot2_f32_bf16 v42, v161, v54, 0
    v_dot2_f32_bf16 v43, v163, v55, 0
    v_dot2_f32_bf16 v44, v164, v56, 0
    v_dot2_f32_bf16 v45, v166, v57, 0
    v_dot2_f32_bf16 v46, v165, v58, 0
    v_dot2_f32_bf16 v47, v167, v59, 0
    s_add_u32 s79, s79, 12
    s_cmp_ge_i32 s80, s79
    s_cbranch_scc1 L_kr7g
L_kr7:
    ds_read_b32 v19, v7
    s_sleep 1
    s_waitcnt lgkmcnt(0)
    v_readlane_b32 s80, v19, 5
    s_nop 0
    s_cmp_lt_i32 s80, s79
    s_cbranch_scc1 L_kr7
L_kr7g:
    ds_read_b32 v11, v3 offset:896
    ds_read_b128 v[24:27], v2 offset:36864
    ds_read_b128 v[28:31], v2 offset:37120
    ds_read_b128 v[32:35], v2 offset:37376
    v_add_u32 v6, 1, v6
    ds_write_b32 v5, v6
    s_waitcnt lgkmcnt(3)
    v_and_b32 v12, 0xffff0000, v11
    v_cvt_f32_i32 v24, v24
    v_cvt_f32_i32 v25, v25
    v_cvt_f32_i32 v26, v26
    v_cvt_f32_i32 v27, v27
    v_pk_add_f32 v[24:25], v[24:25], v[12:13] op_sel:[0,0] op_sel_hi:[1,0] neg_lo:[0,1] neg_hi:[0,1]
    v_pk_add_f32 v[26:27], v[26:27], v[12:13] op_sel:[0,0] op_sel_hi:[1,0] neg_lo:[0,1] neg_hi:[0,1]
    v_pk_mul_f32 v[16:17], v[24:25], v[36:37]
    v_pk_fma_f32 v[16:17], v[26:27], v[38:39], v[16:17]
    s_waitcnt lgkmcnt(2)
    v_cvt_f32_i32 v28, v28
    v_cvt_f32_i32 v29, v29
    v_cvt_f32_i32 v30, v30
    v_cvt_f32_i32 v31, v31
    v_pk_add_f32 v[28:29], v[28:29], v[12:13] op_sel:[0,0] op_sel_hi:[1,0] neg_lo:[0,1] neg_hi:[0,1]
    v_pk_add_f32 v[30:31], v[30:31], v[12:13] op_sel:[0,0] op_sel_hi:[1,0] neg_lo:[0,1] neg_hi:[0,1]
    v_pk_fma_f32 v[16:17], v[28:29], v[40:41], v[16:17]
    v_pk_fma_f32 v[16:17], v[30:31], v[42:43], v[16:17]
    s_waitcnt lgkmcnt(1)
    v_cvt_f32_i32 v32, v32
    v_cvt_f32_i32 v33, v33
    v_cvt_f32_i32 v34, v34
    v_cvt_f32_i32 v35, v35
    v_pk_add_f32 v[32:33], v[32:33], v[12:13] op_sel:[0,0] op_sel_hi:[1,0] neg_lo:[0,1] neg_hi:[0,1]
    v_pk_add_f32 v[34:35], v[34:35], v[12:13] op_sel:[0,0] op_sel_hi:[1,0] neg_lo:[0,1] neg_hi:[0,1]
    v_pk_fma_f32 v[16:17], v[32:33], v[44:45], v[16:17]
    v_pk_fma_f32 v[16:17], v[34:35], v[46:47], v[16:17]
    v_add_f32 v16, v16, v17
    v_cndmask_b32 v23, v10, v11, s[86:87]
    v_lshlrev_b32 v23, 16, v23
    v_add_f32_dpp v18, v16, v16 row_ror:8 row_mask:0xf bank_mask:0xc
    v_mul_f32 v23, 0x3dd53b95, v23
    s_nop 0
    v_add_f32_dpp v18, v18, v18 row_half_mirror row_mask:0xf bank_mask:0xf
    s_nop 1
    v_add_f32_dpp v18, v18, v18 quad_perm:[2,3,0,1] row_mask:0xf bank_mask:0xf
    s_nop 1
    v_add_f32_dpp v18, v18, v18 quad_perm:[1,0,3,2] row_mask:0xf bank_mask:0xf
    v_mul_f32 v18, v23, v18
    ds_write_b32 v4, v18 offset:768
    s_mov_b64 exec, 1
    ds_add_u32 v22, v8
    s_mov_b64 exec, -1
    v_add_u32 v3, 1024, v3
    v_add_u32 v4, 1024, v4
    s_add_u32 s81, s81, 1
    s_cmp_lt_u32 s81, 16
    s_cbranch_scc1 L_kph
    v_subrev_u32 v3, 16384, v3
    s_mul_i32 s92, s78, 768
    s_add_u32 s92, s92, 65536
    v_and_b32 v18, 15, v1
    v_lshl_add_u32 v9, v18, 4, s92
    v_lshrrev_b32 v18, 4, v1
    v_lshl_add_u32 v9, v18, 2, v9
    v_mov_b32 v22, 77920
    s_mov_b64 s[20:21], s[74:75]
    s_mov_b32 s22, 1610612736
    s_mov_b32 s23, 0x20000
    s_mov_b64 s[28:29], s[70:71]
    s_mov_b32 s30, 12288
    s_mov_b32 s31, 0x20000
    s_mul_i32 s92, s2, 43691
    s_lshr_b32 s92, s92, 18
    s_mul_i32 s93, s92, 6
    s_sub_u32 s93, s2, s93
    s_lshl2_add_u32 s94, s92, s78
    s_mul_i32 s32, s94, 24576
    s_lshl_b32 s94, s93, 7
    s_add_u32 s32, s32, s94
    s_add_u32 s33, s32, 6144
    s_add_u32 s34, s33, 6144
    s_add_u32 s35, s34, 6144
    s_lshl_b32 s36, s2, 6
    s_lshr_b32 s37, s92, 1
    s_add_u32 s37, s37, 2
    s_min_u32 s37, s37, 16
    v_lshrrev_b32 v19, 3, v1
    v_and_b32 v69, 7, v1
    v_mul_u32_u24 v68, 768, v19
    v_lshl_add_u32 v68, v69, 4, v68
    v_lshlrev_b32 v69, 3, v69
    v_lshl_add_u32 v69, v18, 1, v69
    s_lshl4_add_u32 s92, s78, 78336
    v_lshl_add_u32 v70, v19, 6, s92
    s_lshl_b32 s92, s78, 8
    s_add_u32 s92, s92, 1024
    v_add_u32 v4, s92, v7
    s_mov_b32 s81, 0
    s_nop 0
L_vph:
    v_mov_b64 v[72:73], 0
    v_mov_b64 v[74:75], 0
    v_mov_b64 v[76:77], 0
    v_mov_b64 v[78:79], 0
    v_mov_b64 v[80:81], 0
    v_mov_b64 v[82:83], 0
    s_and_b32 s92, s81, 3
    s_mul_i32 s92, s92, 3072
    v_add_u32 v71, s92, v9
    s_mov_b32 s88, 0
    s_nop 0
L_vw:
    ds_read_b32 v19, v7
    s_waitcnt lgkmcnt(0)
    v_readlane_b32 s92, v19, 15
    v_readlane_b32 s93, v19, 13
    s_add_u32 s92, s92, 4
    s_min_u32 s93, s93, s92
    s_cmp_le_u32 s93, s81
    s_nop 1
    s_cbranch_scc1 L_vw
    s_cmp_lg_u32 s81, 15
    s_cbranch_scc1 L_vit
    v_readlane_b32 s4, v19, 6
    s_cmp_ge_u32 s2, 192
    s_nop 3
    s_cbranch_scc1 L_vit
    s_cmp_eq_u32 s4, 0
    s_cbranch_scc1 L_vw
    ds_read_b128 v[64:67], v70
    s_lshr_b32 s5, s4, 8
    s_lshr_b32 s6, s4, 16
    s_lshr_b32 s7, s4, 24
L_vit:
    s_add_u32 s79, s79, 12
    s_cmp_ge_i32 s80, s79
    s_cbranch_scc1 L_vr0g
L_vr0:
    ds_read_b32 v19, v7
    s_waitcnt lgkmcnt(0)
    v_readlane_b32 s80, v19, 5
    s_nop 0
    s_cmp_lt_i32 s80, s79
    s_cbranch_scc1 L_vr0
L_vr0g:
    ds_read_b32 v10, v3 offset:0
    ds_read_b128 v[24:27], v2 offset:0
    ds_read_b128 v[28:31], v2 offset:256
    ds_read_b128 v[32:35], v2 offset:512
    v_add_u32 v6, 1, v6
    ds_write_b32 v5, v6
    s_waitcnt lgkmcnt(3)
    v_cvt_f32_i32 v24, v24
    v_cvt_f32_i32 v25, v25
    v_cvt_f32_i32 v26, v26
    v_cvt_f32_i32 v27, v27
    v_pk_fma_f32 v[72:73], v[24:25], v[10:11], v[72:73] op_sel:[0,0,0] op_sel_hi:[1,0,1]
    v_pk_fma_f32 v[74:75], v[26:27], v[10:11], v[74:75] op_sel:[0,0,0] op_sel_hi:[1,0,1]
    s_waitcnt lgkmcnt(2)
    v_cvt_f32_i32 v28, v28
    v_cvt_f32_i32 v29, v29
    v_cvt_f32_i32 v30, v30
    v_cvt_f32_i32 v31, v31
    v_pk_fma_f32 v[76:77], v[28:29], v[10:11], v[76:77] op_sel:[0,0,0] op_sel_hi:[1,0,1]
    v_pk_fma_f32 v[78:79], v[30:31], v[10:11], v[78:79] op_sel:[0,0,0] op_sel_hi:[1,0,1]
    s_waitcnt lgkmcnt(1)
    v_cvt_f32_i32 v32, v32
    v_cvt_f32_i32 v33, v33
    v_cvt_f32_i32 v34, v34
    v_cvt_f32_i32 v35, v35
    v_pk_fma_f32 v[80:81], v[32:33], v[10:11], v[80:81] op_sel:[0,0,0] op_sel_hi:[1,0,1]
    v_pk_fma_f32 v[82:83], v[34:35], v[10:11], v[82:83] op_sel:[0,0,0] op_sel_hi:[1,0,1]
    s_add_u32 s79, s79, 12
    s_cmp_ge_i32 s80, s79
    s_cbranch_scc1 L_vr1g
L_vr1:
    ds_read_b32 v19, v7
    s_waitcnt lgkmcnt(0)
    v_readlane_b32 s80, v19, 5
    s_nop 0
    s_cmp_lt_i32 s80, s79
    s_cbranch_scc1 L_vr1
L_vr1g:
    ds_read_b32 v10, v3 offset:128
    ds_read_b128 v[24:27], v2 offset:12288
    ds_read_b128 v[28:31], v2 offset:12544
    ds_read_b128 v[32:35], v2 offset:12800
    v_add_u32 v6, 1, v6
    ds_write_b32 v5, v6
    s_waitcnt lgkmcnt(3)
    v_cvt_f32_i32 v24, v24
    v_cvt_f32_i32 v25, v25
    v_cvt_f32_i32 v26, v26
    v_cvt_f32_i32 v27, v27
    v_pk_fma_f32 v[72:73], v[24:25], v[10:11], v[72:73] op_sel:[0,0,0] op_sel_hi:[1,0,1]
    v_pk_fma_f32 v[74:75], v[26:27], v[10:11], v[74:75] op_sel:[0,0,0] op_sel_hi:[1,0,1]
    s_waitcnt lgkmcnt(2)
    v_cvt_f32_i32 v28, v28
    v_cvt_f32_i32 v29, v29
    v_cvt_f32_i32 v30, v30
    v_cvt_f32_i32 v31, v31
    v_pk_fma_f32 v[76:77], v[28:29], v[10:11], v[76:77] op_sel:[0,0,0] op_sel_hi:[1,0,1]
    v_pk_fma_f32 v[78:79], v[30:31], v[10:11], v[78:79] op_sel:[0,0,0] op_sel_hi:[1,0,1]
    s_waitcnt lgkmcnt(1)
    v_cvt_f32_i32 v32, v32
    v_cvt_f32_i32 v33, v33
    v_cvt_f32_i32 v34, v34
    v_cvt_f32_i32 v35, v35
    v_pk_fma_f32 v[80:81], v[32:33], v[10:11], v[80:81] op_sel:[0,0,0] op_sel_hi:[1,0,1]
    v_pk_fma_f32 v[82:83], v[34:35], v[10:11], v[82:83] op_sel:[0,0,0] op_sel_hi:[1,0,1]
    s_add_u32 s79, s79, 12
    s_cmp_ge_i32 s80, s79
    s_cbranch_scc1 L_vr2g
L_vr2:
    ds_read_b32 v19, v7
    s_waitcnt lgkmcnt(0)
    v_readlane_b32 s80, v19, 5
    s_nop 0
    s_cmp_lt_i32 s80, s79
    s_cbranch_scc1 L_vr2
L_vr2g:
    ds_read_b32 v10, v3 offset:256
    ds_read_b128 v[24:27], v2 offset:24576
    ds_read_b128 v[28:31], v2 offset:24832
    ds_read_b128 v[32:35], v2 offset:25088
    v_add_u32 v6, 1, v6
    ds_write_b32 v5, v6
    s_waitcnt lgkmcnt(3)
    v_cvt_f32_i32 v24, v24
    v_cvt_f32_i32 v25, v25
    v_cvt_f32_i32 v26, v26
    v_cvt_f32_i32 v27, v27
    v_pk_fma_f32 v[72:73], v[24:25], v[10:11], v[72:73] op_sel:[0,0,0] op_sel_hi:[1,0,1]
    v_pk_fma_f32 v[74:75], v[26:27], v[10:11], v[74:75] op_sel:[0,0,0] op_sel_hi:[1,0,1]
    s_waitcnt lgkmcnt(2)
    v_cvt_f32_i32 v28, v28
    v_cvt_f32_i32 v29, v29
    v_cvt_f32_i32 v30, v30
    v_cvt_f32_i32 v31, v31
    v_pk_fma_f32 v[76:77], v[28:29], v[10:11], v[76:77] op_sel:[0,0,0] op_sel_hi:[1,0,1]
    v_pk_fma_f32 v[78:79], v[30:31], v[10:11], v[78:79] op_sel:[0,0,0] op_sel_hi:[1,0,1]
    s_waitcnt lgkmcnt(1)
    v_cvt_f32_i32 v32, v32
    v_cvt_f32_i32 v33, v33
    v_cvt_f32_i32 v34, v34
    v_cvt_f32_i32 v35, v35
    v_pk_fma_f32 v[80:81], v[32:33], v[10:11], v[80:81] op_sel:[0,0,0] op_sel_hi:[1,0,1]
    v_pk_fma_f32 v[82:83], v[34:35], v[10:11], v[82:83] op_sel:[0,0,0] op_sel_hi:[1,0,1]
    s_add_u32 s79, s79, 12
    s_cmp_ge_i32 s80, s79
    s_cbranch_scc1 L_vr3g
L_vr3:
    ds_read_b32 v19, v7
    s_waitcnt lgkmcnt(0)
    v_readlane_b32 s80, v19, 5
    s_nop 0
    s_cmp_lt_i32 s80, s79
    s_cbranch_scc1 L_vr3
L_vr3g:
    ds_read_b32 v10, v3 offset:384
    ds_read_b128 v[24:27], v2 offset:36864
    ds_read_b128 v[28:31], v2 offset:37120
    ds_read_b128 v[32:35], v2 offset:37376
    v_add_u32 v6, 1, v6
    ds_write_b32 v5, v6
    v_add_u32 v3, 512, v3
    s_add_u32 s88, s88, 1
    s_cmp_lt_u32 s88, 2
    s_waitcnt lgkmcnt(3)
    v_cvt_f32_i32 v24, v24
    v_cvt_f32_i32 v25, v25
    v_cvt_f32_i32 v26, v26
    v_cvt_f32_i32 v27, v27
    v_pk_fma_f32 v[72:73], v[24:25], v[10:11], v[72:73] op_sel:[0,0,0] op_sel_hi:[1,0,1]
    v_pk_fma_f32 v[74:75], v[26:27], v[10:11], v[74:75] op_sel:[0,0,0] op_sel_hi:[1,0,1]
    s_waitcnt lgkmcnt(2)
    v_cvt_f32_i32 v28, v28
    v_cvt_f32_i32 v29, v29
    v_cvt_f32_i32 v30, v30
    v_cvt_f32_i32 v31, v31
    v_pk_fma_f32 v[76:77], v[28:29], v[10:11], v[76:77] op_sel:[0,0,0] op_sel_hi:[1,0,1]
    v_pk_fma_f32 v[78:79], v[30:31], v[10:11], v[78:79] op_sel:[0,0,0] op_sel_hi:[1,0,1]
    s_waitcnt lgkmcnt(1)
    v_cvt_f32_i32 v32, v32
    v_cvt_f32_i32 v33, v33
    v_cvt_f32_i32 v34, v34
    v_cvt_f32_i32 v35, v35
    v_pk_fma_f32 v[80:81], v[32:33], v[10:11], v[80:81] op_sel:[0,0,0] op_sel_hi:[1,0,1]
    v_pk_fma_f32 v[82:83], v[34:35], v[10:11], v[82:83] op_sel:[0,0,0] op_sel_hi:[1,0,1]
    s_cbranch_scc1 L_vit
    v_permlane32_swap_b32 v72, v74
    v_permlane32_swap_b32 v73, v75
    v_permlane32_swap_b32 v76, v78
    v_permlane32_swap_b32 v77, v79
    v_permlane32_swap_b32 v80, v82
    v_permlane32_swap_b32 v81, v83
    v_pk_add_f32 v[72:73], v[72:73], v[74:75]
    v_pk_add_f32 v[76:77], v[76:77], v[78:79]
    v_pk_add_f32 v[80:81], v[80:81], v[82:83]
    v_permlane16_swap_b32 v72, v73
    v_permlane16_swap_b32 v76, v77
    v_permlane16_swap_b32 v80, v81
    v_add_f32 v36, v72, v73
    v_add_f32 v37, v76, v77
    v_add_f32 v38, v80, v81
    ds_write2st64_b32 v71, v36, v37 offset0:0 offset1:1
    ds_write_b32 v71, v38 offset:512
    s_mov_b64 exec, 1
    ds_add_u32 v22, v8
    s_mov_b64 exec, -1
    v_add_u32 v22, 4, v22
    s_add_u32 s81, s81, 1
    s_cmp_lt_u32 s81, 16
    s_cbranch_scc1 L_vph
    s_cmp_ge_u32 s2, 192
    s_cbranch_scc1 L_cend
L_gw:
    ds_read_b32 v19, v7
    s_waitcnt lgkmcnt(0)
    v_readlane_b32 s92, v19, 8
    s_nop 0
    s_cmp_lt_u32 s92, s37
    s_nop 2
    s_cbranch_scc1 L_gw
L_try:
    buffer_load_dwordx4 v[48:51], v68, s[20:23], s32 offen sc0 sc1
    buffer_load_dwordx4 v[52:55], v68, s[20:23], s33 offen sc0 sc1
    buffer_load_dwordx4 v[56:59], v68, s[20:23], s34 offen sc0 sc1
    buffer_load_dwordx4 v[60:63], v68, s[20:23], s35 offen sc0 sc1
    s_waitcnt vmcnt(3)
    v_xor_b32 v23, s4, v48
    v_bitop3_b32 v23, v23, v49, s5 bitop3:0xf6
    v_pk_mul_f32 v[14:15], v[48:49], v[64:65] op_sel:[0,0] op_sel_hi:[1,0]
    v_bitop3_b32 v23, v23, v50, s6 bitop3:0xf6
    v_bitop3_b32 v23, v23, v51, s7 bitop3:0xf6
    v_pk_mul_f32 v[16:17], v[50:51], v[64:65] op_sel:[0,0] op_sel_hi:[1,0]
    s_waitcnt vmcnt(2)
    v_bitop3_b32 v23, v23, v52, s4 bitop3:0xf6
    v_bitop3_b32 v23, v23, v53, s5 bitop3:0xf6
    v_pk_fma_f32 v[14:15], v[52:53], v[64:65], v[14:15] op_sel:[0,1,0] op_sel_hi:[1,1,1]
    v_bitop3_b32 v23, v23, v54, s6 bitop3:0xf6
    v_bitop3_b32 v23, v23, v55, s7 bitop3:0xf6
    v_pk_fma_f32 v[16:17], v[54:55], v[64:65], v[16:17] op_sel:[0,1,0] op_sel_hi:[1,1,1]
    s_waitcnt vmcnt(1)
    v_bitop3_b32 v23, v23, v56, s4 bitop3:0xf6
    v_bitop3_b32 v23, v23, v57, s5 bitop3:0xf6
    v_pk_fma_f32 v[14:15], v[56:57], v[66:67], v[14:15] op_sel:[0,0,0] op_sel_hi:[1,0,1]
    v_bitop3_b32 v23, v23, v58, s6 bitop3:0xf6
    v_bitop3_b32 v23, v23, v59, s7 bitop3:0xf6
    v_pk_fma_f32 v[16:17], v[58:59], v[66:67], v[16:17] op_sel:[0,0,0] op_sel_hi:[1,0,1]
    s_waitcnt vmcnt(0)
    v_bitop3_b32 v23, v23, v60, s4 bitop3:0xf6
    v_bitop3_b32 v23, v23, v61, s5 bitop3:0xf6
    v_pk_fma_f32 v[14:15], v[60:61], v[66:67], v[14:15] op_sel:[0,1,0] op_sel_hi:[1,1,1]
    v_bitop3_b32 v23, v23, v62, s6 bitop3:0xf6
    v_bitop3_b32 v23, v23, v63, s7 bitop3:0xf6
    v_pk_fma_f32 v[16:17], v[62:63], v[66:67], v[16:17] op_sel:[0,1,0] op_sel_hi:[1,1,1]
    v_and_b32 v23, 0xff, v23
    v_cmp_ne_u32 vcc, 0, v23
    s_nop 4
    s_cbranch_vccz L_cok
    s_mov_b64 exec, vcc
    s_sleep 1
    s_add_u32 s88, s88, 1
    s_cmp_lt_u32 s88, 400000
    s_cbranch_scc1 L_try
L_cok:
    s_mov_b64 exec, -1
    v_permlane32_swap_b32 v14, v16
    v_permlane32_swap_b32 v15, v17
    v_pk_add_f32 v[14:15], v[14:15], v[16:17]
    s_nop 1
    v_permlane16_swap_b32 v14, v15
    v_add_f32 v14, v14, v15
    ds_write_b32 v4, v14
    s_mov_b64 exec, 1
    ds_add_rtn_u32 v18, v7, v8 offset:28
    s_mov_b64 exec, -1
    ds_read2st64_b32 v[14:15], v7 offset0:4 offset1:5
    ds_read2st64_b32 v[16:17], v7 offset0:6 offset1:7
    s_waitcnt lgkmcnt(0)
    v_readfirstlane_b32 s92, v18
    v_pk_add_f32 v[14:15], v[14:15], v[16:17]
    v_add_f32 v14, v14, v15
    s_cmp_lg_u32 s92, 3
    s_nop 1
    s_cbranch_scc1 L_cend
    v_add_f32_dpp v14, v14, v14 row_ror:8 row_mask:0xf bank_mask:0xf
    s_mov_b32 exec_lo, 0x00ff00ff
    s_mov_b32 exec_hi, 0x00ff00ff
    v_cvt_pk_bf16_f32 v14, v14, v14
    buffer_store_short v14, v69, s[28:31], s36 offen
    s_nop 0
L_cend:
    s_waitcnt lgkmcnt(0)
    s_endpgm
L_helper:
    s_memrealtime s[96:97]
    v_bfe_u32 v22, v1, 2, 3
    v_lshl_add_u32 v22, v22, 11, s77
    v_and_b32 v22, 16383, v22
    v_lshrrev_b32 v19, 5, v1
    v_lshl_add_u32 v22, v19, 15, v22
    v_and_b32 v19, 3, v1
    v_lshlrev_b32 v19, 3, v19
    v_lshl_add_u32 v22, v22, 1, v19
    s_lshl_b32 s89, s3, 15
    v_lshlrev_b32 v2, 4, v1
    s_mov_b32 s6, 1048576
    s_mov_b32 s7, 0x20000
    s_mov_b32 s10, 1048576
    s_mov_b32 s11, 0x20000
    s_mov_b32 s14, 1048576
    s_mov_b32 s15, 0x20000
    s_mov_b32 s18, 1048576
    s_mov_b32 s19, 0x20000
    s_waitcnt lgkmcnt(0)
    s_mov_b64 s[4:5], s[52:53]
    s_mov_b64 s[8:9], s[54:55]
    s_mov_b64 s[12:13], s[58:59]
    s_mov_b64 s[16:17], s[60:61]
    buffer_load_dwordx2 v[72:73], v22, s[4:7], s89 offen
    buffer_load_dwordx2 v[74:75], v22, s[8:11], s89 offen
    buffer_load_dwordx2 v[76:77], v22, s[12:15], s89 offen
    buffer_load_dwordx2 v[78:79], v22, s[16:19], s89 offen
    s_add_u32 s89, s89, 131072
    s_barrier
    v_lshrrev_b32 v18, 1, v1
    v_lshlrev_b32 v18, 10, v18
    v_and_b32 v19, 1, v1
    v_lshl_add_u32 v18, v19, 6, v18
    s_lshr_b32 s92, s2, 3
    s_lshl_b32 s92, s92, 15
    s_and_b32 s93, s2, 7
    s_lshl_b32 s93, s93, 7
    s_add_u32 s92, s92, s93
    buffer_load_dword v6, v18, s[4:7], s92 offen
    buffer_load_dword v6, v18, s[8:11], s92 offen
    buffer_load_dword v6, v18, s[12:15], s92 offen
    buffer_load_dword v6, v18, s[16:19], s92 offen
    s_mov_b64 s[20:21], s[74:75]
    s_mov_b32 s22, 1610612736
    s_mov_b32 s23, 0x20000
    s_mov_b64 s[24:25], s[72:73]
    s_mov_b32 s26, 256
    s_mov_b32 s27, 0x20000
    s_mov_b64 s[32:33], s[48:49]
    s_mov_b32 s34, 12288
    s_mov_b32 s35, 0x20000
    s_mov_b64 s[36:37], s[62:63]
    s_mov_b32 s38, 384
    s_mov_b32 s39, 0x20000
    s_mov_b64 s[40:41], s[64:65]
    s_mov_b32 s42, 384
    s_mov_b32 s43, 0x20000
    v_lshlrev_b32 v44, 3, v1
    v_cmp_gt_u32 vcc, 24, v1
    v_mov_b32 v23, 0xffffff40
    v_mov_b32 v18, 192
    v_cndmask_b32 v23, v23, v18, vcc
    v_add_u32 v45, v44, v23
    v_mov_b32 v18, 0x80008000
    v_cndmask_b32 v46, 0, v18, vcc
    s_mov_b32 s78, s96
    s_mov_b32 s94, 0x05040100
    s_mov_b32 s95, 0x07060302
    v_lshlrev_b32 v9, 1, v2
    v_add_u32 v9, 49152, v9
    v_mov_b32 v3, 77824
    v_mov_b32 v4, 0
    v_mov_b32 v5, 0xff
    s_waitcnt vmcnt(4)
    v_perm_b32 v48, v74, v72, s94
    v_perm_b32 v49, v78, v76, s94
    v_perm_b32 v50, v74, v72, s95
    v_perm_b32 v51, v78, v76, s95
    v_perm_b32 v52, v75, v73, s94
    v_perm_b32 v53, v79, v77, s94
    v_perm_b32 v54, v75, v73, s95
    v_perm_b32 v55, v79, v77, s95
    v_mov_b32 v19, 1
    ds_write_b128 v9, v[48:51] offset:0
    ds_write_b128 v9, v[52:55] offset:16
    ds_write_b32 v3, v19 offset:48
    s_waitcnt lgkmcnt(3)
    s_mov_b32 s48, 0
    s_cmp_lg_u32 s2, 0
    s_cbranch_scc1 L_ne0
    s_mul_i32 s49, s78, 0x9e3779b1
    s_lshr_b32 s93, s49, 15
    s_xor_b32 s49, s49, s93
    s_mul_i32 s49, s49, 0x85ebca6b
    s_lshr_b32 s93, s49, 13
    s_xor_b32 s49, s49, s93
    s_max_u32 s49, s49, 1
    v_mov_b32 v14, s49
    v_mov_b32 v15, 0
    s_mov_b64 exec, 1
    buffer_atomic_cmpswap v[14:15], v4, s[24:27], 0 offen sc0 sc1
    s_waitcnt vmcnt(0)
    v_readfirstlane_b32 s48, v14
    s_mov_b64 exec, -1
    s_cmp_eq_u32 s48, 0
    s_cselect_b32 s48, s49, s48
    s_nop 1
L_ne0:
L_sw:
    s_sleep 4
    ds_read_b32 v19, v7
    s_waitcnt lgkmcnt(0)
    v_readlane_b32 s92, v19, 5
    s_nop 0
    s_cmp_lt_i32 s92, 132
    s_nop 2
    s_cbranch_scc1 L_sw
    buffer_load_dwordx2 v[40:41], v44, s[36:39], 0 offen
    buffer_load_dwordx2 v[42:43], v44, s[40:43], 0 offen
    s_mul_i32 s92, s3, 384
    s_add_u32 s92, s92, 6144
    buffer_load_dwordx2 v[136:137], v44, s[32:35], s92 offen
    buffer_load_dwordx2 v[138:139], v45, s[32:35], s92 offen
    buffer_load_dwordx2 v[140:141], v44, s[32:35], s92 offen offset:768
    buffer_load_dwordx2 v[142:143], v45, s[32:35], s92 offen offset:768
    s_add_u32 s92, s92, 1536
    buffer_load_dwordx2 v[144:145], v44, s[32:35], s92 offen
    buffer_load_dwordx2 v[146:147], v45, s[32:35], s92 offen
    buffer_load_dwordx2 v[148:149], v44, s[32:35], s92 offen offset:768
    buffer_load_dwordx2 v[150:151], v45, s[32:35], s92 offen offset:768
    s_add_u32 s92, s92, 1536
    buffer_load_dwordx2 v[152:153], v44, s[32:35], s92 offen
    buffer_load_dwordx2 v[154:155], v45, s[32:35], s92 offen
    buffer_load_dwordx2 v[156:157], v44, s[32:35], s92 offen offset:768
    buffer_load_dwordx2 v[158:159], v45, s[32:35], s92 offen offset:768
    s_add_u32 s92, s92, 1536
    buffer_load_dwordx2 v[160:161], v44, s[32:35], s92 offen
    buffer_load_dwordx2 v[162:163], v45, s[32:35], s92 offen
    buffer_load_dwordx2 v[164:165], v44, s[32:35], s92 offen offset:768
    buffer_load_dwordx2 v[166:167], v45, s[32:35], s92 offen offset:768
    buffer_load_dwordx2 v[80:81], v22, s[4:7], s89 offen
    buffer_load_dwordx2 v[82:83], v22, s[8:11], s89 offen
    buffer_load_dwordx2 v[84:85], v22, s[12:15], s89 offen
    buffer_load_dwordx2 v[86:87], v22, s[16:19], s89 offen
    s_add_u32 s89, s89, 131072
    s_waitcnt vmcnt(0)
    buffer_load_dwordx2 v[88:89], v22, s[4:7], s89 offen
    buffer_load_dwordx2 v[90:91], v22, s[8:11], s89 offen
    buffer_load_dwordx2 v[92:93], v22, s[12:15], s89 offen
    buffer_load_dwordx2 v[94:95], v22, s[16:19], s89 offen
    s_add_u32 s89, s89, 131072
    v_perm_b32 v56, v82, v80, s94
    v_perm_b32 v57, v86, v84, s94
    v_perm_b32 v58, v82, v80, s95
    v_perm_b32 v59, v86, v84, s95
    v_perm_b32 v60, v83, v81, s94
    v_perm_b32 v61, v87, v85, s94
    v_perm_b32 v62, v83, v81, s95
    v_perm_b32 v63, v87, v85, s95
    v_mov_b32 v19, 2
    ds_write_b128 v9, v[56:59] offset:2048
    ds_write_b128 v9, v[60:63] offset:2064
    ds_write_b32 v3, v19 offset:48
    s_waitcnt lgkmcnt(3)
    s_waitcnt vmcnt(0)
    buffer_load_dwordx2 v[96:97], v22, s[4:7], s89 offen
    buffer_load_dwordx2 v[98:99], v22, s[8:11], s89 offen
    buffer_load_dwordx2 v[100:101], v22, s[12:15], s89 offen
    buffer_load_dwordx2 v[102:103], v22, s[16:19], s89 offen
    s_add_u32 s89, s89, 131072
    v_perm_b32 v48, v90, v88, s94
    v_perm_b32 v49, v94, v92, s94
    v_perm_b32 v50, v90, v88, s95
    v_perm_b32 v51, v94, v92, s95
    v_perm_b32 v52, v91, v89, s94
    v_perm_b32 v53, v95, v93, s94
    v_perm_b32 v54, v91, v89, s95
    v_perm_b32 v55, v95, v93, s95
    v_mov_b32 v19, 3
    ds_write_b128 v9, v[48:51] offset:4096
    ds_write_b128 v9, v[52:55] offset:4112
    ds_write_b32 v3, v19 offset:48
    s_waitcnt lgkmcnt(3)
    s_waitcnt vmcnt(0)
    buffer_load_dwordx2 v[104:105], v22, s[4:7], s89 offen
    buffer_load_dwordx2 v[106:107], v22, s[8:11], s89 offen
    buffer_load_dwordx2 v[108:109], v22, s[12:15], s89 offen
    buffer_load_dwordx2 v[110:111], v22, s[16:19], s89 offen
    s_add_u32 s89, s89, 131072
    v_perm_b32 v56, v98, v96, s94
    v_perm_b32 v57, v102, v100, s94
    v_perm_b32 v58, v98, v96, s95
    v_perm_b32 v59, v102, v100, s95
    v_perm_b32 v60, v99, v97, s94
    v_perm_b32 v61, v103, v101, s94
    v_perm_b32 v62, v99, v97, s95
    v_perm_b32 v63, v103, v101, s95
    v_mov_b32 v19, 4
    ds_write_b128 v9, v[56:59] offset:6144
    ds_write_b128 v9, v[60:63] offset:6160
    ds_write_b32 v3, v19 offset:48
    s_waitcnt lgkmcnt(3)
    s_waitcnt vmcnt(0)
    buffer_load_dwordx2 v[112:113], v22, s[4:7], s89 offen
    buffer_load_dwordx2 v[114:115], v22, s[8:11], s89 offen
    buffer_load_dwordx2 v[116:117], v22, s[12:15], s89 offen
    buffer_load_dwordx2 v[118:119], v22, s[16:19], s89 offen
    s_add_u32 s89, s89, 131072
    v_perm_b32 v48, v106, v104, s94
    v_perm_b32 v49, v110, v108, s94
    v_perm_b32 v50, v106, v104, s95
    v_perm_b32 v51, v110, v108, s95
    v_perm_b32 v52, v107, v105, s94
    v_perm_b32 v53, v111, v109, s94
    v_perm_b32 v54, v107, v105, s95
    v_perm_b32 v55, v111, v109, s95
    v_mov_b32 v19, 5
    ds_write_b128 v9, v[48:51] offset:8192
    ds_write_b128 v9, v[52:55] offset:8208
    ds_write_b32 v3, v19 offset:48
    s_waitcnt lgkmcnt(3)
    s_waitcnt vmcnt(0)
    buffer_load_dwordx2 v[120:121], v22, s[4:7], s89 offen
    buffer_load_dwordx2 v[122:123], v22, s[8:11], s89 offen
    buffer_load_dwordx2 v[124:125], v22, s[12:15], s89 offen
    buffer_load_dwordx2 v[126:127], v22, s[16:19], s89 offen
    s_add_u32 s89, s89, 131072
    v_perm_b32 v56, v114, v112, s94
    v_perm_b32 v57, v118, v116, s94
    v_perm_b32 v58, v114, v112, s95
    v_perm_b32 v59, v118, v116, s95
    v_perm_b32 v60, v115, v113, s94
    v_perm_b32 v61, v119, v117, s94
    v_perm_b32 v62, v115, v113, s95
    v_perm_b32 v63, v119, v117, s95
    v_mov_b32 v19, 6
    ds_write_b128 v9, v[56:59] offset:10240
    ds_write_b128 v9, v[60:63] offset:10256
    ds_write_b32 v3, v19 offset:48
    s_waitcnt lgkmcnt(3)
    s_waitcnt vmcnt(0)
    buffer_load_dwordx2 v[128:129], v22, s[4:7], s89 offen
    buffer_load_dwordx2 v[130:131], v22, s[8:11], s89 offen
    buffer_load_dwordx2 v[132:133], v22, s[12:15], s89 offen
    buffer_load_dwordx2 v[134:135], v22, s[16:19], s89 offen
    s_add_u32 s89, s89, 131072
    v_perm_b32 v48, v122, v120, s94
    v_perm_b32 v49, v126, v124, s94
    v_perm_b32 v50, v122, v120, s95
    v_perm_b32 v51, v126, v124, s95
    v_perm_b32 v52, v123, v121, s94
    v_perm_b32 v53, v127, v125, s94
    v_perm_b32 v54, v123, v121, s95
    v_perm_b32 v55, v127, v125, s95
    v_mov_b32 v19, 7
    ds_write_b128 v9, v[48:51] offset:12288
    ds_write_b128 v9, v[52:55] offset:12304
    ds_write_b32 v3, v19 offset:48
    s_waitcnt lgkmcnt(3)
    s_waitcnt vmcnt(0)
    v_perm_b32 v56, v130, v128, s94
    v_perm_b32 v57, v134, v132, s94
    v_perm_b32 v58, v130, v128, s95
    v_perm_b32 v59, v134, v132, s95
    v_perm_b32 v60, v131, v129, s94
    v_perm_b32 v61, v135, v133, s94
    v_perm_b32 v62, v131, v129, s95
    v_perm_b32 v63, v135, v133, s95
    v_mov_b32 v19, 8
    ds_write_b128 v9, v[56:59] offset:14336
    ds_write_b128 v9, v[60:63] offset:14352
    ds_write_b32 v3, v19 offset:48
    s_waitcnt lgkmcnt(3)
    s_getpc_b64 s[92:93]
L_pc:
    s_sub_u32 s92, s92, L_pc-standalone__kv_cache_quant_pre_rope_vs_post_rope__decode_kernel
    s_subb_u32 s93, s93, 0
    s_lshr_b32 s94, s2, 3
    v_lshl_add_u32 v19, v1, 5, s94
    v_lshlrev_b32 v19, 7, v19
    v_min_u32 v19, L_end-standalone__kv_cache_quant_pre_rope_vs_post_rope__decode_kernel, v19
    s_mov_b64 exec, 63
    global_load_dword v6, v19, s[92:93]
    s_mov_b64 exec, -1
    v_lshlrev_b32 v18, 1, v44
    v_lshlrev_b32 v19, 1, v45
    v_add_u32 v18, 71680, v18
    v_add_u32 v19, 71680, v19
    v_mov_b32 v23, 78000
    s_mov_b32 s89, 0
    s_waitcnt lgkmcnt(0)
    v_xor_b32 v42, v42, v46
    v_xor_b32 v43, v43, v46
    v_lshlrev_b32 v48, 16, v40
    v_and_b32 v49, 0xffff0000, v40
    v_lshlrev_b32 v50, 16, v41
    v_and_b32 v51, 0xffff0000, v41
    v_lshlrev_b32 v52, 16, v42
    v_and_b32 v53, 0xffff0000, v42
    v_lshlrev_b32 v54, 16, v43
    v_and_b32 v55, 0xffff0000, v43
    v_and_b32 v46, 0x80000000, v46
    s_nop 1
L_hq:
    v_mov_b64 v[24:25], v[136:137]
    v_mov_b64 v[26:27], v[138:139]
    v_mov_b64 v[28:29], v[140:141]
    v_mov_b64 v[30:31], v[142:143]
    v_mov_b64 v[136:137], v[144:145]
    v_mov_b64 v[138:139], v[146:147]
    v_mov_b64 v[140:141], v[148:149]
    v_mov_b64 v[142:143], v[150:151]
    v_mov_b64 v[144:145], v[152:153]
    v_mov_b64 v[146:147], v[154:155]
    v_mov_b64 v[148:149], v[156:157]
    v_mov_b64 v[150:151], v[158:159]
    v_mov_b64 v[152:153], v[160:161]
    v_mov_b64 v[154:155], v[162:163]
    v_mov_b64 v[156:157], v[164:165]
    v_mov_b64 v[158:159], v[166:167]
    s_mov_b32 exec_hi, 0xffff
    v_lshlrev_b32 v56, 16, v24
    v_and_b32 v57, 0xffff0000, v24
    v_lshlrev_b32 v58, 16, v25
    v_and_b32 v59, 0xffff0000, v25
    v_lshlrev_b32 v60, 16, v26
    v_and_b32 v61, 0xffff0000, v26
    v_lshlrev_b32 v62, 16, v27
    v_and_b32 v63, 0xffff0000, v27
    v_pk_mul_f32 v[56:57], v[56:57], v[48:49]
    v_pk_mul_f32 v[60:61], v[60:61], v[52:53]
    v_pk_mul_f32 v[58:59], v[58:59], v[50:51]
    v_pk_mul_f32 v[62:63], v[62:63], v[54:55]
    v_cvt_pk_bf16_f32 v56, v56, v60
    v_cvt_pk_bf16_f32 v57, v57, v61
    v_cvt_pk_bf16_f32 v58, v58, v62
    v_cvt_pk_bf16_f32 v59, v59, v63
    v_and_b32 v60, 0xffff0000, v56
    v_lshlrev_b32 v56, 16, v56
    v_and_b32 v61, 0xffff0000, v57
    v_lshlrev_b32 v57, 16, v57
    v_and_b32 v62, 0xffff0000, v58
    v_lshlrev_b32 v58, 16, v58
    v_and_b32 v63, 0xffff0000, v59
    v_lshlrev_b32 v59, 16, v59
    v_pk_add_f32 v[56:57], v[56:57], v[60:61]
    v_pk_add_f32 v[58:59], v[58:59], v[62:63]
    v_cvt_pk_bf16_f32 v64, v56, v56
    v_cvt_pk_bf16_f32 v65, v57, v57
    v_cvt_pk_bf16_f32 v66, v58, v58
    v_cvt_pk_bf16_f32 v67, v59, v59
    v_xor_b32 v64, v64, v46
    v_xor_b32 v65, v65, v46
    v_xor_b32 v66, v66, v46
    v_xor_b32 v67, v67, v46
    ds_write_b16 v18, v64 offset:0
    ds_write_b16_d16_hi v19, v64 offset:2
    ds_write_b16 v18, v65 offset:4
    ds_write_b16_d16_hi v19, v65 offset:6
    ds_write_b16 v18, v66 offset:8
    ds_write_b16_d16_hi v19, v66 offset:10
    ds_write_b16 v18, v67 offset:12
    ds_write_b16_d16_hi v19, v67 offset:14
    v_lshlrev_b32 v56, 16, v28
    v_and_b32 v57, 0xffff0000, v28
    v_lshlrev_b32 v58, 16, v29
    v_and_b32 v59, 0xffff0000, v29
    v_lshlrev_b32 v60, 16, v30
    v_and_b32 v61, 0xffff0000, v30
    v_lshlrev_b32 v62, 16, v31
    v_and_b32 v63, 0xffff0000, v31
    v_pk_mul_f32 v[56:57], v[56:57], v[48:49]
    v_pk_mul_f32 v[60:61], v[60:61], v[52:53]
    v_pk_mul_f32 v[58:59], v[58:59], v[50:51]
    v_pk_mul_f32 v[62:63], v[62:63], v[54:55]
    v_cvt_pk_bf16_f32 v56, v56, v60
    v_cvt_pk_bf16_f32 v57, v57, v61
    v_cvt_pk_bf16_f32 v58, v58, v62
    v_cvt_pk_bf16_f32 v59, v59, v63
    v_and_b32 v60, 0xffff0000, v56
    v_lshlrev_b32 v56, 16, v56
    v_and_b32 v61, 0xffff0000, v57
    v_lshlrev_b32 v57, 16, v57
    v_and_b32 v62, 0xffff0000, v58
    v_lshlrev_b32 v58, 16, v58
    v_and_b32 v63, 0xffff0000, v59
    v_lshlrev_b32 v59, 16, v59
    v_pk_add_f32 v[56:57], v[56:57], v[60:61]
    v_pk_add_f32 v[58:59], v[58:59], v[62:63]
    v_cvt_pk_bf16_f32 v68, v56, v56
    v_cvt_pk_bf16_f32 v69, v57, v57
    v_cvt_pk_bf16_f32 v70, v58, v58
    v_cvt_pk_bf16_f32 v71, v59, v59
    v_xor_b32 v68, v68, v46
    v_xor_b32 v69, v69, v46
    v_xor_b32 v70, v70, v46
    v_xor_b32 v71, v71, v46
    ds_write_b16 v18, v68 offset:768
    ds_write_b16_d16_hi v19, v68 offset:770
    ds_write_b16 v18, v69 offset:772
    ds_write_b16_d16_hi v19, v69 offset:774
    ds_write_b16 v18, v70 offset:776
    ds_write_b16_d16_hi v19, v70 offset:778
    ds_write_b16 v18, v71 offset:780
    ds_write_b16_d16_hi v19, v71 offset:782
    s_mov_b32 exec_hi, -1
    ds_write_b32 v23, v5
    s_add_u32 s89, s89, 1
    v_add_u32 v18, 1536, v18
    v_add_u32 v19, 1536, v19
    v_add_u32 v23, 4, v23
    s_cmp_lt_u32 s89, 4
    s_waitcnt lgkmcnt(0)
    s_cbranch_scc1 L_hq
    s_cmp_lg_u32 s48, 0
    s_cbranch_scc1 L_epd
L_epw:
    s_sleep 4
    ds_read_b32 v19, v7
    s_waitcnt lgkmcnt(0)
    v_readlane_b32 s89, v19, 5
    s_nop 0
    s_cmp_lt_i32 s89, 72
    s_nop 2
    s_cbranch_scc1 L_epw
    s_buffer_load_dword s48, s[24:27], 0
    s_waitcnt lgkmcnt(0)
    s_cmp_lg_u32 s48, 0
    s_cbranch_scc1 L_epd
    s_mul_i32 s49, s78, 0x9e3779b1
    s_lshr_b32 s93, s49, 15
    s_xor_b32 s49, s49, s93
    s_mul_i32 s49, s49, 0x85ebca6b
    s_lshr_b32 s93, s49, 13
    s_xor_b32 s49, s49, s93
    s_max_u32 s49, s49, 1
    v_mov_b32 v14, s49
    v_mov_b32 v15, 0
    s_mov_b64 exec, 1
    buffer_atomic_cmpswap v[14:15], v4, s[24:27], 0 offen sc0 sc1
    s_waitcnt vmcnt(0)
    v_readfirstlane_b32 s48, v14
    s_mov_b64 exec, -1
    s_cmp_eq_u32 s48, 0
    s_cselect_b32 s48, s49, s48
    s_nop 1
L_epd:
    s_waitcnt vmcnt(0)
    s_lshr_b32 s49, s48, 8
    s_lshr_b32 s50, s48, 16
    s_lshr_b32 s51, s48, 24
    s_mov_b32 s79, 0
    s_mov_b32 s80, 0
    s_mov_b32 s85, 0
    s_mov_b32 s84, 0
    s_mov_b32 s83, 0
    s_mov_b32 s98, 0
    s_mov_b32 s99, 0
    s_mov_b32 s33, 0
    s_movk_i32 s81, 432
    s_mov_b32 s82, 0x7fffffff
    s_mov_b32 s86, 16
    s_lshr_b32 s92, s2, 4
    s_and_b32 s93, s2, 15
    s_cmp_eq_u32 s92, s93
    s_cselect_b32 s38, s92, 255
    s_mul_i32 s87, s38, 4352
    s_add_u32 s87, s87, 33554432
    s_mov_b32 s88, 33554432
    v_lshrrev_b32 v18, 5, v1
    v_lshlrev_b32 v11, 4, v18
    v_add_u32 v11, 78080, v11
    v_add_u32 v10, 65536, v2
    v_mov_b32 v20, 78080
    s_mov_b32 s39, 8
    s_and_b32 s41, s2, 0x70
    s_and_b32 s92, s2, 7
    s_lshl1_add_u32 s41, s92, s41
    s_lshr_b32 s92, s2, 7
    s_add_u32 s41, s41, s92
    s_lshl_b32 s92, s3, 7
    s_add_u32 s41, s41, s92
    s_mul_i32 s34, s2, 43691
    s_lshr_b32 s34, s34, 18
    s_lshr_b32 s40, s2, 3
    s_and_b32 s40, s40, 31
    s_mul_i32 s40, s40, 24
    s_addk_i32 s40, 1728
    s_cmp_lt_u32 s2, 192
    s_cselect_b32 s40, s40, 0x7fffffff
L_hl:
    s_sleep 4
    ds_read_b32 v19, v7
    s_memrealtime s[96:97]
    s_waitcnt lgkmcnt(0)
    v_readlane_b32 s89, v19, 5
    v_readlane_b32 s90, v19, s86
    s_sub_u32 s96, s96, s78
    s_lshl_b32 s96, s96, 8
    s_mul_i32 s92, s80, s89
    s_add_u32 s92, s92, s79
    s_sub_u32 s92, s96, s92
    s_max_i32 s92, s92, s98
    s_min_i32 s92, s92, s99
    s_mul_i32 s92, s92, 250
    s_add_u32 s92, s92, 21495808
    s_ashr_i32 s92, s92, 20
    s_max_i32 s92, s92, 15
    s_min_i32 s92, s92, 26
    v_mov_b32 v18, s92
    ds_write_b32 v3, v18 offset:16
    s_cmp_ge_i32 s89, s82
    s_cbranch_scc1 L_rd
    s_cmp_ge_i32 s89, s81
    s_cbranch_scc1 L_pub
    s_cmp_eq_u32 s90, s39
    s_cbranch_scc1 L_prep
    s_cmp_ge_i32 s89, s40
    s_cbranch_scc1 L_wts
    s_cmp_eq_u32 s86, 14
    s_cbranch_scc0 L_hl
    s_branch L_late
L_pub:
    s_cmp_eq_u32 s80, 0
    s_cselect_b32 s92, 850, s80
    s_sub_u32 s93, s89, s81
    s_mul_i32 s92, s92, s93
    s_sub_u32 s83, s96, s92
    s_add_u32 s82, s81, 72
    s_addk_i32 s81, 96
    s_cmp_ge_u32 s38, 16
    s_cbranch_scc1 L_hl
    s_lshl_b32 s92, s78, 8
    s_add_u32 s92, s92, s83
    v_mov_b32 v14, s92
    v_mov_b32 v15, s48
    s_mov_b64 exec, 1
    buffer_store_dwordx2 v[14:15], v4, s[20:23], s87 offen sc0 sc1
    s_mov_b64 exec, -1
    s_add_u32 s87, s87, 69632
    s_branch L_hl
L_rd:
    s_lshl_b32 s92, s78, 8
    s_add_u32 s92, s92, s83
    s_mov_b32 s93, 0
    s_mov_b32 s94, 0
    s_buffer_load_dwordx2 s[4:5], s[20:23], s88
    s_add_u32 s88, s88, 4352
    s_buffer_load_dwordx2 s[6:7], s[20:23], s88
    s_add_u32 s88, s88, 4352
    s_buffer_load_dwordx2 s[8:9], s[20:23], s88
    s_add_u32 s88, s88, 4352
    s_buffer_load_dwordx2 s[10:11], s[20:23], s88
    s_add_u32 s88, s88, 4352
    s_buffer_load_dwordx2 s[12:13], s[20:23], s88
    s_add_u32 s88, s88, 4352
    s_buffer_load_dwordx2 s[14:15], s[20:23], s88
    s_add_u32 s88, s88, 4352
    s_buffer_load_dwordx2 s[16:17], s[20:23], s88
    s_add_u32 s88, s88, 4352
    s_buffer_load_dwordx2 s[18:19], s[20:23], s88
    s_add_u32 s88, s88, 4352
    s_waitcnt lgkmcnt(0)
    s_sub_u32 s4, s4, s92
    s_cmp_eq_u32 s5, s48
    s_cselect_b32 s4, s4, 0
    s_addc_u32 s93, s93, 0
    s_add_u32 s94, s94, s4
    s_sub_u32 s6, s6, s92
    s_cmp_eq_u32 s7, s48
    s_cselect_b32 s6, s6, 0
    s_addc_u32 s93, s93, 0
    s_add_u32 s94, s94, s6
    s_sub_u32 s8, s8, s92
    s_cmp_eq_u32 s9, s48
    s_cselect_b32 s8, s8, 0
    s_addc_u32 s93, s93, 0
    s_add_u32 s94, s94, s8
    s_sub_u32 s10, s10, s92
    s_cmp_eq_u32 s11, s48
    s_cselect_b32 s10, s10, 0
    s_addc_u32 s93, s93, 0
    s_add_u32 s94, s94, s10
    s_sub_u32 s12, s12, s92
    s_cmp_eq_u32 s13, s48
    s_cselect_b32 s12, s12, 0
    s_addc_u32 s93, s93, 0
    s_add_u32 s94, s94, s12
    s_sub_u32 s14, s14, s92
    s_cmp_eq_u32 s15, s48
    s_cselect_b32 s14, s14, 0
    s_addc_u32 s93, s93, 0
    s_add_u32 s94, s94, s14
    s_sub_u32 s16, s16, s92
    s_cmp_eq_u32 s17, s48
    s_cselect_b32 s16, s16, 0
    s_addc_u32 s93, s93, 0
    s_add_u32 s94, s94, s16
    s_sub_u32 s18, s18, s92
    s_cmp_eq_u32 s19, s48
    s_cselect_b32 s18, s18, 0
    s_addc_u32 s93, s93, 0
    s_add_u32 s94, s94, s18
    s_buffer_load_dwordx2 s[4:5], s[20:23], s88
    s_add_u32 s88, s88, 4352
    s_buffer_load_dwordx2 s[6:7], s[20:23], s88
    s_add_u32 s88, s88, 4352
    s_buffer_load_dwordx2 s[8:9], s[20:23], s88
    s_add_u32 s88, s88, 4352
    s_buffer_load_dwordx2 s[10:11], s[20:23], s88
    s_add_u32 s88, s88, 4352
    s_buffer_load_dwordx2 s[12:13], s[20:23], s88
    s_add_u32 s88, s88, 4352
    s_buffer_load_dwordx2 s[14:15], s[20:23], s88
    s_add_u32 s88, s88, 4352
    s_buffer_load_dwordx2 s[16:17], s[20:23], s88
    s_add_u32 s88, s88, 4352
    s_buffer_load_dwordx2 s[18:19], s[20:23], s88
    s_add_u32 s88, s88, 4352
    s_waitcnt lgkmcnt(0)
    s_sub_u32 s4, s4, s92
    s_cmp_eq_u32 s5, s48
    s_cselect_b32 s4, s4, 0
    s_addc_u32 s93, s93, 0
    s_add_u32 s94, s94, s4
    s_sub_u32 s6, s6, s92
    s_cmp_eq_u32 s7, s48
    s_cselect_b32 s6, s6, 0
    s_addc_u32 s93, s93, 0
    s_add_u32 s94, s94, s6
    s_sub_u32 s8, s8, s92
    s_cmp_eq_u32 s9, s48
    s_cselect_b32 s8, s8, 0
    s_addc_u32 s93, s93, 0
    s_add_u32 s94, s94, s8
    s_sub_u32 s10, s10, s92
    s_cmp_eq_u32 s11, s48
    s_cselect_b32 s10, s10, 0
    s_addc_u32 s93, s93, 0
    s_add_u32 s94, s94, s10
    s_sub_u32 s12, s12, s92
    s_cmp_eq_u32 s13, s48
    s_cselect_b32 s12, s12, 0
    s_addc_u32 s93, s93, 0
    s_add_u32 s94, s94, s12
    s_sub_u32 s14, s14, s92
    s_cmp_eq_u32 s15, s48
    s_cselect_b32 s14, s14, 0
    s_addc_u32 s93, s93, 0
    s_add_u32 s94, s94, s14
    s_sub_u32 s16, s16, s92
    s_cmp_eq_u32 s17, s48
    s_cselect_b32 s16, s16, 0
    s_addc_u32 s93, s93, 0
    s_add_u32 s94, s94, s16
    s_sub_u32 s18, s18, s92
    s_cmp_eq_u32 s19, s48
    s_cselect_b32 s18, s18, 0
    s_addc_u32 s93, s93, 0
    s_add_u32 s94, s94, s18
    v_cvt_f32_u32 v15, s93
    v_cvt_f32_i32 v14, s94
    v_rcp_f32 v15, v15
    s_nop 0
    v_mul_f32 v14, v14, v15
    v_cvt_i32_f32 v14, v14
    s_sub_u32 s94, s82, 72
    s_mov_b32 s82, 0x7fffffff
    v_readfirstlane_b32 s92, v14
    s_mov_b32 s95, s85
    s_min_u32 s85, s93, 1
    s_cmp_eq_u32 s93, 0
    s_nop 1
    s_cbranch_scc1 L_hl
    s_sub_u32 s98, 0, s92
    s_max_i32 s99, s98, 0
    s_min_i32 s98, s98, 0
    s_add_u32 s99, s99, 6400
    s_sub_u32 s98, s98, 6400
    s_min_i32 s99, s99, 1048576
    s_max_i32 s98, s98, -1048576
    s_add_u32 s92, s92, s83
    s_sub_u32 s93, s92, s84
    s_mov_b32 s84, s92
    s_mul_hi_u32 s93, s93, 44739243
    s_cmp_eq_u32 s95, 0
    s_cselect_b32 s80, 850, s93
    s_max_u32 s80, s80, 1
    s_mul_i32 s93, s80, s94
    s_sub_u32 s79, s92, s93
    s_branch L_hl
L_prep:
    s_cmp_ge_u32 s86, 24
    s_cbranch_scc1 L_mrg
    ds_read_b128 v[24:27], v9
    ds_read_b128 v[28:31], v9 offset:16
    s_add_u32 s86, s86, 1
    s_sub_u32 s92, s86, 16
    s_lshl_b32 s92, s92, 1
    v_mov_b32 v23, s92
    s_waitcnt lgkmcnt(0)
    v_max_f32 v40, v24, v26
    v_max3_f32 v40, v40, v28, v30
    v_lshlrev_b32 v32, 16, v25
    v_lshlrev_b32 v33, 16, v27
    v_lshlrev_b32 v34, 16, v29
    v_lshlrev_b32 v35, 16, v31
    v_max_f32_dpp v40, v40, v40 quad_perm:[1,0,3,2] row_mask:0xf bank_mask:0xf
    s_nop 1
    v_max_f32_dpp v40, v40, v40 quad_perm:[2,3,0,1] row_mask:0xf bank_mask:0xf
    s_nop 1
    v_max_f32_dpp v40, v40, v40 row_half_mirror row_mask:0xf bank_mask:0xf
    s_nop 1
    v_max_f32_dpp v40, v40, v40 row_mirror row_mask:0xf bank_mask:0xf
    v_and_b32 v36, 0xffff0000, v25
    v_and_b32 v37, 0xffff0000, v27
    v_and_b32 v38, 0xffff0000, v29
    v_and_b32 v39, 0xffff0000, v31
    v_mov_b32 v6, v40
    s_nop 1
    v_permlane16_swap_b32 v40, v6
    v_max_f32 v40, v40, v6
    v_sub_f32 v24, v24, v40
    v_sub_f32 v26, v26, v40
    v_sub_f32 v28, v28, v40
    v_sub_f32 v30, v30, v40
    v_exp_f32 v24, v24
    v_exp_f32 v26, v26
    v_exp_f32 v28, v28
    v_exp_f32 v30, v30
    v_add_f32 v42, v24, v26
    v_add_f32 v6, v28, v30
    v_add_f32 v42, v42, v6
    v_mul_f32 v24, v24, v32
    v_mul_f32 v26, v26, v33
    v_mul_f32 v28, v28, v34
    v_mul_f32 v30, v30, v35
    ds_write_b128 v9, v[24:27]
    ds_write_b128 v9, v[28:31] offset:16
    v_mul_f32 v41, v24, v36
    v_fmac_f32 v41, v26, v37
    v_fmac_f32 v41, v28, v38
    v_fmac_f32 v41, v30, v39
    v_add_f32_dpp v42, v42, v42 quad_perm:[1,0,3,2] row_mask:0xf bank_mask:0xf
    s_nop 0
    v_add_f32_dpp v41, v41, v41 quad_perm:[1,0,3,2] row_mask:0xf bank_mask:0xf
    v_add_f32_dpp v42, v42, v42 quad_perm:[2,3,0,1] row_mask:0xf bank_mask:0xf
    s_nop 0
    v_add_f32_dpp v41, v41, v41 quad_perm:[2,3,0,1] row_mask:0xf bank_mask:0xf
    v_add_f32_dpp v42, v42, v42 row_half_mirror row_mask:0xf bank_mask:0xf
    s_nop 0
    v_add_f32_dpp v41, v41, v41 row_half_mirror row_mask:0xf bank_mask:0xf
    v_add_f32_dpp v42, v42, v42 row_mirror row_mask:0xf bank_mask:0xf
    s_nop 0
    v_add_f32_dpp v41, v41, v41 row_mirror row_mask:0xf bank_mask:0xf
    v_mov_b32 v6, v42
    s_nop 1
    v_permlane16_swap_b32 v42, v6
    v_add_f32 v42, v42, v6
    v_mov_b32 v6, v41
    s_nop 1
    v_permlane16_swap_b32 v41, v6
    v_add_f32 v41, v41, v6
    v_sub_f32 v41, 0, v41
    v_mov_b32 v43, v41
    ds_write_b128 v11, v[40:43]
    ds_write_b32 v3, v23 offset:52
    v_add_u32 v9, 2048, v9
    v_add_u32 v11, 32, v11
    s_cmp_eq_u32 s86, 24
    s_waitcnt lgkmcnt(0)
    s_cbranch_scc0 L_hl
    v_add_u32 v9, 49152, v2
    s_mov_b32 s39, 4
    v_add_u32 v18, 78080, v2
    s_mov_b64 exec, 0xffff
    ds_read_b128 v[24:27], v18
    s_lshl_b32 s92, s41, 8
    s_add_u32 s92, s92, 8388608
    s_waitcnt lgkmcnt(0)
    v_mov_b32 v25, s48
    v_mov_b32 v27, s48
    buffer_store_dwordx4 v[24:27], v2, s[20:23], s92 offen sc0 sc1
    s_mov_b64 exec, -1
    s_waitcnt vmcnt(0)
    s_branch L_hl
L_wts:
    s_and_b32 s92, s34, 1
    s_lshl_b32 s92, s92, 15
    s_lshr_b32 s93, s34, 1
    s_lshl4_add_u32 s92, s93, s92
    s_add_u32 s92, s92, 8388608
    s_add_u32 s93, s92, 16384
    v_lshlrev_b32 v18, 8, v1
    s_cmp_eq_u32 s33, 0
    s_nop 0
    s_cbranch_scc0 L_wt1
    buffer_load_dwordx4 v[24:27], v18, s[20:23], s92 offen
    buffer_load_dwordx4 v[28:31], v18, s[20:23], s93 offen
    s_branch L_wt2
L_wt1:
    buffer_load_dwordx4 v[24:27], v18, s[20:23], s92 offen sc0 sc1
    buffer_load_dwordx4 v[28:31], v18, s[20:23], s93 offen sc0 sc1
L_wt2:
    s_add_u32 s33, s33, 1
    s_add_u32 s40, s89, 24
    s_min_i32 s40, s40, 2904
    v_and_b32 v18, 7, v1
    v_lshlrev_b32 v18, 6, v18
    v_lshrrev_b32 v19, 3, v1
    v_lshl_add_u32 v18, v19, 2, v18
    s_waitcnt vmcnt(0)
    v_xor_b32 v23, s48, v25
    v_bitop3_b32 v23, v23, v27, s48 bitop3:0xf6
    v_bitop3_b32 v23, v23, v29, s48 bitop3:0xf6
    v_bitop3_b32 v23, v23, v31, s48 bitop3:0xf6
    v_cmp_ne_u32 vcc, 0, v23
    s_cmp_gt_u32 s33, 200000
    s_nop 3
    s_cbranch_scc1 L_wt3
    s_cbranch_vccnz L_hl
L_wt3:
    s_mov_b32 s40, 0x7fffffff
    v_max_f32 v23, v24, v28
    s_nop 1
    v_max_f32_dpp v23, v23, v23 quad_perm:[1,0,3,2] row_mask:0xf bank_mask:0xf
    s_nop 1
    v_max_f32_dpp v23, v23, v23 quad_perm:[2,3,0,1] row_mask:0xf bank_mask:0xf
    s_nop 1
    v_max_f32_dpp v23, v23, v23 row_half_mirror row_mask:0xf bank_mask:0xf
    s_nop 1
    v_max_f32_dpp v23, v23, v23 row_mirror row_mask:0xf bank_mask:0xf
    v_mov_b32 v6, v23
    s_nop 1
    v_permlane32_swap_b32 v23, v6
    v_max_f32 v23, v23, v6
    v_mov_b32 v6, v23
    s_nop 1
    v_permlane16_swap_b32 v23, v6
    v_max_f32 v23, v23, v6
    v_sub_f32 v24, v24, v23
    v_sub_f32 v28, v28, v23
    v_exp_f32 v24, v24
    v_exp_f32 v28, v28
    v_mul_f32 v23, v24, v26
    v_fmac_f32 v23, v28, v30
    s_nop 1
    v_add_f32_dpp v23, v23, v23 quad_perm:[1,0,3,2] row_mask:0xf bank_mask:0xf
    s_nop 1
    v_add_f32_dpp v23, v23, v23 quad_perm:[2,3,0,1] row_mask:0xf bank_mask:0xf
    s_nop 1
    v_add_f32_dpp v23, v23, v23 row_half_mirror row_mask:0xf bank_mask:0xf
    s_nop 1
    v_add_f32_dpp v23, v23, v23 row_mirror row_mask:0xf bank_mask:0xf
    v_mov_b32 v6, v23
    s_nop 1
    v_permlane32_swap_b32 v23, v6
    v_add_f32 v23, v23, v6
    v_mov_b32 v6, v23
    s_nop 1
    v_permlane16_swap_b32 v23, v6
    v_add_f32 v23, v23, v6
    v_rcp_f32 v23, v23
    s_nop 0
    v_mul_f32 v24, v24, v23
    v_mul_f32 v28, v28, v23
    v_add_u32 v18, 78336, v18
    ds_write2_b32 v18, v24, v28 offset0:0 offset1:8
    v_mov_b32 v19, s48
    ds_write_b32 v3, v19 offset:24
    s_waitcnt lgkmcnt(0)
    s_branch L_hl
L_mrg:
    ds_read_b32 v104, v20 offset:4
    ds_read_b128 v[88:91], v10 offset:0
    ds_read_b128 v[92:95], v10 offset:768
    ds_read_b128 v[96:99], v10 offset:1536
    ds_read_b128 v[100:103], v10 offset:2304
    s_add_u32 s86, s86, 1
    s_sub_u32 s92, s86, 24
    v_mov_b32 v23, s92
    ds_write_b32 v3, v23 offset:60
    s_and_b32 s92, s92, 3
    s_cselect_b32 s92, 1, -3
    s_mul_i32 s92, s92, 3072
    v_add_u32 v10, s92, v10
    v_add_u32 v20, 16, v20
    s_cmp_eq_u32 s86, 39
    s_cselect_b32 s86, 14, s86
    s_waitcnt lgkmcnt(0)
    v_pk_add_f32 v[88:89], v[88:89], v[104:105] op_sel:[0,0] op_sel_hi:[1,0]
    v_pk_add_f32 v[90:91], v[90:91], v[104:105] op_sel:[0,0] op_sel_hi:[1,0]
    v_pk_add_f32 v[92:93], v[92:93], v[96:97]
    v_pk_add_f32 v[94:95], v[94:95], v[98:99]
    v_pk_add_f32 v[88:89], v[88:89], v[100:101]
    v_pk_add_f32 v[90:91], v[90:91], v[102:103]
    v_pk_add_f32 v[88:89], v[88:89], v[92:93]
    v_pk_add_f32 v[90:91], v[90:91], v[94:95]
    v_bfi_b32 v84, v5, s48, v88
    v_bfi_b32 v85, v5, s49, v89
    v_bfi_b32 v86, v5, s50, v90
    v_bfi_b32 v87, v5, s51, v91
    ds_write_b128 v9, v[84:87]
    v_add_u32 v9, 1024, v9
    s_waitcnt lgkmcnt(0)
    s_nop 0
    s_branch L_hl
L_late:
    s_getpc_b64 s[92:93]
    v_lshlrev_b32 v19, 7, v1
    v_min_u32 v19, L_end-L_late-4, v19
    s_mov_b64 exec, 0xff
    global_load_dword v6, v19, s[92:93]
    s_mov_b64 exec, -1
    s_mul_i32 s32, s41, 768
    s_add_u32 s39, s32, 2949120
    s_mul_i32 s42, s80, 3112
    s_add_u32 s42, s42, s79
    s_cmp_eq_u32 s80, 0
    s_cselect_b32 s42, -2, s42
    s_min_u32 s42, s42, -2
    v_add_u32 v9, 49152, v2
    ds_read_b128 v[24:27], v9 offset:0
    ds_read_b128 v[28:31], v9 offset:1024
    ds_read_b128 v[32:35], v9 offset:2048
    ds_read_b128 v[36:39], v9 offset:3072
    ds_read_b128 v[40:43], v9 offset:4096
    ds_read_b128 v[44:47], v9 offset:5120
    ds_read_b128 v[48:51], v9 offset:6144
    ds_read_b128 v[52:55], v9 offset:7168
    ds_read_b128 v[56:59], v9 offset:8192
    ds_read_b128 v[60:63], v9 offset:9216
    s_waitcnt lgkmcnt(0)
    ds_read_b128 v[64:67], v9 offset:10240
    ds_read_b128 v[68:71], v9 offset:11264
    ds_read_b128 v[72:75], v9 offset:12288
    ds_read_b128 v[76:79], v9 offset:13312
    ds_read_b128 v[80:83], v9 offset:14336
    ds_read_b32 v104, v20 offset:4
    s_mov_b32 exec_hi, 0xffff
L_w7:
    ds_read_b32 v19, v7
    ds_read_b128 v[88:91], v10 offset:0
    ds_read_b128 v[92:95], v10 offset:768
    ds_read_b128 v[96:99], v10 offset:1536
    ds_read_b128 v[100:103], v10 offset:2304
    s_memrealtime s[96:97]
    s_waitcnt lgkmcnt(0)
    v_readlane_b32 s92, v19, 39
    v_readlane_b32 s89, v19, 5
    s_cmp_eq_u32 s92, 4
    s_nop 3
    s_cbranch_scc1 L_g7
    s_sub_u32 s96, s96, s78
    s_lshl_b32 s96, s96, 8
    s_cmp_ge_i32 s89, 3084
    s_cbranch_scc1 L_ns7
    s_mul_i32 s92, s80, s89
    s_add_u32 s92, s92, s79
    s_sub_u32 s92, s96, s92
    s_max_i32 s92, s92, s98
    s_min_i32 s92, s92, s99
    s_mul_i32 s92, s92, 250
    s_add_u32 s92, s92, 21495808
    s_ashr_i32 s92, s92, 20
    s_max_i32 s92, s92, 15
    s_min_i32 s92, s92, 26
    v_mov_b32 v18, s92
    ds_write_b32 v3, v18 offset:16
    s_nop 0
L_ns7:
    s_cmp_lt_u32 s96, s42
    s_cbranch_scc1 L_w7
    buffer_store_dwordx4 v[24:27], v2, s[20:23], s32 offen sc0 sc1
    s_add_u32 s32, s32, 196608
    buffer_store_dwordx4 v[28:31], v2, s[20:23], s32 offen sc0 sc1
    s_add_u32 s32, s32, 196608
    buffer_store_dwordx4 v[32:35], v2, s[20:23], s32 offen sc0 sc1
    s_add_u32 s32, s32, 196608
    buffer_store_dwordx4 v[36:39], v2, s[20:23], s32 offen sc0 sc1
    s_add_u32 s32, s32, 196608
    buffer_store_dwordx4 v[40:43], v2, s[20:23], s32 offen sc0 sc1
    s_add_u32 s32, s32, 196608
    buffer_store_dwordx4 v[44:47], v2, s[20:23], s32 offen sc0 sc1
    s_add_u32 s32, s32, 196608
    buffer_store_dwordx4 v[48:51], v2, s[20:23], s32 offen sc0 sc1
    s_add_u32 s32, s32, 196608
    buffer_store_dwordx4 v[52:55], v2, s[20:23], s32 offen sc0 sc1
    s_add_u32 s32, s32, 196608
    buffer_store_dwordx4 v[56:59], v2, s[20:23], s32 offen sc0 sc1
    s_add_u32 s32, s32, 196608
    buffer_store_dwordx4 v[60:63], v2, s[20:23], s32 offen sc0 sc1
    s_add_u32 s32, s32, 196608
    buffer_store_dwordx4 v[64:67], v2, s[20:23], s32 offen sc0 sc1
    s_add_u32 s32, s32, 196608
    buffer_store_dwordx4 v[68:71], v2, s[20:23], s32 offen sc0 sc1
    s_add_u32 s32, s32, 196608
    buffer_store_dwordx4 v[72:75], v2, s[20:23], s32 offen sc0 sc1
    s_add_u32 s32, s32, 196608
    buffer_store_dwordx4 v[76:79], v2, s[20:23], s32 offen sc0 sc1
    s_add_u32 s32, s32, 196608
    buffer_store_dwordx4 v[80:83], v2, s[20:23], s32 offen sc0 sc1
    s_mov_b32 s42, -1
    s_nop 0
    s_branch L_w7
L_g7:
    v_pk_add_f32 v[88:89], v[88:89], v[104:105] op_sel:[0,0] op_sel_hi:[1,0]
    v_pk_add_f32 v[90:91], v[90:91], v[104:105] op_sel:[0,0] op_sel_hi:[1,0]
    v_pk_add_f32 v[92:93], v[92:93], v[96:97]
    v_pk_add_f32 v[94:95], v[94:95], v[98:99]
    v_pk_add_f32 v[88:89], v[88:89], v[100:101]
    v_pk_add_f32 v[90:91], v[90:91], v[102:103]
    v_pk_add_f32 v[88:89], v[88:89], v[92:93]
    v_pk_add_f32 v[90:91], v[90:91], v[94:95]
    v_bfi_b32 v84, v5, s48, v88
    v_bfi_b32 v85, v5, s49, v89
    v_bfi_b32 v86, v5, s50, v90
    v_bfi_b32 v87, v5, s51, v91
    buffer_store_dwordx4 v[84:87], v2, s[20:23], s39 offen sc0 sc1
    s_cmp_eq_u32 s42, -1
    s_nop 0
    s_cbranch_scc1 L_hend
    buffer_store_dwordx4 v[24:27], v2, s[20:23], s32 offen sc0 sc1
    s_add_u32 s32, s32, 196608
    buffer_store_dwordx4 v[28:31], v2, s[20:23], s32 offen sc0 sc1
    s_add_u32 s32, s32, 196608
    buffer_store_dwordx4 v[32:35], v2, s[20:23], s32 offen sc0 sc1
    s_add_u32 s32, s32, 196608
    buffer_store_dwordx4 v[36:39], v2, s[20:23], s32 offen sc0 sc1
    s_add_u32 s32, s32, 196608
    buffer_store_dwordx4 v[40:43], v2, s[20:23], s32 offen sc0 sc1
    s_add_u32 s32, s32, 196608
    buffer_store_dwordx4 v[44:47], v2, s[20:23], s32 offen sc0 sc1
    s_add_u32 s32, s32, 196608
    buffer_store_dwordx4 v[48:51], v2, s[20:23], s32 offen sc0 sc1
    s_add_u32 s32, s32, 196608
    buffer_store_dwordx4 v[52:55], v2, s[20:23], s32 offen sc0 sc1
    s_add_u32 s32, s32, 196608
    buffer_store_dwordx4 v[56:59], v2, s[20:23], s32 offen sc0 sc1
    s_add_u32 s32, s32, 196608
    buffer_store_dwordx4 v[60:63], v2, s[20:23], s32 offen sc0 sc1
    s_add_u32 s32, s32, 196608
    buffer_store_dwordx4 v[64:67], v2, s[20:23], s32 offen sc0 sc1
    s_add_u32 s32, s32, 196608
    buffer_store_dwordx4 v[68:71], v2, s[20:23], s32 offen sc0 sc1
    s_add_u32 s32, s32, 196608
    buffer_store_dwordx4 v[72:75], v2, s[20:23], s32 offen sc0 sc1
    s_add_u32 s32, s32, 196608
    buffer_store_dwordx4 v[76:79], v2, s[20:23], s32 offen sc0 sc1
    s_add_u32 s32, s32, 196608
    buffer_store_dwordx4 v[80:83], v2, s[20:23], s32 offen sc0 sc1
    s_mov_b32 s42, -1
    s_nop 0
L_hend:
    v_mov_b32 v18, 2
    s_waitcnt vmcnt(14)
    ds_write_b32 v3, v18 offset:32
    v_mov_b32 v18, 3
    s_waitcnt vmcnt(13)
    ds_write_b32 v3, v18 offset:32
    v_mov_b32 v18, 4
    s_waitcnt vmcnt(12)
    ds_write_b32 v3, v18 offset:32
    v_mov_b32 v18, 5
    s_waitcnt vmcnt(11)
    ds_write_b32 v3, v18 offset:32
    v_mov_b32 v18, 6
    s_waitcnt vmcnt(10)
    ds_write_b32 v3, v18 offset:32
    v_mov_b32 v18, 7
    s_waitcnt vmcnt(9)
    ds_write_b32 v3, v18 offset:32
    v_mov_b32 v18, 8
    s_waitcnt vmcnt(8)
    ds_write_b32 v3, v18 offset:32
    v_mov_b32 v18, 9
    s_waitcnt vmcnt(7)
    ds_write_b32 v3, v18 offset:32
    v_mov_b32 v18, 10
    s_waitcnt vmcnt(6)
    ds_write_b32 v3, v18 offset:32
    v_mov_b32 v18, 11
    s_waitcnt vmcnt(5)
    ds_write_b32 v3, v18 offset:32
    v_mov_b32 v18, 12
    s_waitcnt vmcnt(4)
    ds_write_b32 v3, v18 offset:32
    v_mov_b32 v18, 13
    s_waitcnt vmcnt(3)
    ds_write_b32 v3, v18 offset:32
    v_mov_b32 v18, 14
    s_waitcnt vmcnt(2)
    ds_write_b32 v3, v18 offset:32
    v_mov_b32 v18, 15
    s_waitcnt vmcnt(1)
    ds_write_b32 v3, v18 offset:32
    v_mov_b32 v18, 16
    s_waitcnt vmcnt(0)
    ds_write_b32 v3, v18 offset:32
    s_waitcnt lgkmcnt(0)
L_end:
    s_endpgm
.section .rodata,"a"
.p2align 6
.amdhsa_kernel standalone__kv_cache_quant_pre_rope_vs_post_rope__decode_kernel
  .amdhsa_next_free_vgpr 168
  .amdhsa_next_free_sgpr 102
  .amdhsa_accum_offset 168
  .amdhsa_group_segment_fixed_size 0
  .amdhsa_kernarg_size 112
  .amdhsa_user_sgpr_count 2
  .amdhsa_user_sgpr_kernarg_segment_ptr 1
  .amdhsa_system_sgpr_workgroup_id_x 1
.end_amdhsa_kernel
```

```asm
; @launch grid=(256,1,1) block=(384,1,1) lds=79872
.amdgcn_target "amdgcn-amd-amdhsa--gfx950"
.text
.globl standalone__kv_cache_quant_pre_rope_vs_post_rope__decode_kernel
.p2align 8
.type standalone__kv_cache_quant_pre_rope_vs_post_rope__decode_kernel,@function
standalone__kv_cache_quant_pre_rope_vs_post_rope__decode_kernel:
    s_load_dwordx16 s[48:63], s[0:1], 0
    s_load_dwordx8 s[64:71], s[0:1], 64
    s_load_dwordx4 s[72:75], s[0:1], 96
    s_cmp_ge_u32 s2, 256
    s_cbranch_scc1 L_end
    v_lshrrev_b32 v18, 6, v0
    v_and_b32 v1, 63, v0
    v_readfirstlane_b32 s76, v18
    v_cmp_eq_u32 vcc, 4, v1
    v_lshlrev_b32 v7, 2, v1
    v_add_u32 v7, 77824, v7
    v_cndmask_b32 v19, 0, 20, vcc
    ds_write_b32 v7, v19
    s_and_b32 s92, s2, 7
    s_lshl_b32 s77, s92, 6
    s_and_b32 s92, s2, 0x60
    s_lshl4_add_u32 s77, s92, s77
    s_and_b32 s92, s2, 0x10
    s_lshl1_add_u32 s77, s92, s77
    s_lshr_b32 s92, s2, 7
    s_lshl4_add_u32 s77, s92, s77
    s_bfe_u32 s3, s2, 0x10003
    s_mul_i32 s92, s3, 8192
    s_add_u32 s77, s77, s92
    s_cmp_lg_u32 s76, 0
    s_cbranch_scc1 L_other
    s_setprio 3
    v_lshlrev_b32 v2, 4, v1
    v_add_u32 v8, 784896, v2
    v_cmp_gt_u32 vcc, 32, v1
    s_mul_i32 s78, s77, 384
    s_mov_b32 s6, 6291456
    s_mov_b32 s7, 0x20000
    v_cndmask_b32 v4, v8, v2, vcc
    s_mov_b32 m0, 0
    s_mov_b32 s81, 0
    v_mov_b32 v6, 77844
    v_mov_b32 v5, -20
    s_waitcnt lgkmcnt(0)
    s_mov_b64 s[4:5], s[66:67]
L_i0:
    s_waitcnt vmcnt(19)
    buffer_load_dwordx4 v2, s[4:7], s78 offen offset:0  lds
    v_add_u32 v5, 3, v5
    s_add_u32 s81, s81, 1
    s_waitcnt vmcnt(19)
    buffer_load_dwordx4 v4, s[4:7], s78 offen offset:1024  lds
    s_and_b32 s92, s81, 3
    s_cselect_b32 s92, 0, -6144
    s_cmp_eq_u32 s81, 8
    s_cselect_b32 s93, 1572864, 0
    s_add_u32 s92, s92, s93
    s_bitcmp1_b32 s81, 2
    s_waitcnt vmcnt(19)
    buffer_load_dwordx4 v8, s[4:7], s78 offen offset:2048  lds
    ds_write_b32 v6, v5
    s_cselect_b64 s[4:5], s[68:69], s[66:67]
    s_addk_i32 m0, 3072
    s_addk_i32 s92, 1536
    s_add_u32 s78, s78, s92
    s_cmp_lg_u32 s81, 6
    s_cbranch_scc1 L_i1
    s_barrier
L_i1:
    s_cmp_lt_u32 s81, 16
    s_cbranch_scc1 L_i0
    ds_read_b32 v3, v7
    s_mul_i32 s79, s3, 12582912
    s_mov_b64 s[4:5], s[50:51]
    s_mov_b32 s6, 402653184
    s_mov_b32 s7, 0x20000
    s_mov_b32 m0, 0
    s_movk_i32 s85, 4096
    s_mov_b32 s81, 0
    s_mul_i32 s78, s77, 768
    s_add_u32 s78, s78, s79
    s_mov_b32 s82, 1
    s_waitcnt lgkmcnt(0)
    v_readlane_b32 s84, v3, 0
    s_nop 4
L_D20:
    s_mul_i32 s92, s81, 12
    s_add_u32 s92, s92, 28
    v_mov_b32 v5, s92
L_B20:
L_B20_0:
    s_cmp_lt_i32 s84, s82
    s_cbranch_scc1 L_B20_0w
    s_waitcnt vmcnt(19)
    buffer_load_dwordx4 v2, s[4:7], s78 offen offset:0 nt lds
    v_add_u32 v5, 3, v5
    s_add_u32 s81, s81, 1
    s_and_b32 s92, s81, 7
    s_waitcnt vmcnt(19)
    buffer_load_dwordx4 v2, s[4:7], s78 offen offset:1024 nt lds
    v_readlane_b32 s84, v3, 1
    ds_read_b32 v3, v7
    s_lshl_b32 s92, s92, 11
    s_waitcnt vmcnt(19)
    buffer_load_dwordx4 v2, s[4:7], s78 offen offset:2048 nt lds
    ds_write_b32 v6, v5
    s_add_u32 s92, s92, s77
    s_and_b32 s92, s92, 16383
L_B20_1:
    s_cmp_lt_i32 s84, s82
    s_cbranch_scc1 L_B20_1w
    s_waitcnt vmcnt(19)
    buffer_load_dwordx4 v2, s[4:7], s78 offen offset:3072 nt lds
    v_add_u32 v5, 3, v5
    s_add_u32 m0, m0, s85
    s_add_u32 s78, s78, s85
    s_waitcnt vmcnt(19)
    buffer_load_dwordx4 v2, s[4:7], s78 offen offset:0 nt lds
    v_readlane_b32 s84, v3, 2
    ds_read_b32 v3, v7
    s_mul_i32 s80, s92, 768
    s_waitcnt vmcnt(19)
    buffer_load_dwordx4 v2, s[4:7], s78 offen offset:1024 nt lds
    ds_write_b32 v6, v5
    s_bfe_u32 s92, s81, 0x40003
    s_mul_i32 s92, s92, 25165824
L_B20_2:
    s_cmp_lt_i32 s84, s82
    s_cbranch_scc1 L_B20_2w
    s_waitcnt vmcnt(19)
    buffer_load_dwordx4 v2, s[4:7], s78 offen offset:2048 nt lds
    v_add_u32 v5, 3, v5
    s_add_u32 s80, s80, s79
    s_add_u32 s80, s80, s92
    s_waitcnt vmcnt(19)
    buffer_load_dwordx4 v2, s[4:7], s78 offen offset:3072 nt lds
    v_readlane_b32 s84, v3, 3
    ds_read_b32 v3, v7
    s_add_u32 m0, m0, s85
    s_add_u32 s78, s78, s85
    s_waitcnt vmcnt(19)
    buffer_load_dwordx4 v2, s[4:7], s78 offen offset:0 nt lds
    ds_write_b32 v6, v5
    s_and_b32 s86, s81, 3
    s_mul_i32 s86, s86, 12288
L_B20_3:
    s_cmp_lt_i32 s84, s82
    s_cbranch_scc1 L_B20_3w
    s_waitcnt vmcnt(19)
    buffer_load_dwordx4 v2, s[4:7], s78 offen offset:1024 nt lds
    v_add_u32 v5, 3, v5
    v_readlane_b32 s83, v3, 4
    s_waitcnt vmcnt(19)
    buffer_load_dwordx4 v2, s[4:7], s78 offen offset:2048 nt lds
    v_readlane_b32 s84, v3, 0
    ds_read_b32 v3, v7
    s_add_u32 s82, s82, 1
    s_cmp_ge_u32 s81, 255
    s_cselect_b32 s83, -1, s83
    s_cmp_ge_u32 s81, 128
    s_waitcnt vmcnt(19)
    buffer_load_dwordx4 v2, s[4:7], s78 offen offset:3072 nt lds
    ds_write_b32 v6, v5
    s_cselect_b64 s[4:5], s[56:57], s[50:51]
    s_mov_b32 m0, s86
    s_mov_b32 s78, s80
    s_cmp_eq_u32 s83, 20
    s_cbranch_scc1 L_B20
L_disp:
    s_cmp_eq_u32 s83, 20
    s_cbranch_scc1 L_D20
    s_cmp_eq_u32 s83, 21
    s_cbranch_scc1 L_D21
    s_cmp_eq_u32 s83, 19
    s_cbranch_scc1 L_D19
    s_cmp_eq_u32 s83, 22
    s_cbranch_scc1 L_D22
    s_cmp_eq_u32 s83, 18
    s_cbranch_scc1 L_D18
    s_cmp_eq_u32 s83, 23
    s_cbranch_scc1 L_D23
    s_cmp_eq_u32 s83, 17
    s_cbranch_scc1 L_D17
    s_cmp_eq_u32 s83, 24
    s_cbranch_scc1 L_D24
    s_cmp_eq_u32 s83, 16
    s_cbranch_scc1 L_D16
    s_cmp_eq_u32 s83, 25
    s_cbranch_scc1 L_D25
    s_cmp_eq_u32 s81, 256
    s_cbranch_scc1 L_drain
    s_cmp_ge_u32 s81, 255
    s_cbranch_scc1 L_D32
    s_cmp_ge_i32 s83, 26
    s_cbranch_scc1 L_D26
    s_branch L_D15
L_D19:
    s_mul_i32 s92, s81, 12
    s_add_u32 s92, s92, 29
    v_mov_b32 v5, s92
L_B19:
L_B19_0:
    s_cmp_lt_i32 s84, s82
    s_cbranch_scc1 L_B19_0w
    s_waitcnt vmcnt(18)
    buffer_load_dwordx4 v2, s[4:7], s78 offen offset:0 nt lds
    v_add_u32 v5, 3, v5
    s_add_u32 s81, s81, 1
    s_and_b32 s92, s81, 7
    s_waitcnt vmcnt(18)
    buffer_load_dwordx4 v2, s[4:7], s78 offen offset:1024 nt lds
    v_readlane_b32 s84, v3, 1
    ds_read_b32 v3, v7
    s_lshl_b32 s92, s92, 11
    s_waitcnt vmcnt(18)
    buffer_load_dwordx4 v2, s[4:7], s78 offen offset:2048 nt lds
    ds_write_b32 v6, v5
    s_add_u32 s92, s92, s77
    s_and_b32 s92, s92, 16383
L_B19_1:
    s_cmp_lt_i32 s84, s82
    s_cbranch_scc1 L_B19_1w
    s_waitcnt vmcnt(18)
    buffer_load_dwordx4 v2, s[4:7], s78 offen offset:3072 nt lds
    v_add_u32 v5, 3, v5
    s_add_u32 m0, m0, s85
    s_add_u32 s78, s78, s85
    s_waitcnt vmcnt(18)
    buffer_load_dwordx4 v2, s[4:7], s78 offen offset:0 nt lds
    v_readlane_b32 s84, v3, 2
    ds_read_b32 v3, v7
    s_mul_i32 s80, s92, 768
    s_waitcnt vmcnt(18)
    buffer_load_dwordx4 v2, s[4:7], s78 offen offset:1024 nt lds
    ds_write_b32 v6, v5
    s_bfe_u32 s92, s81, 0x40003
    s_mul_i32 s92, s92, 25165824
L_B19_2:
    s_cmp_lt_i32 s84, s82
    s_cbranch_scc1 L_B19_2w
    s_waitcnt vmcnt(18)
    buffer_load_dwordx4 v2, s[4:7], s78 offen offset:2048 nt lds
    v_add_u32 v5, 3, v5
    s_add_u32 s80, s80, s79
    s_add_u32 s80, s80, s92
    s_waitcnt vmcnt(18)
    buffer_load_dwordx4 v2, s[4:7], s78 offen offset:3072 nt lds
    v_readlane_b32 s84, v3, 3
    ds_read_b32 v3, v7
    s_add_u32 m0, m0, s85
    s_add_u32 s78, s78, s85
    s_waitcnt vmcnt(18)
    buffer_load_dwordx4 v2, s[4:7], s78 offen offset:0 nt lds
    ds_write_b32 v6, v5
    s_and_b32 s86, s81, 3
    s_mul_i32 s86, s86, 12288
L_B19_3:
    s_cmp_lt_i32 s84, s82
    s_cbranch_scc1 L_B19_3w
    s_waitcnt vmcnt(18)
    buffer_load_dwordx4 v2, s[4:7], s78 offen offset:1024 nt lds
    v_add_u32 v5, 3, v5
    v_readlane_b32 s83, v3, 4
    s_waitcnt vmcnt(18)
    buffer_load_dwordx4 v2, s[4:7], s78 offen offset:2048 nt lds
    v_readlane_b32 s84, v3, 0
    ds_read_b32 v3, v7
    s_add_u32 s82, s82, 1
    s_cmp_ge_u32 s81, 255
    s_cselect_b32 s83, -1, s83
    s_cmp_ge_u32 s81, 128
    s_waitcnt vmcnt(18)
    buffer_load_dwordx4 v2, s[4:7], s78 offen offset:3072 nt lds
    ds_write_b32 v6, v5
    s_cselect_b64 s[4:5], s[56:57], s[50:51]
    s_mov_b32 m0, s86
    s_mov_b32 s78, s80
    s_cmp_eq_u32 s83, 19
    s_cbranch_scc1 L_B19
    s_cmp_eq_u32 s83, -1
    s_cbranch_scc1 L_D32
    s_cmp_eq_u32 s83, 20
    s_cbranch_scc1 L_D20
    s_cmp_eq_u32 s83, 18
    s_cbranch_scc1 L_D18
    s_branch L_disp
L_D21:
    s_mul_i32 s92, s81, 12
    s_add_u32 s92, s92, 27
    v_mov_b32 v5, s92
L_B21:
L_B21_0:
    s_cmp_lt_i32 s84, s82
    s_cbranch_scc1 L_B21_0w
    s_waitcnt vmcnt(20)
    buffer_load_dwordx4 v2, s[4:7], s78 offen offset:0 nt lds
    v_add_u32 v5, 3, v5
    s_add_u32 s81, s81, 1
    s_and_b32 s92, s81, 7
    s_waitcnt vmcnt(20)
    buffer_load_dwordx4 v2, s[4:7], s78 offen offset:1024 nt lds
    v_readlane_b32 s84, v3, 1
    ds_read_b32 v3, v7
    s_lshl_b32 s92, s92, 11
    s_waitcnt vmcnt(20)
    buffer_load_dwordx4 v2, s[4:7], s78 offen offset:2048 nt lds
    ds_write_b32 v6, v5
    s_add_u32 s92, s92, s77
    s_and_b32 s92, s92, 16383
L_B21_1:
    s_cmp_lt_i32 s84, s82
    s_cbranch_scc1 L_B21_1w
    s_waitcnt vmcnt(20)
    buffer_load_dwordx4 v2, s[4:7], s78 offen offset:3072 nt lds
    v_add_u32 v5, 3, v5
    s_add_u32 m0, m0, s85
    s_add_u32 s78, s78, s85
    s_waitcnt vmcnt(20)
    buffer_load_dwordx4 v2, s[4:7], s78 offen offset:0 nt lds
    v_readlane_b32 s84, v3, 2
    ds_read_b32 v3, v7
    s_mul_i32 s80, s92, 768
    s_waitcnt vmcnt(20)
    buffer_load_dwordx4 v2, s[4:7], s78 offen offset:1024 nt lds
    ds_write_b32 v6, v5
    s_bfe_u32 s92, s81, 0x40003
    s_mul_i32 s92, s92, 25165824
L_B21_2:
    s_cmp_lt_i32 s84, s82
    s_cbranch_scc1 L_B21_2w
    s_waitcnt vmcnt(20)
    buffer_load_dwordx4 v2, s[4:7], s78 offen offset:2048 nt lds
    v_add_u32 v5, 3, v5
    s_add_u32 s80, s80, s79
    s_add_u32 s80, s80, s92
    s_waitcnt vmcnt(20)
    buffer_load_dwordx4 v2, s[4:7], s78 offen offset:3072 nt lds
    v_readlane_b32 s84, v3, 3
    ds_read_b32 v3, v7
    s_add_u32 m0, m0, s85
    s_add_u32 s78, s78, s85
    s_waitcnt vmcnt(20)
    buffer_load_dwordx4 v2, s[4:7], s78 offen offset:0 nt lds
    ds_write_b32 v6, v5
    s_and_b32 s86, s81, 3
    s_mul_i32 s86, s86, 12288
L_B21_3:
    s_cmp_lt_i32 s84, s82
    s_cbranch_scc1 L_B21_3w
    s_waitcnt vmcnt(20)
    buffer_load_dwordx4 v2, s[4:7], s78 offen offset:1024 nt lds
    v_add_u32 v5, 3, v5
    v_readlane_b32 s83, v3, 4
    s_waitcnt vmcnt(20)
    buffer_load_dwordx4 v2, s[4:7], s78 offen offset:2048 nt lds
    v_readlane_b32 s84, v3, 0
    ds_read_b32 v3, v7
    s_add_u32 s82, s82, 1
    s_cmp_ge_u32 s81, 255
    s_cselect_b32 s83, -1, s83
    s_cmp_ge_u32 s81, 128
    s_waitcnt vmcnt(20)
    buffer_load_dwordx4 v2, s[4:7], s78 offen offset:3072 nt lds
    ds_write_b32 v6, v5
    s_cselect_b64 s[4:5], s[56:57], s[50:51]
    s_mov_b32 m0, s86
    s_mov_b32 s78, s80
    s_cmp_eq_u32 s83, 21
    s_cbranch_scc1 L_B21
    s_cmp_eq_u32 s83, -1
    s_cbranch_scc1 L_D32
    s_cmp_eq_u32 s83, 20
    s_cbranch_scc1 L_D20
    s_cmp_eq_u32 s83, 22
    s_cbranch_scc1 L_D22
    s_branch L_disp
L_D18:
    s_mul_i32 s92, s81, 12
    s_add_u32 s92, s92, 30
    v_mov_b32 v5, s92
L_B18:
L_B18_0:
    s_cmp_lt_i32 s84, s82
    s_cbranch_scc1 L_B18_0w
    s_waitcnt vmcnt(17)
    buffer_load_dwordx4 v2, s[4:7], s78 offen offset:0 nt lds
    v_add_u32 v5, 3, v5
    s_add_u32 s81, s81, 1
    s_and_b32 s92, s81, 7
    s_waitcnt vmcnt(17)
    buffer_load_dwordx4 v2, s[4:7], s78 offen offset:1024 nt lds
    v_readlane_b32 s84, v3, 1
    ds_read_b32 v3, v7
    s_lshl_b32 s92, s92, 11
    s_waitcnt vmcnt(17)
    buffer_load_dwordx4 v2, s[4:7], s78 offen offset:2048 nt lds
    ds_write_b32 v6, v5
    s_add_u32 s92, s92, s77
    s_and_b32 s92, s92, 16383
L_B18_1:
    s_cmp_lt_i32 s84, s82
    s_cbranch_scc1 L_B18_1w
    s_waitcnt vmcnt(17)
    buffer_load_dwordx4 v2, s[4:7], s78 offen offset:3072 nt lds
    v_add_u32 v5, 3, v5
    s_add_u32 m0, m0, s85
    s_add_u32 s78, s78, s85
    s_waitcnt vmcnt(17)
    buffer_load_dwordx4 v2, s[4:7], s78 offen offset:0 nt lds
    v_readlane_b32 s84, v3, 2
    ds_read_b32 v3, v7
    s_mul_i32 s80, s92, 768
    s_waitcnt vmcnt(17)
    buffer_load_dwordx4 v2, s[4:7], s78 offen offset:1024 nt lds
    ds_write_b32 v6, v5
    s_bfe_u32 s92, s81, 0x40003
    s_mul_i32 s92, s92, 25165824
L_B18_2:
    s_cmp_lt_i32 s84, s82
    s_cbranch_scc1 L_B18_2w
    s_waitcnt vmcnt(17)
    buffer_load_dwordx4 v2, s[4:7], s78 offen offset:2048 nt lds
    v_add_u32 v5, 3, v5
    s_add_u32 s80, s80, s79
    s_add_u32 s80, s80, s92
    s_waitcnt vmcnt(17)
    buffer_load_dwordx4 v2, s[4:7], s78 offen offset:3072 nt lds
    v_readlane_b32 s84, v3, 3
    ds_read_b32 v3, v7
    s_add_u32 m0, m0, s85
    s_add_u32 s78, s78, s85
    s_waitcnt vmcnt(17)
    buffer_load_dwordx4 v2, s[4:7], s78 offen offset:0 nt lds
    ds_write_b32 v6, v5
    s_and_b32 s86, s81, 3
    s_mul_i32 s86, s86, 12288
L_B18_3:
    s_cmp_lt_i32 s84, s82
    s_cbranch_scc1 L_B18_3w
    s_waitcnt vmcnt(17)
    buffer_load_dwordx4 v2, s[4:7], s78 offen offset:1024 nt lds
    v_add_u32 v5, 3, v5
    v_readlane_b32 s83, v3, 4
    s_waitcnt vmcnt(17)
    buffer_load_dwordx4 v2, s[4:7], s78 offen offset:2048 nt lds
    v_readlane_b32 s84, v3, 0
    ds_read_b32 v3, v7
    s_add_u32 s82, s82, 1
    s_cmp_ge_u32 s81, 255
    s_cselect_b32 s83, -1, s83
    s_cmp_ge_u32 s81, 128
    s_waitcnt vmcnt(17)
    buffer_load_dwordx4 v2, s[4:7], s78 offen offset:3072 nt lds
    ds_write_b32 v6, v5
    s_cselect_b64 s[4:5], s[56:57], s[50:51]
    s_mov_b32 m0, s86
    s_mov_b32 s78, s80
    s_cmp_eq_u32 s83, 18
    s_cbranch_scc1 L_B18
    s_cmp_eq_u32 s83, -1
    s_cbranch_scc1 L_D32
    s_cmp_eq_u32 s83, 19
    s_cbranch_scc1 L_D19
    s_cmp_eq_u32 s83, 17
    s_cbranch_scc1 L_D17
    s_branch L_disp
L_D22:
    s_mul_i32 s92, s81, 12
    s_add_u32 s92, s92, 26
    v_mov_b32 v5, s92
L_B22:
L_B22_0:
    s_cmp_lt_i32 s84, s82
    s_cbranch_scc1 L_B22_0w
    s_waitcnt vmcnt(21)
    buffer_load_dwordx4 v2, s[4:7], s78 offen offset:0 nt lds
    v_add_u32 v5, 3, v5
    s_add_u32 s81, s81, 1
    s_and_b32 s92, s81, 7
    s_waitcnt vmcnt(21)
    buffer_load_dwordx4 v2, s[4:7], s78 offen offset:1024 nt lds
    v_readlane_b32 s84, v3, 1
    ds_read_b32 v3, v7
    s_lshl_b32 s92, s92, 11
    s_waitcnt vmcnt(21)
    buffer_load_dwordx4 v2, s[4:7], s78 offen offset:2048 nt lds
    ds_write_b32 v6, v5
    s_add_u32 s92, s92, s77
    s_and_b32 s92, s92, 16383
L_B22_1:
    s_cmp_lt_i32 s84, s82
    s_cbranch_scc1 L_B22_1w
    s_waitcnt vmcnt(21)
    buffer_load_dwordx4 v2, s[4:7], s78 offen offset:3072 nt lds
    v_add_u32 v5, 3, v5
    s_add_u32 m0, m0, s85
    s_add_u32 s78, s78, s85
    s_waitcnt vmcnt(21)
    buffer_load_dwordx4 v2, s[4:7], s78 offen offset:0 nt lds
    v_readlane_b32 s84, v3, 2
    ds_read_b32 v3, v7
    s_mul_i32 s80, s92, 768
    s_waitcnt vmcnt(21)
    buffer_load_dwordx4 v2, s[4:7], s78 offen offset:1024 nt lds
    ds_write_b32 v6, v5
    s_bfe_u32 s92, s81, 0x40003
    s_mul_i32 s92, s92, 25165824
L_B22_2:
    s_cmp_lt_i32 s84, s82
    s_cbranch_scc1 L_B22_2w
    s_waitcnt vmcnt(21)
    buffer_load_dwordx4 v2, s[4:7], s78 offen offset:2048 nt lds
    v_add_u32 v5, 3, v5
    s_add_u32 s80, s80, s79
    s_add_u32 s80, s80, s92
    s_waitcnt vmcnt(21)
    buffer_load_dwordx4 v2, s[4:7], s78 offen offset:3072 nt lds
    v_readlane_b32 s84, v3, 3
    ds_read_b32 v3, v7
    s_add_u32 m0, m0, s85
    s_add_u32 s78, s78, s85
    s_waitcnt vmcnt(21)
    buffer_load_dwordx4 v2, s[4:7], s78 offen offset:0 nt lds
    ds_write_b32 v6, v5
    s_and_b32 s86, s81, 3
    s_mul_i32 s86, s86, 12288
L_B22_3:
    s_cmp_lt_i32 s84, s82
    s_cbranch_scc1 L_B22_3w
    s_waitcnt vmcnt(21)
    buffer_load_dwordx4 v2, s[4:7], s78 offen offset:1024 nt lds
    v_add_u32 v5, 3, v5
    v_readlane_b32 s83, v3, 4
    s_waitcnt vmcnt(21)
    buffer_load_dwordx4 v2, s[4:7], s78 offen offset:2048 nt lds
    v_readlane_b32 s84, v3, 0
    ds_read_b32 v3, v7
    s_add_u32 s82, s82, 1
    s_cmp_ge_u32 s81, 255
    s_cselect_b32 s83, -1, s83
    s_cmp_ge_u32 s81, 128
    s_waitcnt vmcnt(21)
    buffer_load_dwordx4 v2, s[4:7], s78 offen offset:3072 nt lds
    ds_write_b32 v6, v5
    s_cselect_b64 s[4:5], s[56:57], s[50:51]
    s_mov_b32 m0, s86
    s_mov_b32 s78, s80
    s_cmp_eq_u32 s83, 22
    s_cbranch_scc1 L_B22
    s_cmp_eq_u32 s83, -1
    s_cbranch_scc1 L_D32
    s_cmp_eq_u32 s83, 21
    s_cbranch_scc1 L_D21
    s_cmp_eq_u32 s83, 23
    s_cbranch_scc1 L_D23
    s_branch L_disp
L_D17:
    s_mul_i32 s92, s81, 12
    s_add_u32 s92, s92, 31
    v_mov_b32 v5, s92
L_B17:
L_B17_0:
    s_cmp_lt_i32 s84, s82
    s_cbranch_scc1 L_B17_0w
    s_waitcnt vmcnt(16)
    buffer_load_dwordx4 v2, s[4:7], s78 offen offset:0 nt lds
    v_add_u32 v5, 3, v5
    s_add_u32 s81, s81, 1
    s_and_b32 s92, s81, 7
    s_waitcnt vmcnt(16)
    buffer_load_dwordx4 v2, s[4:7], s78 offen offset:1024 nt lds
    v_readlane_b32 s84, v3, 1
    ds_read_b32 v3, v7
    s_lshl_b32 s92, s92, 11
    s_waitcnt vmcnt(16)
    buffer_load_dwordx4 v2, s[4:7], s78 offen offset:2048 nt lds
    ds_write_b32 v6, v5
    s_add_u32 s92, s92, s77
    s_and_b32 s92, s92, 16383
L_B17_1:
    s_cmp_lt_i32 s84, s82
    s_cbranch_scc1 L_B17_1w
    s_waitcnt vmcnt(16)
    buffer_load_dwordx4 v2, s[4:7], s78 offen offset:3072 nt lds
    v_add_u32 v5, 3, v5
    s_add_u32 m0, m0, s85
    s_add_u32 s78, s78, s85
    s_waitcnt vmcnt(16)
    buffer_load_dwordx4 v2, s[4:7], s78 offen offset:0 nt lds
    v_readlane_b32 s84, v3, 2
    ds_read_b32 v3, v7
    s_mul_i32 s80, s92, 768
    s_waitcnt vmcnt(16)
    buffer_load_dwordx4 v2, s[4:7], s78 offen offset:1024 nt lds
    ds_write_b32 v6, v5
    s_bfe_u32 s92, s81, 0x40003
    s_mul_i32 s92, s92, 25165824
L_B17_2:
    s_cmp_lt_i32 s84, s82
    s_cbranch_scc1 L_B17_2w
    s_waitcnt vmcnt(16)
    buffer_load_dwordx4 v2, s[4:7], s78 offen offset:2048 nt lds
    v_add_u32 v5, 3, v5
    s_add_u32 s80, s80, s79
    s_add_u32 s80, s80, s92
    s_waitcnt vmcnt(16)
    buffer_load_dwordx4 v2, s[4:7], s78 offen offset:3072 nt lds
    v_readlane_b32 s84, v3, 3
    ds_read_b32 v3, v7
    s_add_u32 m0, m0, s85
    s_add_u32 s78, s78, s85
    s_waitcnt vmcnt(16)
    buffer_load_dwordx4 v2, s[4:7], s78 offen offset:0 nt lds
    ds_write_b32 v6, v5
    s_and_b32 s86, s81, 3
    s_mul_i32 s86, s86, 12288
L_B17_3:
    s_cmp_lt_i32 s84, s82
    s_cbranch_scc1 L_B17_3w
    s_waitcnt vmcnt(16)
    buffer_load_dwordx4 v2, s[4:7], s78 offen offset:1024 nt lds
    v_add_u32 v5, 3, v5
    v_readlane_b32 s83, v3, 4
    s_waitcnt vmcnt(16)
    buffer_load_dwordx4 v2, s[4:7], s78 offen offset:2048 nt lds
    v_readlane_b32 s84, v3, 0
    ds_read_b32 v3, v7
    s_add_u32 s82, s82, 1
    s_cmp_ge_u32 s81, 255
    s_cselect_b32 s83, -1, s83
    s_cmp_ge_u32 s81, 128
    s_waitcnt vmcnt(16)
    buffer_load_dwordx4 v2, s[4:7], s78 offen offset:3072 nt lds
    ds_write_b32 v6, v5
    s_cselect_b64 s[4:5], s[56:57], s[50:51]
    s_mov_b32 m0, s86
    s_mov_b32 s78, s80
    s_cmp_eq_u32 s83, 17
    s_cbranch_scc1 L_B17
    s_cmp_eq_u32 s83, -1
    s_cbranch_scc1 L_D32
    s_cmp_eq_u32 s83, 18
    s_cbranch_scc1 L_D18
    s_cmp_eq_u32 s83, 16
    s_cbranch_scc1 L_D16
    s_branch L_disp
L_D23:
    s_mul_i32 s92, s81, 12
    s_add_u32 s92, s92, 25
    v_mov_b32 v5, s92
L_B23:
L_B23_0:
    s_cmp_lt_i32 s84, s82
    s_cbranch_scc1 L_B23_0w
    s_waitcnt vmcnt(22)
    buffer_load_dwordx4 v2, s[4:7], s78 offen offset:0 nt lds
    v_add_u32 v5, 3, v5
    s_add_u32 s81, s81, 1
    s_and_b32 s92, s81, 7
    s_waitcnt vmcnt(22)
    buffer_load_dwordx4 v2, s[4:7], s78 offen offset:1024 nt lds
    v_readlane_b32 s84, v3, 1
    ds_read_b32 v3, v7
    s_lshl_b32 s92, s92, 11
    s_waitcnt vmcnt(22)
    buffer_load_dwordx4 v2, s[4:7], s78 offen offset:2048 nt lds
    ds_write_b32 v6, v5
    s_add_u32 s92, s92, s77
    s_and_b32 s92, s92, 16383
L_B23_1:
    s_cmp_lt_i32 s84, s82
    s_cbranch_scc1 L_B23_1w
    s_waitcnt vmcnt(22)
    buffer_load_dwordx4 v2, s[4:7], s78 offen offset:3072 nt lds
    v_add_u32 v5, 3, v5
    s_add_u32 m0, m0, s85
    s_add_u32 s78, s78, s85
    s_waitcnt vmcnt(22)
    buffer_load_dwordx4 v2, s[4:7], s78 offen offset:0 nt lds
    v_readlane_b32 s84, v3, 2
    ds_read_b32 v3, v7
    s_mul_i32 s80, s92, 768
    s_waitcnt vmcnt(22)
    buffer_load_dwordx4 v2, s[4:7], s78 offen offset:1024 nt lds
    ds_write_b32 v6, v5
    s_bfe_u32 s92, s81, 0x40003
    s_mul_i32 s92, s92, 25165824
L_B23_2:
    s_cmp_lt_i32 s84, s82
    s_cbranch_scc1 L_B23_2w
    s_waitcnt vmcnt(22)
    buffer_load_dwordx4 v2, s[4:7], s78 offen offset:2048 nt lds
    v_add_u32 v5, 3, v5
    s_add_u32 s80, s80, s79
    s_add_u32 s80, s80, s92
    s_waitcnt vmcnt(22)
    buffer_load_dwordx4 v2, s[4:7], s78 offen offset:3072 nt lds
    v_readlane_b32 s84, v3, 3
    ds_read_b32 v3, v7
    s_add_u32 m0, m0, s85
    s_add_u32 s78, s78, s85
    s_waitcnt vmcnt(22)
    buffer_load_dwordx4 v2, s[4:7], s78 offen offset:0 nt lds
    ds_write_b32 v6, v5
    s_and_b32 s86, s81, 3
    s_mul_i32 s86, s86, 12288
L_B23_3:
    s_cmp_lt_i32 s84, s82
    s_cbranch_scc1 L_B23_3w
    s_waitcnt vmcnt(22)
    buffer_load_dwordx4 v2, s[4:7], s78 offen offset:1024 nt lds
    v_add_u32 v5, 3, v5
    v_readlane_b32 s83, v3, 4
    s_waitcnt vmcnt(22)
    buffer_load_dwordx4 v2, s[4:7], s78 offen offset:2048 nt lds
    v_readlane_b32 s84, v3, 0
    ds_read_b32 v3, v7
    s_add_u32 s82, s82, 1
    s_cmp_ge_u32 s81, 255
    s_cselect_b32 s83, -1, s83
    s_cmp_ge_u32 s81, 128
    s_waitcnt vmcnt(22)
    buffer_load_dwordx4 v2, s[4:7], s78 offen offset:3072 nt lds
    ds_write_b32 v6, v5
    s_cselect_b64 s[4:5], s[56:57], s[50:51]
    s_mov_b32 m0, s86
    s_mov_b32 s78, s80
    s_cmp_eq_u32 s83, 23
    s_cbranch_scc1 L_B23
    s_cmp_eq_u32 s83, -1
    s_cbranch_scc1 L_D32
    s_cmp_eq_u32 s83, 22
    s_cbranch_scc1 L_D22
    s_cmp_eq_u32 s83, 24
    s_cbranch_scc1 L_D24
    s_branch L_disp
L_D16:
    s_mul_i32 s92, s81, 12
    s_add_u32 s92, s92, 32
    v_mov_b32 v5, s92
L_B16:
L_B16_0:
    s_cmp_lt_i32 s84, s82
    s_cbranch_scc1 L_B16_0w
    s_waitcnt vmcnt(15)
    buffer_load_dwordx4 v2, s[4:7], s78 offen offset:0 nt lds
    v_add_u32 v5, 3, v5
    s_add_u32 s81, s81, 1
    s_and_b32 s92, s81, 7
    s_waitcnt vmcnt(15)
    buffer_load_dwordx4 v2, s[4:7], s78 offen offset:1024 nt lds
    v_readlane_b32 s84, v3, 1
    ds_read_b32 v3, v7
    s_lshl_b32 s92, s92, 11
    s_waitcnt vmcnt(15)
    buffer_load_dwordx4 v2, s[4:7], s78 offen offset:2048 nt lds
    ds_write_b32 v6, v5
    s_add_u32 s92, s92, s77
    s_and_b32 s92, s92, 16383
L_B16_1:
    s_cmp_lt_i32 s84, s82
    s_cbranch_scc1 L_B16_1w
    s_waitcnt vmcnt(15)
    buffer_load_dwordx4 v2, s[4:7], s78 offen offset:3072 nt lds
    v_add_u32 v5, 3, v5
    s_add_u32 m0, m0, s85
    s_add_u32 s78, s78, s85
    s_waitcnt vmcnt(15)
    buffer_load_dwordx4 v2, s[4:7], s78 offen offset:0 nt lds
    v_readlane_b32 s84, v3, 2
    ds_read_b32 v3, v7
    s_mul_i32 s80, s92, 768
    s_waitcnt vmcnt(15)
    buffer_load_dwordx4 v2, s[4:7], s78 offen offset:1024 nt lds
    ds_write_b32 v6, v5
    s_bfe_u32 s92, s81, 0x40003
    s_mul_i32 s92, s92, 25165824
L_B16_2:
    s_cmp_lt_i32 s84, s82
    s_cbranch_scc1 L_B16_2w
    s_waitcnt vmcnt(15)
    buffer_load_dwordx4 v2, s[4:7], s78 offen offset:2048 nt lds
    v_add_u32 v5, 3, v5
    s_add_u32 s80, s80, s79
    s_add_u32 s80, s80, s92
    s_waitcnt vmcnt(15)
    buffer_load_dwordx4 v2, s[4:7], s78 offen offset:3072 nt lds
    v_readlane_b32 s84, v3, 3
    ds_read_b32 v3, v7
    s_add_u32 m0, m0, s85
    s_add_u32 s78, s78, s85
    s_waitcnt vmcnt(15)
    buffer_load_dwordx4 v2, s[4:7], s78 offen offset:0 nt lds
    ds_write_b32 v6, v5
    s_and_b32 s86, s81, 3
    s_mul_i32 s86, s86, 12288
L_B16_3:
    s_cmp_lt_i32 s84, s82
    s_cbranch_scc1 L_B16_3w
    s_waitcnt vmcnt(15)
    buffer_load_dwordx4 v2, s[4:7], s78 offen offset:1024 nt lds
    v_add_u32 v5, 3, v5
    v_readlane_b32 s83, v3, 4
    s_waitcnt vmcnt(15)
    buffer_load_dwordx4 v2, s[4:7], s78 offen offset:2048 nt lds
    v_readlane_b32 s84, v3, 0
    ds_read_b32 v3, v7
    s_add_u32 s82, s82, 1
    s_cmp_ge_u32 s81, 255
    s_cselect_b32 s83, -1, s83
    s_cmp_ge_u32 s81, 128
    s_waitcnt vmcnt(15)
    buffer_load_dwordx4 v2, s[4:7], s78 offen offset:3072 nt lds
    ds_write_b32 v6, v5
    s_cselect_b64 s[4:5], s[56:57], s[50:51]
    s_mov_b32 m0, s86
    s_mov_b32 s78, s80
    s_cmp_eq_u32 s83, 16
    s_cbranch_scc1 L_B16
    s_cmp_eq_u32 s83, -1
    s_cbranch_scc1 L_D32
    s_cmp_eq_u32 s83, 17
    s_cbranch_scc1 L_D17
    s_cmp_eq_u32 s83, 15
    s_cbranch_scc1 L_D15
    s_branch L_disp
L_D24:
    s_mul_i32 s92, s81, 12
    s_add_u32 s92, s92, 24
    v_mov_b32 v5, s92
L_B24:
L_B24_0:
    s_cmp_lt_i32 s84, s82
    s_cbranch_scc1 L_B24_0w
    s_waitcnt vmcnt(23)
    buffer_load_dwordx4 v2, s[4:7], s78 offen offset:0 nt lds
    v_add_u32 v5, 3, v5
    s_add_u32 s81, s81, 1
    s_and_b32 s92, s81, 7
    s_waitcnt vmcnt(23)
    buffer_load_dwordx4 v2, s[4:7], s78 offen offset:1024 nt lds
    v_readlane_b32 s84, v3, 1
    ds_read_b32 v3, v7
    s_lshl_b32 s92, s92, 11
    s_waitcnt vmcnt(23)
    buffer_load_dwordx4 v2, s[4:7], s78 offen offset:2048 nt lds
    ds_write_b32 v6, v5
    s_add_u32 s92, s92, s77
    s_and_b32 s92, s92, 16383
L_B24_1:
    s_cmp_lt_i32 s84, s82
    s_cbranch_scc1 L_B24_1w
    s_waitcnt vmcnt(23)
    buffer_load_dwordx4 v2, s[4:7], s78 offen offset:3072 nt lds
    v_add_u32 v5, 3, v5
    s_add_u32 m0, m0, s85
    s_add_u32 s78, s78, s85
    s_waitcnt vmcnt(23)
    buffer_load_dwordx4 v2, s[4:7], s78 offen offset:0 nt lds
    v_readlane_b32 s84, v3, 2
    ds_read_b32 v3, v7
    s_mul_i32 s80, s92, 768
    s_waitcnt vmcnt(23)
    buffer_load_dwordx4 v2, s[4:7], s78 offen offset:1024 nt lds
    ds_write_b32 v6, v5
    s_bfe_u32 s92, s81, 0x40003
    s_mul_i32 s92, s92, 25165824
L_B24_2:
    s_cmp_lt_i32 s84, s82
    s_cbranch_scc1 L_B24_2w
    s_waitcnt vmcnt(23)
    buffer_load_dwordx4 v2, s[4:7], s78 offen offset:2048 nt lds
    v_add_u32 v5, 3, v5
    s_add_u32 s80, s80, s79
    s_add_u32 s80, s80, s92
    s_waitcnt vmcnt(23)
    buffer_load_dwordx4 v2, s[4:7], s78 offen offset:3072 nt lds
    v_readlane_b32 s84, v3, 3
    ds_read_b32 v3, v7
    s_add_u32 m0, m0, s85
    s_add_u32 s78, s78, s85
    s_waitcnt vmcnt(23)
    buffer_load_dwordx4 v2, s[4:7], s78 offen offset:0 nt lds
    ds_write_b32 v6, v5
    s_and_b32 s86, s81, 3
    s_mul_i32 s86, s86, 12288
L_B24_3:
    s_cmp_lt_i32 s84, s82
    s_cbranch_scc1 L_B24_3w
    s_waitcnt vmcnt(23)
    buffer_load_dwordx4 v2, s[4:7], s78 offen offset:1024 nt lds
    v_add_u32 v5, 3, v5
    v_readlane_b32 s83, v3, 4
    s_waitcnt vmcnt(23)
    buffer_load_dwordx4 v2, s[4:7], s78 offen offset:2048 nt lds
    v_readlane_b32 s84, v3, 0
    ds_read_b32 v3, v7
    s_add_u32 s82, s82, 1
    s_cmp_ge_u32 s81, 255
    s_cselect_b32 s83, -1, s83
    s_cmp_ge_u32 s81, 128
    s_waitcnt vmcnt(23)
    buffer_load_dwordx4 v2, s[4:7], s78 offen offset:3072 nt lds
    ds_write_b32 v6, v5
    s_cselect_b64 s[4:5], s[56:57], s[50:51]
    s_mov_b32 m0, s86
    s_mov_b32 s78, s80
    s_cmp_eq_u32 s83, 24
    s_cbranch_scc1 L_B24
    s_cmp_eq_u32 s83, -1
    s_cbranch_scc1 L_D32
    s_cmp_eq_u32 s83, 23
    s_cbranch_scc1 L_D23
    s_cmp_eq_u32 s83, 25
    s_cbranch_scc1 L_D25
    s_branch L_disp
L_D15:
    s_mul_i32 s92, s81, 12
    s_add_u32 s92, s92, 33
    v_mov_b32 v5, s92
L_B15:
L_B15_0:
    s_cmp_lt_i32 s84, s82
    s_cbranch_scc1 L_B15_0w
    s_waitcnt vmcnt(14)
    buffer_load_dwordx4 v2, s[4:7], s78 offen offset:0 nt lds
    v_add_u32 v5, 3, v5
    s_add_u32 s81, s81, 1
    s_and_b32 s92, s81, 7
    s_waitcnt vmcnt(14)
    buffer_load_dwordx4 v2, s[4:7], s78 offen offset:1024 nt lds
    v_readlane_b32 s84, v3, 1
    ds_read_b32 v3, v7
    s_lshl_b32 s92, s92, 11
    s_waitcnt vmcnt(14)
    buffer_load_dwordx4 v2, s[4:7], s78 offen offset:2048 nt lds
    ds_write_b32 v6, v5
    s_add_u32 s92, s92, s77
    s_and_b32 s92, s92, 16383
L_B15_1:
    s_cmp_lt_i32 s84, s82
    s_cbranch_scc1 L_B15_1w
    s_waitcnt vmcnt(14)
    buffer_load_dwordx4 v2, s[4:7], s78 offen offset:3072 nt lds
    v_add_u32 v5, 3, v5
    s_add_u32 m0, m0, s85
    s_add_u32 s78, s78, s85
    s_waitcnt vmcnt(14)
    buffer_load_dwordx4 v2, s[4:7], s78 offen offset:0 nt lds
    v_readlane_b32 s84, v3, 2
    ds_read_b32 v3, v7
    s_mul_i32 s80, s92, 768
    s_waitcnt vmcnt(14)
    buffer_load_dwordx4 v2, s[4:7], s78 offen offset:1024 nt lds
    ds_write_b32 v6, v5
    s_bfe_u32 s92, s81, 0x40003
    s_mul_i32 s92, s92, 25165824
L_B15_2:
    s_cmp_lt_i32 s84, s82
    s_cbranch_scc1 L_B15_2w
    s_waitcnt vmcnt(14)
    buffer_load_dwordx4 v2, s[4:7], s78 offen offset:2048 nt lds
    v_add_u32 v5, 3, v5
    s_add_u32 s80, s80, s79
    s_add_u32 s80, s80, s92
    s_waitcnt vmcnt(14)
    buffer_load_dwordx4 v2, s[4:7], s78 offen offset:3072 nt lds
    v_readlane_b32 s84, v3, 3
    ds_read_b32 v3, v7
    s_add_u32 m0, m0, s85
    s_add_u32 s78, s78, s85
    s_waitcnt vmcnt(14)
    buffer_load_dwordx4 v2, s[4:7], s78 offen offset:0 nt lds
    ds_write_b32 v6, v5
    s_and_b32 s86, s81, 3
    s_mul_i32 s86, s86, 12288
L_B15_3:
    s_cmp_lt_i32 s84, s82
    s_cbranch_scc1 L_B15_3w
    s_waitcnt vmcnt(14)
    buffer_load_dwordx4 v2, s[4:7], s78 offen offset:1024 nt lds
    v_add_u32 v5, 3, v5
    v_readlane_b32 s83, v3, 4
    s_waitcnt vmcnt(14)
    buffer_load_dwordx4 v2, s[4:7], s78 offen offset:2048 nt lds
    v_readlane_b32 s84, v3, 0
    ds_read_b32 v3, v7
    s_add_u32 s82, s82, 1
    s_cmp_ge_u32 s81, 255
    s_cselect_b32 s83, -1, s83
    s_cmp_ge_u32 s81, 128
    s_waitcnt vmcnt(14)
    buffer_load_dwordx4 v2, s[4:7], s78 offen offset:3072 nt lds
    ds_write_b32 v6, v5
    s_cselect_b64 s[4:5], s[56:57], s[50:51]
    s_mov_b32 m0, s86
    s_mov_b32 s78, s80
    s_cmp_eq_u32 s83, 15
    s_cbranch_scc1 L_B15
    s_cmp_eq_u32 s83, -1
    s_cbranch_scc1 L_D32
    s_cmp_eq_u32 s83, 16
    s_cbranch_scc1 L_D16
    s_branch L_disp
L_D25:
    s_mul_i32 s92, s81, 12
    s_add_u32 s92, s92, 23
    v_mov_b32 v5, s92
L_B25:
L_B25_0:
    s_cmp_lt_i32 s84, s82
    s_cbranch_scc1 L_B25_0w
    s_waitcnt vmcnt(24)
    buffer_load_dwordx4 v2, s[4:7], s78 offen offset:0 nt lds
    v_add_u32 v5, 3, v5
    s_add_u32 s81, s81, 1
    s_and_b32 s92, s81, 7
    s_waitcnt vmcnt(24)
    buffer_load_dwordx4 v2, s[4:7], s78 offen offset:1024 nt lds
    v_readlane_b32 s84, v3, 1
    ds_read_b32 v3, v7
    s_lshl_b32 s92, s92, 11
    s_waitcnt vmcnt(24)
    buffer_load_dwordx4 v2, s[4:7], s78 offen offset:2048 nt lds
    ds_write_b32 v6, v5
    s_add_u32 s92, s92, s77
    s_and_b32 s92, s92, 16383
L_B25_1:
    s_cmp_lt_i32 s84, s82
    s_cbranch_scc1 L_B25_1w
    s_waitcnt vmcnt(24)
    buffer_load_dwordx4 v2, s[4:7], s78 offen offset:3072 nt lds
    v_add_u32 v5, 3, v5
    s_add_u32 m0, m0, s85
    s_add_u32 s78, s78, s85
    s_waitcnt vmcnt(24)
    buffer_load_dwordx4 v2, s[4:7], s78 offen offset:0 nt lds
    v_readlane_b32 s84, v3, 2
    ds_read_b32 v3, v7
    s_mul_i32 s80, s92, 768
    s_waitcnt vmcnt(24)
    buffer_load_dwordx4 v2, s[4:7], s78 offen offset:1024 nt lds
    ds_write_b32 v6, v5
    s_bfe_u32 s92, s81, 0x40003
    s_mul_i32 s92, s92, 25165824
L_B25_2:
    s_cmp_lt_i32 s84, s82
    s_cbranch_scc1 L_B25_2w
    s_waitcnt vmcnt(24)
    buffer_load_dwordx4 v2, s[4:7], s78 offen offset:2048 nt lds
    v_add_u32 v5, 3, v5
    s_add_u32 s80, s80, s79
    s_add_u32 s80, s80, s92
    s_waitcnt vmcnt(24)
    buffer_load_dwordx4 v2, s[4:7], s78 offen offset:3072 nt lds
    v_readlane_b32 s84, v3, 3
    ds_read_b32 v3, v7
    s_add_u32 m0, m0, s85
    s_add_u32 s78, s78, s85
    s_waitcnt vmcnt(24)
    buffer_load_dwordx4 v2, s[4:7], s78 offen offset:0 nt lds
    ds_write_b32 v6, v5
    s_and_b32 s86, s81, 3
    s_mul_i32 s86, s86, 12288
L_B25_3:
    s_cmp_lt_i32 s84, s82
    s_cbranch_scc1 L_B25_3w
    s_waitcnt vmcnt(24)
    buffer_load_dwordx4 v2, s[4:7], s78 offen offset:1024 nt lds
    v_add_u32 v5, 3, v5
    v_readlane_b32 s83, v3, 4
    s_waitcnt vmcnt(24)
    buffer_load_dwordx4 v2, s[4:7], s78 offen offset:2048 nt lds
    v_readlane_b32 s84, v3, 0
    ds_read_b32 v3, v7
    s_add_u32 s82, s82, 1
    s_cmp_ge_u32 s81, 255
    s_cselect_b32 s83, -1, s83
    s_cmp_ge_u32 s81, 128
    s_waitcnt vmcnt(24)
    buffer_load_dwordx4 v2, s[4:7], s78 offen offset:3072 nt lds
    ds_write_b32 v6, v5
    s_cselect_b64 s[4:5], s[56:57], s[50:51]
    s_mov_b32 m0, s86
    s_mov_b32 s78, s80
    s_cmp_eq_u32 s83, 25
    s_cbranch_scc1 L_B25
    s_cmp_eq_u32 s83, -1
    s_cbranch_scc1 L_D32
    s_cmp_eq_u32 s83, 24
    s_cbranch_scc1 L_D24
    s_cmp_eq_u32 s83, 26
    s_cbranch_scc1 L_D26
    s_branch L_disp
L_D26:
    s_mul_i32 s92, s81, 12
    s_add_u32 s92, s92, 22
    v_mov_b32 v5, s92
L_B26:
L_B26_0:
    s_cmp_lt_i32 s84, s82
    s_cbranch_scc1 L_B26_0w
    s_waitcnt vmcnt(25)
    buffer_load_dwordx4 v2, s[4:7], s78 offen offset:0 nt lds
    v_add_u32 v5, 3, v5
    s_add_u32 s81, s81, 1
    s_and_b32 s92, s81, 7
    s_waitcnt vmcnt(25)
    buffer_load_dwordx4 v2, s[4:7], s78 offen offset:1024 nt lds
    v_readlane_b32 s84, v3, 1
    ds_read_b32 v3, v7
    s_lshl_b32 s92, s92, 11
    s_waitcnt vmcnt(25)
    buffer_load_dwordx4 v2, s[4:7], s78 offen offset:2048 nt lds
    ds_write_b32 v6, v5
    s_add_u32 s92, s92, s77
    s_and_b32 s92, s92, 16383
L_B26_1:
    s_cmp_lt_i32 s84, s82
    s_cbranch_scc1 L_B26_1w
    s_waitcnt vmcnt(25)
    buffer_load_dwordx4 v2, s[4:7], s78 offen offset:3072 nt lds
    v_add_u32 v5, 3, v5
    s_add_u32 m0, m0, s85
    s_add_u32 s78, s78, s85
    s_waitcnt vmcnt(25)
    buffer_load_dwordx4 v2, s[4:7], s78 offen offset:0 nt lds
    v_readlane_b32 s84, v3, 2
    ds_read_b32 v3, v7
    s_mul_i32 s80, s92, 768
    s_waitcnt vmcnt(25)
    buffer_load_dwordx4 v2, s[4:7], s78 offen offset:1024 nt lds
    ds_write_b32 v6, v5
    s_bfe_u32 s92, s81, 0x40003
    s_mul_i32 s92, s92, 25165824
L_B26_2:
    s_cmp_lt_i32 s84, s82
    s_cbranch_scc1 L_B26_2w
    s_waitcnt vmcnt(25)
    buffer_load_dwordx4 v2, s[4:7], s78 offen offset:2048 nt lds
    v_add_u32 v5, 3, v5
    s_add_u32 s80, s80, s79
    s_add_u32 s80, s80, s92
    s_waitcnt vmcnt(25)
    buffer_load_dwordx4 v2, s[4:7], s78 offen offset:3072 nt lds
    v_readlane_b32 s84, v3, 3
    ds_read_b32 v3, v7
    s_add_u32 m0, m0, s85
    s_add_u32 s78, s78, s85
    s_waitcnt vmcnt(25)
    buffer_load_dwordx4 v2, s[4:7], s78 offen offset:0 nt lds
    ds_write_b32 v6, v5
    s_and_b32 s86, s81, 3
    s_mul_i32 s86, s86, 12288
L_B26_3:
    s_cmp_lt_i32 s84, s82
    s_cbranch_scc1 L_B26_3w
    s_waitcnt vmcnt(25)
    buffer_load_dwordx4 v2, s[4:7], s78 offen offset:1024 nt lds
    v_add_u32 v5, 3, v5
    v_readlane_b32 s83, v3, 4
    s_waitcnt vmcnt(25)
    buffer_load_dwordx4 v2, s[4:7], s78 offen offset:2048 nt lds
    v_readlane_b32 s84, v3, 0
    ds_read_b32 v3, v7
    s_add_u32 s82, s82, 1
    s_cmp_ge_u32 s81, 255
    s_cselect_b32 s83, -1, s83
    s_cmp_ge_u32 s81, 128
    s_waitcnt vmcnt(25)
    buffer_load_dwordx4 v2, s[4:7], s78 offen offset:3072 nt lds
    ds_write_b32 v6, v5
    s_cselect_b64 s[4:5], s[56:57], s[50:51]
    s_mov_b32 m0, s86
    s_mov_b32 s78, s80
    s_cmp_eq_u32 s83, 26
    s_cbranch_scc1 L_B26
    s_cmp_eq_u32 s83, -1
    s_cbranch_scc1 L_D32
    s_cmp_eq_u32 s83, 25
    s_cbranch_scc1 L_D25
    s_branch L_disp
L_B20_0w:
    ds_read_b32 v3, v7
    s_waitcnt lgkmcnt(0)
    v_readlane_b32 s84, v3, 0
    s_nop 0
    s_branch L_B20_0
L_B20_1w:
    ds_read_b32 v3, v7
    s_waitcnt lgkmcnt(0)
    v_readlane_b32 s84, v3, 1
    s_nop 0
    s_branch L_B20_1
L_B20_2w:
    ds_read_b32 v3, v7
    s_waitcnt lgkmcnt(0)
    v_readlane_b32 s84, v3, 2
    s_nop 0
    s_branch L_B20_2
L_B20_3w:
    ds_read_b32 v3, v7
    s_waitcnt lgkmcnt(0)
    v_readlane_b32 s84, v3, 3
    s_nop 0
    s_branch L_B20_3
L_B19_0w:
    ds_read_b32 v3, v7
    s_waitcnt lgkmcnt(0)
    v_readlane_b32 s84, v3, 0
    s_nop 0
    s_branch L_B19_0
L_B19_1w:
    ds_read_b32 v3, v7
    s_waitcnt lgkmcnt(0)
    v_readlane_b32 s84, v3, 1
    s_nop 0
    s_branch L_B19_1
L_B19_2w:
    ds_read_b32 v3, v7
    s_waitcnt lgkmcnt(0)
    v_readlane_b32 s84, v3, 2
    s_nop 0
    s_branch L_B19_2
L_B19_3w:
    ds_read_b32 v3, v7
    s_waitcnt lgkmcnt(0)
    v_readlane_b32 s84, v3, 3
    s_nop 0
    s_branch L_B19_3
L_B21_0w:
    ds_read_b32 v3, v7
    s_waitcnt lgkmcnt(0)
    v_readlane_b32 s84, v3, 0
    s_nop 0
    s_branch L_B21_0
L_B21_1w:
    ds_read_b32 v3, v7
    s_waitcnt lgkmcnt(0)
    v_readlane_b32 s84, v3, 1
    s_nop 0
    s_branch L_B21_1
L_B21_2w:
    ds_read_b32 v3, v7
    s_waitcnt lgkmcnt(0)
    v_readlane_b32 s84, v3, 2
    s_nop 0
    s_branch L_B21_2
L_B21_3w:
    ds_read_b32 v3, v7
    s_waitcnt lgkmcnt(0)
    v_readlane_b32 s84, v3, 3
    s_nop 0
    s_branch L_B21_3
L_B18_0w:
    ds_read_b32 v3, v7
    s_waitcnt lgkmcnt(0)
    v_readlane_b32 s84, v3, 0
    s_nop 0
    s_branch L_B18_0
L_B18_1w:
    ds_read_b32 v3, v7
    s_waitcnt lgkmcnt(0)
    v_readlane_b32 s84, v3, 1
    s_nop 0
    s_branch L_B18_1
L_B18_2w:
    ds_read_b32 v3, v7
    s_waitcnt lgkmcnt(0)
    v_readlane_b32 s84, v3, 2
    s_nop 0
    s_branch L_B18_2
L_B18_3w:
    ds_read_b32 v3, v7
    s_waitcnt lgkmcnt(0)
    v_readlane_b32 s84, v3, 3
    s_nop 0
    s_branch L_B18_3
L_B22_0w:
    ds_read_b32 v3, v7
    s_waitcnt lgkmcnt(0)
    v_readlane_b32 s84, v3, 0
    s_nop 0
    s_branch L_B22_0
L_B22_1w:
    ds_read_b32 v3, v7
    s_waitcnt lgkmcnt(0)
    v_readlane_b32 s84, v3, 1
    s_nop 0
    s_branch L_B22_1
L_B22_2w:
    ds_read_b32 v3, v7
    s_waitcnt lgkmcnt(0)
    v_readlane_b32 s84, v3, 2
    s_nop 0
    s_branch L_B22_2
L_B22_3w:
    ds_read_b32 v3, v7
    s_waitcnt lgkmcnt(0)
    v_readlane_b32 s84, v3, 3
    s_nop 0
    s_branch L_B22_3
L_B17_0w:
    ds_read_b32 v3, v7
    s_waitcnt lgkmcnt(0)
    v_readlane_b32 s84, v3, 0
    s_nop 0
    s_branch L_B17_0
L_B17_1w:
    ds_read_b32 v3, v7
    s_waitcnt lgkmcnt(0)
    v_readlane_b32 s84, v3, 1
    s_nop 0
    s_branch L_B17_1
L_B17_2w:
    ds_read_b32 v3, v7
    s_waitcnt lgkmcnt(0)
    v_readlane_b32 s84, v3, 2
    s_nop 0
    s_branch L_B17_2
L_B17_3w:
    ds_read_b32 v3, v7
    s_waitcnt lgkmcnt(0)
    v_readlane_b32 s84, v3, 3
    s_nop 0
    s_branch L_B17_3
L_B23_0w:
    ds_read_b32 v3, v7
    s_waitcnt lgkmcnt(0)
    v_readlane_b32 s84, v3, 0
    s_nop 0
    s_branch L_B23_0
L_B23_1w:
    ds_read_b32 v3, v7
    s_waitcnt lgkmcnt(0)
    v_readlane_b32 s84, v3, 1
    s_nop 0
    s_branch L_B23_1
L_B23_2w:
    ds_read_b32 v3, v7
    s_waitcnt lgkmcnt(0)
    v_readlane_b32 s84, v3, 2
    s_nop 0
    s_branch L_B23_2
L_B23_3w:
    ds_read_b32 v3, v7
    s_waitcnt lgkmcnt(0)
    v_readlane_b32 s84, v3, 3
    s_nop 0
    s_branch L_B23_3
L_B16_0w:
    ds_read_b32 v3, v7
    s_waitcnt lgkmcnt(0)
    v_readlane_b32 s84, v3, 0
    s_nop 0
    s_branch L_B16_0
L_B16_1w:
    ds_read_b32 v3, v7
    s_waitcnt lgkmcnt(0)
    v_readlane_b32 s84, v3, 1
    s_nop 0
    s_branch L_B16_1
L_B16_2w:
    ds_read_b32 v3, v7
    s_waitcnt lgkmcnt(0)
    v_readlane_b32 s84, v3, 2
    s_nop 0
    s_branch L_B16_2
L_B16_3w:
    ds_read_b32 v3, v7
    s_waitcnt lgkmcnt(0)
    v_readlane_b32 s84, v3, 3
    s_nop 0
    s_branch L_B16_3
L_B24_0w:
    ds_read_b32 v3, v7
    s_waitcnt lgkmcnt(0)
    v_readlane_b32 s84, v3, 0
    s_nop 0
    s_branch L_B24_0
L_B24_1w:
    ds_read_b32 v3, v7
    s_waitcnt lgkmcnt(0)
    v_readlane_b32 s84, v3, 1
    s_nop 0
    s_branch L_B24_1
L_B24_2w:
    ds_read_b32 v3, v7
    s_waitcnt lgkmcnt(0)
    v_readlane_b32 s84, v3, 2
    s_nop 0
    s_branch L_B24_2
L_B24_3w:
    ds_read_b32 v3, v7
    s_waitcnt lgkmcnt(0)
    v_readlane_b32 s84, v3, 3
    s_nop 0
    s_branch L_B24_3
L_B15_0w:
    ds_read_b32 v3, v7
    s_waitcnt lgkmcnt(0)
    v_readlane_b32 s84, v3, 0
    s_nop 0
    s_branch L_B15_0
L_B15_1w:
    ds_read_b32 v3, v7
    s_waitcnt lgkmcnt(0)
    v_readlane_b32 s84, v3, 1
    s_nop 0
    s_branch L_B15_1
L_B15_2w:
    ds_read_b32 v3, v7
    s_waitcnt lgkmcnt(0)
    v_readlane_b32 s84, v3, 2
    s_nop 0
    s_branch L_B15_2
L_B15_3w:
    ds_read_b32 v3, v7
    s_waitcnt lgkmcnt(0)
    v_readlane_b32 s84, v3, 3
    s_nop 0
    s_branch L_B15_3
L_B25_0w:
    ds_read_b32 v3, v7
    s_waitcnt lgkmcnt(0)
    v_readlane_b32 s84, v3, 0
    s_nop 0
    s_branch L_B25_0
L_B25_1w:
    ds_read_b32 v3, v7
    s_waitcnt lgkmcnt(0)
    v_readlane_b32 s84, v3, 1
    s_nop 0
    s_branch L_B25_1
L_B25_2w:
    ds_read_b32 v3, v7
    s_waitcnt lgkmcnt(0)
    v_readlane_b32 s84, v3, 2
    s_nop 0
    s_branch L_B25_2
L_B25_3w:
    ds_read_b32 v3, v7
    s_waitcnt lgkmcnt(0)
    v_readlane_b32 s84, v3, 3
    s_nop 0
    s_branch L_B25_3
L_B26_0w:
    ds_read_b32 v3, v7
    s_waitcnt lgkmcnt(0)
    v_readlane_b32 s84, v3, 0
    s_nop 0
    s_branch L_B26_0
L_B26_1w:
    ds_read_b32 v3, v7
    s_waitcnt lgkmcnt(0)
    v_readlane_b32 s84, v3, 1
    s_nop 0
    s_branch L_B26_1
L_B26_2w:
    ds_read_b32 v3, v7
    s_waitcnt lgkmcnt(0)
    v_readlane_b32 s84, v3, 2
    s_nop 0
    s_branch L_B26_2
L_B26_3w:
    ds_read_b32 v3, v7
    s_waitcnt lgkmcnt(0)
    v_readlane_b32 s84, v3, 3
    s_nop 0
    s_branch L_B26_3
L_B32_0w:
    ds_read_b32 v3, v7
    s_waitcnt lgkmcnt(0)
    v_readlane_b32 s84, v3, 0
    s_nop 0
    s_branch L_B32_0
L_B32_1w:
    ds_read_b32 v3, v7
    s_waitcnt lgkmcnt(0)
    v_readlane_b32 s84, v3, 1
    s_nop 0
    s_branch L_B32_1
L_B32_2w:
    ds_read_b32 v3, v7
    s_waitcnt lgkmcnt(0)
    v_readlane_b32 s84, v3, 2
    s_nop 0
    s_branch L_B32_2
L_B32_3w:
    ds_read_b32 v3, v7
    s_waitcnt lgkmcnt(0)
    v_readlane_b32 s84, v3, 3
    s_nop 0
    s_branch L_B32_3
L_tail:
L_D32:
    s_mul_i32 s92, s81, 12
    s_add_u32 s92, s92, 16
    v_mov_b32 v5, s92
L_B32:
L_B32_0:
    s_cmp_lt_i32 s84, s82
    s_cbranch_scc1 L_B32_0w
    s_waitcnt vmcnt(31)
    buffer_load_dwordx4 v2, s[4:7], s78 offen offset:0 nt lds
    v_add_u32 v5, 3, v5
    s_add_u32 s81, s81, 1
    s_and_b32 s92, s81, 7
    s_waitcnt vmcnt(31)
    buffer_load_dwordx4 v2, s[4:7], s78 offen offset:1024 nt lds
    v_readlane_b32 s84, v3, 1
    ds_read_b32 v3, v7
    s_lshl_b32 s92, s92, 11
    s_waitcnt vmcnt(31)
    buffer_load_dwordx4 v2, s[4:7], s78 offen offset:2048 nt lds
    ds_write_b32 v6, v5
    s_add_u32 s92, s92, s77
    s_and_b32 s92, s92, 16383
L_B32_1:
    s_cmp_lt_i32 s84, s82
    s_cbranch_scc1 L_B32_1w
    s_waitcnt vmcnt(31)
    buffer_load_dwordx4 v2, s[4:7], s78 offen offset:3072 nt lds
    v_add_u32 v5, 3, v5
    s_add_u32 m0, m0, s85
    s_add_u32 s78, s78, s85
    s_waitcnt vmcnt(31)
    buffer_load_dwordx4 v2, s[4:7], s78 offen offset:0 nt lds
    v_readlane_b32 s84, v3, 2
    ds_read_b32 v3, v7
    s_mul_i32 s80, s92, 768
    s_waitcnt vmcnt(31)
    buffer_load_dwordx4 v2, s[4:7], s78 offen offset:1024 nt lds
    ds_write_b32 v6, v5
    s_bfe_u32 s92, s81, 0x40003
    s_mul_i32 s92, s92, 25165824
L_B32_2:
    s_cmp_lt_i32 s84, s82
    s_cbranch_scc1 L_B32_2w
    s_waitcnt vmcnt(31)
    buffer_load_dwordx4 v2, s[4:7], s78 offen offset:2048 nt lds
    v_add_u32 v5, 3, v5
    s_add_u32 s80, s80, s79
    s_add_u32 s80, s80, s92
    s_waitcnt vmcnt(31)
    buffer_load_dwordx4 v2, s[4:7], s78 offen offset:3072 nt lds
    v_readlane_b32 s84, v3, 3
    ds_read_b32 v3, v7
    s_add_u32 m0, m0, s85
    s_add_u32 s78, s78, s85
    s_waitcnt vmcnt(31)
    buffer_load_dwordx4 v2, s[4:7], s78 offen offset:0 nt lds
    ds_write_b32 v6, v5
    s_and_b32 s86, s81, 3
    s_mul_i32 s86, s86, 12288
L_B32_3:
    s_cmp_lt_i32 s84, s82
    s_cbranch_scc1 L_B32_3w
    s_waitcnt vmcnt(31)
    buffer_load_dwordx4 v2, s[4:7], s78 offen offset:1024 nt lds
    v_add_u32 v5, 3, v5
    v_readlane_b32 s83, v3, 4
    s_waitcnt vmcnt(31)
    buffer_load_dwordx4 v2, s[4:7], s78 offen offset:2048 nt lds
    v_readlane_b32 s84, v3, 0
    ds_read_b32 v3, v7
    s_add_u32 s82, s82, 1
    s_cmp_eq_u32 s81, 256
    s_cselect_b32 s83, -1, 32
    s_cmp_ge_u32 s81, 128
    s_waitcnt vmcnt(31)
    buffer_load_dwordx4 v2, s[4:7], s78 offen offset:3072 nt lds
    ds_write_b32 v6, v5
    s_cselect_b64 s[4:5], s[56:57], s[50:51]
    s_mov_b32 m0, s86
    s_mov_b32 s78, s80
    s_cmp_eq_u32 s83, 32
    s_cbranch_scc1 L_B32
L_drain:
    v_mov_b32 v18, 3090
    s_waitcnt vmcnt(30)
    ds_write_b32 v6, v18
    v_mov_b32 v18, 3093
    s_waitcnt vmcnt(27)
    ds_write_b32 v6, v18
    v_mov_b32 v18, 3096
    s_waitcnt vmcnt(24)
    ds_write_b32 v6, v18
    v_mov_b32 v18, 3099
    s_waitcnt vmcnt(21)
    ds_write_b32 v6, v18
    v_mov_b32 v18, 3102
    s_waitcnt vmcnt(18)
    ds_write_b32 v6, v18
    v_mov_b32 v18, 3105
    s_waitcnt vmcnt(15)
    ds_write_b32 v6, v18
    v_mov_b32 v18, 3108
    s_waitcnt vmcnt(12)
    ds_write_b32 v6, v18
    v_mov_b32 v18, 3111
    s_waitcnt vmcnt(9)
    ds_write_b32 v6, v18
    v_mov_b32 v18, 3114
    s_waitcnt vmcnt(6)
    ds_write_b32 v6, v18
    v_mov_b32 v18, 3117
    s_waitcnt vmcnt(3)
    ds_write_b32 v6, v18
    v_mov_b32 v18, 3120
    s_waitcnt vmcnt(0)
    ds_write_b32 v6, v18
    s_waitcnt lgkmcnt(0)
    s_endpgm
L_other:
    s_cmp_eq_u32 s76, 5
    s_cbranch_scc1 L_helper
    s_sub_u32 s78, s76, 1
    v_lshlrev_b32 v44, 3, v1
    v_cmp_gt_u32 vcc, 24, v1
    v_mov_b32 v23, 0xffffff40
    v_mov_b32 v18, 192
    v_cndmask_b32 v23, v23, v18, vcc
    v_add_u32 v45, v44, v23
    v_mov_b32 v18, 0x80008000
    v_cndmask_b32 v46, 0, v18, vcc
    v_lshrrev_b32 v19, 4, v1
    v_and_b32 v23, 15, v1
    v_mul_u32_u24 v20, 384, v19
    v_lshl_add_u32 v20, v23, 3, v20
    v_cmp_lt_u32 s[86:87], 7, v23
    v_mov_b32 v21, -64
    v_mov_b32 v18, 320
    v_cndmask_b32 v21, v18, v21, s[86:87]
    v_add_u32 v21, v20, v21
    s_lshl2_add_u32 s95, s78, s3
    s_mul_i32 s95, s95, 384
    s_lshl2_add_u32 s89, s78, s77
    s_xor_b32 s89, s89, 8192
    s_mov_b32 s34, 12288
    s_mov_b32 s35, 0x20000
    s_mov_b32 s38, 384
    s_mov_b32 s39, 0x20000
    s_mov_b32 s42, 384
    s_mov_b32 s43, 0x20000
    s_mov_b32 s14, 6291456
    s_mov_b32 s15, 0x20000
    s_mov_b32 s18, 6291456
    s_mov_b32 s19, 0x20000
    s_waitcnt lgkmcnt(0)
    s_mov_b64 s[32:33], s[48:49]
    s_mov_b64 s[36:37], s[62:63]
    s_mov_b64 s[40:41], s[64:65]
    buffer_load_dwordx2 v[24:25], v44, s[32:35], s95 offen
    buffer_load_dwordx2 v[26:27], v45, s[32:35], s95 offen
    buffer_load_dwordx2 v[28:29], v44, s[32:35], s95 offen offset:768
    buffer_load_dwordx2 v[30:31], v45, s[32:35], s95 offen offset:768
    buffer_load_dwordx2 v[40:41], v44, s[36:39], 0 offen
    buffer_load_dwordx2 v[42:43], v44, s[40:43], 0 offen
    s_mov_b64 s[12:13], s[66:67]
    s_mov_b64 s[16:17], s[68:69]
    s_barrier
    s_mov_b32 s83, 0x05040100
    s_mov_b32 s84, 0x07060302
    s_mul_i32 s92, s78, 3072
    v_lshl_add_u32 v2, v20, 1, s92
    v_add_u32 v12, s92, v20
    v_add_u32 v13, s92, v21
    s_lshl_b32 s92, s78, 5
    s_add_u32 s92, s92, 49152
    v_lshl_add_u32 v3, v19, 3, s92
    v_lshrrev_b32 v18, 3, v23
    v_lshl_add_u32 v4, v18, 7, v3
    v_lshlrev_b32 v9, 4, v23
    v_add_u32 v9, 65536, v9
    s_lshl2_add_u32 s92, s78, 77824
    v_mov_b32 v5, s92
    v_mov_b32 v6, 0
    v_mov_b32 v8, 1
    s_mul_i32 s79, s78, 3
    s_sub_u32 s79, s79, 9
    s_mov_b32 s80, 0
    s_mov_b32 s81, 0
    s_mul_i32 s92, s78, 1536
    s_add_u32 s92, s92, 65536
    v_lshl_add_u32 v14, v44, 1, s92
    v_lshl_add_u32 v16, v45, 1, s92
    s_waitcnt vmcnt(0)
    v_xor_b32 v42, v42, v46
    v_xor_b32 v43, v43, v46
    v_lshlrev_b32 v48, 16, v40
    v_and_b32 v49, 0xffff0000, v40
    v_lshlrev_b32 v50, 16, v41
    v_and_b32 v51, 0xffff0000, v41
    v_lshlrev_b32 v52, 16, v42
    v_and_b32 v53, 0xffff0000, v42
    v_lshlrev_b32 v54, 16, v43
    v_and_b32 v55, 0xffff0000, v43
    v_and_b32 v46, 0x80000000, v46
    s_mov_b32 exec_hi, 0xffff
    v_lshlrev_b32 v56, 16, v24
    v_and_b32 v57, 0xffff0000, v24
    v_lshlrev_b32 v58, 16, v25
    v_and_b32 v59, 0xffff0000, v25
    v_lshlrev_b32 v60, 16, v26
    v_and_b32 v61, 0xffff0000, v26
    v_lshlrev_b32 v62, 16, v27
    v_and_b32 v63, 0xffff0000, v27
    v_pk_mul_f32 v[56:57], v[56:57], v[48:49]
    v_pk_mul_f32 v[60:61], v[60:61], v[52:53]
    v_pk_mul_f32 v[58:59], v[58:59], v[50:51]
    v_pk_mul_f32 v[62:63], v[62:63], v[54:55]
    v_cvt_pk_bf16_f32 v56, v56, v60
    v_cvt_pk_bf16_f32 v57, v57, v61
    v_cvt_pk_bf16_f32 v58, v58, v62
    v_cvt_pk_bf16_f32 v59, v59, v63
    v_and_b32 v60, 0xffff0000, v56
    v_lshlrev_b32 v56, 16, v56
    v_and_b32 v61, 0xffff0000, v57
    v_lshlrev_b32 v57, 16, v57
    v_and_b32 v62, 0xffff0000, v58
    v_lshlrev_b32 v58, 16, v58
    v_and_b32 v63, 0xffff0000, v59
    v_lshlrev_b32 v59, 16, v59
    v_pk_add_f32 v[56:57], v[56:57], v[60:61]
    v_pk_add_f32 v[58:59], v[58:59], v[62:63]
    v_cvt_pk_bf16_f32 v64, v56, v56
    v_cvt_pk_bf16_f32 v65, v57, v57
    v_cvt_pk_bf16_f32 v66, v58, v58
    v_cvt_pk_bf16_f32 v67, v59, v59
    v_xor_b32 v64, v64, v46
    v_xor_b32 v65, v65, v46
    v_xor_b32 v66, v66, v46
    v_xor_b32 v67, v67, v46
    ds_write_b16 v14, v64 offset:0
    ds_write_b16_d16_hi v16, v64 offset:2
    ds_write_b16 v14, v65 offset:4
    ds_write_b16_d16_hi v16, v65 offset:6
    ds_write_b16 v14, v66 offset:8
    ds_write_b16_d16_hi v16, v66 offset:10
    ds_write_b16 v14, v67 offset:12
    ds_write_b16_d16_hi v16, v67 offset:14
    v_lshlrev_b32 v56, 16, v28
    v_and_b32 v57, 0xffff0000, v28
    v_lshlrev_b32 v58, 16, v29
    v_and_b32 v59, 0xffff0000, v29
    v_lshlrev_b32 v60, 16, v30
    v_and_b32 v61, 0xffff0000, v30
    v_lshlrev_b32 v62, 16, v31
    v_and_b32 v63, 0xffff0000, v31
    v_pk_mul_f32 v[56:57], v[56:57], v[48:49]
    v_pk_mul_f32 v[60:61], v[60:61], v[52:53]
    v_pk_mul_f32 v[58:59], v[58:59], v[50:51]
    v_pk_mul_f32 v[62:63], v[62:63], v[54:55]
    v_cvt_pk_bf16_f32 v56, v56, v60
    v_cvt_pk_bf16_f32 v57, v57, v61
    v_cvt_pk_bf16_f32 v58, v58, v62
    v_cvt_pk_bf16_f32 v59, v59, v63
    v_and_b32 v60, 0xffff0000, v56
    v_lshlrev_b32 v56, 16, v56
    v_and_b32 v61, 0xffff0000, v57
    v_lshlrev_b32 v57, 16, v57
    v_and_b32 v62, 0xffff0000, v58
    v_lshlrev_b32 v58, 16, v58
    v_and_b32 v63, 0xffff0000, v59
    v_lshlrev_b32 v59, 16, v59
    v_pk_add_f32 v[56:57], v[56:57], v[60:61]
    v_pk_add_f32 v[58:59], v[58:59], v[62:63]
    v_cvt_pk_bf16_f32 v68, v56, v56
    v_cvt_pk_bf16_f32 v69, v57, v57
    v_cvt_pk_bf16_f32 v70, v58, v58
    v_cvt_pk_bf16_f32 v71, v59, v59
    v_xor_b32 v68, v68, v46
    v_xor_b32 v69, v69, v46
    v_xor_b32 v70, v70, v46
    v_xor_b32 v71, v71, v46
    ds_write_b16 v14, v68 offset:768
    ds_write_b16_d16_hi v16, v68 offset:770
    ds_write_b16 v14, v69 offset:772
    ds_write_b16_d16_hi v16, v69 offset:774
    ds_write_b16 v14, v70 offset:776
    ds_write_b16_d16_hi v16, v70 offset:778
    ds_write_b16 v14, v71 offset:780
    ds_write_b16_d16_hi v16, v71 offset:782
    s_mov_b32 exec_hi, -1
    ds_write_b32 v5, v8 offset:160
    s_add_u32 s79, s79, 12
    s_cmp_ge_i32 s80, s79
    s_cbranch_scc1 L_cr0g
L_cr0:
    ds_read_b32 v19, v7
    s_sleep 1
    s_waitcnt lgkmcnt(0)
    v_readlane_b32 s80, v19, 5
    s_nop 0
    s_cmp_lt_i32 s80, s79
    s_cbranch_scc1 L_cr0
L_cr0g:
    ds_read_b64 v[72:73], v12 offset:0
    ds_read_b64 v[76:77], v12 offset:128
    ds_read_b64 v[80:81], v12 offset:256
    ds_read_b64 v[84:85], v12 offset:1536
    ds_read_b64 v[88:89], v12 offset:1664
    ds_read_b64 v[92:93], v12 offset:1792
    v_add_u32 v6, 1, v6
    ds_write_b32 v5, v6
    s_add_u32 s79, s79, 12
    s_cmp_ge_i32 s80, s79
    s_cbranch_scc1 L_cr1g
L_cr1:
    ds_read_b32 v19, v7
    s_sleep 1
    s_waitcnt lgkmcnt(0)
    v_readlane_b32 s80, v19, 5
    s_nop 0
    s_cmp_lt_i32 s80, s79
    s_cbranch_scc1 L_cr1
L_cr1g:
    ds_read_b64 v[74:75], v12 offset:12480
    ds_read_b64 v[78:79], v13 offset:12288
    ds_read_b64 v[82:83], v12 offset:12352
    ds_read_b64 v[86:87], v12 offset:14016
    ds_read_b64 v[90:91], v13 offset:13824
    ds_read_b64 v[94:95], v12 offset:13888
    v_add_u32 v6, 1, v6
    ds_write_b32 v5, v6
    s_mul_i32 s82, s89, 384
    s_add_u32 s89, s89, 2048
    s_and_b32 s89, s89, 16383
    buffer_load_dwordx2 v[120:121], v20, s[12:15], s82 offen offset:0
    buffer_load_dwordx2 v[122:123], v20, s[16:19], s82 offen offset:192
    buffer_load_dwordx2 v[124:125], v20, s[12:15], s82 offen offset:128
    buffer_load_dwordx2 v[126:127], v21, s[16:19], s82 offen
    buffer_load_dwordx2 v[128:129], v20, s[12:15], s82 offen offset:256
    buffer_load_dwordx2 v[130:131], v20, s[16:19], s82 offen offset:64
    s_add_u32 s79, s79, 12
    s_cmp_ge_i32 s80, s79
    s_cbranch_scc1 L_cr2g
L_cr2:
    ds_read_b32 v19, v7
    s_sleep 1
    s_waitcnt lgkmcnt(0)
    v_readlane_b32 s80, v19, 5
    s_nop 0
    s_cmp_lt_i32 s80, s79
    s_cbranch_scc1 L_cr2
L_cr2g:
    ds_read_b64 v[96:97], v12 offset:24576
    ds_read_b64 v[100:101], v12 offset:24704
    ds_read_b64 v[104:105], v12 offset:24832
    ds_read_b64 v[108:109], v12 offset:26112
    ds_read_b64 v[112:113], v12 offset:26240
    ds_read_b64 v[116:117], v12 offset:26368
    v_add_u32 v6, 1, v6
    ds_write_b32 v5, v6
    s_add_u32 s79, s79, 12
    s_cmp_ge_i32 s80, s79
    s_cbranch_scc1 L_cr3g
L_cr3:
    ds_read_b32 v19, v7
    s_sleep 1
    s_waitcnt lgkmcnt(0)
    v_readlane_b32 s80, v19, 5
    s_nop 0
    s_cmp_lt_i32 s80, s79
    s_cbranch_scc1 L_cr3
L_cr3g:
    ds_read_b64 v[98:99], v12 offset:37056
    ds_read_b64 v[102:103], v13 offset:36864
    ds_read_b64 v[106:107], v12 offset:36928
    ds_read_b64 v[110:111], v12 offset:38592
    ds_read_b64 v[114:115], v13 offset:38400
    ds_read_b64 v[118:119], v12 offset:38464
    v_add_u32 v6, 1, v6
    ds_write_b32 v5, v6
    s_mul_i32 s82, s89, 384
    s_add_u32 s89, s89, 2048
    s_and_b32 s89, s89, 16383
    buffer_load_dwordx2 v[132:133], v20, s[12:15], s82 offen offset:0
    buffer_load_dwordx2 v[134:135], v20, s[16:19], s82 offen offset:192
    buffer_load_dwordx2 v[136:137], v20, s[12:15], s82 offen offset:128
    buffer_load_dwordx2 v[138:139], v21, s[16:19], s82 offen
    buffer_load_dwordx2 v[140:141], v20, s[12:15], s82 offen offset:256
    buffer_load_dwordx2 v[142:143], v20, s[16:19], s82 offen offset:64
L_kph:
    s_lshr_b32 s94, s81, 1
    s_add_u32 s88, s94, 40
    s_lshl2_add_u32 s92, s94, 77888
    v_mov_b32 v22, s92
    s_nop 1
L_kw:
    ds_read_b32 v19, v7
    ds_read_b128 v[48:51], v9 offset:0
    ds_read_b128 v[52:55], v9 offset:256
    ds_read_b128 v[56:59], v9 offset:512
    s_waitcnt lgkmcnt(0)
    v_readlane_b32 s92, v19, s88
    v_readlane_b32 s93, v19, 12
    s_cmp_eq_u32 s92, 0
    s_nop 3
    s_cbranch_scc1 L_kw
    s_cmp_le_u32 s93, s94
    s_cbranch_scc1 L_kw
    v_add_u32 v9, 768, v9
    s_cmp_lg_u32 s81, 0
    s_nop 0
    s_cbranch_scc1 L_ncs0
    v_perm_b32 v36, v74, v72, s83
    v_perm_b32 v74, v74, v72, s84
    v_perm_b32 v37, v75, v73, s83
    v_perm_b32 v75, v75, v73, s84
    v_perm_b32 v38, v78, v76, s83
    v_perm_b32 v78, v78, v76, s84
    v_perm_b32 v39, v79, v77, s83
    v_perm_b32 v79, v79, v77, s84
    v_perm_b32 v40, v82, v80, s83
    v_perm_b32 v82, v82, v80, s84
    v_perm_b32 v41, v83, v81, s83
    v_perm_b32 v83, v83, v81, s84
    v_mov_b64 v[72:73], v[36:37]
    v_mov_b64 v[76:77], v[38:39]
    v_mov_b64 v[80:81], v[40:41]
    s_nop 1
L_ncs0:
    v_dot2_f32_bf16 v36, v72, v48, 0
    v_dot2_f32_bf16 v37, v74, v49, 0
    v_dot2_f32_bf16 v38, v73, v50, 0
    v_dot2_f32_bf16 v39, v75, v51, 0
    v_dot2_f32_bf16 v40, v76, v52, 0
    v_dot2_f32_bf16 v41, v78, v53, 0
    v_dot2_f32_bf16 v42, v77, v54, 0
    v_dot2_f32_bf16 v43, v79, v55, 0
    v_dot2_f32_bf16 v44, v80, v56, 0
    v_dot2_f32_bf16 v45, v82, v57, 0
    v_dot2_f32_bf16 v46, v81, v58, 0
    v_dot2_f32_bf16 v47, v83, v59, 0
    s_add_u32 s79, s79, 12
    s_cmp_ge_i32 s80, s79
    s_cbranch_scc1 L_kr0g
L_kr0:
    ds_read_b32 v19, v7
    s_sleep 1
    s_waitcnt lgkmcnt(0)
    v_readlane_b32 s80, v19, 5
    s_nop 0
    s_cmp_lt_i32 s80, s79
    s_cbranch_scc1 L_kr0
L_kr0g:
    ds_read_b32 v10, v3 offset:0
    ds_read_b128 v[24:27], v2 offset:0
    ds_read_b128 v[28:31], v2 offset:256
    ds_read_b128 v[32:35], v2 offset:512
    v_add_u32 v6, 1, v6
    ds_write_b32 v5, v6
    s_waitcnt lgkmcnt(3)
    v_and_b32 v12, 0xffff0000, v10
    v_cvt_f32_i32 v24, v24
    v_cvt_f32_i32 v25, v25
    v_cvt_f32_i32 v26, v26
    v_cvt_f32_i32 v27, v27
    v_pk_add_f32 v[24:25], v[24:25], v[12:13] op_sel:[0,0] op_sel_hi:[1,0] neg_lo:[0,1] neg_hi:[0,1]
    v_pk_add_f32 v[26:27], v[26:27], v[12:13] op_sel:[0,0] op_sel_hi:[1,0] neg_lo:[0,1] neg_hi:[0,1]
    v_pk_mul_f32 v[14:15], v[24:25], v[36:37]
    v_pk_fma_f32 v[14:15], v[26:27], v[38:39], v[14:15]
    s_waitcnt lgkmcnt(2)
    v_cvt_f32_i32 v28, v28
    v_cvt_f32_i32 v29, v29
    v_cvt_f32_i32 v30, v30
    v_cvt_f32_i32 v31, v31
    v_pk_add_f32 v[28:29], v[28:29], v[12:13] op_sel:[0,0] op_sel_hi:[1,0] neg_lo:[0,1] neg_hi:[0,1]
    v_pk_add_f32 v[30:31], v[30:31], v[12:13] op_sel:[0,0] op_sel_hi:[1,0] neg_lo:[0,1] neg_hi:[0,1]
    v_pk_fma_f32 v[14:15], v[28:29], v[40:41], v[14:15]
    v_pk_fma_f32 v[14:15], v[30:31], v[42:43], v[14:15]
    s_waitcnt lgkmcnt(1)
    v_cvt_f32_i32 v32, v32
    v_cvt_f32_i32 v33, v33
    v_cvt_f32_i32 v34, v34
    v_cvt_f32_i32 v35, v35
    v_pk_add_f32 v[32:33], v[32:33], v[12:13] op_sel:[0,0] op_sel_hi:[1,0] neg_lo:[0,1] neg_hi:[0,1]
    v_pk_add_f32 v[34:35], v[34:35], v[12:13] op_sel:[0,0] op_sel_hi:[1,0] neg_lo:[0,1] neg_hi:[0,1]
    v_pk_fma_f32 v[14:15], v[32:33], v[44:45], v[14:15]
    v_pk_fma_f32 v[14:15], v[34:35], v[46:47], v[14:15]
    v_add_f32 v14, v14, v15
    s_nop 1
    v_add_f32_dpp v18, v14, v14 row_ror:8 row_mask:0xf bank_mask:0x3
    s_cmp_lg_u32 s81, 0
    s_nop 0
    s_cbranch_scc1 L_ncs1
    s_mul_i32 s82, s89, 384
    s_add_u32 s89, s89, 2048
    s_and_b32 s89, s89, 16383
    buffer_load_dwordx2 v[144:145], v20, s[12:15], s82 offen offset:0
    buffer_load_dwordx2 v[146:147], v20, s[16:19], s82 offen offset:192
    buffer_load_dwordx2 v[148:149], v20, s[12:15], s82 offen offset:128
    buffer_load_dwordx2 v[150:151], v21, s[16:19], s82 offen
    buffer_load_dwordx2 v[152:153], v20, s[12:15], s82 offen offset:256
    buffer_load_dwordx2 v[154:155], v20, s[16:19], s82 offen offset:64
    v_perm_b32 v36, v86, v84, s83
    v_perm_b32 v86, v86, v84, s84
    v_perm_b32 v37, v87, v85, s83
    v_perm_b32 v87, v87, v85, s84
    v_perm_b32 v38, v90, v88, s83
    v_perm_b32 v90, v90, v88, s84
    v_perm_b32 v39, v91, v89, s83
    v_perm_b32 v91, v91, v89, s84
    v_perm_b32 v40, v94, v92, s83
    v_perm_b32 v94, v94, v92, s84
    v_perm_b32 v41, v95, v93, s83
    v_perm_b32 v95, v95, v93, s84
    v_mov_b64 v[84:85], v[36:37]
    v_mov_b64 v[88:89], v[38:39]
    v_mov_b64 v[92:93], v[40:41]
    s_nop 1
L_ncs1:
    v_dot2_f32_bf16 v36, v84, v48, 0
    v_dot2_f32_bf16 v37, v86, v49, 0
    v_dot2_f32_bf16 v38, v85, v50, 0
    v_dot2_f32_bf16 v39, v87, v51, 0
    v_dot2_f32_bf16 v40, v88, v52, 0
    v_dot2_f32_bf16 v41, v90, v53, 0
    v_dot2_f32_bf16 v42, v89, v54, 0
    v_dot2_f32_bf16 v43, v91, v55, 0
    v_dot2_f32_bf16 v44, v92, v56, 0
    v_dot2_f32_bf16 v45, v94, v57, 0
    v_dot2_f32_bf16 v46, v93, v58, 0
    v_dot2_f32_bf16 v47, v95, v59, 0
    s_add_u32 s79, s79, 12
    s_cmp_ge_i32 s80, s79
    s_cbranch_scc1 L_kr1g
L_kr1:
    ds_read_b32 v19, v7
    s_sleep 1
    s_waitcnt lgkmcnt(0)
    v_readlane_b32 s80, v19, 5
    s_nop 0
    s_cmp_lt_i32 s80, s79
    s_cbranch_scc1 L_kr1
L_kr1g:
    ds_read_b32 v11, v3 offset:128
    ds_read_b128 v[24:27], v2 offset:12288
    ds_read_b128 v[28:31], v2 offset:12544
    ds_read_b128 v[32:35], v2 offset:12800
    v_add_u32 v6, 1, v6
    ds_write_b32 v5, v6
    s_waitcnt lgkmcnt(3)
    v_and_b32 v12, 0xffff0000, v11
    v_cvt_f32_i32 v24, v24
    v_cvt_f32_i32 v25, v25
    v_cvt_f32_i32 v26, v26
    v_cvt_f32_i32 v27, v27
    v_pk_add_f32 v[24:25], v[24:25], v[12:13] op_sel:[0,0] op_sel_hi:[1,0] neg_lo:[0,1] neg_hi:[0,1]
    v_pk_add_f32 v[26:27], v[26:27], v[12:13] op_sel:[0,0] op_sel_hi:[1,0] neg_lo:[0,1] neg_hi:[0,1]
    v_pk_mul_f32 v[16:17], v[24:25], v[36:37]
    v_pk_fma_f32 v[16:17], v[26:27], v[38:39], v[16:17]
    s_waitcnt lgkmcnt(2)
    v_cvt_f32_i32 v28, v28
    v_cvt_f32_i32 v29, v29
    v_cvt_f32_i32 v30, v30
    v_cvt_f32_i32 v31, v31
    v_pk_add_f32 v[28:29], v[28:29], v[12:13] op_sel:[0,0] op_sel_hi:[1,0] neg_lo:[0,1] neg_hi:[0,1]
    v_pk_add_f32 v[30:31], v[30:31], v[12:13] op_sel:[0,0] op_sel_hi:[1,0] neg_lo:[0,1] neg_hi:[0,1]
    v_pk_fma_f32 v[16:17], v[28:29], v[40:41], v[16:17]
    v_pk_fma_f32 v[16:17], v[30:31], v[42:43], v[16:17]
    s_waitcnt lgkmcnt(1)
    v_cvt_f32_i32 v32, v32
    v_cvt_f32_i32 v33, v33
    v_cvt_f32_i32 v34, v34
    v_cvt_f32_i32 v35, v35
    v_pk_add_f32 v[32:33], v[32:33], v[12:13] op_sel:[0,0] op_sel_hi:[1,0] neg_lo:[0,1] neg_hi:[0,1]
    v_pk_add_f32 v[34:35], v[34:35], v[12:13] op_sel:[0,0] op_sel_hi:[1,0] neg_lo:[0,1] neg_hi:[0,1]
    v_pk_fma_f32 v[16:17], v[32:33], v[44:45], v[16:17]
    v_pk_fma_f32 v[16:17], v[34:35], v[46:47], v[16:17]
    v_add_f32 v16, v16, v17
    v_cndmask_b32 v23, v10, v11, s[86:87]
    v_lshlrev_b32 v23, 16, v23
    v_add_f32_dpp v18, v16, v16 row_ror:8 row_mask:0xf bank_mask:0xc
    v_mul_f32 v23, 0x3dd53b95, v23
    s_nop 0
    v_add_f32_dpp v18, v18, v18 row_half_mirror row_mask:0xf bank_mask:0xf
    s_nop 1
    v_add_f32_dpp v18, v18, v18 quad_perm:[2,3,0,1] row_mask:0xf bank_mask:0xf
    s_nop 1
    v_add_f32_dpp v18, v18, v18 quad_perm:[1,0,3,2] row_mask:0xf bank_mask:0xf
    v_mul_f32 v18, v23, v18
    ds_write_b32 v4, v18 offset:0
    s_cmp_lg_u32 s81, 0
    s_cbranch_scc1 L_ncs2
    v_perm_b32 v36, v98, v96, s83
    v_perm_b32 v98, v98, v96, s84
    v_perm_b32 v37, v99, v97, s83
    v_perm_b32 v99, v99, v97, s84
    v_perm_b32 v38, v102, v100, s83
    v_perm_b32 v102, v102, v100, s84
    v_perm_b32 v39, v103, v101, s83
    v_perm_b32 v103, v103, v101, s84
    v_perm_b32 v40, v106, v104, s83
    v_perm_b32 v106, v106, v104, s84
    v_perm_b32 v41, v107, v105, s83
    v_perm_b32 v107, v107, v105, s84
    v_mov_b64 v[96:97], v[36:37]
    v_mov_b64 v[100:101], v[38:39]
    v_mov_b64 v[104:105], v[40:41]
    s_nop 1
L_ncs2:
    v_dot2_f32_bf16 v36, v96, v48, 0
    v_dot2_f32_bf16 v37, v98, v49, 0
    v_dot2_f32_bf16 v38, v97, v50, 0
    v_dot2_f32_bf16 v39, v99, v51, 0
    v_dot2_f32_bf16 v40, v100, v52, 0
    v_dot2_f32_bf16 v41, v102, v53, 0
    v_dot2_f32_bf16 v42, v101, v54, 0
    v_dot2_f32_bf16 v43, v103, v55, 0
    v_dot2_f32_bf16 v44, v104, v56, 0
    v_dot2_f32_bf16 v45, v106, v57, 0
    v_dot2_f32_bf16 v46, v105, v58, 0
    v_dot2_f32_bf16 v47, v107, v59, 0
    s_add_u32 s79, s79, 12
    s_cmp_ge_i32 s80, s79
    s_cbranch_scc1 L_kr2g
L_kr2:
    ds_read_b32 v19, v7
    s_sleep 1
    s_waitcnt lgkmcnt(0)
    v_readlane_b32 s80, v19, 5
    s_nop 0
    s_cmp_lt_i32 s80, s79
    s_cbranch_scc1 L_kr2
L_kr2g:
    ds_read_b32 v10, v3 offset:256
    ds_read_b128 v[24:27], v2 offset:24576
    ds_read_b128 v[28:31], v2 offset:24832
    ds_read_b128 v[32:35], v2 offset:25088
    v_add_u32 v6, 1, v6
    ds_write_b32 v5, v6
    s_waitcnt lgkmcnt(3)
    v_and_b32 v12, 0xffff0000, v10
    v_cvt_f32_i32 v24, v24
    v_cvt_f32_i32 v25, v25
    v_cvt_f32_i32 v26, v26
    v_cvt_f32_i32 v27, v27
    v_pk_add_f32 v[24:25], v[24:25], v[12:13] op_sel:[0,0] op_sel_hi:[1,0] neg_lo:[0,1] neg_hi:[0,1]
    v_pk_add_f32 v[26:27], v[26:27], v[12:13] op_sel:[0,0] op_sel_hi:[1,0] neg_lo:[0,1] neg_hi:[0,1]
    v_pk_mul_f32 v[14:15], v[24:25], v[36:37]
    v_pk_fma_f32 v[14:15], v[26:27], v[38:39], v[14:15]
    s_waitcnt lgkmcnt(2)
    v_cvt_f32_i32 v28, v28
    v_cvt_f32_i32 v29, v29
    v_cvt_f32_i32 v30, v30
    v_cvt_f32_i32 v31, v31
    v_pk_add_f32 v[28:29], v[28:29], v[12:13] op_sel:[0,0] op_sel_hi:[1,0] neg_lo:[0,1] neg_hi:[0,1]
    v_pk_add_f32 v[30:31], v[30:31], v[12:13] op_sel:[0,0] op_sel_hi:[1,0] neg_lo:[0,1] neg_hi:[0,1]
    v_pk_fma_f32 v[14:15], v[28:29], v[40:41], v[14:15]
    v_pk_fma_f32 v[14:15], v[30:31], v[42:43], v[14:15]
    s_waitcnt lgkmcnt(1)
    v_cvt_f32_i32 v32, v32
    v_cvt_f32_i32 v33, v33
    v_cvt_f32_i32 v34, v34
    v_cvt_f32_i32 v35, v35
    v_pk_add_f32 v[32:33], v[32:33], v[12:13] op_sel:[0,0] op_sel_hi:[1,0] neg_lo:[0,1] neg_hi:[0,1]
    v_pk_add_f32 v[34:35], v[34:35], v[12:13] op_sel:[0,0] op_sel_hi:[1,0] neg_lo:[0,1] neg_hi:[0,1]
    v_pk_fma_f32 v[14:15], v[32:33], v[44:45], v[14:15]
    v_pk_fma_f32 v[14:15], v[34:35], v[46:47], v[14:15]
    v_add_f32 v14, v14, v15
    s_nop 1
    v_add_f32_dpp v18, v14, v14 row_ror:8 row_mask:0xf bank_mask:0x3
    s_cmp_lg_u32 s81, 0
    s_nop 0
    s_cbranch_scc1 L_ncs3
    s_mul_i32 s82, s89, 384
    s_add_u32 s89, s89, 2048
    s_and_b32 s89, s89, 16383
    buffer_load_dwordx2 v[156:157], v20, s[12:15], s82 offen offset:0
    buffer_load_dwordx2 v[158:159], v20, s[16:19], s82 offen offset:192
    buffer_load_dwordx2 v[160:161], v20, s[12:15], s82 offen offset:128
    buffer_load_dwordx2 v[162:163], v21, s[16:19], s82 offen
    buffer_load_dwordx2 v[164:165], v20, s[12:15], s82 offen offset:256
    buffer_load_dwordx2 v[166:167], v20, s[16:19], s82 offen offset:64
    v_perm_b32 v36, v110, v108, s83
    v_perm_b32 v110, v110, v108, s84
    v_perm_b32 v37, v111, v109, s83
    v_perm_b32 v111, v111, v109, s84
    v_perm_b32 v38, v114, v112, s83
    v_perm_b32 v114, v114, v112, s84
    v_perm_b32 v39, v115, v113, s83
    v_perm_b32 v115, v115, v113, s84
    v_perm_b32 v40, v118, v116, s83
    v_perm_b32 v118, v118, v116, s84
    v_perm_b32 v41, v119, v117, s83
    v_perm_b32 v119, v119, v117, s84
    v_mov_b64 v[108:109], v[36:37]
    v_mov_b64 v[112:113], v[38:39]
    v_mov_b64 v[116:117], v[40:41]
    s_nop 1
L_ncs3:
    v_dot2_f32_bf16 v36, v108, v48, 0
    v_dot2_f32_bf16 v37, v110, v49, 0
    v_dot2_f32_bf16 v38, v109, v50, 0
    v_dot2_f32_bf16 v39, v111, v51, 0
    v_dot2_f32_bf16 v40, v112, v52, 0
    v_dot2_f32_bf16 v41, v114, v53, 0
    v_dot2_f32_bf16 v42, v113, v54, 0
    v_dot2_f32_bf16 v43, v115, v55, 0
    v_dot2_f32_bf16 v44, v116, v56, 0
    v_dot2_f32_bf16 v45, v118, v57, 0
    v_dot2_f32_bf16 v46, v117, v58, 0
    v_dot2_f32_bf16 v47, v119, v59, 0
    s_add_u32 s79, s79, 12
    s_cmp_ge_i32 s80, s79
    s_cbranch_scc1 L_kr3g
L_kr3:
    ds_read_b32 v19, v7
    s_sleep 1
    s_waitcnt lgkmcnt(0)
    v_readlane_b32 s80, v19, 5
    s_nop 0
    s_cmp_lt_i32 s80, s79
    s_cbranch_scc1 L_kr3
L_kr3g:
    ds_read_b32 v11, v3 offset:384
    ds_read_b128 v[24:27], v2 offset:36864
    ds_read_b128 v[28:31], v2 offset:37120
    ds_read_b128 v[32:35], v2 offset:37376
    v_add_u32 v6, 1, v6
    ds_write_b32 v5, v6
    s_waitcnt lgkmcnt(3)
    v_and_b32 v12, 0xffff0000, v11
    v_cvt_f32_i32 v24, v24
    v_cvt_f32_i32 v25, v25
    v_cvt_f32_i32 v26, v26
    v_cvt_f32_i32 v27, v27
    v_pk_add_f32 v[24:25], v[24:25], v[12:13] op_sel:[0,0] op_sel_hi:[1,0] neg_lo:[0,1] neg_hi:[0,1]
    v_pk_add_f32 v[26:27], v[26:27], v[12:13] op_sel:[0,0] op_sel_hi:[1,0] neg_lo:[0,1] neg_hi:[0,1]
    v_pk_mul_f32 v[16:17], v[24:25], v[36:37]
    v_pk_fma_f32 v[16:17], v[26:27], v[38:39], v[16:17]
    s_waitcnt lgkmcnt(2)
    v_cvt_f32_i32 v28, v28
    v_cvt_f32_i32 v29, v29
    v_cvt_f32_i32 v30, v30
    v_cvt_f32_i32 v31, v31
    v_pk_add_f32 v[28:29], v[28:29], v[12:13] op_sel:[0,0] op_sel_hi:[1,0] neg_lo:[0,1] neg_hi:[0,1]
    v_pk_add_f32 v[30:31], v[30:31], v[12:13] op_sel:[0,0] op_sel_hi:[1,0] neg_lo:[0,1] neg_hi:[0,1]
    v_pk_fma_f32 v[16:17], v[28:29], v[40:41], v[16:17]
    v_pk_fma_f32 v[16:17], v[30:31], v[42:43], v[16:17]
    s_waitcnt lgkmcnt(1)
    v_cvt_f32_i32 v32, v32
    v_cvt_f32_i32 v33, v33
    v_cvt_f32_i32 v34, v34
    v_cvt_f32_i32 v35, v35
    v_pk_add_f32 v[32:33], v[32:33], v[12:13] op_sel:[0,0] op_sel_hi:[1,0] neg_lo:[0,1] neg_hi:[0,1]
    v_pk_add_f32 v[34:35], v[34:35], v[12:13] op_sel:[0,0] op_sel_hi:[1,0] neg_lo:[0,1] neg_hi:[0,1]
    v_pk_fma_f32 v[16:17], v[32:33], v[44:45], v[16:17]
    v_pk_fma_f32 v[16:17], v[34:35], v[46:47], v[16:17]
    v_add_f32 v16, v16, v17
    v_cndmask_b32 v23, v10, v11, s[86:87]
    v_lshlrev_b32 v23, 16, v23
    v_add_f32_dpp v18, v16, v16 row_ror:8 row_mask:0xf bank_mask:0xc
    v_mul_f32 v23, 0x3dd53b95, v23
    s_nop 0
    v_add_f32_dpp v18, v18, v18 row_half_mirror row_mask:0xf bank_mask:0xf
    s_nop 1
    v_add_f32_dpp v18, v18, v18 quad_perm:[2,3,0,1] row_mask:0xf bank_mask:0xf
    s_nop 1
    v_add_f32_dpp v18, v18, v18 quad_perm:[1,0,3,2] row_mask:0xf bank_mask:0xf
    v_mul_f32 v18, v23, v18
    ds_write_b32 v4, v18 offset:256
    s_cmp_lg_u32 s81, 0
    s_cbranch_scc1 L_ncs4
    s_waitcnt vmcnt(18)
    v_perm_b32 v36, v122, v120, s83
    v_perm_b32 v122, v122, v120, s84
    v_perm_b32 v37, v123, v121, s83
    v_perm_b32 v123, v123, v121, s84
    v_perm_b32 v38, v126, v124, s83
    v_perm_b32 v126, v126, v124, s84
    v_perm_b32 v39, v127, v125, s83
    v_perm_b32 v127, v127, v125, s84
    v_perm_b32 v40, v130, v128, s83
    v_perm_b32 v130, v130, v128, s84
    v_perm_b32 v41, v131, v129, s83
    v_perm_b32 v131, v131, v129, s84
    v_mov_b64 v[120:121], v[36:37]
    v_mov_b64 v[124:125], v[38:39]
    v_mov_b64 v[128:129], v[40:41]
    s_nop 1
L_ncs4:
    v_dot2_f32_bf16 v36, v120, v48, 0
    v_dot2_f32_bf16 v37, v122, v49, 0
    v_dot2_f32_bf16 v38, v121, v50, 0
    v_dot2_f32_bf16 v39, v123, v51, 0
    v_dot2_f32_bf16 v40, v124, v52, 0
    v_dot2_f32_bf16 v41, v126, v53, 0
    v_dot2_f32_bf16 v42, v125, v54, 0
    v_dot2_f32_bf16 v43, v127, v55, 0
    v_dot2_f32_bf16 v44, v128, v56, 0
    v_dot2_f32_bf16 v45, v130, v57, 0
    v_dot2_f32_bf16 v46, v129, v58, 0
    v_dot2_f32_bf16 v47, v131, v59, 0
    s_add_u32 s79, s79, 12
    s_cmp_ge_i32 s80, s79
    s_cbranch_scc1 L_kr4g
L_kr4:
    ds_read_b32 v19, v7
    s_sleep 1
    s_waitcnt lgkmcnt(0)
    v_readlane_b32 s80, v19, 5
    s_nop 0
    s_cmp_lt_i32 s80, s79
    s_cbranch_scc1 L_kr4
L_kr4g:
    ds_read_b32 v10, v3 offset:512
    ds_read_b128 v[24:27], v2 offset:0
    ds_read_b128 v[28:31], v2 offset:256
    ds_read_b128 v[32:35], v2 offset:512
    v_add_u32 v6, 1, v6
    ds_write_b32 v5, v6
    s_waitcnt lgkmcnt(3)
    v_and_b32 v12, 0xffff0000, v10
    v_cvt_f32_i32 v24, v24
    v_cvt_f32_i32 v25, v25
    v_cvt_f32_i32 v26, v26
    v_cvt_f32_i32 v27, v27
    v_pk_add_f32 v[24:25], v[24:25], v[12:13] op_sel:[0,0] op_sel_hi:[1,0] neg_lo:[0,1] neg_hi:[0,1]
    v_pk_add_f32 v[26:27], v[26:27], v[12:13] op_sel:[0,0] op_sel_hi:[1,0] neg_lo:[0,1] neg_hi:[0,1]
    v_pk_mul_f32 v[14:15], v[24:25], v[36:37]
    v_pk_fma_f32 v[14:15], v[26:27], v[38:39], v[14:15]
    s_waitcnt lgkmcnt(2)
    v_cvt_f32_i32 v28, v28
    v_cvt_f32_i32 v29, v29
    v_cvt_f32_i32 v30, v30
    v_cvt_f32_i32 v31, v31
    v_pk_add_f32 v[28:29], v[28:29], v[12:13] op_sel:[0,0] op_sel_hi:[1,0] neg_lo:[0,1] neg_hi:[0,1]
    v_pk_add_f32 v[30:31], v[30:31], v[12:13] op_sel:[0,0] op_sel_hi:[1,0] neg_lo:[0,1] neg_hi:[0,1]
    v_pk_fma_f32 v[14:15], v[28:29], v[40:41], v[14:15]
    v_pk_fma_f32 v[14:15], v[30:31], v[42:43], v[14:15]
    s_waitcnt lgkmcnt(1)
    v_cvt_f32_i32 v32, v32
    v_cvt_f32_i32 v33, v33
    v_cvt_f32_i32 v34, v34
    v_cvt_f32_i32 v35, v35
    v_pk_add_f32 v[32:33], v[32:33], v[12:13] op_sel:[0,0] op_sel_hi:[1,0] neg_lo:[0,1] neg_hi:[0,1]
    v_pk_add_f32 v[34:35], v[34:35], v[12:13] op_sel:[0,0] op_sel_hi:[1,0] neg_lo:[0,1] neg_hi:[0,1]
    v_pk_fma_f32 v[14:15], v[32:33], v[44:45], v[14:15]
    v_pk_fma_f32 v[14:15], v[34:35], v[46:47], v[14:15]
    v_add_f32 v14, v14, v15
    s_nop 1
    v_add_f32_dpp v18, v14, v14 row_ror:8 row_mask:0xf bank_mask:0x3
    s_cmp_lg_u32 s81, 0
    s_nop 0
    s_cbranch_scc1 L_ncs5
    s_waitcnt vmcnt(12)
    v_perm_b32 v36, v134, v132, s83
    v_perm_b32 v134, v134, v132, s84
    v_perm_b32 v37, v135, v133, s83
    v_perm_b32 v135, v135, v133, s84
    v_perm_b32 v38, v138, v136, s83
    v_perm_b32 v138, v138, v136, s84
    v_perm_b32 v39, v139, v137, s83
    v_perm_b32 v139, v139, v137, s84
    v_perm_b32 v40, v142, v140, s83
    v_perm_b32 v142, v142, v140, s84
    v_perm_b32 v41, v143, v141, s83
    v_perm_b32 v143, v143, v141, s84
    v_mov_b64 v[132:133], v[36:37]
    v_mov_b64 v[136:137], v[38:39]
    v_mov_b64 v[140:141], v[40:41]
    s_nop 1
L_ncs5:
    v_dot2_f32_bf16 v36, v132, v48, 0
    v_dot2_f32_bf16 v37, v134, v49, 0
    v_dot2_f32_bf16 v38, v133, v50, 0
    v_dot2_f32_bf16 v39, v135, v51, 0
    v_dot2_f32_bf16 v40, v136, v52, 0
    v_dot2_f32_bf16 v41, v138, v53, 0
    v_dot2_f32_bf16 v42, v137, v54, 0
    v_dot2_f32_bf16 v43, v139, v55, 0
    v_dot2_f32_bf16 v44, v140, v56, 0
    v_dot2_f32_bf16 v45, v142, v57, 0
    v_dot2_f32_bf16 v46, v141, v58, 0
    v_dot2_f32_bf16 v47, v143, v59, 0
    s_add_u32 s79, s79, 12
    s_cmp_ge_i32 s80, s79
    s_cbranch_scc1 L_kr5g
L_kr5:
    ds_read_b32 v19, v7
    s_sleep 1
    s_waitcnt lgkmcnt(0)
    v_readlane_b32 s80, v19, 5
    s_nop 0
    s_cmp_lt_i32 s80, s79
    s_cbranch_scc1 L_kr5
L_kr5g:
    ds_read_b32 v11, v3 offset:640
    ds_read_b128 v[24:27], v2 offset:12288
    ds_read_b128 v[28:31], v2 offset:12544
    ds_read_b128 v[32:35], v2 offset:12800
    v_add_u32 v6, 1, v6
    ds_write_b32 v5, v6
    s_waitcnt lgkmcnt(3)
    v_and_b32 v12, 0xffff0000, v11
    v_cvt_f32_i32 v24, v24
    v_cvt_f32_i32 v25, v25
    v_cvt_f32_i32 v26, v26
    v_cvt_f32_i32 v27, v27
    v_pk_add_f32 v[24:25], v[24:25], v[12:13] op_sel:[0,0] op_sel_hi:[1,0] neg_lo:[0,1] neg_hi:[0,1]
    v_pk_add_f32 v[26:27], v[26:27], v[12:13] op_sel:[0,0] op_sel_hi:[1,0] neg_lo:[0,1] neg_hi:[0,1]
    v_pk_mul_f32 v[16:17], v[24:25], v[36:37]
    v_pk_fma_f32 v[16:17], v[26:27], v[38:39], v[16:17]
    s_waitcnt lgkmcnt(2)
    v_cvt_f32_i32 v28, v28
    v_cvt_f32_i32 v29, v29
    v_cvt_f32_i32 v30, v30
    v_cvt_f32_i32 v31, v31
    v_pk_add_f32 v[28:29], v[28:29], v[12:13] op_sel:[0,0] op_sel_hi:[1,0] neg_lo:[0,1] neg_hi:[0,1]
    v_pk_add_f32 v[30:31], v[30:31], v[12:13] op_sel:[0,0] op_sel_hi:[1,0] neg_lo:[0,1] neg_hi:[0,1]
    v_pk_fma_f32 v[16:17], v[28:29], v[40:41], v[16:17]
    v_pk_fma_f32 v[16:17], v[30:31], v[42:43], v[16:17]
    s_waitcnt lgkmcnt(1)
    v_cvt_f32_i32 v32, v32
    v_cvt_f32_i32 v33, v33
    v_cvt_f32_i32 v34, v34
    v_cvt_f32_i32 v35, v35
    v_pk_add_f32 v[32:33], v[32:33], v[12:13] op_sel:[0,0] op_sel_hi:[1,0] neg_lo:[0,1] neg_hi:[0,1]
    v_pk_add_f32 v[34:35], v[34:35], v[12:13] op_sel:[0,0] op_sel_hi:[1,0] neg_lo:[0,1] neg_hi:[0,1]
    v_pk_fma_f32 v[16:17], v[32:33], v[44:45], v[16:17]
    v_pk_fma_f32 v[16:17], v[34:35], v[46:47], v[16:17]
    v_add_f32 v16, v16, v17
    v_cndmask_b32 v23, v10, v11, s[86:87]
    v_lshlrev_b32 v23, 16, v23
    v_add_f32_dpp v18, v16, v16 row_ror:8 row_mask:0xf bank_mask:0xc
    v_mul_f32 v23, 0x3dd53b95, v23
    s_nop 0
    v_add_f32_dpp v18, v18, v18 row_half_mirror row_mask:0xf bank_mask:0xf
    s_nop 1
    v_add_f32_dpp v18, v18, v18 quad_perm:[2,3,0,1] row_mask:0xf bank_mask:0xf
    s_nop 1
    v_add_f32_dpp v18, v18, v18 quad_perm:[1,0,3,2] row_mask:0xf bank_mask:0xf
    v_mul_f32 v18, v23, v18
    ds_write_b32 v4, v18 offset:512
    s_cmp_lg_u32 s81, 0
    s_cbranch_scc1 L_ncs6
    s_waitcnt vmcnt(6)
    v_perm_b32 v36, v146, v144, s83
    v_perm_b32 v146, v146, v144, s84
    v_perm_b32 v37, v147, v145, s83
    v_perm_b32 v147, v147, v145, s84
    v_perm_b32 v38, v150, v148, s83
    v_perm_b32 v150, v150, v148, s84
    v_perm_b32 v39, v151, v149, s83
    v_perm_b32 v151, v151, v149, s84
    v_perm_b32 v40, v154, v152, s83
    v_perm_b32 v154, v154, v152, s84
    v_perm_b32 v41, v155, v153, s83
    v_perm_b32 v155, v155, v153, s84
    v_mov_b64 v[144:145], v[36:37]
    v_mov_b64 v[148:149], v[38:39]
    v_mov_b64 v[152:153], v[40:41]
    s_nop 1
L_ncs6:
    v_dot2_f32_bf16 v36, v144, v48, 0
    v_dot2_f32_bf16 v37, v146, v49, 0
    v_dot2_f32_bf16 v38, v145, v50, 0
    v_dot2_f32_bf16 v39, v147, v51, 0
    v_dot2_f32_bf16 v40, v148, v52, 0
    v_dot2_f32_bf16 v41, v150, v53, 0
    v_dot2_f32_bf16 v42, v149, v54, 0
    v_dot2_f32_bf16 v43, v151, v55, 0
    v_dot2_f32_bf16 v44, v152, v56, 0
    v_dot2_f32_bf16 v45, v154, v57, 0
    v_dot2_f32_bf16 v46, v153, v58, 0
    v_dot2_f32_bf16 v47, v155, v59, 0
    s_add_u32 s79, s79, 12
    s_cmp_ge_i32 s80, s79
    s_cbranch_scc1 L_kr6g
L_kr6:
    ds_read_b32 v19, v7
    s_sleep 1
    s_waitcnt lgkmcnt(0)
    v_readlane_b32 s80, v19, 5
    s_nop 0
    s_cmp_lt_i32 s80, s79
    s_cbranch_scc1 L_kr6
L_kr6g:
    ds_read_b32 v10, v3 offset:768
    ds_read_b128 v[24:27], v2 offset:24576
    ds_read_b128 v[28:31], v2 offset:24832
    ds_read_b128 v[32:35], v2 offset:25088
    v_add_u32 v6, 1, v6
    ds_write_b32 v5, v6
    s_waitcnt lgkmcnt(3)
    v_and_b32 v12, 0xffff0000, v10
    v_cvt_f32_i32 v24, v24
    v_cvt_f32_i32 v25, v25
    v_cvt_f32_i32 v26, v26
    v_cvt_f32_i32 v27, v27
    v_pk_add_f32 v[24:25], v[24:25], v[12:13] op_sel:[0,0] op_sel_hi:[1,0] neg_lo:[0,1] neg_hi:[0,1]
    v_pk_add_f32 v[26:27], v[26:27], v[12:13] op_sel:[0,0] op_sel_hi:[1,0] neg_lo:[0,1] neg_hi:[0,1]
    v_pk_mul_f32 v[14:15], v[24:25], v[36:37]
    v_pk_fma_f32 v[14:15], v[26:27], v[38:39], v[14:15]
    s_waitcnt lgkmcnt(2)
    v_cvt_f32_i32 v28, v28
    v_cvt_f32_i32 v29, v29
    v_cvt_f32_i32 v30, v30
    v_cvt_f32_i32 v31, v31
    v_pk_add_f32 v[28:29], v[28:29], v[12:13] op_sel:[0,0] op_sel_hi:[1,0] neg_lo:[0,1] neg_hi:[0,1]
    v_pk_add_f32 v[30:31], v[30:31], v[12:13] op_sel:[0,0] op_sel_hi:[1,0] neg_lo:[0,1] neg_hi:[0,1]
    v_pk_fma_f32 v[14:15], v[28:29], v[40:41], v[14:15]
    v_pk_fma_f32 v[14:15], v[30:31], v[42:43], v[14:15]
    s_waitcnt lgkmcnt(1)
    v_cvt_f32_i32 v32, v32
    v_cvt_f32_i32 v33, v33
    v_cvt_f32_i32 v34, v34
    v_cvt_f32_i32 v35, v35
    v_pk_add_f32 v[32:33], v[32:33], v[12:13] op_sel:[0,0] op_sel_hi:[1,0] neg_lo:[0,1] neg_hi:[0,1]
    v_pk_add_f32 v[34:35], v[34:35], v[12:13] op_sel:[0,0] op_sel_hi:[1,0] neg_lo:[0,1] neg_hi:[0,1]
    v_pk_fma_f32 v[14:15], v[32:33], v[44:45], v[14:15]
    v_pk_fma_f32 v[14:15], v[34:35], v[46:47], v[14:15]
    v_add_f32 v14, v14, v15
    s_nop 1
    v_add_f32_dpp v18, v14, v14 row_ror:8 row_mask:0xf bank_mask:0x3
    s_cmp_lg_u32 s81, 0
    s_nop 0
    s_cbranch_scc1 L_ncs7
    s_waitcnt vmcnt(0)
    v_perm_b32 v36, v158, v156, s83
    v_perm_b32 v158, v158, v156, s84
    v_perm_b32 v37, v159, v157, s83
    v_perm_b32 v159, v159, v157, s84
    v_perm_b32 v38, v162, v160, s83
    v_perm_b32 v162, v162, v160, s84
    v_perm_b32 v39, v163, v161, s83
    v_perm_b32 v163, v163, v161, s84
    v_perm_b32 v40, v166, v164, s83
    v_perm_b32 v166, v166, v164, s84
    v_perm_b32 v41, v167, v165, s83
    v_perm_b32 v167, v167, v165, s84
    v_mov_b64 v[156:157], v[36:37]
    v_mov_b64 v[160:161], v[38:39]
    v_mov_b64 v[164:165], v[40:41]
    s_nop 1
L_ncs7:
    v_dot2_f32_bf16 v36, v156, v48, 0
    v_dot2_f32_bf16 v37, v158, v49, 0
    v_dot2_f32_bf16 v38, v157, v50, 0
    v_dot2_f32_bf16 v39, v159, v51, 0
    v_dot2_f32_bf16 v40, v160, v52, 0
    v_dot2_f32_bf16 v41, v162, v53, 0
    v_dot2_f32_bf16 v42, v161, v54, 0
    v_dot2_f32_bf16 v43, v163, v55, 0
    v_dot2_f32_bf16 v44, v164, v56, 0
    v_dot2_f32_bf16 v45, v166, v57, 0
    v_dot2_f32_bf16 v46, v165, v58, 0
    v_dot2_f32_bf16 v47, v167, v59, 0
    s_add_u32 s79, s79, 12
    s_cmp_ge_i32 s80, s79
    s_cbranch_scc1 L_kr7g
L_kr7:
    ds_read_b32 v19, v7
    s_sleep 1
    s_waitcnt lgkmcnt(0)
    v_readlane_b32 s80, v19, 5
    s_nop 0
    s_cmp_lt_i32 s80, s79
    s_cbranch_scc1 L_kr7
L_kr7g:
    ds_read_b32 v11, v3 offset:896
    ds_read_b128 v[24:27], v2 offset:36864
    ds_read_b128 v[28:31], v2 offset:37120
    ds_read_b128 v[32:35], v2 offset:37376
    v_add_u32 v6, 1, v6
    ds_write_b32 v5, v6
    s_waitcnt lgkmcnt(3)
    v_and_b32 v12, 0xffff0000, v11
    v_cvt_f32_i32 v24, v24
    v_cvt_f32_i32 v25, v25
    v_cvt_f32_i32 v26, v26
    v_cvt_f32_i32 v27, v27
    v_pk_add_f32 v[24:25], v[24:25], v[12:13] op_sel:[0,0] op_sel_hi:[1,0] neg_lo:[0,1] neg_hi:[0,1]
    v_pk_add_f32 v[26:27], v[26:27], v[12:13] op_sel:[0,0] op_sel_hi:[1,0] neg_lo:[0,1] neg_hi:[0,1]
    v_pk_mul_f32 v[16:17], v[24:25], v[36:37]
    v_pk_fma_f32 v[16:17], v[26:27], v[38:39], v[16:17]
    s_waitcnt lgkmcnt(2)
    v_cvt_f32_i32 v28, v28
    v_cvt_f32_i32 v29, v29
    v_cvt_f32_i32 v30, v30
    v_cvt_f32_i32 v31, v31
    v_pk_add_f32 v[28:29], v[28:29], v[12:13] op_sel:[0,0] op_sel_hi:[1,0] neg_lo:[0,1] neg_hi:[0,1]
    v_pk_add_f32 v[30:31], v[30:31], v[12:13] op_sel:[0,0] op_sel_hi:[1,0] neg_lo:[0,1] neg_hi:[0,1]
    v_pk_fma_f32 v[16:17], v[28:29], v[40:41], v[16:17]
    v_pk_fma_f32 v[16:17], v[30:31], v[42:43], v[16:17]
    s_waitcnt lgkmcnt(1)
    v_cvt_f32_i32 v32, v32
    v_cvt_f32_i32 v33, v33
    v_cvt_f32_i32 v34, v34
    v_cvt_f32_i32 v35, v35
    v_pk_add_f32 v[32:33], v[32:33], v[12:13] op_sel:[0,0] op_sel_hi:[1,0] neg_lo:[0,1] neg_hi:[0,1]
    v_pk_add_f32 v[34:35], v[34:35], v[12:13] op_sel:[0,0] op_sel_hi:[1,0] neg_lo:[0,1] neg_hi:[0,1]
    v_pk_fma_f32 v[16:17], v[32:33], v[44:45], v[16:17]
    v_pk_fma_f32 v[16:17], v[34:35], v[46:47], v[16:17]
    v_add_f32 v16, v16, v17
    v_cndmask_b32 v23, v10, v11, s[86:87]
    v_lshlrev_b32 v23, 16, v23
    v_add_f32_dpp v18, v16, v16 row_ror:8 row_mask:0xf bank_mask:0xc
    v_mul_f32 v23, 0x3dd53b95, v23
    s_nop 0
    v_add_f32_dpp v18, v18, v18 row_half_mirror row_mask:0xf bank_mask:0xf
    s_nop 1
    v_add_f32_dpp v18, v18, v18 quad_perm:[2,3,0,1] row_mask:0xf bank_mask:0xf
    s_nop 1
    v_add_f32_dpp v18, v18, v18 quad_perm:[1,0,3,2] row_mask:0xf bank_mask:0xf
    v_mul_f32 v18, v23, v18
    ds_write_b32 v4, v18 offset:768
    s_mov_b64 exec, 1
    ds_add_u32 v22, v8
    s_mov_b64 exec, -1
    v_add_u32 v3, 1024, v3
    v_add_u32 v4, 1024, v4
    s_add_u32 s81, s81, 1
    s_cmp_lt_u32 s81, 16
    s_cbranch_scc1 L_kph
    v_subrev_u32 v3, 16384, v3
    s_mul_i32 s92, s78, 768
    s_add_u32 s92, s92, 65536
    v_and_b32 v18, 15, v1
    v_lshl_add_u32 v9, v18, 4, s92
    v_lshrrev_b32 v18, 4, v1
    v_lshl_add_u32 v9, v18, 2, v9
    v_mov_b32 v22, 77920
    s_mov_b64 s[20:21], s[74:75]
    s_mov_b32 s22, 1610612736
    s_mov_b32 s23, 0x20000
    s_mov_b64 s[28:29], s[70:71]
    s_mov_b32 s30, 12288
    s_mov_b32 s31, 0x20000
    s_mul_i32 s92, s2, 43691
    s_lshr_b32 s92, s92, 18
    s_mul_i32 s93, s92, 6
    s_sub_u32 s93, s2, s93
    s_lshl2_add_u32 s94, s92, s78
    s_mul_i32 s32, s94, 24576
    s_lshl_b32 s94, s93, 7
    s_add_u32 s32, s32, s94
    s_add_u32 s33, s32, 6144
    s_add_u32 s34, s33, 6144
    s_add_u32 s35, s34, 6144
    s_lshl_b32 s36, s2, 6
    s_lshr_b32 s37, s92, 1
    s_add_u32 s37, s37, 2
    s_min_u32 s37, s37, 16
    v_lshrrev_b32 v19, 3, v1
    v_and_b32 v69, 7, v1
    v_mul_u32_u24 v68, 768, v19
    v_lshl_add_u32 v68, v69, 4, v68
    v_lshlrev_b32 v69, 3, v69
    v_lshl_add_u32 v69, v18, 1, v69
    s_lshl4_add_u32 s92, s78, 78336
    v_lshl_add_u32 v70, v19, 6, s92
    s_lshl_b32 s92, s78, 8
    s_add_u32 s92, s92, 1024
    v_add_u32 v4, s92, v7
    s_mov_b32 s81, 0
    s_nop 0
L_vph:
    v_mov_b64 v[72:73], 0
    v_mov_b64 v[74:75], 0
    v_mov_b64 v[76:77], 0
    v_mov_b64 v[78:79], 0
    v_mov_b64 v[80:81], 0
    v_mov_b64 v[82:83], 0
    s_and_b32 s92, s81, 3
    s_mul_i32 s92, s92, 3072
    v_add_u32 v71, s92, v9
    s_mov_b32 s88, 0
    s_nop 0
L_vw:
    ds_read_b32 v19, v7
    s_waitcnt lgkmcnt(0)
    v_readlane_b32 s92, v19, 15
    v_readlane_b32 s93, v19, 13
    s_add_u32 s92, s92, 4
    s_min_u32 s93, s93, s92
    s_cmp_le_u32 s93, s81
    s_nop 1
    s_cbranch_scc1 L_vw
    s_cmp_lg_u32 s81, 15
    s_cbranch_scc1 L_vit
    v_readlane_b32 s4, v19, 6
    s_cmp_ge_u32 s2, 192
    s_nop 3
    s_cbranch_scc1 L_vit
    s_cmp_eq_u32 s4, 0
    s_cbranch_scc1 L_vw
    ds_read_b128 v[64:67], v70
    s_lshr_b32 s5, s4, 8
    s_lshr_b32 s6, s4, 16
    s_lshr_b32 s7, s4, 24
L_vit:
    s_add_u32 s79, s79, 12
    s_cmp_ge_i32 s80, s79
    s_cbranch_scc1 L_vr0g
L_vr0:
    ds_read_b32 v19, v7
    s_waitcnt lgkmcnt(0)
    v_readlane_b32 s80, v19, 5
    s_nop 0
    s_cmp_lt_i32 s80, s79
    s_cbranch_scc1 L_vr0
L_vr0g:
    ds_read_b32 v10, v3 offset:0
    ds_read_b128 v[24:27], v2 offset:0
    ds_read_b128 v[28:31], v2 offset:256
    ds_read_b128 v[32:35], v2 offset:512
    v_add_u32 v6, 1, v6
    ds_write_b32 v5, v6
    s_waitcnt lgkmcnt(3)
    v_cvt_f32_i32 v24, v24
    v_cvt_f32_i32 v25, v25
    v_cvt_f32_i32 v26, v26
    v_cvt_f32_i32 v27, v27
    v_pk_fma_f32 v[72:73], v[24:25], v[10:11], v[72:73] op_sel:[0,0,0] op_sel_hi:[1,0,1]
    v_pk_fma_f32 v[74:75], v[26:27], v[10:11], v[74:75] op_sel:[0,0,0] op_sel_hi:[1,0,1]
    s_waitcnt lgkmcnt(2)
    v_cvt_f32_i32 v28, v28
    v_cvt_f32_i32 v29, v29
    v_cvt_f32_i32 v30, v30
    v_cvt_f32_i32 v31, v31
    v_pk_fma_f32 v[76:77], v[28:29], v[10:11], v[76:77] op_sel:[0,0,0] op_sel_hi:[1,0,1]
    v_pk_fma_f32 v[78:79], v[30:31], v[10:11], v[78:79] op_sel:[0,0,0] op_sel_hi:[1,0,1]
    s_waitcnt lgkmcnt(1)
    v_cvt_f32_i32 v32, v32
    v_cvt_f32_i32 v33, v33
    v_cvt_f32_i32 v34, v34
    v_cvt_f32_i32 v35, v35
    v_pk_fma_f32 v[80:81], v[32:33], v[10:11], v[80:81] op_sel:[0,0,0] op_sel_hi:[1,0,1]
    v_pk_fma_f32 v[82:83], v[34:35], v[10:11], v[82:83] op_sel:[0,0,0] op_sel_hi:[1,0,1]
    s_add_u32 s79, s79, 12
    s_cmp_ge_i32 s80, s79
    s_cbranch_scc1 L_vr1g
L_vr1:
    ds_read_b32 v19, v7
    s_waitcnt lgkmcnt(0)
    v_readlane_b32 s80, v19, 5
    s_nop 0
    s_cmp_lt_i32 s80, s79
    s_cbranch_scc1 L_vr1
L_vr1g:
    ds_read_b32 v10, v3 offset:128
    ds_read_b128 v[24:27], v2 offset:12288
    ds_read_b128 v[28:31], v2 offset:12544
    ds_read_b128 v[32:35], v2 offset:12800
    v_add_u32 v6, 1, v6
    ds_write_b32 v5, v6
    s_waitcnt lgkmcnt(3)
    v_cvt_f32_i32 v24, v24
    v_cvt_f32_i32 v25, v25
    v_cvt_f32_i32 v26, v26
    v_cvt_f32_i32 v27, v27
    v_pk_fma_f32 v[72:73], v[24:25], v[10:11], v[72:73] op_sel:[0,0,0] op_sel_hi:[1,0,1]
    v_pk_fma_f32 v[74:75], v[26:27], v[10:11], v[74:75] op_sel:[0,0,0] op_sel_hi:[1,0,1]
    s_waitcnt lgkmcnt(2)
    v_cvt_f32_i32 v28, v28
    v_cvt_f32_i32 v29, v29
    v_cvt_f32_i32 v30, v30
    v_cvt_f32_i32 v31, v31
    v_pk_fma_f32 v[76:77], v[28:29], v[10:11], v[76:77] op_sel:[0,0,0] op_sel_hi:[1,0,1]
    v_pk_fma_f32 v[78:79], v[30:31], v[10:11], v[78:79] op_sel:[0,0,0] op_sel_hi:[1,0,1]
    s_waitcnt lgkmcnt(1)
    v_cvt_f32_i32 v32, v32
    v_cvt_f32_i32 v33, v33
    v_cvt_f32_i32 v34, v34
    v_cvt_f32_i32 v35, v35
    v_pk_fma_f32 v[80:81], v[32:33], v[10:11], v[80:81] op_sel:[0,0,0] op_sel_hi:[1,0,1]
    v_pk_fma_f32 v[82:83], v[34:35], v[10:11], v[82:83] op_sel:[0,0,0] op_sel_hi:[1,0,1]
    s_add_u32 s79, s79, 12
    s_cmp_ge_i32 s80, s79
    s_cbranch_scc1 L_vr2g
L_vr2:
    ds_read_b32 v19, v7
    s_waitcnt lgkmcnt(0)
    v_readlane_b32 s80, v19, 5
    s_nop 0
    s_cmp_lt_i32 s80, s79
    s_cbranch_scc1 L_vr2
L_vr2g:
    ds_read_b32 v10, v3 offset:256
    ds_read_b128 v[24:27], v2 offset:24576
    ds_read_b128 v[28:31], v2 offset:24832
    ds_read_b128 v[32:35], v2 offset:25088
    v_add_u32 v6, 1, v6
    ds_write_b32 v5, v6
    s_waitcnt lgkmcnt(3)
    v_cvt_f32_i32 v24, v24
    v_cvt_f32_i32 v25, v25
    v_cvt_f32_i32 v26, v26
    v_cvt_f32_i32 v27, v27
    v_pk_fma_f32 v[72:73], v[24:25], v[10:11], v[72:73] op_sel:[0,0,0] op_sel_hi:[1,0,1]
    v_pk_fma_f32 v[74:75], v[26:27], v[10:11], v[74:75] op_sel:[0,0,0] op_sel_hi:[1,0,1]
    s_waitcnt lgkmcnt(2)
    v_cvt_f32_i32 v28, v28
    v_cvt_f32_i32 v29, v29
    v_cvt_f32_i32 v30, v30
    v_cvt_f32_i32 v31, v31
    v_pk_fma_f32 v[76:77], v[28:29], v[10:11], v[76:77] op_sel:[0,0,0] op_sel_hi:[1,0,1]
    v_pk_fma_f32 v[78:79], v[30:31], v[10:11], v[78:79] op_sel:[0,0,0] op_sel_hi:[1,0,1]
    s_waitcnt lgkmcnt(1)
    v_cvt_f32_i32 v32, v32
    v_cvt_f32_i32 v33, v33
    v_cvt_f32_i32 v34, v34
    v_cvt_f32_i32 v35, v35
    v_pk_fma_f32 v[80:81], v[32:33], v[10:11], v[80:81] op_sel:[0,0,0] op_sel_hi:[1,0,1]
    v_pk_fma_f32 v[82:83], v[34:35], v[10:11], v[82:83] op_sel:[0,0,0] op_sel_hi:[1,0,1]
    s_add_u32 s79, s79, 12
    s_cmp_ge_i32 s80, s79
    s_cbranch_scc1 L_vr3g
L_vr3:
    ds_read_b32 v19, v7
    s_waitcnt lgkmcnt(0)
    v_readlane_b32 s80, v19, 5
    s_nop 0
    s_cmp_lt_i32 s80, s79
    s_cbranch_scc1 L_vr3
L_vr3g:
    ds_read_b32 v10, v3 offset:384
    ds_read_b128 v[24:27], v2 offset:36864
    ds_read_b128 v[28:31], v2 offset:37120
    ds_read_b128 v[32:35], v2 offset:37376
    v_add_u32 v6, 1, v6
    ds_write_b32 v5, v6
    v_add_u32 v3, 512, v3
    s_add_u32 s88, s88, 1
    s_cmp_lt_u32 s88, 2
    s_waitcnt lgkmcnt(3)
    v_cvt_f32_i32 v24, v24
    v_cvt_f32_i32 v25, v25
    v_cvt_f32_i32 v26, v26
    v_cvt_f32_i32 v27, v27
    v_pk_fma_f32 v[72:73], v[24:25], v[10:11], v[72:73] op_sel:[0,0,0] op_sel_hi:[1,0,1]
    v_pk_fma_f32 v[74:75], v[26:27], v[10:11], v[74:75] op_sel:[0,0,0] op_sel_hi:[1,0,1]
    s_waitcnt lgkmcnt(2)
    v_cvt_f32_i32 v28, v28
    v_cvt_f32_i32 v29, v29
    v_cvt_f32_i32 v30, v30
    v_cvt_f32_i32 v31, v31
    v_pk_fma_f32 v[76:77], v[28:29], v[10:11], v[76:77] op_sel:[0,0,0] op_sel_hi:[1,0,1]
    v_pk_fma_f32 v[78:79], v[30:31], v[10:11], v[78:79] op_sel:[0,0,0] op_sel_hi:[1,0,1]
    s_waitcnt lgkmcnt(1)
    v_cvt_f32_i32 v32, v32
    v_cvt_f32_i32 v33, v33
    v_cvt_f32_i32 v34, v34
    v_cvt_f32_i32 v35, v35
    v_pk_fma_f32 v[80:81], v[32:33], v[10:11], v[80:81] op_sel:[0,0,0] op_sel_hi:[1,0,1]
    v_pk_fma_f32 v[82:83], v[34:35], v[10:11], v[82:83] op_sel:[0,0,0] op_sel_hi:[1,0,1]
    s_cbranch_scc1 L_vit
    v_permlane32_swap_b32 v72, v74
    v_permlane32_swap_b32 v73, v75
    v_permlane32_swap_b32 v76, v78
    v_permlane32_swap_b32 v77, v79
    v_permlane32_swap_b32 v80, v82
    v_permlane32_swap_b32 v81, v83
    v_pk_add_f32 v[72:73], v[72:73], v[74:75]
    v_pk_add_f32 v[76:77], v[76:77], v[78:79]
    v_pk_add_f32 v[80:81], v[80:81], v[82:83]
    v_permlane16_swap_b32 v72, v73
    v_permlane16_swap_b32 v76, v77
    v_permlane16_swap_b32 v80, v81
    v_add_f32 v36, v72, v73
    v_add_f32 v37, v76, v77
    v_add_f32 v38, v80, v81
    ds_write2st64_b32 v71, v36, v37 offset0:0 offset1:1
    ds_write_b32 v71, v38 offset:512
    s_mov_b64 exec, 1
    ds_add_u32 v22, v8
    s_mov_b64 exec, -1
    v_add_u32 v22, 4, v22
    s_add_u32 s81, s81, 1
    s_cmp_lt_u32 s81, 16
    s_cbranch_scc1 L_vph
    s_cmp_ge_u32 s2, 192
    s_cbranch_scc1 L_cend
L_gw:
    ds_read_b32 v19, v7
    s_waitcnt lgkmcnt(0)
    v_readlane_b32 s92, v19, 8
    s_nop 0
    s_cmp_lt_u32 s92, s37
    s_nop 2
    s_cbranch_scc1 L_gw
L_try:
    buffer_load_dwordx4 v[48:51], v68, s[20:23], s32 offen sc0 sc1
    buffer_load_dwordx4 v[52:55], v68, s[20:23], s33 offen sc0 sc1
    buffer_load_dwordx4 v[56:59], v68, s[20:23], s34 offen sc0 sc1
    buffer_load_dwordx4 v[60:63], v68, s[20:23], s35 offen sc0 sc1
    s_waitcnt vmcnt(3)
    v_xor_b32 v23, s4, v48
    v_bitop3_b32 v23, v23, v49, s5 bitop3:0xf6
    v_pk_mul_f32 v[14:15], v[48:49], v[64:65] op_sel:[0,0] op_sel_hi:[1,0]
    v_bitop3_b32 v23, v23, v50, s6 bitop3:0xf6
    v_bitop3_b32 v23, v23, v51, s7 bitop3:0xf6
    v_pk_mul_f32 v[16:17], v[50:51], v[64:65] op_sel:[0,0] op_sel_hi:[1,0]
    s_waitcnt vmcnt(2)
    v_bitop3_b32 v23, v23, v52, s4 bitop3:0xf6
    v_bitop3_b32 v23, v23, v53, s5 bitop3:0xf6
    v_pk_fma_f32 v[14:15], v[52:53], v[64:65], v[14:15] op_sel:[0,1,0] op_sel_hi:[1,1,1]
    v_bitop3_b32 v23, v23, v54, s6 bitop3:0xf6
    v_bitop3_b32 v23, v23, v55, s7 bitop3:0xf6
    v_pk_fma_f32 v[16:17], v[54:55], v[64:65], v[16:17] op_sel:[0,1,0] op_sel_hi:[1,1,1]
    s_waitcnt vmcnt(1)
    v_bitop3_b32 v23, v23, v56, s4 bitop3:0xf6
    v_bitop3_b32 v23, v23, v57, s5 bitop3:0xf6
    v_pk_fma_f32 v[14:15], v[56:57], v[66:67], v[14:15] op_sel:[0,0,0] op_sel_hi:[1,0,1]
    v_bitop3_b32 v23, v23, v58, s6 bitop3:0xf6
    v_bitop3_b32 v23, v23, v59, s7 bitop3:0xf6
    v_pk_fma_f32 v[16:17], v[58:59], v[66:67], v[16:17] op_sel:[0,0,0] op_sel_hi:[1,0,1]
    s_waitcnt vmcnt(0)
    v_bitop3_b32 v23, v23, v60, s4 bitop3:0xf6
    v_bitop3_b32 v23, v23, v61, s5 bitop3:0xf6
    v_pk_fma_f32 v[14:15], v[60:61], v[66:67], v[14:15] op_sel:[0,1,0] op_sel_hi:[1,1,1]
    v_bitop3_b32 v23, v23, v62, s6 bitop3:0xf6
    v_bitop3_b32 v23, v23, v63, s7 bitop3:0xf6
    v_pk_fma_f32 v[16:17], v[62:63], v[66:67], v[16:17] op_sel:[0,1,0] op_sel_hi:[1,1,1]
    v_and_b32 v23, 0xff, v23
    v_cmp_ne_u32 vcc, 0, v23
    s_nop 4
    s_cbranch_vccz L_cok
    s_mov_b64 exec, vcc
    s_sleep 1
    s_add_u32 s88, s88, 1
    s_cmp_lt_u32 s88, 400000
    s_cbranch_scc1 L_try
L_cok:
    s_mov_b64 exec, -1
    v_permlane32_swap_b32 v14, v16
    v_permlane32_swap_b32 v15, v17
    v_pk_add_f32 v[14:15], v[14:15], v[16:17]
    s_nop 1
    v_permlane16_swap_b32 v14, v15
    v_add_f32 v14, v14, v15
    ds_write_b32 v4, v14
    s_mov_b64 exec, 1
    ds_add_rtn_u32 v18, v7, v8 offset:28
    s_mov_b64 exec, -1
    ds_read2st64_b32 v[14:15], v7 offset0:4 offset1:5
    ds_read2st64_b32 v[16:17], v7 offset0:6 offset1:7
    s_waitcnt lgkmcnt(0)
    v_readfirstlane_b32 s92, v18
    v_pk_add_f32 v[14:15], v[14:15], v[16:17]
    v_add_f32 v14, v14, v15
    s_cmp_lg_u32 s92, 3
    s_nop 1
    s_cbranch_scc1 L_cend
    v_add_f32_dpp v14, v14, v14 row_ror:8 row_mask:0xf bank_mask:0xf
    s_mov_b32 exec_lo, 0x00ff00ff
    s_mov_b32 exec_hi, 0x00ff00ff
    v_cvt_pk_bf16_f32 v14, v14, v14
    buffer_store_short v14, v69, s[28:31], s36 offen
    s_nop 0
L_cend:
    s_waitcnt lgkmcnt(0)
    s_endpgm
L_helper:
    s_memrealtime s[96:97]
    v_bfe_u32 v22, v1, 2, 3
    v_lshl_add_u32 v22, v22, 11, s77
    v_and_b32 v22, 16383, v22
    v_lshrrev_b32 v19, 5, v1
    v_lshl_add_u32 v22, v19, 15, v22
    v_and_b32 v19, 3, v1
    v_lshlrev_b32 v19, 3, v19
    v_lshl_add_u32 v22, v22, 1, v19
    s_lshl_b32 s91, s3, 15
    v_lshlrev_b32 v2, 4, v1
    s_mov_b32 s6, 1048576
    s_mov_b32 s7, 0x20000
    s_mov_b32 s10, 1048576
    s_mov_b32 s11, 0x20000
    s_mov_b32 s14, 1048576
    s_mov_b32 s15, 0x20000
    s_mov_b32 s18, 1048576
    s_mov_b32 s19, 0x20000
    s_waitcnt lgkmcnt(0)
    s_mov_b64 s[4:5], s[52:53]
    s_mov_b64 s[8:9], s[54:55]
    s_mov_b64 s[12:13], s[58:59]
    s_mov_b64 s[16:17], s[60:61]
    buffer_load_dwordx2 v[108:109], v22, s[4:7], s91 offen
    buffer_load_dwordx2 v[110:111], v22, s[8:11], s91 offen
    buffer_load_dwordx2 v[112:113], v22, s[12:15], s91 offen
    buffer_load_dwordx2 v[114:115], v22, s[16:19], s91 offen
    s_add_u32 s91, s91, 131072
    s_barrier
    v_lshrrev_b32 v18, 1, v1
    v_lshlrev_b32 v18, 10, v18
    v_and_b32 v19, 1, v1
    v_lshl_add_u32 v18, v19, 6, v18
    s_lshr_b32 s92, s2, 3
    s_lshl_b32 s92, s92, 15
    s_and_b32 s93, s2, 7
    s_lshl_b32 s93, s93, 7
    s_add_u32 s92, s92, s93
    buffer_load_dword v6, v18, s[4:7], s92 offen
    buffer_load_dword v6, v18, s[8:11], s92 offen
    buffer_load_dword v6, v18, s[12:15], s92 offen
    buffer_load_dword v6, v18, s[16:19], s92 offen
    s_mov_b64 s[20:21], s[74:75]
    s_mov_b32 s22, 1610612736
    s_mov_b32 s23, 0x20000
    s_mov_b64 s[24:25], s[72:73]
    s_mov_b32 s26, 256
    s_mov_b32 s27, 0x20000
    s_mov_b64 s[32:33], s[48:49]
    s_mov_b32 s34, 12288
    s_mov_b32 s35, 0x20000
    s_mov_b64 s[36:37], s[62:63]
    s_mov_b32 s38, 384
    s_mov_b32 s39, 0x20000
    s_mov_b64 s[40:41], s[64:65]
    s_mov_b32 s42, 384
    s_mov_b32 s43, 0x20000
    v_lshlrev_b32 v44, 3, v1
    v_cmp_gt_u32 vcc, 24, v1
    v_mov_b32 v23, 0xffffff40
    v_mov_b32 v18, 192
    v_cndmask_b32 v23, v23, v18, vcc
    v_add_u32 v45, v44, v23
    v_mov_b32 v18, 0x80008000
    v_cndmask_b32 v46, 0, v18, vcc
    s_mov_b32 s78, s96
    s_mov_b32 s94, 0x05040100
    s_mov_b32 s95, 0x07060302
    v_lshlrev_b32 v9, 1, v2
    v_add_u32 v9, 49152, v9
    v_mov_b32 v3, 77824
    v_mov_b32 v4, 0
    v_mov_b32 v5, 0xff
    v_mov_b32 v12, v9
    buffer_load_dwordx2 v[40:41], v44, s[36:39], 0 offen
    buffer_load_dwordx2 v[42:43], v44, s[40:43], 0 offen
    s_mul_i32 s92, s3, 384
    s_add_u32 s92, s92, 6144
    buffer_load_dwordx2 v[136:137], v44, s[32:35], s92 offen
    buffer_load_dwordx2 v[138:139], v45, s[32:35], s92 offen
    buffer_load_dwordx2 v[140:141], v44, s[32:35], s92 offen offset:768
    buffer_load_dwordx2 v[142:143], v45, s[32:35], s92 offen offset:768
    s_add_u32 s92, s92, 1536
    buffer_load_dwordx2 v[144:145], v44, s[32:35], s92 offen
    buffer_load_dwordx2 v[146:147], v45, s[32:35], s92 offen
    buffer_load_dwordx2 v[148:149], v44, s[32:35], s92 offen offset:768
    buffer_load_dwordx2 v[150:151], v45, s[32:35], s92 offen offset:768
    s_add_u32 s92, s92, 1536
    buffer_load_dwordx2 v[152:153], v44, s[32:35], s92 offen
    buffer_load_dwordx2 v[154:155], v45, s[32:35], s92 offen
    buffer_load_dwordx2 v[156:157], v44, s[32:35], s92 offen offset:768
    buffer_load_dwordx2 v[158:159], v45, s[32:35], s92 offen offset:768
    s_add_u32 s92, s92, 1536
    buffer_load_dwordx2 v[160:161], v44, s[32:35], s92 offen
    buffer_load_dwordx2 v[162:163], v45, s[32:35], s92 offen
    buffer_load_dwordx2 v[164:165], v44, s[32:35], s92 offen offset:768
    buffer_load_dwordx2 v[166:167], v45, s[32:35], s92 offen offset:768
    s_waitcnt vmcnt(22)
    v_perm_b32 v116, v110, v108, s94
    v_perm_b32 v117, v114, v112, s94
    v_perm_b32 v118, v110, v108, s95
    v_perm_b32 v119, v114, v112, s95
    v_perm_b32 v120, v111, v109, s94
    v_perm_b32 v121, v115, v113, s94
    v_perm_b32 v122, v111, v109, s95
    v_perm_b32 v123, v115, v113, s95
    s_lshr_b32 s92, s91, 17
    v_mov_b32 v19, s92
    ds_write_b128 v12, v[116:119]
    ds_write_b128 v12, v[120:123] offset:16
    ds_write_b32 v3, v19 offset:48
    v_add_u32 v12, 2048, v12
    s_mov_b32 s48, 0
    s_cmp_lg_u32 s2, 0
    s_cbranch_scc1 L_ne0
    s_mul_i32 s49, s78, 0x9e3779b1
    s_lshr_b32 s93, s49, 15
    s_xor_b32 s49, s49, s93
    s_mul_i32 s49, s49, 0x85ebca6b
    s_lshr_b32 s93, s49, 13
    s_xor_b32 s49, s49, s93
    s_max_u32 s49, s49, 1
    v_mov_b32 v14, s49
    v_mov_b32 v15, 0
    s_mov_b64 exec, 1
    buffer_atomic_cmpswap v[14:15], v4, s[24:27], 0 offen sc0 sc1
    s_waitcnt vmcnt(0)
    v_readfirstlane_b32 s48, v14
    s_mov_b64 exec, -1
    s_cmp_eq_u32 s48, 0
    s_cselect_b32 s48, s49, s48
    s_nop 1
L_ne0:
    s_getpc_b64 s[92:93]
L_pc:
    s_sub_u32 s92, s92, L_pc-standalone__kv_cache_quant_pre_rope_vs_post_rope__decode_kernel
    s_subb_u32 s93, s93, 0
    s_lshr_b32 s94, s2, 3
    v_lshl_add_u32 v19, v1, 5, s94
    v_lshlrev_b32 v19, 7, v19
    v_min_u32 v19, L_end-standalone__kv_cache_quant_pre_rope_vs_post_rope__decode_kernel, v19
    s_mov_b64 exec, 63
    global_load_dword v6, v19, s[92:93]
    s_mov_b64 exec, -1
    v_lshlrev_b32 v18, 1, v44
    v_lshlrev_b32 v19, 1, v45
    v_add_u32 v18, 71680, v18
    v_add_u32 v19, 71680, v19
    v_mov_b32 v23, 78000
    s_mov_b32 s89, 0
    s_waitcnt vmcnt(1) lgkmcnt(0)
    v_xor_b32 v42, v42, v46
    v_xor_b32 v43, v43, v46
    v_lshlrev_b32 v48, 16, v40
    v_and_b32 v49, 0xffff0000, v40
    v_lshlrev_b32 v50, 16, v41
    v_and_b32 v51, 0xffff0000, v41
    v_lshlrev_b32 v52, 16, v42
    v_and_b32 v53, 0xffff0000, v42
    v_lshlrev_b32 v54, 16, v43
    v_and_b32 v55, 0xffff0000, v43
    v_and_b32 v46, 0x80000000, v46
    s_nop 1
L_hq:
    v_mov_b64 v[24:25], v[136:137]
    v_mov_b64 v[26:27], v[138:139]
    v_mov_b64 v[28:29], v[140:141]
    v_mov_b64 v[30:31], v[142:143]
    v_mov_b64 v[136:137], v[144:145]
    v_mov_b64 v[138:139], v[146:147]
    v_mov_b64 v[140:141], v[148:149]
    v_mov_b64 v[142:143], v[150:151]
    v_mov_b64 v[144:145], v[152:153]
    v_mov_b64 v[146:147], v[154:155]
    v_mov_b64 v[148:149], v[156:157]
    v_mov_b64 v[150:151], v[158:159]
    v_mov_b64 v[152:153], v[160:161]
    v_mov_b64 v[154:155], v[162:163]
    v_mov_b64 v[156:157], v[164:165]
    v_mov_b64 v[158:159], v[166:167]
    s_mov_b32 exec_hi, 0xffff
    v_lshlrev_b32 v56, 16, v24
    v_and_b32 v57, 0xffff0000, v24
    v_lshlrev_b32 v58, 16, v25
    v_and_b32 v59, 0xffff0000, v25
    v_lshlrev_b32 v60, 16, v26
    v_and_b32 v61, 0xffff0000, v26
    v_lshlrev_b32 v62, 16, v27
    v_and_b32 v63, 0xffff0000, v27
    v_pk_mul_f32 v[56:57], v[56:57], v[48:49]
    v_pk_mul_f32 v[60:61], v[60:61], v[52:53]
    v_pk_mul_f32 v[58:59], v[58:59], v[50:51]
    v_pk_mul_f32 v[62:63], v[62:63], v[54:55]
    v_cvt_pk_bf16_f32 v56, v56, v60
    v_cvt_pk_bf16_f32 v57, v57, v61
    v_cvt_pk_bf16_f32 v58, v58, v62
    v_cvt_pk_bf16_f32 v59, v59, v63
    v_and_b32 v60, 0xffff0000, v56
    v_lshlrev_b32 v56, 16, v56
    v_and_b32 v61, 0xffff0000, v57
    v_lshlrev_b32 v57, 16, v57
    v_and_b32 v62, 0xffff0000, v58
    v_lshlrev_b32 v58, 16, v58
    v_and_b32 v63, 0xffff0000, v59
    v_lshlrev_b32 v59, 16, v59
    v_pk_add_f32 v[56:57], v[56:57], v[60:61]
    v_pk_add_f32 v[58:59], v[58:59], v[62:63]
    v_cvt_pk_bf16_f32 v64, v56, v56
    v_cvt_pk_bf16_f32 v65, v57, v57
    v_cvt_pk_bf16_f32 v66, v58, v58
    v_cvt_pk_bf16_f32 v67, v59, v59
    v_xor_b32 v64, v64, v46
    v_xor_b32 v65, v65, v46
    v_xor_b32 v66, v66, v46
    v_xor_b32 v67, v67, v46
    ds_write_b16 v18, v64 offset:0
    ds_write_b16_d16_hi v19, v64 offset:2
    ds_write_b16 v18, v65 offset:4
    ds_write_b16_d16_hi v19, v65 offset:6
    ds_write_b16 v18, v66 offset:8
    ds_write_b16_d16_hi v19, v66 offset:10
    ds_write_b16 v18, v67 offset:12
    ds_write_b16_d16_hi v19, v67 offset:14
    v_lshlrev_b32 v56, 16, v28
    v_and_b32 v57, 0xffff0000, v28
    v_lshlrev_b32 v58, 16, v29
    v_and_b32 v59, 0xffff0000, v29
    v_lshlrev_b32 v60, 16, v30
    v_and_b32 v61, 0xffff0000, v30
    v_lshlrev_b32 v62, 16, v31
    v_and_b32 v63, 0xffff0000, v31
    v_pk_mul_f32 v[56:57], v[56:57], v[48:49]
    v_pk_mul_f32 v[60:61], v[60:61], v[52:53]
    v_pk_mul_f32 v[58:59], v[58:59], v[50:51]
    v_pk_mul_f32 v[62:63], v[62:63], v[54:55]
    v_cvt_pk_bf16_f32 v56, v56, v60
    v_cvt_pk_bf16_f32 v57, v57, v61
    v_cvt_pk_bf16_f32 v58, v58, v62
    v_cvt_pk_bf16_f32 v59, v59, v63
    v_and_b32 v60, 0xffff0000, v56
    v_lshlrev_b32 v56, 16, v56
    v_and_b32 v61, 0xffff0000, v57
    v_lshlrev_b32 v57, 16, v57
    v_and_b32 v62, 0xffff0000, v58
    v_lshlrev_b32 v58, 16, v58
    v_and_b32 v63, 0xffff0000, v59
    v_lshlrev_b32 v59, 16, v59
    v_pk_add_f32 v[56:57], v[56:57], v[60:61]
    v_pk_add_f32 v[58:59], v[58:59], v[62:63]
    v_cvt_pk_bf16_f32 v68, v56, v56
    v_cvt_pk_bf16_f32 v69, v57, v57
    v_cvt_pk_bf16_f32 v70, v58, v58
    v_cvt_pk_bf16_f32 v71, v59, v59
    v_xor_b32 v68, v68, v46
    v_xor_b32 v69, v69, v46
    v_xor_b32 v70, v70, v46
    v_xor_b32 v71, v71, v46
    ds_write_b16 v18, v68 offset:768
    ds_write_b16_d16_hi v19, v68 offset:770
    ds_write_b16 v18, v69 offset:772
    ds_write_b16_d16_hi v19, v69 offset:774
    ds_write_b16 v18, v70 offset:776
    ds_write_b16_d16_hi v19, v70 offset:778
    ds_write_b16 v18, v71 offset:780
    ds_write_b16_d16_hi v19, v71 offset:782
    s_mov_b32 exec_hi, -1
    ds_write_b32 v23, v5
    s_add_u32 s89, s89, 1
    v_add_u32 v18, 1536, v18
    v_add_u32 v19, 1536, v19
    v_add_u32 v23, 4, v23
    s_cmp_lt_u32 s89, 4
    s_waitcnt lgkmcnt(0)
    s_cbranch_scc1 L_hq
    s_cmp_lg_u32 s48, 0
    s_cbranch_scc1 L_epd
L_epw:
    s_sleep 1
    ds_read_b32 v19, v7
    s_waitcnt lgkmcnt(0)
    v_readlane_b32 s89, v19, 5
    s_nop 0
    s_cmp_lt_i32 s89, 72
    s_nop 2
    s_cbranch_scc1 L_epw
    s_buffer_load_dword s48, s[24:27], 0
    s_waitcnt lgkmcnt(0)
    s_cmp_lg_u32 s48, 0
    s_cbranch_scc1 L_epd
    s_mul_i32 s49, s78, 0x9e3779b1
    s_lshr_b32 s93, s49, 15
    s_xor_b32 s49, s49, s93
    s_mul_i32 s49, s49, 0x85ebca6b
    s_lshr_b32 s93, s49, 13
    s_xor_b32 s49, s49, s93
    s_max_u32 s49, s49, 1
    v_mov_b32 v14, s49
    v_mov_b32 v15, 0
    s_mov_b64 exec, 1
    buffer_atomic_cmpswap v[14:15], v4, s[24:27], 0 offen sc0 sc1
    s_waitcnt vmcnt(0)
    v_readfirstlane_b32 s48, v14
    s_mov_b64 exec, -1
    s_cmp_eq_u32 s48, 0
    s_cselect_b32 s48, s49, s48
    s_nop 1
L_epd:
    s_waitcnt vmcnt(0)
    s_lshr_b32 s49, s48, 8
    s_lshr_b32 s50, s48, 16
    s_lshr_b32 s51, s48, 24
    s_mov_b32 s79, 0
    s_mov_b32 s80, 0
    s_mov_b32 s85, 0
    s_mov_b32 s84, 0
    s_mov_b32 s83, 0
    s_mov_b32 s98, 0
    s_mov_b32 s99, 0
    s_mov_b32 s33, 0
    s_movk_i32 s81, 240
    s_mov_b32 s82, 0x7fffffff
    s_movk_i32 s68, 132
    s_mov_b32 s69, 0
    s_mov_b32 s86, 16
    s_lshr_b32 s92, s2, 4
    s_and_b32 s93, s2, 15
    s_cmp_eq_u32 s92, s93
    s_cselect_b32 s38, s92, 255
    s_mul_i32 s87, s38, 4352
    s_add_u32 s87, s87, 33554432
    s_mov_b32 s88, 33554432
    v_lshrrev_b32 v18, 5, v1
    v_lshlrev_b32 v11, 4, v18
    v_add_u32 v11, 78080, v11
    v_add_u32 v10, 65536, v2
    v_mov_b32 v20, 78080
    s_mov_b32 s39, 8
    s_and_b32 s41, s2, 0x70
    s_and_b32 s92, s2, 7
    s_lshl1_add_u32 s41, s92, s41
    s_lshr_b32 s92, s2, 7
    s_add_u32 s41, s41, s92
    s_lshl_b32 s92, s3, 7
    s_add_u32 s41, s41, s92
    s_mul_i32 s34, s2, 43691
    s_lshr_b32 s34, s34, 18
    s_lshr_b32 s40, s2, 3
    s_and_b32 s40, s40, 31
    s_mul_i32 s40, s40, 24
    s_addk_i32 s40, 1728
    s_cmp_lt_u32 s2, 192
    s_cselect_b32 s40, s40, 0x7fffffff
    s_mov_b32 s35, 0
    s_mov_b32 s36, 21495808
    s_mov_b32 s37, 0
L_hl:
    s_sleep 1
    ds_read_b32 v19, v7
    s_memrealtime s[96:97]
    s_waitcnt lgkmcnt(0)
    v_readlane_b32 s89, v19, 5
    v_readlane_b32 s90, v19, s86
    s_sub_u32 s96, s96, s78
    s_lshl_b32 s96, s96, 8
    s_mul_i32 s92, s80, s89
    s_add_u32 s92, s92, s79
    s_sub_u32 s92, s96, s92
    s_max_i32 s92, s92, s98
    s_min_i32 s92, s92, s99
    s_mul_i32 s92, s92, s35
    s_add_u32 s92, s92, s36
    s_ashr_i32 s92, s92, 20
    s_max_i32 s92, s92, 15
    s_min_i32 s92, s92, 26
    v_mov_b32 v18, s92
    ds_write_b32 v3, v18 offset:16
    s_cmp_ge_i32 s89, s82
    s_cbranch_scc1 L_rd
    s_cmp_ge_i32 s89, s81
    s_cbranch_scc1 L_pub
    s_cmp_ge_i32 s89, s68
    s_cbranch_scc1 L_tf
    s_cmp_eq_u32 s90, s39
    s_cbranch_scc1 L_prep
    s_cmp_ge_i32 s89, s40
    s_cbranch_scc1 L_wts
    s_cmp_eq_u32 s86, 14
    s_cbranch_scc0 L_hl
    s_branch L_late
L_tf:
    buffer_load_dwordx2 v[108:109], v22, s[4:7], s91 offen
    buffer_load_dwordx2 v[110:111], v22, s[8:11], s91 offen
    buffer_load_dwordx2 v[112:113], v22, s[12:15], s91 offen
    buffer_load_dwordx2 v[114:115], v22, s[16:19], s91 offen
    s_add_u32 s91, s91, 131072
    s_mov_b32 s94, 0x05040100
    s_mov_b32 s95, 0x07060302
    s_addk_i32 s68, 24
    s_cmp_ge_u32 s91, 1048576
    s_cselect_b32 s68, 0x7fffffff, s68
    s_waitcnt vmcnt(0)
    v_perm_b32 v116, v110, v108, s94
    v_perm_b32 v117, v114, v112, s94
    v_perm_b32 v118, v110, v108, s95
    v_perm_b32 v119, v114, v112, s95
    v_perm_b32 v120, v111, v109, s94
    v_perm_b32 v121, v115, v113, s94
    v_perm_b32 v122, v111, v109, s95
    v_perm_b32 v123, v115, v113, s95
    s_lshr_b32 s92, s91, 17
    v_mov_b32 v19, s92
    ds_write_b128 v12, v[116:119]
    ds_write_b128 v12, v[120:123] offset:16
    ds_write_b32 v3, v19 offset:48
    v_add_u32 v12, 2048, v12
    s_waitcnt lgkmcnt(0)
    s_nop 0
    s_branch L_hl
L_pub:
    s_cmp_eq_u32 s80, 0
    s_cselect_b32 s92, 850, s80
    s_sub_u32 s93, s89, s81
    s_mul_i32 s92, s92, s93
    s_sub_u32 s83, s96, s92
    s_add_u32 s82, s81, 72
    s_cmp_ge_u32 s81, 2544
    s_cselect_b32 s92, 4, 8
    s_mul_i32 s92, s92, 24
    s_add_u32 s81, s81, s92
    s_cmp_ge_u32 s38, 16
    s_cbranch_scc1 L_hl
    s_lshl_b32 s92, s78, 8
    s_add_u32 s92, s92, s83
    v_mov_b32 v14, s92
    v_mov_b32 v15, s48
    s_mov_b64 exec, 1
    buffer_store_dwordx2 v[14:15], v4, s[20:23], s87 offen sc0 sc1
    s_mov_b64 exec, -1
    s_add_u32 s87, s87, 69632
    s_branch L_hl
L_rd:
    s_lshl_b32 s92, s78, 8
    s_add_u32 s92, s92, s83
    s_mov_b32 s93, 0
    s_mov_b32 s94, 0
    s_buffer_load_dwordx2 s[52:53], s[20:23], s88
    s_add_u32 s88, s88, 4352
    s_buffer_load_dwordx2 s[54:55], s[20:23], s88
    s_add_u32 s88, s88, 4352
    s_buffer_load_dwordx2 s[56:57], s[20:23], s88
    s_add_u32 s88, s88, 4352
    s_buffer_load_dwordx2 s[58:59], s[20:23], s88
    s_add_u32 s88, s88, 4352
    s_buffer_load_dwordx2 s[60:61], s[20:23], s88
    s_add_u32 s88, s88, 4352
    s_buffer_load_dwordx2 s[62:63], s[20:23], s88
    s_add_u32 s88, s88, 4352
    s_buffer_load_dwordx2 s[64:65], s[20:23], s88
    s_add_u32 s88, s88, 4352
    s_buffer_load_dwordx2 s[66:67], s[20:23], s88
    s_add_u32 s88, s88, 4352
    s_waitcnt lgkmcnt(0)
    s_sub_u32 s52, s52, s92
    s_cmp_eq_u32 s53, s48
    s_cselect_b32 s52, s52, 0
    s_addc_u32 s93, s93, 0
    s_add_u32 s94, s94, s52
    s_sub_u32 s54, s54, s92
    s_cmp_eq_u32 s55, s48
    s_cselect_b32 s54, s54, 0
    s_addc_u32 s93, s93, 0
    s_add_u32 s94, s94, s54
    s_sub_u32 s56, s56, s92
    s_cmp_eq_u32 s57, s48
    s_cselect_b32 s56, s56, 0
    s_addc_u32 s93, s93, 0
    s_add_u32 s94, s94, s56
    s_sub_u32 s58, s58, s92
    s_cmp_eq_u32 s59, s48
    s_cselect_b32 s58, s58, 0
    s_addc_u32 s93, s93, 0
    s_add_u32 s94, s94, s58
    s_sub_u32 s60, s60, s92
    s_cmp_eq_u32 s61, s48
    s_cselect_b32 s60, s60, 0
    s_addc_u32 s93, s93, 0
    s_add_u32 s94, s94, s60
    s_sub_u32 s62, s62, s92
    s_cmp_eq_u32 s63, s48
    s_cselect_b32 s62, s62, 0
    s_addc_u32 s93, s93, 0
    s_add_u32 s94, s94, s62
    s_sub_u32 s64, s64, s92
    s_cmp_eq_u32 s65, s48
    s_cselect_b32 s64, s64, 0
    s_addc_u32 s93, s93, 0
    s_add_u32 s94, s94, s64
    s_sub_u32 s66, s66, s92
    s_cmp_eq_u32 s67, s48
    s_cselect_b32 s66, s66, 0
    s_addc_u32 s93, s93, 0
    s_add_u32 s94, s94, s66
    s_buffer_load_dwordx2 s[52:53], s[20:23], s88
    s_add_u32 s88, s88, 4352
    s_buffer_load_dwordx2 s[54:55], s[20:23], s88
    s_add_u32 s88, s88, 4352
    s_buffer_load_dwordx2 s[56:57], s[20:23], s88
    s_add_u32 s88, s88, 4352
    s_buffer_load_dwordx2 s[58:59], s[20:23], s88
    s_add_u32 s88, s88, 4352
    s_buffer_load_dwordx2 s[60:61], s[20:23], s88
    s_add_u32 s88, s88, 4352
    s_buffer_load_dwordx2 s[62:63], s[20:23], s88
    s_add_u32 s88, s88, 4352
    s_buffer_load_dwordx2 s[64:65], s[20:23], s88
    s_add_u32 s88, s88, 4352
    s_buffer_load_dwordx2 s[66:67], s[20:23], s88
    s_add_u32 s88, s88, 4352
    s_waitcnt lgkmcnt(0)
    s_sub_u32 s52, s52, s92
    s_cmp_eq_u32 s53, s48
    s_cselect_b32 s52, s52, 0
    s_addc_u32 s93, s93, 0
    s_add_u32 s94, s94, s52
    s_sub_u32 s54, s54, s92
    s_cmp_eq_u32 s55, s48
    s_cselect_b32 s54, s54, 0
    s_addc_u32 s93, s93, 0
    s_add_u32 s94, s94, s54
    s_sub_u32 s56, s56, s92
    s_cmp_eq_u32 s57, s48
    s_cselect_b32 s56, s56, 0
    s_addc_u32 s93, s93, 0
    s_add_u32 s94, s94, s56
    s_sub_u32 s58, s58, s92
    s_cmp_eq_u32 s59, s48
    s_cselect_b32 s58, s58, 0
    s_addc_u32 s93, s93, 0
    s_add_u32 s94, s94, s58
    s_sub_u32 s60, s60, s92
    s_cmp_eq_u32 s61, s48
    s_cselect_b32 s60, s60, 0
    s_addc_u32 s93, s93, 0
    s_add_u32 s94, s94, s60
    s_sub_u32 s62, s62, s92
    s_cmp_eq_u32 s63, s48
    s_cselect_b32 s62, s62, 0
    s_addc_u32 s93, s93, 0
    s_add_u32 s94, s94, s62
    s_sub_u32 s64, s64, s92
    s_cmp_eq_u32 s65, s48
    s_cselect_b32 s64, s64, 0
    s_addc_u32 s93, s93, 0
    s_add_u32 s94, s94, s64
    s_sub_u32 s66, s66, s92
    s_cmp_eq_u32 s67, s48
    s_cselect_b32 s66, s66, 0
    s_addc_u32 s93, s93, 0
    s_add_u32 s94, s94, s66
    v_cvt_f32_u32 v15, s93
    v_cvt_f32_i32 v14, s94
    v_rcp_f32 v15, v15
    s_nop 0
    v_mul_f32 v14, v14, v15
    v_cvt_i32_f32 v14, v14
    s_sub_u32 s94, s82, 72
    s_mov_b32 s82, 0x7fffffff
    v_readfirstlane_b32 s92, v14
    s_mov_b32 s95, s85
    s_min_u32 s85, s93, 1
    s_cmp_eq_u32 s93, 0
    s_nop 1
    s_cbranch_scc1 L_hl
    s_sub_u32 s98, 0, s92
    s_movk_i32 s35, 150
    s_mov_b32 s36, 21495808
    s_movk_i32 s93, 6400
    s_cmp_ge_u32 s94, 2544
    s_cmovk_i32 s35, 350
    s_cmov_b32 s36, 21495808
    s_cmovk_i32 s93, 12800
    s_add_u32 s36, s36, s37
    s_max_i32 s99, s98, 0
    s_min_i32 s98, s98, 0
    s_add_u32 s99, s99, s93
    s_sub_u32 s98, s98, s93
    s_min_i32 s99, s99, 1048576
    s_max_i32 s98, s98, -1048576
    s_add_u32 s92, s92, s83
    s_sub_u32 s93, s92, s84
    s_mov_b32 s84, s92
    s_mov_b32 s80, 22369621
    s_cmp_gt_u32 s94, 2544
    s_cmov_b32 s80, 44739243
    s_mul_hi_u32 s93, s93, s80
    s_cmp_eq_u32 s95, 0
    s_cselect_b32 s80, 850, s93
    s_max_u32 s80, s80, 1
    s_mul_i32 s93, s80, s94
    s_sub_u32 s79, s92, s93
    s_branch L_hl
L_prep:
    s_cmp_ge_u32 s86, 24
    s_cbranch_scc1 L_mrg
    ds_read_b128 v[24:27], v9
    ds_read_b128 v[28:31], v9 offset:16
    s_add_u32 s86, s86, 1
    s_sub_u32 s92, s86, 16
    s_lshl_b32 s92, s92, 1
    v_mov_b32 v23, s92
    s_waitcnt lgkmcnt(0)
    v_max_f32 v40, v24, v26
    v_max3_f32 v40, v40, v28, v30
    v_lshlrev_b32 v32, 16, v25
    v_lshlrev_b32 v33, 16, v27
    v_lshlrev_b32 v34, 16, v29
    v_lshlrev_b32 v35, 16, v31
    v_max_f32_dpp v40, v40, v40 quad_perm:[1,0,3,2] row_mask:0xf bank_mask:0xf
    s_nop 1
    v_max_f32_dpp v40, v40, v40 quad_perm:[2,3,0,1] row_mask:0xf bank_mask:0xf
    s_nop 1
    v_max_f32_dpp v40, v40, v40 row_half_mirror row_mask:0xf bank_mask:0xf
    s_nop 1
    v_max_f32_dpp v40, v40, v40 row_mirror row_mask:0xf bank_mask:0xf
    v_and_b32 v36, 0xffff0000, v25
    v_and_b32 v37, 0xffff0000, v27
    v_and_b32 v38, 0xffff0000, v29
    v_and_b32 v39, 0xffff0000, v31
    v_mov_b32 v6, v40
    s_nop 1
    v_permlane16_swap_b32 v40, v6
    v_max_f32 v40, v40, v6
    v_sub_f32 v24, v24, v40
    v_sub_f32 v26, v26, v40
    v_sub_f32 v28, v28, v40
    v_sub_f32 v30, v30, v40
    v_exp_f32 v24, v24
    v_exp_f32 v26, v26
    v_exp_f32 v28, v28
    v_exp_f32 v30, v30
    v_add_f32 v42, v24, v26
    v_add_f32 v6, v28, v30
    v_add_f32 v42, v42, v6
    v_mul_f32 v24, v24, v32
    v_mul_f32 v26, v26, v33
    v_mul_f32 v28, v28, v34
    v_mul_f32 v30, v30, v35
    ds_write_b128 v9, v[24:27]
    ds_write_b128 v9, v[28:31] offset:16
    v_mul_f32 v41, v24, v36
    v_fmac_f32 v41, v26, v37
    v_fmac_f32 v41, v28, v38
    v_fmac_f32 v41, v30, v39
    v_add_f32_dpp v42, v42, v42 quad_perm:[1,0,3,2] row_mask:0xf bank_mask:0xf
    s_nop 0
    v_add_f32_dpp v41, v41, v41 quad_perm:[1,0,3,2] row_mask:0xf bank_mask:0xf
    v_add_f32_dpp v42, v42, v42 quad_perm:[2,3,0,1] row_mask:0xf bank_mask:0xf
    s_nop 0
    v_add_f32_dpp v41, v41, v41 quad_perm:[2,3,0,1] row_mask:0xf bank_mask:0xf
    v_add_f32_dpp v42, v42, v42 row_half_mirror row_mask:0xf bank_mask:0xf
    s_nop 0
    v_add_f32_dpp v41, v41, v41 row_half_mirror row_mask:0xf bank_mask:0xf
    v_add_f32_dpp v42, v42, v42 row_mirror row_mask:0xf bank_mask:0xf
    s_nop 0
    v_add_f32_dpp v41, v41, v41 row_mirror row_mask:0xf bank_mask:0xf
    v_mov_b32 v6, v42
    s_nop 1
    v_permlane16_swap_b32 v42, v6
    v_add_f32 v42, v42, v6
    v_mov_b32 v6, v41
    s_nop 1
    v_permlane16_swap_b32 v41, v6
    v_add_f32 v41, v41, v6
    v_sub_f32 v41, 0, v41
    v_mov_b32 v43, v41
    ds_write_b128 v11, v[40:43]
    ds_write_b32 v3, v23 offset:52
    v_add_u32 v9, 2048, v9
    v_add_u32 v11, 32, v11
    s_cmp_eq_u32 s86, 24
    s_waitcnt lgkmcnt(0)
    s_cbranch_scc0 L_hl
    v_add_u32 v9, 49152, v2
    s_mov_b32 s39, 4
    v_add_u32 v18, 78080, v2
    s_mov_b64 exec, 0xffff
    ds_read_b128 v[24:27], v18
    s_lshl_b32 s92, s41, 8
    s_add_u32 s92, s92, 8388608
    s_waitcnt lgkmcnt(0)
    v_mov_b32 v25, s48
    v_mov_b32 v27, s48
    buffer_store_dwordx4 v[24:27], v2, s[20:23], s92 offen sc0 sc1
    s_mov_b64 exec, -1
    s_waitcnt vmcnt(0)
    s_branch L_hl
L_wts:
    s_and_b32 s92, s34, 1
    s_lshl_b32 s92, s92, 15
    s_lshr_b32 s93, s34, 1
    s_lshl4_add_u32 s92, s93, s92
    s_add_u32 s92, s92, 8388608
    s_add_u32 s93, s92, 16384
    v_lshlrev_b32 v18, 8, v1
    s_cmp_eq_u32 s33, 0
    s_nop 0
    s_cbranch_scc0 L_wt1
    buffer_load_dwordx4 v[24:27], v18, s[20:23], s92 offen
    buffer_load_dwordx4 v[28:31], v18, s[20:23], s93 offen
    s_branch L_wt2
L_wt1:
    buffer_load_dwordx4 v[24:27], v18, s[20:23], s92 offen sc0 sc1
    buffer_load_dwordx4 v[28:31], v18, s[20:23], s93 offen sc0 sc1
L_wt2:
    s_add_u32 s33, s33, 1
    s_add_u32 s40, s89, 24
    s_min_i32 s40, s40, 2904
    v_and_b32 v18, 7, v1
    v_lshlrev_b32 v18, 6, v18
    v_lshrrev_b32 v19, 3, v1
    v_lshl_add_u32 v18, v19, 2, v18
    s_waitcnt vmcnt(0)
    v_xor_b32 v23, s48, v25
    v_bitop3_b32 v23, v23, v27, s48 bitop3:0xf6
    v_bitop3_b32 v23, v23, v29, s48 bitop3:0xf6
    v_bitop3_b32 v23, v23, v31, s48 bitop3:0xf6
    v_cmp_ne_u32 vcc, 0, v23
    s_cmp_gt_u32 s33, 200000
    s_nop 3
    s_cbranch_scc1 L_wt3
    s_cbranch_vccnz L_hl
L_wt3:
    s_mov_b32 s40, 0x7fffffff
    v_max_f32 v23, v24, v28
    s_nop 1
    v_max_f32_dpp v23, v23, v23 quad_perm:[1,0,3,2] row_mask:0xf bank_mask:0xf
    s_nop 1
    v_max_f32_dpp v23, v23, v23 quad_perm:[2,3,0,1] row_mask:0xf bank_mask:0xf
    s_nop 1
    v_max_f32_dpp v23, v23, v23 row_half_mirror row_mask:0xf bank_mask:0xf
    s_nop 1
    v_max_f32_dpp v23, v23, v23 row_mirror row_mask:0xf bank_mask:0xf
    v_mov_b32 v6, v23
    s_nop 1
    v_permlane32_swap_b32 v23, v6
    v_max_f32 v23, v23, v6
    v_mov_b32 v6, v23
    s_nop 1
    v_permlane16_swap_b32 v23, v6
    v_max_f32 v23, v23, v6
    v_sub_f32 v24, v24, v23
    v_sub_f32 v28, v28, v23
    v_exp_f32 v24, v24
    v_exp_f32 v28, v28
    v_mul_f32 v23, v24, v26
    v_fmac_f32 v23, v28, v30
    s_nop 1
    v_add_f32_dpp v23, v23, v23 quad_perm:[1,0,3,2] row_mask:0xf bank_mask:0xf
    s_nop 1
    v_add_f32_dpp v23, v23, v23 quad_perm:[2,3,0,1] row_mask:0xf bank_mask:0xf
    s_nop 1
    v_add_f32_dpp v23, v23, v23 row_half_mirror row_mask:0xf bank_mask:0xf
    s_nop 1
    v_add_f32_dpp v23, v23, v23 row_mirror row_mask:0xf bank_mask:0xf
    v_mov_b32 v6, v23
    s_nop 1
    v_permlane32_swap_b32 v23, v6
    v_add_f32 v23, v23, v6
    v_mov_b32 v6, v23
    s_nop 1
    v_permlane16_swap_b32 v23, v6
    v_add_f32 v23, v23, v6
    v_rcp_f32 v23, v23
    s_nop 0
    v_mul_f32 v24, v24, v23
    v_mul_f32 v28, v28, v23
    v_add_u32 v18, 78336, v18
    ds_write2_b32 v18, v24, v28 offset0:0 offset1:8
    v_mov_b32 v19, s48
    ds_write_b32 v3, v19 offset:24
    s_waitcnt lgkmcnt(0)
    s_branch L_hl
L_mrg:
    ds_read_b32 v104, v20 offset:4
    ds_read_b128 v[88:91], v10 offset:0
    ds_read_b128 v[92:95], v10 offset:768
    ds_read_b128 v[96:99], v10 offset:1536
    ds_read_b128 v[100:103], v10 offset:2304
    s_add_u32 s86, s86, 1
    s_sub_u32 s92, s86, 24
    v_mov_b32 v23, s92
    ds_write_b32 v3, v23 offset:60
    s_and_b32 s92, s92, 3
    s_cselect_b32 s92, 1, -3
    s_mul_i32 s92, s92, 3072
    v_add_u32 v10, s92, v10
    v_add_u32 v20, 16, v20
    s_cmp_eq_u32 s86, 39
    s_cselect_b32 s86, 14, s86
    s_waitcnt lgkmcnt(0)
    v_pk_add_f32 v[88:89], v[88:89], v[104:105] op_sel:[0,0] op_sel_hi:[1,0]
    v_pk_add_f32 v[90:91], v[90:91], v[104:105] op_sel:[0,0] op_sel_hi:[1,0]
    v_pk_add_f32 v[92:93], v[92:93], v[96:97]
    v_pk_add_f32 v[94:95], v[94:95], v[98:99]
    v_pk_add_f32 v[88:89], v[88:89], v[100:101]
    v_pk_add_f32 v[90:91], v[90:91], v[102:103]
    v_pk_add_f32 v[88:89], v[88:89], v[92:93]
    v_pk_add_f32 v[90:91], v[90:91], v[94:95]
    v_bfi_b32 v84, v5, s48, v88
    v_bfi_b32 v85, v5, s49, v89
    v_bfi_b32 v86, v5, s50, v90
    v_bfi_b32 v87, v5, s51, v91
    ds_write_b128 v9, v[84:87]
    v_add_u32 v9, 1024, v9
    s_waitcnt lgkmcnt(0)
    s_nop 0
    s_branch L_hl
L_late:
    s_getpc_b64 s[92:93]
    v_lshlrev_b32 v19, 7, v1
    v_min_u32 v19, L_end-L_late-4, v19
    s_mov_b64 exec, 0xff
    global_load_dword v6, v19, s[92:93]
    s_mov_b64 exec, -1
    s_mul_i32 s32, s41, 768
    s_add_u32 s39, s32, 2949120
    s_mul_i32 s42, s80, 3112
    s_add_u32 s42, s42, s79
    s_cmp_eq_u32 s80, 0
    s_cselect_b32 s42, -2, s42
    s_min_u32 s42, s42, -2
    v_add_u32 v9, 49152, v2
    ds_read_b128 v[24:27], v9 offset:0
    ds_read_b128 v[28:31], v9 offset:1024
    ds_read_b128 v[32:35], v9 offset:2048
    ds_read_b128 v[36:39], v9 offset:3072
    ds_read_b128 v[40:43], v9 offset:4096
    ds_read_b128 v[44:47], v9 offset:5120
    ds_read_b128 v[48:51], v9 offset:6144
    ds_read_b128 v[52:55], v9 offset:7168
    ds_read_b128 v[56:59], v9 offset:8192
    ds_read_b128 v[60:63], v9 offset:9216
    s_waitcnt lgkmcnt(0)
    ds_read_b128 v[64:67], v9 offset:10240
    ds_read_b128 v[68:71], v9 offset:11264
    ds_read_b128 v[72:75], v9 offset:12288
    ds_read_b128 v[76:79], v9 offset:13312
    ds_read_b128 v[80:83], v9 offset:14336
    ds_read_b32 v104, v20 offset:4
    s_mov_b32 exec_hi, 0xffff
L_w7:
    ds_read_b32 v19, v7
    ds_read_b128 v[88:91], v10 offset:0
    ds_read_b128 v[92:95], v10 offset:768
    ds_read_b128 v[96:99], v10 offset:1536
    ds_read_b128 v[100:103], v10 offset:2304
    s_memrealtime s[96:97]
    s_waitcnt lgkmcnt(0)
    v_readlane_b32 s92, v19, 39
    v_readlane_b32 s89, v19, 5
    s_cmp_eq_u32 s92, 4
    s_nop 3
    s_cbranch_scc1 L_g7
    s_sub_u32 s96, s96, s78
    s_lshl_b32 s96, s96, 8
    s_cmp_ge_i32 s89, 3084
    s_cbranch_scc1 L_ns7
    s_mul_i32 s92, s80, s89
    s_add_u32 s92, s92, s79
    s_sub_u32 s92, s96, s92
    s_max_i32 s92, s92, s98
    s_min_i32 s92, s92, s99
    s_mul_i32 s92, s92, s35
    s_add_u32 s92, s92, s36
    s_ashr_i32 s92, s92, 20
    s_max_i32 s92, s92, 15
    s_min_i32 s92, s92, 26
    v_mov_b32 v18, s92
    ds_write_b32 v3, v18 offset:16
    s_nop 0
L_ns7:
    s_cmp_lt_u32 s96, s42
    s_cbranch_scc1 L_w7
    buffer_store_dwordx4 v[24:27], v2, s[20:23], s32 offen sc0 sc1
    s_add_u32 s32, s32, 196608
    buffer_store_dwordx4 v[28:31], v2, s[20:23], s32 offen sc0 sc1
    s_add_u32 s32, s32, 196608
    buffer_store_dwordx4 v[32:35], v2, s[20:23], s32 offen sc0 sc1
    s_add_u32 s32, s32, 196608
    buffer_store_dwordx4 v[36:39], v2, s[20:23], s32 offen sc0 sc1
    s_add_u32 s32, s32, 196608
    buffer_store_dwordx4 v[40:43], v2, s[20:23], s32 offen sc0 sc1
    s_add_u32 s32, s32, 196608
    buffer_store_dwordx4 v[44:47], v2, s[20:23], s32 offen sc0 sc1
    s_add_u32 s32, s32, 196608
    buffer_store_dwordx4 v[48:51], v2, s[20:23], s32 offen sc0 sc1
    s_add_u32 s32, s32, 196608
    buffer_store_dwordx4 v[52:55], v2, s[20:23], s32 offen sc0 sc1
    s_add_u32 s32, s32, 196608
    buffer_store_dwordx4 v[56:59], v2, s[20:23], s32 offen sc0 sc1
    s_add_u32 s32, s32, 196608
    buffer_store_dwordx4 v[60:63], v2, s[20:23], s32 offen sc0 sc1
    s_add_u32 s32, s32, 196608
    buffer_store_dwordx4 v[64:67], v2, s[20:23], s32 offen sc0 sc1
    s_add_u32 s32, s32, 196608
    buffer_store_dwordx4 v[68:71], v2, s[20:23], s32 offen sc0 sc1
    s_add_u32 s32, s32, 196608
    buffer_store_dwordx4 v[72:75], v2, s[20:23], s32 offen sc0 sc1
    s_add_u32 s32, s32, 196608
    buffer_store_dwordx4 v[76:79], v2, s[20:23], s32 offen sc0 sc1
    s_add_u32 s32, s32, 196608
    buffer_store_dwordx4 v[80:83], v2, s[20:23], s32 offen sc0 sc1
    s_mov_b32 s42, -1
    s_nop 0
    s_branch L_w7
L_g7:
    v_pk_add_f32 v[88:89], v[88:89], v[104:105] op_sel:[0,0] op_sel_hi:[1,0]
    v_pk_add_f32 v[90:91], v[90:91], v[104:105] op_sel:[0,0] op_sel_hi:[1,0]
    v_pk_add_f32 v[92:93], v[92:93], v[96:97]
    v_pk_add_f32 v[94:95], v[94:95], v[98:99]
    v_pk_add_f32 v[88:89], v[88:89], v[100:101]
    v_pk_add_f32 v[90:91], v[90:91], v[102:103]
    v_pk_add_f32 v[88:89], v[88:89], v[92:93]
    v_pk_add_f32 v[90:91], v[90:91], v[94:95]
    v_bfi_b32 v84, v5, s48, v88
    v_bfi_b32 v85, v5, s49, v89
    v_bfi_b32 v86, v5, s50, v90
    v_bfi_b32 v87, v5, s51, v91
    buffer_store_dwordx4 v[84:87], v2, s[20:23], s39 offen sc0 sc1
    s_cmp_eq_u32 s42, -1
    s_nop 0
    s_cbranch_scc1 L_hend
    buffer_store_dwordx4 v[24:27], v2, s[20:23], s32 offen sc0 sc1
    s_add_u32 s32, s32, 196608
    buffer_store_dwordx4 v[28:31], v2, s[20:23], s32 offen sc0 sc1
    s_add_u32 s32, s32, 196608
    buffer_store_dwordx4 v[32:35], v2, s[20:23], s32 offen sc0 sc1
    s_add_u32 s32, s32, 196608
    buffer_store_dwordx4 v[36:39], v2, s[20:23], s32 offen sc0 sc1
    s_add_u32 s32, s32, 196608
    buffer_store_dwordx4 v[40:43], v2, s[20:23], s32 offen sc0 sc1
    s_add_u32 s32, s32, 196608
    buffer_store_dwordx4 v[44:47], v2, s[20:23], s32 offen sc0 sc1
    s_add_u32 s32, s32, 196608
    buffer_store_dwordx4 v[48:51], v2, s[20:23], s32 offen sc0 sc1
    s_add_u32 s32, s32, 196608
    buffer_store_dwordx4 v[52:55], v2, s[20:23], s32 offen sc0 sc1
    s_add_u32 s32, s32, 196608
    buffer_store_dwordx4 v[56:59], v2, s[20:23], s32 offen sc0 sc1
    s_add_u32 s32, s32, 196608
    buffer_store_dwordx4 v[60:63], v2, s[20:23], s32 offen sc0 sc1
    s_add_u32 s32, s32, 196608
    buffer_store_dwordx4 v[64:67], v2, s[20:23], s32 offen sc0 sc1
    s_add_u32 s32, s32, 196608
    buffer_store_dwordx4 v[68:71], v2, s[20:23], s32 offen sc0 sc1
    s_add_u32 s32, s32, 196608
    buffer_store_dwordx4 v[72:75], v2, s[20:23], s32 offen sc0 sc1
    s_add_u32 s32, s32, 196608
    buffer_store_dwordx4 v[76:79], v2, s[20:23], s32 offen sc0 sc1
    s_add_u32 s32, s32, 196608
    buffer_store_dwordx4 v[80:83], v2, s[20:23], s32 offen sc0 sc1
    s_mov_b32 s42, -1
    s_nop 0
L_hend:
    v_mov_b32 v18, 2
    s_waitcnt vmcnt(14)
    ds_write_b32 v3, v18 offset:32
    v_mov_b32 v18, 3
    s_waitcnt vmcnt(13)
    ds_write_b32 v3, v18 offset:32
    v_mov_b32 v18, 4
    s_waitcnt vmcnt(12)
    ds_write_b32 v3, v18 offset:32
    v_mov_b32 v18, 5
    s_waitcnt vmcnt(11)
    ds_write_b32 v3, v18 offset:32
    v_mov_b32 v18, 6
    s_waitcnt vmcnt(10)
    ds_write_b32 v3, v18 offset:32
    v_mov_b32 v18, 7
    s_waitcnt vmcnt(9)
    ds_write_b32 v3, v18 offset:32
    v_mov_b32 v18, 8
    s_waitcnt vmcnt(8)
    ds_write_b32 v3, v18 offset:32
    v_mov_b32 v18, 9
    s_waitcnt vmcnt(7)
    ds_write_b32 v3, v18 offset:32
    v_mov_b32 v18, 10
    s_waitcnt vmcnt(6)
    ds_write_b32 v3, v18 offset:32
    v_mov_b32 v18, 11
    s_waitcnt vmcnt(5)
    ds_write_b32 v3, v18 offset:32
    v_mov_b32 v18, 12
    s_waitcnt vmcnt(4)
    ds_write_b32 v3, v18 offset:32
    v_mov_b32 v18, 13
    s_waitcnt vmcnt(3)
    ds_write_b32 v3, v18 offset:32
    v_mov_b32 v18, 14
    s_waitcnt vmcnt(2)
    ds_write_b32 v3, v18 offset:32
    v_mov_b32 v18, 15
    s_waitcnt vmcnt(1)
    ds_write_b32 v3, v18 offset:32
    v_mov_b32 v18, 16
    s_waitcnt vmcnt(0)
    ds_write_b32 v3, v18 offset:32
    s_waitcnt lgkmcnt(0)
L_end:
    s_endpgm
.section .rodata,"a"
.p2align 6
.amdhsa_kernel standalone__kv_cache_quant_pre_rope_vs_post_rope__decode_kernel
  .amdhsa_next_free_vgpr 168
  .amdhsa_next_free_sgpr 102
  .amdhsa_accum_offset 168
  .amdhsa_group_segment_fixed_size 0
  .amdhsa_kernarg_size 112
  .amdhsa_user_sgpr_count 2
  .amdhsa_user_sgpr_kernarg_segment_ptr 1
  .amdhsa_system_sgpr_workgroup_id_x 1
.end_amdhsa_kernel
```

```asm
; @launch grid=(256,1,1) block=(384,1,1) lds=79872
.amdgcn_target "amdgcn-amd-amdhsa--gfx950"
.text
.globl standalone__kv_cache_quant_pre_rope_vs_post_rope__decode_kernel
.p2align 8
.type standalone__kv_cache_quant_pre_rope_vs_post_rope__decode_kernel,@function
standalone__kv_cache_quant_pre_rope_vs_post_rope__decode_kernel:
    s_load_dwordx16 s[48:63], s[0:1], 0
    s_load_dwordx8 s[64:71], s[0:1], 64
    s_load_dwordx4 s[72:75], s[0:1], 96
    s_cmp_ge_u32 s2, 256
    s_cbranch_scc1 L_end
    v_lshrrev_b32 v18, 6, v0
    v_and_b32 v1, 63, v0
    v_readfirstlane_b32 s76, v18
    v_cmp_eq_u32 vcc, 4, v1
    v_lshlrev_b32 v7, 2, v1
    v_add_u32 v7, 77824, v7
    v_cndmask_b32 v19, 0, 20, vcc
    ds_write_b32 v7, v19
    s_and_b32 s92, s2, 7
    s_lshl_b32 s77, s92, 6
    s_and_b32 s92, s2, 0x60
    s_lshl4_add_u32 s77, s92, s77
    s_and_b32 s92, s2, 0x10
    s_lshl1_add_u32 s77, s92, s77
    s_lshr_b32 s92, s2, 7
    s_lshl4_add_u32 s77, s92, s77
    s_bfe_u32 s3, s2, 0x10003
    s_mul_i32 s92, s3, 8192
    s_add_u32 s77, s77, s92
    s_cmp_lg_u32 s76, 0
    s_cbranch_scc1 L_other
    s_setprio 3
    v_lshlrev_b32 v2, 4, v1
    v_add_u32 v8, 784896, v2
    v_cmp_gt_u32 vcc, 32, v1
    s_mul_i32 s78, s77, 384
    s_mov_b32 s6, 6291456
    s_mov_b32 s7, 0x20000
    v_cndmask_b32 v4, v8, v2, vcc
    s_mov_b32 m0, 0
    s_mov_b32 s81, 0
    v_mov_b32 v6, 77844
    v_mov_b32 v5, -20
    s_waitcnt lgkmcnt(0)
    s_mov_b64 s[4:5], s[66:67]
L_i0:
    s_waitcnt vmcnt(19)
    buffer_load_dwordx4 v2, s[4:7], s78 offen offset:0  lds
    v_add_u32 v5, 3, v5
    s_add_u32 s81, s81, 1
    s_waitcnt vmcnt(19)
    buffer_load_dwordx4 v4, s[4:7], s78 offen offset:1024  lds
    s_and_b32 s92, s81, 3
    s_cselect_b32 s92, 0, -6144
    s_cmp_eq_u32 s81, 8
    s_cselect_b32 s93, 1572864, 0
    s_add_u32 s92, s92, s93
    s_bitcmp1_b32 s81, 2
    s_waitcnt vmcnt(19)
    buffer_load_dwordx4 v8, s[4:7], s78 offen offset:2048  lds
    ds_write_b32 v6, v5
    s_cselect_b64 s[4:5], s[68:69], s[66:67]
    s_addk_i32 m0, 3072
    s_addk_i32 s92, 1536
    s_add_u32 s78, s78, s92
    s_cmp_lg_u32 s81, 6
    s_cbranch_scc1 L_i1
    s_barrier
L_i1:
    s_cmp_lt_u32 s81, 16
    s_cbranch_scc1 L_i0
    ds_read_b32 v3, v7
    s_mul_i32 s79, s3, 12582912
    s_mov_b64 s[4:5], s[50:51]
    s_mov_b32 s6, 402653184
    s_mov_b32 s7, 0x20000
    s_mov_b32 m0, 0
    s_movk_i32 s85, 4096
    s_mov_b32 s81, 0
    s_mul_i32 s78, s77, 768
    s_add_u32 s78, s78, s79
    s_mov_b32 s82, 1
    s_waitcnt lgkmcnt(0)
    v_readlane_b32 s84, v3, 0
    s_nop 4
L_D20:
    s_mul_i32 s92, s81, 12
    s_add_u32 s92, s92, 28
    v_mov_b32 v5, s92
L_B20:
L_B20_0:
    s_cmp_lt_i32 s84, s82
    s_cbranch_scc1 L_B20_0w
    s_waitcnt vmcnt(19)
    buffer_load_dwordx4 v2, s[4:7], s78 offen offset:0 nt lds
    v_add_u32 v5, 3, v5
    s_add_u32 s81, s81, 1
    s_and_b32 s92, s81, 7
    s_waitcnt vmcnt(19)
    buffer_load_dwordx4 v2, s[4:7], s78 offen offset:1024 nt lds
    v_readlane_b32 s84, v3, 1
    ds_read_b32 v3, v7
    s_lshl_b32 s92, s92, 11
    s_waitcnt vmcnt(19)
    buffer_load_dwordx4 v2, s[4:7], s78 offen offset:2048 nt lds
    ds_write_b32 v6, v5
    s_add_u32 s92, s92, s77
    s_and_b32 s92, s92, 16383
L_B20_1:
    s_cmp_lt_i32 s84, s82
    s_cbranch_scc1 L_B20_1w
    s_waitcnt vmcnt(19)
    buffer_load_dwordx4 v2, s[4:7], s78 offen offset:3072 nt lds
    v_add_u32 v5, 3, v5
    s_add_u32 m0, m0, s85
    s_add_u32 s78, s78, s85
    s_waitcnt vmcnt(19)
    buffer_load_dwordx4 v2, s[4:7], s78 offen offset:0 nt lds
    v_readlane_b32 s84, v3, 2
    ds_read_b32 v3, v7
    s_mul_i32 s80, s92, 768
    s_waitcnt vmcnt(19)
    buffer_load_dwordx4 v2, s[4:7], s78 offen offset:1024 nt lds
    ds_write_b32 v6, v5
    s_bfe_u32 s92, s81, 0x40003
    s_mul_i32 s92, s92, 25165824
L_B20_2:
    s_cmp_lt_i32 s84, s82
    s_cbranch_scc1 L_B20_2w
    s_waitcnt vmcnt(19)
    buffer_load_dwordx4 v2, s[4:7], s78 offen offset:2048 nt lds
    v_add_u32 v5, 3, v5
    s_add_u32 s80, s80, s79
    s_add_u32 s80, s80, s92
    s_waitcnt vmcnt(19)
    buffer_load_dwordx4 v2, s[4:7], s78 offen offset:3072 nt lds
    v_readlane_b32 s84, v3, 3
    ds_read_b32 v3, v7
    s_add_u32 m0, m0, s85
    s_add_u32 s78, s78, s85
    s_waitcnt vmcnt(19)
    buffer_load_dwordx4 v2, s[4:7], s78 offen offset:0 nt lds
    ds_write_b32 v6, v5
    s_and_b32 s86, s81, 3
    s_mul_i32 s86, s86, 12288
L_B20_3:
    s_cmp_lt_i32 s84, s82
    s_cbranch_scc1 L_B20_3w
    s_waitcnt vmcnt(19)
    buffer_load_dwordx4 v2, s[4:7], s78 offen offset:1024 nt lds
    v_add_u32 v5, 3, v5
    v_readlane_b32 s83, v3, 4
    s_waitcnt vmcnt(19)
    buffer_load_dwordx4 v2, s[4:7], s78 offen offset:2048 nt lds
    v_readlane_b32 s84, v3, 0
    ds_read_b32 v3, v7
    s_add_u32 s82, s82, 1
    s_cmp_ge_u32 s81, 255
    s_cselect_b32 s83, -1, s83
    s_cmp_ge_u32 s81, 128
    s_waitcnt vmcnt(19)
    buffer_load_dwordx4 v2, s[4:7], s78 offen offset:3072 nt lds
    ds_write_b32 v6, v5
    s_cselect_b64 s[4:5], s[56:57], s[50:51]
    s_mov_b32 m0, s86
    s_mov_b32 s78, s80
    s_cmp_eq_u32 s83, 20
    s_cbranch_scc1 L_B20
L_disp:
    s_cmp_eq_u32 s83, 20
    s_cbranch_scc1 L_D20
    s_cmp_eq_u32 s83, 21
    s_cbranch_scc1 L_D21
    s_cmp_eq_u32 s83, 19
    s_cbranch_scc1 L_D19
    s_cmp_eq_u32 s83, 22
    s_cbranch_scc1 L_D22
    s_cmp_eq_u32 s83, 18
    s_cbranch_scc1 L_D18
    s_cmp_eq_u32 s83, 23
    s_cbranch_scc1 L_D23
    s_cmp_eq_u32 s83, 17
    s_cbranch_scc1 L_D17
    s_cmp_eq_u32 s83, 24
    s_cbranch_scc1 L_D24
    s_cmp_eq_u32 s83, 16
    s_cbranch_scc1 L_D16
    s_cmp_eq_u32 s83, 25
    s_cbranch_scc1 L_D25
    s_cmp_eq_u32 s81, 256
    s_cbranch_scc1 L_drain
    s_cmp_ge_u32 s81, 255
    s_cbranch_scc1 L_D32
    s_cmp_ge_i32 s83, 26
    s_cbranch_scc1 L_D26
    s_branch L_D15
L_D19:
    s_mul_i32 s92, s81, 12
    s_add_u32 s92, s92, 29
    v_mov_b32 v5, s92
L_B19:
L_B19_0:
    s_cmp_lt_i32 s84, s82
    s_cbranch_scc1 L_B19_0w
    s_waitcnt vmcnt(18)
    buffer_load_dwordx4 v2, s[4:7], s78 offen offset:0 nt lds
    v_add_u32 v5, 3, v5
    s_add_u32 s81, s81, 1
    s_and_b32 s92, s81, 7
    s_waitcnt vmcnt(18)
    buffer_load_dwordx4 v2, s[4:7], s78 offen offset:1024 nt lds
    v_readlane_b32 s84, v3, 1
    ds_read_b32 v3, v7
    s_lshl_b32 s92, s92, 11
    s_waitcnt vmcnt(18)
    buffer_load_dwordx4 v2, s[4:7], s78 offen offset:2048 nt lds
    ds_write_b32 v6, v5
    s_add_u32 s92, s92, s77
    s_and_b32 s92, s92, 16383
L_B19_1:
    s_cmp_lt_i32 s84, s82
    s_cbranch_scc1 L_B19_1w
    s_waitcnt vmcnt(18)
    buffer_load_dwordx4 v2, s[4:7], s78 offen offset:3072 nt lds
    v_add_u32 v5, 3, v5
    s_add_u32 m0, m0, s85
    s_add_u32 s78, s78, s85
    s_waitcnt vmcnt(18)
    buffer_load_dwordx4 v2, s[4:7], s78 offen offset:0 nt lds
    v_readlane_b32 s84, v3, 2
    ds_read_b32 v3, v7
    s_mul_i32 s80, s92, 768
    s_waitcnt vmcnt(18)
    buffer_load_dwordx4 v2, s[4:7], s78 offen offset:1024 nt lds
    ds_write_b32 v6, v5
    s_bfe_u32 s92, s81, 0x40003
    s_mul_i32 s92, s92, 25165824
L_B19_2:
    s_cmp_lt_i32 s84, s82
    s_cbranch_scc1 L_B19_2w
    s_waitcnt vmcnt(18)
    buffer_load_dwordx4 v2, s[4:7], s78 offen offset:2048 nt lds
    v_add_u32 v5, 3, v5
    s_add_u32 s80, s80, s79
    s_add_u32 s80, s80, s92
    s_waitcnt vmcnt(18)
    buffer_load_dwordx4 v2, s[4:7], s78 offen offset:3072 nt lds
    v_readlane_b32 s84, v3, 3
    ds_read_b32 v3, v7
    s_add_u32 m0, m0, s85
    s_add_u32 s78, s78, s85
    s_waitcnt vmcnt(18)
    buffer_load_dwordx4 v2, s[4:7], s78 offen offset:0 nt lds
    ds_write_b32 v6, v5
    s_and_b32 s86, s81, 3
    s_mul_i32 s86, s86, 12288
L_B19_3:
    s_cmp_lt_i32 s84, s82
    s_cbranch_scc1 L_B19_3w
    s_waitcnt vmcnt(18)
    buffer_load_dwordx4 v2, s[4:7], s78 offen offset:1024 nt lds
    v_add_u32 v5, 3, v5
    v_readlane_b32 s83, v3, 4
    s_waitcnt vmcnt(18)
    buffer_load_dwordx4 v2, s[4:7], s78 offen offset:2048 nt lds
    v_readlane_b32 s84, v3, 0
    ds_read_b32 v3, v7
    s_add_u32 s82, s82, 1
    s_cmp_ge_u32 s81, 255
    s_cselect_b32 s83, -1, s83
    s_cmp_ge_u32 s81, 128
    s_waitcnt vmcnt(18)
    buffer_load_dwordx4 v2, s[4:7], s78 offen offset:3072 nt lds
    ds_write_b32 v6, v5
    s_cselect_b64 s[4:5], s[56:57], s[50:51]
    s_mov_b32 m0, s86
    s_mov_b32 s78, s80
    s_cmp_eq_u32 s83, 19
    s_cbranch_scc1 L_B19
    s_cmp_eq_u32 s83, -1
    s_cbranch_scc1 L_D32
    s_cmp_eq_u32 s83, 20
    s_cbranch_scc1 L_D20
    s_cmp_eq_u32 s83, 18
    s_cbranch_scc1 L_D18
    s_branch L_disp
L_D21:
    s_mul_i32 s92, s81, 12
    s_add_u32 s92, s92, 27
    v_mov_b32 v5, s92
L_B21:
L_B21_0:
    s_cmp_lt_i32 s84, s82
    s_cbranch_scc1 L_B21_0w
    s_waitcnt vmcnt(20)
    buffer_load_dwordx4 v2, s[4:7], s78 offen offset:0 nt lds
    v_add_u32 v5, 3, v5
    s_add_u32 s81, s81, 1
    s_and_b32 s92, s81, 7
    s_waitcnt vmcnt(20)
    buffer_load_dwordx4 v2, s[4:7], s78 offen offset:1024 nt lds
    v_readlane_b32 s84, v3, 1
    ds_read_b32 v3, v7
    s_lshl_b32 s92, s92, 11
    s_waitcnt vmcnt(20)
    buffer_load_dwordx4 v2, s[4:7], s78 offen offset:2048 nt lds
    ds_write_b32 v6, v5
    s_add_u32 s92, s92, s77
    s_and_b32 s92, s92, 16383
L_B21_1:
    s_cmp_lt_i32 s84, s82
    s_cbranch_scc1 L_B21_1w
    s_waitcnt vmcnt(20)
    buffer_load_dwordx4 v2, s[4:7], s78 offen offset:3072 nt lds
    v_add_u32 v5, 3, v5
    s_add_u32 m0, m0, s85
    s_add_u32 s78, s78, s85
    s_waitcnt vmcnt(20)
    buffer_load_dwordx4 v2, s[4:7], s78 offen offset:0 nt lds
    v_readlane_b32 s84, v3, 2
    ds_read_b32 v3, v7
    s_mul_i32 s80, s92, 768
    s_waitcnt vmcnt(20)
    buffer_load_dwordx4 v2, s[4:7], s78 offen offset:1024 nt lds
    ds_write_b32 v6, v5
    s_bfe_u32 s92, s81, 0x40003
    s_mul_i32 s92, s92, 25165824
L_B21_2:
    s_cmp_lt_i32 s84, s82
    s_cbranch_scc1 L_B21_2w
    s_waitcnt vmcnt(20)
    buffer_load_dwordx4 v2, s[4:7], s78 offen offset:2048 nt lds
    v_add_u32 v5, 3, v5
    s_add_u32 s80, s80, s79
    s_add_u32 s80, s80, s92
    s_waitcnt vmcnt(20)
    buffer_load_dwordx4 v2, s[4:7], s78 offen offset:3072 nt lds
    v_readlane_b32 s84, v3, 3
    ds_read_b32 v3, v7
    s_add_u32 m0, m0, s85
    s_add_u32 s78, s78, s85
    s_waitcnt vmcnt(20)
    buffer_load_dwordx4 v2, s[4:7], s78 offen offset:0 nt lds
    ds_write_b32 v6, v5
    s_and_b32 s86, s81, 3
    s_mul_i32 s86, s86, 12288
L_B21_3:
    s_cmp_lt_i32 s84, s82
    s_cbranch_scc1 L_B21_3w
    s_waitcnt vmcnt(20)
    buffer_load_dwordx4 v2, s[4:7], s78 offen offset:1024 nt lds
    v_add_u32 v5, 3, v5
    v_readlane_b32 s83, v3, 4
    s_waitcnt vmcnt(20)
    buffer_load_dwordx4 v2, s[4:7], s78 offen offset:2048 nt lds
    v_readlane_b32 s84, v3, 0
    ds_read_b32 v3, v7
    s_add_u32 s82, s82, 1
    s_cmp_ge_u32 s81, 255
    s_cselect_b32 s83, -1, s83
    s_cmp_ge_u32 s81, 128
    s_waitcnt vmcnt(20)
    buffer_load_dwordx4 v2, s[4:7], s78 offen offset:3072 nt lds
    ds_write_b32 v6, v5
    s_cselect_b64 s[4:5], s[56:57], s[50:51]
    s_mov_b32 m0, s86
    s_mov_b32 s78, s80
    s_cmp_eq_u32 s83, 21
    s_cbranch_scc1 L_B21
    s_cmp_eq_u32 s83, -1
    s_cbranch_scc1 L_D32
    s_cmp_eq_u32 s83, 20
    s_cbranch_scc1 L_D20
    s_cmp_eq_u32 s83, 22
    s_cbranch_scc1 L_D22
    s_branch L_disp
L_D18:
    s_mul_i32 s92, s81, 12
    s_add_u32 s92, s92, 30
    v_mov_b32 v5, s92
L_B18:
L_B18_0:
    s_cmp_lt_i32 s84, s82
    s_cbranch_scc1 L_B18_0w
    s_waitcnt vmcnt(17)
    buffer_load_dwordx4 v2, s[4:7], s78 offen offset:0 nt lds
    v_add_u32 v5, 3, v5
    s_add_u32 s81, s81, 1
    s_and_b32 s92, s81, 7
    s_waitcnt vmcnt(17)
    buffer_load_dwordx4 v2, s[4:7], s78 offen offset:1024 nt lds
    v_readlane_b32 s84, v3, 1
    ds_read_b32 v3, v7
    s_lshl_b32 s92, s92, 11
    s_waitcnt vmcnt(17)
    buffer_load_dwordx4 v2, s[4:7], s78 offen offset:2048 nt lds
    ds_write_b32 v6, v5
    s_add_u32 s92, s92, s77
    s_and_b32 s92, s92, 16383
L_B18_1:
    s_cmp_lt_i32 s84, s82
    s_cbranch_scc1 L_B18_1w
    s_waitcnt vmcnt(17)
    buffer_load_dwordx4 v2, s[4:7], s78 offen offset:3072 nt lds
    v_add_u32 v5, 3, v5
    s_add_u32 m0, m0, s85
    s_add_u32 s78, s78, s85
    s_waitcnt vmcnt(17)
    buffer_load_dwordx4 v2, s[4:7], s78 offen offset:0 nt lds
    v_readlane_b32 s84, v3, 2
    ds_read_b32 v3, v7
    s_mul_i32 s80, s92, 768
    s_waitcnt vmcnt(17)
    buffer_load_dwordx4 v2, s[4:7], s78 offen offset:1024 nt lds
    ds_write_b32 v6, v5
    s_bfe_u32 s92, s81, 0x40003
    s_mul_i32 s92, s92, 25165824
L_B18_2:
    s_cmp_lt_i32 s84, s82
    s_cbranch_scc1 L_B18_2w
    s_waitcnt vmcnt(17)
    buffer_load_dwordx4 v2, s[4:7], s78 offen offset:2048 nt lds
    v_add_u32 v5, 3, v5
    s_add_u32 s80, s80, s79
    s_add_u32 s80, s80, s92
    s_waitcnt vmcnt(17)
    buffer_load_dwordx4 v2, s[4:7], s78 offen offset:3072 nt lds
    v_readlane_b32 s84, v3, 3
    ds_read_b32 v3, v7
    s_add_u32 m0, m0, s85
    s_add_u32 s78, s78, s85
    s_waitcnt vmcnt(17)
    buffer_load_dwordx4 v2, s[4:7], s78 offen offset:0 nt lds
    ds_write_b32 v6, v5
    s_and_b32 s86, s81, 3
    s_mul_i32 s86, s86, 12288
L_B18_3:
    s_cmp_lt_i32 s84, s82
    s_cbranch_scc1 L_B18_3w
    s_waitcnt vmcnt(17)
    buffer_load_dwordx4 v2, s[4:7], s78 offen offset:1024 nt lds
    v_add_u32 v5, 3, v5
    v_readlane_b32 s83, v3, 4
    s_waitcnt vmcnt(17)
    buffer_load_dwordx4 v2, s[4:7], s78 offen offset:2048 nt lds
    v_readlane_b32 s84, v3, 0
    ds_read_b32 v3, v7
    s_add_u32 s82, s82, 1
    s_cmp_ge_u32 s81, 255
    s_cselect_b32 s83, -1, s83
    s_cmp_ge_u32 s81, 128
    s_waitcnt vmcnt(17)
    buffer_load_dwordx4 v2, s[4:7], s78 offen offset:3072 nt lds
    ds_write_b32 v6, v5
    s_cselect_b64 s[4:5], s[56:57], s[50:51]
    s_mov_b32 m0, s86
    s_mov_b32 s78, s80
    s_cmp_eq_u32 s83, 18
    s_cbranch_scc1 L_B18
    s_cmp_eq_u32 s83, -1
    s_cbranch_scc1 L_D32
    s_cmp_eq_u32 s83, 19
    s_cbranch_scc1 L_D19
    s_cmp_eq_u32 s83, 17
    s_cbranch_scc1 L_D17
    s_branch L_disp
L_D22:
    s_mul_i32 s92, s81, 12
    s_add_u32 s92, s92, 26
    v_mov_b32 v5, s92
L_B22:
L_B22_0:
    s_cmp_lt_i32 s84, s82
    s_cbranch_scc1 L_B22_0w
    s_waitcnt vmcnt(21)
    buffer_load_dwordx4 v2, s[4:7], s78 offen offset:0 nt lds
    v_add_u32 v5, 3, v5
    s_add_u32 s81, s81, 1
    s_and_b32 s92, s81, 7
    s_waitcnt vmcnt(21)
    buffer_load_dwordx4 v2, s[4:7], s78 offen offset:1024 nt lds
    v_readlane_b32 s84, v3, 1
    ds_read_b32 v3, v7
    s_lshl_b32 s92, s92, 11
    s_waitcnt vmcnt(21)
    buffer_load_dwordx4 v2, s[4:7], s78 offen offset:2048 nt lds
    ds_write_b32 v6, v5
    s_add_u32 s92, s92, s77
    s_and_b32 s92, s92, 16383
L_B22_1:
    s_cmp_lt_i32 s84, s82
    s_cbranch_scc1 L_B22_1w
    s_waitcnt vmcnt(21)
    buffer_load_dwordx4 v2, s[4:7], s78 offen offset:3072 nt lds
    v_add_u32 v5, 3, v5
    s_add_u32 m0, m0, s85
    s_add_u32 s78, s78, s85
    s_waitcnt vmcnt(21)
    buffer_load_dwordx4 v2, s[4:7], s78 offen offset:0 nt lds
    v_readlane_b32 s84, v3, 2
    ds_read_b32 v3, v7
    s_mul_i32 s80, s92, 768
    s_waitcnt vmcnt(21)
    buffer_load_dwordx4 v2, s[4:7], s78 offen offset:1024 nt lds
    ds_write_b32 v6, v5
    s_bfe_u32 s92, s81, 0x40003
    s_mul_i32 s92, s92, 25165824
L_B22_2:
    s_cmp_lt_i32 s84, s82
    s_cbranch_scc1 L_B22_2w
    s_waitcnt vmcnt(21)
    buffer_load_dwordx4 v2, s[4:7], s78 offen offset:2048 nt lds
    v_add_u32 v5, 3, v5
    s_add_u32 s80, s80, s79
    s_add_u32 s80, s80, s92
    s_waitcnt vmcnt(21)
    buffer_load_dwordx4 v2, s[4:7], s78 offen offset:3072 nt lds
    v_readlane_b32 s84, v3, 3
    ds_read_b32 v3, v7
    s_add_u32 m0, m0, s85
    s_add_u32 s78, s78, s85
    s_waitcnt vmcnt(21)
    buffer_load_dwordx4 v2, s[4:7], s78 offen offset:0 nt lds
    ds_write_b32 v6, v5
    s_and_b32 s86, s81, 3
    s_mul_i32 s86, s86, 12288
L_B22_3:
    s_cmp_lt_i32 s84, s82
    s_cbranch_scc1 L_B22_3w
    s_waitcnt vmcnt(21)
    buffer_load_dwordx4 v2, s[4:7], s78 offen offset:1024 nt lds
    v_add_u32 v5, 3, v5
    v_readlane_b32 s83, v3, 4
    s_waitcnt vmcnt(21)
    buffer_load_dwordx4 v2, s[4:7], s78 offen offset:2048 nt lds
    v_readlane_b32 s84, v3, 0
    ds_read_b32 v3, v7
    s_add_u32 s82, s82, 1
    s_cmp_ge_u32 s81, 255
    s_cselect_b32 s83, -1, s83
    s_cmp_ge_u32 s81, 128
    s_waitcnt vmcnt(21)
    buffer_load_dwordx4 v2, s[4:7], s78 offen offset:3072 nt lds
    ds_write_b32 v6, v5
    s_cselect_b64 s[4:5], s[56:57], s[50:51]
    s_mov_b32 m0, s86
    s_mov_b32 s78, s80
    s_cmp_eq_u32 s83, 22
    s_cbranch_scc1 L_B22
    s_cmp_eq_u32 s83, -1
    s_cbranch_scc1 L_D32
    s_cmp_eq_u32 s83, 21
    s_cbranch_scc1 L_D21
    s_cmp_eq_u32 s83, 23
    s_cbranch_scc1 L_D23
    s_branch L_disp
L_D17:
    s_mul_i32 s92, s81, 12
    s_add_u32 s92, s92, 31
    v_mov_b32 v5, s92
L_B17:
L_B17_0:
    s_cmp_lt_i32 s84, s82
    s_cbranch_scc1 L_B17_0w
    s_waitcnt vmcnt(16)
    buffer_load_dwordx4 v2, s[4:7], s78 offen offset:0 nt lds
    v_add_u32 v5, 3, v5
    s_add_u32 s81, s81, 1
    s_and_b32 s92, s81, 7
    s_waitcnt vmcnt(16)
    buffer_load_dwordx4 v2, s[4:7], s78 offen offset:1024 nt lds
    v_readlane_b32 s84, v3, 1
    ds_read_b32 v3, v7
    s_lshl_b32 s92, s92, 11
    s_waitcnt vmcnt(16)
    buffer_load_dwordx4 v2, s[4:7], s78 offen offset:2048 nt lds
    ds_write_b32 v6, v5
    s_add_u32 s92, s92, s77
    s_and_b32 s92, s92, 16383
L_B17_1:
    s_cmp_lt_i32 s84, s82
    s_cbranch_scc1 L_B17_1w
    s_waitcnt vmcnt(16)
    buffer_load_dwordx4 v2, s[4:7], s78 offen offset:3072 nt lds
    v_add_u32 v5, 3, v5
    s_add_u32 m0, m0, s85
    s_add_u32 s78, s78, s85
    s_waitcnt vmcnt(16)
    buffer_load_dwordx4 v2, s[4:7], s78 offen offset:0 nt lds
    v_readlane_b32 s84, v3, 2
    ds_read_b32 v3, v7
    s_mul_i32 s80, s92, 768
    s_waitcnt vmcnt(16)
    buffer_load_dwordx4 v2, s[4:7], s78 offen offset:1024 nt lds
    ds_write_b32 v6, v5
    s_bfe_u32 s92, s81, 0x40003
    s_mul_i32 s92, s92, 25165824
L_B17_2:
    s_cmp_lt_i32 s84, s82
    s_cbranch_scc1 L_B17_2w
    s_waitcnt vmcnt(16)
    buffer_load_dwordx4 v2, s[4:7], s78 offen offset:2048 nt lds
    v_add_u32 v5, 3, v5
    s_add_u32 s80, s80, s79
    s_add_u32 s80, s80, s92
    s_waitcnt vmcnt(16)
    buffer_load_dwordx4 v2, s[4:7], s78 offen offset:3072 nt lds
    v_readlane_b32 s84, v3, 3
    ds_read_b32 v3, v7
    s_add_u32 m0, m0, s85
    s_add_u32 s78, s78, s85
    s_waitcnt vmcnt(16)
    buffer_load_dwordx4 v2, s[4:7], s78 offen offset:0 nt lds
    ds_write_b32 v6, v5
    s_and_b32 s86, s81, 3
    s_mul_i32 s86, s86, 12288
L_B17_3:
    s_cmp_lt_i32 s84, s82
    s_cbranch_scc1 L_B17_3w
    s_waitcnt vmcnt(16)
    buffer_load_dwordx4 v2, s[4:7], s78 offen offset:1024 nt lds
    v_add_u32 v5, 3, v5
    v_readlane_b32 s83, v3, 4
    s_waitcnt vmcnt(16)
    buffer_load_dwordx4 v2, s[4:7], s78 offen offset:2048 nt lds
    v_readlane_b32 s84, v3, 0
    ds_read_b32 v3, v7
    s_add_u32 s82, s82, 1
    s_cmp_ge_u32 s81, 255
    s_cselect_b32 s83, -1, s83
    s_cmp_ge_u32 s81, 128
    s_waitcnt vmcnt(16)
    buffer_load_dwordx4 v2, s[4:7], s78 offen offset:3072 nt lds
    ds_write_b32 v6, v5
    s_cselect_b64 s[4:5], s[56:57], s[50:51]
    s_mov_b32 m0, s86
    s_mov_b32 s78, s80
    s_cmp_eq_u32 s83, 17
    s_cbranch_scc1 L_B17
    s_cmp_eq_u32 s83, -1
    s_cbranch_scc1 L_D32
    s_cmp_eq_u32 s83, 18
    s_cbranch_scc1 L_D18
    s_cmp_eq_u32 s83, 16
    s_cbranch_scc1 L_D16
    s_branch L_disp
L_D23:
    s_mul_i32 s92, s81, 12
    s_add_u32 s92, s92, 25
    v_mov_b32 v5, s92
L_B23:
L_B23_0:
    s_cmp_lt_i32 s84, s82
    s_cbranch_scc1 L_B23_0w
    s_waitcnt vmcnt(22)
    buffer_load_dwordx4 v2, s[4:7], s78 offen offset:0 nt lds
    v_add_u32 v5, 3, v5
    s_add_u32 s81, s81, 1
    s_and_b32 s92, s81, 7
    s_waitcnt vmcnt(22)
    buffer_load_dwordx4 v2, s[4:7], s78 offen offset:1024 nt lds
    v_readlane_b32 s84, v3, 1
    ds_read_b32 v3, v7
    s_lshl_b32 s92, s92, 11
    s_waitcnt vmcnt(22)
    buffer_load_dwordx4 v2, s[4:7], s78 offen offset:2048 nt lds
    ds_write_b32 v6, v5
    s_add_u32 s92, s92, s77
    s_and_b32 s92, s92, 16383
L_B23_1:
    s_cmp_lt_i32 s84, s82
    s_cbranch_scc1 L_B23_1w
    s_waitcnt vmcnt(22)
    buffer_load_dwordx4 v2, s[4:7], s78 offen offset:3072 nt lds
    v_add_u32 v5, 3, v5
    s_add_u32 m0, m0, s85
    s_add_u32 s78, s78, s85
    s_waitcnt vmcnt(22)
    buffer_load_dwordx4 v2, s[4:7], s78 offen offset:0 nt lds
    v_readlane_b32 s84, v3, 2
    ds_read_b32 v3, v7
    s_mul_i32 s80, s92, 768
    s_waitcnt vmcnt(22)
    buffer_load_dwordx4 v2, s[4:7], s78 offen offset:1024 nt lds
    ds_write_b32 v6, v5
    s_bfe_u32 s92, s81, 0x40003
    s_mul_i32 s92, s92, 25165824
L_B23_2:
    s_cmp_lt_i32 s84, s82
    s_cbranch_scc1 L_B23_2w
    s_waitcnt vmcnt(22)
    buffer_load_dwordx4 v2, s[4:7], s78 offen offset:2048 nt lds
    v_add_u32 v5, 3, v5
    s_add_u32 s80, s80, s79
    s_add_u32 s80, s80, s92
    s_waitcnt vmcnt(22)
    buffer_load_dwordx4 v2, s[4:7], s78 offen offset:3072 nt lds
    v_readlane_b32 s84, v3, 3
    ds_read_b32 v3, v7
    s_add_u32 m0, m0, s85
    s_add_u32 s78, s78, s85
    s_waitcnt vmcnt(22)
    buffer_load_dwordx4 v2, s[4:7], s78 offen offset:0 nt lds
    ds_write_b32 v6, v5
    s_and_b32 s86, s81, 3
    s_mul_i32 s86, s86, 12288
L_B23_3:
    s_cmp_lt_i32 s84, s82
    s_cbranch_scc1 L_B23_3w
    s_waitcnt vmcnt(22)
    buffer_load_dwordx4 v2, s[4:7], s78 offen offset:1024 nt lds
    v_add_u32 v5, 3, v5
    v_readlane_b32 s83, v3, 4
    s_waitcnt vmcnt(22)
    buffer_load_dwordx4 v2, s[4:7], s78 offen offset:2048 nt lds
    v_readlane_b32 s84, v3, 0
    ds_read_b32 v3, v7
    s_add_u32 s82, s82, 1
    s_cmp_ge_u32 s81, 255
    s_cselect_b32 s83, -1, s83
    s_cmp_ge_u32 s81, 128
    s_waitcnt vmcnt(22)
    buffer_load_dwordx4 v2, s[4:7], s78 offen offset:3072 nt lds
    ds_write_b32 v6, v5
    s_cselect_b64 s[4:5], s[56:57], s[50:51]
    s_mov_b32 m0, s86
    s_mov_b32 s78, s80
    s_cmp_eq_u32 s83, 23
    s_cbranch_scc1 L_B23
    s_cmp_eq_u32 s83, -1
    s_cbranch_scc1 L_D32
    s_cmp_eq_u32 s83, 22
    s_cbranch_scc1 L_D22
    s_cmp_eq_u32 s83, 24
    s_cbranch_scc1 L_D24
    s_branch L_disp
L_D16:
    s_mul_i32 s92, s81, 12
    s_add_u32 s92, s92, 32
    v_mov_b32 v5, s92
L_B16:
L_B16_0:
    s_cmp_lt_i32 s84, s82
    s_cbranch_scc1 L_B16_0w
    s_waitcnt vmcnt(15)
    buffer_load_dwordx4 v2, s[4:7], s78 offen offset:0 nt lds
    v_add_u32 v5, 3, v5
    s_add_u32 s81, s81, 1
    s_and_b32 s92, s81, 7
    s_waitcnt vmcnt(15)
    buffer_load_dwordx4 v2, s[4:7], s78 offen offset:1024 nt lds
    v_readlane_b32 s84, v3, 1
    ds_read_b32 v3, v7
    s_lshl_b32 s92, s92, 11
    s_waitcnt vmcnt(15)
    buffer_load_dwordx4 v2, s[4:7], s78 offen offset:2048 nt lds
    ds_write_b32 v6, v5
    s_add_u32 s92, s92, s77
    s_and_b32 s92, s92, 16383
L_B16_1:
    s_cmp_lt_i32 s84, s82
    s_cbranch_scc1 L_B16_1w
    s_waitcnt vmcnt(15)
    buffer_load_dwordx4 v2, s[4:7], s78 offen offset:3072 nt lds
    v_add_u32 v5, 3, v5
    s_add_u32 m0, m0, s85
    s_add_u32 s78, s78, s85
    s_waitcnt vmcnt(15)
    buffer_load_dwordx4 v2, s[4:7], s78 offen offset:0 nt lds
    v_readlane_b32 s84, v3, 2
    ds_read_b32 v3, v7
    s_mul_i32 s80, s92, 768
    s_waitcnt vmcnt(15)
    buffer_load_dwordx4 v2, s[4:7], s78 offen offset:1024 nt lds
    ds_write_b32 v6, v5
    s_bfe_u32 s92, s81, 0x40003
    s_mul_i32 s92, s92, 25165824
L_B16_2:
    s_cmp_lt_i32 s84, s82
    s_cbranch_scc1 L_B16_2w
    s_waitcnt vmcnt(15)
    buffer_load_dwordx4 v2, s[4:7], s78 offen offset:2048 nt lds
    v_add_u32 v5, 3, v5
    s_add_u32 s80, s80, s79
    s_add_u32 s80, s80, s92
    s_waitcnt vmcnt(15)
    buffer_load_dwordx4 v2, s[4:7], s78 offen offset:3072 nt lds
    v_readlane_b32 s84, v3, 3
    ds_read_b32 v3, v7
    s_add_u32 m0, m0, s85
    s_add_u32 s78, s78, s85
    s_waitcnt vmcnt(15)
    buffer_load_dwordx4 v2, s[4:7], s78 offen offset:0 nt lds
    ds_write_b32 v6, v5
    s_and_b32 s86, s81, 3
    s_mul_i32 s86, s86, 12288
L_B16_3:
    s_cmp_lt_i32 s84, s82
    s_cbranch_scc1 L_B16_3w
    s_waitcnt vmcnt(15)
    buffer_load_dwordx4 v2, s[4:7], s78 offen offset:1024 nt lds
    v_add_u32 v5, 3, v5
    v_readlane_b32 s83, v3, 4
    s_waitcnt vmcnt(15)
    buffer_load_dwordx4 v2, s[4:7], s78 offen offset:2048 nt lds
    v_readlane_b32 s84, v3, 0
    ds_read_b32 v3, v7
    s_add_u32 s82, s82, 1
    s_cmp_ge_u32 s81, 255
    s_cselect_b32 s83, -1, s83
    s_cmp_ge_u32 s81, 128
    s_waitcnt vmcnt(15)
    buffer_load_dwordx4 v2, s[4:7], s78 offen offset:3072 nt lds
    ds_write_b32 v6, v5
    s_cselect_b64 s[4:5], s[56:57], s[50:51]
    s_mov_b32 m0, s86
    s_mov_b32 s78, s80
    s_cmp_eq_u32 s83, 16
    s_cbranch_scc1 L_B16
    s_cmp_eq_u32 s83, -1
    s_cbranch_scc1 L_D32
    s_cmp_eq_u32 s83, 17
    s_cbranch_scc1 L_D17
    s_cmp_eq_u32 s83, 15
    s_cbranch_scc1 L_D15
    s_branch L_disp
L_D24:
    s_mul_i32 s92, s81, 12
    s_add_u32 s92, s92, 24
    v_mov_b32 v5, s92
L_B24:
L_B24_0:
    s_cmp_lt_i32 s84, s82
    s_cbranch_scc1 L_B24_0w
    s_waitcnt vmcnt(23)
    buffer_load_dwordx4 v2, s[4:7], s78 offen offset:0 nt lds
    v_add_u32 v5, 3, v5
    s_add_u32 s81, s81, 1
    s_and_b32 s92, s81, 7
    s_waitcnt vmcnt(23)
    buffer_load_dwordx4 v2, s[4:7], s78 offen offset:1024 nt lds
    v_readlane_b32 s84, v3, 1
    ds_read_b32 v3, v7
    s_lshl_b32 s92, s92, 11
    s_waitcnt vmcnt(23)
    buffer_load_dwordx4 v2, s[4:7], s78 offen offset:2048 nt lds
    ds_write_b32 v6, v5
    s_add_u32 s92, s92, s77
    s_and_b32 s92, s92, 16383
L_B24_1:
    s_cmp_lt_i32 s84, s82
    s_cbranch_scc1 L_B24_1w
    s_waitcnt vmcnt(23)
    buffer_load_dwordx4 v2, s[4:7], s78 offen offset:3072 nt lds
    v_add_u32 v5, 3, v5
    s_add_u32 m0, m0, s85
    s_add_u32 s78, s78, s85
    s_waitcnt vmcnt(23)
    buffer_load_dwordx4 v2, s[4:7], s78 offen offset:0 nt lds
    v_readlane_b32 s84, v3, 2
    ds_read_b32 v3, v7
    s_mul_i32 s80, s92, 768
    s_waitcnt vmcnt(23)
    buffer_load_dwordx4 v2, s[4:7], s78 offen offset:1024 nt lds
    ds_write_b32 v6, v5
    s_bfe_u32 s92, s81, 0x40003
    s_mul_i32 s92, s92, 25165824
L_B24_2:
    s_cmp_lt_i32 s84, s82
    s_cbranch_scc1 L_B24_2w
    s_waitcnt vmcnt(23)
    buffer_load_dwordx4 v2, s[4:7], s78 offen offset:2048 nt lds
    v_add_u32 v5, 3, v5
    s_add_u32 s80, s80, s79
    s_add_u32 s80, s80, s92
    s_waitcnt vmcnt(23)
    buffer_load_dwordx4 v2, s[4:7], s78 offen offset:3072 nt lds
    v_readlane_b32 s84, v3, 3
    ds_read_b32 v3, v7
    s_add_u32 m0, m0, s85
    s_add_u32 s78, s78, s85
    s_waitcnt vmcnt(23)
    buffer_load_dwordx4 v2, s[4:7], s78 offen offset:0 nt lds
    ds_write_b32 v6, v5
    s_and_b32 s86, s81, 3
    s_mul_i32 s86, s86, 12288
L_B24_3:
    s_cmp_lt_i32 s84, s82
    s_cbranch_scc1 L_B24_3w
    s_waitcnt vmcnt(23)
    buffer_load_dwordx4 v2, s[4:7], s78 offen offset:1024 nt lds
    v_add_u32 v5, 3, v5
    v_readlane_b32 s83, v3, 4
    s_waitcnt vmcnt(23)
    buffer_load_dwordx4 v2, s[4:7], s78 offen offset:2048 nt lds
    v_readlane_b32 s84, v3, 0
    ds_read_b32 v3, v7
    s_add_u32 s82, s82, 1
    s_cmp_ge_u32 s81, 255
    s_cselect_b32 s83, -1, s83
    s_cmp_ge_u32 s81, 128
    s_waitcnt vmcnt(23)
    buffer_load_dwordx4 v2, s[4:7], s78 offen offset:3072 nt lds
    ds_write_b32 v6, v5
    s_cselect_b64 s[4:5], s[56:57], s[50:51]
    s_mov_b32 m0, s86
    s_mov_b32 s78, s80
    s_cmp_eq_u32 s83, 24
    s_cbranch_scc1 L_B24
    s_cmp_eq_u32 s83, -1
    s_cbranch_scc1 L_D32
    s_cmp_eq_u32 s83, 23
    s_cbranch_scc1 L_D23
    s_cmp_eq_u32 s83, 25
    s_cbranch_scc1 L_D25
    s_branch L_disp
L_D15:
    s_mul_i32 s92, s81, 12
    s_add_u32 s92, s92, 33
    v_mov_b32 v5, s92
L_B15:
L_B15_0:
    s_cmp_lt_i32 s84, s82
    s_cbranch_scc1 L_B15_0w
    s_waitcnt vmcnt(14)
    buffer_load_dwordx4 v2, s[4:7], s78 offen offset:0 nt lds
    v_add_u32 v5, 3, v5
    s_add_u32 s81, s81, 1
    s_and_b32 s92, s81, 7
    s_waitcnt vmcnt(14)
    buffer_load_dwordx4 v2, s[4:7], s78 offen offset:1024 nt lds
    v_readlane_b32 s84, v3, 1
    ds_read_b32 v3, v7
    s_lshl_b32 s92, s92, 11
    s_waitcnt vmcnt(14)
    buffer_load_dwordx4 v2, s[4:7], s78 offen offset:2048 nt lds
    ds_write_b32 v6, v5
    s_add_u32 s92, s92, s77
    s_and_b32 s92, s92, 16383
L_B15_1:
    s_cmp_lt_i32 s84, s82
    s_cbranch_scc1 L_B15_1w
    s_waitcnt vmcnt(14)
    buffer_load_dwordx4 v2, s[4:7], s78 offen offset:3072 nt lds
    v_add_u32 v5, 3, v5
    s_add_u32 m0, m0, s85
    s_add_u32 s78, s78, s85
    s_waitcnt vmcnt(14)
    buffer_load_dwordx4 v2, s[4:7], s78 offen offset:0 nt lds
    v_readlane_b32 s84, v3, 2
    ds_read_b32 v3, v7
    s_mul_i32 s80, s92, 768
    s_waitcnt vmcnt(14)
    buffer_load_dwordx4 v2, s[4:7], s78 offen offset:1024 nt lds
    ds_write_b32 v6, v5
    s_bfe_u32 s92, s81, 0x40003
    s_mul_i32 s92, s92, 25165824
L_B15_2:
    s_cmp_lt_i32 s84, s82
    s_cbranch_scc1 L_B15_2w
    s_waitcnt vmcnt(14)
    buffer_load_dwordx4 v2, s[4:7], s78 offen offset:2048 nt lds
    v_add_u32 v5, 3, v5
    s_add_u32 s80, s80, s79
    s_add_u32 s80, s80, s92
    s_waitcnt vmcnt(14)
    buffer_load_dwordx4 v2, s[4:7], s78 offen offset:3072 nt lds
    v_readlane_b32 s84, v3, 3
    ds_read_b32 v3, v7
    s_add_u32 m0, m0, s85
    s_add_u32 s78, s78, s85
    s_waitcnt vmcnt(14)
    buffer_load_dwordx4 v2, s[4:7], s78 offen offset:0 nt lds
    ds_write_b32 v6, v5
    s_and_b32 s86, s81, 3
    s_mul_i32 s86, s86, 12288
L_B15_3:
    s_cmp_lt_i32 s84, s82
    s_cbranch_scc1 L_B15_3w
    s_waitcnt vmcnt(14)
    buffer_load_dwordx4 v2, s[4:7], s78 offen offset:1024 nt lds
    v_add_u32 v5, 3, v5
    v_readlane_b32 s83, v3, 4
    s_waitcnt vmcnt(14)
    buffer_load_dwordx4 v2, s[4:7], s78 offen offset:2048 nt lds
    v_readlane_b32 s84, v3, 0
    ds_read_b32 v3, v7
    s_add_u32 s82, s82, 1
    s_cmp_ge_u32 s81, 255
    s_cselect_b32 s83, -1, s83
    s_cmp_ge_u32 s81, 128
    s_waitcnt vmcnt(14)
    buffer_load_dwordx4 v2, s[4:7], s78 offen offset:3072 nt lds
    ds_write_b32 v6, v5
    s_cselect_b64 s[4:5], s[56:57], s[50:51]
    s_mov_b32 m0, s86
    s_mov_b32 s78, s80
    s_cmp_eq_u32 s83, 15
    s_cbranch_scc1 L_B15
    s_cmp_eq_u32 s83, -1
    s_cbranch_scc1 L_D32
    s_cmp_eq_u32 s83, 16
    s_cbranch_scc1 L_D16
    s_branch L_disp
L_D25:
    s_mul_i32 s92, s81, 12
    s_add_u32 s92, s92, 23
    v_mov_b32 v5, s92
L_B25:
L_B25_0:
    s_cmp_lt_i32 s84, s82
    s_cbranch_scc1 L_B25_0w
    s_waitcnt vmcnt(24)
    buffer_load_dwordx4 v2, s[4:7], s78 offen offset:0 nt lds
    v_add_u32 v5, 3, v5
    s_add_u32 s81, s81, 1
    s_and_b32 s92, s81, 7
    s_waitcnt vmcnt(24)
    buffer_load_dwordx4 v2, s[4:7], s78 offen offset:1024 nt lds
    v_readlane_b32 s84, v3, 1
    ds_read_b32 v3, v7
    s_lshl_b32 s92, s92, 11
    s_waitcnt vmcnt(24)
    buffer_load_dwordx4 v2, s[4:7], s78 offen offset:2048 nt lds
    ds_write_b32 v6, v5
    s_add_u32 s92, s92, s77
    s_and_b32 s92, s92, 16383
L_B25_1:
    s_cmp_lt_i32 s84, s82
    s_cbranch_scc1 L_B25_1w
    s_waitcnt vmcnt(24)
    buffer_load_dwordx4 v2, s[4:7], s78 offen offset:3072 nt lds
    v_add_u32 v5, 3, v5
    s_add_u32 m0, m0, s85
    s_add_u32 s78, s78, s85
    s_waitcnt vmcnt(24)
    buffer_load_dwordx4 v2, s[4:7], s78 offen offset:0 nt lds
    v_readlane_b32 s84, v3, 2
    ds_read_b32 v3, v7
    s_mul_i32 s80, s92, 768
    s_waitcnt vmcnt(24)
    buffer_load_dwordx4 v2, s[4:7], s78 offen offset:1024 nt lds
    ds_write_b32 v6, v5
    s_bfe_u32 s92, s81, 0x40003
    s_mul_i32 s92, s92, 25165824
L_B25_2:
    s_cmp_lt_i32 s84, s82
    s_cbranch_scc1 L_B25_2w
    s_waitcnt vmcnt(24)
    buffer_load_dwordx4 v2, s[4:7], s78 offen offset:2048 nt lds
    v_add_u32 v5, 3, v5
    s_add_u32 s80, s80, s79
    s_add_u32 s80, s80, s92
    s_waitcnt vmcnt(24)
    buffer_load_dwordx4 v2, s[4:7], s78 offen offset:3072 nt lds
    v_readlane_b32 s84, v3, 3
    ds_read_b32 v3, v7
    s_add_u32 m0, m0, s85
    s_add_u32 s78, s78, s85
    s_waitcnt vmcnt(24)
    buffer_load_dwordx4 v2, s[4:7], s78 offen offset:0 nt lds
    ds_write_b32 v6, v5
    s_and_b32 s86, s81, 3
    s_mul_i32 s86, s86, 12288
L_B25_3:
    s_cmp_lt_i32 s84, s82
    s_cbranch_scc1 L_B25_3w
    s_waitcnt vmcnt(24)
    buffer_load_dwordx4 v2, s[4:7], s78 offen offset:1024 nt lds
    v_add_u32 v5, 3, v5
    v_readlane_b32 s83, v3, 4
    s_waitcnt vmcnt(24)
    buffer_load_dwordx4 v2, s[4:7], s78 offen offset:2048 nt lds
    v_readlane_b32 s84, v3, 0
    ds_read_b32 v3, v7
    s_add_u32 s82, s82, 1
    s_cmp_ge_u32 s81, 255
    s_cselect_b32 s83, -1, s83
    s_cmp_ge_u32 s81, 128
    s_waitcnt vmcnt(24)
    buffer_load_dwordx4 v2, s[4:7], s78 offen offset:3072 nt lds
    ds_write_b32 v6, v5
    s_cselect_b64 s[4:5], s[56:57], s[50:51]
    s_mov_b32 m0, s86
    s_mov_b32 s78, s80
    s_cmp_eq_u32 s83, 25
    s_cbranch_scc1 L_B25
    s_cmp_eq_u32 s83, -1
    s_cbranch_scc1 L_D32
    s_cmp_eq_u32 s83, 24
    s_cbranch_scc1 L_D24
    s_cmp_eq_u32 s83, 26
    s_cbranch_scc1 L_D26
    s_branch L_disp
L_D26:
    s_mul_i32 s92, s81, 12
    s_add_u32 s92, s92, 22
    v_mov_b32 v5, s92
L_B26:
L_B26_0:
    s_cmp_lt_i32 s84, s82
    s_cbranch_scc1 L_B26_0w
    s_waitcnt vmcnt(25)
    buffer_load_dwordx4 v2, s[4:7], s78 offen offset:0 nt lds
    v_add_u32 v5, 3, v5
    s_add_u32 s81, s81, 1
    s_and_b32 s92, s81, 7
    s_waitcnt vmcnt(25)
    buffer_load_dwordx4 v2, s[4:7], s78 offen offset:1024 nt lds
    v_readlane_b32 s84, v3, 1
    ds_read_b32 v3, v7
    s_lshl_b32 s92, s92, 11
    s_waitcnt vmcnt(25)
    buffer_load_dwordx4 v2, s[4:7], s78 offen offset:2048 nt lds
    ds_write_b32 v6, v5
    s_add_u32 s92, s92, s77
    s_and_b32 s92, s92, 16383
L_B26_1:
    s_cmp_lt_i32 s84, s82
    s_cbranch_scc1 L_B26_1w
    s_waitcnt vmcnt(25)
    buffer_load_dwordx4 v2, s[4:7], s78 offen offset:3072 nt lds
    v_add_u32 v5, 3, v5
    s_add_u32 m0, m0, s85
    s_add_u32 s78, s78, s85
    s_waitcnt vmcnt(25)
    buffer_load_dwordx4 v2, s[4:7], s78 offen offset:0 nt lds
    v_readlane_b32 s84, v3, 2
    ds_read_b32 v3, v7
    s_mul_i32 s80, s92, 768
    s_waitcnt vmcnt(25)
    buffer_load_dwordx4 v2, s[4:7], s78 offen offset:1024 nt lds
    ds_write_b32 v6, v5
    s_bfe_u32 s92, s81, 0x40003
    s_mul_i32 s92, s92, 25165824
L_B26_2:
    s_cmp_lt_i32 s84, s82
    s_cbranch_scc1 L_B26_2w
    s_waitcnt vmcnt(25)
    buffer_load_dwordx4 v2, s[4:7], s78 offen offset:2048 nt lds
    v_add_u32 v5, 3, v5
    s_add_u32 s80, s80, s79
    s_add_u32 s80, s80, s92
    s_waitcnt vmcnt(25)
    buffer_load_dwordx4 v2, s[4:7], s78 offen offset:3072 nt lds
    v_readlane_b32 s84, v3, 3
    ds_read_b32 v3, v7
    s_add_u32 m0, m0, s85
    s_add_u32 s78, s78, s85
    s_waitcnt vmcnt(25)
    buffer_load_dwordx4 v2, s[4:7], s78 offen offset:0 nt lds
    ds_write_b32 v6, v5
    s_and_b32 s86, s81, 3
    s_mul_i32 s86, s86, 12288
L_B26_3:
    s_cmp_lt_i32 s84, s82
    s_cbranch_scc1 L_B26_3w
    s_waitcnt vmcnt(25)
    buffer_load_dwordx4 v2, s[4:7], s78 offen offset:1024 nt lds
    v_add_u32 v5, 3, v5
    v_readlane_b32 s83, v3, 4
    s_waitcnt vmcnt(25)
    buffer_load_dwordx4 v2, s[4:7], s78 offen offset:2048 nt lds
    v_readlane_b32 s84, v3, 0
    ds_read_b32 v3, v7
    s_add_u32 s82, s82, 1
    s_cmp_ge_u32 s81, 255
    s_cselect_b32 s83, -1, s83
    s_cmp_ge_u32 s81, 128
    s_waitcnt vmcnt(25)
    buffer_load_dwordx4 v2, s[4:7], s78 offen offset:3072 nt lds
    ds_write_b32 v6, v5
    s_cselect_b64 s[4:5], s[56:57], s[50:51]
    s_mov_b32 m0, s86
    s_mov_b32 s78, s80
    s_cmp_eq_u32 s83, 26
    s_cbranch_scc1 L_B26
    s_cmp_eq_u32 s83, -1
    s_cbranch_scc1 L_D32
    s_cmp_eq_u32 s83, 25
    s_cbranch_scc1 L_D25
    s_branch L_disp
L_B20_0w:
    ds_read_b32 v3, v7
    s_waitcnt lgkmcnt(0)
    v_readlane_b32 s84, v3, 0
    s_nop 0
    s_branch L_B20_0
L_B20_1w:
    ds_read_b32 v3, v7
    s_waitcnt lgkmcnt(0)
    v_readlane_b32 s84, v3, 1
    s_nop 0
    s_branch L_B20_1
L_B20_2w:
    ds_read_b32 v3, v7
    s_waitcnt lgkmcnt(0)
    v_readlane_b32 s84, v3, 2
    s_nop 0
    s_branch L_B20_2
L_B20_3w:
    ds_read_b32 v3, v7
    s_waitcnt lgkmcnt(0)
    v_readlane_b32 s84, v3, 3
    s_nop 0
    s_branch L_B20_3
L_B19_0w:
    ds_read_b32 v3, v7
    s_waitcnt lgkmcnt(0)
    v_readlane_b32 s84, v3, 0
    s_nop 0
    s_branch L_B19_0
L_B19_1w:
    ds_read_b32 v3, v7
    s_waitcnt lgkmcnt(0)
    v_readlane_b32 s84, v3, 1
    s_nop 0
    s_branch L_B19_1
L_B19_2w:
    ds_read_b32 v3, v7
    s_waitcnt lgkmcnt(0)
    v_readlane_b32 s84, v3, 2
    s_nop 0
    s_branch L_B19_2
L_B19_3w:
    ds_read_b32 v3, v7
    s_waitcnt lgkmcnt(0)
    v_readlane_b32 s84, v3, 3
    s_nop 0
    s_branch L_B19_3
L_B21_0w:
    ds_read_b32 v3, v7
    s_waitcnt lgkmcnt(0)
    v_readlane_b32 s84, v3, 0
    s_nop 0
    s_branch L_B21_0
L_B21_1w:
    ds_read_b32 v3, v7
    s_waitcnt lgkmcnt(0)
    v_readlane_b32 s84, v3, 1
    s_nop 0
    s_branch L_B21_1
L_B21_2w:
    ds_read_b32 v3, v7
    s_waitcnt lgkmcnt(0)
    v_readlane_b32 s84, v3, 2
    s_nop 0
    s_branch L_B21_2
L_B21_3w:
    ds_read_b32 v3, v7
    s_waitcnt lgkmcnt(0)
    v_readlane_b32 s84, v3, 3
    s_nop 0
    s_branch L_B21_3
L_B18_0w:
    ds_read_b32 v3, v7
    s_waitcnt lgkmcnt(0)
    v_readlane_b32 s84, v3, 0
    s_nop 0
    s_branch L_B18_0
L_B18_1w:
    ds_read_b32 v3, v7
    s_waitcnt lgkmcnt(0)
    v_readlane_b32 s84, v3, 1
    s_nop 0
    s_branch L_B18_1
L_B18_2w:
    ds_read_b32 v3, v7
    s_waitcnt lgkmcnt(0)
    v_readlane_b32 s84, v3, 2
    s_nop 0
    s_branch L_B18_2
L_B18_3w:
    ds_read_b32 v3, v7
    s_waitcnt lgkmcnt(0)
    v_readlane_b32 s84, v3, 3
    s_nop 0
    s_branch L_B18_3
L_B22_0w:
    ds_read_b32 v3, v7
    s_waitcnt lgkmcnt(0)
    v_readlane_b32 s84, v3, 0
    s_nop 0
    s_branch L_B22_0
L_B22_1w:
    ds_read_b32 v3, v7
    s_waitcnt lgkmcnt(0)
    v_readlane_b32 s84, v3, 1
    s_nop 0
    s_branch L_B22_1
L_B22_2w:
    ds_read_b32 v3, v7
    s_waitcnt lgkmcnt(0)
    v_readlane_b32 s84, v3, 2
    s_nop 0
    s_branch L_B22_2
L_B22_3w:
    ds_read_b32 v3, v7
    s_waitcnt lgkmcnt(0)
    v_readlane_b32 s84, v3, 3
    s_nop 0
    s_branch L_B22_3
L_B17_0w:
    ds_read_b32 v3, v7
    s_waitcnt lgkmcnt(0)
    v_readlane_b32 s84, v3, 0
    s_nop 0
    s_branch L_B17_0
L_B17_1w:
    ds_read_b32 v3, v7
    s_waitcnt lgkmcnt(0)
    v_readlane_b32 s84, v3, 1
    s_nop 0
    s_branch L_B17_1
L_B17_2w:
    ds_read_b32 v3, v7
    s_waitcnt lgkmcnt(0)
    v_readlane_b32 s84, v3, 2
    s_nop 0
    s_branch L_B17_2
L_B17_3w:
    ds_read_b32 v3, v7
    s_waitcnt lgkmcnt(0)
    v_readlane_b32 s84, v3, 3
    s_nop 0
    s_branch L_B17_3
L_B23_0w:
    ds_read_b32 v3, v7
    s_waitcnt lgkmcnt(0)
    v_readlane_b32 s84, v3, 0
    s_nop 0
    s_branch L_B23_0
L_B23_1w:
    ds_read_b32 v3, v7
    s_waitcnt lgkmcnt(0)
    v_readlane_b32 s84, v3, 1
    s_nop 0
    s_branch L_B23_1
L_B23_2w:
    ds_read_b32 v3, v7
    s_waitcnt lgkmcnt(0)
    v_readlane_b32 s84, v3, 2
    s_nop 0
    s_branch L_B23_2
L_B23_3w:
    ds_read_b32 v3, v7
    s_waitcnt lgkmcnt(0)
    v_readlane_b32 s84, v3, 3
    s_nop 0
    s_branch L_B23_3
L_B16_0w:
    ds_read_b32 v3, v7
    s_waitcnt lgkmcnt(0)
    v_readlane_b32 s84, v3, 0
    s_nop 0
    s_branch L_B16_0
L_B16_1w:
    ds_read_b32 v3, v7
    s_waitcnt lgkmcnt(0)
    v_readlane_b32 s84, v3, 1
    s_nop 0
    s_branch L_B16_1
L_B16_2w:
    ds_read_b32 v3, v7
    s_waitcnt lgkmcnt(0)
    v_readlane_b32 s84, v3, 2
    s_nop 0
    s_branch L_B16_2
L_B16_3w:
    ds_read_b32 v3, v7
    s_waitcnt lgkmcnt(0)
    v_readlane_b32 s84, v3, 3
    s_nop 0
    s_branch L_B16_3
L_B24_0w:
    ds_read_b32 v3, v7
    s_waitcnt lgkmcnt(0)
    v_readlane_b32 s84, v3, 0
    s_nop 0
    s_branch L_B24_0
L_B24_1w:
    ds_read_b32 v3, v7
    s_waitcnt lgkmcnt(0)
    v_readlane_b32 s84, v3, 1
    s_nop 0
    s_branch L_B24_1
L_B24_2w:
    ds_read_b32 v3, v7
    s_waitcnt lgkmcnt(0)
    v_readlane_b32 s84, v3, 2
    s_nop 0
    s_branch L_B24_2
L_B24_3w:
    ds_read_b32 v3, v7
    s_waitcnt lgkmcnt(0)
    v_readlane_b32 s84, v3, 3
    s_nop 0
    s_branch L_B24_3
L_B15_0w:
    ds_read_b32 v3, v7
    s_waitcnt lgkmcnt(0)
    v_readlane_b32 s84, v3, 0
    s_nop 0
    s_branch L_B15_0
L_B15_1w:
    ds_read_b32 v3, v7
    s_waitcnt lgkmcnt(0)
    v_readlane_b32 s84, v3, 1
    s_nop 0
    s_branch L_B15_1
L_B15_2w:
    ds_read_b32 v3, v7
    s_waitcnt lgkmcnt(0)
    v_readlane_b32 s84, v3, 2
    s_nop 0
    s_branch L_B15_2
L_B15_3w:
    ds_read_b32 v3, v7
    s_waitcnt lgkmcnt(0)
    v_readlane_b32 s84, v3, 3
    s_nop 0
    s_branch L_B15_3
L_B25_0w:
    ds_read_b32 v3, v7
    s_waitcnt lgkmcnt(0)
    v_readlane_b32 s84, v3, 0
    s_nop 0
    s_branch L_B25_0
L_B25_1w:
    ds_read_b32 v3, v7
    s_waitcnt lgkmcnt(0)
    v_readlane_b32 s84, v3, 1
    s_nop 0
    s_branch L_B25_1
L_B25_2w:
    ds_read_b32 v3, v7
    s_waitcnt lgkmcnt(0)
    v_readlane_b32 s84, v3, 2
    s_nop 0
    s_branch L_B25_2
L_B25_3w:
    ds_read_b32 v3, v7
    s_waitcnt lgkmcnt(0)
    v_readlane_b32 s84, v3, 3
    s_nop 0
    s_branch L_B25_3
L_B26_0w:
    ds_read_b32 v3, v7
    s_waitcnt lgkmcnt(0)
    v_readlane_b32 s84, v3, 0
    s_nop 0
    s_branch L_B26_0
L_B26_1w:
    ds_read_b32 v3, v7
    s_waitcnt lgkmcnt(0)
    v_readlane_b32 s84, v3, 1
    s_nop 0
    s_branch L_B26_1
L_B26_2w:
    ds_read_b32 v3, v7
    s_waitcnt lgkmcnt(0)
    v_readlane_b32 s84, v3, 2
    s_nop 0
    s_branch L_B26_2
L_B26_3w:
    ds_read_b32 v3, v7
    s_waitcnt lgkmcnt(0)
    v_readlane_b32 s84, v3, 3
    s_nop 0
    s_branch L_B26_3
L_B32_0w:
    ds_read_b32 v3, v7
    s_waitcnt lgkmcnt(0)
    v_readlane_b32 s84, v3, 0
    s_nop 0
    s_branch L_B32_0
L_B32_1w:
    ds_read_b32 v3, v7
    s_waitcnt lgkmcnt(0)
    v_readlane_b32 s84, v3, 1
    s_nop 0
    s_branch L_B32_1
L_B32_2w:
    ds_read_b32 v3, v7
    s_waitcnt lgkmcnt(0)
    v_readlane_b32 s84, v3, 2
    s_nop 0
    s_branch L_B32_2
L_B32_3w:
    ds_read_b32 v3, v7
    s_waitcnt lgkmcnt(0)
    v_readlane_b32 s84, v3, 3
    s_nop 0
    s_branch L_B32_3
L_tail:
L_D32:
    s_mul_i32 s92, s81, 12
    s_add_u32 s92, s92, 16
    v_mov_b32 v5, s92
L_B32:
L_B32_0:
    s_cmp_lt_i32 s84, s82
    s_cbranch_scc1 L_B32_0w
    s_waitcnt vmcnt(31)
    buffer_load_dwordx4 v2, s[4:7], s78 offen offset:0 nt lds
    v_add_u32 v5, 3, v5
    s_add_u32 s81, s81, 1
    s_and_b32 s92, s81, 7
    s_waitcnt vmcnt(31)
    buffer_load_dwordx4 v2, s[4:7], s78 offen offset:1024 nt lds
    v_readlane_b32 s84, v3, 1
    ds_read_b32 v3, v7
    s_lshl_b32 s92, s92, 11
    s_waitcnt vmcnt(31)
    buffer_load_dwordx4 v2, s[4:7], s78 offen offset:2048 nt lds
    ds_write_b32 v6, v5
    s_add_u32 s92, s92, s77
    s_and_b32 s92, s92, 16383
L_B32_1:
    s_cmp_lt_i32 s84, s82
    s_cbranch_scc1 L_B32_1w
    s_waitcnt vmcnt(31)
    buffer_load_dwordx4 v2, s[4:7], s78 offen offset:3072 nt lds
    v_add_u32 v5, 3, v5
    s_add_u32 m0, m0, s85
    s_add_u32 s78, s78, s85
    s_waitcnt vmcnt(31)
    buffer_load_dwordx4 v2, s[4:7], s78 offen offset:0 nt lds
    v_readlane_b32 s84, v3, 2
    ds_read_b32 v3, v7
    s_mul_i32 s80, s92, 768
    s_waitcnt vmcnt(31)
    buffer_load_dwordx4 v2, s[4:7], s78 offen offset:1024 nt lds
    ds_write_b32 v6, v5
    s_bfe_u32 s92, s81, 0x40003
    s_mul_i32 s92, s92, 25165824
L_B32_2:
    s_cmp_lt_i32 s84, s82
    s_cbranch_scc1 L_B32_2w
    s_waitcnt vmcnt(31)
    buffer_load_dwordx4 v2, s[4:7], s78 offen offset:2048 nt lds
    v_add_u32 v5, 3, v5
    s_add_u32 s80, s80, s79
    s_add_u32 s80, s80, s92
    s_waitcnt vmcnt(31)
    buffer_load_dwordx4 v2, s[4:7], s78 offen offset:3072 nt lds
    v_readlane_b32 s84, v3, 3
    ds_read_b32 v3, v7
    s_add_u32 m0, m0, s85
    s_add_u32 s78, s78, s85
    s_waitcnt vmcnt(31)
    buffer_load_dwordx4 v2, s[4:7], s78 offen offset:0 nt lds
    ds_write_b32 v6, v5
    s_and_b32 s86, s81, 3
    s_mul_i32 s86, s86, 12288
L_B32_3:
    s_cmp_lt_i32 s84, s82
    s_cbranch_scc1 L_B32_3w
    s_waitcnt vmcnt(31)
    buffer_load_dwordx4 v2, s[4:7], s78 offen offset:1024 nt lds
    v_add_u32 v5, 3, v5
    v_readlane_b32 s83, v3, 4
    s_waitcnt vmcnt(31)
    buffer_load_dwordx4 v2, s[4:7], s78 offen offset:2048 nt lds
    v_readlane_b32 s84, v3, 0
    ds_read_b32 v3, v7
    s_add_u32 s82, s82, 1
    s_cmp_eq_u32 s81, 256
    s_cselect_b32 s83, -1, 32
    s_cmp_ge_u32 s81, 128
    s_waitcnt vmcnt(31)
    buffer_load_dwordx4 v2, s[4:7], s78 offen offset:3072 nt lds
    ds_write_b32 v6, v5
    s_cselect_b64 s[4:5], s[56:57], s[50:51]
    s_mov_b32 m0, s86
    s_mov_b32 s78, s80
    s_cmp_eq_u32 s83, 32
    s_cbranch_scc1 L_B32
L_drain:
    v_mov_b32 v18, 3090
    s_waitcnt vmcnt(30)
    ds_write_b32 v6, v18
    v_mov_b32 v18, 3093
    s_waitcnt vmcnt(27)
    ds_write_b32 v6, v18
    v_mov_b32 v18, 3096
    s_waitcnt vmcnt(24)
    ds_write_b32 v6, v18
    v_mov_b32 v18, 3099
    s_waitcnt vmcnt(21)
    ds_write_b32 v6, v18
    v_mov_b32 v18, 3102
    s_waitcnt vmcnt(18)
    ds_write_b32 v6, v18
    v_mov_b32 v18, 3105
    s_waitcnt vmcnt(15)
    ds_write_b32 v6, v18
    v_mov_b32 v18, 3108
    s_waitcnt vmcnt(12)
    ds_write_b32 v6, v18
    v_mov_b32 v18, 3111
    s_waitcnt vmcnt(9)
    ds_write_b32 v6, v18
    v_mov_b32 v18, 3114
    s_waitcnt vmcnt(6)
    ds_write_b32 v6, v18
    v_mov_b32 v18, 3117
    s_waitcnt vmcnt(3)
    ds_write_b32 v6, v18
    v_mov_b32 v18, 3120
    s_waitcnt vmcnt(0)
    ds_write_b32 v6, v18
    s_waitcnt lgkmcnt(0)
    s_endpgm
L_other:
    s_cmp_eq_u32 s76, 5
    s_cbranch_scc1 L_helper
    s_sub_u32 s78, s76, 1
    v_lshlrev_b32 v44, 3, v1
    v_cmp_gt_u32 vcc, 24, v1
    v_mov_b32 v23, 0xffffff40
    v_mov_b32 v18, 192
    v_cndmask_b32 v23, v23, v18, vcc
    v_add_u32 v45, v44, v23
    v_mov_b32 v18, 0x80008000
    v_cndmask_b32 v46, 0, v18, vcc
    v_lshrrev_b32 v19, 4, v1
    v_and_b32 v23, 15, v1
    v_mul_u32_u24 v20, 384, v19
    v_lshl_add_u32 v20, v23, 3, v20
    v_cmp_lt_u32 s[86:87], 7, v23
    v_mov_b32 v21, -64
    v_mov_b32 v18, 320
    v_cndmask_b32 v21, v18, v21, s[86:87]
    v_add_u32 v21, v20, v21
    s_lshl2_add_u32 s95, s78, s3
    s_mul_i32 s95, s95, 384
    s_lshl2_add_u32 s89, s78, s77
    s_xor_b32 s89, s89, 8192
    s_mov_b32 s34, 12288
    s_mov_b32 s35, 0x20000
    s_mov_b32 s38, 384
    s_mov_b32 s39, 0x20000
    s_mov_b32 s42, 384
    s_mov_b32 s43, 0x20000
    s_mov_b32 s14, 6291456
    s_mov_b32 s15, 0x20000
    s_mov_b32 s18, 6291456
    s_mov_b32 s19, 0x20000
    s_waitcnt lgkmcnt(0)
    s_mov_b64 s[32:33], s[48:49]
    s_mov_b64 s[36:37], s[62:63]
    s_mov_b64 s[40:41], s[64:65]
    buffer_load_dwordx2 v[24:25], v44, s[32:35], s95 offen
    buffer_load_dwordx2 v[26:27], v45, s[32:35], s95 offen
    buffer_load_dwordx2 v[28:29], v44, s[32:35], s95 offen offset:768
    buffer_load_dwordx2 v[30:31], v45, s[32:35], s95 offen offset:768
    buffer_load_dwordx2 v[40:41], v44, s[36:39], 0 offen
    buffer_load_dwordx2 v[42:43], v44, s[40:43], 0 offen
    s_mov_b64 s[12:13], s[66:67]
    s_mov_b64 s[16:17], s[68:69]
    s_barrier
    s_mov_b32 s83, 0x05040100
    s_mov_b32 s84, 0x07060302
    s_mul_i32 s92, s78, 3072
    v_lshl_add_u32 v2, v20, 1, s92
    v_add_u32 v12, s92, v20
    v_add_u32 v13, s92, v21
    s_lshl_b32 s92, s78, 5
    s_add_u32 s92, s92, 49152
    v_lshl_add_u32 v3, v19, 3, s92
    v_lshrrev_b32 v18, 3, v23
    v_lshl_add_u32 v4, v18, 7, v3
    v_lshlrev_b32 v9, 4, v23
    v_add_u32 v9, 65536, v9
    s_lshl2_add_u32 s92, s78, 77824
    v_mov_b32 v5, s92
    v_mov_b32 v6, 0
    v_mov_b32 v8, 1
    s_mul_i32 s79, s78, 3
    s_sub_u32 s79, s79, 9
    s_mov_b32 s80, 0
    s_mov_b32 s81, 0
    s_mul_i32 s92, s78, 1536
    s_add_u32 s92, s92, 65536
    v_lshl_add_u32 v14, v44, 1, s92
    v_lshl_add_u32 v16, v45, 1, s92
    s_waitcnt vmcnt(0)
    v_xor_b32 v42, v42, v46
    v_xor_b32 v43, v43, v46
    v_lshlrev_b32 v48, 16, v40
    v_and_b32 v49, 0xffff0000, v40
    v_lshlrev_b32 v50, 16, v41
    v_and_b32 v51, 0xffff0000, v41
    v_lshlrev_b32 v52, 16, v42
    v_and_b32 v53, 0xffff0000, v42
    v_lshlrev_b32 v54, 16, v43
    v_and_b32 v55, 0xffff0000, v43
    v_and_b32 v46, 0x80000000, v46
    s_mov_b32 exec_hi, 0xffff
    v_lshlrev_b32 v56, 16, v24
    v_and_b32 v57, 0xffff0000, v24
    v_lshlrev_b32 v58, 16, v25
    v_and_b32 v59, 0xffff0000, v25
    v_lshlrev_b32 v60, 16, v26
    v_and_b32 v61, 0xffff0000, v26
    v_lshlrev_b32 v62, 16, v27
    v_and_b32 v63, 0xffff0000, v27
    v_pk_mul_f32 v[56:57], v[56:57], v[48:49]
    v_pk_mul_f32 v[60:61], v[60:61], v[52:53]
    v_pk_mul_f32 v[58:59], v[58:59], v[50:51]
    v_pk_mul_f32 v[62:63], v[62:63], v[54:55]
    v_cvt_pk_bf16_f32 v56, v56, v60
    v_cvt_pk_bf16_f32 v57, v57, v61
    v_cvt_pk_bf16_f32 v58, v58, v62
    v_cvt_pk_bf16_f32 v59, v59, v63
    v_and_b32 v60, 0xffff0000, v56
    v_lshlrev_b32 v56, 16, v56
    v_and_b32 v61, 0xffff0000, v57
    v_lshlrev_b32 v57, 16, v57
    v_and_b32 v62, 0xffff0000, v58
    v_lshlrev_b32 v58, 16, v58
    v_and_b32 v63, 0xffff0000, v59
    v_lshlrev_b32 v59, 16, v59
    v_pk_add_f32 v[56:57], v[56:57], v[60:61]
    v_pk_add_f32 v[58:59], v[58:59], v[62:63]
    v_cvt_pk_bf16_f32 v64, v56, v56
    v_cvt_pk_bf16_f32 v65, v57, v57
    v_cvt_pk_bf16_f32 v66, v58, v58
    v_cvt_pk_bf16_f32 v67, v59, v59
    v_xor_b32 v64, v64, v46
    v_xor_b32 v65, v65, v46
    v_xor_b32 v66, v66, v46
    v_xor_b32 v67, v67, v46
    ds_write_b16 v14, v64 offset:0
    ds_write_b16_d16_hi v16, v64 offset:2
    ds_write_b16 v14, v65 offset:4
    ds_write_b16_d16_hi v16, v65 offset:6
    ds_write_b16 v14, v66 offset:8
    ds_write_b16_d16_hi v16, v66 offset:10
    ds_write_b16 v14, v67 offset:12
    ds_write_b16_d16_hi v16, v67 offset:14
    v_lshlrev_b32 v56, 16, v28
    v_and_b32 v57, 0xffff0000, v28
    v_lshlrev_b32 v58, 16, v29
    v_and_b32 v59, 0xffff0000, v29
    v_lshlrev_b32 v60, 16, v30
    v_and_b32 v61, 0xffff0000, v30
    v_lshlrev_b32 v62, 16, v31
    v_and_b32 v63, 0xffff0000, v31
    v_pk_mul_f32 v[56:57], v[56:57], v[48:49]
    v_pk_mul_f32 v[60:61], v[60:61], v[52:53]
    v_pk_mul_f32 v[58:59], v[58:59], v[50:51]
    v_pk_mul_f32 v[62:63], v[62:63], v[54:55]
    v_cvt_pk_bf16_f32 v56, v56, v60
    v_cvt_pk_bf16_f32 v57, v57, v61
    v_cvt_pk_bf16_f32 v58, v58, v62
    v_cvt_pk_bf16_f32 v59, v59, v63
    v_and_b32 v60, 0xffff0000, v56
    v_lshlrev_b32 v56, 16, v56
    v_and_b32 v61, 0xffff0000, v57
    v_lshlrev_b32 v57, 16, v57
    v_and_b32 v62, 0xffff0000, v58
    v_lshlrev_b32 v58, 16, v58
    v_and_b32 v63, 0xffff0000, v59
    v_lshlrev_b32 v59, 16, v59
    v_pk_add_f32 v[56:57], v[56:57], v[60:61]
    v_pk_add_f32 v[58:59], v[58:59], v[62:63]
    v_cvt_pk_bf16_f32 v68, v56, v56
    v_cvt_pk_bf16_f32 v69, v57, v57
    v_cvt_pk_bf16_f32 v70, v58, v58
    v_cvt_pk_bf16_f32 v71, v59, v59
    v_xor_b32 v68, v68, v46
    v_xor_b32 v69, v69, v46
    v_xor_b32 v70, v70, v46
    v_xor_b32 v71, v71, v46
    ds_write_b16 v14, v68 offset:768
    ds_write_b16_d16_hi v16, v68 offset:770
    ds_write_b16 v14, v69 offset:772
    ds_write_b16_d16_hi v16, v69 offset:774
    ds_write_b16 v14, v70 offset:776
    ds_write_b16_d16_hi v16, v70 offset:778
    ds_write_b16 v14, v71 offset:780
    ds_write_b16_d16_hi v16, v71 offset:782
    s_mov_b32 exec_hi, -1
    ds_write_b32 v5, v8 offset:160
    s_add_u32 s79, s79, 12
    s_cmp_ge_i32 s80, s79
    s_cbranch_scc1 L_cr0g
L_cr0:
    ds_read_b32 v19, v7
    s_sleep 1
    s_waitcnt lgkmcnt(0)
    v_readlane_b32 s80, v19, 5
    s_nop 0
    s_cmp_lt_i32 s80, s79
    s_cbranch_scc1 L_cr0
L_cr0g:
    ds_read_b64 v[72:73], v12 offset:0
    ds_read_b64 v[76:77], v12 offset:128
    ds_read_b64 v[80:81], v12 offset:256
    ds_read_b64 v[84:85], v12 offset:1536
    ds_read_b64 v[88:89], v12 offset:1664
    ds_read_b64 v[92:93], v12 offset:1792
    v_add_u32 v6, 1, v6
    ds_write_b32 v5, v6
    s_add_u32 s79, s79, 12
    s_cmp_ge_i32 s80, s79
    s_cbranch_scc1 L_cr1g
L_cr1:
    ds_read_b32 v19, v7
    s_sleep 1
    s_waitcnt lgkmcnt(0)
    v_readlane_b32 s80, v19, 5
    s_nop 0
    s_cmp_lt_i32 s80, s79
    s_cbranch_scc1 L_cr1
L_cr1g:
    ds_read_b64 v[74:75], v12 offset:12480
    ds_read_b64 v[78:79], v13 offset:12288
    ds_read_b64 v[82:83], v12 offset:12352
    ds_read_b64 v[86:87], v12 offset:14016
    ds_read_b64 v[90:91], v13 offset:13824
    ds_read_b64 v[94:95], v12 offset:13888
    v_add_u32 v6, 1, v6
    ds_write_b32 v5, v6
    s_mul_i32 s82, s89, 384
    s_add_u32 s89, s89, 2048
    s_and_b32 s89, s89, 16383
    buffer_load_dwordx2 v[120:121], v20, s[12:15], s82 offen offset:0
    buffer_load_dwordx2 v[122:123], v20, s[16:19], s82 offen offset:192
    buffer_load_dwordx2 v[124:125], v20, s[12:15], s82 offen offset:128
    buffer_load_dwordx2 v[126:127], v21, s[16:19], s82 offen
    buffer_load_dwordx2 v[128:129], v20, s[12:15], s82 offen offset:256
    buffer_load_dwordx2 v[130:131], v20, s[16:19], s82 offen offset:64
    s_add_u32 s79, s79, 12
    s_cmp_ge_i32 s80, s79
    s_cbranch_scc1 L_cr2g
L_cr2:
    ds_read_b32 v19, v7
    s_sleep 1
    s_waitcnt lgkmcnt(0)
    v_readlane_b32 s80, v19, 5
    s_nop 0
    s_cmp_lt_i32 s80, s79
    s_cbranch_scc1 L_cr2
L_cr2g:
    ds_read_b64 v[96:97], v12 offset:24576
    ds_read_b64 v[100:101], v12 offset:24704
    ds_read_b64 v[104:105], v12 offset:24832
    ds_read_b64 v[108:109], v12 offset:26112
    ds_read_b64 v[112:113], v12 offset:26240
    ds_read_b64 v[116:117], v12 offset:26368
    v_add_u32 v6, 1, v6
    ds_write_b32 v5, v6
    s_add_u32 s79, s79, 12
    s_cmp_ge_i32 s80, s79
    s_cbranch_scc1 L_cr3g
L_cr3:
    ds_read_b32 v19, v7
    s_sleep 1
    s_waitcnt lgkmcnt(0)
    v_readlane_b32 s80, v19, 5
    s_nop 0
    s_cmp_lt_i32 s80, s79
    s_cbranch_scc1 L_cr3
L_cr3g:
    ds_read_b64 v[98:99], v12 offset:37056
    ds_read_b64 v[102:103], v13 offset:36864
    ds_read_b64 v[106:107], v12 offset:36928
    ds_read_b64 v[110:111], v12 offset:38592
    ds_read_b64 v[114:115], v13 offset:38400
    ds_read_b64 v[118:119], v12 offset:38464
    v_add_u32 v6, 1, v6
    ds_write_b32 v5, v6
    s_mul_i32 s82, s89, 384
    s_add_u32 s89, s89, 2048
    s_and_b32 s89, s89, 16383
    buffer_load_dwordx2 v[132:133], v20, s[12:15], s82 offen offset:0
    buffer_load_dwordx2 v[134:135], v20, s[16:19], s82 offen offset:192
    buffer_load_dwordx2 v[136:137], v20, s[12:15], s82 offen offset:128
    buffer_load_dwordx2 v[138:139], v21, s[16:19], s82 offen
    buffer_load_dwordx2 v[140:141], v20, s[12:15], s82 offen offset:256
    buffer_load_dwordx2 v[142:143], v20, s[16:19], s82 offen offset:64
L_kph:
    s_lshr_b32 s94, s81, 1
    s_add_u32 s88, s94, 40
    s_lshl2_add_u32 s92, s94, 77888
    v_mov_b32 v22, s92
    s_nop 1
L_kw:
    ds_read_b32 v19, v7
    ds_read_b128 v[48:51], v9 offset:0
    ds_read_b128 v[52:55], v9 offset:256
    ds_read_b128 v[56:59], v9 offset:512
    s_waitcnt lgkmcnt(0)
    v_readlane_b32 s92, v19, s88
    v_readlane_b32 s93, v19, 12
    s_cmp_eq_u32 s92, 0
    s_nop 3
    s_cbranch_scc1 L_kw
    s_cmp_le_u32 s93, s94
    s_cbranch_scc1 L_kw
    v_add_u32 v9, 768, v9
    s_cmp_lg_u32 s81, 0
    s_nop 0
    s_cbranch_scc1 L_ncs0
    v_perm_b32 v36, v74, v72, s83
    v_perm_b32 v74, v74, v72, s84
    v_perm_b32 v37, v75, v73, s83
    v_perm_b32 v75, v75, v73, s84
    v_perm_b32 v38, v78, v76, s83
    v_perm_b32 v78, v78, v76, s84
    v_perm_b32 v39, v79, v77, s83
    v_perm_b32 v79, v79, v77, s84
    v_perm_b32 v40, v82, v80, s83
    v_perm_b32 v82, v82, v80, s84
    v_perm_b32 v41, v83, v81, s83
    v_perm_b32 v83, v83, v81, s84
    v_mov_b64 v[72:73], v[36:37]
    v_mov_b64 v[76:77], v[38:39]
    v_mov_b64 v[80:81], v[40:41]
    s_nop 1
L_ncs0:
    v_dot2_f32_bf16 v36, v72, v48, 0
    v_dot2_f32_bf16 v37, v74, v49, 0
    v_dot2_f32_bf16 v38, v73, v50, 0
    v_dot2_f32_bf16 v39, v75, v51, 0
    v_dot2_f32_bf16 v40, v76, v52, 0
    v_dot2_f32_bf16 v41, v78, v53, 0
    v_dot2_f32_bf16 v42, v77, v54, 0
    v_dot2_f32_bf16 v43, v79, v55, 0
    v_dot2_f32_bf16 v44, v80, v56, 0
    v_dot2_f32_bf16 v45, v82, v57, 0
    v_dot2_f32_bf16 v46, v81, v58, 0
    v_dot2_f32_bf16 v47, v83, v59, 0
    s_add_u32 s79, s79, 12
    s_cmp_ge_i32 s80, s79
    s_cbranch_scc1 L_kr0g
L_kr0:
    ds_read_b32 v19, v7
    s_sleep 1
    s_waitcnt lgkmcnt(0)
    v_readlane_b32 s80, v19, 5
    s_nop 0
    s_cmp_lt_i32 s80, s79
    s_cbranch_scc1 L_kr0
L_kr0g:
    ds_read_b32 v10, v3 offset:0
    ds_read_b128 v[24:27], v2 offset:0
    ds_read_b128 v[28:31], v2 offset:256
    ds_read_b128 v[32:35], v2 offset:512
    v_add_u32 v6, 1, v6
    ds_write_b32 v5, v6
    s_waitcnt lgkmcnt(3)
    v_and_b32 v12, 0xffff0000, v10
    v_cvt_f32_i32 v24, v24
    v_cvt_f32_i32 v25, v25
    v_cvt_f32_i32 v26, v26
    v_cvt_f32_i32 v27, v27
    v_pk_add_f32 v[24:25], v[24:25], v[12:13] op_sel:[0,0] op_sel_hi:[1,0] neg_lo:[0,1] neg_hi:[0,1]
    v_pk_add_f32 v[26:27], v[26:27], v[12:13] op_sel:[0,0] op_sel_hi:[1,0] neg_lo:[0,1] neg_hi:[0,1]
    v_pk_mul_f32 v[14:15], v[24:25], v[36:37]
    v_pk_fma_f32 v[14:15], v[26:27], v[38:39], v[14:15]
    s_waitcnt lgkmcnt(2)
    v_cvt_f32_i32 v28, v28
    v_cvt_f32_i32 v29, v29
    v_cvt_f32_i32 v30, v30
    v_cvt_f32_i32 v31, v31
    v_pk_add_f32 v[28:29], v[28:29], v[12:13] op_sel:[0,0] op_sel_hi:[1,0] neg_lo:[0,1] neg_hi:[0,1]
    v_pk_add_f32 v[30:31], v[30:31], v[12:13] op_sel:[0,0] op_sel_hi:[1,0] neg_lo:[0,1] neg_hi:[0,1]
    v_pk_fma_f32 v[14:15], v[28:29], v[40:41], v[14:15]
    v_pk_fma_f32 v[14:15], v[30:31], v[42:43], v[14:15]
    s_waitcnt lgkmcnt(1)
    v_cvt_f32_i32 v32, v32
    v_cvt_f32_i32 v33, v33
    v_cvt_f32_i32 v34, v34
    v_cvt_f32_i32 v35, v35
    v_pk_add_f32 v[32:33], v[32:33], v[12:13] op_sel:[0,0] op_sel_hi:[1,0] neg_lo:[0,1] neg_hi:[0,1]
    v_pk_add_f32 v[34:35], v[34:35], v[12:13] op_sel:[0,0] op_sel_hi:[1,0] neg_lo:[0,1] neg_hi:[0,1]
    v_pk_fma_f32 v[14:15], v[32:33], v[44:45], v[14:15]
    v_pk_fma_f32 v[14:15], v[34:35], v[46:47], v[14:15]
    v_add_f32 v14, v14, v15
    s_nop 1
    v_add_f32_dpp v18, v14, v14 row_ror:8 row_mask:0xf bank_mask:0x3
    s_cmp_lg_u32 s81, 0
    s_nop 0
    s_cbranch_scc1 L_ncs1
    s_mul_i32 s82, s89, 384
    s_add_u32 s89, s89, 2048
    s_and_b32 s89, s89, 16383
    buffer_load_dwordx2 v[144:145], v20, s[12:15], s82 offen offset:0
    buffer_load_dwordx2 v[146:147], v20, s[16:19], s82 offen offset:192
    buffer_load_dwordx2 v[148:149], v20, s[12:15], s82 offen offset:128
    buffer_load_dwordx2 v[150:151], v21, s[16:19], s82 offen
    buffer_load_dwordx2 v[152:153], v20, s[12:15], s82 offen offset:256
    buffer_load_dwordx2 v[154:155], v20, s[16:19], s82 offen offset:64
    v_perm_b32 v36, v86, v84, s83
    v_perm_b32 v86, v86, v84, s84
    v_perm_b32 v37, v87, v85, s83
    v_perm_b32 v87, v87, v85, s84
    v_perm_b32 v38, v90, v88, s83
    v_perm_b32 v90, v90, v88, s84
    v_perm_b32 v39, v91, v89, s83
    v_perm_b32 v91, v91, v89, s84
    v_perm_b32 v40, v94, v92, s83
    v_perm_b32 v94, v94, v92, s84
    v_perm_b32 v41, v95, v93, s83
    v_perm_b32 v95, v95, v93, s84
    v_mov_b64 v[84:85], v[36:37]
    v_mov_b64 v[88:89], v[38:39]
    v_mov_b64 v[92:93], v[40:41]
    s_nop 1
L_ncs1:
    v_dot2_f32_bf16 v36, v84, v48, 0
    v_dot2_f32_bf16 v37, v86, v49, 0
    v_dot2_f32_bf16 v38, v85, v50, 0
    v_dot2_f32_bf16 v39, v87, v51, 0
    v_dot2_f32_bf16 v40, v88, v52, 0
    v_dot2_f32_bf16 v41, v90, v53, 0
    v_dot2_f32_bf16 v42, v89, v54, 0
    v_dot2_f32_bf16 v43, v91, v55, 0
    v_dot2_f32_bf16 v44, v92, v56, 0
    v_dot2_f32_bf16 v45, v94, v57, 0
    v_dot2_f32_bf16 v46, v93, v58, 0
    v_dot2_f32_bf16 v47, v95, v59, 0
    s_add_u32 s79, s79, 12
    s_cmp_ge_i32 s80, s79
    s_cbranch_scc1 L_kr1g
L_kr1:
    ds_read_b32 v19, v7
    s_sleep 1
    s_waitcnt lgkmcnt(0)
    v_readlane_b32 s80, v19, 5
    s_nop 0
    s_cmp_lt_i32 s80, s79
    s_cbranch_scc1 L_kr1
L_kr1g:
    ds_read_b32 v11, v3 offset:128
    ds_read_b128 v[24:27], v2 offset:12288
    ds_read_b128 v[28:31], v2 offset:12544
    ds_read_b128 v[32:35], v2 offset:12800
    v_add_u32 v6, 1, v6
    ds_write_b32 v5, v6
    s_waitcnt lgkmcnt(3)
    v_and_b32 v12, 0xffff0000, v11
    v_cvt_f32_i32 v24, v24
    v_cvt_f32_i32 v25, v25
    v_cvt_f32_i32 v26, v26
    v_cvt_f32_i32 v27, v27
    v_pk_add_f32 v[24:25], v[24:25], v[12:13] op_sel:[0,0] op_sel_hi:[1,0] neg_lo:[0,1] neg_hi:[0,1]
    v_pk_add_f32 v[26:27], v[26:27], v[12:13] op_sel:[0,0] op_sel_hi:[1,0] neg_lo:[0,1] neg_hi:[0,1]
    v_pk_mul_f32 v[16:17], v[24:25], v[36:37]
    v_pk_fma_f32 v[16:17], v[26:27], v[38:39], v[16:17]
    s_waitcnt lgkmcnt(2)
    v_cvt_f32_i32 v28, v28
    v_cvt_f32_i32 v29, v29
    v_cvt_f32_i32 v30, v30
    v_cvt_f32_i32 v31, v31
    v_pk_add_f32 v[28:29], v[28:29], v[12:13] op_sel:[0,0] op_sel_hi:[1,0] neg_lo:[0,1] neg_hi:[0,1]
    v_pk_add_f32 v[30:31], v[30:31], v[12:13] op_sel:[0,0] op_sel_hi:[1,0] neg_lo:[0,1] neg_hi:[0,1]
    v_pk_fma_f32 v[16:17], v[28:29], v[40:41], v[16:17]
    v_pk_fma_f32 v[16:17], v[30:31], v[42:43], v[16:17]
    s_waitcnt lgkmcnt(1)
    v_cvt_f32_i32 v32, v32
    v_cvt_f32_i32 v33, v33
    v_cvt_f32_i32 v34, v34
    v_cvt_f32_i32 v35, v35
    v_pk_add_f32 v[32:33], v[32:33], v[12:13] op_sel:[0,0] op_sel_hi:[1,0] neg_lo:[0,1] neg_hi:[0,1]
    v_pk_add_f32 v[34:35], v[34:35], v[12:13] op_sel:[0,0] op_sel_hi:[1,0] neg_lo:[0,1] neg_hi:[0,1]
    v_pk_fma_f32 v[16:17], v[32:33], v[44:45], v[16:17]
    v_pk_fma_f32 v[16:17], v[34:35], v[46:47], v[16:17]
    v_add_f32 v16, v16, v17
    v_cndmask_b32 v23, v10, v11, s[86:87]
    v_lshlrev_b32 v23, 16, v23
    v_add_f32_dpp v18, v16, v16 row_ror:8 row_mask:0xf bank_mask:0xc
    v_mul_f32 v23, 0x3dd53b95, v23
    s_nop 0
    v_add_f32_dpp v18, v18, v18 row_half_mirror row_mask:0xf bank_mask:0xf
    s_nop 1
    v_add_f32_dpp v18, v18, v18 quad_perm:[2,3,0,1] row_mask:0xf bank_mask:0xf
    s_nop 1
    v_add_f32_dpp v18, v18, v18 quad_perm:[1,0,3,2] row_mask:0xf bank_mask:0xf
    v_mul_f32 v18, v23, v18
    ds_write_b32 v4, v18 offset:0
    s_cmp_lg_u32 s81, 0
    s_cbranch_scc1 L_ncs2
    v_perm_b32 v36, v98, v96, s83
    v_perm_b32 v98, v98, v96, s84
    v_perm_b32 v37, v99, v97, s83
    v_perm_b32 v99, v99, v97, s84
    v_perm_b32 v38, v102, v100, s83
    v_perm_b32 v102, v102, v100, s84
    v_perm_b32 v39, v103, v101, s83
    v_perm_b32 v103, v103, v101, s84
    v_perm_b32 v40, v106, v104, s83
    v_perm_b32 v106, v106, v104, s84
    v_perm_b32 v41, v107, v105, s83
    v_perm_b32 v107, v107, v105, s84
    v_mov_b64 v[96:97], v[36:37]
    v_mov_b64 v[100:101], v[38:39]
    v_mov_b64 v[104:105], v[40:41]
    s_nop 1
L_ncs2:
    v_dot2_f32_bf16 v36, v96, v48, 0
    v_dot2_f32_bf16 v37, v98, v49, 0
    v_dot2_f32_bf16 v38, v97, v50, 0
    v_dot2_f32_bf16 v39, v99, v51, 0
    v_dot2_f32_bf16 v40, v100, v52, 0
    v_dot2_f32_bf16 v41, v102, v53, 0
    v_dot2_f32_bf16 v42, v101, v54, 0
    v_dot2_f32_bf16 v43, v103, v55, 0
    v_dot2_f32_bf16 v44, v104, v56, 0
    v_dot2_f32_bf16 v45, v106, v57, 0
    v_dot2_f32_bf16 v46, v105, v58, 0
    v_dot2_f32_bf16 v47, v107, v59, 0
    s_add_u32 s79, s79, 12
    s_cmp_ge_i32 s80, s79
    s_cbranch_scc1 L_kr2g
L_kr2:
    ds_read_b32 v19, v7
    s_sleep 1
    s_waitcnt lgkmcnt(0)
    v_readlane_b32 s80, v19, 5
    s_nop 0
    s_cmp_lt_i32 s80, s79
    s_cbranch_scc1 L_kr2
L_kr2g:
    ds_read_b32 v10, v3 offset:256
    ds_read_b128 v[24:27], v2 offset:24576
    ds_read_b128 v[28:31], v2 offset:24832
    ds_read_b128 v[32:35], v2 offset:25088
    v_add_u32 v6, 1, v6
    ds_write_b32 v5, v6
    s_waitcnt lgkmcnt(3)
    v_and_b32 v12, 0xffff0000, v10
    v_cvt_f32_i32 v24, v24
    v_cvt_f32_i32 v25, v25
    v_cvt_f32_i32 v26, v26
    v_cvt_f32_i32 v27, v27
    v_pk_add_f32 v[24:25], v[24:25], v[12:13] op_sel:[0,0] op_sel_hi:[1,0] neg_lo:[0,1] neg_hi:[0,1]
    v_pk_add_f32 v[26:27], v[26:27], v[12:13] op_sel:[0,0] op_sel_hi:[1,0] neg_lo:[0,1] neg_hi:[0,1]
    v_pk_mul_f32 v[14:15], v[24:25], v[36:37]
    v_pk_fma_f32 v[14:15], v[26:27], v[38:39], v[14:15]
    s_waitcnt lgkmcnt(2)
    v_cvt_f32_i32 v28, v28
    v_cvt_f32_i32 v29, v29
    v_cvt_f32_i32 v30, v30
    v_cvt_f32_i32 v31, v31
    v_pk_add_f32 v[28:29], v[28:29], v[12:13] op_sel:[0,0] op_sel_hi:[1,0] neg_lo:[0,1] neg_hi:[0,1]
    v_pk_add_f32 v[30:31], v[30:31], v[12:13] op_sel:[0,0] op_sel_hi:[1,0] neg_lo:[0,1] neg_hi:[0,1]
    v_pk_fma_f32 v[14:15], v[28:29], v[40:41], v[14:15]
    v_pk_fma_f32 v[14:15], v[30:31], v[42:43], v[14:15]
    s_waitcnt lgkmcnt(1)
    v_cvt_f32_i32 v32, v32
    v_cvt_f32_i32 v33, v33
    v_cvt_f32_i32 v34, v34
    v_cvt_f32_i32 v35, v35
    v_pk_add_f32 v[32:33], v[32:33], v[12:13] op_sel:[0,0] op_sel_hi:[1,0] neg_lo:[0,1] neg_hi:[0,1]
    v_pk_add_f32 v[34:35], v[34:35], v[12:13] op_sel:[0,0] op_sel_hi:[1,0] neg_lo:[0,1] neg_hi:[0,1]
    v_pk_fma_f32 v[14:15], v[32:33], v[44:45], v[14:15]
    v_pk_fma_f32 v[14:15], v[34:35], v[46:47], v[14:15]
    v_add_f32 v14, v14, v15
    s_nop 1
    v_add_f32_dpp v18, v14, v14 row_ror:8 row_mask:0xf bank_mask:0x3
    s_cmp_lg_u32 s81, 0
    s_nop 0
    s_cbranch_scc1 L_ncs3
    s_mul_i32 s82, s89, 384
    s_add_u32 s89, s89, 2048
    s_and_b32 s89, s89, 16383
    buffer_load_dwordx2 v[156:157], v20, s[12:15], s82 offen offset:0
    buffer_load_dwordx2 v[158:159], v20, s[16:19], s82 offen offset:192
    buffer_load_dwordx2 v[160:161], v20, s[12:15], s82 offen offset:128
    buffer_load_dwordx2 v[162:163], v21, s[16:19], s82 offen
    buffer_load_dwordx2 v[164:165], v20, s[12:15], s82 offen offset:256
    buffer_load_dwordx2 v[166:167], v20, s[16:19], s82 offen offset:64
    v_perm_b32 v36, v110, v108, s83
    v_perm_b32 v110, v110, v108, s84
    v_perm_b32 v37, v111, v109, s83
    v_perm_b32 v111, v111, v109, s84
    v_perm_b32 v38, v114, v112, s83
    v_perm_b32 v114, v114, v112, s84
    v_perm_b32 v39, v115, v113, s83
    v_perm_b32 v115, v115, v113, s84
    v_perm_b32 v40, v118, v116, s83
    v_perm_b32 v118, v118, v116, s84
    v_perm_b32 v41, v119, v117, s83
    v_perm_b32 v119, v119, v117, s84
    v_mov_b64 v[108:109], v[36:37]
    v_mov_b64 v[112:113], v[38:39]
    v_mov_b64 v[116:117], v[40:41]
    s_nop 1
L_ncs3:
    v_dot2_f32_bf16 v36, v108, v48, 0
    v_dot2_f32_bf16 v37, v110, v49, 0
    v_dot2_f32_bf16 v38, v109, v50, 0
    v_dot2_f32_bf16 v39, v111, v51, 0
    v_dot2_f32_bf16 v40, v112, v52, 0
    v_dot2_f32_bf16 v41, v114, v53, 0
    v_dot2_f32_bf16 v42, v113, v54, 0
    v_dot2_f32_bf16 v43, v115, v55, 0
    v_dot2_f32_bf16 v44, v116, v56, 0
    v_dot2_f32_bf16 v45, v118, v57, 0
    v_dot2_f32_bf16 v46, v117, v58, 0
    v_dot2_f32_bf16 v47, v119, v59, 0
    s_add_u32 s79, s79, 12
    s_cmp_ge_i32 s80, s79
    s_cbranch_scc1 L_kr3g
L_kr3:
    ds_read_b32 v19, v7
    s_sleep 1
    s_waitcnt lgkmcnt(0)
    v_readlane_b32 s80, v19, 5
    s_nop 0
    s_cmp_lt_i32 s80, s79
    s_cbranch_scc1 L_kr3
L_kr3g:
    ds_read_b32 v11, v3 offset:384
    ds_read_b128 v[24:27], v2 offset:36864
    ds_read_b128 v[28:31], v2 offset:37120
    ds_read_b128 v[32:35], v2 offset:37376
    v_add_u32 v6, 1, v6
    ds_write_b32 v5, v6
    s_waitcnt lgkmcnt(3)
    v_and_b32 v12, 0xffff0000, v11
    v_cvt_f32_i32 v24, v24
    v_cvt_f32_i32 v25, v25
    v_cvt_f32_i32 v26, v26
    v_cvt_f32_i32 v27, v27
    v_pk_add_f32 v[24:25], v[24:25], v[12:13] op_sel:[0,0] op_sel_hi:[1,0] neg_lo:[0,1] neg_hi:[0,1]
    v_pk_add_f32 v[26:27], v[26:27], v[12:13] op_sel:[0,0] op_sel_hi:[1,0] neg_lo:[0,1] neg_hi:[0,1]
    v_pk_mul_f32 v[16:17], v[24:25], v[36:37]
    v_pk_fma_f32 v[16:17], v[26:27], v[38:39], v[16:17]
    s_waitcnt lgkmcnt(2)
    v_cvt_f32_i32 v28, v28
    v_cvt_f32_i32 v29, v29
    v_cvt_f32_i32 v30, v30
    v_cvt_f32_i32 v31, v31
    v_pk_add_f32 v[28:29], v[28:29], v[12:13] op_sel:[0,0] op_sel_hi:[1,0] neg_lo:[0,1] neg_hi:[0,1]
    v_pk_add_f32 v[30:31], v[30:31], v[12:13] op_sel:[0,0] op_sel_hi:[1,0] neg_lo:[0,1] neg_hi:[0,1]
    v_pk_fma_f32 v[16:17], v[28:29], v[40:41], v[16:17]
    v_pk_fma_f32 v[16:17], v[30:31], v[42:43], v[16:17]
    s_waitcnt lgkmcnt(1)
    v_cvt_f32_i32 v32, v32
    v_cvt_f32_i32 v33, v33
    v_cvt_f32_i32 v34, v34
    v_cvt_f32_i32 v35, v35
    v_pk_add_f32 v[32:33], v[32:33], v[12:13] op_sel:[0,0] op_sel_hi:[1,0] neg_lo:[0,1] neg_hi:[0,1]
    v_pk_add_f32 v[34:35], v[34:35], v[12:13] op_sel:[0,0] op_sel_hi:[1,0] neg_lo:[0,1] neg_hi:[0,1]
    v_pk_fma_f32 v[16:17], v[32:33], v[44:45], v[16:17]
    v_pk_fma_f32 v[16:17], v[34:35], v[46:47], v[16:17]
    v_add_f32 v16, v16, v17
    v_cndmask_b32 v23, v10, v11, s[86:87]
    v_lshlrev_b32 v23, 16, v23
    v_add_f32_dpp v18, v16, v16 row_ror:8 row_mask:0xf bank_mask:0xc
    v_mul_f32 v23, 0x3dd53b95, v23
    s_nop 0
    v_add_f32_dpp v18, v18, v18 row_half_mirror row_mask:0xf bank_mask:0xf
    s_nop 1
    v_add_f32_dpp v18, v18, v18 quad_perm:[2,3,0,1] row_mask:0xf bank_mask:0xf
    s_nop 1
    v_add_f32_dpp v18, v18, v18 quad_perm:[1,0,3,2] row_mask:0xf bank_mask:0xf
    v_mul_f32 v18, v23, v18
    ds_write_b32 v4, v18 offset:256
    s_cmp_lg_u32 s81, 0
    s_cbranch_scc1 L_ncs4
    s_waitcnt vmcnt(18)
    v_perm_b32 v36, v122, v120, s83
    v_perm_b32 v122, v122, v120, s84
    v_perm_b32 v37, v123, v121, s83
    v_perm_b32 v123, v123, v121, s84
    v_perm_b32 v38, v126, v124, s83
    v_perm_b32 v126, v126, v124, s84
    v_perm_b32 v39, v127, v125, s83
    v_perm_b32 v127, v127, v125, s84
    v_perm_b32 v40, v130, v128, s83
    v_perm_b32 v130, v130, v128, s84
    v_perm_b32 v41, v131, v129, s83
    v_perm_b32 v131, v131, v129, s84
    v_mov_b64 v[120:121], v[36:37]
    v_mov_b64 v[124:125], v[38:39]
    v_mov_b64 v[128:129], v[40:41]
    s_nop 1
L_ncs4:
    v_dot2_f32_bf16 v36, v120, v48, 0
    v_dot2_f32_bf16 v37, v122, v49, 0
    v_dot2_f32_bf16 v38, v121, v50, 0
    v_dot2_f32_bf16 v39, v123, v51, 0
    v_dot2_f32_bf16 v40, v124, v52, 0
    v_dot2_f32_bf16 v41, v126, v53, 0
    v_dot2_f32_bf16 v42, v125, v54, 0
    v_dot2_f32_bf16 v43, v127, v55, 0
    v_dot2_f32_bf16 v44, v128, v56, 0
    v_dot2_f32_bf16 v45, v130, v57, 0
    v_dot2_f32_bf16 v46, v129, v58, 0
    v_dot2_f32_bf16 v47, v131, v59, 0
    s_add_u32 s79, s79, 12
    s_cmp_ge_i32 s80, s79
    s_cbranch_scc1 L_kr4g
L_kr4:
    ds_read_b32 v19, v7
    s_sleep 1
    s_waitcnt lgkmcnt(0)
    v_readlane_b32 s80, v19, 5
    s_nop 0
    s_cmp_lt_i32 s80, s79
    s_cbranch_scc1 L_kr4
L_kr4g:
    ds_read_b32 v10, v3 offset:512
    ds_read_b128 v[24:27], v2 offset:0
    ds_read_b128 v[28:31], v2 offset:256
    ds_read_b128 v[32:35], v2 offset:512
    v_add_u32 v6, 1, v6
    ds_write_b32 v5, v6
    s_waitcnt lgkmcnt(3)
    v_and_b32 v12, 0xffff0000, v10
    v_cvt_f32_i32 v24, v24
    v_cvt_f32_i32 v25, v25
    v_cvt_f32_i32 v26, v26
    v_cvt_f32_i32 v27, v27
    v_pk_add_f32 v[24:25], v[24:25], v[12:13] op_sel:[0,0] op_sel_hi:[1,0] neg_lo:[0,1] neg_hi:[0,1]
    v_pk_add_f32 v[26:27], v[26:27], v[12:13] op_sel:[0,0] op_sel_hi:[1,0] neg_lo:[0,1] neg_hi:[0,1]
    v_pk_mul_f32 v[14:15], v[24:25], v[36:37]
    v_pk_fma_f32 v[14:15], v[26:27], v[38:39], v[14:15]
    s_waitcnt lgkmcnt(2)
    v_cvt_f32_i32 v28, v28
    v_cvt_f32_i32 v29, v29
    v_cvt_f32_i32 v30, v30
    v_cvt_f32_i32 v31, v31
    v_pk_add_f32 v[28:29], v[28:29], v[12:13] op_sel:[0,0] op_sel_hi:[1,0] neg_lo:[0,1] neg_hi:[0,1]
    v_pk_add_f32 v[30:31], v[30:31], v[12:13] op_sel:[0,0] op_sel_hi:[1,0] neg_lo:[0,1] neg_hi:[0,1]
    v_pk_fma_f32 v[14:15], v[28:29], v[40:41], v[14:15]
    v_pk_fma_f32 v[14:15], v[30:31], v[42:43], v[14:15]
    s_waitcnt lgkmcnt(1)
    v_cvt_f32_i32 v32, v32
    v_cvt_f32_i32 v33, v33
    v_cvt_f32_i32 v34, v34
    v_cvt_f32_i32 v35, v35
    v_pk_add_f32 v[32:33], v[32:33], v[12:13] op_sel:[0,0] op_sel_hi:[1,0] neg_lo:[0,1] neg_hi:[0,1]
    v_pk_add_f32 v[34:35], v[34:35], v[12:13] op_sel:[0,0] op_sel_hi:[1,0] neg_lo:[0,1] neg_hi:[0,1]
    v_pk_fma_f32 v[14:15], v[32:33], v[44:45], v[14:15]
    v_pk_fma_f32 v[14:15], v[34:35], v[46:47], v[14:15]
    v_add_f32 v14, v14, v15
    s_nop 1
    v_add_f32_dpp v18, v14, v14 row_ror:8 row_mask:0xf bank_mask:0x3
    s_cmp_lg_u32 s81, 0
    s_nop 0
    s_cbranch_scc1 L_ncs5
    s_waitcnt vmcnt(12)
    v_perm_b32 v36, v134, v132, s83
    v_perm_b32 v134, v134, v132, s84
    v_perm_b32 v37, v135, v133, s83
    v_perm_b32 v135, v135, v133, s84
    v_perm_b32 v38, v138, v136, s83
    v_perm_b32 v138, v138, v136, s84
    v_perm_b32 v39, v139, v137, s83
    v_perm_b32 v139, v139, v137, s84
    v_perm_b32 v40, v142, v140, s83
    v_perm_b32 v142, v142, v140, s84
    v_perm_b32 v41, v143, v141, s83
    v_perm_b32 v143, v143, v141, s84
    v_mov_b64 v[132:133], v[36:37]
    v_mov_b64 v[136:137], v[38:39]
    v_mov_b64 v[140:141], v[40:41]
    s_nop 1
L_ncs5:
    v_dot2_f32_bf16 v36, v132, v48, 0
    v_dot2_f32_bf16 v37, v134, v49, 0
    v_dot2_f32_bf16 v38, v133, v50, 0
    v_dot2_f32_bf16 v39, v135, v51, 0
    v_dot2_f32_bf16 v40, v136, v52, 0
    v_dot2_f32_bf16 v41, v138, v53, 0
    v_dot2_f32_bf16 v42, v137, v54, 0
    v_dot2_f32_bf16 v43, v139, v55, 0
    v_dot2_f32_bf16 v44, v140, v56, 0
    v_dot2_f32_bf16 v45, v142, v57, 0
    v_dot2_f32_bf16 v46, v141, v58, 0
    v_dot2_f32_bf16 v47, v143, v59, 0
    s_add_u32 s79, s79, 12
    s_cmp_ge_i32 s80, s79
    s_cbranch_scc1 L_kr5g
L_kr5:
    ds_read_b32 v19, v7
    s_sleep 1
    s_waitcnt lgkmcnt(0)
    v_readlane_b32 s80, v19, 5
    s_nop 0
    s_cmp_lt_i32 s80, s79
    s_cbranch_scc1 L_kr5
L_kr5g:
    ds_read_b32 v11, v3 offset:640
    ds_read_b128 v[24:27], v2 offset:12288
    ds_read_b128 v[28:31], v2 offset:12544
    ds_read_b128 v[32:35], v2 offset:12800
    v_add_u32 v6, 1, v6
    ds_write_b32 v5, v6
    s_waitcnt lgkmcnt(3)
    v_and_b32 v12, 0xffff0000, v11
    v_cvt_f32_i32 v24, v24
    v_cvt_f32_i32 v25, v25
    v_cvt_f32_i32 v26, v26
    v_cvt_f32_i32 v27, v27
    v_pk_add_f32 v[24:25], v[24:25], v[12:13] op_sel:[0,0] op_sel_hi:[1,0] neg_lo:[0,1] neg_hi:[0,1]
    v_pk_add_f32 v[26:27], v[26:27], v[12:13] op_sel:[0,0] op_sel_hi:[1,0] neg_lo:[0,1] neg_hi:[0,1]
    v_pk_mul_f32 v[16:17], v[24:25], v[36:37]
    v_pk_fma_f32 v[16:17], v[26:27], v[38:39], v[16:17]
    s_waitcnt lgkmcnt(2)
    v_cvt_f32_i32 v28, v28
    v_cvt_f32_i32 v29, v29
    v_cvt_f32_i32 v30, v30
    v_cvt_f32_i32 v31, v31
    v_pk_add_f32 v[28:29], v[28:29], v[12:13] op_sel:[0,0] op_sel_hi:[1,0] neg_lo:[0,1] neg_hi:[0,1]
    v_pk_add_f32 v[30:31], v[30:31], v[12:13] op_sel:[0,0] op_sel_hi:[1,0] neg_lo:[0,1] neg_hi:[0,1]
    v_pk_fma_f32 v[16:17], v[28:29], v[40:41], v[16:17]
    v_pk_fma_f32 v[16:17], v[30:31], v[42:43], v[16:17]
    s_waitcnt lgkmcnt(1)
    v_cvt_f32_i32 v32, v32
    v_cvt_f32_i32 v33, v33
    v_cvt_f32_i32 v34, v34
    v_cvt_f32_i32 v35, v35
    v_pk_add_f32 v[32:33], v[32:33], v[12:13] op_sel:[0,0] op_sel_hi:[1,0] neg_lo:[0,1] neg_hi:[0,1]
    v_pk_add_f32 v[34:35], v[34:35], v[12:13] op_sel:[0,0] op_sel_hi:[1,0] neg_lo:[0,1] neg_hi:[0,1]
    v_pk_fma_f32 v[16:17], v[32:33], v[44:45], v[16:17]
    v_pk_fma_f32 v[16:17], v[34:35], v[46:47], v[16:17]
    v_add_f32 v16, v16, v17
    v_cndmask_b32 v23, v10, v11, s[86:87]
    v_lshlrev_b32 v23, 16, v23
    v_add_f32_dpp v18, v16, v16 row_ror:8 row_mask:0xf bank_mask:0xc
    v_mul_f32 v23, 0x3dd53b95, v23
    s_nop 0
    v_add_f32_dpp v18, v18, v18 row_half_mirror row_mask:0xf bank_mask:0xf
    s_nop 1
    v_add_f32_dpp v18, v18, v18 quad_perm:[2,3,0,1] row_mask:0xf bank_mask:0xf
    s_nop 1
    v_add_f32_dpp v18, v18, v18 quad_perm:[1,0,3,2] row_mask:0xf bank_mask:0xf
    v_mul_f32 v18, v23, v18
    ds_write_b32 v4, v18 offset:512
    s_cmp_lg_u32 s81, 0
    s_cbranch_scc1 L_ncs6
    s_waitcnt vmcnt(6)
    v_perm_b32 v36, v146, v144, s83
    v_perm_b32 v146, v146, v144, s84
    v_perm_b32 v37, v147, v145, s83
    v_perm_b32 v147, v147, v145, s84
    v_perm_b32 v38, v150, v148, s83
    v_perm_b32 v150, v150, v148, s84
    v_perm_b32 v39, v151, v149, s83
    v_perm_b32 v151, v151, v149, s84
    v_perm_b32 v40, v154, v152, s83
    v_perm_b32 v154, v154, v152, s84
    v_perm_b32 v41, v155, v153, s83
    v_perm_b32 v155, v155, v153, s84
    v_mov_b64 v[144:145], v[36:37]
    v_mov_b64 v[148:149], v[38:39]
    v_mov_b64 v[152:153], v[40:41]
    s_nop 1
L_ncs6:
    v_dot2_f32_bf16 v36, v144, v48, 0
    v_dot2_f32_bf16 v37, v146, v49, 0
    v_dot2_f32_bf16 v38, v145, v50, 0
    v_dot2_f32_bf16 v39, v147, v51, 0
    v_dot2_f32_bf16 v40, v148, v52, 0
    v_dot2_f32_bf16 v41, v150, v53, 0
    v_dot2_f32_bf16 v42, v149, v54, 0
    v_dot2_f32_bf16 v43, v151, v55, 0
    v_dot2_f32_bf16 v44, v152, v56, 0
    v_dot2_f32_bf16 v45, v154, v57, 0
    v_dot2_f32_bf16 v46, v153, v58, 0
    v_dot2_f32_bf16 v47, v155, v59, 0
    s_add_u32 s79, s79, 12
    s_cmp_ge_i32 s80, s79
    s_cbranch_scc1 L_kr6g
L_kr6:
    ds_read_b32 v19, v7
    s_sleep 1
    s_waitcnt lgkmcnt(0)
    v_readlane_b32 s80, v19, 5
    s_nop 0
    s_cmp_lt_i32 s80, s79
    s_cbranch_scc1 L_kr6
L_kr6g:
    ds_read_b32 v10, v3 offset:768
    ds_read_b128 v[24:27], v2 offset:24576
    ds_read_b128 v[28:31], v2 offset:24832
    ds_read_b128 v[32:35], v2 offset:25088
    v_add_u32 v6, 1, v6
    ds_write_b32 v5, v6
    s_waitcnt lgkmcnt(3)
    v_and_b32 v12, 0xffff0000, v10
    v_cvt_f32_i32 v24, v24
    v_cvt_f32_i32 v25, v25
    v_cvt_f32_i32 v26, v26
    v_cvt_f32_i32 v27, v27
    v_pk_add_f32 v[24:25], v[24:25], v[12:13] op_sel:[0,0] op_sel_hi:[1,0] neg_lo:[0,1] neg_hi:[0,1]
    v_pk_add_f32 v[26:27], v[26:27], v[12:13] op_sel:[0,0] op_sel_hi:[1,0] neg_lo:[0,1] neg_hi:[0,1]
    v_pk_mul_f32 v[14:15], v[24:25], v[36:37]
    v_pk_fma_f32 v[14:15], v[26:27], v[38:39], v[14:15]
    s_waitcnt lgkmcnt(2)
    v_cvt_f32_i32 v28, v28
    v_cvt_f32_i32 v29, v29
    v_cvt_f32_i32 v30, v30
    v_cvt_f32_i32 v31, v31
    v_pk_add_f32 v[28:29], v[28:29], v[12:13] op_sel:[0,0] op_sel_hi:[1,0] neg_lo:[0,1] neg_hi:[0,1]
    v_pk_add_f32 v[30:31], v[30:31], v[12:13] op_sel:[0,0] op_sel_hi:[1,0] neg_lo:[0,1] neg_hi:[0,1]
    v_pk_fma_f32 v[14:15], v[28:29], v[40:41], v[14:15]
    v_pk_fma_f32 v[14:15], v[30:31], v[42:43], v[14:15]
    s_waitcnt lgkmcnt(1)
    v_cvt_f32_i32 v32, v32
    v_cvt_f32_i32 v33, v33
    v_cvt_f32_i32 v34, v34
    v_cvt_f32_i32 v35, v35
    v_pk_add_f32 v[32:33], v[32:33], v[12:13] op_sel:[0,0] op_sel_hi:[1,0] neg_lo:[0,1] neg_hi:[0,1]
    v_pk_add_f32 v[34:35], v[34:35], v[12:13] op_sel:[0,0] op_sel_hi:[1,0] neg_lo:[0,1] neg_hi:[0,1]
    v_pk_fma_f32 v[14:15], v[32:33], v[44:45], v[14:15]
    v_pk_fma_f32 v[14:15], v[34:35], v[46:47], v[14:15]
    v_add_f32 v14, v14, v15
    s_nop 1
    v_add_f32_dpp v18, v14, v14 row_ror:8 row_mask:0xf bank_mask:0x3
    s_cmp_lg_u32 s81, 0
    s_nop 0
    s_cbranch_scc1 L_ncs7
    s_waitcnt vmcnt(0)
    v_perm_b32 v36, v158, v156, s83
    v_perm_b32 v158, v158, v156, s84
    v_perm_b32 v37, v159, v157, s83
    v_perm_b32 v159, v159, v157, s84
    v_perm_b32 v38, v162, v160, s83
    v_perm_b32 v162, v162, v160, s84
    v_perm_b32 v39, v163, v161, s83
    v_perm_b32 v163, v163, v161, s84
    v_perm_b32 v40, v166, v164, s83
    v_perm_b32 v166, v166, v164, s84
    v_perm_b32 v41, v167, v165, s83
    v_perm_b32 v167, v167, v165, s84
    v_mov_b64 v[156:157], v[36:37]
    v_mov_b64 v[160:161], v[38:39]
    v_mov_b64 v[164:165], v[40:41]
    s_nop 1
L_ncs7:
    v_dot2_f32_bf16 v36, v156, v48, 0
    v_dot2_f32_bf16 v37, v158, v49, 0
    v_dot2_f32_bf16 v38, v157, v50, 0
    v_dot2_f32_bf16 v39, v159, v51, 0
    v_dot2_f32_bf16 v40, v160, v52, 0
    v_dot2_f32_bf16 v41, v162, v53, 0
    v_dot2_f32_bf16 v42, v161, v54, 0
    v_dot2_f32_bf16 v43, v163, v55, 0
    v_dot2_f32_bf16 v44, v164, v56, 0
    v_dot2_f32_bf16 v45, v166, v57, 0
    v_dot2_f32_bf16 v46, v165, v58, 0
    v_dot2_f32_bf16 v47, v167, v59, 0
    s_add_u32 s79, s79, 12
    s_cmp_ge_i32 s80, s79
    s_cbranch_scc1 L_kr7g
L_kr7:
    ds_read_b32 v19, v7
    s_sleep 1
    s_waitcnt lgkmcnt(0)
    v_readlane_b32 s80, v19, 5
    s_nop 0
    s_cmp_lt_i32 s80, s79
    s_cbranch_scc1 L_kr7
L_kr7g:
    ds_read_b32 v11, v3 offset:896
    ds_read_b128 v[24:27], v2 offset:36864
    ds_read_b128 v[28:31], v2 offset:37120
    ds_read_b128 v[32:35], v2 offset:37376
    v_add_u32 v6, 1, v6
    ds_write_b32 v5, v6
    s_waitcnt lgkmcnt(3)
    v_and_b32 v12, 0xffff0000, v11
    v_cvt_f32_i32 v24, v24
    v_cvt_f32_i32 v25, v25
    v_cvt_f32_i32 v26, v26
    v_cvt_f32_i32 v27, v27
    v_pk_add_f32 v[24:25], v[24:25], v[12:13] op_sel:[0,0] op_sel_hi:[1,0] neg_lo:[0,1] neg_hi:[0,1]
    v_pk_add_f32 v[26:27], v[26:27], v[12:13] op_sel:[0,0] op_sel_hi:[1,0] neg_lo:[0,1] neg_hi:[0,1]
    v_pk_mul_f32 v[16:17], v[24:25], v[36:37]
    v_pk_fma_f32 v[16:17], v[26:27], v[38:39], v[16:17]
    s_waitcnt lgkmcnt(2)
    v_cvt_f32_i32 v28, v28
    v_cvt_f32_i32 v29, v29
    v_cvt_f32_i32 v30, v30
    v_cvt_f32_i32 v31, v31
    v_pk_add_f32 v[28:29], v[28:29], v[12:13] op_sel:[0,0] op_sel_hi:[1,0] neg_lo:[0,1] neg_hi:[0,1]
    v_pk_add_f32 v[30:31], v[30:31], v[12:13] op_sel:[0,0] op_sel_hi:[1,0] neg_lo:[0,1] neg_hi:[0,1]
    v_pk_fma_f32 v[16:17], v[28:29], v[40:41], v[16:17]
    v_pk_fma_f32 v[16:17], v[30:31], v[42:43], v[16:17]
    s_waitcnt lgkmcnt(1)
    v_cvt_f32_i32 v32, v32
    v_cvt_f32_i32 v33, v33
    v_cvt_f32_i32 v34, v34
    v_cvt_f32_i32 v35, v35
    v_pk_add_f32 v[32:33], v[32:33], v[12:13] op_sel:[0,0] op_sel_hi:[1,0] neg_lo:[0,1] neg_hi:[0,1]
    v_pk_add_f32 v[34:35], v[34:35], v[12:13] op_sel:[0,0] op_sel_hi:[1,0] neg_lo:[0,1] neg_hi:[0,1]
    v_pk_fma_f32 v[16:17], v[32:33], v[44:45], v[16:17]
    v_pk_fma_f32 v[16:17], v[34:35], v[46:47], v[16:17]
    v_add_f32 v16, v16, v17
    v_cndmask_b32 v23, v10, v11, s[86:87]
    v_lshlrev_b32 v23, 16, v23
    v_add_f32_dpp v18, v16, v16 row_ror:8 row_mask:0xf bank_mask:0xc
    v_mul_f32 v23, 0x3dd53b95, v23
    s_nop 0
    v_add_f32_dpp v18, v18, v18 row_half_mirror row_mask:0xf bank_mask:0xf
    s_nop 1
    v_add_f32_dpp v18, v18, v18 quad_perm:[2,3,0,1] row_mask:0xf bank_mask:0xf
    s_nop 1
    v_add_f32_dpp v18, v18, v18 quad_perm:[1,0,3,2] row_mask:0xf bank_mask:0xf
    v_mul_f32 v18, v23, v18
    ds_write_b32 v4, v18 offset:768
    s_mov_b64 exec, 1
    ds_add_u32 v22, v8
    s_mov_b64 exec, -1
    v_add_u32 v3, 1024, v3
    v_add_u32 v4, 1024, v4
    s_add_u32 s81, s81, 1
    s_cmp_lt_u32 s81, 16
    s_cbranch_scc1 L_kph
    v_subrev_u32 v3, 16384, v3
    s_mul_i32 s92, s78, 768
    s_add_u32 s92, s92, 65536
    v_and_b32 v18, 15, v1
    v_lshl_add_u32 v9, v18, 4, s92
    v_lshrrev_b32 v18, 4, v1
    v_lshl_add_u32 v9, v18, 2, v9
    v_mov_b32 v22, 77920
    s_mov_b64 s[20:21], s[74:75]
    s_mov_b32 s22, 1610612736
    s_mov_b32 s23, 0x20000
    s_mov_b64 s[28:29], s[70:71]
    s_mov_b32 s30, 12288
    s_mov_b32 s31, 0x20000
    s_lshr_b32 s93, s2, 3
    s_mul_i32 s92, s93, 43
    s_lshr_b32 s92, s92, 8
    s_mul_i32 s94, s92, 6
    s_sub_u32 s93, s93, s94
    s_and_b32 s94, s2, 6
    s_lshl1_add_u32 s92, s94, s92
    s_and_b32 s94, s2, 1
    s_lshl1_add_u32 s92, s92, s94
    s_lshl2_add_u32 s94, s92, s78
    s_mul_i32 s32, s94, 24576
    s_lshl_b32 s94, s93, 7
    s_add_u32 s32, s32, s94
    s_add_u32 s33, s32, 6144
    s_add_u32 s34, s33, 6144
    s_add_u32 s35, s34, 6144
    s_mul_i32 s36, s92, 6
    s_add_u32 s36, s36, s93
    s_lshl_b32 s36, s36, 6
    s_lshr_b32 s37, s92, 1
    s_add_u32 s37, s37, 2
    s_min_u32 s37, s37, 16
    v_lshrrev_b32 v19, 3, v1
    v_and_b32 v69, 7, v1
    v_mul_u32_u24 v68, 768, v19
    v_lshl_add_u32 v68, v69, 4, v68
    v_lshlrev_b32 v69, 3, v69
    v_lshl_add_u32 v69, v18, 1, v69
    s_lshl4_add_u32 s92, s78, 78336
    v_lshl_add_u32 v70, v19, 6, s92
    s_lshl_b32 s92, s78, 8
    s_add_u32 s92, s92, 1024
    v_add_u32 v4, s92, v7
    s_mov_b32 s81, 0
    s_nop 0
L_vph:
    v_mov_b64 v[72:73], 0
    v_mov_b64 v[74:75], 0
    v_mov_b64 v[76:77], 0
    v_mov_b64 v[78:79], 0
    v_mov_b64 v[80:81], 0
    v_mov_b64 v[82:83], 0
    s_and_b32 s92, s81, 3
    s_mul_i32 s92, s92, 3072
    v_add_u32 v71, s92, v9
    s_mov_b32 s88, 0
    s_nop 0
L_vw:
    ds_read_b32 v19, v7
    s_waitcnt lgkmcnt(0)
    v_readlane_b32 s92, v19, 15
    v_readlane_b32 s93, v19, 13
    s_add_u32 s92, s92, 4
    s_min_u32 s93, s93, s92
    s_cmp_le_u32 s93, s81
    s_nop 1
    s_cbranch_scc1 L_vw
    s_cmp_lg_u32 s81, 15
    s_cbranch_scc1 L_vit
    v_readlane_b32 s4, v19, 6
    s_cmp_ge_u32 s2, 192
    s_nop 3
    s_cbranch_scc1 L_vit
    s_cmp_eq_u32 s4, 0
    s_cbranch_scc1 L_vw
    ds_read_b128 v[64:67], v70
    s_lshr_b32 s5, s4, 8
    s_lshr_b32 s6, s4, 16
    s_lshr_b32 s7, s4, 24
L_vit:
    s_add_u32 s79, s79, 12
    s_cmp_ge_i32 s80, s79
    s_cbranch_scc1 L_vr0g
L_vr0:
    ds_read_b32 v19, v7
    s_waitcnt lgkmcnt(0)
    v_readlane_b32 s80, v19, 5
    s_nop 0
    s_cmp_lt_i32 s80, s79
    s_cbranch_scc1 L_vr0
L_vr0g:
    ds_read_b32 v10, v3 offset:0
    ds_read_b128 v[24:27], v2 offset:0
    ds_read_b128 v[28:31], v2 offset:256
    ds_read_b128 v[32:35], v2 offset:512
    v_add_u32 v6, 1, v6
    ds_write_b32 v5, v6
    s_waitcnt lgkmcnt(3)
    v_cvt_f32_i32 v24, v24
    v_cvt_f32_i32 v25, v25
    v_cvt_f32_i32 v26, v26
    v_cvt_f32_i32 v27, v27
    v_pk_fma_f32 v[72:73], v[24:25], v[10:11], v[72:73] op_sel:[0,0,0] op_sel_hi:[1,0,1]
    v_pk_fma_f32 v[74:75], v[26:27], v[10:11], v[74:75] op_sel:[0,0,0] op_sel_hi:[1,0,1]
    s_waitcnt lgkmcnt(2)
    v_cvt_f32_i32 v28, v28
    v_cvt_f32_i32 v29, v29
    v_cvt_f32_i32 v30, v30
    v_cvt_f32_i32 v31, v31
    v_pk_fma_f32 v[76:77], v[28:29], v[10:11], v[76:77] op_sel:[0,0,0] op_sel_hi:[1,0,1]
    v_pk_fma_f32 v[78:79], v[30:31], v[10:11], v[78:79] op_sel:[0,0,0] op_sel_hi:[1,0,1]
    s_waitcnt lgkmcnt(1)
    v_cvt_f32_i32 v32, v32
    v_cvt_f32_i32 v33, v33
    v_cvt_f32_i32 v34, v34
    v_cvt_f32_i32 v35, v35
    v_pk_fma_f32 v[80:81], v[32:33], v[10:11], v[80:81] op_sel:[0,0,0] op_sel_hi:[1,0,1]
    v_pk_fma_f32 v[82:83], v[34:35], v[10:11], v[82:83] op_sel:[0,0,0] op_sel_hi:[1,0,1]
    s_add_u32 s79, s79, 12
    s_cmp_ge_i32 s80, s79
    s_cbranch_scc1 L_vr1g
L_vr1:
    ds_read_b32 v19, v7
    s_waitcnt lgkmcnt(0)
    v_readlane_b32 s80, v19, 5
    s_nop 0
    s_cmp_lt_i32 s80, s79
    s_cbranch_scc1 L_vr1
L_vr1g:
    ds_read_b32 v10, v3 offset:128
    ds_read_b128 v[24:27], v2 offset:12288
    ds_read_b128 v[28:31], v2 offset:12544
    ds_read_b128 v[32:35], v2 offset:12800
    v_add_u32 v6, 1, v6
    ds_write_b32 v5, v6
    s_waitcnt lgkmcnt(3)
    v_cvt_f32_i32 v24, v24
    v_cvt_f32_i32 v25, v25
    v_cvt_f32_i32 v26, v26
    v_cvt_f32_i32 v27, v27
    v_pk_fma_f32 v[72:73], v[24:25], v[10:11], v[72:73] op_sel:[0,0,0] op_sel_hi:[1,0,1]
    v_pk_fma_f32 v[74:75], v[26:27], v[10:11], v[74:75] op_sel:[0,0,0] op_sel_hi:[1,0,1]
    s_waitcnt lgkmcnt(2)
    v_cvt_f32_i32 v28, v28
    v_cvt_f32_i32 v29, v29
    v_cvt_f32_i32 v30, v30
    v_cvt_f32_i32 v31, v31
    v_pk_fma_f32 v[76:77], v[28:29], v[10:11], v[76:77] op_sel:[0,0,0] op_sel_hi:[1,0,1]
    v_pk_fma_f32 v[78:79], v[30:31], v[10:11], v[78:79] op_sel:[0,0,0] op_sel_hi:[1,0,1]
    s_waitcnt lgkmcnt(1)
    v_cvt_f32_i32 v32, v32
    v_cvt_f32_i32 v33, v33
    v_cvt_f32_i32 v34, v34
    v_cvt_f32_i32 v35, v35
    v_pk_fma_f32 v[80:81], v[32:33], v[10:11], v[80:81] op_sel:[0,0,0] op_sel_hi:[1,0,1]
    v_pk_fma_f32 v[82:83], v[34:35], v[10:11], v[82:83] op_sel:[0,0,0] op_sel_hi:[1,0,1]
    s_add_u32 s79, s79, 12
    s_cmp_ge_i32 s80, s79
    s_cbranch_scc1 L_vr2g
L_vr2:
    ds_read_b32 v19, v7
    s_waitcnt lgkmcnt(0)
    v_readlane_b32 s80, v19, 5
    s_nop 0
    s_cmp_lt_i32 s80, s79
    s_cbranch_scc1 L_vr2
L_vr2g:
    ds_read_b32 v10, v3 offset:256
    ds_read_b128 v[24:27], v2 offset:24576
    ds_read_b128 v[28:31], v2 offset:24832
    ds_read_b128 v[32:35], v2 offset:25088
    v_add_u32 v6, 1, v6
    ds_write_b32 v5, v6
    s_waitcnt lgkmcnt(3)
    v_cvt_f32_i32 v24, v24
    v_cvt_f32_i32 v25, v25
    v_cvt_f32_i32 v26, v26
    v_cvt_f32_i32 v27, v27
    v_pk_fma_f32 v[72:73], v[24:25], v[10:11], v[72:73] op_sel:[0,0,0] op_sel_hi:[1,0,1]
    v_pk_fma_f32 v[74:75], v[26:27], v[10:11], v[74:75] op_sel:[0,0,0] op_sel_hi:[1,0,1]
    s_waitcnt lgkmcnt(2)
    v_cvt_f32_i32 v28, v28
    v_cvt_f32_i32 v29, v29
    v_cvt_f32_i32 v30, v30
    v_cvt_f32_i32 v31, v31
    v_pk_fma_f32 v[76:77], v[28:29], v[10:11], v[76:77] op_sel:[0,0,0] op_sel_hi:[1,0,1]
    v_pk_fma_f32 v[78:79], v[30:31], v[10:11], v[78:79] op_sel:[0,0,0] op_sel_hi:[1,0,1]
    s_waitcnt lgkmcnt(1)
    v_cvt_f32_i32 v32, v32
    v_cvt_f32_i32 v33, v33
    v_cvt_f32_i32 v34, v34
    v_cvt_f32_i32 v35, v35
    v_pk_fma_f32 v[80:81], v[32:33], v[10:11], v[80:81] op_sel:[0,0,0] op_sel_hi:[1,0,1]
    v_pk_fma_f32 v[82:83], v[34:35], v[10:11], v[82:83] op_sel:[0,0,0] op_sel_hi:[1,0,1]
    s_add_u32 s79, s79, 12
    s_cmp_ge_i32 s80, s79
    s_cbranch_scc1 L_vr3g
L_vr3:
    ds_read_b32 v19, v7
    s_waitcnt lgkmcnt(0)
    v_readlane_b32 s80, v19, 5
    s_nop 0
    s_cmp_lt_i32 s80, s79
    s_cbranch_scc1 L_vr3
L_vr3g:
    ds_read_b32 v10, v3 offset:384
    ds_read_b128 v[24:27], v2 offset:36864
    ds_read_b128 v[28:31], v2 offset:37120
    ds_read_b128 v[32:35], v2 offset:37376
    v_add_u32 v6, 1, v6
    ds_write_b32 v5, v6
    v_add_u32 v3, 512, v3
    s_add_u32 s88, s88, 1
    s_cmp_lt_u32 s88, 2
    s_waitcnt lgkmcnt(3)
    v_cvt_f32_i32 v24, v24
    v_cvt_f32_i32 v25, v25
    v_cvt_f32_i32 v26, v26
    v_cvt_f32_i32 v27, v27
    v_pk_fma_f32 v[72:73], v[24:25], v[10:11], v[72:73] op_sel:[0,0,0] op_sel_hi:[1,0,1]
    v_pk_fma_f32 v[74:75], v[26:27], v[10:11], v[74:75] op_sel:[0,0,0] op_sel_hi:[1,0,1]
    s_waitcnt lgkmcnt(2)
    v_cvt_f32_i32 v28, v28
    v_cvt_f32_i32 v29, v29
    v_cvt_f32_i32 v30, v30
    v_cvt_f32_i32 v31, v31
    v_pk_fma_f32 v[76:77], v[28:29], v[10:11], v[76:77] op_sel:[0,0,0] op_sel_hi:[1,0,1]
    v_pk_fma_f32 v[78:79], v[30:31], v[10:11], v[78:79] op_sel:[0,0,0] op_sel_hi:[1,0,1]
    s_waitcnt lgkmcnt(1)
    v_cvt_f32_i32 v32, v32
    v_cvt_f32_i32 v33, v33
    v_cvt_f32_i32 v34, v34
    v_cvt_f32_i32 v35, v35
    v_pk_fma_f32 v[80:81], v[32:33], v[10:11], v[80:81] op_sel:[0,0,0] op_sel_hi:[1,0,1]
    v_pk_fma_f32 v[82:83], v[34:35], v[10:11], v[82:83] op_sel:[0,0,0] op_sel_hi:[1,0,1]
    s_cbranch_scc1 L_vit
    v_permlane32_swap_b32 v72, v74
    v_permlane32_swap_b32 v73, v75
    v_permlane32_swap_b32 v76, v78
    v_permlane32_swap_b32 v77, v79
    v_permlane32_swap_b32 v80, v82
    v_permlane32_swap_b32 v81, v83
    v_pk_add_f32 v[72:73], v[72:73], v[74:75]
    v_pk_add_f32 v[76:77], v[76:77], v[78:79]
    v_pk_add_f32 v[80:81], v[80:81], v[82:83]
    v_permlane16_swap_b32 v72, v73
    v_permlane16_swap_b32 v76, v77
    v_permlane16_swap_b32 v80, v81
    v_add_f32 v36, v72, v73
    v_add_f32 v37, v76, v77
    v_add_f32 v38, v80, v81
    ds_write2st64_b32 v71, v36, v37 offset0:0 offset1:1
    ds_write_b32 v71, v38 offset:512
    s_mov_b64 exec, 1
    ds_add_u32 v22, v8
    s_mov_b64 exec, -1
    v_add_u32 v22, 4, v22
    s_add_u32 s81, s81, 1
    s_cmp_lt_u32 s81, 16
    s_cbranch_scc1 L_vph
    s_cmp_ge_u32 s2, 192
    s_cbranch_scc1 L_cend
L_gw:
    ds_read_b32 v19, v7
    s_waitcnt lgkmcnt(0)
    v_readlane_b32 s92, v19, 8
    s_nop 0
    s_cmp_lt_u32 s92, s37
    s_nop 2
    s_cbranch_scc1 L_gw
L_try:
    buffer_load_dwordx4 v[48:51], v68, s[20:23], s32 offen sc0 sc1
    buffer_load_dwordx4 v[52:55], v68, s[20:23], s33 offen sc0 sc1
    buffer_load_dwordx4 v[56:59], v68, s[20:23], s34 offen sc0 sc1
    buffer_load_dwordx4 v[60:63], v68, s[20:23], s35 offen sc0 sc1
    s_waitcnt vmcnt(3)
    v_xor_b32 v23, s4, v48
    v_bitop3_b32 v23, v23, v49, s5 bitop3:0xf6
    v_pk_mul_f32 v[14:15], v[48:49], v[64:65] op_sel:[0,0] op_sel_hi:[1,0]
    v_bitop3_b32 v23, v23, v50, s6 bitop3:0xf6
    v_bitop3_b32 v23, v23, v51, s7 bitop3:0xf6
    v_pk_mul_f32 v[16:17], v[50:51], v[64:65] op_sel:[0,0] op_sel_hi:[1,0]
    s_waitcnt vmcnt(2)
    v_bitop3_b32 v23, v23, v52, s4 bitop3:0xf6
    v_bitop3_b32 v23, v23, v53, s5 bitop3:0xf6
    v_pk_fma_f32 v[14:15], v[52:53], v[64:65], v[14:15] op_sel:[0,1,0] op_sel_hi:[1,1,1]
    v_bitop3_b32 v23, v23, v54, s6 bitop3:0xf6
    v_bitop3_b32 v23, v23, v55, s7 bitop3:0xf6
    v_pk_fma_f32 v[16:17], v[54:55], v[64:65], v[16:17] op_sel:[0,1,0] op_sel_hi:[1,1,1]
    s_waitcnt vmcnt(1)
    v_bitop3_b32 v23, v23, v56, s4 bitop3:0xf6
    v_bitop3_b32 v23, v23, v57, s5 bitop3:0xf6
    v_pk_fma_f32 v[14:15], v[56:57], v[66:67], v[14:15] op_sel:[0,0,0] op_sel_hi:[1,0,1]
    v_bitop3_b32 v23, v23, v58, s6 bitop3:0xf6
    v_bitop3_b32 v23, v23, v59, s7 bitop3:0xf6
    v_pk_fma_f32 v[16:17], v[58:59], v[66:67], v[16:17] op_sel:[0,0,0] op_sel_hi:[1,0,1]
    s_waitcnt vmcnt(0)
    v_bitop3_b32 v23, v23, v60, s4 bitop3:0xf6
    v_bitop3_b32 v23, v23, v61, s5 bitop3:0xf6
    v_pk_fma_f32 v[14:15], v[60:61], v[66:67], v[14:15] op_sel:[0,1,0] op_sel_hi:[1,1,1]
    v_bitop3_b32 v23, v23, v62, s6 bitop3:0xf6
    v_bitop3_b32 v23, v23, v63, s7 bitop3:0xf6
    v_pk_fma_f32 v[16:17], v[62:63], v[66:67], v[16:17] op_sel:[0,1,0] op_sel_hi:[1,1,1]
    v_and_b32 v23, 0xff, v23
    v_cmp_ne_u32 vcc, 0, v23
    s_nop 4
    s_cbranch_vccz L_cok
    s_mov_b64 exec, vcc
    s_sleep 1
    s_add_u32 s88, s88, 1
    s_cmp_lt_u32 s88, 400000
    s_cbranch_scc1 L_try
L_cok:
    s_mov_b64 exec, -1
    v_permlane32_swap_b32 v14, v16
    v_permlane32_swap_b32 v15, v17
    v_pk_add_f32 v[14:15], v[14:15], v[16:17]
    s_nop 1
    v_permlane16_swap_b32 v14, v15
    v_add_f32 v14, v14, v15
    ds_write_b32 v4, v14
    s_mov_b64 exec, 1
    ds_add_rtn_u32 v18, v7, v8 offset:28
    s_mov_b64 exec, -1
    ds_read2st64_b32 v[14:15], v7 offset0:4 offset1:5
    ds_read2st64_b32 v[16:17], v7 offset0:6 offset1:7
    s_waitcnt lgkmcnt(0)
    v_readfirstlane_b32 s92, v18
    v_pk_add_f32 v[14:15], v[14:15], v[16:17]
    v_add_f32 v14, v14, v15
    s_cmp_lg_u32 s92, 3
    s_nop 1
    s_cbranch_scc1 L_cend
    v_add_f32_dpp v14, v14, v14 row_ror:8 row_mask:0xf bank_mask:0xf
    s_mov_b32 exec_lo, 0x00ff00ff
    s_mov_b32 exec_hi, 0x00ff00ff
    v_cvt_pk_bf16_f32 v14, v14, v14
    buffer_store_short v14, v69, s[28:31], s36 offen
    s_nop 0
L_cend:
    s_waitcnt lgkmcnt(0)
    s_endpgm
L_helper:
    s_memrealtime s[96:97]
    v_bfe_u32 v22, v1, 2, 3
    v_lshl_add_u32 v22, v22, 11, s77
    v_and_b32 v22, 16383, v22
    v_lshrrev_b32 v19, 5, v1
    v_lshl_add_u32 v22, v19, 15, v22
    v_and_b32 v19, 3, v1
    v_lshlrev_b32 v19, 3, v19
    v_lshl_add_u32 v22, v22, 1, v19
    s_lshl_b32 s91, s3, 15
    v_lshlrev_b32 v2, 4, v1
    s_mov_b32 s6, 1048576
    s_mov_b32 s7, 0x20000
    s_mov_b32 s10, 1048576
    s_mov_b32 s11, 0x20000
    s_mov_b32 s14, 1048576
    s_mov_b32 s15, 0x20000
    s_mov_b32 s18, 1048576
    s_mov_b32 s19, 0x20000
    s_waitcnt lgkmcnt(0)
    s_mov_b64 s[4:5], s[52:53]
    s_mov_b64 s[8:9], s[54:55]
    s_mov_b64 s[12:13], s[58:59]
    s_mov_b64 s[16:17], s[60:61]
    buffer_load_dwordx2 v[108:109], v22, s[4:7], s91 offen
    buffer_load_dwordx2 v[110:111], v22, s[8:11], s91 offen
    buffer_load_dwordx2 v[112:113], v22, s[12:15], s91 offen
    buffer_load_dwordx2 v[114:115], v22, s[16:19], s91 offen
    s_add_u32 s91, s91, 131072
    s_barrier
    v_lshrrev_b32 v18, 1, v1
    v_lshlrev_b32 v18, 10, v18
    v_and_b32 v19, 1, v1
    v_lshl_add_u32 v18, v19, 6, v18
    s_lshr_b32 s92, s2, 3
    s_lshl_b32 s92, s92, 15
    s_and_b32 s93, s2, 7
    s_lshl_b32 s93, s93, 7
    s_add_u32 s92, s92, s93
    buffer_load_dword v6, v18, s[4:7], s92 offen
    buffer_load_dword v6, v18, s[8:11], s92 offen
    buffer_load_dword v6, v18, s[12:15], s92 offen
    buffer_load_dword v6, v18, s[16:19], s92 offen
    s_mov_b64 s[20:21], s[74:75]
    s_mov_b32 s22, 1610612736
    s_mov_b32 s23, 0x20000
    s_mov_b64 s[24:25], s[72:73]
    s_mov_b32 s26, 256
    s_mov_b32 s27, 0x20000
    s_mov_b64 s[32:33], s[48:49]
    s_mov_b32 s34, 12288
    s_mov_b32 s35, 0x20000
    s_mov_b64 s[36:37], s[62:63]
    s_mov_b32 s38, 384
    s_mov_b32 s39, 0x20000
    s_mov_b64 s[40:41], s[64:65]
    s_mov_b32 s42, 384
    s_mov_b32 s43, 0x20000
    v_lshlrev_b32 v44, 3, v1
    v_cmp_gt_u32 vcc, 24, v1
    v_mov_b32 v23, 0xffffff40
    v_mov_b32 v18, 192
    v_cndmask_b32 v23, v23, v18, vcc
    v_add_u32 v45, v44, v23
    v_mov_b32 v18, 0x80008000
    v_cndmask_b32 v46, 0, v18, vcc
    s_mov_b32 s78, s96
    s_mov_b32 s94, 0x05040100
    s_mov_b32 s95, 0x07060302
    v_lshlrev_b32 v9, 1, v2
    v_add_u32 v9, 49152, v9
    v_mov_b32 v3, 77824
    v_mov_b32 v4, 0
    v_mov_b32 v5, 0xff
    v_mov_b32 v12, v9
    buffer_load_dwordx2 v[40:41], v44, s[36:39], 0 offen
    buffer_load_dwordx2 v[42:43], v44, s[40:43], 0 offen
    s_mul_i32 s92, s3, 384
    s_add_u32 s92, s92, 6144
    buffer_load_dwordx2 v[136:137], v44, s[32:35], s92 offen
    buffer_load_dwordx2 v[138:139], v45, s[32:35], s92 offen
    buffer_load_dwordx2 v[140:141], v44, s[32:35], s92 offen offset:768
    buffer_load_dwordx2 v[142:143], v45, s[32:35], s92 offen offset:768
    s_add_u32 s92, s92, 1536
    buffer_load_dwordx2 v[144:145], v44, s[32:35], s92 offen
    buffer_load_dwordx2 v[146:147], v45, s[32:35], s92 offen
    buffer_load_dwordx2 v[148:149], v44, s[32:35], s92 offen offset:768
    buffer_load_dwordx2 v[150:151], v45, s[32:35], s92 offen offset:768
    s_add_u32 s92, s92, 1536
    buffer_load_dwordx2 v[152:153], v44, s[32:35], s92 offen
    buffer_load_dwordx2 v[154:155], v45, s[32:35], s92 offen
    buffer_load_dwordx2 v[156:157], v44, s[32:35], s92 offen offset:768
    buffer_load_dwordx2 v[158:159], v45, s[32:35], s92 offen offset:768
    s_add_u32 s92, s92, 1536
    buffer_load_dwordx2 v[160:161], v44, s[32:35], s92 offen
    buffer_load_dwordx2 v[162:163], v45, s[32:35], s92 offen
    buffer_load_dwordx2 v[164:165], v44, s[32:35], s92 offen offset:768
    buffer_load_dwordx2 v[166:167], v45, s[32:35], s92 offen offset:768
    s_waitcnt vmcnt(22)
    v_perm_b32 v116, v110, v108, s94
    v_perm_b32 v117, v114, v112, s94
    v_perm_b32 v118, v110, v108, s95
    v_perm_b32 v119, v114, v112, s95
    v_perm_b32 v120, v111, v109, s94
    v_perm_b32 v121, v115, v113, s94
    v_perm_b32 v122, v111, v109, s95
    v_perm_b32 v123, v115, v113, s95
    s_lshr_b32 s92, s91, 17
    v_mov_b32 v19, s92
    ds_write_b128 v12, v[116:119]
    ds_write_b128 v12, v[120:123] offset:16
    ds_write_b32 v3, v19 offset:48
    v_add_u32 v12, 2048, v12
    s_mov_b32 s48, 0
    s_cmp_lg_u32 s2, 0
    s_cbranch_scc1 L_ne0
    s_mul_i32 s49, s78, 0x9e3779b1
    s_lshr_b32 s93, s49, 15
    s_xor_b32 s49, s49, s93
    s_mul_i32 s49, s49, 0x85ebca6b
    s_lshr_b32 s93, s49, 13
    s_xor_b32 s49, s49, s93
    s_max_u32 s49, s49, 1
    v_mov_b32 v14, s49
    v_mov_b32 v15, 0
    s_mov_b64 exec, 1
    buffer_atomic_cmpswap v[14:15], v4, s[24:27], 0 offen sc0 sc1
    s_waitcnt vmcnt(0)
    v_readfirstlane_b32 s48, v14
    s_mov_b64 exec, -1
    s_cmp_eq_u32 s48, 0
    s_cselect_b32 s48, s49, s48
    s_nop 1
L_ne0:
    s_getpc_b64 s[92:93]
L_pc:
    s_sub_u32 s92, s92, L_pc-standalone__kv_cache_quant_pre_rope_vs_post_rope__decode_kernel
    s_subb_u32 s93, s93, 0
    s_lshr_b32 s94, s2, 3
    v_lshl_add_u32 v19, v1, 5, s94
    v_lshlrev_b32 v19, 7, v19
    v_min_u32 v19, L_end-standalone__kv_cache_quant_pre_rope_vs_post_rope__decode_kernel, v19
    s_mov_b64 exec, 63
    global_load_dword v6, v19, s[92:93]
    s_mov_b64 exec, -1
    v_lshlrev_b32 v18, 1, v44
    v_lshlrev_b32 v19, 1, v45
    v_add_u32 v18, 71680, v18
    v_add_u32 v19, 71680, v19
    v_mov_b32 v23, 78000
    s_mov_b32 s89, 0
    s_waitcnt vmcnt(1) lgkmcnt(0)
    v_xor_b32 v42, v42, v46
    v_xor_b32 v43, v43, v46
    v_lshlrev_b32 v48, 16, v40
    v_and_b32 v49, 0xffff0000, v40
    v_lshlrev_b32 v50, 16, v41
    v_and_b32 v51, 0xffff0000, v41
    v_lshlrev_b32 v52, 16, v42
    v_and_b32 v53, 0xffff0000, v42
    v_lshlrev_b32 v54, 16, v43
    v_and_b32 v55, 0xffff0000, v43
    v_and_b32 v46, 0x80000000, v46
    s_nop 1
L_hq:
    v_mov_b64 v[24:25], v[136:137]
    v_mov_b64 v[26:27], v[138:139]
    v_mov_b64 v[28:29], v[140:141]
    v_mov_b64 v[30:31], v[142:143]
    v_mov_b64 v[136:137], v[144:145]
    v_mov_b64 v[138:139], v[146:147]
    v_mov_b64 v[140:141], v[148:149]
    v_mov_b64 v[142:143], v[150:151]
    v_mov_b64 v[144:145], v[152:153]
    v_mov_b64 v[146:147], v[154:155]
    v_mov_b64 v[148:149], v[156:157]
    v_mov_b64 v[150:151], v[158:159]
    v_mov_b64 v[152:153], v[160:161]
    v_mov_b64 v[154:155], v[162:163]
    v_mov_b64 v[156:157], v[164:165]
    v_mov_b64 v[158:159], v[166:167]
    s_mov_b32 exec_hi, 0xffff
    v_lshlrev_b32 v56, 16, v24
    v_and_b32 v57, 0xffff0000, v24
    v_lshlrev_b32 v58, 16, v25
    v_and_b32 v59, 0xffff0000, v25
    v_lshlrev_b32 v60, 16, v26
    v_and_b32 v61, 0xffff0000, v26
    v_lshlrev_b32 v62, 16, v27
    v_and_b32 v63, 0xffff0000, v27
    v_pk_mul_f32 v[56:57], v[56:57], v[48:49]
    v_pk_mul_f32 v[60:61], v[60:61], v[52:53]
    v_pk_mul_f32 v[58:59], v[58:59], v[50:51]
    v_pk_mul_f32 v[62:63], v[62:63], v[54:55]
    v_cvt_pk_bf16_f32 v56, v56, v60
    v_cvt_pk_bf16_f32 v57, v57, v61
    v_cvt_pk_bf16_f32 v58, v58, v62
    v_cvt_pk_bf16_f32 v59, v59, v63
    v_and_b32 v60, 0xffff0000, v56
    v_lshlrev_b32 v56, 16, v56
    v_and_b32 v61, 0xffff0000, v57
    v_lshlrev_b32 v57, 16, v57
    v_and_b32 v62, 0xffff0000, v58
    v_lshlrev_b32 v58, 16, v58
    v_and_b32 v63, 0xffff0000, v59
    v_lshlrev_b32 v59, 16, v59
    v_pk_add_f32 v[56:57], v[56:57], v[60:61]
    v_pk_add_f32 v[58:59], v[58:59], v[62:63]
    v_cvt_pk_bf16_f32 v64, v56, v56
    v_cvt_pk_bf16_f32 v65, v57, v57
    v_cvt_pk_bf16_f32 v66, v58, v58
    v_cvt_pk_bf16_f32 v67, v59, v59
    v_xor_b32 v64, v64, v46
    v_xor_b32 v65, v65, v46
    v_xor_b32 v66, v66, v46
    v_xor_b32 v67, v67, v46
    ds_write_b16 v18, v64 offset:0
    ds_write_b16_d16_hi v19, v64 offset:2
    ds_write_b16 v18, v65 offset:4
    ds_write_b16_d16_hi v19, v65 offset:6
    ds_write_b16 v18, v66 offset:8
    ds_write_b16_d16_hi v19, v66 offset:10
    ds_write_b16 v18, v67 offset:12
    ds_write_b16_d16_hi v19, v67 offset:14
    v_lshlrev_b32 v56, 16, v28
    v_and_b32 v57, 0xffff0000, v28
    v_lshlrev_b32 v58, 16, v29
    v_and_b32 v59, 0xffff0000, v29
    v_lshlrev_b32 v60, 16, v30
    v_and_b32 v61, 0xffff0000, v30
    v_lshlrev_b32 v62, 16, v31
    v_and_b32 v63, 0xffff0000, v31
    v_pk_mul_f32 v[56:57], v[56:57], v[48:49]
    v_pk_mul_f32 v[60:61], v[60:61], v[52:53]
    v_pk_mul_f32 v[58:59], v[58:59], v[50:51]
    v_pk_mul_f32 v[62:63], v[62:63], v[54:55]
    v_cvt_pk_bf16_f32 v56, v56, v60
    v_cvt_pk_bf16_f32 v57, v57, v61
    v_cvt_pk_bf16_f32 v58, v58, v62
    v_cvt_pk_bf16_f32 v59, v59, v63
    v_and_b32 v60, 0xffff0000, v56
    v_lshlrev_b32 v56, 16, v56
    v_and_b32 v61, 0xffff0000, v57
    v_lshlrev_b32 v57, 16, v57
    v_and_b32 v62, 0xffff0000, v58
    v_lshlrev_b32 v58, 16, v58
    v_and_b32 v63, 0xffff0000, v59
    v_lshlrev_b32 v59, 16, v59
    v_pk_add_f32 v[56:57], v[56:57], v[60:61]
    v_pk_add_f32 v[58:59], v[58:59], v[62:63]
    v_cvt_pk_bf16_f32 v68, v56, v56
    v_cvt_pk_bf16_f32 v69, v57, v57
    v_cvt_pk_bf16_f32 v70, v58, v58
    v_cvt_pk_bf16_f32 v71, v59, v59
    v_xor_b32 v68, v68, v46
    v_xor_b32 v69, v69, v46
    v_xor_b32 v70, v70, v46
    v_xor_b32 v71, v71, v46
    ds_write_b16 v18, v68 offset:768
    ds_write_b16_d16_hi v19, v68 offset:770
    ds_write_b16 v18, v69 offset:772
    ds_write_b16_d16_hi v19, v69 offset:774
    ds_write_b16 v18, v70 offset:776
    ds_write_b16_d16_hi v19, v70 offset:778
    ds_write_b16 v18, v71 offset:780
    ds_write_b16_d16_hi v19, v71 offset:782
    s_mov_b32 exec_hi, -1
    ds_write_b32 v23, v5
    s_add_u32 s89, s89, 1
    v_add_u32 v18, 1536, v18
    v_add_u32 v19, 1536, v19
    v_add_u32 v23, 4, v23
    s_cmp_lt_u32 s89, 4
    s_waitcnt lgkmcnt(0)
    s_cbranch_scc1 L_hq
    s_cmp_lg_u32 s48, 0
    s_cbranch_scc1 L_epd
L_epw:
    s_sleep 1
    ds_read_b32 v19, v7
    s_waitcnt lgkmcnt(0)
    v_readlane_b32 s89, v19, 5
    s_nop 0
    s_cmp_lt_i32 s89, 72
    s_nop 2
    s_cbranch_scc1 L_epw
    s_buffer_load_dword s48, s[24:27], 0
    s_waitcnt lgkmcnt(0)
    s_cmp_lg_u32 s48, 0
    s_cbranch_scc1 L_epd
    s_mul_i32 s49, s78, 0x9e3779b1
    s_lshr_b32 s93, s49, 15
    s_xor_b32 s49, s49, s93
    s_mul_i32 s49, s49, 0x85ebca6b
    s_lshr_b32 s93, s49, 13
    s_xor_b32 s49, s49, s93
    s_max_u32 s49, s49, 1
    v_mov_b32 v14, s49
    v_mov_b32 v15, 0
    s_mov_b64 exec, 1
    buffer_atomic_cmpswap v[14:15], v4, s[24:27], 0 offen sc0 sc1
    s_waitcnt vmcnt(0)
    v_readfirstlane_b32 s48, v14
    s_mov_b64 exec, -1
    s_cmp_eq_u32 s48, 0
    s_cselect_b32 s48, s49, s48
    s_nop 1
L_epd:
    s_waitcnt vmcnt(0)
    s_lshr_b32 s49, s48, 8
    s_lshr_b32 s50, s48, 16
    s_lshr_b32 s51, s48, 24
    s_mov_b32 s79, 0
    s_mov_b32 s80, 0
    s_mov_b32 s85, 0
    s_mov_b32 s84, 0
    s_mov_b32 s83, 0
    s_mov_b32 s98, 0
    s_mov_b32 s99, 0
    s_mov_b32 s33, 0
    s_movk_i32 s81, 240
    s_mov_b32 s82, 0x7fffffff
    s_movk_i32 s68, 132
    s_mov_b32 s69, 0
    s_mov_b32 s86, 16
    s_lshr_b32 s92, s2, 4
    s_and_b32 s93, s2, 15
    s_cmp_eq_u32 s92, s93
    s_cselect_b32 s38, s92, 255
    s_mul_i32 s87, s38, 4352
    s_add_u32 s87, s87, 33554432
    s_mov_b32 s88, 33554432
    v_lshrrev_b32 v18, 5, v1
    v_lshlrev_b32 v11, 4, v18
    v_add_u32 v11, 78080, v11
    v_add_u32 v10, 65536, v2
    v_mov_b32 v20, 78080
    s_mov_b32 s39, 8
    s_and_b32 s41, s2, 0x70
    s_and_b32 s92, s2, 7
    s_lshl1_add_u32 s41, s92, s41
    s_lshr_b32 s92, s2, 7
    s_add_u32 s41, s41, s92
    s_lshl_b32 s92, s3, 7
    s_add_u32 s41, s41, s92
    s_lshr_b32 s92, s2, 3
    s_mul_i32 s34, s92, 43
    s_lshr_b32 s34, s34, 8
    s_mul_i32 s93, s34, 6
    s_sub_u32 s92, s92, s93
    s_and_b32 s93, s2, 6
    s_lshl1_add_u32 s34, s93, s34
    s_and_b32 s93, s2, 1
    s_lshl1_add_u32 s34, s34, s93
    s_lshr_b32 s40, s2, 3
    s_and_b32 s40, s40, 31
    s_mul_i32 s40, s40, 24
    s_addk_i32 s40, 1728
    s_cmp_lt_u32 s2, 192
    s_cselect_b32 s40, s40, 0x7fffffff
    s_mov_b32 s35, 0
    s_mov_b32 s36, 21495808
    s_mov_b32 s37, 0
L_hl:
    s_sleep 1
    ds_read_b32 v19, v7
    s_memrealtime s[96:97]
    s_waitcnt lgkmcnt(0)
    v_readlane_b32 s89, v19, 5
    v_readlane_b32 s90, v19, s86
    s_sub_u32 s96, s96, s78
    s_lshl_b32 s96, s96, 8
    s_mul_i32 s92, s80, s89
    s_add_u32 s92, s92, s79
    s_sub_u32 s92, s96, s92
    s_max_i32 s92, s92, s98
    s_min_i32 s92, s92, s99
    s_mul_i32 s92, s92, s35
    s_add_u32 s92, s92, s36
    s_ashr_i32 s92, s92, 20
    s_max_i32 s92, s92, 15
    s_min_i32 s92, s92, 26
    v_mov_b32 v18, s92
    ds_write_b32 v3, v18 offset:16
    s_cmp_ge_i32 s89, s82
    s_cbranch_scc1 L_rd
    s_cmp_ge_i32 s89, s81
    s_cbranch_scc1 L_pub
    s_cmp_ge_i32 s89, s68
    s_cbranch_scc1 L_tf
    s_cmp_eq_u32 s90, s39
    s_cbranch_scc1 L_prep
    s_cmp_ge_i32 s89, s40
    s_cbranch_scc1 L_wts
    s_cmp_eq_u32 s86, 14
    s_cbranch_scc0 L_hl
    s_branch L_late
L_tf:
    buffer_load_dwordx2 v[108:109], v22, s[4:7], s91 offen
    buffer_load_dwordx2 v[110:111], v22, s[8:11], s91 offen
    buffer_load_dwordx2 v[112:113], v22, s[12:15], s91 offen
    buffer_load_dwordx2 v[114:115], v22, s[16:19], s91 offen
    s_add_u32 s91, s91, 131072
    s_mov_b32 s94, 0x05040100
    s_mov_b32 s95, 0x07060302
    s_addk_i32 s68, 24
    s_cmp_ge_u32 s91, 1048576
    s_cselect_b32 s68, 0x7fffffff, s68
    s_waitcnt vmcnt(0)
    v_perm_b32 v116, v110, v108, s94
    v_perm_b32 v117, v114, v112, s94
    v_perm_b32 v118, v110, v108, s95
    v_perm_b32 v119, v114, v112, s95
    v_perm_b32 v120, v111, v109, s94
    v_perm_b32 v121, v115, v113, s94
    v_perm_b32 v122, v111, v109, s95
    v_perm_b32 v123, v115, v113, s95
    s_lshr_b32 s92, s91, 17
    v_mov_b32 v19, s92
    ds_write_b128 v12, v[116:119]
    ds_write_b128 v12, v[120:123] offset:16
    ds_write_b32 v3, v19 offset:48
    v_add_u32 v12, 2048, v12
    s_waitcnt lgkmcnt(0)
    s_nop 0
    s_branch L_hl
L_pub:
    s_cmp_eq_u32 s80, 0
    s_cselect_b32 s92, 850, s80
    s_sub_u32 s93, s89, s81
    s_mul_i32 s92, s92, s93
    s_sub_u32 s83, s96, s92
    s_add_u32 s82, s81, 72
    s_cmp_ge_u32 s81, 2544
    s_cselect_b32 s92, 4, 8
    s_mul_i32 s92, s92, 24
    s_add_u32 s81, s81, s92
    s_cmp_ge_u32 s38, 16
    s_cbranch_scc1 L_hl
    s_lshl_b32 s92, s78, 8
    s_add_u32 s92, s92, s83
    v_mov_b32 v14, s92
    v_mov_b32 v15, s48
    s_mov_b64 exec, 1
    buffer_store_dwordx2 v[14:15], v4, s[20:23], s87 offen sc0 sc1
    s_mov_b64 exec, -1
    s_add_u32 s87, s87, 69632
    s_branch L_hl
L_rd:
    s_lshl_b32 s92, s78, 8
    s_add_u32 s92, s92, s83
    s_mov_b32 s93, 0
    s_mov_b32 s94, 0
    s_buffer_load_dwordx2 s[52:53], s[20:23], s88
    s_add_u32 s88, s88, 4352
    s_buffer_load_dwordx2 s[54:55], s[20:23], s88
    s_add_u32 s88, s88, 4352
    s_buffer_load_dwordx2 s[56:57], s[20:23], s88
    s_add_u32 s88, s88, 4352
    s_buffer_load_dwordx2 s[58:59], s[20:23], s88
    s_add_u32 s88, s88, 4352
    s_buffer_load_dwordx2 s[60:61], s[20:23], s88
    s_add_u32 s88, s88, 4352
    s_buffer_load_dwordx2 s[62:63], s[20:23], s88
    s_add_u32 s88, s88, 4352
    s_buffer_load_dwordx2 s[64:65], s[20:23], s88
    s_add_u32 s88, s88, 4352
    s_buffer_load_dwordx2 s[66:67], s[20:23], s88
    s_add_u32 s88, s88, 4352
    s_waitcnt lgkmcnt(0)
    s_sub_u32 s52, s52, s92
    s_cmp_eq_u32 s53, s48
    s_cselect_b32 s52, s52, 0
    s_addc_u32 s93, s93, 0
    s_add_u32 s94, s94, s52
    s_sub_u32 s54, s54, s92
    s_cmp_eq_u32 s55, s48
    s_cselect_b32 s54, s54, 0
    s_addc_u32 s93, s93, 0
    s_add_u32 s94, s94, s54
    s_sub_u32 s56, s56, s92
    s_cmp_eq_u32 s57, s48
    s_cselect_b32 s56, s56, 0
    s_addc_u32 s93, s93, 0
    s_add_u32 s94, s94, s56
    s_sub_u32 s58, s58, s92
    s_cmp_eq_u32 s59, s48
    s_cselect_b32 s58, s58, 0
    s_addc_u32 s93, s93, 0
    s_add_u32 s94, s94, s58
    s_sub_u32 s60, s60, s92
    s_cmp_eq_u32 s61, s48
    s_cselect_b32 s60, s60, 0
    s_addc_u32 s93, s93, 0
    s_add_u32 s94, s94, s60
    s_sub_u32 s62, s62, s92
    s_cmp_eq_u32 s63, s48
    s_cselect_b32 s62, s62, 0
    s_addc_u32 s93, s93, 0
    s_add_u32 s94, s94, s62
    s_sub_u32 s64, s64, s92
    s_cmp_eq_u32 s65, s48
    s_cselect_b32 s64, s64, 0
    s_addc_u32 s93, s93, 0
    s_add_u32 s94, s94, s64
    s_sub_u32 s66, s66, s92
    s_cmp_eq_u32 s67, s48
    s_cselect_b32 s66, s66, 0
    s_addc_u32 s93, s93, 0
    s_add_u32 s94, s94, s66
    s_buffer_load_dwordx2 s[52:53], s[20:23], s88
    s_add_u32 s88, s88, 4352
    s_buffer_load_dwordx2 s[54:55], s[20:23], s88
    s_add_u32 s88, s88, 4352
    s_buffer_load_dwordx2 s[56:57], s[20:23], s88
    s_add_u32 s88, s88, 4352
    s_buffer_load_dwordx2 s[58:59], s[20:23], s88
    s_add_u32 s88, s88, 4352
    s_buffer_load_dwordx2 s[60:61], s[20:23], s88
    s_add_u32 s88, s88, 4352
    s_buffer_load_dwordx2 s[62:63], s[20:23], s88
    s_add_u32 s88, s88, 4352
    s_buffer_load_dwordx2 s[64:65], s[20:23], s88
    s_add_u32 s88, s88, 4352
    s_buffer_load_dwordx2 s[66:67], s[20:23], s88
    s_add_u32 s88, s88, 4352
    s_waitcnt lgkmcnt(0)
    s_sub_u32 s52, s52, s92
    s_cmp_eq_u32 s53, s48
    s_cselect_b32 s52, s52, 0
    s_addc_u32 s93, s93, 0
    s_add_u32 s94, s94, s52
    s_sub_u32 s54, s54, s92
    s_cmp_eq_u32 s55, s48
    s_cselect_b32 s54, s54, 0
    s_addc_u32 s93, s93, 0
    s_add_u32 s94, s94, s54
    s_sub_u32 s56, s56, s92
    s_cmp_eq_u32 s57, s48
    s_cselect_b32 s56, s56, 0
    s_addc_u32 s93, s93, 0
    s_add_u32 s94, s94, s56
    s_sub_u32 s58, s58, s92
    s_cmp_eq_u32 s59, s48
    s_cselect_b32 s58, s58, 0
    s_addc_u32 s93, s93, 0
    s_add_u32 s94, s94, s58
    s_sub_u32 s60, s60, s92
    s_cmp_eq_u32 s61, s48
    s_cselect_b32 s60, s60, 0
    s_addc_u32 s93, s93, 0
    s_add_u32 s94, s94, s60
    s_sub_u32 s62, s62, s92
    s_cmp_eq_u32 s63, s48
    s_cselect_b32 s62, s62, 0
    s_addc_u32 s93, s93, 0
    s_add_u32 s94, s94, s62
    s_sub_u32 s64, s64, s92
    s_cmp_eq_u32 s65, s48
    s_cselect_b32 s64, s64, 0
    s_addc_u32 s93, s93, 0
    s_add_u32 s94, s94, s64
    s_sub_u32 s66, s66, s92
    s_cmp_eq_u32 s67, s48
    s_cselect_b32 s66, s66, 0
    s_addc_u32 s93, s93, 0
    s_add_u32 s94, s94, s66
    v_cvt_f32_u32 v15, s93
    v_cvt_f32_i32 v14, s94
    v_rcp_f32 v15, v15
    s_nop 0
    v_mul_f32 v14, v14, v15
    v_cvt_i32_f32 v14, v14
    s_sub_u32 s94, s82, 72
    s_mov_b32 s82, 0x7fffffff
    v_readfirstlane_b32 s92, v14
    s_mov_b32 s95, s85
    s_min_u32 s85, s93, 1
    s_cmp_eq_u32 s93, 0
    s_nop 1
    s_cbranch_scc1 L_hl
    s_sub_u32 s98, 0, s92
    s_movk_i32 s35, 150
    s_mov_b32 s36, 21495808
    s_movk_i32 s93, 6400
    s_cmp_ge_u32 s94, 2544
    s_cmovk_i32 s35, 350
    s_cmov_b32 s36, 21495808
    s_cmovk_i32 s93, 12800
    s_add_u32 s36, s36, s37
    s_max_i32 s99, s98, 0
    s_min_i32 s98, s98, 0
    s_add_u32 s99, s99, s93
    s_sub_u32 s98, s98, s93
    s_min_i32 s99, s99, 1048576
    s_max_i32 s98, s98, -1048576
    s_add_u32 s92, s92, s83
    s_sub_u32 s93, s92, s84
    s_mov_b32 s84, s92
    s_mov_b32 s80, 22369621
    s_cmp_gt_u32 s94, 2544
    s_cmov_b32 s80, 44739243
    s_mul_hi_u32 s93, s93, s80
    s_cmp_eq_u32 s95, 0
    s_cselect_b32 s80, 850, s93
    s_max_u32 s80, s80, 1
    s_mul_i32 s93, s80, s94
    s_sub_u32 s79, s92, s93
    s_branch L_hl
L_prep:
    s_cmp_ge_u32 s86, 24
    s_cbranch_scc1 L_mrg
    ds_read_b128 v[24:27], v9
    ds_read_b128 v[28:31], v9 offset:16
    s_add_u32 s86, s86, 1
    s_sub_u32 s92, s86, 16
    s_lshl_b32 s92, s92, 1
    v_mov_b32 v23, s92
    s_waitcnt lgkmcnt(0)
    v_max_f32 v40, v24, v26
    v_max3_f32 v40, v40, v28, v30
    v_lshlrev_b32 v32, 16, v25
    v_lshlrev_b32 v33, 16, v27
    v_lshlrev_b32 v34, 16, v29
    v_lshlrev_b32 v35, 16, v31
    v_max_f32_dpp v40, v40, v40 quad_perm:[1,0,3,2] row_mask:0xf bank_mask:0xf
    s_nop 1
    v_max_f32_dpp v40, v40, v40 quad_perm:[2,3,0,1] row_mask:0xf bank_mask:0xf
    s_nop 1
    v_max_f32_dpp v40, v40, v40 row_half_mirror row_mask:0xf bank_mask:0xf
    s_nop 1
    v_max_f32_dpp v40, v40, v40 row_mirror row_mask:0xf bank_mask:0xf
    v_and_b32 v36, 0xffff0000, v25
    v_and_b32 v37, 0xffff0000, v27
    v_and_b32 v38, 0xffff0000, v29
    v_and_b32 v39, 0xffff0000, v31
    v_mov_b32 v6, v40
    s_nop 1
    v_permlane16_swap_b32 v40, v6
    v_max_f32 v40, v40, v6
    v_sub_f32 v24, v24, v40
    v_sub_f32 v26, v26, v40
    v_sub_f32 v28, v28, v40
    v_sub_f32 v30, v30, v40
    v_exp_f32 v24, v24
    v_exp_f32 v26, v26
    v_exp_f32 v28, v28
    v_exp_f32 v30, v30
    v_add_f32 v42, v24, v26
    v_add_f32 v6, v28, v30
    v_add_f32 v42, v42, v6
    v_mul_f32 v24, v24, v32
    v_mul_f32 v26, v26, v33
    v_mul_f32 v28, v28, v34
    v_mul_f32 v30, v30, v35
    ds_write_b128 v9, v[24:27]
    ds_write_b128 v9, v[28:31] offset:16
    v_mul_f32 v41, v24, v36
    v_fmac_f32 v41, v26, v37
    v_fmac_f32 v41, v28, v38
    v_fmac_f32 v41, v30, v39
    v_add_f32_dpp v42, v42, v42 quad_perm:[1,0,3,2] row_mask:0xf bank_mask:0xf
    s_nop 0
    v_add_f32_dpp v41, v41, v41 quad_perm:[1,0,3,2] row_mask:0xf bank_mask:0xf
    v_add_f32_dpp v42, v42, v42 quad_perm:[2,3,0,1] row_mask:0xf bank_mask:0xf
    s_nop 0
    v_add_f32_dpp v41, v41, v41 quad_perm:[2,3,0,1] row_mask:0xf bank_mask:0xf
    v_add_f32_dpp v42, v42, v42 row_half_mirror row_mask:0xf bank_mask:0xf
    s_nop 0
    v_add_f32_dpp v41, v41, v41 row_half_mirror row_mask:0xf bank_mask:0xf
    v_add_f32_dpp v42, v42, v42 row_mirror row_mask:0xf bank_mask:0xf
    s_nop 0
    v_add_f32_dpp v41, v41, v41 row_mirror row_mask:0xf bank_mask:0xf
    v_mov_b32 v6, v42
    s_nop 1
    v_permlane16_swap_b32 v42, v6
    v_add_f32 v42, v42, v6
    v_mov_b32 v6, v41
    s_nop 1
    v_permlane16_swap_b32 v41, v6
    v_add_f32 v41, v41, v6
    v_sub_f32 v41, 0, v41
    v_mov_b32 v43, v41
    ds_write_b128 v11, v[40:43]
    ds_write_b32 v3, v23 offset:52
    v_add_u32 v9, 2048, v9
    v_add_u32 v11, 32, v11
    s_cmp_eq_u32 s86, 24
    s_waitcnt lgkmcnt(0)
    s_cbranch_scc0 L_hl
    v_add_u32 v9, 49152, v2
    s_mov_b32 s39, 4
    v_add_u32 v18, 78080, v2
    s_mov_b64 exec, 0xffff
    ds_read_b128 v[24:27], v18
    s_lshl_b32 s92, s41, 8
    s_add_u32 s92, s92, 8388608
    s_waitcnt lgkmcnt(0)
    v_mov_b32 v25, s48
    v_mov_b32 v27, s48
    buffer_store_dwordx4 v[24:27], v2, s[20:23], s92 offen sc0 sc1
    s_mov_b64 exec, -1
    s_waitcnt vmcnt(0)
    s_branch L_hl
L_wts:
    s_and_b32 s92, s34, 1
    s_lshl_b32 s92, s92, 15
    s_lshr_b32 s93, s34, 1
    s_lshl4_add_u32 s92, s93, s92
    s_add_u32 s92, s92, 8388608
    s_add_u32 s93, s92, 16384
    v_lshlrev_b32 v18, 8, v1
    s_cmp_eq_u32 s33, 0
    s_nop 0
    s_cbranch_scc0 L_wt1
    s_mul_i32 s94, s69, 8
    s_bfm_b64 exec, 8, s94
    buffer_load_dwordx4 v[24:27], v18, s[20:23], s92 offen
    buffer_load_dwordx4 v[28:31], v18, s[20:23], s93 offen
    s_mov_b64 exec, -1
    s_add_u32 s69, s69, 1
    s_add_u32 s40, s89, 6
    s_min_i32 s40, s40, 2904
    s_cmp_lt_u32 s69, 8
    s_cbranch_scc1 L_hl
    s_branch L_wt2
L_wt1:
    buffer_load_dwordx4 v[24:27], v18, s[20:23], s92 offen sc0 sc1
    buffer_load_dwordx4 v[28:31], v18, s[20:23], s93 offen sc0 sc1
L_wt2:
    s_add_u32 s33, s33, 1
    s_add_u32 s40, s89, 24
    s_min_i32 s40, s40, 2904
    v_and_b32 v18, 7, v1
    v_lshlrev_b32 v18, 6, v18
    v_lshrrev_b32 v19, 3, v1
    v_lshl_add_u32 v18, v19, 2, v18
    s_waitcnt vmcnt(0)
    v_xor_b32 v23, s48, v25
    v_bitop3_b32 v23, v23, v27, s48 bitop3:0xf6
    v_bitop3_b32 v23, v23, v29, s48 bitop3:0xf6
    v_bitop3_b32 v23, v23, v31, s48 bitop3:0xf6
    v_cmp_ne_u32 vcc, 0, v23
    s_cmp_gt_u32 s33, 200000
    s_nop 3
    s_cbranch_scc1 L_wt3
    s_cbranch_vccnz L_hl
L_wt3:
    s_mov_b32 s40, 0x7fffffff
    v_max_f32 v23, v24, v28
    s_nop 1
    v_max_f32_dpp v23, v23, v23 quad_perm:[1,0,3,2] row_mask:0xf bank_mask:0xf
    s_nop 1
    v_max_f32_dpp v23, v23, v23 quad_perm:[2,3,0,1] row_mask:0xf bank_mask:0xf
    s_nop 1
    v_max_f32_dpp v23, v23, v23 row_half_mirror row_mask:0xf bank_mask:0xf
    s_nop 1
    v_max_f32_dpp v23, v23, v23 row_mirror row_mask:0xf bank_mask:0xf
    v_mov_b32 v6, v23
    s_nop 1
    v_permlane32_swap_b32 v23, v6
    v_max_f32 v23, v23, v6
    v_mov_b32 v6, v23
    s_nop 1
    v_permlane16_swap_b32 v23, v6
    v_max_f32 v23, v23, v6
    v_sub_f32 v24, v24, v23
    v_sub_f32 v28, v28, v23
    v_exp_f32 v24, v24
    v_exp_f32 v28, v28
    v_mul_f32 v23, v24, v26
    v_fmac_f32 v23, v28, v30
    s_nop 1
    v_add_f32_dpp v23, v23, v23 quad_perm:[1,0,3,2] row_mask:0xf bank_mask:0xf
    s_nop 1
    v_add_f32_dpp v23, v23, v23 quad_perm:[2,3,0,1] row_mask:0xf bank_mask:0xf
    s_nop 1
    v_add_f32_dpp v23, v23, v23 row_half_mirror row_mask:0xf bank_mask:0xf
    s_nop 1
    v_add_f32_dpp v23, v23, v23 row_mirror row_mask:0xf bank_mask:0xf
    v_mov_b32 v6, v23
    s_nop 1
    v_permlane32_swap_b32 v23, v6
    v_add_f32 v23, v23, v6
    v_mov_b32 v6, v23
    s_nop 1
    v_permlane16_swap_b32 v23, v6
    v_add_f32 v23, v23, v6
    v_rcp_f32 v23, v23
    s_nop 0
    v_mul_f32 v24, v24, v23
    v_mul_f32 v28, v28, v23
    v_add_u32 v18, 78336, v18
    ds_write2_b32 v18, v24, v28 offset0:0 offset1:8
    v_mov_b32 v19, s48
    ds_write_b32 v3, v19 offset:24
    s_waitcnt lgkmcnt(0)
    s_branch L_hl
L_mrg:
    ds_read_b32 v104, v20 offset:4
    ds_read_b128 v[88:91], v10 offset:0
    ds_read_b128 v[92:95], v10 offset:768
    ds_read_b128 v[96:99], v10 offset:1536
    ds_read_b128 v[100:103], v10 offset:2304
    s_add_u32 s86, s86, 1
    s_sub_u32 s92, s86, 24
    v_mov_b32 v23, s92
    ds_write_b32 v3, v23 offset:60
    s_and_b32 s92, s92, 3
    s_cselect_b32 s92, 1, -3
    s_mul_i32 s92, s92, 3072
    v_add_u32 v10, s92, v10
    v_add_u32 v20, 16, v20
    s_cmp_eq_u32 s86, 39
    s_cselect_b32 s86, 14, s86
    s_waitcnt lgkmcnt(0)
    v_pk_add_f32 v[88:89], v[88:89], v[104:105] op_sel:[0,0] op_sel_hi:[1,0]
    v_pk_add_f32 v[90:91], v[90:91], v[104:105] op_sel:[0,0] op_sel_hi:[1,0]
    v_pk_add_f32 v[92:93], v[92:93], v[96:97]
    v_pk_add_f32 v[94:95], v[94:95], v[98:99]
    v_pk_add_f32 v[88:89], v[88:89], v[100:101]
    v_pk_add_f32 v[90:91], v[90:91], v[102:103]
    v_pk_add_f32 v[88:89], v[88:89], v[92:93]
    v_pk_add_f32 v[90:91], v[90:91], v[94:95]
    v_bfi_b32 v84, v5, s48, v88
    v_bfi_b32 v85, v5, s49, v89
    v_bfi_b32 v86, v5, s50, v90
    v_bfi_b32 v87, v5, s51, v91
    ds_write_b128 v9, v[84:87]
    v_add_u32 v9, 1024, v9
    s_waitcnt lgkmcnt(0)
    s_nop 0
    s_branch L_hl
L_late:
    s_getpc_b64 s[92:93]
L_pc2:
    v_lshlrev_b32 v19, 7, v1
    v_min_u32 v19, L_end-L_pc2, v19
    s_mov_b64 exec, 0xff
    global_load_dword v6, v19, s[92:93]
    s_mov_b64 exec, -1
    s_mul_i32 s32, s41, 768
    s_add_u32 s39, s32, 2949120
    s_mul_i32 s42, s80, 3112
    s_add_u32 s42, s42, s79
    s_cmp_eq_u32 s80, 0
    s_cselect_b32 s42, -2, s42
    s_min_u32 s42, s42, -2
    v_add_u32 v9, 49152, v2
    ds_read_b128 v[24:27], v9 offset:0
    ds_read_b128 v[28:31], v9 offset:1024
    ds_read_b128 v[32:35], v9 offset:2048
    ds_read_b128 v[36:39], v9 offset:3072
    ds_read_b128 v[40:43], v9 offset:4096
    ds_read_b128 v[44:47], v9 offset:5120
    ds_read_b128 v[48:51], v9 offset:6144
    ds_read_b128 v[52:55], v9 offset:7168
    ds_read_b128 v[56:59], v9 offset:8192
    ds_read_b128 v[60:63], v9 offset:9216
    s_waitcnt lgkmcnt(0)
    ds_read_b128 v[64:67], v9 offset:10240
    ds_read_b128 v[68:71], v9 offset:11264
    ds_read_b128 v[72:75], v9 offset:12288
    ds_read_b128 v[76:79], v9 offset:13312
    ds_read_b128 v[80:83], v9 offset:14336
    ds_read_b32 v104, v20 offset:4
    s_mov_b32 exec_hi, 0xffff
L_w7:
    ds_read_b32 v19, v7
    ds_read_b128 v[88:91], v10 offset:0
    ds_read_b128 v[92:95], v10 offset:768
    ds_read_b128 v[96:99], v10 offset:1536
    ds_read_b128 v[100:103], v10 offset:2304
    s_memrealtime s[96:97]
    s_waitcnt lgkmcnt(0)
    v_readlane_b32 s92, v19, 39
    v_readlane_b32 s89, v19, 5
    s_cmp_eq_u32 s92, 4
    s_nop 3
    s_cbranch_scc1 L_g7
    s_sub_u32 s96, s96, s78
    s_lshl_b32 s96, s96, 8
    s_cmp_ge_i32 s89, 3084
    s_cbranch_scc1 L_ns7
    s_mul_i32 s92, s80, s89
    s_add_u32 s92, s92, s79
    s_sub_u32 s92, s96, s92
    s_max_i32 s92, s92, s98
    s_min_i32 s92, s92, s99
    s_mul_i32 s92, s92, s35
    s_add_u32 s92, s92, s36
    s_ashr_i32 s92, s92, 20
    s_max_i32 s92, s92, 15
    s_min_i32 s92, s92, 26
    v_mov_b32 v18, s92
    ds_write_b32 v3, v18 offset:16
    s_nop 0
L_ns7:
    s_cmp_lt_u32 s96, s42
    s_cbranch_scc1 L_w7
    buffer_store_dwordx4 v[24:27], v2, s[20:23], s32 offen sc0 sc1
    s_add_u32 s32, s32, 196608
    buffer_store_dwordx4 v[28:31], v2, s[20:23], s32 offen sc0 sc1
    s_add_u32 s32, s32, 196608
    buffer_store_dwordx4 v[32:35], v2, s[20:23], s32 offen sc0 sc1
    s_add_u32 s32, s32, 196608
    buffer_store_dwordx4 v[36:39], v2, s[20:23], s32 offen sc0 sc1
    s_add_u32 s32, s32, 196608
    buffer_store_dwordx4 v[40:43], v2, s[20:23], s32 offen sc0 sc1
    s_add_u32 s32, s32, 196608
    buffer_store_dwordx4 v[44:47], v2, s[20:23], s32 offen sc0 sc1
    s_add_u32 s32, s32, 196608
    buffer_store_dwordx4 v[48:51], v2, s[20:23], s32 offen sc0 sc1
    s_add_u32 s32, s32, 196608
    buffer_store_dwordx4 v[52:55], v2, s[20:23], s32 offen sc0 sc1
    s_add_u32 s32, s32, 196608
    buffer_store_dwordx4 v[56:59], v2, s[20:23], s32 offen sc0 sc1
    s_add_u32 s32, s32, 196608
    buffer_store_dwordx4 v[60:63], v2, s[20:23], s32 offen sc0 sc1
    s_add_u32 s32, s32, 196608
    buffer_store_dwordx4 v[64:67], v2, s[20:23], s32 offen sc0 sc1
    s_add_u32 s32, s32, 196608
    buffer_store_dwordx4 v[68:71], v2, s[20:23], s32 offen sc0 sc1
    s_add_u32 s32, s32, 196608
    buffer_store_dwordx4 v[72:75], v2, s[20:23], s32 offen sc0 sc1
    s_add_u32 s32, s32, 196608
    buffer_store_dwordx4 v[76:79], v2, s[20:23], s32 offen sc0 sc1
    s_add_u32 s32, s32, 196608
    buffer_store_dwordx4 v[80:83], v2, s[20:23], s32 offen sc0 sc1
    s_mov_b32 s42, -1
    s_nop 0
L_w8:
    ds_read_b32 v19, v7
    ds_read_b128 v[88:91], v10 offset:0
    ds_read_b128 v[92:95], v10 offset:768
    ds_read_b128 v[96:99], v10 offset:1536
    ds_read_b128 v[100:103], v10 offset:2304
    s_waitcnt lgkmcnt(4)
    v_readlane_b32 s92, v19, 39
    s_nop 0
    s_cmp_lg_u32 s92, 4
    s_waitcnt lgkmcnt(0)
    s_cbranch_scc1 L_w8
L_g7:
    v_pk_add_f32 v[88:89], v[88:89], v[104:105] op_sel:[0,0] op_sel_hi:[1,0]
    v_pk_add_f32 v[90:91], v[90:91], v[104:105] op_sel:[0,0] op_sel_hi:[1,0]
    v_pk_add_f32 v[92:93], v[92:93], v[96:97]
    v_pk_add_f32 v[94:95], v[94:95], v[98:99]
    v_pk_add_f32 v[88:89], v[88:89], v[100:101]
    v_pk_add_f32 v[90:91], v[90:91], v[102:103]
    v_pk_add_f32 v[88:89], v[88:89], v[92:93]
    v_pk_add_f32 v[90:91], v[90:91], v[94:95]
    v_bfi_b32 v84, v5, s48, v88
    v_bfi_b32 v85, v5, s49, v89
    v_bfi_b32 v86, v5, s50, v90
    v_bfi_b32 v87, v5, s51, v91
    buffer_store_dwordx4 v[84:87], v2, s[20:23], s39 offen sc0 sc1
    s_cmp_eq_u32 s42, -1
    s_nop 0
    s_cbranch_scc1 L_hend
    buffer_store_dwordx4 v[24:27], v2, s[20:23], s32 offen sc0 sc1
    s_add_u32 s32, s32, 196608
    buffer_store_dwordx4 v[28:31], v2, s[20:23], s32 offen sc0 sc1
    s_add_u32 s32, s32, 196608
    buffer_store_dwordx4 v[32:35], v2, s[20:23], s32 offen sc0 sc1
    s_add_u32 s32, s32, 196608
    buffer_store_dwordx4 v[36:39], v2, s[20:23], s32 offen sc0 sc1
    s_add_u32 s32, s32, 196608
    buffer_store_dwordx4 v[40:43], v2, s[20:23], s32 offen sc0 sc1
    s_add_u32 s32, s32, 196608
    buffer_store_dwordx4 v[44:47], v2, s[20:23], s32 offen sc0 sc1
    s_add_u32 s32, s32, 196608
    buffer_store_dwordx4 v[48:51], v2, s[20:23], s32 offen sc0 sc1
    s_add_u32 s32, s32, 196608
    buffer_store_dwordx4 v[52:55], v2, s[20:23], s32 offen sc0 sc1
    s_add_u32 s32, s32, 196608
    buffer_store_dwordx4 v[56:59], v2, s[20:23], s32 offen sc0 sc1
    s_add_u32 s32, s32, 196608
    buffer_store_dwordx4 v[60:63], v2, s[20:23], s32 offen sc0 sc1
    s_add_u32 s32, s32, 196608
    buffer_store_dwordx4 v[64:67], v2, s[20:23], s32 offen sc0 sc1
    s_add_u32 s32, s32, 196608
    buffer_store_dwordx4 v[68:71], v2, s[20:23], s32 offen sc0 sc1
    s_add_u32 s32, s32, 196608
    buffer_store_dwordx4 v[72:75], v2, s[20:23], s32 offen sc0 sc1
    s_add_u32 s32, s32, 196608
    buffer_store_dwordx4 v[76:79], v2, s[20:23], s32 offen sc0 sc1
    s_add_u32 s32, s32, 196608
    buffer_store_dwordx4 v[80:83], v2, s[20:23], s32 offen sc0 sc1
    s_mov_b32 s42, -1
    s_nop 0
L_hend:
    v_mov_b32 v18, 2
    s_waitcnt vmcnt(14)
    ds_write_b32 v3, v18 offset:32
    v_mov_b32 v18, 3
    s_waitcnt vmcnt(13)
    ds_write_b32 v3, v18 offset:32
    v_mov_b32 v18, 4
    s_waitcnt vmcnt(12)
    ds_write_b32 v3, v18 offset:32
    v_mov_b32 v18, 5
    s_waitcnt vmcnt(11)
    ds_write_b32 v3, v18 offset:32
    v_mov_b32 v18, 6
    s_waitcnt vmcnt(10)
    ds_write_b32 v3, v18 offset:32
    v_mov_b32 v18, 7
    s_waitcnt vmcnt(9)
    ds_write_b32 v3, v18 offset:32
    v_mov_b32 v18, 8
    s_waitcnt vmcnt(8)
    ds_write_b32 v3, v18 offset:32
    v_mov_b32 v18, 9
    s_waitcnt vmcnt(7)
    ds_write_b32 v3, v18 offset:32
    v_mov_b32 v18, 10
    s_waitcnt vmcnt(6)
    ds_write_b32 v3, v18 offset:32
    v_mov_b32 v18, 11
    s_waitcnt vmcnt(5)
    ds_write_b32 v3, v18 offset:32
    v_mov_b32 v18, 12
    s_waitcnt vmcnt(4)
    ds_write_b32 v3, v18 offset:32
    v_mov_b32 v18, 13
    s_waitcnt vmcnt(3)
    ds_write_b32 v3, v18 offset:32
    v_mov_b32 v18, 14
    s_waitcnt vmcnt(2)
    ds_write_b32 v3, v18 offset:32
    v_mov_b32 v18, 15
    s_waitcnt vmcnt(1)
    ds_write_b32 v3, v18 offset:32
    v_mov_b32 v18, 16
    s_waitcnt vmcnt(0)
    ds_write_b32 v3, v18 offset:32
    s_waitcnt lgkmcnt(0)
L_end:
    s_endpgm
.section .rodata,"a"
.p2align 6
.amdhsa_kernel standalone__kv_cache_quant_pre_rope_vs_post_rope__decode_kernel
  .amdhsa_next_free_vgpr 168
  .amdhsa_next_free_sgpr 102
  .amdhsa_accum_offset 168
  .amdhsa_group_segment_fixed_size 0
  .amdhsa_kernarg_size 112
  .amdhsa_user_sgpr_count 2
  .amdhsa_user_sgpr_kernarg_segment_ptr 1
  .amdhsa_system_sgpr_workgroup_id_x 1
.end_amdhsa_kernel
```

```asm
; @launch grid=(256,1,1) block=(384,1,1) lds=79872
.amdgcn_target "amdgcn-amd-amdhsa--gfx950"
.text
.globl standalone__kv_cache_quant_pre_rope_vs_post_rope__decode_kernel
.p2align 8
.type standalone__kv_cache_quant_pre_rope_vs_post_rope__decode_kernel,@function
standalone__kv_cache_quant_pre_rope_vs_post_rope__decode_kernel:
    s_load_dwordx16 s[48:63], s[0:1], 0
    s_load_dwordx8 s[64:71], s[0:1], 64
    s_load_dwordx4 s[72:75], s[0:1], 96
    s_cmp_ge_u32 s2, 256
    s_cbranch_scc1 L_end
    v_lshrrev_b32 v18, 6, v0
    v_and_b32 v1, 63, v0
    v_readfirstlane_b32 s76, v18
    v_cmp_eq_u32 vcc, 4, v1
    v_lshlrev_b32 v7, 2, v1
    v_add_u32 v7, 77824, v7
    v_cndmask_b32 v19, 0, 20, vcc
    ds_write_b32 v7, v19
    s_and_b32 s92, s2, 7
    s_lshl_b32 s77, s92, 6
    s_and_b32 s92, s2, 0x60
    s_lshl4_add_u32 s77, s92, s77
    s_and_b32 s92, s2, 0x10
    s_lshl1_add_u32 s77, s92, s77
    s_lshr_b32 s92, s2, 7
    s_lshl4_add_u32 s77, s92, s77
    s_bfe_u32 s3, s2, 0x10003
    s_mul_i32 s92, s3, 8192
    s_add_u32 s77, s77, s92
    s_cmp_lg_u32 s76, 0
    s_cbranch_scc1 L_other
    s_setprio 3
    v_lshlrev_b32 v2, 4, v1
    v_add_u32 v8, 784896, v2
    v_cmp_gt_u32 vcc, 32, v1
    s_mul_i32 s78, s77, 384
    s_mov_b32 s6, 6291456
    s_mov_b32 s7, 0x20000
    v_cndmask_b32 v4, v8, v2, vcc
    s_mov_b32 m0, 0
    s_mov_b32 s81, 0
    v_mov_b32 v6, 77844
    v_mov_b32 v5, -20
    s_waitcnt lgkmcnt(0)
    s_mov_b64 s[4:5], s[66:67]
L_i0:
    s_waitcnt vmcnt(19)
    buffer_load_dwordx4 v2, s[4:7], s78 offen offset:0  lds
    v_add_u32 v5, 3, v5
    s_add_u32 s81, s81, 1
    s_waitcnt vmcnt(19)
    buffer_load_dwordx4 v4, s[4:7], s78 offen offset:1024  lds
    s_and_b32 s92, s81, 3
    s_cselect_b32 s92, 0, -6144
    s_cmp_eq_u32 s81, 8
    s_cselect_b32 s93, 1572864, 0
    s_add_u32 s92, s92, s93
    s_bitcmp1_b32 s81, 2
    s_waitcnt vmcnt(19)
    buffer_load_dwordx4 v8, s[4:7], s78 offen offset:2048  lds
    ds_write_b32 v6, v5
    s_cselect_b64 s[4:5], s[68:69], s[66:67]
    s_addk_i32 m0, 3072
    s_addk_i32 s92, 1536
    s_add_u32 s78, s78, s92
    s_cmp_lg_u32 s81, 6
    s_cbranch_scc1 L_i1
    s_barrier
L_i1:
    s_cmp_lt_u32 s81, 16
    s_cbranch_scc1 L_i0
    ds_read_b32 v3, v7
    s_mul_i32 s79, s3, 12582912
    s_mov_b64 s[4:5], s[50:51]
    s_mov_b32 s6, 402653184
    s_mov_b32 s7, 0x20000
    s_mov_b32 m0, 0
    s_movk_i32 s85, 4096
    s_mov_b32 s81, 0
    s_mul_i32 s78, s77, 768
    s_add_u32 s78, s78, s79
    s_mov_b32 s82, 1
    s_waitcnt lgkmcnt(0)
    v_readlane_b32 s84, v3, 0
    s_nop 4
L_D20:
    s_mul_i32 s92, s81, 12
    s_add_u32 s92, s92, 28
    v_mov_b32 v5, s92
L_B20:
L_B20_0:
    s_cmp_lt_i32 s84, s82
    s_cbranch_scc1 L_B20_0w
    s_waitcnt vmcnt(19)
    buffer_load_dwordx4 v2, s[4:7], s78 offen offset:0 nt lds
    v_add_u32 v5, 3, v5
    s_add_u32 s81, s81, 1
    s_and_b32 s92, s81, 7
    s_waitcnt vmcnt(19)
    buffer_load_dwordx4 v2, s[4:7], s78 offen offset:1024 nt lds
    v_readlane_b32 s84, v3, 1
    ds_read_b32 v3, v7
    s_lshl_b32 s92, s92, 11
    s_add_u32 s92, s92, s77
    s_waitcnt vmcnt(19)
    buffer_load_dwordx4 v2, s[4:7], s78 offen offset:2048 nt lds
    ds_write_b32 v6, v5
    s_and_b32 s92, s92, 16383
    s_mul_i32 s80, s92, 768
L_B20_1:
    s_cmp_lt_i32 s84, s82
    s_cbranch_scc1 L_B20_1w
    s_waitcnt vmcnt(19)
    buffer_load_dwordx4 v2, s[4:7], s78 offen offset:3072 nt lds
    v_add_u32 v5, 3, v5
    s_add_u32 m0, m0, s85
    s_add_u32 s78, s78, s85
    s_waitcnt vmcnt(19)
    buffer_load_dwordx4 v2, s[4:7], s78 offen offset:0 nt lds
    v_readlane_b32 s84, v3, 2
    ds_read_b32 v3, v7
    s_bfe_u32 s92, s81, 0x40003
    s_bfe_i32 s93, s81, 0x10007
    s_waitcnt vmcnt(19)
    buffer_load_dwordx4 v2, s[4:7], s78 offen offset:1024 nt lds
    ds_write_b32 v6, v5
    s_xor_b32 s92, s92, s93
    s_and_b32 s92, s92, 15
L_B20_2:
    s_cmp_lt_i32 s84, s82
    s_cbranch_scc1 L_B20_2w
    s_waitcnt vmcnt(19)
    buffer_load_dwordx4 v2, s[4:7], s78 offen offset:2048 nt lds
    v_add_u32 v5, 3, v5
    s_mul_i32 s92, s92, 25165824
    s_add_u32 s80, s80, s79
    s_waitcnt vmcnt(19)
    buffer_load_dwordx4 v2, s[4:7], s78 offen offset:3072 nt lds
    v_readlane_b32 s84, v3, 3
    ds_read_b32 v3, v7
    s_add_u32 m0, m0, s85
    s_add_u32 s78, s78, s85
    s_waitcnt vmcnt(19)
    buffer_load_dwordx4 v2, s[4:7], s78 offen offset:0 nt lds
    ds_write_b32 v6, v5
    s_add_u32 s80, s80, s92
    s_and_b32 s86, s81, 3
L_B20_3:
    s_cmp_lt_i32 s84, s82
    s_cbranch_scc1 L_B20_3w
    s_waitcnt vmcnt(19)
    buffer_load_dwordx4 v2, s[4:7], s78 offen offset:1024 nt lds
    v_add_u32 v5, 3, v5
    v_readlane_b32 s83, v3, 4
    s_mul_i32 s86, s86, 12288
    s_waitcnt vmcnt(19)
    buffer_load_dwordx4 v2, s[4:7], s78 offen offset:2048 nt lds
    v_readlane_b32 s84, v3, 0
    ds_read_b32 v3, v7
    s_add_u32 s82, s82, 1
    s_cmp_ge_u32 s81, 255
    s_cselect_b32 s83, -1, s83
    s_cmp_ge_u32 s81, 128
    s_waitcnt vmcnt(19)
    buffer_load_dwordx4 v2, s[4:7], s78 offen offset:3072 nt lds
    ds_write_b32 v6, v5
    s_cselect_b64 s[4:5], s[56:57], s[50:51]
    s_mov_b32 m0, s86
    s_mov_b32 s78, s80
    s_cmp_eq_u32 s83, 20
    s_cbranch_scc1 L_B20
L_disp:
    s_cmp_eq_u32 s83, 20
    s_cbranch_scc1 L_D20
    s_cmp_eq_u32 s83, 21
    s_cbranch_scc1 L_D21
    s_cmp_eq_u32 s83, 19
    s_cbranch_scc1 L_D19
    s_cmp_eq_u32 s83, 22
    s_cbranch_scc1 L_D22
    s_cmp_eq_u32 s83, 18
    s_cbranch_scc1 L_D18
    s_cmp_eq_u32 s83, 23
    s_cbranch_scc1 L_D23
    s_cmp_eq_u32 s83, 17
    s_cbranch_scc1 L_D17
    s_cmp_eq_u32 s83, 24
    s_cbranch_scc1 L_D24
    s_cmp_eq_u32 s83, 16
    s_cbranch_scc1 L_D16
    s_cmp_eq_u32 s83, 25
    s_cbranch_scc1 L_D25
    s_cmp_eq_u32 s81, 256
    s_cbranch_scc1 L_drain
    s_cmp_ge_u32 s81, 255
    s_cbranch_scc1 L_D32
    s_cmp_ge_i32 s83, 26
    s_cbranch_scc1 L_D26
    s_branch L_D15
L_D19:
    s_mul_i32 s92, s81, 12
    s_add_u32 s92, s92, 29
    v_mov_b32 v5, s92
L_B19:
L_B19_0:
    s_cmp_lt_i32 s84, s82
    s_cbranch_scc1 L_B19_0w
    s_waitcnt vmcnt(18)
    buffer_load_dwordx4 v2, s[4:7], s78 offen offset:0 nt lds
    v_add_u32 v5, 3, v5
    s_add_u32 s81, s81, 1
    s_and_b32 s92, s81, 7
    s_waitcnt vmcnt(18)
    buffer_load_dwordx4 v2, s[4:7], s78 offen offset:1024 nt lds
    v_readlane_b32 s84, v3, 1
    ds_read_b32 v3, v7
    s_lshl_b32 s92, s92, 11
    s_add_u32 s92, s92, s77
    s_waitcnt vmcnt(18)
    buffer_load_dwordx4 v2, s[4:7], s78 offen offset:2048 nt lds
    ds_write_b32 v6, v5
    s_and_b32 s92, s92, 16383
    s_mul_i32 s80, s92, 768
L_B19_1:
    s_cmp_lt_i32 s84, s82
    s_cbranch_scc1 L_B19_1w
    s_waitcnt vmcnt(18)
    buffer_load_dwordx4 v2, s[4:7], s78 offen offset:3072 nt lds
    v_add_u32 v5, 3, v5
    s_add_u32 m0, m0, s85
    s_add_u32 s78, s78, s85
    s_waitcnt vmcnt(18)
    buffer_load_dwordx4 v2, s[4:7], s78 offen offset:0 nt lds
    v_readlane_b32 s84, v3, 2
    ds_read_b32 v3, v7
    s_bfe_u32 s92, s81, 0x40003
    s_bfe_i32 s93, s81, 0x10007
    s_waitcnt vmcnt(18)
    buffer_load_dwordx4 v2, s[4:7], s78 offen offset:1024 nt lds
    ds_write_b32 v6, v5
    s_xor_b32 s92, s92, s93
    s_and_b32 s92, s92, 15
L_B19_2:
    s_cmp_lt_i32 s84, s82
    s_cbranch_scc1 L_B19_2w
    s_waitcnt vmcnt(18)
    buffer_load_dwordx4 v2, s[4:7], s78 offen offset:2048 nt lds
    v_add_u32 v5, 3, v5
    s_mul_i32 s92, s92, 25165824
    s_add_u32 s80, s80, s79
    s_waitcnt vmcnt(18)
    buffer_load_dwordx4 v2, s[4:7], s78 offen offset:3072 nt lds
    v_readlane_b32 s84, v3, 3
    ds_read_b32 v3, v7
    s_add_u32 m0, m0, s85
    s_add_u32 s78, s78, s85
    s_waitcnt vmcnt(18)
    buffer_load_dwordx4 v2, s[4:7], s78 offen offset:0 nt lds
    ds_write_b32 v6, v5
    s_add_u32 s80, s80, s92
    s_and_b32 s86, s81, 3
L_B19_3:
    s_cmp_lt_i32 s84, s82
    s_cbranch_scc1 L_B19_3w
    s_waitcnt vmcnt(18)
    buffer_load_dwordx4 v2, s[4:7], s78 offen offset:1024 nt lds
    v_add_u32 v5, 3, v5
    v_readlane_b32 s83, v3, 4
    s_mul_i32 s86, s86, 12288
    s_waitcnt vmcnt(18)
    buffer_load_dwordx4 v2, s[4:7], s78 offen offset:2048 nt lds
    v_readlane_b32 s84, v3, 0
    ds_read_b32 v3, v7
    s_add_u32 s82, s82, 1
    s_cmp_ge_u32 s81, 255
    s_cselect_b32 s83, -1, s83
    s_cmp_ge_u32 s81, 128
    s_waitcnt vmcnt(18)
    buffer_load_dwordx4 v2, s[4:7], s78 offen offset:3072 nt lds
    ds_write_b32 v6, v5
    s_cselect_b64 s[4:5], s[56:57], s[50:51]
    s_mov_b32 m0, s86
    s_mov_b32 s78, s80
    s_cmp_eq_u32 s83, 19
    s_cbranch_scc1 L_B19
    s_cmp_eq_u32 s83, -1
    s_cbranch_scc1 L_D32
    s_cmp_eq_u32 s83, 20
    s_cbranch_scc1 L_D20
    s_cmp_eq_u32 s83, 18
    s_cbranch_scc1 L_D18
    s_branch L_disp
L_D21:
    s_mul_i32 s92, s81, 12
    s_add_u32 s92, s92, 27
    v_mov_b32 v5, s92
L_B21:
L_B21_0:
    s_cmp_lt_i32 s84, s82
    s_cbranch_scc1 L_B21_0w
    s_waitcnt vmcnt(20)
    buffer_load_dwordx4 v2, s[4:7], s78 offen offset:0 nt lds
    v_add_u32 v5, 3, v5
    s_add_u32 s81, s81, 1
    s_and_b32 s92, s81, 7
    s_waitcnt vmcnt(20)
    buffer_load_dwordx4 v2, s[4:7], s78 offen offset:1024 nt lds
    v_readlane_b32 s84, v3, 1
    ds_read_b32 v3, v7
    s_lshl_b32 s92, s92, 11
    s_add_u32 s92, s92, s77
    s_waitcnt vmcnt(20)
    buffer_load_dwordx4 v2, s[4:7], s78 offen offset:2048 nt lds
    ds_write_b32 v6, v5
    s_and_b32 s92, s92, 16383
    s_mul_i32 s80, s92, 768
L_B21_1:
    s_cmp_lt_i32 s84, s82
    s_cbranch_scc1 L_B21_1w
    s_waitcnt vmcnt(20)
    buffer_load_dwordx4 v2, s[4:7], s78 offen offset:3072 nt lds
    v_add_u32 v5, 3, v5
    s_add_u32 m0, m0, s85
    s_add_u32 s78, s78, s85
    s_waitcnt vmcnt(20)
    buffer_load_dwordx4 v2, s[4:7], s78 offen offset:0 nt lds
    v_readlane_b32 s84, v3, 2
    ds_read_b32 v3, v7
    s_bfe_u32 s92, s81, 0x40003
    s_bfe_i32 s93, s81, 0x10007
    s_waitcnt vmcnt(20)
    buffer_load_dwordx4 v2, s[4:7], s78 offen offset:1024 nt lds
    ds_write_b32 v6, v5
    s_xor_b32 s92, s92, s93
    s_and_b32 s92, s92, 15
L_B21_2:
    s_cmp_lt_i32 s84, s82
    s_cbranch_scc1 L_B21_2w
    s_waitcnt vmcnt(20)
    buffer_load_dwordx4 v2, s[4:7], s78 offen offset:2048 nt lds
    v_add_u32 v5, 3, v5
    s_mul_i32 s92, s92, 25165824
    s_add_u32 s80, s80, s79
    s_waitcnt vmcnt(20)
    buffer_load_dwordx4 v2, s[4:7], s78 offen offset:3072 nt lds
    v_readlane_b32 s84, v3, 3
    ds_read_b32 v3, v7
    s_add_u32 m0, m0, s85
    s_add_u32 s78, s78, s85
    s_waitcnt vmcnt(20)
    buffer_load_dwordx4 v2, s[4:7], s78 offen offset:0 nt lds
    ds_write_b32 v6, v5
    s_add_u32 s80, s80, s92
    s_and_b32 s86, s81, 3
L_B21_3:
    s_cmp_lt_i32 s84, s82
    s_cbranch_scc1 L_B21_3w
    s_waitcnt vmcnt(20)
    buffer_load_dwordx4 v2, s[4:7], s78 offen offset:1024 nt lds
    v_add_u32 v5, 3, v5
    v_readlane_b32 s83, v3, 4
    s_mul_i32 s86, s86, 12288
    s_waitcnt vmcnt(20)
    buffer_load_dwordx4 v2, s[4:7], s78 offen offset:2048 nt lds
    v_readlane_b32 s84, v3, 0
    ds_read_b32 v3, v7
    s_add_u32 s82, s82, 1
    s_cmp_ge_u32 s81, 255
    s_cselect_b32 s83, -1, s83
    s_cmp_ge_u32 s81, 128
    s_waitcnt vmcnt(20)
    buffer_load_dwordx4 v2, s[4:7], s78 offen offset:3072 nt lds
    ds_write_b32 v6, v5
    s_cselect_b64 s[4:5], s[56:57], s[50:51]
    s_mov_b32 m0, s86
    s_mov_b32 s78, s80
    s_cmp_eq_u32 s83, 21
    s_cbranch_scc1 L_B21
    s_cmp_eq_u32 s83, -1
    s_cbranch_scc1 L_D32
    s_cmp_eq_u32 s83, 20
    s_cbranch_scc1 L_D20
    s_cmp_eq_u32 s83, 22
    s_cbranch_scc1 L_D22
    s_branch L_disp
L_D18:
    s_mul_i32 s92, s81, 12
    s_add_u32 s92, s92, 30
    v_mov_b32 v5, s92
L_B18:
L_B18_0:
    s_cmp_lt_i32 s84, s82
    s_cbranch_scc1 L_B18_0w
    s_waitcnt vmcnt(17)
    buffer_load_dwordx4 v2, s[4:7], s78 offen offset:0 nt lds
    v_add_u32 v5, 3, v5
    s_add_u32 s81, s81, 1
    s_and_b32 s92, s81, 7
    s_waitcnt vmcnt(17)
    buffer_load_dwordx4 v2, s[4:7], s78 offen offset:1024 nt lds
    v_readlane_b32 s84, v3, 1
    ds_read_b32 v3, v7
    s_lshl_b32 s92, s92, 11
    s_add_u32 s92, s92, s77
    s_waitcnt vmcnt(17)
    buffer_load_dwordx4 v2, s[4:7], s78 offen offset:2048 nt lds
    ds_write_b32 v6, v5
    s_and_b32 s92, s92, 16383
    s_mul_i32 s80, s92, 768
L_B18_1:
    s_cmp_lt_i32 s84, s82
    s_cbranch_scc1 L_B18_1w
    s_waitcnt vmcnt(17)
    buffer_load_dwordx4 v2, s[4:7], s78 offen offset:3072 nt lds
    v_add_u32 v5, 3, v5
    s_add_u32 m0, m0, s85
    s_add_u32 s78, s78, s85
    s_waitcnt vmcnt(17)
    buffer_load_dwordx4 v2, s[4:7], s78 offen offset:0 nt lds
    v_readlane_b32 s84, v3, 2
    ds_read_b32 v3, v7
    s_bfe_u32 s92, s81, 0x40003
    s_bfe_i32 s93, s81, 0x10007
    s_waitcnt vmcnt(17)
    buffer_load_dwordx4 v2, s[4:7], s78 offen offset:1024 nt lds
    ds_write_b32 v6, v5
    s_xor_b32 s92, s92, s93
    s_and_b32 s92, s92, 15
L_B18_2:
    s_cmp_lt_i32 s84, s82
    s_cbranch_scc1 L_B18_2w
    s_waitcnt vmcnt(17)
    buffer_load_dwordx4 v2, s[4:7], s78 offen offset:2048 nt lds
    v_add_u32 v5, 3, v5
    s_mul_i32 s92, s92, 25165824
    s_add_u32 s80, s80, s79
    s_waitcnt vmcnt(17)
    buffer_load_dwordx4 v2, s[4:7], s78 offen offset:3072 nt lds
    v_readlane_b32 s84, v3, 3
    ds_read_b32 v3, v7
    s_add_u32 m0, m0, s85
    s_add_u32 s78, s78, s85
    s_waitcnt vmcnt(17)
    buffer_load_dwordx4 v2, s[4:7], s78 offen offset:0 nt lds
    ds_write_b32 v6, v5
    s_add_u32 s80, s80, s92
    s_and_b32 s86, s81, 3
L_B18_3:
    s_cmp_lt_i32 s84, s82
    s_cbranch_scc1 L_B18_3w
    s_waitcnt vmcnt(17)
    buffer_load_dwordx4 v2, s[4:7], s78 offen offset:1024 nt lds
    v_add_u32 v5, 3, v5
    v_readlane_b32 s83, v3, 4
    s_mul_i32 s86, s86, 12288
    s_waitcnt vmcnt(17)
    buffer_load_dwordx4 v2, s[4:7], s78 offen offset:2048 nt lds
    v_readlane_b32 s84, v3, 0
    ds_read_b32 v3, v7
    s_add_u32 s82, s82, 1
    s_cmp_ge_u32 s81, 255
    s_cselect_b32 s83, -1, s83
    s_cmp_ge_u32 s81, 128
    s_waitcnt vmcnt(17)
    buffer_load_dwordx4 v2, s[4:7], s78 offen offset:3072 nt lds
    ds_write_b32 v6, v5
    s_cselect_b64 s[4:5], s[56:57], s[50:51]
    s_mov_b32 m0, s86
    s_mov_b32 s78, s80
    s_cmp_eq_u32 s83, 18
    s_cbranch_scc1 L_B18
    s_cmp_eq_u32 s83, -1
    s_cbranch_scc1 L_D32
    s_cmp_eq_u32 s83, 19
    s_cbranch_scc1 L_D19
    s_cmp_eq_u32 s83, 17
    s_cbranch_scc1 L_D17
    s_branch L_disp
L_D22:
    s_mul_i32 s92, s81, 12
    s_add_u32 s92, s92, 26
    v_mov_b32 v5, s92
L_B22:
L_B22_0:
    s_cmp_lt_i32 s84, s82
    s_cbranch_scc1 L_B22_0w
    s_waitcnt vmcnt(21)
    buffer_load_dwordx4 v2, s[4:7], s78 offen offset:0 nt lds
    v_add_u32 v5, 3, v5
    s_add_u32 s81, s81, 1
    s_and_b32 s92, s81, 7
    s_waitcnt vmcnt(21)
    buffer_load_dwordx4 v2, s[4:7], s78 offen offset:1024 nt lds
    v_readlane_b32 s84, v3, 1
    ds_read_b32 v3, v7
    s_lshl_b32 s92, s92, 11
    s_add_u32 s92, s92, s77
    s_waitcnt vmcnt(21)
    buffer_load_dwordx4 v2, s[4:7], s78 offen offset:2048 nt lds
    ds_write_b32 v6, v5
    s_and_b32 s92, s92, 16383
    s_mul_i32 s80, s92, 768
L_B22_1:
    s_cmp_lt_i32 s84, s82
    s_cbranch_scc1 L_B22_1w
    s_waitcnt vmcnt(21)
    buffer_load_dwordx4 v2, s[4:7], s78 offen offset:3072 nt lds
    v_add_u32 v5, 3, v5
    s_add_u32 m0, m0, s85
    s_add_u32 s78, s78, s85
    s_waitcnt vmcnt(21)
    buffer_load_dwordx4 v2, s[4:7], s78 offen offset:0 nt lds
    v_readlane_b32 s84, v3, 2
    ds_read_b32 v3, v7
    s_bfe_u32 s92, s81, 0x40003
    s_bfe_i32 s93, s81, 0x10007
    s_waitcnt vmcnt(21)
    buffer_load_dwordx4 v2, s[4:7], s78 offen offset:1024 nt lds
    ds_write_b32 v6, v5
    s_xor_b32 s92, s92, s93
    s_and_b32 s92, s92, 15
L_B22_2:
    s_cmp_lt_i32 s84, s82
    s_cbranch_scc1 L_B22_2w
    s_waitcnt vmcnt(21)
    buffer_load_dwordx4 v2, s[4:7], s78 offen offset:2048 nt lds
    v_add_u32 v5, 3, v5
    s_mul_i32 s92, s92, 25165824
    s_add_u32 s80, s80, s79
    s_waitcnt vmcnt(21)
    buffer_load_dwordx4 v2, s[4:7], s78 offen offset:3072 nt lds
    v_readlane_b32 s84, v3, 3
    ds_read_b32 v3, v7
    s_add_u32 m0, m0, s85
    s_add_u32 s78, s78, s85
    s_waitcnt vmcnt(21)
    buffer_load_dwordx4 v2, s[4:7], s78 offen offset:0 nt lds
    ds_write_b32 v6, v5
    s_add_u32 s80, s80, s92
    s_and_b32 s86, s81, 3
L_B22_3:
    s_cmp_lt_i32 s84, s82
    s_cbranch_scc1 L_B22_3w
    s_waitcnt vmcnt(21)
    buffer_load_dwordx4 v2, s[4:7], s78 offen offset:1024 nt lds
    v_add_u32 v5, 3, v5
    v_readlane_b32 s83, v3, 4
    s_mul_i32 s86, s86, 12288
    s_waitcnt vmcnt(21)
    buffer_load_dwordx4 v2, s[4:7], s78 offen offset:2048 nt lds
    v_readlane_b32 s84, v3, 0
    ds_read_b32 v3, v7
    s_add_u32 s82, s82, 1
    s_cmp_ge_u32 s81, 255
    s_cselect_b32 s83, -1, s83
    s_cmp_ge_u32 s81, 128
    s_waitcnt vmcnt(21)
    buffer_load_dwordx4 v2, s[4:7], s78 offen offset:3072 nt lds
    ds_write_b32 v6, v5
    s_cselect_b64 s[4:5], s[56:57], s[50:51]
    s_mov_b32 m0, s86
    s_mov_b32 s78, s80
    s_cmp_eq_u32 s83, 22
    s_cbranch_scc1 L_B22
    s_cmp_eq_u32 s83, -1
    s_cbranch_scc1 L_D32
    s_cmp_eq_u32 s83, 21
    s_cbranch_scc1 L_D21
    s_cmp_eq_u32 s83, 23
    s_cbranch_scc1 L_D23
    s_branch L_disp
L_D17:
    s_mul_i32 s92, s81, 12
    s_add_u32 s92, s92, 31
    v_mov_b32 v5, s92
L_B17:
L_B17_0:
    s_cmp_lt_i32 s84, s82
    s_cbranch_scc1 L_B17_0w
    s_waitcnt vmcnt(16)
    buffer_load_dwordx4 v2, s[4:7], s78 offen offset:0 nt lds
    v_add_u32 v5, 3, v5
    s_add_u32 s81, s81, 1
    s_and_b32 s92, s81, 7
    s_waitcnt vmcnt(16)
    buffer_load_dwordx4 v2, s[4:7], s78 offen offset:1024 nt lds
    v_readlane_b32 s84, v3, 1
    ds_read_b32 v3, v7
    s_lshl_b32 s92, s92, 11
    s_add_u32 s92, s92, s77
    s_waitcnt vmcnt(16)
    buffer_load_dwordx4 v2, s[4:7], s78 offen offset:2048 nt lds
    ds_write_b32 v6, v5
    s_and_b32 s92, s92, 16383
    s_mul_i32 s80, s92, 768
L_B17_1:
    s_cmp_lt_i32 s84, s82
    s_cbranch_scc1 L_B17_1w
    s_waitcnt vmcnt(16)
    buffer_load_dwordx4 v2, s[4:7], s78 offen offset:3072 nt lds
    v_add_u32 v5, 3, v5
    s_add_u32 m0, m0, s85
    s_add_u32 s78, s78, s85
    s_waitcnt vmcnt(16)
    buffer_load_dwordx4 v2, s[4:7], s78 offen offset:0 nt lds
    v_readlane_b32 s84, v3, 2
    ds_read_b32 v3, v7
    s_bfe_u32 s92, s81, 0x40003
    s_bfe_i32 s93, s81, 0x10007
    s_waitcnt vmcnt(16)
    buffer_load_dwordx4 v2, s[4:7], s78 offen offset:1024 nt lds
    ds_write_b32 v6, v5
    s_xor_b32 s92, s92, s93
    s_and_b32 s92, s92, 15
L_B17_2:
    s_cmp_lt_i32 s84, s82
    s_cbranch_scc1 L_B17_2w
    s_waitcnt vmcnt(16)
    buffer_load_dwordx4 v2, s[4:7], s78 offen offset:2048 nt lds
    v_add_u32 v5, 3, v5
    s_mul_i32 s92, s92, 25165824
    s_add_u32 s80, s80, s79
    s_waitcnt vmcnt(16)
    buffer_load_dwordx4 v2, s[4:7], s78 offen offset:3072 nt lds
    v_readlane_b32 s84, v3, 3
    ds_read_b32 v3, v7
    s_add_u32 m0, m0, s85
    s_add_u32 s78, s78, s85
    s_waitcnt vmcnt(16)
    buffer_load_dwordx4 v2, s[4:7], s78 offen offset:0 nt lds
    ds_write_b32 v6, v5
    s_add_u32 s80, s80, s92
    s_and_b32 s86, s81, 3
L_B17_3:
    s_cmp_lt_i32 s84, s82
    s_cbranch_scc1 L_B17_3w
    s_waitcnt vmcnt(16)
    buffer_load_dwordx4 v2, s[4:7], s78 offen offset:1024 nt lds
    v_add_u32 v5, 3, v5
    v_readlane_b32 s83, v3, 4
    s_mul_i32 s86, s86, 12288
    s_waitcnt vmcnt(16)
    buffer_load_dwordx4 v2, s[4:7], s78 offen offset:2048 nt lds
    v_readlane_b32 s84, v3, 0
    ds_read_b32 v3, v7
    s_add_u32 s82, s82, 1
    s_cmp_ge_u32 s81, 255
    s_cselect_b32 s83, -1, s83
    s_cmp_ge_u32 s81, 128
    s_waitcnt vmcnt(16)
    buffer_load_dwordx4 v2, s[4:7], s78 offen offset:3072 nt lds
    ds_write_b32 v6, v5
    s_cselect_b64 s[4:5], s[56:57], s[50:51]
    s_mov_b32 m0, s86
    s_mov_b32 s78, s80
    s_cmp_eq_u32 s83, 17
    s_cbranch_scc1 L_B17
    s_cmp_eq_u32 s83, -1
    s_cbranch_scc1 L_D32
    s_cmp_eq_u32 s83, 18
    s_cbranch_scc1 L_D18
    s_cmp_eq_u32 s83, 16
    s_cbranch_scc1 L_D16
    s_branch L_disp
L_D23:
    s_mul_i32 s92, s81, 12
    s_add_u32 s92, s92, 25
    v_mov_b32 v5, s92
L_B23:
L_B23_0:
    s_cmp_lt_i32 s84, s82
    s_cbranch_scc1 L_B23_0w
    s_waitcnt vmcnt(22)
    buffer_load_dwordx4 v2, s[4:7], s78 offen offset:0 nt lds
    v_add_u32 v5, 3, v5
    s_add_u32 s81, s81, 1
    s_and_b32 s92, s81, 7
    s_waitcnt vmcnt(22)
    buffer_load_dwordx4 v2, s[4:7], s78 offen offset:1024 nt lds
    v_readlane_b32 s84, v3, 1
    ds_read_b32 v3, v7
    s_lshl_b32 s92, s92, 11
    s_add_u32 s92, s92, s77
    s_waitcnt vmcnt(22)
    buffer_load_dwordx4 v2, s[4:7], s78 offen offset:2048 nt lds
    ds_write_b32 v6, v5
    s_and_b32 s92, s92, 16383
    s_mul_i32 s80, s92, 768
L_B23_1:
    s_cmp_lt_i32 s84, s82
    s_cbranch_scc1 L_B23_1w
    s_waitcnt vmcnt(22)
    buffer_load_dwordx4 v2, s[4:7], s78 offen offset:3072 nt lds
    v_add_u32 v5, 3, v5
    s_add_u32 m0, m0, s85
    s_add_u32 s78, s78, s85
    s_waitcnt vmcnt(22)
    buffer_load_dwordx4 v2, s[4:7], s78 offen offset:0 nt lds
    v_readlane_b32 s84, v3, 2
    ds_read_b32 v3, v7
    s_bfe_u32 s92, s81, 0x40003
    s_bfe_i32 s93, s81, 0x10007
    s_waitcnt vmcnt(22)
    buffer_load_dwordx4 v2, s[4:7], s78 offen offset:1024 nt lds
    ds_write_b32 v6, v5
    s_xor_b32 s92, s92, s93
    s_and_b32 s92, s92, 15
L_B23_2:
    s_cmp_lt_i32 s84, s82
    s_cbranch_scc1 L_B23_2w
    s_waitcnt vmcnt(22)
    buffer_load_dwordx4 v2, s[4:7], s78 offen offset:2048 nt lds
    v_add_u32 v5, 3, v5
    s_mul_i32 s92, s92, 25165824
    s_add_u32 s80, s80, s79
    s_waitcnt vmcnt(22)
    buffer_load_dwordx4 v2, s[4:7], s78 offen offset:3072 nt lds
    v_readlane_b32 s84, v3, 3
    ds_read_b32 v3, v7
    s_add_u32 m0, m0, s85
    s_add_u32 s78, s78, s85
    s_waitcnt vmcnt(22)
    buffer_load_dwordx4 v2, s[4:7], s78 offen offset:0 nt lds
    ds_write_b32 v6, v5
    s_add_u32 s80, s80, s92
    s_and_b32 s86, s81, 3
L_B23_3:
    s_cmp_lt_i32 s84, s82
    s_cbranch_scc1 L_B23_3w
    s_waitcnt vmcnt(22)
    buffer_load_dwordx4 v2, s[4:7], s78 offen offset:1024 nt lds
    v_add_u32 v5, 3, v5
    v_readlane_b32 s83, v3, 4
    s_mul_i32 s86, s86, 12288
    s_waitcnt vmcnt(22)
    buffer_load_dwordx4 v2, s[4:7], s78 offen offset:2048 nt lds
    v_readlane_b32 s84, v3, 0
    ds_read_b32 v3, v7
    s_add_u32 s82, s82, 1
    s_cmp_ge_u32 s81, 255
    s_cselect_b32 s83, -1, s83
    s_cmp_ge_u32 s81, 128
    s_waitcnt vmcnt(22)
    buffer_load_dwordx4 v2, s[4:7], s78 offen offset:3072 nt lds
    ds_write_b32 v6, v5
    s_cselect_b64 s[4:5], s[56:57], s[50:51]
    s_mov_b32 m0, s86
    s_mov_b32 s78, s80
    s_cmp_eq_u32 s83, 23
    s_cbranch_scc1 L_B23
    s_cmp_eq_u32 s83, -1
    s_cbranch_scc1 L_D32
    s_cmp_eq_u32 s83, 22
    s_cbranch_scc1 L_D22
    s_cmp_eq_u32 s83, 24
    s_cbranch_scc1 L_D24
    s_branch L_disp
L_D16:
    s_mul_i32 s92, s81, 12
    s_add_u32 s92, s92, 32
    v_mov_b32 v5, s92
L_B16:
L_B16_0:
    s_cmp_lt_i32 s84, s82
    s_cbranch_scc1 L_B16_0w
    s_waitcnt vmcnt(15)
    buffer_load_dwordx4 v2, s[4:7], s78 offen offset:0 nt lds
    v_add_u32 v5, 3, v5
    s_add_u32 s81, s81, 1
    s_and_b32 s92, s81, 7
    s_waitcnt vmcnt(15)
    buffer_load_dwordx4 v2, s[4:7], s78 offen offset:1024 nt lds
    v_readlane_b32 s84, v3, 1
    ds_read_b32 v3, v7
    s_lshl_b32 s92, s92, 11
    s_add_u32 s92, s92, s77
    s_waitcnt vmcnt(15)
    buffer_load_dwordx4 v2, s[4:7], s78 offen offset:2048 nt lds
    ds_write_b32 v6, v5
    s_and_b32 s92, s92, 16383
    s_mul_i32 s80, s92, 768
L_B16_1:
    s_cmp_lt_i32 s84, s82
    s_cbranch_scc1 L_B16_1w
    s_waitcnt vmcnt(15)
    buffer_load_dwordx4 v2, s[4:7], s78 offen offset:3072 nt lds
    v_add_u32 v5, 3, v5
    s_add_u32 m0, m0, s85
    s_add_u32 s78, s78, s85
    s_waitcnt vmcnt(15)
    buffer_load_dwordx4 v2, s[4:7], s78 offen offset:0 nt lds
    v_readlane_b32 s84, v3, 2
    ds_read_b32 v3, v7
    s_bfe_u32 s92, s81, 0x40003
    s_bfe_i32 s93, s81, 0x10007
    s_waitcnt vmcnt(15)
    buffer_load_dwordx4 v2, s[4:7], s78 offen offset:1024 nt lds
    ds_write_b32 v6, v5
    s_xor_b32 s92, s92, s93
    s_and_b32 s92, s92, 15
L_B16_2:
    s_cmp_lt_i32 s84, s82
    s_cbranch_scc1 L_B16_2w
    s_waitcnt vmcnt(15)
    buffer_load_dwordx4 v2, s[4:7], s78 offen offset:2048 nt lds
    v_add_u32 v5, 3, v5
    s_mul_i32 s92, s92, 25165824
    s_add_u32 s80, s80, s79
    s_waitcnt vmcnt(15)
    buffer_load_dwordx4 v2, s[4:7], s78 offen offset:3072 nt lds
    v_readlane_b32 s84, v3, 3
    ds_read_b32 v3, v7
    s_add_u32 m0, m0, s85
    s_add_u32 s78, s78, s85
    s_waitcnt vmcnt(15)
    buffer_load_dwordx4 v2, s[4:7], s78 offen offset:0 nt lds
    ds_write_b32 v6, v5
    s_add_u32 s80, s80, s92
    s_and_b32 s86, s81, 3
L_B16_3:
    s_cmp_lt_i32 s84, s82
    s_cbranch_scc1 L_B16_3w
    s_waitcnt vmcnt(15)
    buffer_load_dwordx4 v2, s[4:7], s78 offen offset:1024 nt lds
    v_add_u32 v5, 3, v5
    v_readlane_b32 s83, v3, 4
    s_mul_i32 s86, s86, 12288
    s_waitcnt vmcnt(15)
    buffer_load_dwordx4 v2, s[4:7], s78 offen offset:2048 nt lds
    v_readlane_b32 s84, v3, 0
    ds_read_b32 v3, v7
    s_add_u32 s82, s82, 1
    s_cmp_ge_u32 s81, 255
    s_cselect_b32 s83, -1, s83
    s_cmp_ge_u32 s81, 128
    s_waitcnt vmcnt(15)
    buffer_load_dwordx4 v2, s[4:7], s78 offen offset:3072 nt lds
    ds_write_b32 v6, v5
    s_cselect_b64 s[4:5], s[56:57], s[50:51]
    s_mov_b32 m0, s86
    s_mov_b32 s78, s80
    s_cmp_eq_u32 s83, 16
    s_cbranch_scc1 L_B16
    s_cmp_eq_u32 s83, -1
    s_cbranch_scc1 L_D32
    s_cmp_eq_u32 s83, 17
    s_cbranch_scc1 L_D17
    s_cmp_eq_u32 s83, 15
    s_cbranch_scc1 L_D15
    s_branch L_disp
L_D24:
    s_mul_i32 s92, s81, 12
    s_add_u32 s92, s92, 24
    v_mov_b32 v5, s92
L_B24:
L_B24_0:
    s_cmp_lt_i32 s84, s82
    s_cbranch_scc1 L_B24_0w
    s_waitcnt vmcnt(23)
    buffer_load_dwordx4 v2, s[4:7], s78 offen offset:0 nt lds
    v_add_u32 v5, 3, v5
    s_add_u32 s81, s81, 1
    s_and_b32 s92, s81, 7
    s_waitcnt vmcnt(23)
    buffer_load_dwordx4 v2, s[4:7], s78 offen offset:1024 nt lds
    v_readlane_b32 s84, v3, 1
    ds_read_b32 v3, v7
    s_lshl_b32 s92, s92, 11
    s_add_u32 s92, s92, s77
    s_waitcnt vmcnt(23)
    buffer_load_dwordx4 v2, s[4:7], s78 offen offset:2048 nt lds
    ds_write_b32 v6, v5
    s_and_b32 s92, s92, 16383
    s_mul_i32 s80, s92, 768
L_B24_1:
    s_cmp_lt_i32 s84, s82
    s_cbranch_scc1 L_B24_1w
    s_waitcnt vmcnt(23)
    buffer_load_dwordx4 v2, s[4:7], s78 offen offset:3072 nt lds
    v_add_u32 v5, 3, v5
    s_add_u32 m0, m0, s85
    s_add_u32 s78, s78, s85
    s_waitcnt vmcnt(23)
    buffer_load_dwordx4 v2, s[4:7], s78 offen offset:0 nt lds
    v_readlane_b32 s84, v3, 2
    ds_read_b32 v3, v7
    s_bfe_u32 s92, s81, 0x40003
    s_bfe_i32 s93, s81, 0x10007
    s_waitcnt vmcnt(23)
    buffer_load_dwordx4 v2, s[4:7], s78 offen offset:1024 nt lds
    ds_write_b32 v6, v5
    s_xor_b32 s92, s92, s93
    s_and_b32 s92, s92, 15
L_B24_2:
    s_cmp_lt_i32 s84, s82
    s_cbranch_scc1 L_B24_2w
    s_waitcnt vmcnt(23)
    buffer_load_dwordx4 v2, s[4:7], s78 offen offset:2048 nt lds
    v_add_u32 v5, 3, v5
    s_mul_i32 s92, s92, 25165824
    s_add_u32 s80, s80, s79
    s_waitcnt vmcnt(23)
    buffer_load_dwordx4 v2, s[4:7], s78 offen offset:3072 nt lds
    v_readlane_b32 s84, v3, 3
    ds_read_b32 v3, v7
    s_add_u32 m0, m0, s85
    s_add_u32 s78, s78, s85
    s_waitcnt vmcnt(23)
    buffer_load_dwordx4 v2, s[4:7], s78 offen offset:0 nt lds
    ds_write_b32 v6, v5
    s_add_u32 s80, s80, s92
    s_and_b32 s86, s81, 3
L_B24_3:
    s_cmp_lt_i32 s84, s82
    s_cbranch_scc1 L_B24_3w
    s_waitcnt vmcnt(23)
    buffer_load_dwordx4 v2, s[4:7], s78 offen offset:1024 nt lds
    v_add_u32 v5, 3, v5
    v_readlane_b32 s83, v3, 4
    s_mul_i32 s86, s86, 12288
    s_waitcnt vmcnt(23)
    buffer_load_dwordx4 v2, s[4:7], s78 offen offset:2048 nt lds
    v_readlane_b32 s84, v3, 0
    ds_read_b32 v3, v7
    s_add_u32 s82, s82, 1
    s_cmp_ge_u32 s81, 255
    s_cselect_b32 s83, -1, s83
    s_cmp_ge_u32 s81, 128
    s_waitcnt vmcnt(23)
    buffer_load_dwordx4 v2, s[4:7], s78 offen offset:3072 nt lds
    ds_write_b32 v6, v5
    s_cselect_b64 s[4:5], s[56:57], s[50:51]
    s_mov_b32 m0, s86
    s_mov_b32 s78, s80
    s_cmp_eq_u32 s83, 24
    s_cbranch_scc1 L_B24
    s_cmp_eq_u32 s83, -1
    s_cbranch_scc1 L_D32
    s_cmp_eq_u32 s83, 23
    s_cbranch_scc1 L_D23
    s_cmp_eq_u32 s83, 25
    s_cbranch_scc1 L_D25
    s_branch L_disp
L_D15:
    s_mul_i32 s92, s81, 12
    s_add_u32 s92, s92, 33
    v_mov_b32 v5, s92
L_B15:
L_B15_0:
    s_cmp_lt_i32 s84, s82
    s_cbranch_scc1 L_B15_0w
    s_waitcnt vmcnt(14)
    buffer_load_dwordx4 v2, s[4:7], s78 offen offset:0 nt lds
    v_add_u32 v5, 3, v5
    s_add_u32 s81, s81, 1
    s_and_b32 s92, s81, 7
    s_waitcnt vmcnt(14)
    buffer_load_dwordx4 v2, s[4:7], s78 offen offset:1024 nt lds
    v_readlane_b32 s84, v3, 1
    ds_read_b32 v3, v7
    s_lshl_b32 s92, s92, 11
    s_add_u32 s92, s92, s77
    s_waitcnt vmcnt(14)
    buffer_load_dwordx4 v2, s[4:7], s78 offen offset:2048 nt lds
    ds_write_b32 v6, v5
    s_and_b32 s92, s92, 16383
    s_mul_i32 s80, s92, 768
L_B15_1:
    s_cmp_lt_i32 s84, s82
    s_cbranch_scc1 L_B15_1w
    s_waitcnt vmcnt(14)
    buffer_load_dwordx4 v2, s[4:7], s78 offen offset:3072 nt lds
    v_add_u32 v5, 3, v5
    s_add_u32 m0, m0, s85
    s_add_u32 s78, s78, s85
    s_waitcnt vmcnt(14)
    buffer_load_dwordx4 v2, s[4:7], s78 offen offset:0 nt lds
    v_readlane_b32 s84, v3, 2
    ds_read_b32 v3, v7
    s_bfe_u32 s92, s81, 0x40003
    s_bfe_i32 s93, s81, 0x10007
    s_waitcnt vmcnt(14)
    buffer_load_dwordx4 v2, s[4:7], s78 offen offset:1024 nt lds
    ds_write_b32 v6, v5
    s_xor_b32 s92, s92, s93
    s_and_b32 s92, s92, 15
L_B15_2:
    s_cmp_lt_i32 s84, s82
    s_cbranch_scc1 L_B15_2w
    s_waitcnt vmcnt(14)
    buffer_load_dwordx4 v2, s[4:7], s78 offen offset:2048 nt lds
    v_add_u32 v5, 3, v5
    s_mul_i32 s92, s92, 25165824
    s_add_u32 s80, s80, s79
    s_waitcnt vmcnt(14)
    buffer_load_dwordx4 v2, s[4:7], s78 offen offset:3072 nt lds
    v_readlane_b32 s84, v3, 3
    ds_read_b32 v3, v7
    s_add_u32 m0, m0, s85
    s_add_u32 s78, s78, s85
    s_waitcnt vmcnt(14)
    buffer_load_dwordx4 v2, s[4:7], s78 offen offset:0 nt lds
    ds_write_b32 v6, v5
    s_add_u32 s80, s80, s92
    s_and_b32 s86, s81, 3
L_B15_3:
    s_cmp_lt_i32 s84, s82
    s_cbranch_scc1 L_B15_3w
    s_waitcnt vmcnt(14)
    buffer_load_dwordx4 v2, s[4:7], s78 offen offset:1024 nt lds
    v_add_u32 v5, 3, v5
    v_readlane_b32 s83, v3, 4
    s_mul_i32 s86, s86, 12288
    s_waitcnt vmcnt(14)
    buffer_load_dwordx4 v2, s[4:7], s78 offen offset:2048 nt lds
    v_readlane_b32 s84, v3, 0
    ds_read_b32 v3, v7
    s_add_u32 s82, s82, 1
    s_cmp_ge_u32 s81, 255
    s_cselect_b32 s83, -1, s83
    s_cmp_ge_u32 s81, 128
    s_waitcnt vmcnt(14)
    buffer_load_dwordx4 v2, s[4:7], s78 offen offset:3072 nt lds
    ds_write_b32 v6, v5
    s_cselect_b64 s[4:5], s[56:57], s[50:51]
    s_mov_b32 m0, s86
    s_mov_b32 s78, s80
    s_cmp_eq_u32 s83, 15
    s_cbranch_scc1 L_B15
    s_cmp_eq_u32 s83, -1
    s_cbranch_scc1 L_D32
    s_cmp_eq_u32 s83, 16
    s_cbranch_scc1 L_D16
    s_branch L_disp
L_D25:
    s_mul_i32 s92, s81, 12
    s_add_u32 s92, s92, 23
    v_mov_b32 v5, s92
L_B25:
L_B25_0:
    s_cmp_lt_i32 s84, s82
    s_cbranch_scc1 L_B25_0w
    s_waitcnt vmcnt(24)
    buffer_load_dwordx4 v2, s[4:7], s78 offen offset:0 nt lds
    v_add_u32 v5, 3, v5
    s_add_u32 s81, s81, 1
    s_and_b32 s92, s81, 7
    s_waitcnt vmcnt(24)
    buffer_load_dwordx4 v2, s[4:7], s78 offen offset:1024 nt lds
    v_readlane_b32 s84, v3, 1
    ds_read_b32 v3, v7
    s_lshl_b32 s92, s92, 11
    s_add_u32 s92, s92, s77
    s_waitcnt vmcnt(24)
    buffer_load_dwordx4 v2, s[4:7], s78 offen offset:2048 nt lds
    ds_write_b32 v6, v5
    s_and_b32 s92, s92, 16383
    s_mul_i32 s80, s92, 768
L_B25_1:
    s_cmp_lt_i32 s84, s82
    s_cbranch_scc1 L_B25_1w
    s_waitcnt vmcnt(24)
    buffer_load_dwordx4 v2, s[4:7], s78 offen offset:3072 nt lds
    v_add_u32 v5, 3, v5
    s_add_u32 m0, m0, s85
    s_add_u32 s78, s78, s85
    s_waitcnt vmcnt(24)
    buffer_load_dwordx4 v2, s[4:7], s78 offen offset:0 nt lds
    v_readlane_b32 s84, v3, 2
    ds_read_b32 v3, v7
    s_bfe_u32 s92, s81, 0x40003
    s_bfe_i32 s93, s81, 0x10007
    s_waitcnt vmcnt(24)
    buffer_load_dwordx4 v2, s[4:7], s78 offen offset:1024 nt lds
    ds_write_b32 v6, v5
    s_xor_b32 s92, s92, s93
    s_and_b32 s92, s92, 15
L_B25_2:
    s_cmp_lt_i32 s84, s82
    s_cbranch_scc1 L_B25_2w
    s_waitcnt vmcnt(24)
    buffer_load_dwordx4 v2, s[4:7], s78 offen offset:2048 nt lds
    v_add_u32 v5, 3, v5
    s_mul_i32 s92, s92, 25165824
    s_add_u32 s80, s80, s79
    s_waitcnt vmcnt(24)
    buffer_load_dwordx4 v2, s[4:7], s78 offen offset:3072 nt lds
    v_readlane_b32 s84, v3, 3
    ds_read_b32 v3, v7
    s_add_u32 m0, m0, s85
    s_add_u32 s78, s78, s85
    s_waitcnt vmcnt(24)
    buffer_load_dwordx4 v2, s[4:7], s78 offen offset:0 nt lds
    ds_write_b32 v6, v5
    s_add_u32 s80, s80, s92
    s_and_b32 s86, s81, 3
L_B25_3:
    s_cmp_lt_i32 s84, s82
    s_cbranch_scc1 L_B25_3w
    s_waitcnt vmcnt(24)
    buffer_load_dwordx4 v2, s[4:7], s78 offen offset:1024 nt lds
    v_add_u32 v5, 3, v5
    v_readlane_b32 s83, v3, 4
    s_mul_i32 s86, s86, 12288
    s_waitcnt vmcnt(24)
    buffer_load_dwordx4 v2, s[4:7], s78 offen offset:2048 nt lds
    v_readlane_b32 s84, v3, 0
    ds_read_b32 v3, v7
    s_add_u32 s82, s82, 1
    s_cmp_ge_u32 s81, 255
    s_cselect_b32 s83, -1, s83
    s_cmp_ge_u32 s81, 128
    s_waitcnt vmcnt(24)
    buffer_load_dwordx4 v2, s[4:7], s78 offen offset:3072 nt lds
    ds_write_b32 v6, v5
    s_cselect_b64 s[4:5], s[56:57], s[50:51]
    s_mov_b32 m0, s86
    s_mov_b32 s78, s80
    s_cmp_eq_u32 s83, 25
    s_cbranch_scc1 L_B25
    s_cmp_eq_u32 s83, -1
    s_cbranch_scc1 L_D32
    s_cmp_eq_u32 s83, 24
    s_cbranch_scc1 L_D24
    s_cmp_eq_u32 s83, 26
    s_cbranch_scc1 L_D26
    s_branch L_disp
L_D26:
    s_mul_i32 s92, s81, 12
    s_add_u32 s92, s92, 22
    v_mov_b32 v5, s92
L_B26:
L_B26_0:
    s_cmp_lt_i32 s84, s82
    s_cbranch_scc1 L_B26_0w
    s_waitcnt vmcnt(25)
    buffer_load_dwordx4 v2, s[4:7], s78 offen offset:0 nt lds
    v_add_u32 v5, 3, v5
    s_add_u32 s81, s81, 1
    s_and_b32 s92, s81, 7
    s_waitcnt vmcnt(25)
    buffer_load_dwordx4 v2, s[4:7], s78 offen offset:1024 nt lds
    v_readlane_b32 s84, v3, 1
    ds_read_b32 v3, v7
    s_lshl_b32 s92, s92, 11
    s_add_u32 s92, s92, s77
    s_waitcnt vmcnt(25)
    buffer_load_dwordx4 v2, s[4:7], s78 offen offset:2048 nt lds
    ds_write_b32 v6, v5
    s_and_b32 s92, s92, 16383
    s_mul_i32 s80, s92, 768
L_B26_1:
    s_cmp_lt_i32 s84, s82
    s_cbranch_scc1 L_B26_1w
    s_waitcnt vmcnt(25)
    buffer_load_dwordx4 v2, s[4:7], s78 offen offset:3072 nt lds
    v_add_u32 v5, 3, v5
    s_add_u32 m0, m0, s85
    s_add_u32 s78, s78, s85
    s_waitcnt vmcnt(25)
    buffer_load_dwordx4 v2, s[4:7], s78 offen offset:0 nt lds
    v_readlane_b32 s84, v3, 2
    ds_read_b32 v3, v7
    s_bfe_u32 s92, s81, 0x40003
    s_bfe_i32 s93, s81, 0x10007
    s_waitcnt vmcnt(25)
    buffer_load_dwordx4 v2, s[4:7], s78 offen offset:1024 nt lds
    ds_write_b32 v6, v5
    s_xor_b32 s92, s92, s93
    s_and_b32 s92, s92, 15
L_B26_2:
    s_cmp_lt_i32 s84, s82
    s_cbranch_scc1 L_B26_2w
    s_waitcnt vmcnt(25)
    buffer_load_dwordx4 v2, s[4:7], s78 offen offset:2048 nt lds
    v_add_u32 v5, 3, v5
    s_mul_i32 s92, s92, 25165824
    s_add_u32 s80, s80, s79
    s_waitcnt vmcnt(25)
    buffer_load_dwordx4 v2, s[4:7], s78 offen offset:3072 nt lds
    v_readlane_b32 s84, v3, 3
    ds_read_b32 v3, v7
    s_add_u32 m0, m0, s85
    s_add_u32 s78, s78, s85
    s_waitcnt vmcnt(25)
    buffer_load_dwordx4 v2, s[4:7], s78 offen offset:0 nt lds
    ds_write_b32 v6, v5
    s_add_u32 s80, s80, s92
    s_and_b32 s86, s81, 3
L_B26_3:
    s_cmp_lt_i32 s84, s82
    s_cbranch_scc1 L_B26_3w
    s_waitcnt vmcnt(25)
    buffer_load_dwordx4 v2, s[4:7], s78 offen offset:1024 nt lds
    v_add_u32 v5, 3, v5
    v_readlane_b32 s83, v3, 4
    s_mul_i32 s86, s86, 12288
    s_waitcnt vmcnt(25)
    buffer_load_dwordx4 v2, s[4:7], s78 offen offset:2048 nt lds
    v_readlane_b32 s84, v3, 0
    ds_read_b32 v3, v7
    s_add_u32 s82, s82, 1
    s_cmp_ge_u32 s81, 255
    s_cselect_b32 s83, -1, s83
    s_cmp_ge_u32 s81, 128
    s_waitcnt vmcnt(25)
    buffer_load_dwordx4 v2, s[4:7], s78 offen offset:3072 nt lds
    ds_write_b32 v6, v5
    s_cselect_b64 s[4:5], s[56:57], s[50:51]
    s_mov_b32 m0, s86
    s_mov_b32 s78, s80
    s_cmp_eq_u32 s83, 26
    s_cbranch_scc1 L_B26
    s_cmp_eq_u32 s83, -1
    s_cbranch_scc1 L_D32
    s_cmp_eq_u32 s83, 25
    s_cbranch_scc1 L_D25
    s_branch L_disp
L_B20_0w:
    ds_read_b32 v3, v7
    s_waitcnt lgkmcnt(0)
    v_readlane_b32 s84, v3, 0
    s_nop 0
    s_branch L_B20_0
L_B20_1w:
    ds_read_b32 v3, v7
    s_waitcnt lgkmcnt(0)
    v_readlane_b32 s84, v3, 1
    s_nop 0
    s_branch L_B20_1
L_B20_2w:
    ds_read_b32 v3, v7
    s_waitcnt lgkmcnt(0)
    v_readlane_b32 s84, v3, 2
    s_nop 0
    s_branch L_B20_2
L_B20_3w:
    ds_read_b32 v3, v7
    s_waitcnt lgkmcnt(0)
    v_readlane_b32 s84, v3, 3
    s_nop 0
    s_branch L_B20_3
L_B19_0w:
    ds_read_b32 v3, v7
    s_waitcnt lgkmcnt(0)
    v_readlane_b32 s84, v3, 0
    s_nop 0
    s_branch L_B19_0
L_B19_1w:
    ds_read_b32 v3, v7
    s_waitcnt lgkmcnt(0)
    v_readlane_b32 s84, v3, 1
    s_nop 0
    s_branch L_B19_1
L_B19_2w:
    ds_read_b32 v3, v7
    s_waitcnt lgkmcnt(0)
    v_readlane_b32 s84, v3, 2
    s_nop 0
    s_branch L_B19_2
L_B19_3w:
    ds_read_b32 v3, v7
    s_waitcnt lgkmcnt(0)
    v_readlane_b32 s84, v3, 3
    s_nop 0
    s_branch L_B19_3
L_B21_0w:
    ds_read_b32 v3, v7
    s_waitcnt lgkmcnt(0)
    v_readlane_b32 s84, v3, 0
    s_nop 0
    s_branch L_B21_0
L_B21_1w:
    ds_read_b32 v3, v7
    s_waitcnt lgkmcnt(0)
    v_readlane_b32 s84, v3, 1
    s_nop 0
    s_branch L_B21_1
L_B21_2w:
    ds_read_b32 v3, v7
    s_waitcnt lgkmcnt(0)
    v_readlane_b32 s84, v3, 2
    s_nop 0
    s_branch L_B21_2
L_B21_3w:
    ds_read_b32 v3, v7
    s_waitcnt lgkmcnt(0)
    v_readlane_b32 s84, v3, 3
    s_nop 0
    s_branch L_B21_3
L_B18_0w:
    ds_read_b32 v3, v7
    s_waitcnt lgkmcnt(0)
    v_readlane_b32 s84, v3, 0
    s_nop 0
    s_branch L_B18_0
L_B18_1w:
    ds_read_b32 v3, v7
    s_waitcnt lgkmcnt(0)
    v_readlane_b32 s84, v3, 1
    s_nop 0
    s_branch L_B18_1
L_B18_2w:
    ds_read_b32 v3, v7
    s_waitcnt lgkmcnt(0)
    v_readlane_b32 s84, v3, 2
    s_nop 0
    s_branch L_B18_2
L_B18_3w:
    ds_read_b32 v3, v7
    s_waitcnt lgkmcnt(0)
    v_readlane_b32 s84, v3, 3
    s_nop 0
    s_branch L_B18_3
L_B22_0w:
    ds_read_b32 v3, v7
    s_waitcnt lgkmcnt(0)
    v_readlane_b32 s84, v3, 0
    s_nop 0
    s_branch L_B22_0
L_B22_1w:
    ds_read_b32 v3, v7
    s_waitcnt lgkmcnt(0)
    v_readlane_b32 s84, v3, 1
    s_nop 0
    s_branch L_B22_1
L_B22_2w:
    ds_read_b32 v3, v7
    s_waitcnt lgkmcnt(0)
    v_readlane_b32 s84, v3, 2
    s_nop 0
    s_branch L_B22_2
L_B22_3w:
    ds_read_b32 v3, v7
    s_waitcnt lgkmcnt(0)
    v_readlane_b32 s84, v3, 3
    s_nop 0
    s_branch L_B22_3
L_B17_0w:
    ds_read_b32 v3, v7
    s_waitcnt lgkmcnt(0)
    v_readlane_b32 s84, v3, 0
    s_nop 0
    s_branch L_B17_0
L_B17_1w:
    ds_read_b32 v3, v7
    s_waitcnt lgkmcnt(0)
    v_readlane_b32 s84, v3, 1
    s_nop 0
    s_branch L_B17_1
L_B17_2w:
    ds_read_b32 v3, v7
    s_waitcnt lgkmcnt(0)
    v_readlane_b32 s84, v3, 2
    s_nop 0
    s_branch L_B17_2
L_B17_3w:
    ds_read_b32 v3, v7
    s_waitcnt lgkmcnt(0)
    v_readlane_b32 s84, v3, 3
    s_nop 0
    s_branch L_B17_3
L_B23_0w:
    ds_read_b32 v3, v7
    s_waitcnt lgkmcnt(0)
    v_readlane_b32 s84, v3, 0
    s_nop 0
    s_branch L_B23_0
L_B23_1w:
    ds_read_b32 v3, v7
    s_waitcnt lgkmcnt(0)
    v_readlane_b32 s84, v3, 1
    s_nop 0
    s_branch L_B23_1
L_B23_2w:
    ds_read_b32 v3, v7
    s_waitcnt lgkmcnt(0)
    v_readlane_b32 s84, v3, 2
    s_nop 0
    s_branch L_B23_2
L_B23_3w:
    ds_read_b32 v3, v7
    s_waitcnt lgkmcnt(0)
    v_readlane_b32 s84, v3, 3
    s_nop 0
    s_branch L_B23_3
L_B16_0w:
    ds_read_b32 v3, v7
    s_waitcnt lgkmcnt(0)
    v_readlane_b32 s84, v3, 0
    s_nop 0
    s_branch L_B16_0
L_B16_1w:
    ds_read_b32 v3, v7
    s_waitcnt lgkmcnt(0)
    v_readlane_b32 s84, v3, 1
    s_nop 0
    s_branch L_B16_1
L_B16_2w:
    ds_read_b32 v3, v7
    s_waitcnt lgkmcnt(0)
    v_readlane_b32 s84, v3, 2
    s_nop 0
    s_branch L_B16_2
L_B16_3w:
    ds_read_b32 v3, v7
    s_waitcnt lgkmcnt(0)
    v_readlane_b32 s84, v3, 3
    s_nop 0
    s_branch L_B16_3
L_B24_0w:
    ds_read_b32 v3, v7
    s_waitcnt lgkmcnt(0)
    v_readlane_b32 s84, v3, 0
    s_nop 0
    s_branch L_B24_0
L_B24_1w:
    ds_read_b32 v3, v7
    s_waitcnt lgkmcnt(0)
    v_readlane_b32 s84, v3, 1
    s_nop 0
    s_branch L_B24_1
L_B24_2w:
    ds_read_b32 v3, v7
    s_waitcnt lgkmcnt(0)
    v_readlane_b32 s84, v3, 2
    s_nop 0
    s_branch L_B24_2
L_B24_3w:
    ds_read_b32 v3, v7
    s_waitcnt lgkmcnt(0)
    v_readlane_b32 s84, v3, 3
    s_nop 0
    s_branch L_B24_3
L_B15_0w:
    ds_read_b32 v3, v7
    s_waitcnt lgkmcnt(0)
    v_readlane_b32 s84, v3, 0
    s_nop 0
    s_branch L_B15_0
L_B15_1w:
    ds_read_b32 v3, v7
    s_waitcnt lgkmcnt(0)
    v_readlane_b32 s84, v3, 1
    s_nop 0
    s_branch L_B15_1
L_B15_2w:
    ds_read_b32 v3, v7
    s_waitcnt lgkmcnt(0)
    v_readlane_b32 s84, v3, 2
    s_nop 0
    s_branch L_B15_2
L_B15_3w:
    ds_read_b32 v3, v7
    s_waitcnt lgkmcnt(0)
    v_readlane_b32 s84, v3, 3
    s_nop 0
    s_branch L_B15_3
L_B25_0w:
    ds_read_b32 v3, v7
    s_waitcnt lgkmcnt(0)
    v_readlane_b32 s84, v3, 0
    s_nop 0
    s_branch L_B25_0
L_B25_1w:
    ds_read_b32 v3, v7
    s_waitcnt lgkmcnt(0)
    v_readlane_b32 s84, v3, 1
    s_nop 0
    s_branch L_B25_1
L_B25_2w:
    ds_read_b32 v3, v7
    s_waitcnt lgkmcnt(0)
    v_readlane_b32 s84, v3, 2
    s_nop 0
    s_branch L_B25_2
L_B25_3w:
    ds_read_b32 v3, v7
    s_waitcnt lgkmcnt(0)
    v_readlane_b32 s84, v3, 3
    s_nop 0
    s_branch L_B25_3
L_B26_0w:
    ds_read_b32 v3, v7
    s_waitcnt lgkmcnt(0)
    v_readlane_b32 s84, v3, 0
    s_nop 0
    s_branch L_B26_0
L_B26_1w:
    ds_read_b32 v3, v7
    s_waitcnt lgkmcnt(0)
    v_readlane_b32 s84, v3, 1
    s_nop 0
    s_branch L_B26_1
L_B26_2w:
    ds_read_b32 v3, v7
    s_waitcnt lgkmcnt(0)
    v_readlane_b32 s84, v3, 2
    s_nop 0
    s_branch L_B26_2
L_B26_3w:
    ds_read_b32 v3, v7
    s_waitcnt lgkmcnt(0)
    v_readlane_b32 s84, v3, 3
    s_nop 0
    s_branch L_B26_3
L_B32_0w:
    ds_read_b32 v3, v7
    s_waitcnt lgkmcnt(0)
    v_readlane_b32 s84, v3, 0
    s_nop 0
    s_branch L_B32_0
L_B32_1w:
    ds_read_b32 v3, v7
    s_waitcnt lgkmcnt(0)
    v_readlane_b32 s84, v3, 1
    s_nop 0
    s_branch L_B32_1
L_B32_2w:
    ds_read_b32 v3, v7
    s_waitcnt lgkmcnt(0)
    v_readlane_b32 s84, v3, 2
    s_nop 0
    s_branch L_B32_2
L_B32_3w:
    ds_read_b32 v3, v7
    s_waitcnt lgkmcnt(0)
    v_readlane_b32 s84, v3, 3
    s_nop 0
    s_branch L_B32_3
L_tail:
L_D32:
    s_mul_i32 s92, s81, 12
    s_add_u32 s92, s92, 16
    v_mov_b32 v5, s92
L_B32:
L_B32_0:
    s_cmp_lt_i32 s84, s82
    s_cbranch_scc1 L_B32_0w
    s_waitcnt vmcnt(31)
    buffer_load_dwordx4 v2, s[4:7], s78 offen offset:0 nt lds
    v_add_u32 v5, 3, v5
    s_add_u32 s81, s81, 1
    s_and_b32 s92, s81, 7
    s_waitcnt vmcnt(31)
    buffer_load_dwordx4 v2, s[4:7], s78 offen offset:1024 nt lds
    v_readlane_b32 s84, v3, 1
    ds_read_b32 v3, v7
    s_lshl_b32 s92, s92, 11
    s_add_u32 s92, s92, s77
    s_waitcnt vmcnt(31)
    buffer_load_dwordx4 v2, s[4:7], s78 offen offset:2048 nt lds
    ds_write_b32 v6, v5
    s_and_b32 s92, s92, 16383
    s_mul_i32 s80, s92, 768
L_B32_1:
    s_cmp_lt_i32 s84, s82
    s_cbranch_scc1 L_B32_1w
    s_waitcnt vmcnt(31)
    buffer_load_dwordx4 v2, s[4:7], s78 offen offset:3072 nt lds
    v_add_u32 v5, 3, v5
    s_add_u32 m0, m0, s85
    s_add_u32 s78, s78, s85
    s_waitcnt vmcnt(31)
    buffer_load_dwordx4 v2, s[4:7], s78 offen offset:0 nt lds
    v_readlane_b32 s84, v3, 2
    ds_read_b32 v3, v7
    s_bfe_u32 s92, s81, 0x40003
    s_bfe_i32 s93, s81, 0x10007
    s_waitcnt vmcnt(31)
    buffer_load_dwordx4 v2, s[4:7], s78 offen offset:1024 nt lds
    ds_write_b32 v6, v5
    s_xor_b32 s92, s92, s93
    s_and_b32 s92, s92, 15
L_B32_2:
    s_cmp_lt_i32 s84, s82
    s_cbranch_scc1 L_B32_2w
    s_waitcnt vmcnt(31)
    buffer_load_dwordx4 v2, s[4:7], s78 offen offset:2048 nt lds
    v_add_u32 v5, 3, v5
    s_mul_i32 s92, s92, 25165824
    s_add_u32 s80, s80, s79
    s_waitcnt vmcnt(31)
    buffer_load_dwordx4 v2, s[4:7], s78 offen offset:3072 nt lds
    v_readlane_b32 s84, v3, 3
    ds_read_b32 v3, v7
    s_add_u32 m0, m0, s85
    s_add_u32 s78, s78, s85
    s_waitcnt vmcnt(31)
    buffer_load_dwordx4 v2, s[4:7], s78 offen offset:0 nt lds
    ds_write_b32 v6, v5
    s_add_u32 s80, s80, s92
    s_and_b32 s86, s81, 3
L_B32_3:
    s_cmp_lt_i32 s84, s82
    s_cbranch_scc1 L_B32_3w
    s_waitcnt vmcnt(31)
    buffer_load_dwordx4 v2, s[4:7], s78 offen offset:1024 nt lds
    v_add_u32 v5, 3, v5
    v_readlane_b32 s83, v3, 4
    s_mul_i32 s86, s86, 12288
    s_waitcnt vmcnt(31)
    buffer_load_dwordx4 v2, s[4:7], s78 offen offset:2048 nt lds
    v_readlane_b32 s84, v3, 0
    ds_read_b32 v3, v7
    s_add_u32 s82, s82, 1
    s_cmp_eq_u32 s81, 256
    s_cselect_b32 s83, -1, 32
    s_cmp_ge_u32 s81, 128
    s_waitcnt vmcnt(31)
    buffer_load_dwordx4 v2, s[4:7], s78 offen offset:3072 nt lds
    ds_write_b32 v6, v5
    s_cselect_b64 s[4:5], s[56:57], s[50:51]
    s_mov_b32 m0, s86
    s_mov_b32 s78, s80
    s_cmp_eq_u32 s83, 32
    s_cbranch_scc1 L_B32
L_drain:
    v_mov_b32 v18, 3090
    s_waitcnt vmcnt(30)
    ds_write_b32 v6, v18
    v_mov_b32 v18, 3093
    s_waitcnt vmcnt(27)
    ds_write_b32 v6, v18
    v_mov_b32 v18, 3096
    s_waitcnt vmcnt(24)
    ds_write_b32 v6, v18
    v_mov_b32 v18, 3099
    s_waitcnt vmcnt(21)
    ds_write_b32 v6, v18
    v_mov_b32 v18, 3102
    s_waitcnt vmcnt(18)
    ds_write_b32 v6, v18
    v_mov_b32 v18, 3105
    s_waitcnt vmcnt(15)
    ds_write_b32 v6, v18
    v_mov_b32 v18, 3108
    s_waitcnt vmcnt(12)
    ds_write_b32 v6, v18
    v_mov_b32 v18, 3111
    s_waitcnt vmcnt(9)
    ds_write_b32 v6, v18
    v_mov_b32 v18, 3114
    s_waitcnt vmcnt(6)
    ds_write_b32 v6, v18
    v_mov_b32 v18, 3117
    s_waitcnt vmcnt(3)
    ds_write_b32 v6, v18
    v_mov_b32 v18, 3120
    s_waitcnt vmcnt(0)
    ds_write_b32 v6, v18
    s_waitcnt lgkmcnt(0)
    s_endpgm
L_other:
    s_cmp_eq_u32 s76, 5
    s_cbranch_scc1 L_helper
    s_sub_u32 s78, s76, 1
    v_lshlrev_b32 v44, 3, v1
    v_cmp_gt_u32 vcc, 24, v1
    v_mov_b32 v23, 0xffffff40
    v_mov_b32 v18, 192
    v_cndmask_b32 v23, v23, v18, vcc
    v_add_u32 v45, v44, v23
    v_mov_b32 v18, 0x80008000
    v_cndmask_b32 v46, 0, v18, vcc
    v_lshrrev_b32 v19, 4, v1
    v_and_b32 v23, 15, v1
    v_mul_u32_u24 v20, 384, v19
    v_lshl_add_u32 v20, v23, 3, v20
    v_cmp_lt_u32 s[86:87], 7, v23
    v_mov_b32 v21, -64
    v_mov_b32 v18, 320
    v_cndmask_b32 v21, v18, v21, s[86:87]
    v_add_u32 v21, v20, v21
    s_lshl2_add_u32 s95, s78, s3
    s_mul_i32 s95, s95, 384
    s_lshl2_add_u32 s89, s78, s77
    s_xor_b32 s89, s89, 8192
    s_mov_b32 s34, 12288
    s_mov_b32 s35, 0x20000
    s_mov_b32 s38, 384
    s_mov_b32 s39, 0x20000
    s_mov_b32 s42, 384
    s_mov_b32 s43, 0x20000
    s_mov_b32 s14, 6291456
    s_mov_b32 s15, 0x20000
    s_mov_b32 s18, 6291456
    s_mov_b32 s19, 0x20000
    s_waitcnt lgkmcnt(0)
    s_mov_b64 s[32:33], s[48:49]
    s_mov_b64 s[36:37], s[62:63]
    s_mov_b64 s[40:41], s[64:65]
    buffer_load_dwordx2 v[24:25], v44, s[32:35], s95 offen
    buffer_load_dwordx2 v[26:27], v45, s[32:35], s95 offen
    buffer_load_dwordx2 v[28:29], v44, s[32:35], s95 offen offset:768
    buffer_load_dwordx2 v[30:31], v45, s[32:35], s95 offen offset:768
    buffer_load_dwordx2 v[40:41], v44, s[36:39], 0 offen
    buffer_load_dwordx2 v[42:43], v44, s[40:43], 0 offen
    s_mov_b64 s[12:13], s[66:67]
    s_mov_b64 s[16:17], s[68:69]
    s_barrier
    s_mov_b32 s83, 0x05040100
    s_mov_b32 s84, 0x07060302
    s_mul_i32 s92, s78, 3072
    v_lshl_add_u32 v2, v20, 1, s92
    v_add_u32 v12, s92, v20
    v_add_u32 v13, s92, v21
    s_lshl_b32 s92, s78, 5
    s_add_u32 s92, s92, 49152
    v_lshl_add_u32 v3, v19, 3, s92
    v_lshrrev_b32 v18, 3, v23
    v_lshl_add_u32 v4, v18, 7, v3
    v_lshlrev_b32 v9, 4, v23
    v_add_u32 v9, 65536, v9
    s_lshl2_add_u32 s92, s78, 77824
    v_mov_b32 v5, s92
    v_mov_b32 v6, 0
    v_mov_b32 v8, 1
    s_mul_i32 s79, s78, 3
    s_sub_u32 s79, s79, 9
    s_mov_b32 s80, 0
    s_mov_b32 s81, 0
    s_mul_i32 s92, s78, 1536
    s_add_u32 s92, s92, 65536
    v_lshl_add_u32 v14, v44, 1, s92
    v_lshl_add_u32 v16, v45, 1, s92
    s_waitcnt vmcnt(0)
    v_xor_b32 v42, v42, v46
    v_xor_b32 v43, v43, v46
    v_lshlrev_b32 v48, 16, v40
    v_and_b32 v49, 0xffff0000, v40
    v_lshlrev_b32 v50, 16, v41
    v_and_b32 v51, 0xffff0000, v41
    v_lshlrev_b32 v52, 16, v42
    v_and_b32 v53, 0xffff0000, v42
    v_lshlrev_b32 v54, 16, v43
    v_and_b32 v55, 0xffff0000, v43
    v_and_b32 v46, 0x80000000, v46
    s_mov_b32 exec_hi, 0xffff
    v_lshlrev_b32 v56, 16, v24
    v_and_b32 v57, 0xffff0000, v24
    v_lshlrev_b32 v58, 16, v25
    v_and_b32 v59, 0xffff0000, v25
    v_lshlrev_b32 v60, 16, v26
    v_and_b32 v61, 0xffff0000, v26
    v_lshlrev_b32 v62, 16, v27
    v_and_b32 v63, 0xffff0000, v27
    v_pk_mul_f32 v[56:57], v[56:57], v[48:49]
    v_pk_mul_f32 v[60:61], v[60:61], v[52:53]
    v_pk_mul_f32 v[58:59], v[58:59], v[50:51]
    v_pk_mul_f32 v[62:63], v[62:63], v[54:55]
    v_cvt_pk_bf16_f32 v56, v56, v60
    v_cvt_pk_bf16_f32 v57, v57, v61
    v_cvt_pk_bf16_f32 v58, v58, v62
    v_cvt_pk_bf16_f32 v59, v59, v63
    v_and_b32 v60, 0xffff0000, v56
    v_lshlrev_b32 v56, 16, v56
    v_and_b32 v61, 0xffff0000, v57
    v_lshlrev_b32 v57, 16, v57
    v_and_b32 v62, 0xffff0000, v58
    v_lshlrev_b32 v58, 16, v58
    v_and_b32 v63, 0xffff0000, v59
    v_lshlrev_b32 v59, 16, v59
    v_pk_add_f32 v[56:57], v[56:57], v[60:61]
    v_pk_add_f32 v[58:59], v[58:59], v[62:63]
    v_cvt_pk_bf16_f32 v64, v56, v56
    v_cvt_pk_bf16_f32 v65, v57, v57
    v_cvt_pk_bf16_f32 v66, v58, v58
    v_cvt_pk_bf16_f32 v67, v59, v59
    v_xor_b32 v64, v64, v46
    v_xor_b32 v65, v65, v46
    v_xor_b32 v66, v66, v46
    v_xor_b32 v67, v67, v46
    ds_write_b16 v14, v64 offset:0
    ds_write_b16_d16_hi v16, v64 offset:2
    ds_write_b16 v14, v65 offset:4
    ds_write_b16_d16_hi v16, v65 offset:6
    ds_write_b16 v14, v66 offset:8
    ds_write_b16_d16_hi v16, v66 offset:10
    ds_write_b16 v14, v67 offset:12
    ds_write_b16_d16_hi v16, v67 offset:14
    v_lshlrev_b32 v56, 16, v28
    v_and_b32 v57, 0xffff0000, v28
    v_lshlrev_b32 v58, 16, v29
    v_and_b32 v59, 0xffff0000, v29
    v_lshlrev_b32 v60, 16, v30
    v_and_b32 v61, 0xffff0000, v30
    v_lshlrev_b32 v62, 16, v31
    v_and_b32 v63, 0xffff0000, v31
    v_pk_mul_f32 v[56:57], v[56:57], v[48:49]
    v_pk_mul_f32 v[60:61], v[60:61], v[52:53]
    v_pk_mul_f32 v[58:59], v[58:59], v[50:51]
    v_pk_mul_f32 v[62:63], v[62:63], v[54:55]
    v_cvt_pk_bf16_f32 v56, v56, v60
    v_cvt_pk_bf16_f32 v57, v57, v61
    v_cvt_pk_bf16_f32 v58, v58, v62
    v_cvt_pk_bf16_f32 v59, v59, v63
    v_and_b32 v60, 0xffff0000, v56
    v_lshlrev_b32 v56, 16, v56
    v_and_b32 v61, 0xffff0000, v57
    v_lshlrev_b32 v57, 16, v57
    v_and_b32 v62, 0xffff0000, v58
    v_lshlrev_b32 v58, 16, v58
    v_and_b32 v63, 0xffff0000, v59
    v_lshlrev_b32 v59, 16, v59
    v_pk_add_f32 v[56:57], v[56:57], v[60:61]
    v_pk_add_f32 v[58:59], v[58:59], v[62:63]
    v_cvt_pk_bf16_f32 v68, v56, v56
    v_cvt_pk_bf16_f32 v69, v57, v57
    v_cvt_pk_bf16_f32 v70, v58, v58
    v_cvt_pk_bf16_f32 v71, v59, v59
    v_xor_b32 v68, v68, v46
    v_xor_b32 v69, v69, v46
    v_xor_b32 v70, v70, v46
    v_xor_b32 v71, v71, v46
    ds_write_b16 v14, v68 offset:768
    ds_write_b16_d16_hi v16, v68 offset:770
    ds_write_b16 v14, v69 offset:772
    ds_write_b16_d16_hi v16, v69 offset:774
    ds_write_b16 v14, v70 offset:776
    ds_write_b16_d16_hi v16, v70 offset:778
    ds_write_b16 v14, v71 offset:780
    ds_write_b16_d16_hi v16, v71 offset:782
    s_mov_b32 exec_hi, -1
    ds_write_b32 v5, v8 offset:160
    s_add_u32 s79, s79, 12
    s_cmp_ge_i32 s80, s79
    s_cbranch_scc1 L_cr0g
L_cr0:
    ds_read_b32 v19, v7
    s_sleep 1
    s_waitcnt lgkmcnt(0)
    v_readlane_b32 s80, v19, 5
    s_nop 0
    s_cmp_lt_i32 s80, s79
    s_cbranch_scc1 L_cr0
L_cr0g:
    ds_read_b64 v[72:73], v12 offset:0
    ds_read_b64 v[76:77], v12 offset:128
    ds_read_b64 v[80:81], v12 offset:256
    ds_read_b64 v[84:85], v12 offset:1536
    ds_read_b64 v[88:89], v12 offset:1664
    ds_read_b64 v[92:93], v12 offset:1792
    v_add_u32 v6, 1, v6
    ds_write_b32 v5, v6
    s_add_u32 s79, s79, 12
    s_cmp_ge_i32 s80, s79
    s_cbranch_scc1 L_cr1g
L_cr1:
    ds_read_b32 v19, v7
    s_sleep 1
    s_waitcnt lgkmcnt(0)
    v_readlane_b32 s80, v19, 5
    s_nop 0
    s_cmp_lt_i32 s80, s79
    s_cbranch_scc1 L_cr1
L_cr1g:
    ds_read_b64 v[74:75], v12 offset:12480
    ds_read_b64 v[78:79], v13 offset:12288
    ds_read_b64 v[82:83], v12 offset:12352
    ds_read_b64 v[86:87], v12 offset:14016
    ds_read_b64 v[90:91], v13 offset:13824
    ds_read_b64 v[94:95], v12 offset:13888
    v_add_u32 v6, 1, v6
    ds_write_b32 v5, v6
    s_mul_i32 s82, s89, 384
    s_add_u32 s89, s89, 2048
    s_and_b32 s89, s89, 16383
    buffer_load_dwordx2 v[120:121], v20, s[12:15], s82 offen offset:0
    buffer_load_dwordx2 v[122:123], v20, s[16:19], s82 offen offset:192
    buffer_load_dwordx2 v[124:125], v20, s[12:15], s82 offen offset:128
    buffer_load_dwordx2 v[126:127], v21, s[16:19], s82 offen
    buffer_load_dwordx2 v[128:129], v20, s[12:15], s82 offen offset:256
    buffer_load_dwordx2 v[130:131], v20, s[16:19], s82 offen offset:64
    s_add_u32 s79, s79, 12
    s_cmp_ge_i32 s80, s79
    s_cbranch_scc1 L_cr2g
L_cr2:
    ds_read_b32 v19, v7
    s_sleep 1
    s_waitcnt lgkmcnt(0)
    v_readlane_b32 s80, v19, 5
    s_nop 0
    s_cmp_lt_i32 s80, s79
    s_cbranch_scc1 L_cr2
L_cr2g:
    ds_read_b64 v[96:97], v12 offset:24576
    ds_read_b64 v[100:101], v12 offset:24704
    ds_read_b64 v[104:105], v12 offset:24832
    ds_read_b64 v[108:109], v12 offset:26112
    ds_read_b64 v[112:113], v12 offset:26240
    ds_read_b64 v[116:117], v12 offset:26368
    v_add_u32 v6, 1, v6
    ds_write_b32 v5, v6
    s_add_u32 s79, s79, 12
    s_cmp_ge_i32 s80, s79
    s_cbranch_scc1 L_cr3g
L_cr3:
    ds_read_b32 v19, v7
    s_sleep 1
    s_waitcnt lgkmcnt(0)
    v_readlane_b32 s80, v19, 5
    s_nop 0
    s_cmp_lt_i32 s80, s79
    s_cbranch_scc1 L_cr3
L_cr3g:
    ds_read_b64 v[98:99], v12 offset:37056
    ds_read_b64 v[102:103], v13 offset:36864
    ds_read_b64 v[106:107], v12 offset:36928
    ds_read_b64 v[110:111], v12 offset:38592
    ds_read_b64 v[114:115], v13 offset:38400
    ds_read_b64 v[118:119], v12 offset:38464
    v_add_u32 v6, 1, v6
    ds_write_b32 v5, v6
    s_mul_i32 s82, s89, 384
    s_add_u32 s89, s89, 2048
    s_and_b32 s89, s89, 16383
    buffer_load_dwordx2 v[132:133], v20, s[12:15], s82 offen offset:0
    buffer_load_dwordx2 v[134:135], v20, s[16:19], s82 offen offset:192
    buffer_load_dwordx2 v[136:137], v20, s[12:15], s82 offen offset:128
    buffer_load_dwordx2 v[138:139], v21, s[16:19], s82 offen
    buffer_load_dwordx2 v[140:141], v20, s[12:15], s82 offen offset:256
    buffer_load_dwordx2 v[142:143], v20, s[16:19], s82 offen offset:64
L_kph:
    s_lshr_b32 s94, s81, 1
    s_add_u32 s88, s94, 40
    s_lshl2_add_u32 s92, s94, 77888
    v_mov_b32 v22, s92
    s_nop 1
L_kw:
    ds_read_b32 v19, v7
    ds_read_b128 v[48:51], v9 offset:0
    ds_read_b128 v[52:55], v9 offset:256
    ds_read_b128 v[56:59], v9 offset:512
    s_waitcnt lgkmcnt(0)
    v_readlane_b32 s92, v19, s88
    v_readlane_b32 s93, v19, 12
    s_cmp_eq_u32 s92, 0
    s_nop 3
    s_cbranch_scc1 L_kw
    s_cmp_le_u32 s93, s94
    s_cbranch_scc1 L_kw
    v_add_u32 v9, 768, v9
    s_cmp_lg_u32 s81, 0
    s_nop 0
    s_cbranch_scc1 L_ncs0
    v_perm_b32 v36, v74, v72, s83
    v_perm_b32 v74, v74, v72, s84
    v_perm_b32 v37, v75, v73, s83
    v_perm_b32 v75, v75, v73, s84
    v_perm_b32 v38, v78, v76, s83
    v_perm_b32 v78, v78, v76, s84
    v_perm_b32 v39, v79, v77, s83
    v_perm_b32 v79, v79, v77, s84
    v_perm_b32 v40, v82, v80, s83
    v_perm_b32 v82, v82, v80, s84
    v_perm_b32 v41, v83, v81, s83
    v_perm_b32 v83, v83, v81, s84
    v_mov_b64 v[72:73], v[36:37]
    v_mov_b64 v[76:77], v[38:39]
    v_mov_b64 v[80:81], v[40:41]
    s_nop 1
L_ncs0:
    v_dot2_f32_bf16 v36, v72, v48, 0
    v_dot2_f32_bf16 v37, v74, v49, 0
    v_dot2_f32_bf16 v38, v73, v50, 0
    v_dot2_f32_bf16 v39, v75, v51, 0
    v_dot2_f32_bf16 v40, v76, v52, 0
    v_dot2_f32_bf16 v41, v78, v53, 0
    v_dot2_f32_bf16 v42, v77, v54, 0
    v_dot2_f32_bf16 v43, v79, v55, 0
    v_dot2_f32_bf16 v44, v80, v56, 0
    v_dot2_f32_bf16 v45, v82, v57, 0
    v_dot2_f32_bf16 v46, v81, v58, 0
    v_dot2_f32_bf16 v47, v83, v59, 0
    s_add_u32 s79, s79, 12
    s_cmp_ge_i32 s80, s79
    s_cbranch_scc1 L_kr0g
L_kr0:
    ds_read_b32 v19, v7
    s_sleep 1
    s_waitcnt lgkmcnt(0)
    v_readlane_b32 s80, v19, 5
    s_nop 0
    s_cmp_lt_i32 s80, s79
    s_cbranch_scc1 L_kr0
L_kr0g:
    ds_read_b32 v10, v3 offset:0
    ds_read_b128 v[24:27], v2 offset:0
    ds_read_b128 v[28:31], v2 offset:256
    ds_read_b128 v[32:35], v2 offset:512
    v_add_u32 v6, 1, v6
    ds_write_b32 v5, v6
    s_waitcnt lgkmcnt(3)
    v_and_b32 v12, 0xffff0000, v10
    v_cvt_f32_i32 v24, v24
    v_cvt_f32_i32 v25, v25
    v_cvt_f32_i32 v26, v26
    v_cvt_f32_i32 v27, v27
    v_pk_add_f32 v[24:25], v[24:25], v[12:13] op_sel:[0,0] op_sel_hi:[1,0] neg_lo:[0,1] neg_hi:[0,1]
    v_pk_add_f32 v[26:27], v[26:27], v[12:13] op_sel:[0,0] op_sel_hi:[1,0] neg_lo:[0,1] neg_hi:[0,1]
    v_pk_mul_f32 v[14:15], v[24:25], v[36:37]
    v_pk_fma_f32 v[14:15], v[26:27], v[38:39], v[14:15]
    s_waitcnt lgkmcnt(2)
    v_cvt_f32_i32 v28, v28
    v_cvt_f32_i32 v29, v29
    v_cvt_f32_i32 v30, v30
    v_cvt_f32_i32 v31, v31
    v_pk_add_f32 v[28:29], v[28:29], v[12:13] op_sel:[0,0] op_sel_hi:[1,0] neg_lo:[0,1] neg_hi:[0,1]
    v_pk_add_f32 v[30:31], v[30:31], v[12:13] op_sel:[0,0] op_sel_hi:[1,0] neg_lo:[0,1] neg_hi:[0,1]
    v_pk_fma_f32 v[14:15], v[28:29], v[40:41], v[14:15]
    v_pk_fma_f32 v[14:15], v[30:31], v[42:43], v[14:15]
    s_waitcnt lgkmcnt(1)
    v_cvt_f32_i32 v32, v32
    v_cvt_f32_i32 v33, v33
    v_cvt_f32_i32 v34, v34
    v_cvt_f32_i32 v35, v35
    v_pk_add_f32 v[32:33], v[32:33], v[12:13] op_sel:[0,0] op_sel_hi:[1,0] neg_lo:[0,1] neg_hi:[0,1]
    v_pk_add_f32 v[34:35], v[34:35], v[12:13] op_sel:[0,0] op_sel_hi:[1,0] neg_lo:[0,1] neg_hi:[0,1]
    v_pk_fma_f32 v[14:15], v[32:33], v[44:45], v[14:15]
    v_pk_fma_f32 v[14:15], v[34:35], v[46:47], v[14:15]
    v_add_f32 v14, v14, v15
    s_nop 1
    v_add_f32_dpp v18, v14, v14 row_ror:8 row_mask:0xf bank_mask:0x3
    s_cmp_lg_u32 s81, 0
    s_nop 0
    s_cbranch_scc1 L_ncs1
    s_mul_i32 s82, s89, 384
    s_add_u32 s89, s89, 2048
    s_and_b32 s89, s89, 16383
    buffer_load_dwordx2 v[144:145], v20, s[12:15], s82 offen offset:0
    buffer_load_dwordx2 v[146:147], v20, s[16:19], s82 offen offset:192
    buffer_load_dwordx2 v[148:149], v20, s[12:15], s82 offen offset:128
    buffer_load_dwordx2 v[150:151], v21, s[16:19], s82 offen
    buffer_load_dwordx2 v[152:153], v20, s[12:15], s82 offen offset:256
    buffer_load_dwordx2 v[154:155], v20, s[16:19], s82 offen offset:64
    v_perm_b32 v36, v86, v84, s83
    v_perm_b32 v86, v86, v84, s84
    v_perm_b32 v37, v87, v85, s83
    v_perm_b32 v87, v87, v85, s84
    v_perm_b32 v38, v90, v88, s83
    v_perm_b32 v90, v90, v88, s84
    v_perm_b32 v39, v91, v89, s83
    v_perm_b32 v91, v91, v89, s84
    v_perm_b32 v40, v94, v92, s83
    v_perm_b32 v94, v94, v92, s84
    v_perm_b32 v41, v95, v93, s83
    v_perm_b32 v95, v95, v93, s84
    v_mov_b64 v[84:85], v[36:37]
    v_mov_b64 v[88:89], v[38:39]
    v_mov_b64 v[92:93], v[40:41]
    s_nop 1
L_ncs1:
    v_dot2_f32_bf16 v36, v84, v48, 0
    v_dot2_f32_bf16 v37, v86, v49, 0
    v_dot2_f32_bf16 v38, v85, v50, 0
    v_dot2_f32_bf16 v39, v87, v51, 0
    v_dot2_f32_bf16 v40, v88, v52, 0
    v_dot2_f32_bf16 v41, v90, v53, 0
    v_dot2_f32_bf16 v42, v89, v54, 0
    v_dot2_f32_bf16 v43, v91, v55, 0
    v_dot2_f32_bf16 v44, v92, v56, 0
    v_dot2_f32_bf16 v45, v94, v57, 0
    v_dot2_f32_bf16 v46, v93, v58, 0
    v_dot2_f32_bf16 v47, v95, v59, 0
    s_add_u32 s79, s79, 12
    s_cmp_ge_i32 s80, s79
    s_cbranch_scc1 L_kr1g
L_kr1:
    ds_read_b32 v19, v7
    s_sleep 1
    s_waitcnt lgkmcnt(0)
    v_readlane_b32 s80, v19, 5
    s_nop 0
    s_cmp_lt_i32 s80, s79
    s_cbranch_scc1 L_kr1
L_kr1g:
    ds_read_b32 v11, v3 offset:128
    ds_read_b128 v[24:27], v2 offset:12288
    ds_read_b128 v[28:31], v2 offset:12544
    ds_read_b128 v[32:35], v2 offset:12800
    v_add_u32 v6, 1, v6
    ds_write_b32 v5, v6
    s_waitcnt lgkmcnt(3)
    v_and_b32 v12, 0xffff0000, v11
    v_cvt_f32_i32 v24, v24
    v_cvt_f32_i32 v25, v25
    v_cvt_f32_i32 v26, v26
    v_cvt_f32_i32 v27, v27
    v_pk_add_f32 v[24:25], v[24:25], v[12:13] op_sel:[0,0] op_sel_hi:[1,0] neg_lo:[0,1] neg_hi:[0,1]
    v_pk_add_f32 v[26:27], v[26:27], v[12:13] op_sel:[0,0] op_sel_hi:[1,0] neg_lo:[0,1] neg_hi:[0,1]
    v_pk_mul_f32 v[16:17], v[24:25], v[36:37]
    v_pk_fma_f32 v[16:17], v[26:27], v[38:39], v[16:17]
    s_waitcnt lgkmcnt(2)
    v_cvt_f32_i32 v28, v28
    v_cvt_f32_i32 v29, v29
    v_cvt_f32_i32 v30, v30
    v_cvt_f32_i32 v31, v31
    v_pk_add_f32 v[28:29], v[28:29], v[12:13] op_sel:[0,0] op_sel_hi:[1,0] neg_lo:[0,1] neg_hi:[0,1]
    v_pk_add_f32 v[30:31], v[30:31], v[12:13] op_sel:[0,0] op_sel_hi:[1,0] neg_lo:[0,1] neg_hi:[0,1]
    v_pk_fma_f32 v[16:17], v[28:29], v[40:41], v[16:17]
    v_pk_fma_f32 v[16:17], v[30:31], v[42:43], v[16:17]
    s_waitcnt lgkmcnt(1)
    v_cvt_f32_i32 v32, v32
    v_cvt_f32_i32 v33, v33
    v_cvt_f32_i32 v34, v34
    v_cvt_f32_i32 v35, v35
    v_pk_add_f32 v[32:33], v[32:33], v[12:13] op_sel:[0,0] op_sel_hi:[1,0] neg_lo:[0,1] neg_hi:[0,1]
    v_pk_add_f32 v[34:35], v[34:35], v[12:13] op_sel:[0,0] op_sel_hi:[1,0] neg_lo:[0,1] neg_hi:[0,1]
    v_pk_fma_f32 v[16:17], v[32:33], v[44:45], v[16:17]
    v_pk_fma_f32 v[16:17], v[34:35], v[46:47], v[16:17]
    v_add_f32 v16, v16, v17
    v_cndmask_b32 v23, v10, v11, s[86:87]
    v_lshlrev_b32 v23, 16, v23
    v_add_f32_dpp v18, v16, v16 row_ror:8 row_mask:0xf bank_mask:0xc
    v_mul_f32 v23, 0x3dd53b95, v23
    s_nop 0
    v_add_f32_dpp v18, v18, v18 row_half_mirror row_mask:0xf bank_mask:0xf
    s_nop 1
    v_add_f32_dpp v18, v18, v18 quad_perm:[2,3,0,1] row_mask:0xf bank_mask:0xf
    s_nop 1
    v_add_f32_dpp v18, v18, v18 quad_perm:[1,0,3,2] row_mask:0xf bank_mask:0xf
    v_mul_f32 v18, v23, v18
    ds_write_b32 v4, v18 offset:0
    s_cmp_lg_u32 s81, 0
    s_cbranch_scc1 L_ncs2
    v_perm_b32 v36, v98, v96, s83
    v_perm_b32 v98, v98, v96, s84
    v_perm_b32 v37, v99, v97, s83
    v_perm_b32 v99, v99, v97, s84
    v_perm_b32 v38, v102, v100, s83
    v_perm_b32 v102, v102, v100, s84
    v_perm_b32 v39, v103, v101, s83
    v_perm_b32 v103, v103, v101, s84
    v_perm_b32 v40, v106, v104, s83
    v_perm_b32 v106, v106, v104, s84
    v_perm_b32 v41, v107, v105, s83
    v_perm_b32 v107, v107, v105, s84
    v_mov_b64 v[96:97], v[36:37]
    v_mov_b64 v[100:101], v[38:39]
    v_mov_b64 v[104:105], v[40:41]
    s_nop 1
L_ncs2:
    v_dot2_f32_bf16 v36, v96, v48, 0
    v_dot2_f32_bf16 v37, v98, v49, 0
    v_dot2_f32_bf16 v38, v97, v50, 0
    v_dot2_f32_bf16 v39, v99, v51, 0
    v_dot2_f32_bf16 v40, v100, v52, 0
    v_dot2_f32_bf16 v41, v102, v53, 0
    v_dot2_f32_bf16 v42, v101, v54, 0
    v_dot2_f32_bf16 v43, v103, v55, 0
    v_dot2_f32_bf16 v44, v104, v56, 0
    v_dot2_f32_bf16 v45, v106, v57, 0
    v_dot2_f32_bf16 v46, v105, v58, 0
    v_dot2_f32_bf16 v47, v107, v59, 0
    s_add_u32 s79, s79, 12
    s_cmp_ge_i32 s80, s79
    s_cbranch_scc1 L_kr2g
L_kr2:
    ds_read_b32 v19, v7
    s_sleep 1
    s_waitcnt lgkmcnt(0)
    v_readlane_b32 s80, v19, 5
    s_nop 0
    s_cmp_lt_i32 s80, s79
    s_cbranch_scc1 L_kr2
L_kr2g:
    ds_read_b32 v10, v3 offset:256
    ds_read_b128 v[24:27], v2 offset:24576
    ds_read_b128 v[28:31], v2 offset:24832
    ds_read_b128 v[32:35], v2 offset:25088
    v_add_u32 v6, 1, v6
    ds_write_b32 v5, v6
    s_waitcnt lgkmcnt(3)
    v_and_b32 v12, 0xffff0000, v10
    v_cvt_f32_i32 v24, v24
    v_cvt_f32_i32 v25, v25
    v_cvt_f32_i32 v26, v26
    v_cvt_f32_i32 v27, v27
    v_pk_add_f32 v[24:25], v[24:25], v[12:13] op_sel:[0,0] op_sel_hi:[1,0] neg_lo:[0,1] neg_hi:[0,1]
    v_pk_add_f32 v[26:27], v[26:27], v[12:13] op_sel:[0,0] op_sel_hi:[1,0] neg_lo:[0,1] neg_hi:[0,1]
    v_pk_mul_f32 v[14:15], v[24:25], v[36:37]
    v_pk_fma_f32 v[14:15], v[26:27], v[38:39], v[14:15]
    s_waitcnt lgkmcnt(2)
    v_cvt_f32_i32 v28, v28
    v_cvt_f32_i32 v29, v29
    v_cvt_f32_i32 v30, v30
    v_cvt_f32_i32 v31, v31
    v_pk_add_f32 v[28:29], v[28:29], v[12:13] op_sel:[0,0] op_sel_hi:[1,0] neg_lo:[0,1] neg_hi:[0,1]
    v_pk_add_f32 v[30:31], v[30:31], v[12:13] op_sel:[0,0] op_sel_hi:[1,0] neg_lo:[0,1] neg_hi:[0,1]
    v_pk_fma_f32 v[14:15], v[28:29], v[40:41], v[14:15]
    v_pk_fma_f32 v[14:15], v[30:31], v[42:43], v[14:15]
    s_waitcnt lgkmcnt(1)
    v_cvt_f32_i32 v32, v32
    v_cvt_f32_i32 v33, v33
    v_cvt_f32_i32 v34, v34
    v_cvt_f32_i32 v35, v35
    v_pk_add_f32 v[32:33], v[32:33], v[12:13] op_sel:[0,0] op_sel_hi:[1,0] neg_lo:[0,1] neg_hi:[0,1]
    v_pk_add_f32 v[34:35], v[34:35], v[12:13] op_sel:[0,0] op_sel_hi:[1,0] neg_lo:[0,1] neg_hi:[0,1]
    v_pk_fma_f32 v[14:15], v[32:33], v[44:45], v[14:15]
    v_pk_fma_f32 v[14:15], v[34:35], v[46:47], v[14:15]
    v_add_f32 v14, v14, v15
    s_nop 1
    v_add_f32_dpp v18, v14, v14 row_ror:8 row_mask:0xf bank_mask:0x3
    s_cmp_lg_u32 s81, 0
    s_nop 0
    s_cbranch_scc1 L_ncs3
    s_mul_i32 s82, s89, 384
    s_add_u32 s89, s89, 2048
    s_and_b32 s89, s89, 16383
    buffer_load_dwordx2 v[156:157], v20, s[12:15], s82 offen offset:0
    buffer_load_dwordx2 v[158:159], v20, s[16:19], s82 offen offset:192
    buffer_load_dwordx2 v[160:161], v20, s[12:15], s82 offen offset:128
    buffer_load_dwordx2 v[162:163], v21, s[16:19], s82 offen
    buffer_load_dwordx2 v[164:165], v20, s[12:15], s82 offen offset:256
    buffer_load_dwordx2 v[166:167], v20, s[16:19], s82 offen offset:64
    v_perm_b32 v36, v110, v108, s83
    v_perm_b32 v110, v110, v108, s84
    v_perm_b32 v37, v111, v109, s83
    v_perm_b32 v111, v111, v109, s84
    v_perm_b32 v38, v114, v112, s83
    v_perm_b32 v114, v114, v112, s84
    v_perm_b32 v39, v115, v113, s83
    v_perm_b32 v115, v115, v113, s84
    v_perm_b32 v40, v118, v116, s83
    v_perm_b32 v118, v118, v116, s84
    v_perm_b32 v41, v119, v117, s83
    v_perm_b32 v119, v119, v117, s84
    v_mov_b64 v[108:109], v[36:37]
    v_mov_b64 v[112:113], v[38:39]
    v_mov_b64 v[116:117], v[40:41]
    s_nop 1
L_ncs3:
    v_dot2_f32_bf16 v36, v108, v48, 0
    v_dot2_f32_bf16 v37, v110, v49, 0
    v_dot2_f32_bf16 v38, v109, v50, 0
    v_dot2_f32_bf16 v39, v111, v51, 0
    v_dot2_f32_bf16 v40, v112, v52, 0
    v_dot2_f32_bf16 v41, v114, v53, 0
    v_dot2_f32_bf16 v42, v113, v54, 0
    v_dot2_f32_bf16 v43, v115, v55, 0
    v_dot2_f32_bf16 v44, v116, v56, 0
    v_dot2_f32_bf16 v45, v118, v57, 0
    v_dot2_f32_bf16 v46, v117, v58, 0
    v_dot2_f32_bf16 v47, v119, v59, 0
    s_add_u32 s79, s79, 12
    s_cmp_ge_i32 s80, s79
    s_cbranch_scc1 L_kr3g
L_kr3:
    ds_read_b32 v19, v7
    s_sleep 1
    s_waitcnt lgkmcnt(0)
    v_readlane_b32 s80, v19, 5
    s_nop 0
    s_cmp_lt_i32 s80, s79
    s_cbranch_scc1 L_kr3
L_kr3g:
    ds_read_b32 v11, v3 offset:384
    ds_read_b128 v[24:27], v2 offset:36864
    ds_read_b128 v[28:31], v2 offset:37120
    ds_read_b128 v[32:35], v2 offset:37376
    v_add_u32 v6, 1, v6
    ds_write_b32 v5, v6
    s_waitcnt lgkmcnt(3)
    v_and_b32 v12, 0xffff0000, v11
    v_cvt_f32_i32 v24, v24
    v_cvt_f32_i32 v25, v25
    v_cvt_f32_i32 v26, v26
    v_cvt_f32_i32 v27, v27
    v_pk_add_f32 v[24:25], v[24:25], v[12:13] op_sel:[0,0] op_sel_hi:[1,0] neg_lo:[0,1] neg_hi:[0,1]
    v_pk_add_f32 v[26:27], v[26:27], v[12:13] op_sel:[0,0] op_sel_hi:[1,0] neg_lo:[0,1] neg_hi:[0,1]
    v_pk_mul_f32 v[16:17], v[24:25], v[36:37]
    v_pk_fma_f32 v[16:17], v[26:27], v[38:39], v[16:17]
    s_waitcnt lgkmcnt(2)
    v_cvt_f32_i32 v28, v28
    v_cvt_f32_i32 v29, v29
    v_cvt_f32_i32 v30, v30
    v_cvt_f32_i32 v31, v31
    v_pk_add_f32 v[28:29], v[28:29], v[12:13] op_sel:[0,0] op_sel_hi:[1,0] neg_lo:[0,1] neg_hi:[0,1]
    v_pk_add_f32 v[30:31], v[30:31], v[12:13] op_sel:[0,0] op_sel_hi:[1,0] neg_lo:[0,1] neg_hi:[0,1]
    v_pk_fma_f32 v[16:17], v[28:29], v[40:41], v[16:17]
    v_pk_fma_f32 v[16:17], v[30:31], v[42:43], v[16:17]
    s_waitcnt lgkmcnt(1)
    v_cvt_f32_i32 v32, v32
    v_cvt_f32_i32 v33, v33
    v_cvt_f32_i32 v34, v34
    v_cvt_f32_i32 v35, v35
    v_pk_add_f32 v[32:33], v[32:33], v[12:13] op_sel:[0,0] op_sel_hi:[1,0] neg_lo:[0,1] neg_hi:[0,1]
    v_pk_add_f32 v[34:35], v[34:35], v[12:13] op_sel:[0,0] op_sel_hi:[1,0] neg_lo:[0,1] neg_hi:[0,1]
    v_pk_fma_f32 v[16:17], v[32:33], v[44:45], v[16:17]
    v_pk_fma_f32 v[16:17], v[34:35], v[46:47], v[16:17]
    v_add_f32 v16, v16, v17
    v_cndmask_b32 v23, v10, v11, s[86:87]
    v_lshlrev_b32 v23, 16, v23
    v_add_f32_dpp v18, v16, v16 row_ror:8 row_mask:0xf bank_mask:0xc
    v_mul_f32 v23, 0x3dd53b95, v23
    s_nop 0
    v_add_f32_dpp v18, v18, v18 row_half_mirror row_mask:0xf bank_mask:0xf
    s_nop 1
    v_add_f32_dpp v18, v18, v18 quad_perm:[2,3,0,1] row_mask:0xf bank_mask:0xf
    s_nop 1
    v_add_f32_dpp v18, v18, v18 quad_perm:[1,0,3,2] row_mask:0xf bank_mask:0xf
    v_mul_f32 v18, v23, v18
    ds_write_b32 v4, v18 offset:256
    s_cmp_lg_u32 s81, 0
    s_cbranch_scc1 L_ncs4
    s_waitcnt vmcnt(18)
    v_perm_b32 v36, v122, v120, s83
    v_perm_b32 v122, v122, v120, s84
    v_perm_b32 v37, v123, v121, s83
    v_perm_b32 v123, v123, v121, s84
    v_perm_b32 v38, v126, v124, s83
    v_perm_b32 v126, v126, v124, s84
    v_perm_b32 v39, v127, v125, s83
    v_perm_b32 v127, v127, v125, s84
    v_perm_b32 v40, v130, v128, s83
    v_perm_b32 v130, v130, v128, s84
    v_perm_b32 v41, v131, v129, s83
    v_perm_b32 v131, v131, v129, s84
    v_mov_b64 v[120:121], v[36:37]
    v_mov_b64 v[124:125], v[38:39]
    v_mov_b64 v[128:129], v[40:41]
    s_nop 1
L_ncs4:
    v_dot2_f32_bf16 v36, v120, v48, 0
    v_dot2_f32_bf16 v37, v122, v49, 0
    v_dot2_f32_bf16 v38, v121, v50, 0
    v_dot2_f32_bf16 v39, v123, v51, 0
    v_dot2_f32_bf16 v40, v124, v52, 0
    v_dot2_f32_bf16 v41, v126, v53, 0
    v_dot2_f32_bf16 v42, v125, v54, 0
    v_dot2_f32_bf16 v43, v127, v55, 0
    v_dot2_f32_bf16 v44, v128, v56, 0
    v_dot2_f32_bf16 v45, v130, v57, 0
    v_dot2_f32_bf16 v46, v129, v58, 0
    v_dot2_f32_bf16 v47, v131, v59, 0
    s_add_u32 s79, s79, 12
    s_cmp_ge_i32 s80, s79
    s_cbranch_scc1 L_kr4g
L_kr4:
    ds_read_b32 v19, v7
    s_sleep 1
    s_waitcnt lgkmcnt(0)
    v_readlane_b32 s80, v19, 5
    s_nop 0
    s_cmp_lt_i32 s80, s79
    s_cbranch_scc1 L_kr4
L_kr4g:
    ds_read_b32 v10, v3 offset:512
    ds_read_b128 v[24:27], v2 offset:0
    ds_read_b128 v[28:31], v2 offset:256
    ds_read_b128 v[32:35], v2 offset:512
    v_add_u32 v6, 1, v6
    ds_write_b32 v5, v6
    s_waitcnt lgkmcnt(3)
    v_and_b32 v12, 0xffff0000, v10
    v_cvt_f32_i32 v24, v24
    v_cvt_f32_i32 v25, v25
    v_cvt_f32_i32 v26, v26
    v_cvt_f32_i32 v27, v27
    v_pk_add_f32 v[24:25], v[24:25], v[12:13] op_sel:[0,0] op_sel_hi:[1,0] neg_lo:[0,1] neg_hi:[0,1]
    v_pk_add_f32 v[26:27], v[26:27], v[12:13] op_sel:[0,0] op_sel_hi:[1,0] neg_lo:[0,1] neg_hi:[0,1]
    v_pk_mul_f32 v[14:15], v[24:25], v[36:37]
    v_pk_fma_f32 v[14:15], v[26:27], v[38:39], v[14:15]
    s_waitcnt lgkmcnt(2)
    v_cvt_f32_i32 v28, v28
    v_cvt_f32_i32 v29, v29
    v_cvt_f32_i32 v30, v30
    v_cvt_f32_i32 v31, v31
    v_pk_add_f32 v[28:29], v[28:29], v[12:13] op_sel:[0,0] op_sel_hi:[1,0] neg_lo:[0,1] neg_hi:[0,1]
    v_pk_add_f32 v[30:31], v[30:31], v[12:13] op_sel:[0,0] op_sel_hi:[1,0] neg_lo:[0,1] neg_hi:[0,1]
    v_pk_fma_f32 v[14:15], v[28:29], v[40:41], v[14:15]
    v_pk_fma_f32 v[14:15], v[30:31], v[42:43], v[14:15]
    s_waitcnt lgkmcnt(1)
    v_cvt_f32_i32 v32, v32
    v_cvt_f32_i32 v33, v33
    v_cvt_f32_i32 v34, v34
    v_cvt_f32_i32 v35, v35
    v_pk_add_f32 v[32:33], v[32:33], v[12:13] op_sel:[0,0] op_sel_hi:[1,0] neg_lo:[0,1] neg_hi:[0,1]
    v_pk_add_f32 v[34:35], v[34:35], v[12:13] op_sel:[0,0] op_sel_hi:[1,0] neg_lo:[0,1] neg_hi:[0,1]
    v_pk_fma_f32 v[14:15], v[32:33], v[44:45], v[14:15]
    v_pk_fma_f32 v[14:15], v[34:35], v[46:47], v[14:15]
    v_add_f32 v14, v14, v15
    s_nop 1
    v_add_f32_dpp v18, v14, v14 row_ror:8 row_mask:0xf bank_mask:0x3
    s_cmp_lg_u32 s81, 0
    s_nop 0
    s_cbranch_scc1 L_ncs5
    s_waitcnt vmcnt(12)
    v_perm_b32 v36, v134, v132, s83
    v_perm_b32 v134, v134, v132, s84
    v_perm_b32 v37, v135, v133, s83
    v_perm_b32 v135, v135, v133, s84
    v_perm_b32 v38, v138, v136, s83
    v_perm_b32 v138, v138, v136, s84
    v_perm_b32 v39, v139, v137, s83
    v_perm_b32 v139, v139, v137, s84
    v_perm_b32 v40, v142, v140, s83
    v_perm_b32 v142, v142, v140, s84
    v_perm_b32 v41, v143, v141, s83
    v_perm_b32 v143, v143, v141, s84
    v_mov_b64 v[132:133], v[36:37]
    v_mov_b64 v[136:137], v[38:39]
    v_mov_b64 v[140:141], v[40:41]
    s_nop 1
L_ncs5:
    v_dot2_f32_bf16 v36, v132, v48, 0
    v_dot2_f32_bf16 v37, v134, v49, 0
    v_dot2_f32_bf16 v38, v133, v50, 0
    v_dot2_f32_bf16 v39, v135, v51, 0
    v_dot2_f32_bf16 v40, v136, v52, 0
    v_dot2_f32_bf16 v41, v138, v53, 0
    v_dot2_f32_bf16 v42, v137, v54, 0
    v_dot2_f32_bf16 v43, v139, v55, 0
    v_dot2_f32_bf16 v44, v140, v56, 0
    v_dot2_f32_bf16 v45, v142, v57, 0
    v_dot2_f32_bf16 v46, v141, v58, 0
    v_dot2_f32_bf16 v47, v143, v59, 0
    s_add_u32 s79, s79, 12
    s_cmp_ge_i32 s80, s79
    s_cbranch_scc1 L_kr5g
L_kr5:
    ds_read_b32 v19, v7
    s_sleep 1
    s_waitcnt lgkmcnt(0)
    v_readlane_b32 s80, v19, 5
    s_nop 0
    s_cmp_lt_i32 s80, s79
    s_cbranch_scc1 L_kr5
L_kr5g:
    ds_read_b32 v11, v3 offset:640
    ds_read_b128 v[24:27], v2 offset:12288
    ds_read_b128 v[28:31], v2 offset:12544
    ds_read_b128 v[32:35], v2 offset:12800
    v_add_u32 v6, 1, v6
    ds_write_b32 v5, v6
    s_waitcnt lgkmcnt(3)
    v_and_b32 v12, 0xffff0000, v11
    v_cvt_f32_i32 v24, v24
    v_cvt_f32_i32 v25, v25
    v_cvt_f32_i32 v26, v26
    v_cvt_f32_i32 v27, v27
    v_pk_add_f32 v[24:25], v[24:25], v[12:13] op_sel:[0,0] op_sel_hi:[1,0] neg_lo:[0,1] neg_hi:[0,1]
    v_pk_add_f32 v[26:27], v[26:27], v[12:13] op_sel:[0,0] op_sel_hi:[1,0] neg_lo:[0,1] neg_hi:[0,1]
    v_pk_mul_f32 v[16:17], v[24:25], v[36:37]
    v_pk_fma_f32 v[16:17], v[26:27], v[38:39], v[16:17]
    s_waitcnt lgkmcnt(2)
    v_cvt_f32_i32 v28, v28
    v_cvt_f32_i32 v29, v29
    v_cvt_f32_i32 v30, v30
    v_cvt_f32_i32 v31, v31
    v_pk_add_f32 v[28:29], v[28:29], v[12:13] op_sel:[0,0] op_sel_hi:[1,0] neg_lo:[0,1] neg_hi:[0,1]
    v_pk_add_f32 v[30:31], v[30:31], v[12:13] op_sel:[0,0] op_sel_hi:[1,0] neg_lo:[0,1] neg_hi:[0,1]
    v_pk_fma_f32 v[16:17], v[28:29], v[40:41], v[16:17]
    v_pk_fma_f32 v[16:17], v[30:31], v[42:43], v[16:17]
    s_waitcnt lgkmcnt(1)
    v_cvt_f32_i32 v32, v32
    v_cvt_f32_i32 v33, v33
    v_cvt_f32_i32 v34, v34
    v_cvt_f32_i32 v35, v35
    v_pk_add_f32 v[32:33], v[32:33], v[12:13] op_sel:[0,0] op_sel_hi:[1,0] neg_lo:[0,1] neg_hi:[0,1]
    v_pk_add_f32 v[34:35], v[34:35], v[12:13] op_sel:[0,0] op_sel_hi:[1,0] neg_lo:[0,1] neg_hi:[0,1]
    v_pk_fma_f32 v[16:17], v[32:33], v[44:45], v[16:17]
    v_pk_fma_f32 v[16:17], v[34:35], v[46:47], v[16:17]
    v_add_f32 v16, v16, v17
    v_cndmask_b32 v23, v10, v11, s[86:87]
    v_lshlrev_b32 v23, 16, v23
    v_add_f32_dpp v18, v16, v16 row_ror:8 row_mask:0xf bank_mask:0xc
    v_mul_f32 v23, 0x3dd53b95, v23
    s_nop 0
    v_add_f32_dpp v18, v18, v18 row_half_mirror row_mask:0xf bank_mask:0xf
    s_nop 1
    v_add_f32_dpp v18, v18, v18 quad_perm:[2,3,0,1] row_mask:0xf bank_mask:0xf
    s_nop 1
    v_add_f32_dpp v18, v18, v18 quad_perm:[1,0,3,2] row_mask:0xf bank_mask:0xf
    v_mul_f32 v18, v23, v18
    ds_write_b32 v4, v18 offset:512
    s_cmp_lg_u32 s81, 0
    s_cbranch_scc1 L_ncs6
    s_waitcnt vmcnt(6)
    v_perm_b32 v36, v146, v144, s83
    v_perm_b32 v146, v146, v144, s84
    v_perm_b32 v37, v147, v145, s83
    v_perm_b32 v147, v147, v145, s84
    v_perm_b32 v38, v150, v148, s83
    v_perm_b32 v150, v150, v148, s84
    v_perm_b32 v39, v151, v149, s83
    v_perm_b32 v151, v151, v149, s84
    v_perm_b32 v40, v154, v152, s83
    v_perm_b32 v154, v154, v152, s84
    v_perm_b32 v41, v155, v153, s83
    v_perm_b32 v155, v155, v153, s84
    v_mov_b64 v[144:145], v[36:37]
    v_mov_b64 v[148:149], v[38:39]
    v_mov_b64 v[152:153], v[40:41]
    s_nop 1
L_ncs6:
    v_dot2_f32_bf16 v36, v144, v48, 0
    v_dot2_f32_bf16 v37, v146, v49, 0
    v_dot2_f32_bf16 v38, v145, v50, 0
    v_dot2_f32_bf16 v39, v147, v51, 0
    v_dot2_f32_bf16 v40, v148, v52, 0
    v_dot2_f32_bf16 v41, v150, v53, 0
    v_dot2_f32_bf16 v42, v149, v54, 0
    v_dot2_f32_bf16 v43, v151, v55, 0
    v_dot2_f32_bf16 v44, v152, v56, 0
    v_dot2_f32_bf16 v45, v154, v57, 0
    v_dot2_f32_bf16 v46, v153, v58, 0
    v_dot2_f32_bf16 v47, v155, v59, 0
    s_add_u32 s79, s79, 12
    s_cmp_ge_i32 s80, s79
    s_cbranch_scc1 L_kr6g
L_kr6:
    ds_read_b32 v19, v7
    s_sleep 1
    s_waitcnt lgkmcnt(0)
    v_readlane_b32 s80, v19, 5
    s_nop 0
    s_cmp_lt_i32 s80, s79
    s_cbranch_scc1 L_kr6
L_kr6g:
    ds_read_b32 v10, v3 offset:768
    ds_read_b128 v[24:27], v2 offset:24576
    ds_read_b128 v[28:31], v2 offset:24832
    ds_read_b128 v[32:35], v2 offset:25088
    v_add_u32 v6, 1, v6
    ds_write_b32 v5, v6
    s_waitcnt lgkmcnt(3)
    v_and_b32 v12, 0xffff0000, v10
    v_cvt_f32_i32 v24, v24
    v_cvt_f32_i32 v25, v25
    v_cvt_f32_i32 v26, v26
    v_cvt_f32_i32 v27, v27
    v_pk_add_f32 v[24:25], v[24:25], v[12:13] op_sel:[0,0] op_sel_hi:[1,0] neg_lo:[0,1] neg_hi:[0,1]
    v_pk_add_f32 v[26:27], v[26:27], v[12:13] op_sel:[0,0] op_sel_hi:[1,0] neg_lo:[0,1] neg_hi:[0,1]
    v_pk_mul_f32 v[14:15], v[24:25], v[36:37]
    v_pk_fma_f32 v[14:15], v[26:27], v[38:39], v[14:15]
    s_waitcnt lgkmcnt(2)
    v_cvt_f32_i32 v28, v28
    v_cvt_f32_i32 v29, v29
    v_cvt_f32_i32 v30, v30
    v_cvt_f32_i32 v31, v31
    v_pk_add_f32 v[28:29], v[28:29], v[12:13] op_sel:[0,0] op_sel_hi:[1,0] neg_lo:[0,1] neg_hi:[0,1]
    v_pk_add_f32 v[30:31], v[30:31], v[12:13] op_sel:[0,0] op_sel_hi:[1,0] neg_lo:[0,1] neg_hi:[0,1]
    v_pk_fma_f32 v[14:15], v[28:29], v[40:41], v[14:15]
    v_pk_fma_f32 v[14:15], v[30:31], v[42:43], v[14:15]
    s_waitcnt lgkmcnt(1)
    v_cvt_f32_i32 v32, v32
    v_cvt_f32_i32 v33, v33
    v_cvt_f32_i32 v34, v34
    v_cvt_f32_i32 v35, v35
    v_pk_add_f32 v[32:33], v[32:33], v[12:13] op_sel:[0,0] op_sel_hi:[1,0] neg_lo:[0,1] neg_hi:[0,1]
    v_pk_add_f32 v[34:35], v[34:35], v[12:13] op_sel:[0,0] op_sel_hi:[1,0] neg_lo:[0,1] neg_hi:[0,1]
    v_pk_fma_f32 v[14:15], v[32:33], v[44:45], v[14:15]
    v_pk_fma_f32 v[14:15], v[34:35], v[46:47], v[14:15]
    v_add_f32 v14, v14, v15
    s_nop 1
    v_add_f32_dpp v18, v14, v14 row_ror:8 row_mask:0xf bank_mask:0x3
    s_cmp_lg_u32 s81, 0
    s_nop 0
    s_cbranch_scc1 L_ncs7
    s_waitcnt vmcnt(0)
    v_perm_b32 v36, v158, v156, s83
    v_perm_b32 v158, v158, v156, s84
    v_perm_b32 v37, v159, v157, s83
    v_perm_b32 v159, v159, v157, s84
    v_perm_b32 v38, v162, v160, s83
    v_perm_b32 v162, v162, v160, s84
    v_perm_b32 v39, v163, v161, s83
    v_perm_b32 v163, v163, v161, s84
    v_perm_b32 v40, v166, v164, s83
    v_perm_b32 v166, v166, v164, s84
    v_perm_b32 v41, v167, v165, s83
    v_perm_b32 v167, v167, v165, s84
    v_mov_b64 v[156:157], v[36:37]
    v_mov_b64 v[160:161], v[38:39]
    v_mov_b64 v[164:165], v[40:41]
    s_nop 1
L_ncs7:
    v_dot2_f32_bf16 v36, v156, v48, 0
    v_dot2_f32_bf16 v37, v158, v49, 0
    v_dot2_f32_bf16 v38, v157, v50, 0
    v_dot2_f32_bf16 v39, v159, v51, 0
    v_dot2_f32_bf16 v40, v160, v52, 0
    v_dot2_f32_bf16 v41, v162, v53, 0
    v_dot2_f32_bf16 v42, v161, v54, 0
    v_dot2_f32_bf16 v43, v163, v55, 0
    v_dot2_f32_bf16 v44, v164, v56, 0
    v_dot2_f32_bf16 v45, v166, v57, 0
    v_dot2_f32_bf16 v46, v165, v58, 0
    v_dot2_f32_bf16 v47, v167, v59, 0
    s_add_u32 s79, s79, 12
    s_cmp_ge_i32 s80, s79
    s_cbranch_scc1 L_kr7g
L_kr7:
    ds_read_b32 v19, v7
    s_sleep 1
    s_waitcnt lgkmcnt(0)
    v_readlane_b32 s80, v19, 5
    s_nop 0
    s_cmp_lt_i32 s80, s79
    s_cbranch_scc1 L_kr7
L_kr7g:
    ds_read_b32 v11, v3 offset:896
    ds_read_b128 v[24:27], v2 offset:36864
    ds_read_b128 v[28:31], v2 offset:37120
    ds_read_b128 v[32:35], v2 offset:37376
    v_add_u32 v6, 1, v6
    ds_write_b32 v5, v6
    s_waitcnt lgkmcnt(3)
    v_and_b32 v12, 0xffff0000, v11
    v_cvt_f32_i32 v24, v24
    v_cvt_f32_i32 v25, v25
    v_cvt_f32_i32 v26, v26
    v_cvt_f32_i32 v27, v27
    v_pk_add_f32 v[24:25], v[24:25], v[12:13] op_sel:[0,0] op_sel_hi:[1,0] neg_lo:[0,1] neg_hi:[0,1]
    v_pk_add_f32 v[26:27], v[26:27], v[12:13] op_sel:[0,0] op_sel_hi:[1,0] neg_lo:[0,1] neg_hi:[0,1]
    v_pk_mul_f32 v[16:17], v[24:25], v[36:37]
    v_pk_fma_f32 v[16:17], v[26:27], v[38:39], v[16:17]
    s_waitcnt lgkmcnt(2)
    v_cvt_f32_i32 v28, v28
    v_cvt_f32_i32 v29, v29
    v_cvt_f32_i32 v30, v30
    v_cvt_f32_i32 v31, v31
    v_pk_add_f32 v[28:29], v[28:29], v[12:13] op_sel:[0,0] op_sel_hi:[1,0] neg_lo:[0,1] neg_hi:[0,1]
    v_pk_add_f32 v[30:31], v[30:31], v[12:13] op_sel:[0,0] op_sel_hi:[1,0] neg_lo:[0,1] neg_hi:[0,1]
    v_pk_fma_f32 v[16:17], v[28:29], v[40:41], v[16:17]
    v_pk_fma_f32 v[16:17], v[30:31], v[42:43], v[16:17]
    s_waitcnt lgkmcnt(1)
    v_cvt_f32_i32 v32, v32
    v_cvt_f32_i32 v33, v33
    v_cvt_f32_i32 v34, v34
    v_cvt_f32_i32 v35, v35
    v_pk_add_f32 v[32:33], v[32:33], v[12:13] op_sel:[0,0] op_sel_hi:[1,0] neg_lo:[0,1] neg_hi:[0,1]
    v_pk_add_f32 v[34:35], v[34:35], v[12:13] op_sel:[0,0] op_sel_hi:[1,0] neg_lo:[0,1] neg_hi:[0,1]
    v_pk_fma_f32 v[16:17], v[32:33], v[44:45], v[16:17]
    v_pk_fma_f32 v[16:17], v[34:35], v[46:47], v[16:17]
    v_add_f32 v16, v16, v17
    v_cndmask_b32 v23, v10, v11, s[86:87]
    v_lshlrev_b32 v23, 16, v23
    v_add_f32_dpp v18, v16, v16 row_ror:8 row_mask:0xf bank_mask:0xc
    v_mul_f32 v23, 0x3dd53b95, v23
    s_nop 0
    v_add_f32_dpp v18, v18, v18 row_half_mirror row_mask:0xf bank_mask:0xf
    s_nop 1
    v_add_f32_dpp v18, v18, v18 quad_perm:[2,3,0,1] row_mask:0xf bank_mask:0xf
    s_nop 1
    v_add_f32_dpp v18, v18, v18 quad_perm:[1,0,3,2] row_mask:0xf bank_mask:0xf
    v_mul_f32 v18, v23, v18
    ds_write_b32 v4, v18 offset:768
    s_mov_b64 exec, 1
    ds_add_u32 v22, v8
    s_mov_b64 exec, -1
    v_add_u32 v3, 1024, v3
    v_add_u32 v4, 1024, v4
    s_add_u32 s81, s81, 1
    s_cmp_lt_u32 s81, 16
    s_cbranch_scc1 L_kph
    v_subrev_u32 v3, 1024, v3
    s_mul_i32 s92, s78, 768
    s_add_u32 s92, s92, 65536
    v_and_b32 v18, 15, v1
    v_lshl_add_u32 v9, v18, 4, s92
    v_lshrrev_b32 v18, 4, v1
    v_lshl_add_u32 v9, v18, 2, v9
    v_mov_b32 v22, 77920
    s_mov_b64 s[20:21], s[74:75]
    s_mov_b32 s22, 1610612736
    s_mov_b32 s23, 0x20000
    s_mov_b64 s[28:29], s[70:71]
    s_mov_b32 s30, 12288
    s_mov_b32 s31, 0x20000
    s_lshr_b32 s93, s2, 3
    s_mul_i32 s92, s93, 43
    s_lshr_b32 s92, s92, 8
    s_mul_i32 s94, s92, 6
    s_sub_u32 s93, s93, s94
    s_and_b32 s94, s2, 6
    s_lshl1_add_u32 s92, s94, s92
    s_and_b32 s94, s2, 1
    s_lshl1_add_u32 s92, s92, s94
    s_lshl2_add_u32 s94, s92, s78
    s_mul_i32 s32, s94, 24576
    s_lshl_b32 s94, s93, 7
    s_add_u32 s32, s32, s94
    s_add_u32 s33, s32, 6144
    s_add_u32 s34, s33, 6144
    s_add_u32 s35, s34, 6144
    s_mul_i32 s36, s92, 6
    s_add_u32 s36, s36, s93
    s_lshl_b32 s36, s36, 6
    s_lshr_b32 s37, s92, 1
    s_sub_u32 s37, s37, 1
    s_and_b32 s37, s37, 15
    s_add_u32 s37, s37, 2
    s_min_u32 s37, s37, 16
    v_lshrrev_b32 v19, 3, v1
    v_and_b32 v69, 7, v1
    v_mul_u32_u24 v68, 768, v19
    v_lshl_add_u32 v68, v69, 4, v68
    v_lshlrev_b32 v69, 3, v69
    v_lshl_add_u32 v69, v18, 1, v69
    s_lshl4_add_u32 s92, s78, 78336
    v_lshl_add_u32 v70, v19, 6, s92
    s_lshl_b32 s92, s78, 8
    s_add_u32 s92, s92, 1024
    v_add_u32 v4, s92, v7
    s_mov_b32 s81, 0
    s_nop 0
L_vph:
    v_mov_b64 v[72:73], 0
    v_mov_b64 v[74:75], 0
    v_mov_b64 v[76:77], 0
    v_mov_b64 v[78:79], 0
    v_mov_b64 v[80:81], 0
    v_mov_b64 v[82:83], 0
    s_and_b32 s92, s81, 3
    s_mul_i32 s92, s92, 3072
    v_add_u32 v71, s92, v9
    s_mov_b32 s88, 0
    s_nop 0
L_vw:
    ds_read_b32 v19, v7
    s_waitcnt lgkmcnt(0)
    v_readlane_b32 s92, v19, 15
    v_readlane_b32 s93, v19, 13
    s_nop 0
    s_and_b32 s93, s93, 16
    s_add_u32 s92, s92, 4
    s_min_u32 s93, s93, s92
    s_cmp_le_u32 s93, s81
    s_cbranch_scc1 L_vw
    s_cmp_lg_u32 s81, 15
    s_cbranch_scc1 L_vit
    v_readlane_b32 s4, v19, 6
    s_cmp_ge_u32 s2, 192
    s_nop 3
    s_cbranch_scc1 L_vit
    s_cmp_eq_u32 s4, 0
    s_cbranch_scc1 L_vw
    ds_read_b128 v[64:67], v70
    s_lshr_b32 s5, s4, 8
    s_lshr_b32 s6, s4, 16
    s_lshr_b32 s7, s4, 24
L_vit:
    s_add_u32 s79, s79, 12
    s_cmp_ge_i32 s80, s79
    s_cbranch_scc1 L_vr0g
L_vr0:
    ds_read_b32 v19, v7
    s_waitcnt lgkmcnt(0)
    v_readlane_b32 s80, v19, 5
    s_nop 0
    s_cmp_lt_i32 s80, s79
    s_cbranch_scc1 L_vr0
L_vr0g:
    ds_read_b32 v10, v3 offset:0
    ds_read_b128 v[24:27], v2 offset:0
    ds_read_b128 v[28:31], v2 offset:256
    ds_read_b128 v[32:35], v2 offset:512
    v_add_u32 v6, 1, v6
    ds_write_b32 v5, v6
    s_waitcnt lgkmcnt(3)
    v_cvt_f32_i32 v24, v24
    v_cvt_f32_i32 v25, v25
    v_cvt_f32_i32 v26, v26
    v_cvt_f32_i32 v27, v27
    v_pk_fma_f32 v[72:73], v[24:25], v[10:11], v[72:73] op_sel:[0,0,0] op_sel_hi:[1,0,1]
    v_pk_fma_f32 v[74:75], v[26:27], v[10:11], v[74:75] op_sel:[0,0,0] op_sel_hi:[1,0,1]
    s_waitcnt lgkmcnt(2)
    v_cvt_f32_i32 v28, v28
    v_cvt_f32_i32 v29, v29
    v_cvt_f32_i32 v30, v30
    v_cvt_f32_i32 v31, v31
    v_pk_fma_f32 v[76:77], v[28:29], v[10:11], v[76:77] op_sel:[0,0,0] op_sel_hi:[1,0,1]
    v_pk_fma_f32 v[78:79], v[30:31], v[10:11], v[78:79] op_sel:[0,0,0] op_sel_hi:[1,0,1]
    s_waitcnt lgkmcnt(1)
    v_cvt_f32_i32 v32, v32
    v_cvt_f32_i32 v33, v33
    v_cvt_f32_i32 v34, v34
    v_cvt_f32_i32 v35, v35
    v_pk_fma_f32 v[80:81], v[32:33], v[10:11], v[80:81] op_sel:[0,0,0] op_sel_hi:[1,0,1]
    v_pk_fma_f32 v[82:83], v[34:35], v[10:11], v[82:83] op_sel:[0,0,0] op_sel_hi:[1,0,1]
    s_add_u32 s79, s79, 12
    s_cmp_ge_i32 s80, s79
    s_cbranch_scc1 L_vr1g
L_vr1:
    ds_read_b32 v19, v7
    s_waitcnt lgkmcnt(0)
    v_readlane_b32 s80, v19, 5
    s_nop 0
    s_cmp_lt_i32 s80, s79
    s_cbranch_scc1 L_vr1
L_vr1g:
    ds_read_b32 v10, v3 offset:128
    ds_read_b128 v[24:27], v2 offset:12288
    ds_read_b128 v[28:31], v2 offset:12544
    ds_read_b128 v[32:35], v2 offset:12800
    v_add_u32 v6, 1, v6
    ds_write_b32 v5, v6
    s_waitcnt lgkmcnt(3)
    v_cvt_f32_i32 v24, v24
    v_cvt_f32_i32 v25, v25
    v_cvt_f32_i32 v26, v26
    v_cvt_f32_i32 v27, v27
    v_pk_fma_f32 v[72:73], v[24:25], v[10:11], v[72:73] op_sel:[0,0,0] op_sel_hi:[1,0,1]
    v_pk_fma_f32 v[74:75], v[26:27], v[10:11], v[74:75] op_sel:[0,0,0] op_sel_hi:[1,0,1]
    s_waitcnt lgkmcnt(2)
    v_cvt_f32_i32 v28, v28
    v_cvt_f32_i32 v29, v29
    v_cvt_f32_i32 v30, v30
    v_cvt_f32_i32 v31, v31
    v_pk_fma_f32 v[76:77], v[28:29], v[10:11], v[76:77] op_sel:[0,0,0] op_sel_hi:[1,0,1]
    v_pk_fma_f32 v[78:79], v[30:31], v[10:11], v[78:79] op_sel:[0,0,0] op_sel_hi:[1,0,1]
    s_waitcnt lgkmcnt(1)
    v_cvt_f32_i32 v32, v32
    v_cvt_f32_i32 v33, v33
    v_cvt_f32_i32 v34, v34
    v_cvt_f32_i32 v35, v35
    v_pk_fma_f32 v[80:81], v[32:33], v[10:11], v[80:81] op_sel:[0,0,0] op_sel_hi:[1,0,1]
    v_pk_fma_f32 v[82:83], v[34:35], v[10:11], v[82:83] op_sel:[0,0,0] op_sel_hi:[1,0,1]
    s_add_u32 s79, s79, 12
    s_cmp_ge_i32 s80, s79
    s_cbranch_scc1 L_vr2g
L_vr2:
    ds_read_b32 v19, v7
    s_waitcnt lgkmcnt(0)
    v_readlane_b32 s80, v19, 5
    s_nop 0
    s_cmp_lt_i32 s80, s79
    s_cbranch_scc1 L_vr2
L_vr2g:
    ds_read_b32 v10, v3 offset:256
    ds_read_b128 v[24:27], v2 offset:24576
    ds_read_b128 v[28:31], v2 offset:24832
    ds_read_b128 v[32:35], v2 offset:25088
    v_add_u32 v6, 1, v6
    ds_write_b32 v5, v6
    s_waitcnt lgkmcnt(3)
    v_cvt_f32_i32 v24, v24
    v_cvt_f32_i32 v25, v25
    v_cvt_f32_i32 v26, v26
    v_cvt_f32_i32 v27, v27
    v_pk_fma_f32 v[72:73], v[24:25], v[10:11], v[72:73] op_sel:[0,0,0] op_sel_hi:[1,0,1]
    v_pk_fma_f32 v[74:75], v[26:27], v[10:11], v[74:75] op_sel:[0,0,0] op_sel_hi:[1,0,1]
    s_waitcnt lgkmcnt(2)
    v_cvt_f32_i32 v28, v28
    v_cvt_f32_i32 v29, v29
    v_cvt_f32_i32 v30, v30
    v_cvt_f32_i32 v31, v31
    v_pk_fma_f32 v[76:77], v[28:29], v[10:11], v[76:77] op_sel:[0,0,0] op_sel_hi:[1,0,1]
    v_pk_fma_f32 v[78:79], v[30:31], v[10:11], v[78:79] op_sel:[0,0,0] op_sel_hi:[1,0,1]
    s_waitcnt lgkmcnt(1)
    v_cvt_f32_i32 v32, v32
    v_cvt_f32_i32 v33, v33
    v_cvt_f32_i32 v34, v34
    v_cvt_f32_i32 v35, v35
    v_pk_fma_f32 v[80:81], v[32:33], v[10:11], v[80:81] op_sel:[0,0,0] op_sel_hi:[1,0,1]
    v_pk_fma_f32 v[82:83], v[34:35], v[10:11], v[82:83] op_sel:[0,0,0] op_sel_hi:[1,0,1]
    s_add_u32 s79, s79, 12
    s_cmp_ge_i32 s80, s79
    s_cbranch_scc1 L_vr3g
L_vr3:
    ds_read_b32 v19, v7
    s_waitcnt lgkmcnt(0)
    v_readlane_b32 s80, v19, 5
    s_nop 0
    s_cmp_lt_i32 s80, s79
    s_cbranch_scc1 L_vr3
L_vr3g:
    ds_read_b32 v10, v3 offset:384
    ds_read_b128 v[24:27], v2 offset:36864
    ds_read_b128 v[28:31], v2 offset:37120
    ds_read_b128 v[32:35], v2 offset:37376
    v_add_u32 v6, 1, v6
    ds_write_b32 v5, v6
    v_add_u32 v3, 512, v3
    s_add_u32 s88, s88, 1
    s_cmp_lt_u32 s88, 2
    s_waitcnt lgkmcnt(3)
    v_cvt_f32_i32 v24, v24
    v_cvt_f32_i32 v25, v25
    v_cvt_f32_i32 v26, v26
    v_cvt_f32_i32 v27, v27
    v_pk_fma_f32 v[72:73], v[24:25], v[10:11], v[72:73] op_sel:[0,0,0] op_sel_hi:[1,0,1]
    v_pk_fma_f32 v[74:75], v[26:27], v[10:11], v[74:75] op_sel:[0,0,0] op_sel_hi:[1,0,1]
    s_waitcnt lgkmcnt(2)
    v_cvt_f32_i32 v28, v28
    v_cvt_f32_i32 v29, v29
    v_cvt_f32_i32 v30, v30
    v_cvt_f32_i32 v31, v31
    v_pk_fma_f32 v[76:77], v[28:29], v[10:11], v[76:77] op_sel:[0,0,0] op_sel_hi:[1,0,1]
    v_pk_fma_f32 v[78:79], v[30:31], v[10:11], v[78:79] op_sel:[0,0,0] op_sel_hi:[1,0,1]
    s_waitcnt lgkmcnt(1)
    v_cvt_f32_i32 v32, v32
    v_cvt_f32_i32 v33, v33
    v_cvt_f32_i32 v34, v34
    v_cvt_f32_i32 v35, v35
    v_pk_fma_f32 v[80:81], v[32:33], v[10:11], v[80:81] op_sel:[0,0,0] op_sel_hi:[1,0,1]
    v_pk_fma_f32 v[82:83], v[34:35], v[10:11], v[82:83] op_sel:[0,0,0] op_sel_hi:[1,0,1]
    s_cbranch_scc1 L_vit
    v_permlane32_swap_b32 v72, v74
    v_permlane32_swap_b32 v73, v75
    v_permlane32_swap_b32 v76, v78
    v_permlane32_swap_b32 v77, v79
    v_permlane32_swap_b32 v80, v82
    v_permlane32_swap_b32 v81, v83
    v_pk_add_f32 v[72:73], v[72:73], v[74:75]
    v_pk_add_f32 v[76:77], v[76:77], v[78:79]
    v_pk_add_f32 v[80:81], v[80:81], v[82:83]
    v_permlane16_swap_b32 v72, v73
    v_permlane16_swap_b32 v76, v77
    v_permlane16_swap_b32 v80, v81
    v_add_f32 v36, v72, v73
    v_add_f32 v37, v76, v77
    v_add_f32 v38, v80, v81
    ds_write2st64_b32 v71, v36, v37 offset0:0 offset1:1
    ds_write_b32 v71, v38 offset:512
    s_mov_b64 exec, 1
    ds_add_u32 v22, v8
    s_mov_b64 exec, -1
    v_add_u32 v22, 4, v22
    v_subrev_u32 v3, 2048, v3
    s_add_u32 s81, s81, 1
    s_cmp_lt_u32 s81, 16
    s_cbranch_scc1 L_vph
    s_cmp_ge_u32 s2, 192
    s_cbranch_scc1 L_cend
L_gw:
    ds_read_b32 v19, v7
    s_waitcnt lgkmcnt(0)
    v_readlane_b32 s92, v19, 8
    s_nop 0
    s_cmp_lt_u32 s92, s37
    s_nop 2
    s_cbranch_scc1 L_gw
L_try:
    buffer_load_dwordx4 v[48:51], v68, s[20:23], s32 offen sc0 sc1
    buffer_load_dwordx4 v[52:55], v68, s[20:23], s33 offen sc0 sc1
    buffer_load_dwordx4 v[56:59], v68, s[20:23], s34 offen sc0 sc1
    buffer_load_dwordx4 v[60:63], v68, s[20:23], s35 offen sc0 sc1
    s_waitcnt vmcnt(3)
    v_xor_b32 v23, s4, v48
    v_bitop3_b32 v23, v23, v49, s5 bitop3:0xf6
    v_pk_mul_f32 v[14:15], v[48:49], v[64:65] op_sel:[0,0] op_sel_hi:[1,0]
    v_bitop3_b32 v23, v23, v50, s6 bitop3:0xf6
    v_bitop3_b32 v23, v23, v51, s7 bitop3:0xf6
    v_pk_mul_f32 v[16:17], v[50:51], v[64:65] op_sel:[0,0] op_sel_hi:[1,0]
    s_waitcnt vmcnt(2)
    v_bitop3_b32 v23, v23, v52, s4 bitop3:0xf6
    v_bitop3_b32 v23, v23, v53, s5 bitop3:0xf6
    v_pk_fma_f32 v[14:15], v[52:53], v[64:65], v[14:15] op_sel:[0,1,0] op_sel_hi:[1,1,1]
    v_bitop3_b32 v23, v23, v54, s6 bitop3:0xf6
    v_bitop3_b32 v23, v23, v55, s7 bitop3:0xf6
    v_pk_fma_f32 v[16:17], v[54:55], v[64:65], v[16:17] op_sel:[0,1,0] op_sel_hi:[1,1,1]
    s_waitcnt vmcnt(1)
    v_bitop3_b32 v23, v23, v56, s4 bitop3:0xf6
    v_bitop3_b32 v23, v23, v57, s5 bitop3:0xf6
    v_pk_fma_f32 v[14:15], v[56:57], v[66:67], v[14:15] op_sel:[0,0,0] op_sel_hi:[1,0,1]
    v_bitop3_b32 v23, v23, v58, s6 bitop3:0xf6
    v_bitop3_b32 v23, v23, v59, s7 bitop3:0xf6
    v_pk_fma_f32 v[16:17], v[58:59], v[66:67], v[16:17] op_sel:[0,0,0] op_sel_hi:[1,0,1]
    s_waitcnt vmcnt(0)
    v_bitop3_b32 v23, v23, v60, s4 bitop3:0xf6
    v_bitop3_b32 v23, v23, v61, s5 bitop3:0xf6
    v_pk_fma_f32 v[14:15], v[60:61], v[66:67], v[14:15] op_sel:[0,1,0] op_sel_hi:[1,1,1]
    v_bitop3_b32 v23, v23, v62, s6 bitop3:0xf6
    v_bitop3_b32 v23, v23, v63, s7 bitop3:0xf6
    v_pk_fma_f32 v[16:17], v[62:63], v[66:67], v[16:17] op_sel:[0,1,0] op_sel_hi:[1,1,1]
    v_and_b32 v23, 0xff, v23
    v_cmp_ne_u32 vcc, 0, v23
    s_nop 4
    s_cbranch_vccz L_cok
    s_mov_b64 exec, vcc
    s_sleep 1
    s_add_u32 s88, s88, 1
    s_cmp_lt_u32 s88, 400000
    s_cbranch_scc1 L_try
L_cok:
    s_mov_b64 exec, -1
    v_permlane32_swap_b32 v14, v16
    v_permlane32_swap_b32 v15, v17
    v_pk_add_f32 v[14:15], v[14:15], v[16:17]
    s_nop 1
    v_permlane16_swap_b32 v14, v15
    v_add_f32 v14, v14, v15
    ds_write_b32 v4, v14
    s_mov_b64 exec, 1
    ds_add_rtn_u32 v18, v7, v8 offset:28
    s_mov_b64 exec, -1
    ds_read2st64_b32 v[14:15], v7 offset0:4 offset1:5
    ds_read2st64_b32 v[16:17], v7 offset0:6 offset1:7
    s_waitcnt lgkmcnt(0)
    v_readfirstlane_b32 s92, v18
    v_pk_add_f32 v[14:15], v[14:15], v[16:17]
    v_add_f32 v14, v14, v15
    s_cmp_lg_u32 s92, 3
    s_nop 1
    s_cbranch_scc1 L_cend
    v_add_f32_dpp v14, v14, v14 row_ror:8 row_mask:0xf bank_mask:0xf
    s_mov_b32 exec_lo, 0x00ff00ff
    s_mov_b32 exec_hi, 0x00ff00ff
    v_cvt_pk_bf16_f32 v14, v14, v14
    buffer_store_short v14, v69, s[28:31], s36 offen
    s_nop 0
L_cend:
    s_waitcnt lgkmcnt(0)
    s_endpgm
L_helper:
    s_memrealtime s[96:97]
    v_bfe_u32 v22, v1, 2, 3
    v_lshl_add_u32 v22, v22, 11, s77
    v_and_b32 v22, 16383, v22
    v_lshrrev_b32 v19, 5, v1
    v_lshl_add_u32 v22, v19, 15, v22
    v_and_b32 v19, 3, v1
    v_lshlrev_b32 v19, 3, v19
    v_lshl_add_u32 v22, v22, 1, v19
    s_lshl_b32 s91, s3, 15
    v_lshlrev_b32 v2, 4, v1
    s_mov_b32 s6, 1048576
    s_mov_b32 s7, 0x20000
    s_mov_b32 s10, 1048576
    s_mov_b32 s11, 0x20000
    s_mov_b32 s14, 1048576
    s_mov_b32 s15, 0x20000
    s_mov_b32 s18, 1048576
    s_mov_b32 s19, 0x20000
    s_waitcnt lgkmcnt(0)
    s_mov_b64 s[4:5], s[52:53]
    s_mov_b64 s[8:9], s[54:55]
    s_mov_b64 s[12:13], s[58:59]
    s_mov_b64 s[16:17], s[60:61]
    buffer_load_dwordx2 v[108:109], v22, s[4:7], s91 offen
    buffer_load_dwordx2 v[110:111], v22, s[8:11], s91 offen
    buffer_load_dwordx2 v[112:113], v22, s[12:15], s91 offen
    buffer_load_dwordx2 v[114:115], v22, s[16:19], s91 offen
    s_add_u32 s91, s91, 131072
    s_barrier
    v_lshrrev_b32 v18, 1, v1
    v_lshlrev_b32 v18, 10, v18
    v_and_b32 v19, 1, v1
    v_lshl_add_u32 v18, v19, 6, v18
    s_lshr_b32 s92, s2, 3
    s_lshl_b32 s92, s92, 15
    s_and_b32 s93, s2, 7
    s_lshl_b32 s93, s93, 7
    s_add_u32 s92, s92, s93
    buffer_load_dword v6, v18, s[4:7], s92 offen
    buffer_load_dword v6, v18, s[8:11], s92 offen
    buffer_load_dword v6, v18, s[12:15], s92 offen
    buffer_load_dword v6, v18, s[16:19], s92 offen
    s_mov_b64 s[20:21], s[74:75]
    s_mov_b32 s22, 1610612736
    s_mov_b32 s23, 0x20000
    s_mov_b64 s[24:25], s[72:73]
    s_mov_b32 s26, 256
    s_mov_b32 s27, 0x20000
    s_mov_b64 s[32:33], s[48:49]
    s_mov_b32 s34, 12288
    s_mov_b32 s35, 0x20000
    s_mov_b64 s[36:37], s[62:63]
    s_mov_b32 s38, 384
    s_mov_b32 s39, 0x20000
    s_mov_b64 s[40:41], s[64:65]
    s_mov_b32 s42, 384
    s_mov_b32 s43, 0x20000
    v_lshlrev_b32 v44, 3, v1
    v_cmp_gt_u32 vcc, 24, v1
    v_mov_b32 v23, 0xffffff40
    v_mov_b32 v18, 192
    v_cndmask_b32 v23, v23, v18, vcc
    v_add_u32 v45, v44, v23
    v_mov_b32 v18, 0x80008000
    v_cndmask_b32 v46, 0, v18, vcc
    s_mov_b32 s78, s96
    s_mov_b32 s94, 0x05040100
    s_mov_b32 s95, 0x07060302
    v_lshlrev_b32 v9, 1, v2
    v_add_u32 v9, 49152, v9
    v_mov_b32 v3, 77824
    v_mov_b32 v4, 0
    v_mov_b32 v5, 0xff
    v_mov_b32 v12, v9
    buffer_load_dwordx2 v[40:41], v44, s[36:39], 0 offen
    buffer_load_dwordx2 v[42:43], v44, s[40:43], 0 offen
    s_mul_i32 s92, s3, 384
    s_add_u32 s92, s92, 6144
    buffer_load_dwordx2 v[136:137], v44, s[32:35], s92 offen
    buffer_load_dwordx2 v[138:139], v45, s[32:35], s92 offen
    buffer_load_dwordx2 v[140:141], v44, s[32:35], s92 offen offset:768
    buffer_load_dwordx2 v[142:143], v45, s[32:35], s92 offen offset:768
    s_add_u32 s92, s92, 1536
    buffer_load_dwordx2 v[144:145], v44, s[32:35], s92 offen
    buffer_load_dwordx2 v[146:147], v45, s[32:35], s92 offen
    buffer_load_dwordx2 v[148:149], v44, s[32:35], s92 offen offset:768
    buffer_load_dwordx2 v[150:151], v45, s[32:35], s92 offen offset:768
    s_add_u32 s92, s92, 1536
    buffer_load_dwordx2 v[152:153], v44, s[32:35], s92 offen
    buffer_load_dwordx2 v[154:155], v45, s[32:35], s92 offen
    buffer_load_dwordx2 v[156:157], v44, s[32:35], s92 offen offset:768
    buffer_load_dwordx2 v[158:159], v45, s[32:35], s92 offen offset:768
    s_add_u32 s92, s92, 1536
    buffer_load_dwordx2 v[160:161], v44, s[32:35], s92 offen
    buffer_load_dwordx2 v[162:163], v45, s[32:35], s92 offen
    buffer_load_dwordx2 v[164:165], v44, s[32:35], s92 offen offset:768
    buffer_load_dwordx2 v[166:167], v45, s[32:35], s92 offen offset:768
    s_waitcnt vmcnt(22)
    v_perm_b32 v116, v110, v108, s94
    v_perm_b32 v117, v114, v112, s94
    v_perm_b32 v118, v110, v108, s95
    v_perm_b32 v119, v114, v112, s95
    v_perm_b32 v120, v111, v109, s94
    v_perm_b32 v121, v115, v113, s94
    v_perm_b32 v122, v111, v109, s95
    v_perm_b32 v123, v115, v113, s95
    s_lshr_b32 s92, s91, 17
    v_mov_b32 v19, s92
    ds_write_b128 v12, v[116:119]
    ds_write_b128 v12, v[120:123] offset:16
    ds_write_b32 v3, v19 offset:48
    v_add_u32 v12, 2048, v12
    s_mov_b32 s48, 0
    s_cmp_lg_u32 s2, 0
    s_cbranch_scc1 L_ne0
    s_mul_i32 s49, s78, 0x9e3779b1
    s_lshr_b32 s93, s49, 15
    s_xor_b32 s49, s49, s93
    s_mul_i32 s49, s49, 0x85ebca6b
    s_lshr_b32 s93, s49, 13
    s_xor_b32 s49, s49, s93
    s_max_u32 s49, s49, 1
    v_mov_b32 v14, s49
    v_mov_b32 v15, 0
    s_mov_b64 exec, 1
    buffer_atomic_cmpswap v[14:15], v4, s[24:27], 0 offen sc0 sc1
    s_waitcnt vmcnt(0)
    v_readfirstlane_b32 s48, v14
    s_mov_b64 exec, -1
    s_cmp_eq_u32 s48, 0
    s_cselect_b32 s48, s49, s48
    s_nop 1
L_ne0:
    s_getpc_b64 s[92:93]
L_pc:
    s_sub_u32 s92, s92, L_pc-standalone__kv_cache_quant_pre_rope_vs_post_rope__decode_kernel
    s_subb_u32 s93, s93, 0
    s_lshr_b32 s94, s2, 3
    v_lshl_add_u32 v19, v1, 5, s94
    v_lshlrev_b32 v19, 7, v19
    v_min_u32 v19, L_end-standalone__kv_cache_quant_pre_rope_vs_post_rope__decode_kernel, v19
    s_mov_b64 exec, 63
    global_load_dword v6, v19, s[92:93]
    s_mov_b64 exec, -1
    v_lshlrev_b32 v18, 1, v44
    v_lshlrev_b32 v19, 1, v45
    v_add_u32 v18, 71680, v18
    v_add_u32 v19, 71680, v19
    v_mov_b32 v23, 78000
    s_mov_b32 s89, 0
    s_waitcnt vmcnt(1) lgkmcnt(0)
    v_xor_b32 v42, v42, v46
    v_xor_b32 v43, v43, v46
    v_lshlrev_b32 v48, 16, v40
    v_and_b32 v49, 0xffff0000, v40
    v_lshlrev_b32 v50, 16, v41
    v_and_b32 v51, 0xffff0000, v41
    v_lshlrev_b32 v52, 16, v42
    v_and_b32 v53, 0xffff0000, v42
    v_lshlrev_b32 v54, 16, v43
    v_and_b32 v55, 0xffff0000, v43
    v_and_b32 v46, 0x80000000, v46
    s_nop 1
L_hq:
    v_mov_b64 v[24:25], v[136:137]
    v_mov_b64 v[26:27], v[138:139]
    v_mov_b64 v[28:29], v[140:141]
    v_mov_b64 v[30:31], v[142:143]
    v_mov_b64 v[136:137], v[144:145]
    v_mov_b64 v[138:139], v[146:147]
    v_mov_b64 v[140:141], v[148:149]
    v_mov_b64 v[142:143], v[150:151]
    v_mov_b64 v[144:145], v[152:153]
    v_mov_b64 v[146:147], v[154:155]
    v_mov_b64 v[148:149], v[156:157]
    v_mov_b64 v[150:151], v[158:159]
    v_mov_b64 v[152:153], v[160:161]
    v_mov_b64 v[154:155], v[162:163]
    v_mov_b64 v[156:157], v[164:165]
    v_mov_b64 v[158:159], v[166:167]
    s_mov_b32 exec_hi, 0xffff
    v_lshlrev_b32 v56, 16, v24
    v_and_b32 v57, 0xffff0000, v24
    v_lshlrev_b32 v58, 16, v25
    v_and_b32 v59, 0xffff0000, v25
    v_lshlrev_b32 v60, 16, v26
    v_and_b32 v61, 0xffff0000, v26
    v_lshlrev_b32 v62, 16, v27
    v_and_b32 v63, 0xffff0000, v27
    v_pk_mul_f32 v[56:57], v[56:57], v[48:49]
    v_pk_mul_f32 v[60:61], v[60:61], v[52:53]
    v_pk_mul_f32 v[58:59], v[58:59], v[50:51]
    v_pk_mul_f32 v[62:63], v[62:63], v[54:55]
    v_cvt_pk_bf16_f32 v56, v56, v60
    v_cvt_pk_bf16_f32 v57, v57, v61
    v_cvt_pk_bf16_f32 v58, v58, v62
    v_cvt_pk_bf16_f32 v59, v59, v63
    v_and_b32 v60, 0xffff0000, v56
    v_lshlrev_b32 v56, 16, v56
    v_and_b32 v61, 0xffff0000, v57
    v_lshlrev_b32 v57, 16, v57
    v_and_b32 v62, 0xffff0000, v58
    v_lshlrev_b32 v58, 16, v58
    v_and_b32 v63, 0xffff0000, v59
    v_lshlrev_b32 v59, 16, v59
    v_pk_add_f32 v[56:57], v[56:57], v[60:61]
    v_pk_add_f32 v[58:59], v[58:59], v[62:63]
    v_cvt_pk_bf16_f32 v64, v56, v56
    v_cvt_pk_bf16_f32 v65, v57, v57
    v_cvt_pk_bf16_f32 v66, v58, v58
    v_cvt_pk_bf16_f32 v67, v59, v59
    v_xor_b32 v64, v64, v46
    v_xor_b32 v65, v65, v46
    v_xor_b32 v66, v66, v46
    v_xor_b32 v67, v67, v46
    ds_write_b16 v18, v64 offset:0
    ds_write_b16_d16_hi v19, v64 offset:2
    ds_write_b16 v18, v65 offset:4
    ds_write_b16_d16_hi v19, v65 offset:6
    ds_write_b16 v18, v66 offset:8
    ds_write_b16_d16_hi v19, v66 offset:10
    ds_write_b16 v18, v67 offset:12
    ds_write_b16_d16_hi v19, v67 offset:14
    v_lshlrev_b32 v56, 16, v28
    v_and_b32 v57, 0xffff0000, v28
    v_lshlrev_b32 v58, 16, v29
    v_and_b32 v59, 0xffff0000, v29
    v_lshlrev_b32 v60, 16, v30
    v_and_b32 v61, 0xffff0000, v30
    v_lshlrev_b32 v62, 16, v31
    v_and_b32 v63, 0xffff0000, v31
    v_pk_mul_f32 v[56:57], v[56:57], v[48:49]
    v_pk_mul_f32 v[60:61], v[60:61], v[52:53]
    v_pk_mul_f32 v[58:59], v[58:59], v[50:51]
    v_pk_mul_f32 v[62:63], v[62:63], v[54:55]
    v_cvt_pk_bf16_f32 v56, v56, v60
    v_cvt_pk_bf16_f32 v57, v57, v61
    v_cvt_pk_bf16_f32 v58, v58, v62
    v_cvt_pk_bf16_f32 v59, v59, v63
    v_and_b32 v60, 0xffff0000, v56
    v_lshlrev_b32 v56, 16, v56
    v_and_b32 v61, 0xffff0000, v57
    v_lshlrev_b32 v57, 16, v57
    v_and_b32 v62, 0xffff0000, v58
    v_lshlrev_b32 v58, 16, v58
    v_and_b32 v63, 0xffff0000, v59
    v_lshlrev_b32 v59, 16, v59
    v_pk_add_f32 v[56:57], v[56:57], v[60:61]
    v_pk_add_f32 v[58:59], v[58:59], v[62:63]
    v_cvt_pk_bf16_f32 v68, v56, v56
    v_cvt_pk_bf16_f32 v69, v57, v57
    v_cvt_pk_bf16_f32 v70, v58, v58
    v_cvt_pk_bf16_f32 v71, v59, v59
    v_xor_b32 v68, v68, v46
    v_xor_b32 v69, v69, v46
    v_xor_b32 v70, v70, v46
    v_xor_b32 v71, v71, v46
    ds_write_b16 v18, v68 offset:768
    ds_write_b16_d16_hi v19, v68 offset:770
    ds_write_b16 v18, v69 offset:772
    ds_write_b16_d16_hi v19, v69 offset:774
    ds_write_b16 v18, v70 offset:776
    ds_write_b16_d16_hi v19, v70 offset:778
    ds_write_b16 v18, v71 offset:780
    ds_write_b16_d16_hi v19, v71 offset:782
    s_mov_b32 exec_hi, -1
    ds_write_b32 v23, v5
    s_add_u32 s89, s89, 1
    v_add_u32 v18, 1536, v18
    v_add_u32 v19, 1536, v19
    v_add_u32 v23, 4, v23
    s_cmp_lt_u32 s89, 4
    s_waitcnt lgkmcnt(0)
    s_cbranch_scc1 L_hq
    s_cmp_lg_u32 s48, 0
    s_cbranch_scc1 L_epd
L_epw:
    s_sleep 1
    ds_read_b32 v19, v7
    s_waitcnt lgkmcnt(0)
    v_readlane_b32 s89, v19, 5
    s_nop 0
    s_cmp_lt_i32 s89, 72
    s_nop 2
    s_cbranch_scc1 L_epw
    s_buffer_load_dword s48, s[24:27], 0
    s_waitcnt lgkmcnt(0)
    s_cmp_lg_u32 s48, 0
    s_cbranch_scc1 L_epd
    s_mul_i32 s49, s78, 0x9e3779b1
    s_lshr_b32 s93, s49, 15
    s_xor_b32 s49, s49, s93
    s_mul_i32 s49, s49, 0x85ebca6b
    s_lshr_b32 s93, s49, 13
    s_xor_b32 s49, s49, s93
    s_max_u32 s49, s49, 1
    v_mov_b32 v14, s49
    v_mov_b32 v15, 0
    s_mov_b64 exec, 1
    buffer_atomic_cmpswap v[14:15], v4, s[24:27], 0 offen sc0 sc1
    s_waitcnt vmcnt(0)
    v_readfirstlane_b32 s48, v14
    s_mov_b64 exec, -1
    s_cmp_eq_u32 s48, 0
    s_cselect_b32 s48, s49, s48
    s_nop 1
L_epd:
    s_waitcnt vmcnt(0)
    s_lshr_b32 s49, s48, 8
    s_lshr_b32 s50, s48, 16
    s_lshr_b32 s51, s48, 24
    s_mov_b32 s79, 0
    s_mov_b32 s80, 0
    s_mov_b32 s85, 0
    s_mov_b32 s84, 0
    s_mov_b32 s83, 0
    s_mov_b32 s98, 0
    s_mov_b32 s99, 0
    s_mov_b32 s33, 0
    s_movk_i32 s81, 240
    s_mov_b32 s82, 0x7fffffff
    s_movk_i32 s70, 850
    s_movk_i32 s71, 850
    s_movk_i32 s68, 132
    s_mov_b32 s69, 0
    s_mov_b32 s86, 16
    s_lshr_b32 s92, s2, 4
    s_and_b32 s93, s2, 15
    s_cmp_eq_u32 s92, s93
    s_cselect_b32 s38, s92, 255
    s_mul_i32 s87, s38, 4352
    s_add_u32 s87, s87, 33554432
    s_mov_b32 s88, 33554432
    v_lshrrev_b32 v18, 5, v1
    v_lshlrev_b32 v11, 4, v18
    v_add_u32 v11, 78080, v11
    v_add_u32 v10, 65536, v2
    v_mov_b32 v20, 78320
    s_mov_b32 s39, 8
    s_and_b32 s41, s2, 0x70
    s_and_b32 s92, s2, 7
    s_lshl1_add_u32 s41, s92, s41
    s_lshr_b32 s92, s2, 7
    s_add_u32 s41, s41, s92
    s_lshl_b32 s92, s3, 7
    s_add_u32 s41, s41, s92
    s_lshr_b32 s92, s2, 3
    s_mul_i32 s34, s92, 43
    s_lshr_b32 s34, s34, 8
    s_mul_i32 s93, s34, 6
    s_sub_u32 s92, s92, s93
    s_and_b32 s93, s2, 6
    s_lshl1_add_u32 s34, s93, s34
    s_and_b32 s93, s2, 1
    s_lshl1_add_u32 s34, s34, s93
    s_lshr_b32 s40, s2, 3
    s_and_b32 s40, s40, 31
    s_mul_i32 s40, s40, 24
    s_addk_i32 s40, 1728
    s_cmp_lt_u32 s2, 192
    s_cselect_b32 s40, s40, 0x7fffffff
    s_mov_b32 s35, 0
    s_mov_b32 s36, 21495808
    s_mov_b32 s37, 0
L_hl:
    s_sleep 1
    ds_read_b32 v19, v7
    s_memrealtime s[96:97]
    s_waitcnt lgkmcnt(0)
    v_readlane_b32 s89, v19, 5
    v_readlane_b32 s90, v19, s86
    s_sub_u32 s96, s96, s78
    s_lshl_b32 s96, s96, 8
    s_mul_i32 s92, s80, s89
    s_add_u32 s92, s92, s79
    s_sub_u32 s92, s96, s92
    s_max_i32 s92, s92, s98
    s_min_i32 s92, s92, s99
    s_mul_i32 s92, s92, s35
    s_add_u32 s92, s92, s36
    s_ashr_i32 s92, s92, 20
    s_max_i32 s92, s92, 15
    s_min_i32 s92, s92, 26
    v_mov_b32 v18, s92
    ds_write_b32 v3, v18 offset:16
    s_cmp_ge_i32 s89, s82
    s_cbranch_scc1 L_rd
    s_cmp_ge_i32 s89, s81
    s_cbranch_scc1 L_pub
    s_cmp_ge_i32 s89, s68
    s_cbranch_scc1 L_tf
    s_cmp_eq_u32 s90, s39
    s_cbranch_scc1 L_prep
    s_cmp_ge_i32 s89, s40
    s_cbranch_scc1 L_wts
    s_cmp_eq_u32 s86, 14
    s_cbranch_scc0 L_hl
    s_branch L_late
L_tf:
    buffer_load_dwordx2 v[108:109], v22, s[4:7], s91 offen
    buffer_load_dwordx2 v[110:111], v22, s[8:11], s91 offen
    buffer_load_dwordx2 v[112:113], v22, s[12:15], s91 offen
    buffer_load_dwordx2 v[114:115], v22, s[16:19], s91 offen
    s_add_u32 s91, s91, 131072
    s_mov_b32 s94, 0x05040100
    s_mov_b32 s95, 0x07060302
    s_addk_i32 s68, 24
    s_cmp_ge_u32 s91, 1048576
    s_cselect_b32 s68, 0x7fffffff, s68
    s_waitcnt vmcnt(0)
    v_perm_b32 v116, v110, v108, s94
    v_perm_b32 v117, v114, v112, s94
    v_perm_b32 v118, v110, v108, s95
    v_perm_b32 v119, v114, v112, s95
    v_perm_b32 v120, v111, v109, s94
    v_perm_b32 v121, v115, v113, s94
    v_perm_b32 v122, v111, v109, s95
    v_perm_b32 v123, v115, v113, s95
    s_lshr_b32 s92, s91, 17
    v_mov_b32 v19, s92
    ds_write_b128 v12, v[116:119]
    ds_write_b128 v12, v[120:123] offset:16
    ds_write_b32 v3, v19 offset:48
    v_add_u32 v12, 2048, v12
    s_waitcnt lgkmcnt(0)
    s_nop 0
    s_branch L_hl
L_pub:
    s_cmp_eq_u32 s80, 0
    s_cselect_b32 s92, 850, s80
    s_sub_u32 s93, s89, s81
    s_mul_i32 s92, s92, s93
    s_sub_u32 s83, s96, s92
    s_add_u32 s82, s81, 72
    s_cmp_ge_u32 s81, 2544
    s_cselect_b32 s92, 4, 8
    s_mul_i32 s92, s92, 24
    s_add_u32 s81, s81, s92
    s_cmp_ge_u32 s38, 16
    s_cbranch_scc1 L_hl
    s_lshl_b32 s92, s78, 8
    s_add_u32 s92, s92, s83
    v_mov_b32 v14, s92
    v_mov_b32 v15, s48
    s_mov_b64 exec, 1
    buffer_store_dwordx2 v[14:15], v4, s[20:23], s87 offen sc0 sc1
    s_mov_b64 exec, -1
    s_add_u32 s87, s87, 69632
    s_branch L_hl
L_rd:
    s_lshl_b32 s92, s78, 8
    s_add_u32 s92, s92, s83
    s_mov_b32 s93, 0
    s_mov_b32 s94, 0
    s_buffer_load_dwordx2 s[52:53], s[20:23], s88
    s_add_u32 s88, s88, 4352
    s_buffer_load_dwordx2 s[54:55], s[20:23], s88
    s_add_u32 s88, s88, 4352
    s_buffer_load_dwordx2 s[56:57], s[20:23], s88
    s_add_u32 s88, s88, 4352
    s_buffer_load_dwordx2 s[58:59], s[20:23], s88
    s_add_u32 s88, s88, 4352
    s_buffer_load_dwordx2 s[60:61], s[20:23], s88
    s_add_u32 s88, s88, 4352
    s_buffer_load_dwordx2 s[62:63], s[20:23], s88
    s_add_u32 s88, s88, 4352
    s_buffer_load_dwordx2 s[64:65], s[20:23], s88
    s_add_u32 s88, s88, 4352
    s_buffer_load_dwordx2 s[66:67], s[20:23], s88
    s_add_u32 s88, s88, 4352
    s_waitcnt lgkmcnt(0)
    s_sub_u32 s52, s52, s92
    s_cmp_eq_u32 s53, s48
    s_cselect_b32 s52, s52, 0
    s_addc_u32 s93, s93, 0
    s_add_u32 s94, s94, s52
    s_sub_u32 s54, s54, s92
    s_cmp_eq_u32 s55, s48
    s_cselect_b32 s54, s54, 0
    s_addc_u32 s93, s93, 0
    s_add_u32 s94, s94, s54
    s_sub_u32 s56, s56, s92
    s_cmp_eq_u32 s57, s48
    s_cselect_b32 s56, s56, 0
    s_addc_u32 s93, s93, 0
    s_add_u32 s94, s94, s56
    s_sub_u32 s58, s58, s92
    s_cmp_eq_u32 s59, s48
    s_cselect_b32 s58, s58, 0
    s_addc_u32 s93, s93, 0
    s_add_u32 s94, s94, s58
    s_sub_u32 s60, s60, s92
    s_cmp_eq_u32 s61, s48
    s_cselect_b32 s60, s60, 0
    s_addc_u32 s93, s93, 0
    s_add_u32 s94, s94, s60
    s_sub_u32 s62, s62, s92
    s_cmp_eq_u32 s63, s48
    s_cselect_b32 s62, s62, 0
    s_addc_u32 s93, s93, 0
    s_add_u32 s94, s94, s62
    s_sub_u32 s64, s64, s92
    s_cmp_eq_u32 s65, s48
    s_cselect_b32 s64, s64, 0
    s_addc_u32 s93, s93, 0
    s_add_u32 s94, s94, s64
    s_sub_u32 s66, s66, s92
    s_cmp_eq_u32 s67, s48
    s_cselect_b32 s66, s66, 0
    s_addc_u32 s93, s93, 0
    s_add_u32 s94, s94, s66
    s_buffer_load_dwordx2 s[52:53], s[20:23], s88
    s_add_u32 s88, s88, 4352
    s_buffer_load_dwordx2 s[54:55], s[20:23], s88
    s_add_u32 s88, s88, 4352
    s_buffer_load_dwordx2 s[56:57], s[20:23], s88
    s_add_u32 s88, s88, 4352
    s_buffer_load_dwordx2 s[58:59], s[20:23], s88
    s_add_u32 s88, s88, 4352
    s_buffer_load_dwordx2 s[60:61], s[20:23], s88
    s_add_u32 s88, s88, 4352
    s_buffer_load_dwordx2 s[62:63], s[20:23], s88
    s_add_u32 s88, s88, 4352
    s_buffer_load_dwordx2 s[64:65], s[20:23], s88
    s_add_u32 s88, s88, 4352
    s_buffer_load_dwordx2 s[66:67], s[20:23], s88
    s_add_u32 s88, s88, 4352
    s_waitcnt lgkmcnt(0)
    s_sub_u32 s52, s52, s92
    s_cmp_eq_u32 s53, s48
    s_cselect_b32 s52, s52, 0
    s_addc_u32 s93, s93, 0
    s_add_u32 s94, s94, s52
    s_sub_u32 s54, s54, s92
    s_cmp_eq_u32 s55, s48
    s_cselect_b32 s54, s54, 0
    s_addc_u32 s93, s93, 0
    s_add_u32 s94, s94, s54
    s_sub_u32 s56, s56, s92
    s_cmp_eq_u32 s57, s48
    s_cselect_b32 s56, s56, 0
    s_addc_u32 s93, s93, 0
    s_add_u32 s94, s94, s56
    s_sub_u32 s58, s58, s92
    s_cmp_eq_u32 s59, s48
    s_cselect_b32 s58, s58, 0
    s_addc_u32 s93, s93, 0
    s_add_u32 s94, s94, s58
    s_sub_u32 s60, s60, s92
    s_cmp_eq_u32 s61, s48
    s_cselect_b32 s60, s60, 0
    s_addc_u32 s93, s93, 0
    s_add_u32 s94, s94, s60
    s_sub_u32 s62, s62, s92
    s_cmp_eq_u32 s63, s48
    s_cselect_b32 s62, s62, 0
    s_addc_u32 s93, s93, 0
    s_add_u32 s94, s94, s62
    s_sub_u32 s64, s64, s92
    s_cmp_eq_u32 s65, s48
    s_cselect_b32 s64, s64, 0
    s_addc_u32 s93, s93, 0
    s_add_u32 s94, s94, s64
    s_sub_u32 s66, s66, s92
    s_cmp_eq_u32 s67, s48
    s_cselect_b32 s66, s66, 0
    s_addc_u32 s93, s93, 0
    s_add_u32 s94, s94, s66
    v_cvt_f32_u32 v15, s93
    v_cvt_f32_i32 v14, s94
    v_rcp_f32 v15, v15
    s_nop 0
    v_mul_f32 v14, v14, v15
    v_cvt_i32_f32 v14, v14
    s_sub_u32 s94, s82, 72
    s_mov_b32 s82, 0x7fffffff
    v_readfirstlane_b32 s92, v14
    s_mov_b32 s95, s85
    s_min_u32 s85, s93, 1
    s_cmp_eq_u32 s93, 0
    s_nop 1
    s_cbranch_scc1 L_hl
    s_sub_u32 s98, 0, s92
    s_movk_i32 s35, 150
    s_mov_b32 s36, 21495808
    s_movk_i32 s93, 6400
    s_cmp_ge_u32 s94, 2544
    s_cmovk_i32 s35, 350
    s_cmov_b32 s36, 21495808
    s_cmovk_i32 s93, 12800
    s_add_u32 s36, s36, s37
    s_max_i32 s99, s98, 0
    s_min_i32 s98, s98, 0
    s_add_u32 s99, s99, s93
    s_sub_u32 s98, s98, s93
    s_min_i32 s99, s99, 1048576
    s_max_i32 s98, s98, -1048576
    s_add_u32 s92, s92, s83
    s_sub_u32 s93, s92, s84
    s_mov_b32 s84, s92
    s_mov_b32 s80, 22369621
    s_cmp_gt_u32 s94, 2544
    s_cmov_b32 s80, 44739243
    s_mul_hi_u32 s93, s93, s80
    s_cmp_eq_u32 s95, 0
    s_cselect_b32 s80, 850, s93
    s_min_u32 s93, s70, s71
    s_max_u32 s95, s70, s71
    s_mov_b32 s71, s70
    s_mov_b32 s70, s80
    s_min_u32 s80, s80, s95
    s_max_u32 s80, s80, s93
    s_max_u32 s80, s80, 1
    s_mul_i32 s93, s80, s94
    s_sub_u32 s79, s92, s93
    s_branch L_hl
L_prep:
    s_cmp_ge_u32 s86, 24
    s_cbranch_scc1 L_mrg
    ds_read_b128 v[24:27], v9
    ds_read_b128 v[28:31], v9 offset:16
    s_add_u32 s86, s86, 1
    s_sub_u32 s92, s86, 16
    s_lshl_b32 s92, s92, 1
    v_mov_b32 v23, s92
    s_waitcnt lgkmcnt(0)
    v_max_f32 v40, v24, v26
    v_max3_f32 v40, v40, v28, v30
    v_lshlrev_b32 v32, 16, v25
    v_lshlrev_b32 v33, 16, v27
    v_lshlrev_b32 v34, 16, v29
    v_lshlrev_b32 v35, 16, v31
    v_max_f32_dpp v40, v40, v40 quad_perm:[1,0,3,2] row_mask:0xf bank_mask:0xf
    s_nop 1
    v_max_f32_dpp v40, v40, v40 quad_perm:[2,3,0,1] row_mask:0xf bank_mask:0xf
    s_nop 1
    v_max_f32_dpp v40, v40, v40 row_half_mirror row_mask:0xf bank_mask:0xf
    s_nop 1
    v_max_f32_dpp v40, v40, v40 row_mirror row_mask:0xf bank_mask:0xf
    v_and_b32 v36, 0xffff0000, v25
    v_and_b32 v37, 0xffff0000, v27
    v_and_b32 v38, 0xffff0000, v29
    v_and_b32 v39, 0xffff0000, v31
    v_mov_b32 v6, v40
    s_nop 1
    v_permlane16_swap_b32 v40, v6
    v_max_f32 v40, v40, v6
    v_sub_f32 v24, v24, v40
    v_sub_f32 v26, v26, v40
    v_sub_f32 v28, v28, v40
    v_sub_f32 v30, v30, v40
    v_exp_f32 v24, v24
    v_exp_f32 v26, v26
    v_exp_f32 v28, v28
    v_exp_f32 v30, v30
    v_add_f32 v42, v24, v26
    v_add_f32 v6, v28, v30
    v_add_f32 v42, v42, v6
    v_mul_f32 v24, v24, v32
    v_mul_f32 v26, v26, v33
    v_mul_f32 v28, v28, v34
    v_mul_f32 v30, v30, v35
    ds_write_b128 v9, v[24:27]
    ds_write_b128 v9, v[28:31] offset:16
    v_mul_f32 v41, v24, v36
    v_fmac_f32 v41, v26, v37
    v_fmac_f32 v41, v28, v38
    v_fmac_f32 v41, v30, v39
    v_add_f32_dpp v42, v42, v42 quad_perm:[1,0,3,2] row_mask:0xf bank_mask:0xf
    s_nop 0
    v_add_f32_dpp v41, v41, v41 quad_perm:[1,0,3,2] row_mask:0xf bank_mask:0xf
    v_add_f32_dpp v42, v42, v42 quad_perm:[2,3,0,1] row_mask:0xf bank_mask:0xf
    s_nop 0
    v_add_f32_dpp v41, v41, v41 quad_perm:[2,3,0,1] row_mask:0xf bank_mask:0xf
    v_add_f32_dpp v42, v42, v42 row_half_mirror row_mask:0xf bank_mask:0xf
    s_nop 0
    v_add_f32_dpp v41, v41, v41 row_half_mirror row_mask:0xf bank_mask:0xf
    v_add_f32_dpp v42, v42, v42 row_mirror row_mask:0xf bank_mask:0xf
    s_nop 0
    v_add_f32_dpp v41, v41, v41 row_mirror row_mask:0xf bank_mask:0xf
    v_mov_b32 v6, v42
    s_nop 1
    v_permlane16_swap_b32 v42, v6
    v_add_f32 v42, v42, v6
    v_mov_b32 v6, v41
    s_nop 1
    v_permlane16_swap_b32 v41, v6
    v_add_f32 v41, v41, v6
    v_sub_f32 v41, 0, v41
    v_mov_b32 v43, v41
    ds_write_b128 v11, v[40:43]
    ds_write_b32 v3, v23 offset:52
    v_add_u32 v9, 2048, v9
    v_add_u32 v11, 32, v11
    s_cmp_eq_u32 s86, 24
    s_waitcnt lgkmcnt(0)
    s_cbranch_scc0 L_hl
    v_add_u32 v9, 64512, v2
    s_mov_b32 s39, 4
    v_add_u32 v18, 78080, v2
    s_mov_b64 exec, 0xffff
    ds_read_b128 v[24:27], v18
    s_lshl_b32 s92, s41, 8
    s_add_u32 s92, s92, 8388608
    s_waitcnt lgkmcnt(0)
    v_mov_b32 v25, s48
    v_mov_b32 v27, s48
    buffer_store_dwordx4 v[24:27], v2, s[20:23], s92 offen sc0 sc1
    s_mov_b64 exec, -1
    s_waitcnt vmcnt(0)
    s_branch L_hl
L_wts:
    s_and_b32 s92, s34, 1
    s_lshl_b32 s92, s92, 15
    s_lshr_b32 s93, s34, 1
    s_lshl4_add_u32 s92, s93, s92
    s_add_u32 s92, s92, 8388608
    s_add_u32 s93, s92, 16384
    v_lshlrev_b32 v18, 8, v1
    s_cmp_eq_u32 s33, 0
    s_nop 0
    s_cbranch_scc0 L_wt1
    s_mul_i32 s94, s69, 8
    s_bfm_b64 exec, 8, s94
    buffer_load_dwordx4 v[24:27], v18, s[20:23], s92 offen
    buffer_load_dwordx4 v[28:31], v18, s[20:23], s93 offen
    s_mov_b64 exec, -1
    s_add_u32 s69, s69, 1
    s_add_u32 s40, s89, 6
    s_min_i32 s40, s40, 2904
    s_cmp_lt_u32 s69, 8
    s_cbranch_scc1 L_hl
    s_branch L_wt2
L_wt1:
    buffer_load_dwordx4 v[24:27], v18, s[20:23], s92 offen sc0 sc1
    buffer_load_dwordx4 v[28:31], v18, s[20:23], s93 offen sc0 sc1
L_wt2:
    s_add_u32 s33, s33, 1
    s_add_u32 s40, s89, 24
    s_min_i32 s40, s40, 2904
    v_and_b32 v18, 7, v1
    v_lshlrev_b32 v18, 6, v18
    v_lshrrev_b32 v19, 3, v1
    v_lshl_add_u32 v18, v19, 2, v18
    s_waitcnt vmcnt(0)
    v_xor_b32 v23, s48, v25
    v_bitop3_b32 v23, v23, v27, s48 bitop3:0xf6
    v_bitop3_b32 v23, v23, v29, s48 bitop3:0xf6
    v_bitop3_b32 v23, v23, v31, s48 bitop3:0xf6
    v_cmp_ne_u32 vcc, 0, v23
    s_cmp_gt_u32 s33, 200000
    s_nop 3
    s_cbranch_scc1 L_wt3
    s_cbranch_vccnz L_hl
L_wt3:
    s_mov_b32 s40, 0x7fffffff
    v_max_f32 v23, v24, v28
    s_nop 1
    v_max_f32_dpp v23, v23, v23 quad_perm:[1,0,3,2] row_mask:0xf bank_mask:0xf
    s_nop 1
    v_max_f32_dpp v23, v23, v23 quad_perm:[2,3,0,1] row_mask:0xf bank_mask:0xf
    s_nop 1
    v_max_f32_dpp v23, v23, v23 row_half_mirror row_mask:0xf bank_mask:0xf
    s_nop 1
    v_max_f32_dpp v23, v23, v23 row_mirror row_mask:0xf bank_mask:0xf
    v_mov_b32 v6, v23
    s_nop 1
    v_permlane32_swap_b32 v23, v6
    v_max_f32 v23, v23, v6
    v_mov_b32 v6, v23
    s_nop 1
    v_permlane16_swap_b32 v23, v6
    v_max_f32 v23, v23, v6
    v_sub_f32 v24, v24, v23
    v_sub_f32 v28, v28, v23
    v_exp_f32 v24, v24
    v_exp_f32 v28, v28
    v_mul_f32 v23, v24, v26
    v_fmac_f32 v23, v28, v30
    s_nop 1
    v_add_f32_dpp v23, v23, v23 quad_perm:[1,0,3,2] row_mask:0xf bank_mask:0xf
    s_nop 1
    v_add_f32_dpp v23, v23, v23 quad_perm:[2,3,0,1] row_mask:0xf bank_mask:0xf
    s_nop 1
    v_add_f32_dpp v23, v23, v23 row_half_mirror row_mask:0xf bank_mask:0xf
    s_nop 1
    v_add_f32_dpp v23, v23, v23 row_mirror row_mask:0xf bank_mask:0xf
    v_mov_b32 v6, v23
    s_nop 1
    v_permlane32_swap_b32 v23, v6
    v_add_f32 v23, v23, v6
    v_mov_b32 v6, v23
    s_nop 1
    v_permlane16_swap_b32 v23, v6
    v_add_f32 v23, v23, v6
    v_rcp_f32 v23, v23
    s_nop 0
    v_mul_f32 v24, v24, v23
    v_mul_f32 v28, v28, v23
    v_add_u32 v18, 78336, v18
    ds_write2_b32 v18, v24, v28 offset0:0 offset1:8
    v_mov_b32 v19, s48
    ds_write_b32 v3, v19 offset:24
    s_waitcnt lgkmcnt(0)
    s_branch L_hl
L_mrg:
    ds_read_b32 v104, v20 offset:4
    ds_read_b128 v[88:91], v10 offset:0
    ds_read_b128 v[92:95], v10 offset:768
    ds_read_b128 v[96:99], v10 offset:1536
    ds_read_b128 v[100:103], v10 offset:2304
    s_add_u32 s86, s86, 1
    s_sub_u32 s92, s86, 24
    v_mov_b32 v23, s92
    ds_write_b32 v3, v23 offset:60
    s_and_b32 s92, s92, 3
    s_cselect_b32 s92, 1, -3
    s_mul_i32 s92, s92, 3072
    v_add_u32 v10, s92, v10
    v_subrev_u32 v20, 16, v20
    s_cmp_eq_u32 s86, 39
    s_cselect_b32 s86, 14, s86
    s_waitcnt lgkmcnt(0)
    v_pk_add_f32 v[88:89], v[88:89], v[104:105] op_sel:[0,0] op_sel_hi:[1,0]
    v_pk_add_f32 v[90:91], v[90:91], v[104:105] op_sel:[0,0] op_sel_hi:[1,0]
    v_pk_add_f32 v[92:93], v[92:93], v[96:97]
    v_pk_add_f32 v[94:95], v[94:95], v[98:99]
    v_pk_add_f32 v[88:89], v[88:89], v[100:101]
    v_pk_add_f32 v[90:91], v[90:91], v[102:103]
    v_pk_add_f32 v[88:89], v[88:89], v[92:93]
    v_pk_add_f32 v[90:91], v[90:91], v[94:95]
    v_bfi_b32 v84, v5, s48, v88
    v_bfi_b32 v85, v5, s49, v89
    v_bfi_b32 v86, v5, s50, v90
    v_bfi_b32 v87, v5, s51, v91
    ds_write_b128 v9, v[84:87]
    v_subrev_u32 v9, 1024, v9
    s_waitcnt lgkmcnt(0)
    s_nop 0
    s_branch L_hl
L_late:
    s_getpc_b64 s[92:93]
L_pc2:
    v_lshlrev_b32 v19, 7, v1
    v_min_u32 v19, L_end-L_pc2, v19
    s_mov_b64 exec, 0xff
    global_load_dword v6, v19, s[92:93]
    s_mov_b64 exec, -1
    s_mul_i32 s32, s41, 768
    s_mov_b32 s39, s32
    s_add_u32 s32, s32, 196608
    s_mul_i32 s42, s80, 3112
    s_add_u32 s42, s42, s79
    s_cmp_eq_u32 s80, 0
    s_cselect_b32 s42, -2, s42
    s_min_u32 s42, s42, -2
    v_add_u32 v9, 49152, v2
    ds_read_b128 v[24:27], v9 offset:1024
    ds_read_b128 v[28:31], v9 offset:2048
    ds_read_b128 v[32:35], v9 offset:3072
    ds_read_b128 v[36:39], v9 offset:4096
    ds_read_b128 v[40:43], v9 offset:5120
    ds_read_b128 v[44:47], v9 offset:6144
    ds_read_b128 v[48:51], v9 offset:7168
    ds_read_b128 v[52:55], v9 offset:8192
    ds_read_b128 v[56:59], v9 offset:9216
    ds_read_b128 v[60:63], v9 offset:10240
    s_waitcnt lgkmcnt(0)
    ds_read_b128 v[64:67], v9 offset:11264
    ds_read_b128 v[68:71], v9 offset:12288
    ds_read_b128 v[72:75], v9 offset:13312
    ds_read_b128 v[76:79], v9 offset:14336
    ds_read_b128 v[80:83], v9 offset:15360
    ds_read_b32 v104, v20 offset:4
    s_mov_b32 exec_hi, 0xffff
L_w7:
    ds_read_b32 v19, v7
    ds_read_b128 v[88:91], v10 offset:0
    ds_read_b128 v[92:95], v10 offset:768
    ds_read_b128 v[96:99], v10 offset:1536
    ds_read_b128 v[100:103], v10 offset:2304
    s_memrealtime s[96:97]
    s_waitcnt lgkmcnt(0)
    v_readlane_b32 s92, v19, 39
    v_readlane_b32 s89, v19, 5
    s_cmp_eq_u32 s92, 4
    s_nop 3
    s_cbranch_scc1 L_g7
    s_sub_u32 s96, s96, s78
    s_lshl_b32 s96, s96, 8
    s_cmp_ge_i32 s89, 3084
    s_cbranch_scc1 L_ns7
    s_mul_i32 s92, s80, s89
    s_add_u32 s92, s92, s79
    s_sub_u32 s92, s96, s92
    s_max_i32 s92, s92, s98
    s_min_i32 s92, s92, s99
    s_mul_i32 s92, s92, s35
    s_add_u32 s92, s92, s36
    s_ashr_i32 s92, s92, 20
    s_max_i32 s92, s92, 15
    s_min_i32 s92, s92, 26
    v_mov_b32 v18, s92
    ds_write_b32 v3, v18 offset:16
    s_nop 0
L_ns7:
    s_cmp_lt_u32 s96, s42
    s_cbranch_scc1 L_w7
    buffer_store_dwordx4 v[24:27], v2, s[20:23], s32 offen sc0 sc1
    s_add_u32 s32, s32, 196608
    buffer_store_dwordx4 v[28:31], v2, s[20:23], s32 offen sc0 sc1
    s_add_u32 s32, s32, 196608
    buffer_store_dwordx4 v[32:35], v2, s[20:23], s32 offen sc0 sc1
    s_add_u32 s32, s32, 196608
    buffer_store_dwordx4 v[36:39], v2, s[20:23], s32 offen sc0 sc1
    s_add_u32 s32, s32, 196608
    buffer_store_dwordx4 v[40:43], v2, s[20:23], s32 offen sc0 sc1
    s_add_u32 s32, s32, 196608
    buffer_store_dwordx4 v[44:47], v2, s[20:23], s32 offen sc0 sc1
    s_add_u32 s32, s32, 196608
    buffer_store_dwordx4 v[48:51], v2, s[20:23], s32 offen sc0 sc1
    s_add_u32 s32, s32, 196608
    buffer_store_dwordx4 v[52:55], v2, s[20:23], s32 offen sc0 sc1
    s_add_u32 s32, s32, 196608
    buffer_store_dwordx4 v[56:59], v2, s[20:23], s32 offen sc0 sc1
    s_add_u32 s32, s32, 196608
    buffer_store_dwordx4 v[60:63], v2, s[20:23], s32 offen sc0 sc1
    s_add_u32 s32, s32, 196608
    buffer_store_dwordx4 v[64:67], v2, s[20:23], s32 offen sc0 sc1
    s_add_u32 s32, s32, 196608
    buffer_store_dwordx4 v[68:71], v2, s[20:23], s32 offen sc0 sc1
    s_add_u32 s32, s32, 196608
    buffer_store_dwordx4 v[72:75], v2, s[20:23], s32 offen sc0 sc1
    s_add_u32 s32, s32, 196608
    buffer_store_dwordx4 v[76:79], v2, s[20:23], s32 offen sc0 sc1
    s_add_u32 s32, s32, 196608
    buffer_store_dwordx4 v[80:83], v2, s[20:23], s32 offen sc0 sc1
    s_mov_b32 s42, -1
    s_nop 0
L_w8:
    ds_read_b32 v19, v7
    ds_read_b128 v[88:91], v10 offset:0
    ds_read_b128 v[92:95], v10 offset:768
    ds_read_b128 v[96:99], v10 offset:1536
    ds_read_b128 v[100:103], v10 offset:2304
    s_waitcnt lgkmcnt(4)
    v_readlane_b32 s92, v19, 39
    s_nop 0
    s_cmp_lg_u32 s92, 4
    s_waitcnt lgkmcnt(0)
    s_cbranch_scc1 L_w8
L_g7:
    v_pk_add_f32 v[88:89], v[88:89], v[104:105] op_sel:[0,0] op_sel_hi:[1,0]
    v_pk_add_f32 v[90:91], v[90:91], v[104:105] op_sel:[0,0] op_sel_hi:[1,0]
    v_pk_add_f32 v[92:93], v[92:93], v[96:97]
    v_pk_add_f32 v[94:95], v[94:95], v[98:99]
    v_pk_add_f32 v[88:89], v[88:89], v[100:101]
    v_pk_add_f32 v[90:91], v[90:91], v[102:103]
    v_pk_add_f32 v[88:89], v[88:89], v[92:93]
    v_pk_add_f32 v[90:91], v[90:91], v[94:95]
    v_bfi_b32 v84, v5, s48, v88
    v_bfi_b32 v85, v5, s49, v89
    v_bfi_b32 v86, v5, s50, v90
    v_bfi_b32 v87, v5, s51, v91
    buffer_store_dwordx4 v[84:87], v2, s[20:23], s39 offen sc0 sc1
    s_cmp_eq_u32 s42, -1
    s_nop 0
    s_cbranch_scc1 L_hend
    buffer_store_dwordx4 v[24:27], v2, s[20:23], s32 offen sc0 sc1
    s_add_u32 s32, s32, 196608
    buffer_store_dwordx4 v[28:31], v2, s[20:23], s32 offen sc0 sc1
    s_add_u32 s32, s32, 196608
    buffer_store_dwordx4 v[32:35], v2, s[20:23], s32 offen sc0 sc1
    s_add_u32 s32, s32, 196608
    buffer_store_dwordx4 v[36:39], v2, s[20:23], s32 offen sc0 sc1
    s_add_u32 s32, s32, 196608
    buffer_store_dwordx4 v[40:43], v2, s[20:23], s32 offen sc0 sc1
    s_add_u32 s32, s32, 196608
    buffer_store_dwordx4 v[44:47], v2, s[20:23], s32 offen sc0 sc1
    s_add_u32 s32, s32, 196608
    buffer_store_dwordx4 v[48:51], v2, s[20:23], s32 offen sc0 sc1
    s_add_u32 s32, s32, 196608
    buffer_store_dwordx4 v[52:55], v2, s[20:23], s32 offen sc0 sc1
    s_add_u32 s32, s32, 196608
    buffer_store_dwordx4 v[56:59], v2, s[20:23], s32 offen sc0 sc1
    s_add_u32 s32, s32, 196608
    buffer_store_dwordx4 v[60:63], v2, s[20:23], s32 offen sc0 sc1
    s_add_u32 s32, s32, 196608
    buffer_store_dwordx4 v[64:67], v2, s[20:23], s32 offen sc0 sc1
    s_add_u32 s32, s32, 196608
    buffer_store_dwordx4 v[68:71], v2, s[20:23], s32 offen sc0 sc1
    s_add_u32 s32, s32, 196608
    buffer_store_dwordx4 v[72:75], v2, s[20:23], s32 offen sc0 sc1
    s_add_u32 s32, s32, 196608
    buffer_store_dwordx4 v[76:79], v2, s[20:23], s32 offen sc0 sc1
    s_add_u32 s32, s32, 196608
    buffer_store_dwordx4 v[80:83], v2, s[20:23], s32 offen sc0 sc1
    s_mov_b32 s42, -1
    s_nop 0
L_hend:
    v_mov_b32 v18, 2
    s_waitcnt vmcnt(14)
    ds_write_b32 v3, v18 offset:32
    v_mov_b32 v18, 3
    s_waitcnt vmcnt(13)
    ds_write_b32 v3, v18 offset:32
    v_mov_b32 v18, 4
    s_waitcnt vmcnt(12)
    ds_write_b32 v3, v18 offset:32
    v_mov_b32 v18, 5
    s_waitcnt vmcnt(11)
    ds_write_b32 v3, v18 offset:32
    v_mov_b32 v18, 6
    s_waitcnt vmcnt(10)
    ds_write_b32 v3, v18 offset:32
    v_mov_b32 v18, 7
    s_waitcnt vmcnt(9)
    ds_write_b32 v3, v18 offset:32
    v_mov_b32 v18, 8
    s_waitcnt vmcnt(8)
    ds_write_b32 v3, v18 offset:32
    v_mov_b32 v18, 9
    s_waitcnt vmcnt(7)
    ds_write_b32 v3, v18 offset:32
    v_mov_b32 v18, 10
    s_waitcnt vmcnt(6)
    ds_write_b32 v3, v18 offset:32
    v_mov_b32 v18, 11
    s_waitcnt vmcnt(5)
    ds_write_b32 v3, v18 offset:32
    v_mov_b32 v18, 12
    s_waitcnt vmcnt(4)
    ds_write_b32 v3, v18 offset:32
    v_mov_b32 v18, 13
    s_waitcnt vmcnt(3)
    ds_write_b32 v3, v18 offset:32
    v_mov_b32 v18, 14
    s_waitcnt vmcnt(2)
    ds_write_b32 v3, v18 offset:32
    v_mov_b32 v18, 15
    s_waitcnt vmcnt(1)
    ds_write_b32 v3, v18 offset:32
    v_mov_b32 v18, 16
    s_waitcnt vmcnt(0)
    ds_write_b32 v3, v18 offset:32
    s_waitcnt lgkmcnt(0)
L_end:
    s_endpgm
.section .rodata,"a"
.p2align 6
.amdhsa_kernel standalone__kv_cache_quant_pre_rope_vs_post_rope__decode_kernel
  .amdhsa_next_free_vgpr 168
  .amdhsa_next_free_sgpr 102
  .amdhsa_accum_offset 168
  .amdhsa_group_segment_fixed_size 0
  .amdhsa_kernarg_size 112
  .amdhsa_user_sgpr_count 2
  .amdhsa_user_sgpr_kernarg_segment_ptr 1
  .amdhsa_system_sgpr_workgroup_id_x 1
.end_amdhsa_kernel
```

```asm
; @launch grid=(256,1,1) block=(384,1,1) lds=79872
.amdgcn_target "amdgcn-amd-amdhsa--gfx950"
.text
.globl standalone__kv_cache_quant_pre_rope_vs_post_rope__decode_kernel
.p2align 8
.type standalone__kv_cache_quant_pre_rope_vs_post_rope__decode_kernel,@function
standalone__kv_cache_quant_pre_rope_vs_post_rope__decode_kernel:
    s_load_dwordx16 s[48:63], s[0:1], 0
    s_load_dwordx8 s[64:71], s[0:1], 64
    s_load_dwordx4 s[72:75], s[0:1], 96
    s_cmp_ge_u32 s2, 256
    s_cbranch_scc1 L_end
    v_lshrrev_b32 v18, 6, v0
    v_and_b32 v1, 63, v0
    v_readfirstlane_b32 s76, v18
    v_cmp_eq_u32 vcc, 4, v1
    v_lshlrev_b32 v7, 2, v1
    v_add_u32 v7, 77824, v7
    v_cndmask_b32 v19, 0, 20, vcc
    ds_write_b32 v7, v19
    s_and_b32 s92, s2, 7
    s_lshl_b32 s77, s92, 6
    s_and_b32 s92, s2, 0x60
    s_lshl4_add_u32 s77, s92, s77
    s_and_b32 s92, s2, 0x10
    s_lshl1_add_u32 s77, s92, s77
    s_lshr_b32 s92, s2, 7
    s_lshl4_add_u32 s77, s92, s77
    s_bfe_u32 s3, s2, 0x10003
    s_mul_i32 s92, s3, 8192
    s_add_u32 s77, s77, s92
    s_cmp_lg_u32 s76, 0
    s_cbranch_scc1 L_other
    s_setprio 3
    v_lshlrev_b32 v2, 4, v1
    v_add_u32 v8, 784896, v2
    v_cmp_gt_u32 vcc, 32, v1
    s_mul_i32 s78, s77, 384
    s_mov_b32 s6, 6291456
    s_mov_b32 s7, 0x20000
    v_cndmask_b32 v4, v8, v2, vcc
    s_mov_b32 m0, 0
    s_mov_b32 s81, 0
    v_mov_b32 v6, 77844
    v_mov_b32 v5, -20
    s_waitcnt lgkmcnt(0)
    s_mov_b64 s[4:5], s[66:67]
L_i0:
    s_waitcnt vmcnt(19)
    buffer_load_dwordx4 v2, s[4:7], s78 offen offset:0  lds
    v_add_u32 v5, 3, v5
    s_add_u32 s81, s81, 1
    s_waitcnt vmcnt(19)
    buffer_load_dwordx4 v4, s[4:7], s78 offen offset:1024  lds
    s_and_b32 s92, s81, 3
    s_cselect_b32 s92, 0, -6144
    s_cmp_eq_u32 s81, 8
    s_cselect_b32 s93, 1572864, 0
    s_add_u32 s92, s92, s93
    s_bitcmp1_b32 s81, 2
    s_waitcnt vmcnt(19)
    buffer_load_dwordx4 v8, s[4:7], s78 offen offset:2048  lds
    ds_write_b32 v6, v5
    s_cselect_b64 s[4:5], s[68:69], s[66:67]
    s_addk_i32 m0, 3072
    s_addk_i32 s92, 1536
    s_add_u32 s78, s78, s92
    s_cmp_lg_u32 s81, 6
    s_cbranch_scc1 L_i1
    s_barrier
L_i1:
    s_cmp_lt_u32 s81, 16
    s_cbranch_scc1 L_i0
    ds_read_b32 v3, v7
    s_mul_i32 s79, s3, 12582912
    s_mov_b64 s[4:5], s[50:51]
    s_mov_b32 s6, 402653184
    s_mov_b32 s7, 0x20000
    s_mov_b32 m0, 0
    s_movk_i32 s85, 4096
    s_mov_b32 s81, 0
    s_mul_i32 s78, s77, 768
    s_add_u32 s78, s78, s79
    s_mov_b32 s82, 1
    s_waitcnt lgkmcnt(0)
    v_readlane_b32 s84, v3, 0
    s_nop 4
L_D20:
    s_mul_i32 s92, s81, 12
    s_add_u32 s92, s92, 28
    v_mov_b32 v5, s92
L_B20:
L_B20_0:
    s_cmp_lt_i32 s84, s82
    s_cbranch_scc1 L_B20_0w
    s_waitcnt vmcnt(19)
    buffer_load_dwordx4 v2, s[4:7], s78 offen offset:0 nt lds
    v_add_u32 v5, 3, v5
    s_add_u32 s81, s81, 1
    s_and_b32 s92, s81, 7
    s_waitcnt vmcnt(19)
    buffer_load_dwordx4 v2, s[4:7], s78 offen offset:1024 nt lds
    v_readlane_b32 s84, v3, 1
    ds_read_b32 v3, v7
    s_lshl_b32 s92, s92, 11
    s_add_u32 s92, s92, s77
    s_waitcnt vmcnt(19)
    buffer_load_dwordx4 v2, s[4:7], s78 offen offset:2048 nt lds
    ds_write_b32 v6, v5
    s_and_b32 s92, s92, 16383
    s_mul_i32 s80, s92, 768
L_B20_1:
    s_cmp_lt_i32 s84, s82
    s_cbranch_scc1 L_B20_1w
    s_waitcnt vmcnt(19)
    buffer_load_dwordx4 v2, s[4:7], s78 offen offset:3072 nt lds
    v_add_u32 v5, 3, v5
    s_add_u32 m0, m0, s85
    s_add_u32 s78, s78, s85
    s_waitcnt vmcnt(19)
    buffer_load_dwordx4 v2, s[4:7], s78 offen offset:0 nt lds
    v_readlane_b32 s84, v3, 2
    ds_read_b32 v3, v7
    s_bfe_u32 s92, s81, 0x40003
    s_bfe_i32 s93, s81, 0x10007
    s_waitcnt vmcnt(19)
    buffer_load_dwordx4 v2, s[4:7], s78 offen offset:1024 nt lds
    ds_write_b32 v6, v5
    s_xor_b32 s92, s92, s93
    s_and_b32 s92, s92, 15
L_B20_2:
    s_cmp_lt_i32 s84, s82
    s_cbranch_scc1 L_B20_2w
    s_waitcnt vmcnt(19)
    buffer_load_dwordx4 v2, s[4:7], s78 offen offset:2048 nt lds
    v_add_u32 v5, 3, v5
    s_mul_i32 s92, s92, 25165824
    s_add_u32 s80, s80, s79
    s_waitcnt vmcnt(19)
    buffer_load_dwordx4 v2, s[4:7], s78 offen offset:3072 nt lds
    v_readlane_b32 s84, v3, 3
    ds_read_b32 v3, v7
    s_add_u32 m0, m0, s85
    s_add_u32 s78, s78, s85
    s_waitcnt vmcnt(19)
    buffer_load_dwordx4 v2, s[4:7], s78 offen offset:0 nt lds
    ds_write_b32 v6, v5
    s_add_u32 s80, s80, s92
    s_and_b32 s86, s81, 3
L_B20_3:
    s_cmp_lt_i32 s84, s82
    s_cbranch_scc1 L_B20_3w
    s_waitcnt vmcnt(19)
    buffer_load_dwordx4 v2, s[4:7], s78 offen offset:1024 nt lds
    v_add_u32 v5, 3, v5
    v_readlane_b32 s83, v3, 4
    s_mul_i32 s86, s86, 12288
    s_waitcnt vmcnt(19)
    buffer_load_dwordx4 v2, s[4:7], s78 offen offset:2048 nt lds
    v_readlane_b32 s84, v3, 0
    ds_read_b32 v3, v7
    s_add_u32 s82, s82, 1
    s_cmp_ge_u32 s81, 255
    s_cselect_b32 s83, -1, s83
    s_cmp_ge_u32 s81, 128
    s_waitcnt vmcnt(19)
    buffer_load_dwordx4 v2, s[4:7], s78 offen offset:3072 nt lds
    ds_write_b32 v6, v5
    s_cselect_b64 s[4:5], s[56:57], s[50:51]
    s_mov_b32 m0, s86
    s_mov_b32 s78, s80
    s_cmp_eq_u32 s83, 20
    s_cbranch_scc1 L_B20
L_disp:
    s_cmp_eq_u32 s83, 20
    s_cbranch_scc1 L_D20
    s_cmp_eq_u32 s83, 21
    s_cbranch_scc1 L_D21
    s_cmp_eq_u32 s83, 19
    s_cbranch_scc1 L_D19
    s_cmp_eq_u32 s83, 22
    s_cbranch_scc1 L_D22
    s_cmp_eq_u32 s83, 18
    s_cbranch_scc1 L_D18
    s_cmp_eq_u32 s83, 23
    s_cbranch_scc1 L_D23
    s_cmp_eq_u32 s83, 17
    s_cbranch_scc1 L_D17
    s_cmp_eq_u32 s83, 24
    s_cbranch_scc1 L_D24
    s_cmp_eq_u32 s83, 16
    s_cbranch_scc1 L_D16
    s_cmp_eq_u32 s83, 25
    s_cbranch_scc1 L_D25
    s_cmp_eq_u32 s81, 256
    s_cbranch_scc1 L_drain
    s_cmp_ge_u32 s81, 255
    s_cbranch_scc1 L_D32
    s_cmp_ge_i32 s83, 26
    s_cbranch_scc1 L_D26
    s_branch L_D15
L_D19:
    s_mul_i32 s92, s81, 12
    s_add_u32 s92, s92, 29
    v_mov_b32 v5, s92
L_B19:
L_B19_0:
    s_cmp_lt_i32 s84, s82
    s_cbranch_scc1 L_B19_0w
    s_waitcnt vmcnt(18)
    buffer_load_dwordx4 v2, s[4:7], s78 offen offset:0 nt lds
    v_add_u32 v5, 3, v5
    s_add_u32 s81, s81, 1
    s_and_b32 s92, s81, 7
    s_waitcnt vmcnt(18)
    buffer_load_dwordx4 v2, s[4:7], s78 offen offset:1024 nt lds
    v_readlane_b32 s84, v3, 1
    ds_read_b32 v3, v7
    s_lshl_b32 s92, s92, 11
    s_add_u32 s92, s92, s77
    s_waitcnt vmcnt(18)
    buffer_load_dwordx4 v2, s[4:7], s78 offen offset:2048 nt lds
    ds_write_b32 v6, v5
    s_and_b32 s92, s92, 16383
    s_mul_i32 s80, s92, 768
L_B19_1:
    s_cmp_lt_i32 s84, s82
    s_cbranch_scc1 L_B19_1w
    s_waitcnt vmcnt(18)
    buffer_load_dwordx4 v2, s[4:7], s78 offen offset:3072 nt lds
    v_add_u32 v5, 3, v5
    s_add_u32 m0, m0, s85
    s_add_u32 s78, s78, s85
    s_waitcnt vmcnt(18)
    buffer_load_dwordx4 v2, s[4:7], s78 offen offset:0 nt lds
    v_readlane_b32 s84, v3, 2
    ds_read_b32 v3, v7
    s_bfe_u32 s92, s81, 0x40003
    s_bfe_i32 s93, s81, 0x10007
    s_waitcnt vmcnt(18)
    buffer_load_dwordx4 v2, s[4:7], s78 offen offset:1024 nt lds
    ds_write_b32 v6, v5
    s_xor_b32 s92, s92, s93
    s_and_b32 s92, s92, 15
L_B19_2:
    s_cmp_lt_i32 s84, s82
    s_cbranch_scc1 L_B19_2w
    s_waitcnt vmcnt(18)
    buffer_load_dwordx4 v2, s[4:7], s78 offen offset:2048 nt lds
    v_add_u32 v5, 3, v5
    s_mul_i32 s92, s92, 25165824
    s_add_u32 s80, s80, s79
    s_waitcnt vmcnt(18)
    buffer_load_dwordx4 v2, s[4:7], s78 offen offset:3072 nt lds
    v_readlane_b32 s84, v3, 3
    ds_read_b32 v3, v7
    s_add_u32 m0, m0, s85
    s_add_u32 s78, s78, s85
    s_waitcnt vmcnt(18)
    buffer_load_dwordx4 v2, s[4:7], s78 offen offset:0 nt lds
    ds_write_b32 v6, v5
    s_add_u32 s80, s80, s92
    s_and_b32 s86, s81, 3
L_B19_3:
    s_cmp_lt_i32 s84, s82
    s_cbranch_scc1 L_B19_3w
    s_waitcnt vmcnt(18)
    buffer_load_dwordx4 v2, s[4:7], s78 offen offset:1024 nt lds
    v_add_u32 v5, 3, v5
    v_readlane_b32 s83, v3, 4
    s_mul_i32 s86, s86, 12288
    s_waitcnt vmcnt(18)
    buffer_load_dwordx4 v2, s[4:7], s78 offen offset:2048 nt lds
    v_readlane_b32 s84, v3, 0
    ds_read_b32 v3, v7
    s_add_u32 s82, s82, 1
    s_cmp_ge_u32 s81, 255
    s_cselect_b32 s83, -1, s83
    s_cmp_ge_u32 s81, 128
    s_waitcnt vmcnt(18)
    buffer_load_dwordx4 v2, s[4:7], s78 offen offset:3072 nt lds
    ds_write_b32 v6, v5
    s_cselect_b64 s[4:5], s[56:57], s[50:51]
    s_mov_b32 m0, s86
    s_mov_b32 s78, s80
    s_cmp_eq_u32 s83, 19
    s_cbranch_scc1 L_B19
    s_cmp_eq_u32 s83, -1
    s_cbranch_scc1 L_D32
    s_cmp_eq_u32 s83, 20
    s_cbranch_scc1 L_D20
    s_cmp_eq_u32 s83, 18
    s_cbranch_scc1 L_D18
    s_branch L_disp
L_D21:
    s_mul_i32 s92, s81, 12
    s_add_u32 s92, s92, 27
    v_mov_b32 v5, s92
L_B21:
L_B21_0:
    s_cmp_lt_i32 s84, s82
    s_cbranch_scc1 L_B21_0w
    s_waitcnt vmcnt(20)
    buffer_load_dwordx4 v2, s[4:7], s78 offen offset:0 nt lds
    v_add_u32 v5, 3, v5
    s_add_u32 s81, s81, 1
    s_and_b32 s92, s81, 7
    s_waitcnt vmcnt(20)
    buffer_load_dwordx4 v2, s[4:7], s78 offen offset:1024 nt lds
    v_readlane_b32 s84, v3, 1
    ds_read_b32 v3, v7
    s_lshl_b32 s92, s92, 11
    s_add_u32 s92, s92, s77
    s_waitcnt vmcnt(20)
    buffer_load_dwordx4 v2, s[4:7], s78 offen offset:2048 nt lds
    ds_write_b32 v6, v5
    s_and_b32 s92, s92, 16383
    s_mul_i32 s80, s92, 768
L_B21_1:
    s_cmp_lt_i32 s84, s82
    s_cbranch_scc1 L_B21_1w
    s_waitcnt vmcnt(20)
    buffer_load_dwordx4 v2, s[4:7], s78 offen offset:3072 nt lds
    v_add_u32 v5, 3, v5
    s_add_u32 m0, m0, s85
    s_add_u32 s78, s78, s85
    s_waitcnt vmcnt(20)
    buffer_load_dwordx4 v2, s[4:7], s78 offen offset:0 nt lds
    v_readlane_b32 s84, v3, 2
    ds_read_b32 v3, v7
    s_bfe_u32 s92, s81, 0x40003
    s_bfe_i32 s93, s81, 0x10007
    s_waitcnt vmcnt(20)
    buffer_load_dwordx4 v2, s[4:7], s78 offen offset:1024 nt lds
    ds_write_b32 v6, v5
    s_xor_b32 s92, s92, s93
    s_and_b32 s92, s92, 15
L_B21_2:
    s_cmp_lt_i32 s84, s82
    s_cbranch_scc1 L_B21_2w
    s_waitcnt vmcnt(20)
    buffer_load_dwordx4 v2, s[4:7], s78 offen offset:2048 nt lds
    v_add_u32 v5, 3, v5
    s_mul_i32 s92, s92, 25165824
    s_add_u32 s80, s80, s79
    s_waitcnt vmcnt(20)
    buffer_load_dwordx4 v2, s[4:7], s78 offen offset:3072 nt lds
    v_readlane_b32 s84, v3, 3
    ds_read_b32 v3, v7
    s_add_u32 m0, m0, s85
    s_add_u32 s78, s78, s85
    s_waitcnt vmcnt(20)
    buffer_load_dwordx4 v2, s[4:7], s78 offen offset:0 nt lds
    ds_write_b32 v6, v5
    s_add_u32 s80, s80, s92
    s_and_b32 s86, s81, 3
L_B21_3:
    s_cmp_lt_i32 s84, s82
    s_cbranch_scc1 L_B21_3w
    s_waitcnt vmcnt(20)
    buffer_load_dwordx4 v2, s[4:7], s78 offen offset:1024 nt lds
    v_add_u32 v5, 3, v5
    v_readlane_b32 s83, v3, 4
    s_mul_i32 s86, s86, 12288
    s_waitcnt vmcnt(20)
    buffer_load_dwordx4 v2, s[4:7], s78 offen offset:2048 nt lds
    v_readlane_b32 s84, v3, 0
    ds_read_b32 v3, v7
    s_add_u32 s82, s82, 1
    s_cmp_ge_u32 s81, 255
    s_cselect_b32 s83, -1, s83
    s_cmp_ge_u32 s81, 128
    s_waitcnt vmcnt(20)
    buffer_load_dwordx4 v2, s[4:7], s78 offen offset:3072 nt lds
    ds_write_b32 v6, v5
    s_cselect_b64 s[4:5], s[56:57], s[50:51]
    s_mov_b32 m0, s86
    s_mov_b32 s78, s80
    s_cmp_eq_u32 s83, 21
    s_cbranch_scc1 L_B21
    s_cmp_eq_u32 s83, -1
    s_cbranch_scc1 L_D32
    s_cmp_eq_u32 s83, 20
    s_cbranch_scc1 L_D20
    s_cmp_eq_u32 s83, 22
    s_cbranch_scc1 L_D22
    s_branch L_disp
L_D18:
    s_mul_i32 s92, s81, 12
    s_add_u32 s92, s92, 30
    v_mov_b32 v5, s92
L_B18:
L_B18_0:
    s_cmp_lt_i32 s84, s82
    s_cbranch_scc1 L_B18_0w
    s_waitcnt vmcnt(17)
    buffer_load_dwordx4 v2, s[4:7], s78 offen offset:0 nt lds
    v_add_u32 v5, 3, v5
    s_add_u32 s81, s81, 1
    s_and_b32 s92, s81, 7
    s_waitcnt vmcnt(17)
    buffer_load_dwordx4 v2, s[4:7], s78 offen offset:1024 nt lds
    v_readlane_b32 s84, v3, 1
    ds_read_b32 v3, v7
    s_lshl_b32 s92, s92, 11
    s_add_u32 s92, s92, s77
    s_waitcnt vmcnt(17)
    buffer_load_dwordx4 v2, s[4:7], s78 offen offset:2048 nt lds
    ds_write_b32 v6, v5
    s_and_b32 s92, s92, 16383
    s_mul_i32 s80, s92, 768
L_B18_1:
    s_cmp_lt_i32 s84, s82
    s_cbranch_scc1 L_B18_1w
    s_waitcnt vmcnt(17)
    buffer_load_dwordx4 v2, s[4:7], s78 offen offset:3072 nt lds
    v_add_u32 v5, 3, v5
    s_add_u32 m0, m0, s85
    s_add_u32 s78, s78, s85
    s_waitcnt vmcnt(17)
    buffer_load_dwordx4 v2, s[4:7], s78 offen offset:0 nt lds
    v_readlane_b32 s84, v3, 2
    ds_read_b32 v3, v7
    s_bfe_u32 s92, s81, 0x40003
    s_bfe_i32 s93, s81, 0x10007
    s_waitcnt vmcnt(17)
    buffer_load_dwordx4 v2, s[4:7], s78 offen offset:1024 nt lds
    ds_write_b32 v6, v5
    s_xor_b32 s92, s92, s93
    s_and_b32 s92, s92, 15
L_B18_2:
    s_cmp_lt_i32 s84, s82
    s_cbranch_scc1 L_B18_2w
    s_waitcnt vmcnt(17)
    buffer_load_dwordx4 v2, s[4:7], s78 offen offset:2048 nt lds
    v_add_u32 v5, 3, v5
    s_mul_i32 s92, s92, 25165824
    s_add_u32 s80, s80, s79
    s_waitcnt vmcnt(17)
    buffer_load_dwordx4 v2, s[4:7], s78 offen offset:3072 nt lds
    v_readlane_b32 s84, v3, 3
    ds_read_b32 v3, v7
    s_add_u32 m0, m0, s85
    s_add_u32 s78, s78, s85
    s_waitcnt vmcnt(17)
    buffer_load_dwordx4 v2, s[4:7], s78 offen offset:0 nt lds
    ds_write_b32 v6, v5
    s_add_u32 s80, s80, s92
    s_and_b32 s86, s81, 3
L_B18_3:
    s_cmp_lt_i32 s84, s82
    s_cbranch_scc1 L_B18_3w
    s_waitcnt vmcnt(17)
    buffer_load_dwordx4 v2, s[4:7], s78 offen offset:1024 nt lds
    v_add_u32 v5, 3, v5
    v_readlane_b32 s83, v3, 4
    s_mul_i32 s86, s86, 12288
    s_waitcnt vmcnt(17)
    buffer_load_dwordx4 v2, s[4:7], s78 offen offset:2048 nt lds
    v_readlane_b32 s84, v3, 0
    ds_read_b32 v3, v7
    s_add_u32 s82, s82, 1
    s_cmp_ge_u32 s81, 255
    s_cselect_b32 s83, -1, s83
    s_cmp_ge_u32 s81, 128
    s_waitcnt vmcnt(17)
    buffer_load_dwordx4 v2, s[4:7], s78 offen offset:3072 nt lds
    ds_write_b32 v6, v5
    s_cselect_b64 s[4:5], s[56:57], s[50:51]
    s_mov_b32 m0, s86
    s_mov_b32 s78, s80
    s_cmp_eq_u32 s83, 18
    s_cbranch_scc1 L_B18
    s_cmp_eq_u32 s83, -1
    s_cbranch_scc1 L_D32
    s_cmp_eq_u32 s83, 19
    s_cbranch_scc1 L_D19
    s_cmp_eq_u32 s83, 17
    s_cbranch_scc1 L_D17
    s_branch L_disp
L_D22:
    s_mul_i32 s92, s81, 12
    s_add_u32 s92, s92, 26
    v_mov_b32 v5, s92
L_B22:
L_B22_0:
    s_cmp_lt_i32 s84, s82
    s_cbranch_scc1 L_B22_0w
    s_waitcnt vmcnt(21)
    buffer_load_dwordx4 v2, s[4:7], s78 offen offset:0 nt lds
    v_add_u32 v5, 3, v5
    s_add_u32 s81, s81, 1
    s_and_b32 s92, s81, 7
    s_waitcnt vmcnt(21)
    buffer_load_dwordx4 v2, s[4:7], s78 offen offset:1024 nt lds
    v_readlane_b32 s84, v3, 1
    ds_read_b32 v3, v7
    s_lshl_b32 s92, s92, 11
    s_add_u32 s92, s92, s77
    s_waitcnt vmcnt(21)
    buffer_load_dwordx4 v2, s[4:7], s78 offen offset:2048 nt lds
    ds_write_b32 v6, v5
    s_and_b32 s92, s92, 16383
    s_mul_i32 s80, s92, 768
L_B22_1:
    s_cmp_lt_i32 s84, s82
    s_cbranch_scc1 L_B22_1w
    s_waitcnt vmcnt(21)
    buffer_load_dwordx4 v2, s[4:7], s78 offen offset:3072 nt lds
    v_add_u32 v5, 3, v5
    s_add_u32 m0, m0, s85
    s_add_u32 s78, s78, s85
    s_waitcnt vmcnt(21)
    buffer_load_dwordx4 v2, s[4:7], s78 offen offset:0 nt lds
    v_readlane_b32 s84, v3, 2
    ds_read_b32 v3, v7
    s_bfe_u32 s92, s81, 0x40003
    s_bfe_i32 s93, s81, 0x10007
    s_waitcnt vmcnt(21)
    buffer_load_dwordx4 v2, s[4:7], s78 offen offset:1024 nt lds
    ds_write_b32 v6, v5
    s_xor_b32 s92, s92, s93
    s_and_b32 s92, s92, 15
L_B22_2:
    s_cmp_lt_i32 s84, s82
    s_cbranch_scc1 L_B22_2w
    s_waitcnt vmcnt(21)
    buffer_load_dwordx4 v2, s[4:7], s78 offen offset:2048 nt lds
    v_add_u32 v5, 3, v5
    s_mul_i32 s92, s92, 25165824
    s_add_u32 s80, s80, s79
    s_waitcnt vmcnt(21)
    buffer_load_dwordx4 v2, s[4:7], s78 offen offset:3072 nt lds
    v_readlane_b32 s84, v3, 3
    ds_read_b32 v3, v7
    s_add_u32 m0, m0, s85
    s_add_u32 s78, s78, s85
    s_waitcnt vmcnt(21)
    buffer_load_dwordx4 v2, s[4:7], s78 offen offset:0 nt lds
    ds_write_b32 v6, v5
    s_add_u32 s80, s80, s92
    s_and_b32 s86, s81, 3
L_B22_3:
    s_cmp_lt_i32 s84, s82
    s_cbranch_scc1 L_B22_3w
    s_waitcnt vmcnt(21)
    buffer_load_dwordx4 v2, s[4:7], s78 offen offset:1024 nt lds
    v_add_u32 v5, 3, v5
    v_readlane_b32 s83, v3, 4
    s_mul_i32 s86, s86, 12288
    s_waitcnt vmcnt(21)
    buffer_load_dwordx4 v2, s[4:7], s78 offen offset:2048 nt lds
    v_readlane_b32 s84, v3, 0
    ds_read_b32 v3, v7
    s_add_u32 s82, s82, 1
    s_cmp_ge_u32 s81, 255
    s_cselect_b32 s83, -1, s83
    s_cmp_ge_u32 s81, 128
    s_waitcnt vmcnt(21)
    buffer_load_dwordx4 v2, s[4:7], s78 offen offset:3072 nt lds
    ds_write_b32 v6, v5
    s_cselect_b64 s[4:5], s[56:57], s[50:51]
    s_mov_b32 m0, s86
    s_mov_b32 s78, s80
    s_cmp_eq_u32 s83, 22
    s_cbranch_scc1 L_B22
    s_cmp_eq_u32 s83, -1
    s_cbranch_scc1 L_D32
    s_cmp_eq_u32 s83, 21
    s_cbranch_scc1 L_D21
    s_cmp_eq_u32 s83, 23
    s_cbranch_scc1 L_D23
    s_branch L_disp
L_D17:
    s_mul_i32 s92, s81, 12
    s_add_u32 s92, s92, 31
    v_mov_b32 v5, s92
L_B17:
L_B17_0:
    s_cmp_lt_i32 s84, s82
    s_cbranch_scc1 L_B17_0w
    s_waitcnt vmcnt(16)
    buffer_load_dwordx4 v2, s[4:7], s78 offen offset:0 nt lds
    v_add_u32 v5, 3, v5
    s_add_u32 s81, s81, 1
    s_and_b32 s92, s81, 7
    s_waitcnt vmcnt(16)
    buffer_load_dwordx4 v2, s[4:7], s78 offen offset:1024 nt lds
    v_readlane_b32 s84, v3, 1
    ds_read_b32 v3, v7
    s_lshl_b32 s92, s92, 11
    s_add_u32 s92, s92, s77
    s_waitcnt vmcnt(16)
    buffer_load_dwordx4 v2, s[4:7], s78 offen offset:2048 nt lds
    ds_write_b32 v6, v5
    s_and_b32 s92, s92, 16383
    s_mul_i32 s80, s92, 768
L_B17_1:
    s_cmp_lt_i32 s84, s82
    s_cbranch_scc1 L_B17_1w
    s_waitcnt vmcnt(16)
    buffer_load_dwordx4 v2, s[4:7], s78 offen offset:3072 nt lds
    v_add_u32 v5, 3, v5
    s_add_u32 m0, m0, s85
    s_add_u32 s78, s78, s85
    s_waitcnt vmcnt(16)
    buffer_load_dwordx4 v2, s[4:7], s78 offen offset:0 nt lds
    v_readlane_b32 s84, v3, 2
    ds_read_b32 v3, v7
    s_bfe_u32 s92, s81, 0x40003
    s_bfe_i32 s93, s81, 0x10007
    s_waitcnt vmcnt(16)
    buffer_load_dwordx4 v2, s[4:7], s78 offen offset:1024 nt lds
    ds_write_b32 v6, v5
    s_xor_b32 s92, s92, s93
    s_and_b32 s92, s92, 15
L_B17_2:
    s_cmp_lt_i32 s84, s82
    s_cbranch_scc1 L_B17_2w
    s_waitcnt vmcnt(16)
    buffer_load_dwordx4 v2, s[4:7], s78 offen offset:2048 nt lds
    v_add_u32 v5, 3, v5
    s_mul_i32 s92, s92, 25165824
    s_add_u32 s80, s80, s79
    s_waitcnt vmcnt(16)
    buffer_load_dwordx4 v2, s[4:7], s78 offen offset:3072 nt lds
    v_readlane_b32 s84, v3, 3
    ds_read_b32 v3, v7
    s_add_u32 m0, m0, s85
    s_add_u32 s78, s78, s85
    s_waitcnt vmcnt(16)
    buffer_load_dwordx4 v2, s[4:7], s78 offen offset:0 nt lds
    ds_write_b32 v6, v5
    s_add_u32 s80, s80, s92
    s_and_b32 s86, s81, 3
L_B17_3:
    s_cmp_lt_i32 s84, s82
    s_cbranch_scc1 L_B17_3w
    s_waitcnt vmcnt(16)
    buffer_load_dwordx4 v2, s[4:7], s78 offen offset:1024 nt lds
    v_add_u32 v5, 3, v5
    v_readlane_b32 s83, v3, 4
    s_mul_i32 s86, s86, 12288
    s_waitcnt vmcnt(16)
    buffer_load_dwordx4 v2, s[4:7], s78 offen offset:2048 nt lds
    v_readlane_b32 s84, v3, 0
    ds_read_b32 v3, v7
    s_add_u32 s82, s82, 1
    s_cmp_ge_u32 s81, 255
    s_cselect_b32 s83, -1, s83
    s_cmp_ge_u32 s81, 128
    s_waitcnt vmcnt(16)
    buffer_load_dwordx4 v2, s[4:7], s78 offen offset:3072 nt lds
    ds_write_b32 v6, v5
    s_cselect_b64 s[4:5], s[56:57], s[50:51]
    s_mov_b32 m0, s86
    s_mov_b32 s78, s80
    s_cmp_eq_u32 s83, 17
    s_cbranch_scc1 L_B17
    s_cmp_eq_u32 s83, -1
    s_cbranch_scc1 L_D32
    s_cmp_eq_u32 s83, 18
    s_cbranch_scc1 L_D18
    s_cmp_eq_u32 s83, 16
    s_cbranch_scc1 L_D16
    s_branch L_disp
L_D23:
    s_mul_i32 s92, s81, 12
    s_add_u32 s92, s92, 25
    v_mov_b32 v5, s92
L_B23:
L_B23_0:
    s_cmp_lt_i32 s84, s82
    s_cbranch_scc1 L_B23_0w
    s_waitcnt vmcnt(22)
    buffer_load_dwordx4 v2, s[4:7], s78 offen offset:0 nt lds
    v_add_u32 v5, 3, v5
    s_add_u32 s81, s81, 1
    s_and_b32 s92, s81, 7
    s_waitcnt vmcnt(22)
    buffer_load_dwordx4 v2, s[4:7], s78 offen offset:1024 nt lds
    v_readlane_b32 s84, v3, 1
    ds_read_b32 v3, v7
    s_lshl_b32 s92, s92, 11
    s_add_u32 s92, s92, s77
    s_waitcnt vmcnt(22)
    buffer_load_dwordx4 v2, s[4:7], s78 offen offset:2048 nt lds
    ds_write_b32 v6, v5
    s_and_b32 s92, s92, 16383
    s_mul_i32 s80, s92, 768
L_B23_1:
    s_cmp_lt_i32 s84, s82
    s_cbranch_scc1 L_B23_1w
    s_waitcnt vmcnt(22)
    buffer_load_dwordx4 v2, s[4:7], s78 offen offset:3072 nt lds
    v_add_u32 v5, 3, v5
    s_add_u32 m0, m0, s85
    s_add_u32 s78, s78, s85
    s_waitcnt vmcnt(22)
    buffer_load_dwordx4 v2, s[4:7], s78 offen offset:0 nt lds
    v_readlane_b32 s84, v3, 2
    ds_read_b32 v3, v7
    s_bfe_u32 s92, s81, 0x40003
    s_bfe_i32 s93, s81, 0x10007
    s_waitcnt vmcnt(22)
    buffer_load_dwordx4 v2, s[4:7], s78 offen offset:1024 nt lds
    ds_write_b32 v6, v5
    s_xor_b32 s92, s92, s93
    s_and_b32 s92, s92, 15
L_B23_2:
    s_cmp_lt_i32 s84, s82
    s_cbranch_scc1 L_B23_2w
    s_waitcnt vmcnt(22)
    buffer_load_dwordx4 v2, s[4:7], s78 offen offset:2048 nt lds
    v_add_u32 v5, 3, v5
    s_mul_i32 s92, s92, 25165824
    s_add_u32 s80, s80, s79
    s_waitcnt vmcnt(22)
    buffer_load_dwordx4 v2, s[4:7], s78 offen offset:3072 nt lds
    v_readlane_b32 s84, v3, 3
    ds_read_b32 v3, v7
    s_add_u32 m0, m0, s85
    s_add_u32 s78, s78, s85
    s_waitcnt vmcnt(22)
    buffer_load_dwordx4 v2, s[4:7], s78 offen offset:0 nt lds
    ds_write_b32 v6, v5
    s_add_u32 s80, s80, s92
    s_and_b32 s86, s81, 3
L_B23_3:
    s_cmp_lt_i32 s84, s82
    s_cbranch_scc1 L_B23_3w
    s_waitcnt vmcnt(22)
    buffer_load_dwordx4 v2, s[4:7], s78 offen offset:1024 nt lds
    v_add_u32 v5, 3, v5
    v_readlane_b32 s83, v3, 4
    s_mul_i32 s86, s86, 12288
    s_waitcnt vmcnt(22)
    buffer_load_dwordx4 v2, s[4:7], s78 offen offset:2048 nt lds
    v_readlane_b32 s84, v3, 0
    ds_read_b32 v3, v7
    s_add_u32 s82, s82, 1
    s_cmp_ge_u32 s81, 255
    s_cselect_b32 s83, -1, s83
    s_cmp_ge_u32 s81, 128
    s_waitcnt vmcnt(22)
    buffer_load_dwordx4 v2, s[4:7], s78 offen offset:3072 nt lds
    ds_write_b32 v6, v5
    s_cselect_b64 s[4:5], s[56:57], s[50:51]
    s_mov_b32 m0, s86
    s_mov_b32 s78, s80
    s_cmp_eq_u32 s83, 23
    s_cbranch_scc1 L_B23
    s_cmp_eq_u32 s83, -1
    s_cbranch_scc1 L_D32
    s_cmp_eq_u32 s83, 22
    s_cbranch_scc1 L_D22
    s_cmp_eq_u32 s83, 24
    s_cbranch_scc1 L_D24
    s_branch L_disp
L_D16:
    s_mul_i32 s92, s81, 12
    s_add_u32 s92, s92, 32
    v_mov_b32 v5, s92
L_B16:
L_B16_0:
    s_cmp_lt_i32 s84, s82
    s_cbranch_scc1 L_B16_0w
    s_waitcnt vmcnt(15)
    buffer_load_dwordx4 v2, s[4:7], s78 offen offset:0 nt lds
    v_add_u32 v5, 3, v5
    s_add_u32 s81, s81, 1
    s_and_b32 s92, s81, 7
    s_waitcnt vmcnt(15)
    buffer_load_dwordx4 v2, s[4:7], s78 offen offset:1024 nt lds
    v_readlane_b32 s84, v3, 1
    ds_read_b32 v3, v7
    s_lshl_b32 s92, s92, 11
    s_add_u32 s92, s92, s77
    s_waitcnt vmcnt(15)
    buffer_load_dwordx4 v2, s[4:7], s78 offen offset:2048 nt lds
    ds_write_b32 v6, v5
    s_and_b32 s92, s92, 16383
    s_mul_i32 s80, s92, 768
L_B16_1:
    s_cmp_lt_i32 s84, s82
    s_cbranch_scc1 L_B16_1w
    s_waitcnt vmcnt(15)
    buffer_load_dwordx4 v2, s[4:7], s78 offen offset:3072 nt lds
    v_add_u32 v5, 3, v5
    s_add_u32 m0, m0, s85
    s_add_u32 s78, s78, s85
    s_waitcnt vmcnt(15)
    buffer_load_dwordx4 v2, s[4:7], s78 offen offset:0 nt lds
    v_readlane_b32 s84, v3, 2
    ds_read_b32 v3, v7
    s_bfe_u32 s92, s81, 0x40003
    s_bfe_i32 s93, s81, 0x10007
    s_waitcnt vmcnt(15)
    buffer_load_dwordx4 v2, s[4:7], s78 offen offset:1024 nt lds
    ds_write_b32 v6, v5
    s_xor_b32 s92, s92, s93
    s_and_b32 s92, s92, 15
L_B16_2:
    s_cmp_lt_i32 s84, s82
    s_cbranch_scc1 L_B16_2w
    s_waitcnt vmcnt(15)
    buffer_load_dwordx4 v2, s[4:7], s78 offen offset:2048 nt lds
    v_add_u32 v5, 3, v5
    s_mul_i32 s92, s92, 25165824
    s_add_u32 s80, s80, s79
    s_waitcnt vmcnt(15)
    buffer_load_dwordx4 v2, s[4:7], s78 offen offset:3072 nt lds
    v_readlane_b32 s84, v3, 3
    ds_read_b32 v3, v7
    s_add_u32 m0, m0, s85
    s_add_u32 s78, s78, s85
    s_waitcnt vmcnt(15)
    buffer_load_dwordx4 v2, s[4:7], s78 offen offset:0 nt lds
    ds_write_b32 v6, v5
    s_add_u32 s80, s80, s92
    s_and_b32 s86, s81, 3
L_B16_3:
    s_cmp_lt_i32 s84, s82
    s_cbranch_scc1 L_B16_3w
    s_waitcnt vmcnt(15)
    buffer_load_dwordx4 v2, s[4:7], s78 offen offset:1024 nt lds
    v_add_u32 v5, 3, v5
    v_readlane_b32 s83, v3, 4
    s_mul_i32 s86, s86, 12288
    s_waitcnt vmcnt(15)
    buffer_load_dwordx4 v2, s[4:7], s78 offen offset:2048 nt lds
    v_readlane_b32 s84, v3, 0
    ds_read_b32 v3, v7
    s_add_u32 s82, s82, 1
    s_cmp_ge_u32 s81, 255
    s_cselect_b32 s83, -1, s83
    s_cmp_ge_u32 s81, 128
    s_waitcnt vmcnt(15)
    buffer_load_dwordx4 v2, s[4:7], s78 offen offset:3072 nt lds
    ds_write_b32 v6, v5
    s_cselect_b64 s[4:5], s[56:57], s[50:51]
    s_mov_b32 m0, s86
    s_mov_b32 s78, s80
    s_cmp_eq_u32 s83, 16
    s_cbranch_scc1 L_B16
    s_cmp_eq_u32 s83, -1
    s_cbranch_scc1 L_D32
    s_cmp_eq_u32 s83, 17
    s_cbranch_scc1 L_D17
    s_cmp_eq_u32 s83, 15
    s_cbranch_scc1 L_D15
    s_branch L_disp
L_D24:
    s_mul_i32 s92, s81, 12
    s_add_u32 s92, s92, 24
    v_mov_b32 v5, s92
L_B24:
L_B24_0:
    s_cmp_lt_i32 s84, s82
    s_cbranch_scc1 L_B24_0w
    s_waitcnt vmcnt(23)
    buffer_load_dwordx4 v2, s[4:7], s78 offen offset:0 nt lds
    v_add_u32 v5, 3, v5
    s_add_u32 s81, s81, 1
    s_and_b32 s92, s81, 7
    s_waitcnt vmcnt(23)
    buffer_load_dwordx4 v2, s[4:7], s78 offen offset:1024 nt lds
    v_readlane_b32 s84, v3, 1
    ds_read_b32 v3, v7
    s_lshl_b32 s92, s92, 11
    s_add_u32 s92, s92, s77
    s_waitcnt vmcnt(23)
    buffer_load_dwordx4 v2, s[4:7], s78 offen offset:2048 nt lds
    ds_write_b32 v6, v5
    s_and_b32 s92, s92, 16383
    s_mul_i32 s80, s92, 768
L_B24_1:
    s_cmp_lt_i32 s84, s82
    s_cbranch_scc1 L_B24_1w
    s_waitcnt vmcnt(23)
    buffer_load_dwordx4 v2, s[4:7], s78 offen offset:3072 nt lds
    v_add_u32 v5, 3, v5
    s_add_u32 m0, m0, s85
    s_add_u32 s78, s78, s85
    s_waitcnt vmcnt(23)
    buffer_load_dwordx4 v2, s[4:7], s78 offen offset:0 nt lds
    v_readlane_b32 s84, v3, 2
    ds_read_b32 v3, v7
    s_bfe_u32 s92, s81, 0x40003
    s_bfe_i32 s93, s81, 0x10007
    s_waitcnt vmcnt(23)
    buffer_load_dwordx4 v2, s[4:7], s78 offen offset:1024 nt lds
    ds_write_b32 v6, v5
    s_xor_b32 s92, s92, s93
    s_and_b32 s92, s92, 15
L_B24_2:
    s_cmp_lt_i32 s84, s82
    s_cbranch_scc1 L_B24_2w
    s_waitcnt vmcnt(23)
    buffer_load_dwordx4 v2, s[4:7], s78 offen offset:2048 nt lds
    v_add_u32 v5, 3, v5
    s_mul_i32 s92, s92, 25165824
    s_add_u32 s80, s80, s79
    s_waitcnt vmcnt(23)
    buffer_load_dwordx4 v2, s[4:7], s78 offen offset:3072 nt lds
    v_readlane_b32 s84, v3, 3
    ds_read_b32 v3, v7
    s_add_u32 m0, m0, s85
    s_add_u32 s78, s78, s85
    s_waitcnt vmcnt(23)
    buffer_load_dwordx4 v2, s[4:7], s78 offen offset:0 nt lds
    ds_write_b32 v6, v5
    s_add_u32 s80, s80, s92
    s_and_b32 s86, s81, 3
L_B24_3:
    s_cmp_lt_i32 s84, s82
    s_cbranch_scc1 L_B24_3w
    s_waitcnt vmcnt(23)
    buffer_load_dwordx4 v2, s[4:7], s78 offen offset:1024 nt lds
    v_add_u32 v5, 3, v5
    v_readlane_b32 s83, v3, 4
    s_mul_i32 s86, s86, 12288
    s_waitcnt vmcnt(23)
    buffer_load_dwordx4 v2, s[4:7], s78 offen offset:2048 nt lds
    v_readlane_b32 s84, v3, 0
    ds_read_b32 v3, v7
    s_add_u32 s82, s82, 1
    s_cmp_ge_u32 s81, 255
    s_cselect_b32 s83, -1, s83
    s_cmp_ge_u32 s81, 128
    s_waitcnt vmcnt(23)
    buffer_load_dwordx4 v2, s[4:7], s78 offen offset:3072 nt lds
    ds_write_b32 v6, v5
    s_cselect_b64 s[4:5], s[56:57], s[50:51]
    s_mov_b32 m0, s86
    s_mov_b32 s78, s80
    s_cmp_eq_u32 s83, 24
    s_cbranch_scc1 L_B24
    s_cmp_eq_u32 s83, -1
    s_cbranch_scc1 L_D32
    s_cmp_eq_u32 s83, 23
    s_cbranch_scc1 L_D23
    s_cmp_eq_u32 s83, 25
    s_cbranch_scc1 L_D25
    s_branch L_disp
L_D15:
    s_mul_i32 s92, s81, 12
    s_add_u32 s92, s92, 33
    v_mov_b32 v5, s92
L_B15:
L_B15_0:
    s_cmp_lt_i32 s84, s82
    s_cbranch_scc1 L_B15_0w
    s_waitcnt vmcnt(14)
    buffer_load_dwordx4 v2, s[4:7], s78 offen offset:0 nt lds
    v_add_u32 v5, 3, v5
    s_add_u32 s81, s81, 1
    s_and_b32 s92, s81, 7
    s_waitcnt vmcnt(14)
    buffer_load_dwordx4 v2, s[4:7], s78 offen offset:1024 nt lds
    v_readlane_b32 s84, v3, 1
    ds_read_b32 v3, v7
    s_lshl_b32 s92, s92, 11
    s_add_u32 s92, s92, s77
    s_waitcnt vmcnt(14)
    buffer_load_dwordx4 v2, s[4:7], s78 offen offset:2048 nt lds
    ds_write_b32 v6, v5
    s_and_b32 s92, s92, 16383
    s_mul_i32 s80, s92, 768
L_B15_1:
    s_cmp_lt_i32 s84, s82
    s_cbranch_scc1 L_B15_1w
    s_waitcnt vmcnt(14)
    buffer_load_dwordx4 v2, s[4:7], s78 offen offset:3072 nt lds
    v_add_u32 v5, 3, v5
    s_add_u32 m0, m0, s85
    s_add_u32 s78, s78, s85
    s_waitcnt vmcnt(14)
    buffer_load_dwordx4 v2, s[4:7], s78 offen offset:0 nt lds
    v_readlane_b32 s84, v3, 2
    ds_read_b32 v3, v7
    s_bfe_u32 s92, s81, 0x40003
    s_bfe_i32 s93, s81, 0x10007
    s_waitcnt vmcnt(14)
    buffer_load_dwordx4 v2, s[4:7], s78 offen offset:1024 nt lds
    ds_write_b32 v6, v5
    s_xor_b32 s92, s92, s93
    s_and_b32 s92, s92, 15
L_B15_2:
    s_cmp_lt_i32 s84, s82
    s_cbranch_scc1 L_B15_2w
    s_waitcnt vmcnt(14)
    buffer_load_dwordx4 v2, s[4:7], s78 offen offset:2048 nt lds
    v_add_u32 v5, 3, v5
    s_mul_i32 s92, s92, 25165824
    s_add_u32 s80, s80, s79
    s_waitcnt vmcnt(14)
    buffer_load_dwordx4 v2, s[4:7], s78 offen offset:3072 nt lds
    v_readlane_b32 s84, v3, 3
    ds_read_b32 v3, v7
    s_add_u32 m0, m0, s85
    s_add_u32 s78, s78, s85
    s_waitcnt vmcnt(14)
    buffer_load_dwordx4 v2, s[4:7], s78 offen offset:0 nt lds
    ds_write_b32 v6, v5
    s_add_u32 s80, s80, s92
    s_and_b32 s86, s81, 3
L_B15_3:
    s_cmp_lt_i32 s84, s82
    s_cbranch_scc1 L_B15_3w
    s_waitcnt vmcnt(14)
    buffer_load_dwordx4 v2, s[4:7], s78 offen offset:1024 nt lds
    v_add_u32 v5, 3, v5
    v_readlane_b32 s83, v3, 4
    s_mul_i32 s86, s86, 12288
    s_waitcnt vmcnt(14)
    buffer_load_dwordx4 v2, s[4:7], s78 offen offset:2048 nt lds
    v_readlane_b32 s84, v3, 0
    ds_read_b32 v3, v7
    s_add_u32 s82, s82, 1
    s_cmp_ge_u32 s81, 255
    s_cselect_b32 s83, -1, s83
    s_cmp_ge_u32 s81, 128
    s_waitcnt vmcnt(14)
    buffer_load_dwordx4 v2, s[4:7], s78 offen offset:3072 nt lds
    ds_write_b32 v6, v5
    s_cselect_b64 s[4:5], s[56:57], s[50:51]
    s_mov_b32 m0, s86
    s_mov_b32 s78, s80
    s_cmp_eq_u32 s83, 15
    s_cbranch_scc1 L_B15
    s_cmp_eq_u32 s83, -1
    s_cbranch_scc1 L_D32
    s_cmp_eq_u32 s83, 16
    s_cbranch_scc1 L_D16
    s_branch L_disp
L_D25:
    s_mul_i32 s92, s81, 12
    s_add_u32 s92, s92, 23
    v_mov_b32 v5, s92
L_B25:
L_B25_0:
    s_cmp_lt_i32 s84, s82
    s_cbranch_scc1 L_B25_0w
    s_waitcnt vmcnt(24)
    buffer_load_dwordx4 v2, s[4:7], s78 offen offset:0 nt lds
    v_add_u32 v5, 3, v5
    s_add_u32 s81, s81, 1
    s_and_b32 s92, s81, 7
    s_waitcnt vmcnt(24)
    buffer_load_dwordx4 v2, s[4:7], s78 offen offset:1024 nt lds
    v_readlane_b32 s84, v3, 1
    ds_read_b32 v3, v7
    s_lshl_b32 s92, s92, 11
    s_add_u32 s92, s92, s77
    s_waitcnt vmcnt(24)
    buffer_load_dwordx4 v2, s[4:7], s78 offen offset:2048 nt lds
    ds_write_b32 v6, v5
    s_and_b32 s92, s92, 16383
    s_mul_i32 s80, s92, 768
L_B25_1:
    s_cmp_lt_i32 s84, s82
    s_cbranch_scc1 L_B25_1w
    s_waitcnt vmcnt(24)
    buffer_load_dwordx4 v2, s[4:7], s78 offen offset:3072 nt lds
    v_add_u32 v5, 3, v5
    s_add_u32 m0, m0, s85
    s_add_u32 s78, s78, s85
    s_waitcnt vmcnt(24)
    buffer_load_dwordx4 v2, s[4:7], s78 offen offset:0 nt lds
    v_readlane_b32 s84, v3, 2
    ds_read_b32 v3, v7
    s_bfe_u32 s92, s81, 0x40003
    s_bfe_i32 s93, s81, 0x10007
    s_waitcnt vmcnt(24)
    buffer_load_dwordx4 v2, s[4:7], s78 offen offset:1024 nt lds
    ds_write_b32 v6, v5
    s_xor_b32 s92, s92, s93
    s_and_b32 s92, s92, 15
L_B25_2:
    s_cmp_lt_i32 s84, s82
    s_cbranch_scc1 L_B25_2w
    s_waitcnt vmcnt(24)
    buffer_load_dwordx4 v2, s[4:7], s78 offen offset:2048 nt lds
    v_add_u32 v5, 3, v5
    s_mul_i32 s92, s92, 25165824
    s_add_u32 s80, s80, s79
    s_waitcnt vmcnt(24)
    buffer_load_dwordx4 v2, s[4:7], s78 offen offset:3072 nt lds
    v_readlane_b32 s84, v3, 3
    ds_read_b32 v3, v7
    s_add_u32 m0, m0, s85
    s_add_u32 s78, s78, s85
    s_waitcnt vmcnt(24)
    buffer_load_dwordx4 v2, s[4:7], s78 offen offset:0 nt lds
    ds_write_b32 v6, v5
    s_add_u32 s80, s80, s92
    s_and_b32 s86, s81, 3
L_B25_3:
    s_cmp_lt_i32 s84, s82
    s_cbranch_scc1 L_B25_3w
    s_waitcnt vmcnt(24)
    buffer_load_dwordx4 v2, s[4:7], s78 offen offset:1024 nt lds
    v_add_u32 v5, 3, v5
    v_readlane_b32 s83, v3, 4
    s_mul_i32 s86, s86, 12288
    s_waitcnt vmcnt(24)
    buffer_load_dwordx4 v2, s[4:7], s78 offen offset:2048 nt lds
    v_readlane_b32 s84, v3, 0
    ds_read_b32 v3, v7
    s_add_u32 s82, s82, 1
    s_cmp_ge_u32 s81, 255
    s_cselect_b32 s83, -1, s83
    s_cmp_ge_u32 s81, 128
    s_waitcnt vmcnt(24)
    buffer_load_dwordx4 v2, s[4:7], s78 offen offset:3072 nt lds
    ds_write_b32 v6, v5
    s_cselect_b64 s[4:5], s[56:57], s[50:51]
    s_mov_b32 m0, s86
    s_mov_b32 s78, s80
    s_cmp_eq_u32 s83, 25
    s_cbranch_scc1 L_B25
    s_cmp_eq_u32 s83, -1
    s_cbranch_scc1 L_D32
    s_cmp_eq_u32 s83, 24
    s_cbranch_scc1 L_D24
    s_cmp_eq_u32 s83, 26
    s_cbranch_scc1 L_D26
    s_branch L_disp
L_D26:
    s_mul_i32 s92, s81, 12
    s_add_u32 s92, s92, 22
    v_mov_b32 v5, s92
L_B26:
L_B26_0:
    s_cmp_lt_i32 s84, s82
    s_cbranch_scc1 L_B26_0w
    s_waitcnt vmcnt(25)
    buffer_load_dwordx4 v2, s[4:7], s78 offen offset:0 nt lds
    v_add_u32 v5, 3, v5
    s_add_u32 s81, s81, 1
    s_and_b32 s92, s81, 7
    s_waitcnt vmcnt(25)
    buffer_load_dwordx4 v2, s[4:7], s78 offen offset:1024 nt lds
    v_readlane_b32 s84, v3, 1
    ds_read_b32 v3, v7
    s_lshl_b32 s92, s92, 11
    s_add_u32 s92, s92, s77
    s_waitcnt vmcnt(25)
    buffer_load_dwordx4 v2, s[4:7], s78 offen offset:2048 nt lds
    ds_write_b32 v6, v5
    s_and_b32 s92, s92, 16383
    s_mul_i32 s80, s92, 768
L_B26_1:
    s_cmp_lt_i32 s84, s82
    s_cbranch_scc1 L_B26_1w
    s_waitcnt vmcnt(25)
    buffer_load_dwordx4 v2, s[4:7], s78 offen offset:3072 nt lds
    v_add_u32 v5, 3, v5
    s_add_u32 m0, m0, s85
    s_add_u32 s78, s78, s85
    s_waitcnt vmcnt(25)
    buffer_load_dwordx4 v2, s[4:7], s78 offen offset:0 nt lds
    v_readlane_b32 s84, v3, 2
    ds_read_b32 v3, v7
    s_bfe_u32 s92, s81, 0x40003
    s_bfe_i32 s93, s81, 0x10007
    s_waitcnt vmcnt(25)
    buffer_load_dwordx4 v2, s[4:7], s78 offen offset:1024 nt lds
    ds_write_b32 v6, v5
    s_xor_b32 s92, s92, s93
    s_and_b32 s92, s92, 15
L_B26_2:
    s_cmp_lt_i32 s84, s82
    s_cbranch_scc1 L_B26_2w
    s_waitcnt vmcnt(25)
    buffer_load_dwordx4 v2, s[4:7], s78 offen offset:2048 nt lds
    v_add_u32 v5, 3, v5
    s_mul_i32 s92, s92, 25165824
    s_add_u32 s80, s80, s79
    s_waitcnt vmcnt(25)
    buffer_load_dwordx4 v2, s[4:7], s78 offen offset:3072 nt lds
    v_readlane_b32 s84, v3, 3
    ds_read_b32 v3, v7
    s_add_u32 m0, m0, s85
    s_add_u32 s78, s78, s85
    s_waitcnt vmcnt(25)
    buffer_load_dwordx4 v2, s[4:7], s78 offen offset:0 nt lds
    ds_write_b32 v6, v5
    s_add_u32 s80, s80, s92
    s_and_b32 s86, s81, 3
L_B26_3:
    s_cmp_lt_i32 s84, s82
    s_cbranch_scc1 L_B26_3w
    s_waitcnt vmcnt(25)
    buffer_load_dwordx4 v2, s[4:7], s78 offen offset:1024 nt lds
    v_add_u32 v5, 3, v5
    v_readlane_b32 s83, v3, 4
    s_mul_i32 s86, s86, 12288
    s_waitcnt vmcnt(25)
    buffer_load_dwordx4 v2, s[4:7], s78 offen offset:2048 nt lds
    v_readlane_b32 s84, v3, 0
    ds_read_b32 v3, v7
    s_add_u32 s82, s82, 1
    s_cmp_ge_u32 s81, 255
    s_cselect_b32 s83, -1, s83
    s_cmp_ge_u32 s81, 128
    s_waitcnt vmcnt(25)
    buffer_load_dwordx4 v2, s[4:7], s78 offen offset:3072 nt lds
    ds_write_b32 v6, v5
    s_cselect_b64 s[4:5], s[56:57], s[50:51]
    s_mov_b32 m0, s86
    s_mov_b32 s78, s80
    s_cmp_eq_u32 s83, 26
    s_cbranch_scc1 L_B26
    s_cmp_eq_u32 s83, -1
    s_cbranch_scc1 L_D32
    s_cmp_eq_u32 s83, 25
    s_cbranch_scc1 L_D25
    s_branch L_disp
L_B20_0w:
    ds_read_b32 v3, v7
    s_waitcnt lgkmcnt(0)
    v_readlane_b32 s84, v3, 0
    s_nop 0
    s_branch L_B20_0
L_B20_1w:
    ds_read_b32 v3, v7
    s_waitcnt lgkmcnt(0)
    v_readlane_b32 s84, v3, 1
    s_nop 0
    s_branch L_B20_1
L_B20_2w:
    ds_read_b32 v3, v7
    s_waitcnt lgkmcnt(0)
    v_readlane_b32 s84, v3, 2
    s_nop 0
    s_branch L_B20_2
L_B20_3w:
    ds_read_b32 v3, v7
    s_waitcnt lgkmcnt(0)
    v_readlane_b32 s84, v3, 3
    s_nop 0
    s_branch L_B20_3
L_B19_0w:
    ds_read_b32 v3, v7
    s_waitcnt lgkmcnt(0)
    v_readlane_b32 s84, v3, 0
    s_nop 0
    s_branch L_B19_0
L_B19_1w:
    ds_read_b32 v3, v7
    s_waitcnt lgkmcnt(0)
    v_readlane_b32 s84, v3, 1
    s_nop 0
    s_branch L_B19_1
L_B19_2w:
    ds_read_b32 v3, v7
    s_waitcnt lgkmcnt(0)
    v_readlane_b32 s84, v3, 2
    s_nop 0
    s_branch L_B19_2
L_B19_3w:
    ds_read_b32 v3, v7
    s_waitcnt lgkmcnt(0)
    v_readlane_b32 s84, v3, 3
    s_nop 0
    s_branch L_B19_3
L_B21_0w:
    ds_read_b32 v3, v7
    s_waitcnt lgkmcnt(0)
    v_readlane_b32 s84, v3, 0
    s_nop 0
    s_branch L_B21_0
L_B21_1w:
    ds_read_b32 v3, v7
    s_waitcnt lgkmcnt(0)
    v_readlane_b32 s84, v3, 1
    s_nop 0
    s_branch L_B21_1
L_B21_2w:
    ds_read_b32 v3, v7
    s_waitcnt lgkmcnt(0)
    v_readlane_b32 s84, v3, 2
    s_nop 0
    s_branch L_B21_2
L_B21_3w:
    ds_read_b32 v3, v7
    s_waitcnt lgkmcnt(0)
    v_readlane_b32 s84, v3, 3
    s_nop 0
    s_branch L_B21_3
L_B18_0w:
    ds_read_b32 v3, v7
    s_waitcnt lgkmcnt(0)
    v_readlane_b32 s84, v3, 0
    s_nop 0
    s_branch L_B18_0
L_B18_1w:
    ds_read_b32 v3, v7
    s_waitcnt lgkmcnt(0)
    v_readlane_b32 s84, v3, 1
    s_nop 0
    s_branch L_B18_1
L_B18_2w:
    ds_read_b32 v3, v7
    s_waitcnt lgkmcnt(0)
    v_readlane_b32 s84, v3, 2
    s_nop 0
    s_branch L_B18_2
L_B18_3w:
    ds_read_b32 v3, v7
    s_waitcnt lgkmcnt(0)
    v_readlane_b32 s84, v3, 3
    s_nop 0
    s_branch L_B18_3
L_B22_0w:
    ds_read_b32 v3, v7
    s_waitcnt lgkmcnt(0)
    v_readlane_b32 s84, v3, 0
    s_nop 0
    s_branch L_B22_0
L_B22_1w:
    ds_read_b32 v3, v7
    s_waitcnt lgkmcnt(0)
    v_readlane_b32 s84, v3, 1
    s_nop 0
    s_branch L_B22_1
L_B22_2w:
    ds_read_b32 v3, v7
    s_waitcnt lgkmcnt(0)
    v_readlane_b32 s84, v3, 2
    s_nop 0
    s_branch L_B22_2
L_B22_3w:
    ds_read_b32 v3, v7
    s_waitcnt lgkmcnt(0)
    v_readlane_b32 s84, v3, 3
    s_nop 0
    s_branch L_B22_3
L_B17_0w:
    ds_read_b32 v3, v7
    s_waitcnt lgkmcnt(0)
    v_readlane_b32 s84, v3, 0
    s_nop 0
    s_branch L_B17_0
L_B17_1w:
    ds_read_b32 v3, v7
    s_waitcnt lgkmcnt(0)
    v_readlane_b32 s84, v3, 1
    s_nop 0
    s_branch L_B17_1
L_B17_2w:
    ds_read_b32 v3, v7
    s_waitcnt lgkmcnt(0)
    v_readlane_b32 s84, v3, 2
    s_nop 0
    s_branch L_B17_2
L_B17_3w:
    ds_read_b32 v3, v7
    s_waitcnt lgkmcnt(0)
    v_readlane_b32 s84, v3, 3
    s_nop 0
    s_branch L_B17_3
L_B23_0w:
    ds_read_b32 v3, v7
    s_waitcnt lgkmcnt(0)
    v_readlane_b32 s84, v3, 0
    s_nop 0
    s_branch L_B23_0
L_B23_1w:
    ds_read_b32 v3, v7
    s_waitcnt lgkmcnt(0)
    v_readlane_b32 s84, v3, 1
    s_nop 0
    s_branch L_B23_1
L_B23_2w:
    ds_read_b32 v3, v7
    s_waitcnt lgkmcnt(0)
    v_readlane_b32 s84, v3, 2
    s_nop 0
    s_branch L_B23_2
L_B23_3w:
    ds_read_b32 v3, v7
    s_waitcnt lgkmcnt(0)
    v_readlane_b32 s84, v3, 3
    s_nop 0
    s_branch L_B23_3
L_B16_0w:
    ds_read_b32 v3, v7
    s_waitcnt lgkmcnt(0)
    v_readlane_b32 s84, v3, 0
    s_nop 0
    s_branch L_B16_0
L_B16_1w:
    ds_read_b32 v3, v7
    s_waitcnt lgkmcnt(0)
    v_readlane_b32 s84, v3, 1
    s_nop 0
    s_branch L_B16_1
L_B16_2w:
    ds_read_b32 v3, v7
    s_waitcnt lgkmcnt(0)
    v_readlane_b32 s84, v3, 2
    s_nop 0
    s_branch L_B16_2
L_B16_3w:
    ds_read_b32 v3, v7
    s_waitcnt lgkmcnt(0)
    v_readlane_b32 s84, v3, 3
    s_nop 0
    s_branch L_B16_3
L_B24_0w:
    ds_read_b32 v3, v7
    s_waitcnt lgkmcnt(0)
    v_readlane_b32 s84, v3, 0
    s_nop 0
    s_branch L_B24_0
L_B24_1w:
    ds_read_b32 v3, v7
    s_waitcnt lgkmcnt(0)
    v_readlane_b32 s84, v3, 1
    s_nop 0
    s_branch L_B24_1
L_B24_2w:
    ds_read_b32 v3, v7
    s_waitcnt lgkmcnt(0)
    v_readlane_b32 s84, v3, 2
    s_nop 0
    s_branch L_B24_2
L_B24_3w:
    ds_read_b32 v3, v7
    s_waitcnt lgkmcnt(0)
    v_readlane_b32 s84, v3, 3
    s_nop 0
    s_branch L_B24_3
L_B15_0w:
    ds_read_b32 v3, v7
    s_waitcnt lgkmcnt(0)
    v_readlane_b32 s84, v3, 0
    s_nop 0
    s_branch L_B15_0
L_B15_1w:
    ds_read_b32 v3, v7
    s_waitcnt lgkmcnt(0)
    v_readlane_b32 s84, v3, 1
    s_nop 0
    s_branch L_B15_1
L_B15_2w:
    ds_read_b32 v3, v7
    s_waitcnt lgkmcnt(0)
    v_readlane_b32 s84, v3, 2
    s_nop 0
    s_branch L_B15_2
L_B15_3w:
    ds_read_b32 v3, v7
    s_waitcnt lgkmcnt(0)
    v_readlane_b32 s84, v3, 3
    s_nop 0
    s_branch L_B15_3
L_B25_0w:
    ds_read_b32 v3, v7
    s_waitcnt lgkmcnt(0)
    v_readlane_b32 s84, v3, 0
    s_nop 0
    s_branch L_B25_0
L_B25_1w:
    ds_read_b32 v3, v7
    s_waitcnt lgkmcnt(0)
    v_readlane_b32 s84, v3, 1
    s_nop 0
    s_branch L_B25_1
L_B25_2w:
    ds_read_b32 v3, v7
    s_waitcnt lgkmcnt(0)
    v_readlane_b32 s84, v3, 2
    s_nop 0
    s_branch L_B25_2
L_B25_3w:
    ds_read_b32 v3, v7
    s_waitcnt lgkmcnt(0)
    v_readlane_b32 s84, v3, 3
    s_nop 0
    s_branch L_B25_3
L_B26_0w:
    ds_read_b32 v3, v7
    s_waitcnt lgkmcnt(0)
    v_readlane_b32 s84, v3, 0
    s_nop 0
    s_branch L_B26_0
L_B26_1w:
    ds_read_b32 v3, v7
    s_waitcnt lgkmcnt(0)
    v_readlane_b32 s84, v3, 1
    s_nop 0
    s_branch L_B26_1
L_B26_2w:
    ds_read_b32 v3, v7
    s_waitcnt lgkmcnt(0)
    v_readlane_b32 s84, v3, 2
    s_nop 0
    s_branch L_B26_2
L_B26_3w:
    ds_read_b32 v3, v7
    s_waitcnt lgkmcnt(0)
    v_readlane_b32 s84, v3, 3
    s_nop 0
    s_branch L_B26_3
L_B32_0w:
    ds_read_b32 v3, v7
    s_waitcnt lgkmcnt(0)
    v_readlane_b32 s84, v3, 0
    s_nop 0
    s_branch L_B32_0
L_B32_1w:
    ds_read_b32 v3, v7
    s_waitcnt lgkmcnt(0)
    v_readlane_b32 s84, v3, 1
    s_nop 0
    s_branch L_B32_1
L_B32_2w:
    ds_read_b32 v3, v7
    s_waitcnt lgkmcnt(0)
    v_readlane_b32 s84, v3, 2
    s_nop 0
    s_branch L_B32_2
L_B32_3w:
    ds_read_b32 v3, v7
    s_waitcnt lgkmcnt(0)
    v_readlane_b32 s84, v3, 3
    s_nop 0
    s_branch L_B32_3
L_tail:
L_D32:
    s_mul_i32 s92, s81, 12
    s_add_u32 s92, s92, 16
    v_mov_b32 v5, s92
L_B32:
L_B32_0:
    s_cmp_lt_i32 s84, s82
    s_cbranch_scc1 L_B32_0w
    s_waitcnt vmcnt(31)
    buffer_load_dwordx4 v2, s[4:7], s78 offen offset:0 nt lds
    v_add_u32 v5, 3, v5
    s_add_u32 s81, s81, 1
    s_and_b32 s92, s81, 7
    s_waitcnt vmcnt(31)
    buffer_load_dwordx4 v2, s[4:7], s78 offen offset:1024 nt lds
    v_readlane_b32 s84, v3, 1
    ds_read_b32 v3, v7
    s_lshl_b32 s92, s92, 11
    s_add_u32 s92, s92, s77
    s_waitcnt vmcnt(31)
    buffer_load_dwordx4 v2, s[4:7], s78 offen offset:2048 nt lds
    ds_write_b32 v6, v5
    s_and_b32 s92, s92, 16383
    s_mul_i32 s80, s92, 768
L_B32_1:
    s_cmp_lt_i32 s84, s82
    s_cbranch_scc1 L_B32_1w
    s_waitcnt vmcnt(31)
    buffer_load_dwordx4 v2, s[4:7], s78 offen offset:3072 nt lds
    v_add_u32 v5, 3, v5
    s_add_u32 m0, m0, s85
    s_add_u32 s78, s78, s85
    s_waitcnt vmcnt(31)
    buffer_load_dwordx4 v2, s[4:7], s78 offen offset:0 nt lds
    v_readlane_b32 s84, v3, 2
    ds_read_b32 v3, v7
    s_bfe_u32 s92, s81, 0x40003
    s_bfe_i32 s93, s81, 0x10007
    s_waitcnt vmcnt(31)
    buffer_load_dwordx4 v2, s[4:7], s78 offen offset:1024 nt lds
    ds_write_b32 v6, v5
    s_xor_b32 s92, s92, s93
    s_and_b32 s92, s92, 15
L_B32_2:
    s_cmp_lt_i32 s84, s82
    s_cbranch_scc1 L_B32_2w
    s_waitcnt vmcnt(31)
    buffer_load_dwordx4 v2, s[4:7], s78 offen offset:2048 nt lds
    v_add_u32 v5, 3, v5
    s_mul_i32 s92, s92, 25165824
    s_add_u32 s80, s80, s79
    s_waitcnt vmcnt(31)
    buffer_load_dwordx4 v2, s[4:7], s78 offen offset:3072 nt lds
    v_readlane_b32 s84, v3, 3
    ds_read_b32 v3, v7
    s_add_u32 m0, m0, s85
    s_add_u32 s78, s78, s85
    s_waitcnt vmcnt(31)
    buffer_load_dwordx4 v2, s[4:7], s78 offen offset:0 nt lds
    ds_write_b32 v6, v5
    s_add_u32 s80, s80, s92
    s_and_b32 s86, s81, 3
L_B32_3:
    s_cmp_lt_i32 s84, s82
    s_cbranch_scc1 L_B32_3w
    s_waitcnt vmcnt(31)
    buffer_load_dwordx4 v2, s[4:7], s78 offen offset:1024 nt lds
    v_add_u32 v5, 3, v5
    v_readlane_b32 s83, v3, 4
    s_mul_i32 s86, s86, 12288
    s_waitcnt vmcnt(31)
    buffer_load_dwordx4 v2, s[4:7], s78 offen offset:2048 nt lds
    v_readlane_b32 s84, v3, 0
    ds_read_b32 v3, v7
    s_add_u32 s82, s82, 1
    s_cmp_eq_u32 s81, 256
    s_cselect_b32 s83, -1, 32
    s_cmp_ge_u32 s81, 128
    s_waitcnt vmcnt(31)
    buffer_load_dwordx4 v2, s[4:7], s78 offen offset:3072 nt lds
    ds_write_b32 v6, v5
    s_cselect_b64 s[4:5], s[56:57], s[50:51]
    s_mov_b32 m0, s86
    s_mov_b32 s78, s80
    s_cmp_eq_u32 s83, 32
    s_cbranch_scc1 L_B32
L_drain:
    v_mov_b32 v18, 3090
    s_waitcnt vmcnt(30)
    ds_write_b32 v6, v18
    v_mov_b32 v18, 3093
    s_waitcnt vmcnt(27)
    ds_write_b32 v6, v18
    v_mov_b32 v18, 3096
    s_waitcnt vmcnt(24)
    ds_write_b32 v6, v18
    v_mov_b32 v18, 3099
    s_waitcnt vmcnt(21)
    ds_write_b32 v6, v18
    v_mov_b32 v18, 3102
    s_waitcnt vmcnt(18)
    ds_write_b32 v6, v18
    v_mov_b32 v18, 3105
    s_waitcnt vmcnt(15)
    ds_write_b32 v6, v18
    v_mov_b32 v18, 3108
    s_waitcnt vmcnt(12)
    ds_write_b32 v6, v18
    v_mov_b32 v18, 3111
    s_waitcnt vmcnt(9)
    ds_write_b32 v6, v18
    v_mov_b32 v18, 3114
    s_waitcnt vmcnt(6)
    ds_write_b32 v6, v18
    v_mov_b32 v18, 3117
    s_waitcnt vmcnt(3)
    ds_write_b32 v6, v18
    v_mov_b32 v18, 3120
    s_waitcnt vmcnt(0)
    ds_write_b32 v6, v18
    s_waitcnt lgkmcnt(0)
    s_endpgm
L_other:
    s_cmp_eq_u32 s76, 5
    s_cbranch_scc1 L_helper
    s_sub_u32 s78, s76, 1
    v_lshlrev_b32 v44, 3, v1
    v_cmp_gt_u32 vcc, 24, v1
    v_mov_b32 v23, 0xffffff40
    v_mov_b32 v18, 192
    v_cndmask_b32 v23, v23, v18, vcc
    v_add_u32 v45, v44, v23
    v_mov_b32 v18, 0x80008000
    v_cndmask_b32 v46, 0, v18, vcc
    v_lshrrev_b32 v19, 4, v1
    v_and_b32 v23, 15, v1
    v_mul_u32_u24 v20, 384, v19
    v_lshl_add_u32 v20, v23, 3, v20
    v_cmp_lt_u32 s[86:87], 7, v23
    v_mov_b32 v21, -64
    v_mov_b32 v18, 320
    v_cndmask_b32 v21, v18, v21, s[86:87]
    v_add_u32 v21, v20, v21
    s_lshl2_add_u32 s95, s78, s3
    s_mul_i32 s95, s95, 384
    s_lshl2_add_u32 s89, s78, s77
    s_xor_b32 s89, s89, 8192
    s_mov_b32 s34, 12288
    s_mov_b32 s35, 0x20000
    s_mov_b32 s38, 384
    s_mov_b32 s39, 0x20000
    s_mov_b32 s42, 384
    s_mov_b32 s43, 0x20000
    s_mov_b32 s14, 6291456
    s_mov_b32 s15, 0x20000
    s_mov_b32 s18, 6291456
    s_mov_b32 s19, 0x20000
    s_waitcnt lgkmcnt(0)
    s_mov_b64 s[32:33], s[48:49]
    s_mov_b64 s[36:37], s[62:63]
    s_mov_b64 s[40:41], s[64:65]
    buffer_load_dwordx2 v[24:25], v44, s[32:35], s95 offen
    buffer_load_dwordx2 v[26:27], v45, s[32:35], s95 offen
    buffer_load_dwordx2 v[28:29], v44, s[32:35], s95 offen offset:768
    buffer_load_dwordx2 v[30:31], v45, s[32:35], s95 offen offset:768
    buffer_load_dwordx2 v[40:41], v44, s[36:39], 0 offen
    buffer_load_dwordx2 v[42:43], v44, s[40:43], 0 offen
    s_mov_b64 s[12:13], s[66:67]
    s_mov_b64 s[16:17], s[68:69]
    s_barrier
    s_mov_b32 s83, 0x05040100
    s_mov_b32 s84, 0x07060302
    s_mul_i32 s92, s78, 3072
    v_lshl_add_u32 v2, v20, 1, s92
    v_add_u32 v12, s92, v20
    v_add_u32 v13, s92, v21
    s_lshl_b32 s92, s78, 5
    s_add_u32 s92, s92, 49152
    v_lshl_add_u32 v3, v19, 3, s92
    v_lshrrev_b32 v18, 3, v23
    v_lshl_add_u32 v4, v18, 7, v3
    v_lshlrev_b32 v9, 4, v23
    v_add_u32 v9, 65536, v9
    s_lshl2_add_u32 s92, s78, 77824
    v_mov_b32 v5, s92
    v_mov_b32 v6, 0
    v_mov_b32 v8, 1
    s_mul_i32 s79, s78, 3
    s_sub_u32 s79, s79, 9
    s_mov_b32 s80, 0
    s_mov_b32 s81, 0
    s_mul_i32 s92, s78, 1536
    s_add_u32 s92, s92, 65536
    v_lshl_add_u32 v14, v44, 1, s92
    v_lshl_add_u32 v16, v45, 1, s92
    s_waitcnt vmcnt(0)
    v_xor_b32 v42, v42, v46
    v_xor_b32 v43, v43, v46
    v_lshlrev_b32 v48, 16, v40
    v_and_b32 v49, 0xffff0000, v40
    v_lshlrev_b32 v50, 16, v41
    v_and_b32 v51, 0xffff0000, v41
    v_lshlrev_b32 v52, 16, v42
    v_and_b32 v53, 0xffff0000, v42
    v_lshlrev_b32 v54, 16, v43
    v_and_b32 v55, 0xffff0000, v43
    v_and_b32 v46, 0x80000000, v46
    s_mov_b32 exec_hi, 0xffff
    v_lshlrev_b32 v56, 16, v24
    v_and_b32 v57, 0xffff0000, v24
    v_lshlrev_b32 v58, 16, v25
    v_and_b32 v59, 0xffff0000, v25
    v_lshlrev_b32 v60, 16, v26
    v_and_b32 v61, 0xffff0000, v26
    v_lshlrev_b32 v62, 16, v27
    v_and_b32 v63, 0xffff0000, v27
    v_pk_mul_f32 v[56:57], v[56:57], v[48:49]
    v_pk_mul_f32 v[60:61], v[60:61], v[52:53]
    v_pk_mul_f32 v[58:59], v[58:59], v[50:51]
    v_pk_mul_f32 v[62:63], v[62:63], v[54:55]
    v_cvt_pk_bf16_f32 v56, v56, v60
    v_cvt_pk_bf16_f32 v57, v57, v61
    v_cvt_pk_bf16_f32 v58, v58, v62
    v_cvt_pk_bf16_f32 v59, v59, v63
    v_and_b32 v60, 0xffff0000, v56
    v_lshlrev_b32 v56, 16, v56
    v_and_b32 v61, 0xffff0000, v57
    v_lshlrev_b32 v57, 16, v57
    v_and_b32 v62, 0xffff0000, v58
    v_lshlrev_b32 v58, 16, v58
    v_and_b32 v63, 0xffff0000, v59
    v_lshlrev_b32 v59, 16, v59
    v_pk_add_f32 v[56:57], v[56:57], v[60:61]
    v_pk_add_f32 v[58:59], v[58:59], v[62:63]
    v_cvt_pk_bf16_f32 v64, v56, v56
    v_cvt_pk_bf16_f32 v65, v57, v57
    v_cvt_pk_bf16_f32 v66, v58, v58
    v_cvt_pk_bf16_f32 v67, v59, v59
    v_xor_b32 v64, v64, v46
    v_xor_b32 v65, v65, v46
    v_xor_b32 v66, v66, v46
    v_xor_b32 v67, v67, v46
    ds_write_b16 v14, v64 offset:0
    ds_write_b16_d16_hi v16, v64 offset:2
    ds_write_b16 v14, v65 offset:4
    ds_write_b16_d16_hi v16, v65 offset:6
    ds_write_b16 v14, v66 offset:8
    ds_write_b16_d16_hi v16, v66 offset:10
    ds_write_b16 v14, v67 offset:12
    ds_write_b16_d16_hi v16, v67 offset:14
    v_lshlrev_b32 v56, 16, v28
    v_and_b32 v57, 0xffff0000, v28
    v_lshlrev_b32 v58, 16, v29
    v_and_b32 v59, 0xffff0000, v29
    v_lshlrev_b32 v60, 16, v30
    v_and_b32 v61, 0xffff0000, v30
    v_lshlrev_b32 v62, 16, v31
    v_and_b32 v63, 0xffff0000, v31
    v_pk_mul_f32 v[56:57], v[56:57], v[48:49]
    v_pk_mul_f32 v[60:61], v[60:61], v[52:53]
    v_pk_mul_f32 v[58:59], v[58:59], v[50:51]
    v_pk_mul_f32 v[62:63], v[62:63], v[54:55]
    v_cvt_pk_bf16_f32 v56, v56, v60
    v_cvt_pk_bf16_f32 v57, v57, v61
    v_cvt_pk_bf16_f32 v58, v58, v62
    v_cvt_pk_bf16_f32 v59, v59, v63
    v_and_b32 v60, 0xffff0000, v56
    v_lshlrev_b32 v56, 16, v56
    v_and_b32 v61, 0xffff0000, v57
    v_lshlrev_b32 v57, 16, v57
    v_and_b32 v62, 0xffff0000, v58
    v_lshlrev_b32 v58, 16, v58
    v_and_b32 v63, 0xffff0000, v59
    v_lshlrev_b32 v59, 16, v59
    v_pk_add_f32 v[56:57], v[56:57], v[60:61]
    v_pk_add_f32 v[58:59], v[58:59], v[62:63]
    v_cvt_pk_bf16_f32 v68, v56, v56
    v_cvt_pk_bf16_f32 v69, v57, v57
    v_cvt_pk_bf16_f32 v70, v58, v58
    v_cvt_pk_bf16_f32 v71, v59, v59
    v_xor_b32 v68, v68, v46
    v_xor_b32 v69, v69, v46
    v_xor_b32 v70, v70, v46
    v_xor_b32 v71, v71, v46
    ds_write_b16 v14, v68 offset:768
    ds_write_b16_d16_hi v16, v68 offset:770
    ds_write_b16 v14, v69 offset:772
    ds_write_b16_d16_hi v16, v69 offset:774
    ds_write_b16 v14, v70 offset:776
    ds_write_b16_d16_hi v16, v70 offset:778
    ds_write_b16 v14, v71 offset:780
    ds_write_b16_d16_hi v16, v71 offset:782
    s_mov_b32 exec_hi, -1
    ds_write_b32 v5, v8 offset:160
    s_add_u32 s79, s79, 12
    s_cmp_ge_i32 s80, s79
    s_cbranch_scc1 L_cr0g
L_cr0:
    ds_read_b32 v19, v7
    s_sleep 1
    s_waitcnt lgkmcnt(0)
    v_readlane_b32 s80, v19, 5
    s_nop 0
    s_cmp_lt_i32 s80, s79
    s_cbranch_scc1 L_cr0
L_cr0g:
    ds_read_b64 v[72:73], v12 offset:0
    ds_read_b64 v[76:77], v12 offset:128
    ds_read_b64 v[80:81], v12 offset:256
    ds_read_b64 v[84:85], v12 offset:1536
    ds_read_b64 v[88:89], v12 offset:1664
    ds_read_b64 v[92:93], v12 offset:1792
    v_add_u32 v6, 1, v6
    ds_write_b32 v5, v6
    s_add_u32 s79, s79, 12
    s_cmp_ge_i32 s80, s79
    s_cbranch_scc1 L_cr1g
L_cr1:
    ds_read_b32 v19, v7
    s_sleep 1
    s_waitcnt lgkmcnt(0)
    v_readlane_b32 s80, v19, 5
    s_nop 0
    s_cmp_lt_i32 s80, s79
    s_cbranch_scc1 L_cr1
L_cr1g:
    ds_read_b64 v[74:75], v12 offset:12480
    ds_read_b64 v[78:79], v13 offset:12288
    ds_read_b64 v[82:83], v12 offset:12352
    ds_read_b64 v[86:87], v12 offset:14016
    ds_read_b64 v[90:91], v13 offset:13824
    ds_read_b64 v[94:95], v12 offset:13888
    v_add_u32 v6, 1, v6
    ds_write_b32 v5, v6
    s_mul_i32 s82, s89, 384
    s_add_u32 s89, s89, 2048
    s_and_b32 s89, s89, 16383
    buffer_load_dwordx2 v[120:121], v20, s[12:15], s82 offen offset:0
    buffer_load_dwordx2 v[122:123], v20, s[16:19], s82 offen offset:192
    buffer_load_dwordx2 v[124:125], v20, s[12:15], s82 offen offset:128
    buffer_load_dwordx2 v[126:127], v21, s[16:19], s82 offen
    buffer_load_dwordx2 v[128:129], v20, s[12:15], s82 offen offset:256
    buffer_load_dwordx2 v[130:131], v20, s[16:19], s82 offen offset:64
    s_add_u32 s79, s79, 12
    s_cmp_ge_i32 s80, s79
    s_cbranch_scc1 L_cr2g
L_cr2:
    ds_read_b32 v19, v7
    s_sleep 1
    s_waitcnt lgkmcnt(0)
    v_readlane_b32 s80, v19, 5
    s_nop 0
    s_cmp_lt_i32 s80, s79
    s_cbranch_scc1 L_cr2
L_cr2g:
    ds_read_b64 v[96:97], v12 offset:24576
    ds_read_b64 v[100:101], v12 offset:24704
    ds_read_b64 v[104:105], v12 offset:24832
    ds_read_b64 v[108:109], v12 offset:26112
    ds_read_b64 v[112:113], v12 offset:26240
    ds_read_b64 v[116:117], v12 offset:26368
    v_add_u32 v6, 1, v6
    ds_write_b32 v5, v6
    s_add_u32 s79, s79, 12
    s_cmp_ge_i32 s80, s79
    s_cbranch_scc1 L_cr3g
L_cr3:
    ds_read_b32 v19, v7
    s_sleep 1
    s_waitcnt lgkmcnt(0)
    v_readlane_b32 s80, v19, 5
    s_nop 0
    s_cmp_lt_i32 s80, s79
    s_cbranch_scc1 L_cr3
L_cr3g:
    ds_read_b64 v[98:99], v12 offset:37056
    ds_read_b64 v[102:103], v13 offset:36864
    ds_read_b64 v[106:107], v12 offset:36928
    ds_read_b64 v[110:111], v12 offset:38592
    ds_read_b64 v[114:115], v13 offset:38400
    ds_read_b64 v[118:119], v12 offset:38464
    v_add_u32 v6, 1, v6
    ds_write_b32 v5, v6
    s_mul_i32 s82, s89, 384
    s_add_u32 s89, s89, 2048
    s_and_b32 s89, s89, 16383
    buffer_load_dwordx2 v[132:133], v20, s[12:15], s82 offen offset:0
    buffer_load_dwordx2 v[134:135], v20, s[16:19], s82 offen offset:192
    buffer_load_dwordx2 v[136:137], v20, s[12:15], s82 offen offset:128
    buffer_load_dwordx2 v[138:139], v21, s[16:19], s82 offen
    buffer_load_dwordx2 v[140:141], v20, s[12:15], s82 offen offset:256
    buffer_load_dwordx2 v[142:143], v20, s[16:19], s82 offen offset:64
L_kph:
    s_lshr_b32 s94, s81, 1
    s_add_u32 s88, s94, 40
    s_lshl2_add_u32 s92, s94, 77888
    v_mov_b32 v22, s92
    s_nop 1
L_kw:
    ds_read_b32 v19, v7
    ds_read_b128 v[48:51], v9 offset:0
    ds_read_b128 v[52:55], v9 offset:256
    ds_read_b128 v[56:59], v9 offset:512
    s_waitcnt lgkmcnt(0)
    v_readlane_b32 s92, v19, s88
    v_readlane_b32 s93, v19, 12
    s_cmp_eq_u32 s92, 0
    s_nop 3
    s_cbranch_scc1 L_kw
    s_cmp_le_u32 s93, s94
    s_cbranch_scc1 L_kw
    v_add_u32 v9, 768, v9
    s_cmp_lg_u32 s81, 0
    s_nop 0
    s_cbranch_scc1 L_ncs0
    v_perm_b32 v36, v74, v72, s83
    v_perm_b32 v74, v74, v72, s84
    v_perm_b32 v37, v75, v73, s83
    v_perm_b32 v75, v75, v73, s84
    v_perm_b32 v38, v78, v76, s83
    v_perm_b32 v78, v78, v76, s84
    v_perm_b32 v39, v79, v77, s83
    v_perm_b32 v79, v79, v77, s84
    v_perm_b32 v40, v82, v80, s83
    v_perm_b32 v82, v82, v80, s84
    v_perm_b32 v41, v83, v81, s83
    v_perm_b32 v83, v83, v81, s84
    v_mov_b64 v[72:73], v[36:37]
    v_mov_b64 v[76:77], v[38:39]
    v_mov_b64 v[80:81], v[40:41]
    s_nop 1
L_ncs0:
    v_dot2_f32_bf16 v36, v72, v48, 0
    v_dot2_f32_bf16 v37, v74, v49, 0
    v_dot2_f32_bf16 v38, v73, v50, 0
    v_dot2_f32_bf16 v39, v75, v51, 0
    v_dot2_f32_bf16 v40, v76, v52, 0
    v_dot2_f32_bf16 v41, v78, v53, 0
    v_dot2_f32_bf16 v42, v77, v54, 0
    v_dot2_f32_bf16 v43, v79, v55, 0
    v_dot2_f32_bf16 v44, v80, v56, 0
    v_dot2_f32_bf16 v45, v82, v57, 0
    v_dot2_f32_bf16 v46, v81, v58, 0
    v_dot2_f32_bf16 v47, v83, v59, 0
    s_add_u32 s79, s79, 12
    s_cmp_ge_i32 s80, s79
    s_cbranch_scc1 L_kr0g
L_kr0:
    ds_read_b32 v19, v7
    s_sleep 1
    s_waitcnt lgkmcnt(0)
    v_readlane_b32 s80, v19, 5
    s_nop 0
    s_cmp_lt_i32 s80, s79
    s_cbranch_scc1 L_kr0
L_kr0g:
    ds_read_b32 v10, v3 offset:0
    ds_read_b128 v[24:27], v2 offset:0
    ds_read_b128 v[28:31], v2 offset:256
    ds_read_b128 v[32:35], v2 offset:512
    v_add_u32 v6, 1, v6
    ds_write_b32 v5, v6
    s_waitcnt lgkmcnt(3)
    v_and_b32 v12, 0xffff0000, v10
    v_cvt_f32_i32 v24, v24
    v_cvt_f32_i32 v25, v25
    v_cvt_f32_i32 v26, v26
    v_cvt_f32_i32 v27, v27
    v_pk_add_f32 v[24:25], v[24:25], v[12:13] op_sel:[0,0] op_sel_hi:[1,0] neg_lo:[0,1] neg_hi:[0,1]
    v_pk_add_f32 v[26:27], v[26:27], v[12:13] op_sel:[0,0] op_sel_hi:[1,0] neg_lo:[0,1] neg_hi:[0,1]
    v_pk_mul_f32 v[14:15], v[24:25], v[36:37]
    v_pk_fma_f32 v[14:15], v[26:27], v[38:39], v[14:15]
    s_waitcnt lgkmcnt(2)
    v_cvt_f32_i32 v28, v28
    v_cvt_f32_i32 v29, v29
    v_cvt_f32_i32 v30, v30
    v_cvt_f32_i32 v31, v31
    v_pk_add_f32 v[28:29], v[28:29], v[12:13] op_sel:[0,0] op_sel_hi:[1,0] neg_lo:[0,1] neg_hi:[0,1]
    v_pk_add_f32 v[30:31], v[30:31], v[12:13] op_sel:[0,0] op_sel_hi:[1,0] neg_lo:[0,1] neg_hi:[0,1]
    v_pk_fma_f32 v[14:15], v[28:29], v[40:41], v[14:15]
    v_pk_fma_f32 v[14:15], v[30:31], v[42:43], v[14:15]
    s_waitcnt lgkmcnt(1)
    v_cvt_f32_i32 v32, v32
    v_cvt_f32_i32 v33, v33
    v_cvt_f32_i32 v34, v34
    v_cvt_f32_i32 v35, v35
    v_pk_add_f32 v[32:33], v[32:33], v[12:13] op_sel:[0,0] op_sel_hi:[1,0] neg_lo:[0,1] neg_hi:[0,1]
    v_pk_add_f32 v[34:35], v[34:35], v[12:13] op_sel:[0,0] op_sel_hi:[1,0] neg_lo:[0,1] neg_hi:[0,1]
    v_pk_fma_f32 v[14:15], v[32:33], v[44:45], v[14:15]
    v_pk_fma_f32 v[14:15], v[34:35], v[46:47], v[14:15]
    v_add_f32 v14, v14, v15
    s_nop 1
    v_add_f32_dpp v18, v14, v14 row_ror:8 row_mask:0xf bank_mask:0x3
    s_cmp_lg_u32 s81, 0
    s_nop 0
    s_cbranch_scc1 L_ncs1
    s_mul_i32 s82, s89, 384
    s_add_u32 s89, s89, 2048
    s_and_b32 s89, s89, 16383
    buffer_load_dwordx2 v[144:145], v20, s[12:15], s82 offen offset:0
    buffer_load_dwordx2 v[146:147], v20, s[16:19], s82 offen offset:192
    buffer_load_dwordx2 v[148:149], v20, s[12:15], s82 offen offset:128
    buffer_load_dwordx2 v[150:151], v21, s[16:19], s82 offen
    buffer_load_dwordx2 v[152:153], v20, s[12:15], s82 offen offset:256
    buffer_load_dwordx2 v[154:155], v20, s[16:19], s82 offen offset:64
    v_perm_b32 v36, v86, v84, s83
    v_perm_b32 v86, v86, v84, s84
    v_perm_b32 v37, v87, v85, s83
    v_perm_b32 v87, v87, v85, s84
    v_perm_b32 v38, v90, v88, s83
    v_perm_b32 v90, v90, v88, s84
    v_perm_b32 v39, v91, v89, s83
    v_perm_b32 v91, v91, v89, s84
    v_perm_b32 v40, v94, v92, s83
    v_perm_b32 v94, v94, v92, s84
    v_perm_b32 v41, v95, v93, s83
    v_perm_b32 v95, v95, v93, s84
    v_mov_b64 v[84:85], v[36:37]
    v_mov_b64 v[88:89], v[38:39]
    v_mov_b64 v[92:93], v[40:41]
    s_nop 1
L_ncs1:
    v_dot2_f32_bf16 v36, v84, v48, 0
    v_dot2_f32_bf16 v37, v86, v49, 0
    v_dot2_f32_bf16 v38, v85, v50, 0
    v_dot2_f32_bf16 v39, v87, v51, 0
    v_dot2_f32_bf16 v40, v88, v52, 0
    v_dot2_f32_bf16 v41, v90, v53, 0
    v_dot2_f32_bf16 v42, v89, v54, 0
    v_dot2_f32_bf16 v43, v91, v55, 0
    v_dot2_f32_bf16 v44, v92, v56, 0
    v_dot2_f32_bf16 v45, v94, v57, 0
    v_dot2_f32_bf16 v46, v93, v58, 0
    v_dot2_f32_bf16 v47, v95, v59, 0
    s_add_u32 s79, s79, 12
    s_cmp_ge_i32 s80, s79
    s_cbranch_scc1 L_kr1g
L_kr1:
    ds_read_b32 v19, v7
    s_sleep 1
    s_waitcnt lgkmcnt(0)
    v_readlane_b32 s80, v19, 5
    s_nop 0
    s_cmp_lt_i32 s80, s79
    s_cbranch_scc1 L_kr1
L_kr1g:
    ds_read_b32 v11, v3 offset:128
    ds_read_b128 v[24:27], v2 offset:12288
    ds_read_b128 v[28:31], v2 offset:12544
    ds_read_b128 v[32:35], v2 offset:12800
    v_add_u32 v6, 1, v6
    ds_write_b32 v5, v6
    s_waitcnt lgkmcnt(3)
    v_and_b32 v12, 0xffff0000, v11
    v_cvt_f32_i32 v24, v24
    v_cvt_f32_i32 v25, v25
    v_cvt_f32_i32 v26, v26
    v_cvt_f32_i32 v27, v27
    v_pk_add_f32 v[24:25], v[24:25], v[12:13] op_sel:[0,0] op_sel_hi:[1,0] neg_lo:[0,1] neg_hi:[0,1]
    v_pk_add_f32 v[26:27], v[26:27], v[12:13] op_sel:[0,0] op_sel_hi:[1,0] neg_lo:[0,1] neg_hi:[0,1]
    v_pk_mul_f32 v[16:17], v[24:25], v[36:37]
    v_pk_fma_f32 v[16:17], v[26:27], v[38:39], v[16:17]
    s_waitcnt lgkmcnt(2)
    v_cvt_f32_i32 v28, v28
    v_cvt_f32_i32 v29, v29
    v_cvt_f32_i32 v30, v30
    v_cvt_f32_i32 v31, v31
    v_pk_add_f32 v[28:29], v[28:29], v[12:13] op_sel:[0,0] op_sel_hi:[1,0] neg_lo:[0,1] neg_hi:[0,1]
    v_pk_add_f32 v[30:31], v[30:31], v[12:13] op_sel:[0,0] op_sel_hi:[1,0] neg_lo:[0,1] neg_hi:[0,1]
    v_pk_fma_f32 v[16:17], v[28:29], v[40:41], v[16:17]
    v_pk_fma_f32 v[16:17], v[30:31], v[42:43], v[16:17]
    s_waitcnt lgkmcnt(1)
    v_cvt_f32_i32 v32, v32
    v_cvt_f32_i32 v33, v33
    v_cvt_f32_i32 v34, v34
    v_cvt_f32_i32 v35, v35
    v_pk_add_f32 v[32:33], v[32:33], v[12:13] op_sel:[0,0] op_sel_hi:[1,0] neg_lo:[0,1] neg_hi:[0,1]
    v_pk_add_f32 v[34:35], v[34:35], v[12:13] op_sel:[0,0] op_sel_hi:[1,0] neg_lo:[0,1] neg_hi:[0,1]
    v_pk_fma_f32 v[16:17], v[32:33], v[44:45], v[16:17]
    v_pk_fma_f32 v[16:17], v[34:35], v[46:47], v[16:17]
    v_add_f32 v16, v16, v17
    v_cndmask_b32 v23, v10, v11, s[86:87]
    v_lshlrev_b32 v23, 16, v23
    v_add_f32_dpp v18, v16, v16 row_ror:8 row_mask:0xf bank_mask:0xc
    v_mul_f32 v23, 0x3dd53b95, v23
    s_nop 0
    v_add_f32_dpp v18, v18, v18 row_half_mirror row_mask:0xf bank_mask:0xf
    s_nop 1
    v_add_f32_dpp v18, v18, v18 quad_perm:[2,3,0,1] row_mask:0xf bank_mask:0xf
    s_nop 1
    v_add_f32_dpp v18, v18, v18 quad_perm:[1,0,3,2] row_mask:0xf bank_mask:0xf
    v_mul_f32 v18, v23, v18
    ds_write_b32 v4, v18 offset:0
    s_cmp_lg_u32 s81, 0
    s_cbranch_scc1 L_ncs2
    v_perm_b32 v36, v98, v96, s83
    v_perm_b32 v98, v98, v96, s84
    v_perm_b32 v37, v99, v97, s83
    v_perm_b32 v99, v99, v97, s84
    v_perm_b32 v38, v102, v100, s83
    v_perm_b32 v102, v102, v100, s84
    v_perm_b32 v39, v103, v101, s83
    v_perm_b32 v103, v103, v101, s84
    v_perm_b32 v40, v106, v104, s83
    v_perm_b32 v106, v106, v104, s84
    v_perm_b32 v41, v107, v105, s83
    v_perm_b32 v107, v107, v105, s84
    v_mov_b64 v[96:97], v[36:37]
    v_mov_b64 v[100:101], v[38:39]
    v_mov_b64 v[104:105], v[40:41]
    s_nop 1
L_ncs2:
    v_dot2_f32_bf16 v36, v96, v48, 0
    v_dot2_f32_bf16 v37, v98, v49, 0
    v_dot2_f32_bf16 v38, v97, v50, 0
    v_dot2_f32_bf16 v39, v99, v51, 0
    v_dot2_f32_bf16 v40, v100, v52, 0
    v_dot2_f32_bf16 v41, v102, v53, 0
    v_dot2_f32_bf16 v42, v101, v54, 0
    v_dot2_f32_bf16 v43, v103, v55, 0
    v_dot2_f32_bf16 v44, v104, v56, 0
    v_dot2_f32_bf16 v45, v106, v57, 0
    v_dot2_f32_bf16 v46, v105, v58, 0
    v_dot2_f32_bf16 v47, v107, v59, 0
    s_add_u32 s79, s79, 12
    s_cmp_ge_i32 s80, s79
    s_cbranch_scc1 L_kr2g
L_kr2:
    ds_read_b32 v19, v7
    s_sleep 1
    s_waitcnt lgkmcnt(0)
    v_readlane_b32 s80, v19, 5
    s_nop 0
    s_cmp_lt_i32 s80, s79
    s_cbranch_scc1 L_kr2
L_kr2g:
    ds_read_b32 v10, v3 offset:256
    ds_read_b128 v[24:27], v2 offset:24576
    ds_read_b128 v[28:31], v2 offset:24832
    ds_read_b128 v[32:35], v2 offset:25088
    v_add_u32 v6, 1, v6
    ds_write_b32 v5, v6
    s_waitcnt lgkmcnt(3)
    v_and_b32 v12, 0xffff0000, v10
    v_cvt_f32_i32 v24, v24
    v_cvt_f32_i32 v25, v25
    v_cvt_f32_i32 v26, v26
    v_cvt_f32_i32 v27, v27
    v_pk_add_f32 v[24:25], v[24:25], v[12:13] op_sel:[0,0] op_sel_hi:[1,0] neg_lo:[0,1] neg_hi:[0,1]
    v_pk_add_f32 v[26:27], v[26:27], v[12:13] op_sel:[0,0] op_sel_hi:[1,0] neg_lo:[0,1] neg_hi:[0,1]
    v_pk_mul_f32 v[14:15], v[24:25], v[36:37]
    v_pk_fma_f32 v[14:15], v[26:27], v[38:39], v[14:15]
    s_waitcnt lgkmcnt(2)
    v_cvt_f32_i32 v28, v28
    v_cvt_f32_i32 v29, v29
    v_cvt_f32_i32 v30, v30
    v_cvt_f32_i32 v31, v31
    v_pk_add_f32 v[28:29], v[28:29], v[12:13] op_sel:[0,0] op_sel_hi:[1,0] neg_lo:[0,1] neg_hi:[0,1]
    v_pk_add_f32 v[30:31], v[30:31], v[12:13] op_sel:[0,0] op_sel_hi:[1,0] neg_lo:[0,1] neg_hi:[0,1]
    v_pk_fma_f32 v[14:15], v[28:29], v[40:41], v[14:15]
    v_pk_fma_f32 v[14:15], v[30:31], v[42:43], v[14:15]
    s_waitcnt lgkmcnt(1)
    v_cvt_f32_i32 v32, v32
    v_cvt_f32_i32 v33, v33
    v_cvt_f32_i32 v34, v34
    v_cvt_f32_i32 v35, v35
    v_pk_add_f32 v[32:33], v[32:33], v[12:13] op_sel:[0,0] op_sel_hi:[1,0] neg_lo:[0,1] neg_hi:[0,1]
    v_pk_add_f32 v[34:35], v[34:35], v[12:13] op_sel:[0,0] op_sel_hi:[1,0] neg_lo:[0,1] neg_hi:[0,1]
    v_pk_fma_f32 v[14:15], v[32:33], v[44:45], v[14:15]
    v_pk_fma_f32 v[14:15], v[34:35], v[46:47], v[14:15]
    v_add_f32 v14, v14, v15
    s_nop 1
    v_add_f32_dpp v18, v14, v14 row_ror:8 row_mask:0xf bank_mask:0x3
    s_cmp_lg_u32 s81, 0
    s_nop 0
    s_cbranch_scc1 L_ncs3
    s_mul_i32 s82, s89, 384
    s_add_u32 s89, s89, 2048
    s_and_b32 s89, s89, 16383
    buffer_load_dwordx2 v[156:157], v20, s[12:15], s82 offen offset:0
    buffer_load_dwordx2 v[158:159], v20, s[16:19], s82 offen offset:192
    buffer_load_dwordx2 v[160:161], v20, s[12:15], s82 offen offset:128
    buffer_load_dwordx2 v[162:163], v21, s[16:19], s82 offen
    buffer_load_dwordx2 v[164:165], v20, s[12:15], s82 offen offset:256
    buffer_load_dwordx2 v[166:167], v20, s[16:19], s82 offen offset:64
    v_perm_b32 v36, v110, v108, s83
    v_perm_b32 v110, v110, v108, s84
    v_perm_b32 v37, v111, v109, s83
    v_perm_b32 v111, v111, v109, s84
    v_perm_b32 v38, v114, v112, s83
    v_perm_b32 v114, v114, v112, s84
    v_perm_b32 v39, v115, v113, s83
    v_perm_b32 v115, v115, v113, s84
    v_perm_b32 v40, v118, v116, s83
    v_perm_b32 v118, v118, v116, s84
    v_perm_b32 v41, v119, v117, s83
    v_perm_b32 v119, v119, v117, s84
    v_mov_b64 v[108:109], v[36:37]
    v_mov_b64 v[112:113], v[38:39]
    v_mov_b64 v[116:117], v[40:41]
    s_nop 1
L_ncs3:
    v_dot2_f32_bf16 v36, v108, v48, 0
    v_dot2_f32_bf16 v37, v110, v49, 0
    v_dot2_f32_bf16 v38, v109, v50, 0
    v_dot2_f32_bf16 v39, v111, v51, 0
    v_dot2_f32_bf16 v40, v112, v52, 0
    v_dot2_f32_bf16 v41, v114, v53, 0
    v_dot2_f32_bf16 v42, v113, v54, 0
    v_dot2_f32_bf16 v43, v115, v55, 0
    v_dot2_f32_bf16 v44, v116, v56, 0
    v_dot2_f32_bf16 v45, v118, v57, 0
    v_dot2_f32_bf16 v46, v117, v58, 0
    v_dot2_f32_bf16 v47, v119, v59, 0
    s_add_u32 s79, s79, 12
    s_cmp_ge_i32 s80, s79
    s_cbranch_scc1 L_kr3g
L_kr3:
    ds_read_b32 v19, v7
    s_sleep 1
    s_waitcnt lgkmcnt(0)
    v_readlane_b32 s80, v19, 5
    s_nop 0
    s_cmp_lt_i32 s80, s79
    s_cbranch_scc1 L_kr3
L_kr3g:
    ds_read_b32 v11, v3 offset:384
    ds_read_b128 v[24:27], v2 offset:36864
    ds_read_b128 v[28:31], v2 offset:37120
    ds_read_b128 v[32:35], v2 offset:37376
    v_add_u32 v6, 1, v6
    ds_write_b32 v5, v6
    s_waitcnt lgkmcnt(3)
    v_and_b32 v12, 0xffff0000, v11
    v_cvt_f32_i32 v24, v24
    v_cvt_f32_i32 v25, v25
    v_cvt_f32_i32 v26, v26
    v_cvt_f32_i32 v27, v27
    v_pk_add_f32 v[24:25], v[24:25], v[12:13] op_sel:[0,0] op_sel_hi:[1,0] neg_lo:[0,1] neg_hi:[0,1]
    v_pk_add_f32 v[26:27], v[26:27], v[12:13] op_sel:[0,0] op_sel_hi:[1,0] neg_lo:[0,1] neg_hi:[0,1]
    v_pk_mul_f32 v[16:17], v[24:25], v[36:37]
    v_pk_fma_f32 v[16:17], v[26:27], v[38:39], v[16:17]
    s_waitcnt lgkmcnt(2)
    v_cvt_f32_i32 v28, v28
    v_cvt_f32_i32 v29, v29
    v_cvt_f32_i32 v30, v30
    v_cvt_f32_i32 v31, v31
    v_pk_add_f32 v[28:29], v[28:29], v[12:13] op_sel:[0,0] op_sel_hi:[1,0] neg_lo:[0,1] neg_hi:[0,1]
    v_pk_add_f32 v[30:31], v[30:31], v[12:13] op_sel:[0,0] op_sel_hi:[1,0] neg_lo:[0,1] neg_hi:[0,1]
    v_pk_fma_f32 v[16:17], v[28:29], v[40:41], v[16:17]
    v_pk_fma_f32 v[16:17], v[30:31], v[42:43], v[16:17]
    s_waitcnt lgkmcnt(1)
    v_cvt_f32_i32 v32, v32
    v_cvt_f32_i32 v33, v33
    v_cvt_f32_i32 v34, v34
    v_cvt_f32_i32 v35, v35
    v_pk_add_f32 v[32:33], v[32:33], v[12:13] op_sel:[0,0] op_sel_hi:[1,0] neg_lo:[0,1] neg_hi:[0,1]
    v_pk_add_f32 v[34:35], v[34:35], v[12:13] op_sel:[0,0] op_sel_hi:[1,0] neg_lo:[0,1] neg_hi:[0,1]
    v_pk_fma_f32 v[16:17], v[32:33], v[44:45], v[16:17]
    v_pk_fma_f32 v[16:17], v[34:35], v[46:47], v[16:17]
    v_add_f32 v16, v16, v17
    v_cndmask_b32 v23, v10, v11, s[86:87]
    v_lshlrev_b32 v23, 16, v23
    v_add_f32_dpp v18, v16, v16 row_ror:8 row_mask:0xf bank_mask:0xc
    v_mul_f32 v23, 0x3dd53b95, v23
    s_nop 0
    v_add_f32_dpp v18, v18, v18 row_half_mirror row_mask:0xf bank_mask:0xf
    s_nop 1
    v_add_f32_dpp v18, v18, v18 quad_perm:[2,3,0,1] row_mask:0xf bank_mask:0xf
    s_nop 1
    v_add_f32_dpp v18, v18, v18 quad_perm:[1,0,3,2] row_mask:0xf bank_mask:0xf
    v_mul_f32 v18, v23, v18
    ds_write_b32 v4, v18 offset:256
    s_cmp_lg_u32 s81, 0
    s_cbranch_scc1 L_ncs4
    s_waitcnt vmcnt(18)
    v_perm_b32 v36, v122, v120, s83
    v_perm_b32 v122, v122, v120, s84
    v_perm_b32 v37, v123, v121, s83
    v_perm_b32 v123, v123, v121, s84
    v_perm_b32 v38, v126, v124, s83
    v_perm_b32 v126, v126, v124, s84
    v_perm_b32 v39, v127, v125, s83
    v_perm_b32 v127, v127, v125, s84
    v_perm_b32 v40, v130, v128, s83
    v_perm_b32 v130, v130, v128, s84
    v_perm_b32 v41, v131, v129, s83
    v_perm_b32 v131, v131, v129, s84
    v_mov_b64 v[120:121], v[36:37]
    v_mov_b64 v[124:125], v[38:39]
    v_mov_b64 v[128:129], v[40:41]
    s_nop 1
L_ncs4:
    v_dot2_f32_bf16 v36, v120, v48, 0
    v_dot2_f32_bf16 v37, v122, v49, 0
    v_dot2_f32_bf16 v38, v121, v50, 0
    v_dot2_f32_bf16 v39, v123, v51, 0
    v_dot2_f32_bf16 v40, v124, v52, 0
    v_dot2_f32_bf16 v41, v126, v53, 0
    v_dot2_f32_bf16 v42, v125, v54, 0
    v_dot2_f32_bf16 v43, v127, v55, 0
    v_dot2_f32_bf16 v44, v128, v56, 0
    v_dot2_f32_bf16 v45, v130, v57, 0
    v_dot2_f32_bf16 v46, v129, v58, 0
    v_dot2_f32_bf16 v47, v131, v59, 0
    s_add_u32 s79, s79, 12
    s_cmp_ge_i32 s80, s79
    s_cbranch_scc1 L_kr4g
L_kr4:
    ds_read_b32 v19, v7
    s_sleep 1
    s_waitcnt lgkmcnt(0)
    v_readlane_b32 s80, v19, 5
    s_nop 0
    s_cmp_lt_i32 s80, s79
    s_cbranch_scc1 L_kr4
L_kr4g:
    ds_read_b32 v10, v3 offset:512
    ds_read_b128 v[24:27], v2 offset:0
    ds_read_b128 v[28:31], v2 offset:256
    ds_read_b128 v[32:35], v2 offset:512
    v_add_u32 v6, 1, v6
    ds_write_b32 v5, v6
    s_waitcnt lgkmcnt(3)
    v_and_b32 v12, 0xffff0000, v10
    v_cvt_f32_i32 v24, v24
    v_cvt_f32_i32 v25, v25
    v_cvt_f32_i32 v26, v26
    v_cvt_f32_i32 v27, v27
    v_pk_add_f32 v[24:25], v[24:25], v[12:13] op_sel:[0,0] op_sel_hi:[1,0] neg_lo:[0,1] neg_hi:[0,1]
    v_pk_add_f32 v[26:27], v[26:27], v[12:13] op_sel:[0,0] op_sel_hi:[1,0] neg_lo:[0,1] neg_hi:[0,1]
    v_pk_mul_f32 v[14:15], v[24:25], v[36:37]
    v_pk_fma_f32 v[14:15], v[26:27], v[38:39], v[14:15]
    s_waitcnt lgkmcnt(2)
    v_cvt_f32_i32 v28, v28
    v_cvt_f32_i32 v29, v29
    v_cvt_f32_i32 v30, v30
    v_cvt_f32_i32 v31, v31
    v_pk_add_f32 v[28:29], v[28:29], v[12:13] op_sel:[0,0] op_sel_hi:[1,0] neg_lo:[0,1] neg_hi:[0,1]
    v_pk_add_f32 v[30:31], v[30:31], v[12:13] op_sel:[0,0] op_sel_hi:[1,0] neg_lo:[0,1] neg_hi:[0,1]
    v_pk_fma_f32 v[14:15], v[28:29], v[40:41], v[14:15]
    v_pk_fma_f32 v[14:15], v[30:31], v[42:43], v[14:15]
    s_waitcnt lgkmcnt(1)
    v_cvt_f32_i32 v32, v32
    v_cvt_f32_i32 v33, v33
    v_cvt_f32_i32 v34, v34
    v_cvt_f32_i32 v35, v35
    v_pk_add_f32 v[32:33], v[32:33], v[12:13] op_sel:[0,0] op_sel_hi:[1,0] neg_lo:[0,1] neg_hi:[0,1]
    v_pk_add_f32 v[34:35], v[34:35], v[12:13] op_sel:[0,0] op_sel_hi:[1,0] neg_lo:[0,1] neg_hi:[0,1]
    v_pk_fma_f32 v[14:15], v[32:33], v[44:45], v[14:15]
    v_pk_fma_f32 v[14:15], v[34:35], v[46:47], v[14:15]
    v_add_f32 v14, v14, v15
    s_nop 1
    v_add_f32_dpp v18, v14, v14 row_ror:8 row_mask:0xf bank_mask:0x3
    s_cmp_lg_u32 s81, 0
    s_nop 0
    s_cbranch_scc1 L_ncs5
    s_waitcnt vmcnt(12)
    v_perm_b32 v36, v134, v132, s83
    v_perm_b32 v134, v134, v132, s84
    v_perm_b32 v37, v135, v133, s83
    v_perm_b32 v135, v135, v133, s84
    v_perm_b32 v38, v138, v136, s83
    v_perm_b32 v138, v138, v136, s84
    v_perm_b32 v39, v139, v137, s83
    v_perm_b32 v139, v139, v137, s84
    v_perm_b32 v40, v142, v140, s83
    v_perm_b32 v142, v142, v140, s84
    v_perm_b32 v41, v143, v141, s83
    v_perm_b32 v143, v143, v141, s84
    v_mov_b64 v[132:133], v[36:37]
    v_mov_b64 v[136:137], v[38:39]
    v_mov_b64 v[140:141], v[40:41]
    s_nop 1
L_ncs5:
    v_dot2_f32_bf16 v36, v132, v48, 0
    v_dot2_f32_bf16 v37, v134, v49, 0
    v_dot2_f32_bf16 v38, v133, v50, 0
    v_dot2_f32_bf16 v39, v135, v51, 0
    v_dot2_f32_bf16 v40, v136, v52, 0
    v_dot2_f32_bf16 v41, v138, v53, 0
    v_dot2_f32_bf16 v42, v137, v54, 0
    v_dot2_f32_bf16 v43, v139, v55, 0
    v_dot2_f32_bf16 v44, v140, v56, 0
    v_dot2_f32_bf16 v45, v142, v57, 0
    v_dot2_f32_bf16 v46, v141, v58, 0
    v_dot2_f32_bf16 v47, v143, v59, 0
    s_add_u32 s79, s79, 12
    s_cmp_ge_i32 s80, s79
    s_cbranch_scc1 L_kr5g
L_kr5:
    ds_read_b32 v19, v7
    s_sleep 1
    s_waitcnt lgkmcnt(0)
    v_readlane_b32 s80, v19, 5
    s_nop 0
    s_cmp_lt_i32 s80, s79
    s_cbranch_scc1 L_kr5
L_kr5g:
    ds_read_b32 v11, v3 offset:640
    ds_read_b128 v[24:27], v2 offset:12288
    ds_read_b128 v[28:31], v2 offset:12544
    ds_read_b128 v[32:35], v2 offset:12800
    v_add_u32 v6, 1, v6
    ds_write_b32 v5, v6
    s_waitcnt lgkmcnt(3)
    v_and_b32 v12, 0xffff0000, v11
    v_cvt_f32_i32 v24, v24
    v_cvt_f32_i32 v25, v25
    v_cvt_f32_i32 v26, v26
    v_cvt_f32_i32 v27, v27
    v_pk_add_f32 v[24:25], v[24:25], v[12:13] op_sel:[0,0] op_sel_hi:[1,0] neg_lo:[0,1] neg_hi:[0,1]
    v_pk_add_f32 v[26:27], v[26:27], v[12:13] op_sel:[0,0] op_sel_hi:[1,0] neg_lo:[0,1] neg_hi:[0,1]
    v_pk_mul_f32 v[16:17], v[24:25], v[36:37]
    v_pk_fma_f32 v[16:17], v[26:27], v[38:39], v[16:17]
    s_waitcnt lgkmcnt(2)
    v_cvt_f32_i32 v28, v28
    v_cvt_f32_i32 v29, v29
    v_cvt_f32_i32 v30, v30
    v_cvt_f32_i32 v31, v31
    v_pk_add_f32 v[28:29], v[28:29], v[12:13] op_sel:[0,0] op_sel_hi:[1,0] neg_lo:[0,1] neg_hi:[0,1]
    v_pk_add_f32 v[30:31], v[30:31], v[12:13] op_sel:[0,0] op_sel_hi:[1,0] neg_lo:[0,1] neg_hi:[0,1]
    v_pk_fma_f32 v[16:17], v[28:29], v[40:41], v[16:17]
    v_pk_fma_f32 v[16:17], v[30:31], v[42:43], v[16:17]
    s_waitcnt lgkmcnt(1)
    v_cvt_f32_i32 v32, v32
    v_cvt_f32_i32 v33, v33
    v_cvt_f32_i32 v34, v34
    v_cvt_f32_i32 v35, v35
    v_pk_add_f32 v[32:33], v[32:33], v[12:13] op_sel:[0,0] op_sel_hi:[1,0] neg_lo:[0,1] neg_hi:[0,1]
    v_pk_add_f32 v[34:35], v[34:35], v[12:13] op_sel:[0,0] op_sel_hi:[1,0] neg_lo:[0,1] neg_hi:[0,1]
    v_pk_fma_f32 v[16:17], v[32:33], v[44:45], v[16:17]
    v_pk_fma_f32 v[16:17], v[34:35], v[46:47], v[16:17]
    v_add_f32 v16, v16, v17
    v_cndmask_b32 v23, v10, v11, s[86:87]
    v_lshlrev_b32 v23, 16, v23
    v_add_f32_dpp v18, v16, v16 row_ror:8 row_mask:0xf bank_mask:0xc
    v_mul_f32 v23, 0x3dd53b95, v23
    s_nop 0
    v_add_f32_dpp v18, v18, v18 row_half_mirror row_mask:0xf bank_mask:0xf
    s_nop 1
    v_add_f32_dpp v18, v18, v18 quad_perm:[2,3,0,1] row_mask:0xf bank_mask:0xf
    s_nop 1
    v_add_f32_dpp v18, v18, v18 quad_perm:[1,0,3,2] row_mask:0xf bank_mask:0xf
    v_mul_f32 v18, v23, v18
    ds_write_b32 v4, v18 offset:512
    s_cmp_lg_u32 s81, 0
    s_cbranch_scc1 L_ncs6
    s_waitcnt vmcnt(6)
    v_perm_b32 v36, v146, v144, s83
    v_perm_b32 v146, v146, v144, s84
    v_perm_b32 v37, v147, v145, s83
    v_perm_b32 v147, v147, v145, s84
    v_perm_b32 v38, v150, v148, s83
    v_perm_b32 v150, v150, v148, s84
    v_perm_b32 v39, v151, v149, s83
    v_perm_b32 v151, v151, v149, s84
    v_perm_b32 v40, v154, v152, s83
    v_perm_b32 v154, v154, v152, s84
    v_perm_b32 v41, v155, v153, s83
    v_perm_b32 v155, v155, v153, s84
    v_mov_b64 v[144:145], v[36:37]
    v_mov_b64 v[148:149], v[38:39]
    v_mov_b64 v[152:153], v[40:41]
    s_nop 1
L_ncs6:
    v_dot2_f32_bf16 v36, v144, v48, 0
    v_dot2_f32_bf16 v37, v146, v49, 0
    v_dot2_f32_bf16 v38, v145, v50, 0
    v_dot2_f32_bf16 v39, v147, v51, 0
    v_dot2_f32_bf16 v40, v148, v52, 0
    v_dot2_f32_bf16 v41, v150, v53, 0
    v_dot2_f32_bf16 v42, v149, v54, 0
    v_dot2_f32_bf16 v43, v151, v55, 0
    v_dot2_f32_bf16 v44, v152, v56, 0
    v_dot2_f32_bf16 v45, v154, v57, 0
    v_dot2_f32_bf16 v46, v153, v58, 0
    v_dot2_f32_bf16 v47, v155, v59, 0
    s_add_u32 s79, s79, 12
    s_cmp_ge_i32 s80, s79
    s_cbranch_scc1 L_kr6g
L_kr6:
    ds_read_b32 v19, v7
    s_sleep 1
    s_waitcnt lgkmcnt(0)
    v_readlane_b32 s80, v19, 5
    s_nop 0
    s_cmp_lt_i32 s80, s79
    s_cbranch_scc1 L_kr6
L_kr6g:
    ds_read_b32 v10, v3 offset:768
    ds_read_b128 v[24:27], v2 offset:24576
    ds_read_b128 v[28:31], v2 offset:24832
    ds_read_b128 v[32:35], v2 offset:25088
    v_add_u32 v6, 1, v6
    ds_write_b32 v5, v6
    s_waitcnt lgkmcnt(3)
    v_and_b32 v12, 0xffff0000, v10
    v_cvt_f32_i32 v24, v24
    v_cvt_f32_i32 v25, v25
    v_cvt_f32_i32 v26, v26
    v_cvt_f32_i32 v27, v27
    v_pk_add_f32 v[24:25], v[24:25], v[12:13] op_sel:[0,0] op_sel_hi:[1,0] neg_lo:[0,1] neg_hi:[0,1]
    v_pk_add_f32 v[26:27], v[26:27], v[12:13] op_sel:[0,0] op_sel_hi:[1,0] neg_lo:[0,1] neg_hi:[0,1]
    v_pk_mul_f32 v[14:15], v[24:25], v[36:37]
    v_pk_fma_f32 v[14:15], v[26:27], v[38:39], v[14:15]
    s_waitcnt lgkmcnt(2)
    v_cvt_f32_i32 v28, v28
    v_cvt_f32_i32 v29, v29
    v_cvt_f32_i32 v30, v30
    v_cvt_f32_i32 v31, v31
    v_pk_add_f32 v[28:29], v[28:29], v[12:13] op_sel:[0,0] op_sel_hi:[1,0] neg_lo:[0,1] neg_hi:[0,1]
    v_pk_add_f32 v[30:31], v[30:31], v[12:13] op_sel:[0,0] op_sel_hi:[1,0] neg_lo:[0,1] neg_hi:[0,1]
    v_pk_fma_f32 v[14:15], v[28:29], v[40:41], v[14:15]
    v_pk_fma_f32 v[14:15], v[30:31], v[42:43], v[14:15]
    s_waitcnt lgkmcnt(1)
    v_cvt_f32_i32 v32, v32
    v_cvt_f32_i32 v33, v33
    v_cvt_f32_i32 v34, v34
    v_cvt_f32_i32 v35, v35
    v_pk_add_f32 v[32:33], v[32:33], v[12:13] op_sel:[0,0] op_sel_hi:[1,0] neg_lo:[0,1] neg_hi:[0,1]
    v_pk_add_f32 v[34:35], v[34:35], v[12:13] op_sel:[0,0] op_sel_hi:[1,0] neg_lo:[0,1] neg_hi:[0,1]
    v_pk_fma_f32 v[14:15], v[32:33], v[44:45], v[14:15]
    v_pk_fma_f32 v[14:15], v[34:35], v[46:47], v[14:15]
    v_add_f32 v14, v14, v15
    s_nop 1
    v_add_f32_dpp v18, v14, v14 row_ror:8 row_mask:0xf bank_mask:0x3
    s_cmp_lg_u32 s81, 0
    s_nop 0
    s_cbranch_scc1 L_ncs7
    s_waitcnt vmcnt(0)
    v_perm_b32 v36, v158, v156, s83
    v_perm_b32 v158, v158, v156, s84
    v_perm_b32 v37, v159, v157, s83
    v_perm_b32 v159, v159, v157, s84
    v_perm_b32 v38, v162, v160, s83
    v_perm_b32 v162, v162, v160, s84
    v_perm_b32 v39, v163, v161, s83
    v_perm_b32 v163, v163, v161, s84
    v_perm_b32 v40, v166, v164, s83
    v_perm_b32 v166, v166, v164, s84
    v_perm_b32 v41, v167, v165, s83
    v_perm_b32 v167, v167, v165, s84
    v_mov_b64 v[156:157], v[36:37]
    v_mov_b64 v[160:161], v[38:39]
    v_mov_b64 v[164:165], v[40:41]
    s_nop 1
L_ncs7:
    v_dot2_f32_bf16 v36, v156, v48, 0
    v_dot2_f32_bf16 v37, v158, v49, 0
    v_dot2_f32_bf16 v38, v157, v50, 0
    v_dot2_f32_bf16 v39, v159, v51, 0
    v_dot2_f32_bf16 v40, v160, v52, 0
    v_dot2_f32_bf16 v41, v162, v53, 0
    v_dot2_f32_bf16 v42, v161, v54, 0
    v_dot2_f32_bf16 v43, v163, v55, 0
    v_dot2_f32_bf16 v44, v164, v56, 0
    v_dot2_f32_bf16 v45, v166, v57, 0
    v_dot2_f32_bf16 v46, v165, v58, 0
    v_dot2_f32_bf16 v47, v167, v59, 0
    s_add_u32 s79, s79, 12
    s_cmp_ge_i32 s80, s79
    s_cbranch_scc1 L_kr7g
L_kr7:
    ds_read_b32 v19, v7
    s_sleep 1
    s_waitcnt lgkmcnt(0)
    v_readlane_b32 s80, v19, 5
    s_nop 0
    s_cmp_lt_i32 s80, s79
    s_cbranch_scc1 L_kr7
L_kr7g:
    ds_read_b32 v11, v3 offset:896
    ds_read_b128 v[24:27], v2 offset:36864
    ds_read_b128 v[28:31], v2 offset:37120
    ds_read_b128 v[32:35], v2 offset:37376
    v_add_u32 v6, 1, v6
    ds_write_b32 v5, v6
    s_waitcnt lgkmcnt(3)
    v_and_b32 v12, 0xffff0000, v11
    v_cvt_f32_i32 v24, v24
    v_cvt_f32_i32 v25, v25
    v_cvt_f32_i32 v26, v26
    v_cvt_f32_i32 v27, v27
    v_pk_add_f32 v[24:25], v[24:25], v[12:13] op_sel:[0,0] op_sel_hi:[1,0] neg_lo:[0,1] neg_hi:[0,1]
    v_pk_add_f32 v[26:27], v[26:27], v[12:13] op_sel:[0,0] op_sel_hi:[1,0] neg_lo:[0,1] neg_hi:[0,1]
    v_pk_mul_f32 v[16:17], v[24:25], v[36:37]
    v_pk_fma_f32 v[16:17], v[26:27], v[38:39], v[16:17]
    s_waitcnt lgkmcnt(2)
    v_cvt_f32_i32 v28, v28
    v_cvt_f32_i32 v29, v29
    v_cvt_f32_i32 v30, v30
    v_cvt_f32_i32 v31, v31
    v_pk_add_f32 v[28:29], v[28:29], v[12:13] op_sel:[0,0] op_sel_hi:[1,0] neg_lo:[0,1] neg_hi:[0,1]
    v_pk_add_f32 v[30:31], v[30:31], v[12:13] op_sel:[0,0] op_sel_hi:[1,0] neg_lo:[0,1] neg_hi:[0,1]
    v_pk_fma_f32 v[16:17], v[28:29], v[40:41], v[16:17]
    v_pk_fma_f32 v[16:17], v[30:31], v[42:43], v[16:17]
    s_waitcnt lgkmcnt(1)
    v_cvt_f32_i32 v32, v32
    v_cvt_f32_i32 v33, v33
    v_cvt_f32_i32 v34, v34
    v_cvt_f32_i32 v35, v35
    v_pk_add_f32 v[32:33], v[32:33], v[12:13] op_sel:[0,0] op_sel_hi:[1,0] neg_lo:[0,1] neg_hi:[0,1]
    v_pk_add_f32 v[34:35], v[34:35], v[12:13] op_sel:[0,0] op_sel_hi:[1,0] neg_lo:[0,1] neg_hi:[0,1]
    v_pk_fma_f32 v[16:17], v[32:33], v[44:45], v[16:17]
    v_pk_fma_f32 v[16:17], v[34:35], v[46:47], v[16:17]
    v_add_f32 v16, v16, v17
    v_cndmask_b32 v23, v10, v11, s[86:87]
    v_lshlrev_b32 v23, 16, v23
    v_add_f32_dpp v18, v16, v16 row_ror:8 row_mask:0xf bank_mask:0xc
    v_mul_f32 v23, 0x3dd53b95, v23
    s_nop 0
    v_add_f32_dpp v18, v18, v18 row_half_mirror row_mask:0xf bank_mask:0xf
    s_nop 1
    v_add_f32_dpp v18, v18, v18 quad_perm:[2,3,0,1] row_mask:0xf bank_mask:0xf
    s_nop 1
    v_add_f32_dpp v18, v18, v18 quad_perm:[1,0,3,2] row_mask:0xf bank_mask:0xf
    v_mul_f32 v18, v23, v18
    ds_write_b32 v4, v18 offset:768
    s_mov_b64 exec, 1
    ds_add_u32 v22, v8
    s_mov_b64 exec, -1
    v_add_u32 v3, 1024, v3
    v_add_u32 v4, 1024, v4
    s_add_u32 s81, s81, 1
    s_cmp_lt_u32 s81, 16
    s_cbranch_scc1 L_kph
    v_subrev_u32 v3, 1024, v3
    s_mul_i32 s92, s78, 768
    s_add_u32 s92, s92, 65536
    v_and_b32 v18, 15, v1
    v_lshl_add_u32 v9, v18, 4, s92
    v_lshrrev_b32 v18, 4, v1
    v_lshl_add_u32 v9, v18, 2, v9
    v_mov_b32 v22, 77920
    s_mov_b64 s[20:21], s[74:75]
    s_mov_b32 s22, 1610612736
    s_mov_b32 s23, 0x20000
    s_mov_b64 s[28:29], s[70:71]
    s_mov_b32 s30, 12288
    s_mov_b32 s31, 0x20000
    s_lshr_b32 s93, s2, 3
    s_mul_i32 s92, s93, 43
    s_lshr_b32 s92, s92, 8
    s_mul_i32 s94, s92, 6
    s_sub_u32 s93, s93, s94
    s_and_b32 s94, s2, 6
    s_lshl1_add_u32 s92, s94, s92
    s_and_b32 s94, s2, 1
    s_lshl1_add_u32 s92, s92, s94
    s_lshl2_add_u32 s94, s92, s78
    s_mul_i32 s32, s94, 24576
    s_lshl_b32 s94, s93, 7
    s_add_u32 s32, s32, s94
    s_add_u32 s33, s32, 6144
    s_add_u32 s34, s33, 6144
    s_add_u32 s35, s34, 6144
    s_mul_i32 s36, s92, 6
    s_add_u32 s36, s36, s93
    s_lshl_b32 s36, s36, 6
    s_lshr_b32 s37, s92, 1
    s_sub_u32 s37, s37, 1
    s_and_b32 s37, s37, 15
    s_add_u32 s37, s37, 2
    s_min_u32 s37, s37, 16
    v_lshrrev_b32 v19, 3, v1
    v_and_b32 v69, 7, v1
    v_mul_u32_u24 v68, 768, v19
    v_lshl_add_u32 v68, v69, 4, v68
    v_lshlrev_b32 v69, 3, v69
    v_lshl_add_u32 v69, v18, 1, v69
    s_lshl4_add_u32 s92, s78, 78336
    v_lshl_add_u32 v70, v19, 6, s92
    s_lshl_b32 s92, s78, 8
    s_add_u32 s92, s92, 1024
    v_add_u32 v4, s92, v7
    s_mov_b32 s81, 0
    s_nop 0
L_vph:
    v_mov_b64 v[72:73], 0
    v_mov_b64 v[74:75], 0
    v_mov_b64 v[76:77], 0
    v_mov_b64 v[78:79], 0
    v_mov_b64 v[80:81], 0
    v_mov_b64 v[82:83], 0
    s_and_b32 s92, s81, 3
    s_mul_i32 s92, s92, 3072
    v_add_u32 v71, s92, v9
    s_mov_b32 s88, 0
    s_nop 0
L_vw:
    ds_read_b32 v19, v7
    s_waitcnt lgkmcnt(0)
    v_readlane_b32 s92, v19, 15
    v_readlane_b32 s93, v19, 13
    s_nop 0
    s_and_b32 s93, s93, 16
    s_add_u32 s92, s92, 4
    s_min_u32 s93, s93, s92
    s_cmp_le_u32 s93, s81
    s_cbranch_scc1 L_vw
    s_cmp_lg_u32 s81, 15
    s_cbranch_scc1 L_vit
    v_readlane_b32 s4, v19, 6
    s_cmp_ge_u32 s2, 192
    s_nop 3
    s_cbranch_scc1 L_vit
    s_cmp_eq_u32 s4, 0
    s_cbranch_scc1 L_vw
    ds_read_b128 v[64:67], v70
    s_bfe_u32 s5, s4, 0x80008
    s_bfe_u32 s6, s4, 0x80010
    s_lshr_b32 s7, s4, 24
    s_and_b32 s4, s4, 0xff
L_vit:
    s_add_u32 s79, s79, 12
    s_cmp_ge_i32 s80, s79
    s_cbranch_scc1 L_vr0g
L_vr0:
    ds_read_b32 v19, v7
    s_waitcnt lgkmcnt(0)
    v_readlane_b32 s80, v19, 5
    s_nop 0
    s_cmp_lt_i32 s80, s79
    s_cbranch_scc1 L_vr0
L_vr0g:
    ds_read_b32 v10, v3 offset:0
    ds_read_b128 v[24:27], v2 offset:0
    ds_read_b128 v[28:31], v2 offset:256
    ds_read_b128 v[32:35], v2 offset:512
    v_add_u32 v6, 1, v6
    ds_write_b32 v5, v6
    s_waitcnt lgkmcnt(3)
    v_cvt_f32_i32 v24, v24
    v_cvt_f32_i32 v25, v25
    v_cvt_f32_i32 v26, v26
    v_cvt_f32_i32 v27, v27
    v_pk_fma_f32 v[72:73], v[24:25], v[10:11], v[72:73] op_sel:[0,0,0] op_sel_hi:[1,0,1]
    v_pk_fma_f32 v[74:75], v[26:27], v[10:11], v[74:75] op_sel:[0,0,0] op_sel_hi:[1,0,1]
    s_waitcnt lgkmcnt(2)
    v_cvt_f32_i32 v28, v28
    v_cvt_f32_i32 v29, v29
    v_cvt_f32_i32 v30, v30
    v_cvt_f32_i32 v31, v31
    v_pk_fma_f32 v[76:77], v[28:29], v[10:11], v[76:77] op_sel:[0,0,0] op_sel_hi:[1,0,1]
    v_pk_fma_f32 v[78:79], v[30:31], v[10:11], v[78:79] op_sel:[0,0,0] op_sel_hi:[1,0,1]
    s_waitcnt lgkmcnt(1)
    v_cvt_f32_i32 v32, v32
    v_cvt_f32_i32 v33, v33
    v_cvt_f32_i32 v34, v34
    v_cvt_f32_i32 v35, v35
    v_pk_fma_f32 v[80:81], v[32:33], v[10:11], v[80:81] op_sel:[0,0,0] op_sel_hi:[1,0,1]
    v_pk_fma_f32 v[82:83], v[34:35], v[10:11], v[82:83] op_sel:[0,0,0] op_sel_hi:[1,0,1]
    s_add_u32 s79, s79, 12
    s_cmp_ge_i32 s80, s79
    s_cbranch_scc1 L_vr1g
L_vr1:
    ds_read_b32 v19, v7
    s_waitcnt lgkmcnt(0)
    v_readlane_b32 s80, v19, 5
    s_nop 0
    s_cmp_lt_i32 s80, s79
    s_cbranch_scc1 L_vr1
L_vr1g:
    ds_read_b32 v10, v3 offset:128
    ds_read_b128 v[24:27], v2 offset:12288
    ds_read_b128 v[28:31], v2 offset:12544
    ds_read_b128 v[32:35], v2 offset:12800
    v_add_u32 v6, 1, v6
    ds_write_b32 v5, v6
    s_waitcnt lgkmcnt(3)
    v_cvt_f32_i32 v24, v24
    v_cvt_f32_i32 v25, v25
    v_cvt_f32_i32 v26, v26
    v_cvt_f32_i32 v27, v27
    v_pk_fma_f32 v[72:73], v[24:25], v[10:11], v[72:73] op_sel:[0,0,0] op_sel_hi:[1,0,1]
    v_pk_fma_f32 v[74:75], v[26:27], v[10:11], v[74:75] op_sel:[0,0,0] op_sel_hi:[1,0,1]
    s_waitcnt lgkmcnt(2)
    v_cvt_f32_i32 v28, v28
    v_cvt_f32_i32 v29, v29
    v_cvt_f32_i32 v30, v30
    v_cvt_f32_i32 v31, v31
    v_pk_fma_f32 v[76:77], v[28:29], v[10:11], v[76:77] op_sel:[0,0,0] op_sel_hi:[1,0,1]
    v_pk_fma_f32 v[78:79], v[30:31], v[10:11], v[78:79] op_sel:[0,0,0] op_sel_hi:[1,0,1]
    s_waitcnt lgkmcnt(1)
    v_cvt_f32_i32 v32, v32
    v_cvt_f32_i32 v33, v33
    v_cvt_f32_i32 v34, v34
    v_cvt_f32_i32 v35, v35
    v_pk_fma_f32 v[80:81], v[32:33], v[10:11], v[80:81] op_sel:[0,0,0] op_sel_hi:[1,0,1]
    v_pk_fma_f32 v[82:83], v[34:35], v[10:11], v[82:83] op_sel:[0,0,0] op_sel_hi:[1,0,1]
    s_add_u32 s79, s79, 12
    s_cmp_ge_i32 s80, s79
    s_cbranch_scc1 L_vr2g
L_vr2:
    ds_read_b32 v19, v7
    s_waitcnt lgkmcnt(0)
    v_readlane_b32 s80, v19, 5
    s_nop 0
    s_cmp_lt_i32 s80, s79
    s_cbranch_scc1 L_vr2
L_vr2g:
    ds_read_b32 v10, v3 offset:256
    ds_read_b128 v[24:27], v2 offset:24576
    ds_read_b128 v[28:31], v2 offset:24832
    ds_read_b128 v[32:35], v2 offset:25088
    v_add_u32 v6, 1, v6
    ds_write_b32 v5, v6
    s_waitcnt lgkmcnt(3)
    v_cvt_f32_i32 v24, v24
    v_cvt_f32_i32 v25, v25
    v_cvt_f32_i32 v26, v26
    v_cvt_f32_i32 v27, v27
    v_pk_fma_f32 v[72:73], v[24:25], v[10:11], v[72:73] op_sel:[0,0,0] op_sel_hi:[1,0,1]
    v_pk_fma_f32 v[74:75], v[26:27], v[10:11], v[74:75] op_sel:[0,0,0] op_sel_hi:[1,0,1]
    s_waitcnt lgkmcnt(2)
    v_cvt_f32_i32 v28, v28
    v_cvt_f32_i32 v29, v29
    v_cvt_f32_i32 v30, v30
    v_cvt_f32_i32 v31, v31
    v_pk_fma_f32 v[76:77], v[28:29], v[10:11], v[76:77] op_sel:[0,0,0] op_sel_hi:[1,0,1]
    v_pk_fma_f32 v[78:79], v[30:31], v[10:11], v[78:79] op_sel:[0,0,0] op_sel_hi:[1,0,1]
    s_waitcnt lgkmcnt(1)
    v_cvt_f32_i32 v32, v32
    v_cvt_f32_i32 v33, v33
    v_cvt_f32_i32 v34, v34
    v_cvt_f32_i32 v35, v35
    v_pk_fma_f32 v[80:81], v[32:33], v[10:11], v[80:81] op_sel:[0,0,0] op_sel_hi:[1,0,1]
    v_pk_fma_f32 v[82:83], v[34:35], v[10:11], v[82:83] op_sel:[0,0,0] op_sel_hi:[1,0,1]
    s_add_u32 s79, s79, 12
    s_cmp_ge_i32 s80, s79
    s_cbranch_scc1 L_vr3g
L_vr3:
    ds_read_b32 v19, v7
    s_waitcnt lgkmcnt(0)
    v_readlane_b32 s80, v19, 5
    s_nop 0
    s_cmp_lt_i32 s80, s79
    s_cbranch_scc1 L_vr3
L_vr3g:
    ds_read_b32 v10, v3 offset:384
    ds_read_b128 v[24:27], v2 offset:36864
    ds_read_b128 v[28:31], v2 offset:37120
    ds_read_b128 v[32:35], v2 offset:37376
    v_add_u32 v6, 1, v6
    ds_write_b32 v5, v6
    v_add_u32 v3, 512, v3
    s_add_u32 s88, s88, 1
    s_cmp_lt_u32 s88, 2
    s_waitcnt lgkmcnt(3)
    v_cvt_f32_i32 v24, v24
    v_cvt_f32_i32 v25, v25
    v_cvt_f32_i32 v26, v26
    v_cvt_f32_i32 v27, v27
    v_pk_fma_f32 v[72:73], v[24:25], v[10:11], v[72:73] op_sel:[0,0,0] op_sel_hi:[1,0,1]
    v_pk_fma_f32 v[74:75], v[26:27], v[10:11], v[74:75] op_sel:[0,0,0] op_sel_hi:[1,0,1]
    s_waitcnt lgkmcnt(2)
    v_cvt_f32_i32 v28, v28
    v_cvt_f32_i32 v29, v29
    v_cvt_f32_i32 v30, v30
    v_cvt_f32_i32 v31, v31
    v_pk_fma_f32 v[76:77], v[28:29], v[10:11], v[76:77] op_sel:[0,0,0] op_sel_hi:[1,0,1]
    v_pk_fma_f32 v[78:79], v[30:31], v[10:11], v[78:79] op_sel:[0,0,0] op_sel_hi:[1,0,1]
    s_waitcnt lgkmcnt(1)
    v_cvt_f32_i32 v32, v32
    v_cvt_f32_i32 v33, v33
    v_cvt_f32_i32 v34, v34
    v_cvt_f32_i32 v35, v35
    v_pk_fma_f32 v[80:81], v[32:33], v[10:11], v[80:81] op_sel:[0,0,0] op_sel_hi:[1,0,1]
    v_pk_fma_f32 v[82:83], v[34:35], v[10:11], v[82:83] op_sel:[0,0,0] op_sel_hi:[1,0,1]
    s_cbranch_scc1 L_vit
    v_permlane32_swap_b32 v72, v74
    v_permlane32_swap_b32 v73, v75
    v_permlane32_swap_b32 v76, v78
    v_permlane32_swap_b32 v77, v79
    v_permlane32_swap_b32 v80, v82
    v_permlane32_swap_b32 v81, v83
    v_pk_add_f32 v[72:73], v[72:73], v[74:75]
    v_pk_add_f32 v[76:77], v[76:77], v[78:79]
    v_pk_add_f32 v[80:81], v[80:81], v[82:83]
    v_permlane16_swap_b32 v72, v73
    v_permlane16_swap_b32 v76, v77
    v_permlane16_swap_b32 v80, v81
    v_add_f32 v36, v72, v73
    v_add_f32 v37, v76, v77
    v_add_f32 v38, v80, v81
    ds_write2st64_b32 v71, v36, v37 offset0:0 offset1:1
    ds_write_b32 v71, v38 offset:512
    s_mov_b64 exec, 1
    ds_add_u32 v22, v8
    s_mov_b64 exec, -1
    v_add_u32 v22, 4, v22
    v_subrev_u32 v3, 2048, v3
    s_add_u32 s81, s81, 1
    s_cmp_lt_u32 s81, 16
    s_cbranch_scc1 L_vph
    s_cmp_ge_u32 s2, 192
    s_cbranch_scc1 L_cend
L_gw:
    ds_read_b32 v19, v7
    s_waitcnt lgkmcnt(0)
    v_readlane_b32 s92, v19, 8
    s_nop 0
    s_cmp_lt_u32 s92, s37
    s_nop 2
    s_cbranch_scc1 L_gw
L_try:
    buffer_load_dwordx4 v[48:51], v68, s[20:23], s32 offen sc0 sc1
    buffer_load_dwordx4 v[52:55], v68, s[20:23], s33 offen sc0 sc1
    buffer_load_dwordx4 v[56:59], v68, s[20:23], s34 offen sc0 sc1
    buffer_load_dwordx4 v[60:63], v68, s[20:23], s35 offen sc0 sc1
    s_waitcnt vmcnt(3)
    v_xor_b32 v48, s4, v48
    v_xor_b32 v49, s5, v49
    v_xor_b32 v50, s6, v50
    v_xor_b32 v51, s7, v51
    v_or_b32 v23, v48, v49
    v_pk_mul_f32 v[14:15], v[48:49], v[64:65] op_sel:[0,0] op_sel_hi:[1,0]
    v_or3_b32 v23, v23, v50, v51
    v_pk_mul_f32 v[16:17], v[50:51], v[64:65] op_sel:[0,0] op_sel_hi:[1,0]
    s_waitcnt vmcnt(2)
    v_xor_b32 v52, s4, v52
    v_xor_b32 v53, s5, v53
    v_xor_b32 v54, s6, v54
    v_xor_b32 v55, s7, v55
    v_or3_b32 v23, v23, v52, v53
    v_pk_fma_f32 v[14:15], v[52:53], v[64:65], v[14:15] op_sel:[0,1,0] op_sel_hi:[1,1,1]
    v_or3_b32 v23, v23, v54, v55
    v_pk_fma_f32 v[16:17], v[54:55], v[64:65], v[16:17] op_sel:[0,1,0] op_sel_hi:[1,1,1]
    s_waitcnt vmcnt(1)
    v_xor_b32 v56, s4, v56
    v_xor_b32 v57, s5, v57
    v_xor_b32 v58, s6, v58
    v_xor_b32 v59, s7, v59
    v_or3_b32 v23, v23, v56, v57
    v_pk_fma_f32 v[14:15], v[56:57], v[66:67], v[14:15] op_sel:[0,0,0] op_sel_hi:[1,0,1]
    v_or3_b32 v23, v23, v58, v59
    v_pk_fma_f32 v[16:17], v[58:59], v[66:67], v[16:17] op_sel:[0,0,0] op_sel_hi:[1,0,1]
    s_waitcnt vmcnt(0)
    v_xor_b32 v60, s4, v60
    v_xor_b32 v61, s5, v61
    v_xor_b32 v62, s6, v62
    v_xor_b32 v63, s7, v63
    v_or3_b32 v23, v23, v60, v61
    v_pk_fma_f32 v[14:15], v[60:61], v[66:67], v[14:15] op_sel:[0,1,0] op_sel_hi:[1,1,1]
    v_or3_b32 v23, v23, v62, v63
    v_pk_fma_f32 v[16:17], v[62:63], v[66:67], v[16:17] op_sel:[0,1,0] op_sel_hi:[1,1,1]
    v_and_b32 v23, 0xff, v23
    v_cmp_ne_u32 vcc, 0, v23
    s_nop 4
    s_cbranch_vccz L_cok
    s_mov_b64 exec, vcc
    s_sleep 1
    s_add_u32 s88, s88, 1
    s_cmp_lt_u32 s88, 400000
    s_cbranch_scc1 L_try
L_cok:
    s_mov_b64 exec, -1
    v_permlane32_swap_b32 v14, v16
    v_permlane32_swap_b32 v15, v17
    v_pk_add_f32 v[14:15], v[14:15], v[16:17]
    s_nop 1
    v_permlane16_swap_b32 v14, v15
    v_add_f32 v14, v14, v15
    ds_write_b32 v4, v14
    s_mov_b64 exec, 1
    ds_add_rtn_u32 v18, v7, v8 offset:28
    s_mov_b64 exec, -1
    ds_read2st64_b32 v[14:15], v7 offset0:4 offset1:5
    ds_read2st64_b32 v[16:17], v7 offset0:6 offset1:7
    s_waitcnt lgkmcnt(0)
    v_readfirstlane_b32 s92, v18
    v_pk_add_f32 v[14:15], v[14:15], v[16:17]
    v_add_f32 v14, v14, v15
    s_cmp_lg_u32 s92, 3
    s_nop 1
    s_cbranch_scc1 L_cend
    v_add_f32_dpp v14, v14, v14 row_ror:8 row_mask:0xf bank_mask:0xf
    s_mov_b32 exec_lo, 0x00ff00ff
    s_mov_b32 exec_hi, 0x00ff00ff
    v_cvt_pk_bf16_f32 v14, v14, v14
    buffer_store_short v14, v69, s[28:31], s36 offen
    s_nop 0
L_cend:
    s_waitcnt lgkmcnt(0)
    s_endpgm
L_helper:
    s_memrealtime s[96:97]
    v_bfe_u32 v22, v1, 2, 3
    v_lshl_add_u32 v22, v22, 11, s77
    v_and_b32 v22, 16383, v22
    v_lshrrev_b32 v19, 5, v1
    v_lshl_add_u32 v22, v19, 15, v22
    v_and_b32 v19, 3, v1
    v_lshlrev_b32 v19, 3, v19
    v_lshl_add_u32 v22, v22, 1, v19
    s_lshl_b32 s91, s3, 15
    v_lshlrev_b32 v2, 4, v1
    s_mov_b32 s6, 1048576
    s_mov_b32 s7, 0x20000
    s_mov_b32 s10, 1048576
    s_mov_b32 s11, 0x20000
    s_mov_b32 s14, 1048576
    s_mov_b32 s15, 0x20000
    s_mov_b32 s18, 1048576
    s_mov_b32 s19, 0x20000
    s_waitcnt lgkmcnt(0)
    s_mov_b64 s[4:5], s[52:53]
    s_mov_b64 s[8:9], s[54:55]
    s_mov_b64 s[12:13], s[58:59]
    s_mov_b64 s[16:17], s[60:61]
    buffer_load_dwordx2 v[108:109], v22, s[4:7], s91 offen
    buffer_load_dwordx2 v[110:111], v22, s[8:11], s91 offen
    buffer_load_dwordx2 v[112:113], v22, s[12:15], s91 offen
    buffer_load_dwordx2 v[114:115], v22, s[16:19], s91 offen
    s_add_u32 s91, s91, 131072
    s_barrier
    v_lshrrev_b32 v18, 1, v1
    v_lshlrev_b32 v18, 10, v18
    v_and_b32 v19, 1, v1
    v_lshl_add_u32 v18, v19, 6, v18
    s_lshr_b32 s92, s2, 3
    s_lshl_b32 s92, s92, 15
    s_and_b32 s93, s2, 7
    s_lshl_b32 s93, s93, 7
    s_add_u32 s92, s92, s93
    buffer_load_dword v6, v18, s[4:7], s92 offen
    buffer_load_dword v6, v18, s[8:11], s92 offen
    buffer_load_dword v6, v18, s[12:15], s92 offen
    buffer_load_dword v6, v18, s[16:19], s92 offen
    s_mov_b64 s[20:21], s[74:75]
    s_mov_b32 s22, 1610612736
    s_mov_b32 s23, 0x20000
    s_mov_b64 s[24:25], s[72:73]
    s_mov_b32 s26, 256
    s_mov_b32 s27, 0x20000
    s_mov_b64 s[32:33], s[48:49]
    s_mov_b32 s34, 12288
    s_mov_b32 s35, 0x20000
    s_mov_b64 s[36:37], s[62:63]
    s_mov_b32 s38, 384
    s_mov_b32 s39, 0x20000
    s_mov_b64 s[40:41], s[64:65]
    s_mov_b32 s42, 384
    s_mov_b32 s43, 0x20000
    v_lshlrev_b32 v44, 3, v1
    v_cmp_gt_u32 vcc, 24, v1
    v_mov_b32 v23, 0xffffff40
    v_mov_b32 v18, 192
    v_cndmask_b32 v23, v23, v18, vcc
    v_add_u32 v45, v44, v23
    v_mov_b32 v18, 0x80008000
    v_cndmask_b32 v46, 0, v18, vcc
    s_mov_b32 s78, s96
    s_mov_b32 s94, 0x05040100
    s_mov_b32 s95, 0x07060302
    v_lshlrev_b32 v9, 1, v2
    v_add_u32 v9, 49152, v9
    v_mov_b32 v3, 77824
    v_mov_b32 v4, 0
    v_mov_b32 v5, 0xff
    v_mov_b32 v12, v9
    buffer_load_dwordx2 v[40:41], v44, s[36:39], 0 offen
    buffer_load_dwordx2 v[42:43], v44, s[40:43], 0 offen
    s_mul_i32 s92, s3, 384
    s_add_u32 s92, s92, 6144
    buffer_load_dwordx2 v[136:137], v44, s[32:35], s92 offen
    buffer_load_dwordx2 v[138:139], v45, s[32:35], s92 offen
    buffer_load_dwordx2 v[140:141], v44, s[32:35], s92 offen offset:768
    buffer_load_dwordx2 v[142:143], v45, s[32:35], s92 offen offset:768
    s_add_u32 s92, s92, 1536
    buffer_load_dwordx2 v[144:145], v44, s[32:35], s92 offen
    buffer_load_dwordx2 v[146:147], v45, s[32:35], s92 offen
    buffer_load_dwordx2 v[148:149], v44, s[32:35], s92 offen offset:768
    buffer_load_dwordx2 v[150:151], v45, s[32:35], s92 offen offset:768
    s_add_u32 s92, s92, 1536
    buffer_load_dwordx2 v[152:153], v44, s[32:35], s92 offen
    buffer_load_dwordx2 v[154:155], v45, s[32:35], s92 offen
    buffer_load_dwordx2 v[156:157], v44, s[32:35], s92 offen offset:768
    buffer_load_dwordx2 v[158:159], v45, s[32:35], s92 offen offset:768
    s_add_u32 s92, s92, 1536
    buffer_load_dwordx2 v[160:161], v44, s[32:35], s92 offen
    buffer_load_dwordx2 v[162:163], v45, s[32:35], s92 offen
    buffer_load_dwordx2 v[164:165], v44, s[32:35], s92 offen offset:768
    buffer_load_dwordx2 v[166:167], v45, s[32:35], s92 offen offset:768
    s_waitcnt vmcnt(22)
    v_perm_b32 v116, v110, v108, s94
    v_perm_b32 v117, v114, v112, s94
    v_perm_b32 v118, v110, v108, s95
    v_perm_b32 v119, v114, v112, s95
    v_perm_b32 v120, v111, v109, s94
    v_perm_b32 v121, v115, v113, s94
    v_perm_b32 v122, v111, v109, s95
    v_perm_b32 v123, v115, v113, s95
    s_lshr_b32 s92, s91, 17
    v_mov_b32 v19, s92
    ds_write_b128 v12, v[116:119]
    ds_write_b128 v12, v[120:123] offset:16
    ds_write_b32 v3, v19 offset:48
    v_add_u32 v12, 2048, v12
    s_mov_b32 s48, 0
    s_cmp_lg_u32 s2, 0
    s_cbranch_scc1 L_ne0
    s_mul_i32 s49, s78, 0x9e3779b1
    s_lshr_b32 s93, s49, 15
    s_xor_b32 s49, s49, s93
    s_mul_i32 s49, s49, 0x85ebca6b
    s_lshr_b32 s93, s49, 13
    s_xor_b32 s49, s49, s93
    s_max_u32 s49, s49, 1
    v_mov_b32 v14, s49
    v_mov_b32 v15, 0
    s_mov_b64 exec, 1
    buffer_atomic_cmpswap v[14:15], v4, s[24:27], 0 offen sc0 sc1
    s_waitcnt vmcnt(0)
    v_readfirstlane_b32 s48, v14
    s_mov_b64 exec, -1
    s_cmp_eq_u32 s48, 0
    s_cselect_b32 s48, s49, s48
    s_nop 1
L_ne0:
    s_getpc_b64 s[92:93]
L_pc:
    s_sub_u32 s92, s92, L_pc-standalone__kv_cache_quant_pre_rope_vs_post_rope__decode_kernel
    s_subb_u32 s93, s93, 0
    s_lshr_b32 s94, s2, 3
    v_lshl_add_u32 v19, v1, 5, s94
    v_lshlrev_b32 v19, 7, v19
    v_min_u32 v19, L_end-standalone__kv_cache_quant_pre_rope_vs_post_rope__decode_kernel, v19
    s_mov_b64 exec, 63
    global_load_dword v6, v19, s[92:93]
    s_mov_b64 exec, -1
    v_lshlrev_b32 v18, 1, v44
    v_lshlrev_b32 v19, 1, v45
    v_add_u32 v18, 71680, v18
    v_add_u32 v19, 71680, v19
    v_mov_b32 v23, 78000
    s_mov_b32 s89, 0
    s_waitcnt vmcnt(1) lgkmcnt(0)
    v_xor_b32 v42, v42, v46
    v_xor_b32 v43, v43, v46
    v_lshlrev_b32 v48, 16, v40
    v_and_b32 v49, 0xffff0000, v40
    v_lshlrev_b32 v50, 16, v41
    v_and_b32 v51, 0xffff0000, v41
    v_lshlrev_b32 v52, 16, v42
    v_and_b32 v53, 0xffff0000, v42
    v_lshlrev_b32 v54, 16, v43
    v_and_b32 v55, 0xffff0000, v43
    v_and_b32 v46, 0x80000000, v46
    s_nop 1
L_hq:
    v_mov_b64 v[24:25], v[136:137]
    v_mov_b64 v[26:27], v[138:139]
    v_mov_b64 v[28:29], v[140:141]
    v_mov_b64 v[30:31], v[142:143]
    v_mov_b64 v[136:137], v[144:145]
    v_mov_b64 v[138:139], v[146:147]
    v_mov_b64 v[140:141], v[148:149]
    v_mov_b64 v[142:143], v[150:151]
    v_mov_b64 v[144:145], v[152:153]
    v_mov_b64 v[146:147], v[154:155]
    v_mov_b64 v[148:149], v[156:157]
    v_mov_b64 v[150:151], v[158:159]
    v_mov_b64 v[152:153], v[160:161]
    v_mov_b64 v[154:155], v[162:163]
    v_mov_b64 v[156:157], v[164:165]
    v_mov_b64 v[158:159], v[166:167]
    s_mov_b32 exec_hi, 0xffff
    v_lshlrev_b32 v56, 16, v24
    v_and_b32 v57, 0xffff0000, v24
    v_lshlrev_b32 v58, 16, v25
    v_and_b32 v59, 0xffff0000, v25
    v_lshlrev_b32 v60, 16, v26
    v_and_b32 v61, 0xffff0000, v26
    v_lshlrev_b32 v62, 16, v27
    v_and_b32 v63, 0xffff0000, v27
    v_pk_mul_f32 v[56:57], v[56:57], v[48:49]
    v_pk_mul_f32 v[60:61], v[60:61], v[52:53]
    v_pk_mul_f32 v[58:59], v[58:59], v[50:51]
    v_pk_mul_f32 v[62:63], v[62:63], v[54:55]
    v_cvt_pk_bf16_f32 v56, v56, v60
    v_cvt_pk_bf16_f32 v57, v57, v61
    v_cvt_pk_bf16_f32 v58, v58, v62
    v_cvt_pk_bf16_f32 v59, v59, v63
    v_and_b32 v60, 0xffff0000, v56
    v_lshlrev_b32 v56, 16, v56
    v_and_b32 v61, 0xffff0000, v57
    v_lshlrev_b32 v57, 16, v57
    v_and_b32 v62, 0xffff0000, v58
    v_lshlrev_b32 v58, 16, v58
    v_and_b32 v63, 0xffff0000, v59
    v_lshlrev_b32 v59, 16, v59
    v_pk_add_f32 v[56:57], v[56:57], v[60:61]
    v_pk_add_f32 v[58:59], v[58:59], v[62:63]
    v_cvt_pk_bf16_f32 v64, v56, v56
    v_cvt_pk_bf16_f32 v65, v57, v57
    v_cvt_pk_bf16_f32 v66, v58, v58
    v_cvt_pk_bf16_f32 v67, v59, v59
    v_xor_b32 v64, v64, v46
    v_xor_b32 v65, v65, v46
    v_xor_b32 v66, v66, v46
    v_xor_b32 v67, v67, v46
    ds_write_b16 v18, v64 offset:0
    ds_write_b16_d16_hi v19, v64 offset:2
    ds_write_b16 v18, v65 offset:4
    ds_write_b16_d16_hi v19, v65 offset:6
    ds_write_b16 v18, v66 offset:8
    ds_write_b16_d16_hi v19, v66 offset:10
    ds_write_b16 v18, v67 offset:12
    ds_write_b16_d16_hi v19, v67 offset:14
    v_lshlrev_b32 v56, 16, v28
    v_and_b32 v57, 0xffff0000, v28
    v_lshlrev_b32 v58, 16, v29
    v_and_b32 v59, 0xffff0000, v29
    v_lshlrev_b32 v60, 16, v30
    v_and_b32 v61, 0xffff0000, v30
    v_lshlrev_b32 v62, 16, v31
    v_and_b32 v63, 0xffff0000, v31
    v_pk_mul_f32 v[56:57], v[56:57], v[48:49]
    v_pk_mul_f32 v[60:61], v[60:61], v[52:53]
    v_pk_mul_f32 v[58:59], v[58:59], v[50:51]
    v_pk_mul_f32 v[62:63], v[62:63], v[54:55]
    v_cvt_pk_bf16_f32 v56, v56, v60
    v_cvt_pk_bf16_f32 v57, v57, v61
    v_cvt_pk_bf16_f32 v58, v58, v62
    v_cvt_pk_bf16_f32 v59, v59, v63
    v_and_b32 v60, 0xffff0000, v56
    v_lshlrev_b32 v56, 16, v56
    v_and_b32 v61, 0xffff0000, v57
    v_lshlrev_b32 v57, 16, v57
    v_and_b32 v62, 0xffff0000, v58
    v_lshlrev_b32 v58, 16, v58
    v_and_b32 v63, 0xffff0000, v59
    v_lshlrev_b32 v59, 16, v59
    v_pk_add_f32 v[56:57], v[56:57], v[60:61]
    v_pk_add_f32 v[58:59], v[58:59], v[62:63]
    v_cvt_pk_bf16_f32 v68, v56, v56
    v_cvt_pk_bf16_f32 v69, v57, v57
    v_cvt_pk_bf16_f32 v70, v58, v58
    v_cvt_pk_bf16_f32 v71, v59, v59
    v_xor_b32 v68, v68, v46
    v_xor_b32 v69, v69, v46
    v_xor_b32 v70, v70, v46
    v_xor_b32 v71, v71, v46
    ds_write_b16 v18, v68 offset:768
    ds_write_b16_d16_hi v19, v68 offset:770
    ds_write_b16 v18, v69 offset:772
    ds_write_b16_d16_hi v19, v69 offset:774
    ds_write_b16 v18, v70 offset:776
    ds_write_b16_d16_hi v19, v70 offset:778
    ds_write_b16 v18, v71 offset:780
    ds_write_b16_d16_hi v19, v71 offset:782
    s_mov_b32 exec_hi, -1
    ds_write_b32 v23, v5
    s_add_u32 s89, s89, 1
    v_add_u32 v18, 1536, v18
    v_add_u32 v19, 1536, v19
    v_add_u32 v23, 4, v23
    s_cmp_lt_u32 s89, 4
    s_waitcnt lgkmcnt(0)
    s_cbranch_scc1 L_hq
    s_cmp_lg_u32 s48, 0
    s_cbranch_scc1 L_epd
L_epw:
    s_sleep 1
    ds_read_b32 v19, v7
    s_waitcnt lgkmcnt(0)
    v_readlane_b32 s89, v19, 5
    s_nop 0
    s_cmp_lt_i32 s89, 72
    s_nop 2
    s_cbranch_scc1 L_epw
    s_buffer_load_dword s48, s[24:27], 0
    s_waitcnt lgkmcnt(0)
    s_cmp_lg_u32 s48, 0
    s_cbranch_scc1 L_epd
    s_mul_i32 s49, s78, 0x9e3779b1
    s_lshr_b32 s93, s49, 15
    s_xor_b32 s49, s49, s93
    s_mul_i32 s49, s49, 0x85ebca6b
    s_lshr_b32 s93, s49, 13
    s_xor_b32 s49, s49, s93
    s_max_u32 s49, s49, 1
    v_mov_b32 v14, s49
    v_mov_b32 v15, 0
    s_mov_b64 exec, 1
    buffer_atomic_cmpswap v[14:15], v4, s[24:27], 0 offen sc0 sc1
    s_waitcnt vmcnt(0)
    v_readfirstlane_b32 s48, v14
    s_mov_b64 exec, -1
    s_cmp_eq_u32 s48, 0
    s_cselect_b32 s48, s49, s48
    s_nop 1
L_epd:
    s_waitcnt vmcnt(0)
    s_lshr_b32 s49, s48, 8
    s_lshr_b32 s50, s48, 16
    s_lshr_b32 s51, s48, 24
    s_mov_b32 s79, 0
    s_mov_b32 s80, 0
    s_mov_b32 s85, 0
    s_mov_b32 s84, 0
    s_mov_b32 s83, 0
    s_mov_b32 s98, 0
    s_mov_b32 s99, 0
    s_mov_b32 s33, 0
    s_movk_i32 s81, 240
    s_mov_b32 s82, 0x7fffffff
    s_movk_i32 s70, 850
    s_movk_i32 s71, 850
    s_movk_i32 s68, 132
    s_mov_b32 s69, 0
    s_mov_b32 s86, 16
    s_lshr_b32 s92, s2, 4
    s_and_b32 s93, s2, 15
    s_cmp_eq_u32 s92, s93
    s_cselect_b32 s38, s92, 255
    s_mul_i32 s87, s38, 4352
    s_add_u32 s87, s87, 33554432
    s_mov_b32 s88, 33554432
    v_lshrrev_b32 v18, 5, v1
    v_lshlrev_b32 v11, 4, v18
    v_add_u32 v11, 78080, v11
    v_add_u32 v10, 65536, v2
    v_mov_b32 v20, 78320
    s_mov_b32 s39, 8
    s_and_b32 s41, s2, 0x70
    s_and_b32 s92, s2, 7
    s_lshl1_add_u32 s41, s92, s41
    s_lshr_b32 s92, s2, 7
    s_add_u32 s41, s41, s92
    s_lshl_b32 s92, s3, 7
    s_add_u32 s41, s41, s92
    s_lshr_b32 s92, s2, 3
    s_mul_i32 s34, s92, 43
    s_lshr_b32 s34, s34, 8
    s_mul_i32 s93, s34, 6
    s_sub_u32 s92, s92, s93
    s_and_b32 s93, s2, 6
    s_lshl1_add_u32 s34, s93, s34
    s_and_b32 s93, s2, 1
    s_lshl1_add_u32 s34, s34, s93
    s_lshr_b32 s40, s2, 3
    s_and_b32 s40, s40, 31
    s_mul_i32 s40, s40, 24
    s_addk_i32 s40, 1728
    s_cmp_lt_u32 s2, 192
    s_cselect_b32 s40, s40, 0x7fffffff
    s_mov_b32 s35, 0
    s_mov_b32 s36, 21495808
    s_mov_b32 s37, 0
L_hl:
    s_sleep 1
    ds_read_b32 v19, v7
    s_memrealtime s[96:97]
    s_waitcnt lgkmcnt(0)
    v_readlane_b32 s89, v19, 5
    v_readlane_b32 s90, v19, s86
    s_sub_u32 s96, s96, s78
    s_lshl_b32 s96, s96, 8
    s_mul_i32 s92, s80, s89
    s_add_u32 s92, s92, s79
    s_sub_u32 s92, s96, s92
    s_max_i32 s92, s92, s98
    s_min_i32 s92, s92, s99
    s_mul_i32 s92, s92, s35
    s_add_u32 s92, s92, s36
    s_ashr_i32 s92, s92, 20
    s_max_i32 s92, s92, 15
    s_min_i32 s92, s92, 26
    v_mov_b32 v18, s92
    ds_write_b32 v3, v18 offset:16
    s_cmp_ge_i32 s89, s82
    s_cbranch_scc1 L_rd
    s_cmp_ge_i32 s89, s81
    s_cbranch_scc1 L_pub
    s_cmp_ge_i32 s89, s68
    s_cbranch_scc1 L_tf
    s_cmp_eq_u32 s90, s39
    s_cbranch_scc1 L_prep
    s_cmp_ge_i32 s89, s40
    s_cbranch_scc1 L_wts
    s_cmp_eq_u32 s86, 14
    s_cbranch_scc0 L_hl
    s_branch L_late
L_tf:
    buffer_load_dwordx2 v[108:109], v22, s[4:7], s91 offen
    buffer_load_dwordx2 v[110:111], v22, s[8:11], s91 offen
    buffer_load_dwordx2 v[112:113], v22, s[12:15], s91 offen
    buffer_load_dwordx2 v[114:115], v22, s[16:19], s91 offen
    s_add_u32 s91, s91, 131072
    s_mov_b32 s94, 0x05040100
    s_mov_b32 s95, 0x07060302
    s_addk_i32 s68, 24
    s_cmp_ge_u32 s91, 1048576
    s_cselect_b32 s68, 0x7fffffff, s68
    s_waitcnt vmcnt(0)
    v_perm_b32 v116, v110, v108, s94
    v_perm_b32 v117, v114, v112, s94
    v_perm_b32 v118, v110, v108, s95
    v_perm_b32 v119, v114, v112, s95
    v_perm_b32 v120, v111, v109, s94
    v_perm_b32 v121, v115, v113, s94
    v_perm_b32 v122, v111, v109, s95
    v_perm_b32 v123, v115, v113, s95
    s_lshr_b32 s92, s91, 17
    v_mov_b32 v19, s92
    ds_write_b128 v12, v[116:119]
    ds_write_b128 v12, v[120:123] offset:16
    ds_write_b32 v3, v19 offset:48
    v_add_u32 v12, 2048, v12
    s_waitcnt lgkmcnt(0)
    s_nop 0
    s_branch L_hl
L_pub:
    s_cmp_eq_u32 s80, 0
    s_cselect_b32 s92, 850, s80
    s_sub_u32 s93, s89, s81
    s_mul_i32 s92, s92, s93
    s_sub_u32 s83, s96, s92
    s_add_u32 s82, s81, 72
    s_cmp_ge_u32 s81, 2544
    s_cselect_b32 s92, 4, 8
    s_mul_i32 s92, s92, 24
    s_add_u32 s81, s81, s92
    s_cmp_ge_u32 s38, 16
    s_cbranch_scc1 L_hl
    s_lshl_b32 s92, s78, 8
    s_add_u32 s92, s92, s83
    v_mov_b32 v14, s92
    v_mov_b32 v15, s48
    s_mov_b64 exec, 1
    buffer_store_dwordx2 v[14:15], v4, s[20:23], s87 offen sc0 sc1
    s_mov_b64 exec, -1
    s_add_u32 s87, s87, 69632
    s_branch L_hl
L_rd:
    s_lshl_b32 s92, s78, 8
    s_add_u32 s92, s92, s83
    s_mov_b32 s93, 0
    s_mov_b32 s94, 0
    s_buffer_load_dwordx2 s[52:53], s[20:23], s88
    s_add_u32 s88, s88, 4352
    s_buffer_load_dwordx2 s[54:55], s[20:23], s88
    s_add_u32 s88, s88, 4352
    s_buffer_load_dwordx2 s[56:57], s[20:23], s88
    s_add_u32 s88, s88, 4352
    s_buffer_load_dwordx2 s[58:59], s[20:23], s88
    s_add_u32 s88, s88, 4352
    s_buffer_load_dwordx2 s[60:61], s[20:23], s88
    s_add_u32 s88, s88, 4352
    s_buffer_load_dwordx2 s[62:63], s[20:23], s88
    s_add_u32 s88, s88, 4352
    s_buffer_load_dwordx2 s[64:65], s[20:23], s88
    s_add_u32 s88, s88, 4352
    s_buffer_load_dwordx2 s[66:67], s[20:23], s88
    s_add_u32 s88, s88, 4352
    s_waitcnt lgkmcnt(0)
    s_sub_u32 s52, s52, s92
    s_cmp_eq_u32 s53, s48
    s_cselect_b32 s52, s52, 0
    s_addc_u32 s93, s93, 0
    s_add_u32 s94, s94, s52
    s_sub_u32 s54, s54, s92
    s_cmp_eq_u32 s55, s48
    s_cselect_b32 s54, s54, 0
    s_addc_u32 s93, s93, 0
    s_add_u32 s94, s94, s54
    s_sub_u32 s56, s56, s92
    s_cmp_eq_u32 s57, s48
    s_cselect_b32 s56, s56, 0
    s_addc_u32 s93, s93, 0
    s_add_u32 s94, s94, s56
    s_sub_u32 s58, s58, s92
    s_cmp_eq_u32 s59, s48
    s_cselect_b32 s58, s58, 0
    s_addc_u32 s93, s93, 0
    s_add_u32 s94, s94, s58
    s_sub_u32 s60, s60, s92
    s_cmp_eq_u32 s61, s48
    s_cselect_b32 s60, s60, 0
    s_addc_u32 s93, s93, 0
    s_add_u32 s94, s94, s60
    s_sub_u32 s62, s62, s92
    s_cmp_eq_u32 s63, s48
    s_cselect_b32 s62, s62, 0
    s_addc_u32 s93, s93, 0
    s_add_u32 s94, s94, s62
    s_sub_u32 s64, s64, s92
    s_cmp_eq_u32 s65, s48
    s_cselect_b32 s64, s64, 0
    s_addc_u32 s93, s93, 0
    s_add_u32 s94, s94, s64
    s_sub_u32 s66, s66, s92
    s_cmp_eq_u32 s67, s48
    s_cselect_b32 s66, s66, 0
    s_addc_u32 s93, s93, 0
    s_add_u32 s94, s94, s66
    s_buffer_load_dwordx2 s[52:53], s[20:23], s88
    s_add_u32 s88, s88, 4352
    s_buffer_load_dwordx2 s[54:55], s[20:23], s88
    s_add_u32 s88, s88, 4352
    s_buffer_load_dwordx2 s[56:57], s[20:23], s88
    s_add_u32 s88, s88, 4352
    s_buffer_load_dwordx2 s[58:59], s[20:23], s88
    s_add_u32 s88, s88, 4352
    s_buffer_load_dwordx2 s[60:61], s[20:23], s88
    s_add_u32 s88, s88, 4352
    s_buffer_load_dwordx2 s[62:63], s[20:23], s88
    s_add_u32 s88, s88, 4352
    s_buffer_load_dwordx2 s[64:65], s[20:23], s88
    s_add_u32 s88, s88, 4352
    s_buffer_load_dwordx2 s[66:67], s[20:23], s88
    s_add_u32 s88, s88, 4352
    s_waitcnt lgkmcnt(0)
    s_sub_u32 s52, s52, s92
    s_cmp_eq_u32 s53, s48
    s_cselect_b32 s52, s52, 0
    s_addc_u32 s93, s93, 0
    s_add_u32 s94, s94, s52
    s_sub_u32 s54, s54, s92
    s_cmp_eq_u32 s55, s48
    s_cselect_b32 s54, s54, 0
    s_addc_u32 s93, s93, 0
    s_add_u32 s94, s94, s54
    s_sub_u32 s56, s56, s92
    s_cmp_eq_u32 s57, s48
    s_cselect_b32 s56, s56, 0
    s_addc_u32 s93, s93, 0
    s_add_u32 s94, s94, s56
    s_sub_u32 s58, s58, s92
    s_cmp_eq_u32 s59, s48
    s_cselect_b32 s58, s58, 0
    s_addc_u32 s93, s93, 0
    s_add_u32 s94, s94, s58
    s_sub_u32 s60, s60, s92
    s_cmp_eq_u32 s61, s48
    s_cselect_b32 s60, s60, 0
    s_addc_u32 s93, s93, 0
    s_add_u32 s94, s94, s60
    s_sub_u32 s62, s62, s92
    s_cmp_eq_u32 s63, s48
    s_cselect_b32 s62, s62, 0
    s_addc_u32 s93, s93, 0
    s_add_u32 s94, s94, s62
    s_sub_u32 s64, s64, s92
    s_cmp_eq_u32 s65, s48
    s_cselect_b32 s64, s64, 0
    s_addc_u32 s93, s93, 0
    s_add_u32 s94, s94, s64
    s_sub_u32 s66, s66, s92
    s_cmp_eq_u32 s67, s48
    s_cselect_b32 s66, s66, 0
    s_addc_u32 s93, s93, 0
    s_add_u32 s94, s94, s66
    v_cvt_f32_u32 v15, s93
    v_cvt_f32_i32 v14, s94
    v_rcp_f32 v15, v15
    s_nop 0
    v_mul_f32 v14, v14, v15
    v_cvt_i32_f32 v14, v14
    s_sub_u32 s94, s82, 72
    s_mov_b32 s82, 0x7fffffff
    v_readfirstlane_b32 s92, v14
    s_mov_b32 s95, s85
    s_min_u32 s85, s93, 1
    s_cmp_eq_u32 s93, 0
    s_nop 1
    s_cbranch_scc1 L_hl
    s_sub_u32 s98, 0, s92
    s_movk_i32 s35, 150
    s_mov_b32 s36, 21495808
    s_movk_i32 s93, 6400
    s_cmp_ge_u32 s94, 2544
    s_cmovk_i32 s35, 350
    s_cmov_b32 s36, 21495808
    s_cmovk_i32 s93, 12800
    s_add_u32 s36, s36, s37
    s_max_i32 s99, s98, 0
    s_min_i32 s98, s98, 0
    s_add_u32 s99, s99, s93
    s_sub_u32 s98, s98, s93
    s_min_i32 s99, s99, 1048576
    s_max_i32 s98, s98, -1048576
    s_add_u32 s92, s92, s83
    s_sub_u32 s93, s92, s84
    s_mov_b32 s84, s92
    s_mov_b32 s80, 22369621
    s_cmp_gt_u32 s94, 2544
    s_cmov_b32 s80, 44739243
    s_mul_hi_u32 s93, s93, s80
    s_cmp_eq_u32 s95, 0
    s_cselect_b32 s80, 850, s93
    s_min_u32 s93, s70, s71
    s_max_u32 s95, s70, s71
    s_mov_b32 s71, s70
    s_mov_b32 s70, s80
    s_min_u32 s80, s80, s95
    s_max_u32 s80, s80, s93
    s_max_u32 s80, s80, 1
    s_mul_i32 s93, s80, s94
    s_sub_u32 s79, s92, s93
    s_branch L_hl
L_prep:
    s_cmp_ge_u32 s86, 24
    s_cbranch_scc1 L_mrg
    ds_read_b128 v[24:27], v9
    ds_read_b128 v[28:31], v9 offset:16
    s_add_u32 s86, s86, 1
    s_sub_u32 s92, s86, 16
    s_lshl_b32 s92, s92, 1
    v_mov_b32 v23, s92
    s_waitcnt lgkmcnt(0)
    v_max_f32 v40, v24, v26
    v_max3_f32 v40, v40, v28, v30
    v_lshlrev_b32 v32, 16, v25
    v_lshlrev_b32 v33, 16, v27
    v_lshlrev_b32 v34, 16, v29
    v_lshlrev_b32 v35, 16, v31
    v_max_f32_dpp v40, v40, v40 quad_perm:[1,0,3,2] row_mask:0xf bank_mask:0xf
    s_nop 1
    v_max_f32_dpp v40, v40, v40 quad_perm:[2,3,0,1] row_mask:0xf bank_mask:0xf
    s_nop 1
    v_max_f32_dpp v40, v40, v40 row_half_mirror row_mask:0xf bank_mask:0xf
    s_nop 1
    v_max_f32_dpp v40, v40, v40 row_mirror row_mask:0xf bank_mask:0xf
    v_and_b32 v36, 0xffff0000, v25
    v_and_b32 v37, 0xffff0000, v27
    v_and_b32 v38, 0xffff0000, v29
    v_and_b32 v39, 0xffff0000, v31
    v_mov_b32 v6, v40
    s_nop 1
    v_permlane16_swap_b32 v40, v6
    v_max_f32 v40, v40, v6
    v_sub_f32 v24, v24, v40
    v_sub_f32 v26, v26, v40
    v_sub_f32 v28, v28, v40
    v_sub_f32 v30, v30, v40
    v_exp_f32 v24, v24
    v_exp_f32 v26, v26
    v_exp_f32 v28, v28
    v_exp_f32 v30, v30
    v_add_f32 v42, v24, v26
    v_add_f32 v6, v28, v30
    v_add_f32 v42, v42, v6
    v_mul_f32 v24, v24, v32
    v_mul_f32 v26, v26, v33
    v_mul_f32 v28, v28, v34
    v_mul_f32 v30, v30, v35
    ds_write_b128 v9, v[24:27]
    ds_write_b128 v9, v[28:31] offset:16
    v_mul_f32 v41, v24, v36
    v_fmac_f32 v41, v26, v37
    v_fmac_f32 v41, v28, v38
    v_fmac_f32 v41, v30, v39
    v_add_f32_dpp v42, v42, v42 quad_perm:[1,0,3,2] row_mask:0xf bank_mask:0xf
    s_nop 0
    v_add_f32_dpp v41, v41, v41 quad_perm:[1,0,3,2] row_mask:0xf bank_mask:0xf
    v_add_f32_dpp v42, v42, v42 quad_perm:[2,3,0,1] row_mask:0xf bank_mask:0xf
    s_nop 0
    v_add_f32_dpp v41, v41, v41 quad_perm:[2,3,0,1] row_mask:0xf bank_mask:0xf
    v_add_f32_dpp v42, v42, v42 row_half_mirror row_mask:0xf bank_mask:0xf
    s_nop 0
    v_add_f32_dpp v41, v41, v41 row_half_mirror row_mask:0xf bank_mask:0xf
    v_add_f32_dpp v42, v42, v42 row_mirror row_mask:0xf bank_mask:0xf
    s_nop 0
    v_add_f32_dpp v41, v41, v41 row_mirror row_mask:0xf bank_mask:0xf
    v_mov_b32 v6, v42
    s_nop 1
    v_permlane16_swap_b32 v42, v6
    v_add_f32 v42, v42, v6
    v_mov_b32 v6, v41
    s_nop 1
    v_permlane16_swap_b32 v41, v6
    v_add_f32 v41, v41, v6
    v_sub_f32 v41, 0, v41
    v_mov_b32 v43, v41
    ds_write_b128 v11, v[40:43]
    ds_write_b32 v3, v23 offset:52
    v_add_u32 v9, 2048, v9
    v_add_u32 v11, 32, v11
    s_cmp_eq_u32 s86, 24
    s_waitcnt lgkmcnt(0)
    s_cbranch_scc0 L_hl
    v_add_u32 v9, 64512, v2
    s_mov_b32 s39, 4
    v_add_u32 v18, 78080, v2
    s_mov_b64 exec, 0xffff
    ds_read_b128 v[24:27], v18
    s_lshl_b32 s92, s41, 8
    s_add_u32 s92, s92, 8388608
    s_waitcnt lgkmcnt(0)
    v_mov_b32 v25, s48
    v_mov_b32 v27, s48
    buffer_store_dwordx4 v[24:27], v2, s[20:23], s92 offen sc0 sc1
    s_mov_b64 exec, -1
    s_waitcnt vmcnt(0)
    s_branch L_hl
L_wts:
    s_and_b32 s92, s34, 1
    s_lshl_b32 s92, s92, 15
    s_lshr_b32 s93, s34, 1
    s_lshl4_add_u32 s92, s93, s92
    s_add_u32 s92, s92, 8388608
    s_add_u32 s93, s92, 16384
    v_lshlrev_b32 v18, 8, v1
    s_cmp_eq_u32 s33, 0
    s_nop 0
    s_cbranch_scc0 L_wt1
    s_mul_i32 s94, s69, 8
    s_bfm_b64 exec, 8, s94
    buffer_load_dwordx4 v[24:27], v18, s[20:23], s92 offen
    buffer_load_dwordx4 v[28:31], v18, s[20:23], s93 offen
    s_mov_b64 exec, -1
    s_add_u32 s69, s69, 1
    s_add_u32 s40, s89, 6
    s_min_i32 s40, s40, 2904
    s_cmp_lt_u32 s69, 8
    s_cbranch_scc1 L_hl
    s_branch L_wt2
L_wt1:
    buffer_load_dwordx4 v[24:27], v18, s[20:23], s92 offen sc0 sc1
    buffer_load_dwordx4 v[28:31], v18, s[20:23], s93 offen sc0 sc1
L_wt2:
    s_add_u32 s33, s33, 1
    s_add_u32 s40, s89, 24
    s_min_i32 s40, s40, 2904
    v_and_b32 v18, 7, v1
    v_lshlrev_b32 v18, 6, v18
    v_lshrrev_b32 v19, 3, v1
    v_lshl_add_u32 v18, v19, 2, v18
    s_waitcnt vmcnt(0)
    v_xor_b32 v23, s48, v25
    v_bitop3_b32 v23, v23, v27, s48 bitop3:0xf6
    v_bitop3_b32 v23, v23, v29, s48 bitop3:0xf6
    v_bitop3_b32 v23, v23, v31, s48 bitop3:0xf6
    v_cmp_ne_u32 vcc, 0, v23
    s_cmp_gt_u32 s33, 200000
    s_nop 3
    s_cbranch_scc1 L_wt3
    s_cbranch_vccnz L_hl
L_wt3:
    s_mov_b32 s40, 0x7fffffff
    v_max_f32 v23, v24, v28
    s_nop 1
    v_max_f32_dpp v23, v23, v23 quad_perm:[1,0,3,2] row_mask:0xf bank_mask:0xf
    s_nop 1
    v_max_f32_dpp v23, v23, v23 quad_perm:[2,3,0,1] row_mask:0xf bank_mask:0xf
    s_nop 1
    v_max_f32_dpp v23, v23, v23 row_half_mirror row_mask:0xf bank_mask:0xf
    s_nop 1
    v_max_f32_dpp v23, v23, v23 row_mirror row_mask:0xf bank_mask:0xf
    v_mov_b32 v6, v23
    s_nop 1
    v_permlane32_swap_b32 v23, v6
    v_max_f32 v23, v23, v6
    v_mov_b32 v6, v23
    s_nop 1
    v_permlane16_swap_b32 v23, v6
    v_max_f32 v23, v23, v6
    v_sub_f32 v24, v24, v23
    v_sub_f32 v28, v28, v23
    v_exp_f32 v24, v24
    v_exp_f32 v28, v28
    v_mul_f32 v23, v24, v26
    v_fmac_f32 v23, v28, v30
    s_nop 1
    v_add_f32_dpp v23, v23, v23 quad_perm:[1,0,3,2] row_mask:0xf bank_mask:0xf
    s_nop 1
    v_add_f32_dpp v23, v23, v23 quad_perm:[2,3,0,1] row_mask:0xf bank_mask:0xf
    s_nop 1
    v_add_f32_dpp v23, v23, v23 row_half_mirror row_mask:0xf bank_mask:0xf
    s_nop 1
    v_add_f32_dpp v23, v23, v23 row_mirror row_mask:0xf bank_mask:0xf
    v_mov_b32 v6, v23
    s_nop 1
    v_permlane32_swap_b32 v23, v6
    v_add_f32 v23, v23, v6
    v_mov_b32 v6, v23
    s_nop 1
    v_permlane16_swap_b32 v23, v6
    v_add_f32 v23, v23, v6
    v_rcp_f32 v23, v23
    s_nop 0
    v_mul_f32 v24, v24, v23
    v_mul_f32 v28, v28, v23
    v_add_u32 v18, 78336, v18
    ds_write2_b32 v18, v24, v28 offset0:0 offset1:8
    v_mov_b32 v19, s48
    ds_write_b32 v3, v19 offset:24
    s_waitcnt lgkmcnt(0)
    s_branch L_hl
L_mrg:
    ds_read_b32 v104, v20 offset:4
    ds_read_b128 v[88:91], v10 offset:0
    ds_read_b128 v[92:95], v10 offset:768
    ds_read_b128 v[96:99], v10 offset:1536
    ds_read_b128 v[100:103], v10 offset:2304
    s_add_u32 s86, s86, 1
    s_sub_u32 s92, s86, 24
    v_mov_b32 v23, s92
    ds_write_b32 v3, v23 offset:60
    s_and_b32 s92, s92, 3
    s_cselect_b32 s92, 1, -3
    s_mul_i32 s92, s92, 3072
    v_add_u32 v10, s92, v10
    v_subrev_u32 v20, 16, v20
    s_cmp_eq_u32 s86, 39
    s_cselect_b32 s86, 14, s86
    s_waitcnt lgkmcnt(0)
    v_pk_add_f32 v[88:89], v[88:89], v[104:105] op_sel:[0,0] op_sel_hi:[1,0]
    v_pk_add_f32 v[90:91], v[90:91], v[104:105] op_sel:[0,0] op_sel_hi:[1,0]
    v_pk_add_f32 v[92:93], v[92:93], v[96:97]
    v_pk_add_f32 v[94:95], v[94:95], v[98:99]
    v_pk_add_f32 v[88:89], v[88:89], v[100:101]
    v_pk_add_f32 v[90:91], v[90:91], v[102:103]
    v_pk_add_f32 v[88:89], v[88:89], v[92:93]
    v_pk_add_f32 v[90:91], v[90:91], v[94:95]
    v_bfi_b32 v84, v5, s48, v88
    v_bfi_b32 v85, v5, s49, v89
    v_bfi_b32 v86, v5, s50, v90
    v_bfi_b32 v87, v5, s51, v91
    ds_write_b128 v9, v[84:87]
    v_subrev_u32 v9, 1024, v9
    s_waitcnt lgkmcnt(0)
    s_nop 0
    s_branch L_hl
L_late:
    s_getpc_b64 s[92:93]
L_pc2:
    v_lshlrev_b32 v19, 7, v1
    v_min_u32 v19, L_end-L_pc2, v19
    s_mov_b64 exec, 0xff
    global_load_dword v6, v19, s[92:93]
    s_mov_b64 exec, -1
    s_mul_i32 s32, s41, 768
    s_mov_b32 s39, s32
    s_add_u32 s32, s32, 196608
    s_mul_i32 s42, s80, 3112
    s_add_u32 s42, s42, s79
    s_cmp_eq_u32 s80, 0
    s_cselect_b32 s42, -2, s42
    s_min_u32 s42, s42, -2
    v_add_u32 v9, 49152, v2
    ds_read_b128 v[24:27], v9 offset:1024
    ds_read_b128 v[28:31], v9 offset:2048
    ds_read_b128 v[32:35], v9 offset:3072
    ds_read_b128 v[36:39], v9 offset:4096
    ds_read_b128 v[40:43], v9 offset:5120
    ds_read_b128 v[44:47], v9 offset:6144
    ds_read_b128 v[48:51], v9 offset:7168
    ds_read_b128 v[52:55], v9 offset:8192
    ds_read_b128 v[56:59], v9 offset:9216
    ds_read_b128 v[60:63], v9 offset:10240
    s_waitcnt lgkmcnt(0)
    ds_read_b128 v[64:67], v9 offset:11264
    ds_read_b128 v[68:71], v9 offset:12288
    ds_read_b128 v[72:75], v9 offset:13312
    ds_read_b128 v[76:79], v9 offset:14336
    ds_read_b128 v[80:83], v9 offset:15360
    ds_read_b32 v104, v20 offset:4
    s_mov_b32 exec_hi, 0xffff
L_w7:
    ds_read_b32 v19, v7
    ds_read_b128 v[88:91], v10 offset:0
    ds_read_b128 v[92:95], v10 offset:768
    ds_read_b128 v[96:99], v10 offset:1536
    ds_read_b128 v[100:103], v10 offset:2304
    s_memrealtime s[96:97]
    s_waitcnt lgkmcnt(0)
    v_readlane_b32 s92, v19, 39
    v_readlane_b32 s89, v19, 5
    s_cmp_eq_u32 s92, 4
    s_nop 3
    s_cbranch_scc1 L_g7
    s_sub_u32 s96, s96, s78
    s_lshl_b32 s96, s96, 8
    s_cmp_ge_i32 s89, 3084
    s_cbranch_scc1 L_ns7
    s_mul_i32 s92, s80, s89
    s_add_u32 s92, s92, s79
    s_sub_u32 s92, s96, s92
    s_max_i32 s92, s92, s98
    s_min_i32 s92, s92, s99
    s_mul_i32 s92, s92, s35
    s_add_u32 s92, s92, s36
    s_ashr_i32 s92, s92, 20
    s_max_i32 s92, s92, 15
    s_min_i32 s92, s92, 26
    v_mov_b32 v18, s92
    ds_write_b32 v3, v18 offset:16
    s_nop 0
L_ns7:
    s_cmp_lt_u32 s96, s42
    s_cbranch_scc1 L_w7
    buffer_store_dwordx4 v[24:27], v2, s[20:23], s32 offen sc0 sc1
    s_add_u32 s32, s32, 196608
    buffer_store_dwordx4 v[28:31], v2, s[20:23], s32 offen sc0 sc1
    s_add_u32 s32, s32, 196608
    buffer_store_dwordx4 v[32:35], v2, s[20:23], s32 offen sc0 sc1
    s_add_u32 s32, s32, 196608
    buffer_store_dwordx4 v[36:39], v2, s[20:23], s32 offen sc0 sc1
    s_add_u32 s32, s32, 196608
    buffer_store_dwordx4 v[40:43], v2, s[20:23], s32 offen sc0 sc1
    s_add_u32 s32, s32, 196608
    buffer_store_dwordx4 v[44:47], v2, s[20:23], s32 offen sc0 sc1
    s_add_u32 s32, s32, 196608
    buffer_store_dwordx4 v[48:51], v2, s[20:23], s32 offen sc0 sc1
    s_add_u32 s32, s32, 196608
    buffer_store_dwordx4 v[52:55], v2, s[20:23], s32 offen sc0 sc1
    s_add_u32 s32, s32, 196608
    buffer_store_dwordx4 v[56:59], v2, s[20:23], s32 offen sc0 sc1
    s_add_u32 s32, s32, 196608
    buffer_store_dwordx4 v[60:63], v2, s[20:23], s32 offen sc0 sc1
    s_add_u32 s32, s32, 196608
    buffer_store_dwordx4 v[64:67], v2, s[20:23], s32 offen sc0 sc1
    s_add_u32 s32, s32, 196608
    buffer_store_dwordx4 v[68:71], v2, s[20:23], s32 offen sc0 sc1
    s_add_u32 s32, s32, 196608
    buffer_store_dwordx4 v[72:75], v2, s[20:23], s32 offen sc0 sc1
    s_add_u32 s32, s32, 196608
    buffer_store_dwordx4 v[76:79], v2, s[20:23], s32 offen sc0 sc1
    s_add_u32 s32, s32, 196608
    buffer_store_dwordx4 v[80:83], v2, s[20:23], s32 offen sc0 sc1
    s_mov_b32 s42, -1
    s_nop 0
L_w8:
    ds_read_b32 v19, v7
    ds_read_b128 v[88:91], v10 offset:0
    ds_read_b128 v[92:95], v10 offset:768
    ds_read_b128 v[96:99], v10 offset:1536
    ds_read_b128 v[100:103], v10 offset:2304
    s_waitcnt lgkmcnt(4)
    v_readlane_b32 s92, v19, 39
    s_nop 0
    s_cmp_lg_u32 s92, 4
    s_waitcnt lgkmcnt(0)
    s_cbranch_scc1 L_w8
L_g7:
    v_pk_add_f32 v[88:89], v[88:89], v[104:105] op_sel:[0,0] op_sel_hi:[1,0]
    v_pk_add_f32 v[90:91], v[90:91], v[104:105] op_sel:[0,0] op_sel_hi:[1,0]
    v_pk_add_f32 v[92:93], v[92:93], v[96:97]
    v_pk_add_f32 v[94:95], v[94:95], v[98:99]
    v_pk_add_f32 v[88:89], v[88:89], v[100:101]
    v_pk_add_f32 v[90:91], v[90:91], v[102:103]
    v_pk_add_f32 v[88:89], v[88:89], v[92:93]
    v_pk_add_f32 v[90:91], v[90:91], v[94:95]
    v_bfi_b32 v84, v5, s48, v88
    v_bfi_b32 v85, v5, s49, v89
    v_bfi_b32 v86, v5, s50, v90
    v_bfi_b32 v87, v5, s51, v91
    buffer_store_dwordx4 v[84:87], v2, s[20:23], s39 offen sc0 sc1
    s_cmp_eq_u32 s42, -1
    s_nop 0
    s_cbranch_scc1 L_hend
    buffer_store_dwordx4 v[24:27], v2, s[20:23], s32 offen sc0 sc1
    s_add_u32 s32, s32, 196608
    buffer_store_dwordx4 v[28:31], v2, s[20:23], s32 offen sc0 sc1
    s_add_u32 s32, s32, 196608
    buffer_store_dwordx4 v[32:35], v2, s[20:23], s32 offen sc0 sc1
    s_add_u32 s32, s32, 196608
    buffer_store_dwordx4 v[36:39], v2, s[20:23], s32 offen sc0 sc1
    s_add_u32 s32, s32, 196608
    buffer_store_dwordx4 v[40:43], v2, s[20:23], s32 offen sc0 sc1
    s_add_u32 s32, s32, 196608
    buffer_store_dwordx4 v[44:47], v2, s[20:23], s32 offen sc0 sc1
    s_add_u32 s32, s32, 196608
    buffer_store_dwordx4 v[48:51], v2, s[20:23], s32 offen sc0 sc1
    s_add_u32 s32, s32, 196608
    buffer_store_dwordx4 v[52:55], v2, s[20:23], s32 offen sc0 sc1
    s_add_u32 s32, s32, 196608
    buffer_store_dwordx4 v[56:59], v2, s[20:23], s32 offen sc0 sc1
    s_add_u32 s32, s32, 196608
    buffer_store_dwordx4 v[60:63], v2, s[20:23], s32 offen sc0 sc1
    s_add_u32 s32, s32, 196608
    buffer_store_dwordx4 v[64:67], v2, s[20:23], s32 offen sc0 sc1
    s_add_u32 s32, s32, 196608
    buffer_store_dwordx4 v[68:71], v2, s[20:23], s32 offen sc0 sc1
    s_add_u32 s32, s32, 196608
    buffer_store_dwordx4 v[72:75], v2, s[20:23], s32 offen sc0 sc1
    s_add_u32 s32, s32, 196608
    buffer_store_dwordx4 v[76:79], v2, s[20:23], s32 offen sc0 sc1
    s_add_u32 s32, s32, 196608
    buffer_store_dwordx4 v[80:83], v2, s[20:23], s32 offen sc0 sc1
    s_mov_b32 s42, -1
    s_nop 0
L_hend:
    v_mov_b32 v18, 2
    s_waitcnt vmcnt(14)
    ds_write_b32 v3, v18 offset:32
    v_mov_b32 v18, 3
    s_waitcnt vmcnt(13)
    ds_write_b32 v3, v18 offset:32
    v_mov_b32 v18, 4
    s_waitcnt vmcnt(12)
    ds_write_b32 v3, v18 offset:32
    v_mov_b32 v18, 5
    s_waitcnt vmcnt(11)
    ds_write_b32 v3, v18 offset:32
    v_mov_b32 v18, 6
    s_waitcnt vmcnt(10)
    ds_write_b32 v3, v18 offset:32
    v_mov_b32 v18, 7
    s_waitcnt vmcnt(9)
    ds_write_b32 v3, v18 offset:32
    v_mov_b32 v18, 8
    s_waitcnt vmcnt(8)
    ds_write_b32 v3, v18 offset:32
    v_mov_b32 v18, 9
    s_waitcnt vmcnt(7)
    ds_write_b32 v3, v18 offset:32
    v_mov_b32 v18, 10
    s_waitcnt vmcnt(6)
    ds_write_b32 v3, v18 offset:32
    v_mov_b32 v18, 11
    s_waitcnt vmcnt(5)
    ds_write_b32 v3, v18 offset:32
    v_mov_b32 v18, 12
    s_waitcnt vmcnt(4)
    ds_write_b32 v3, v18 offset:32
    v_mov_b32 v18, 13
    s_waitcnt vmcnt(3)
    ds_write_b32 v3, v18 offset:32
    v_mov_b32 v18, 14
    s_waitcnt vmcnt(2)
    ds_write_b32 v3, v18 offset:32
    v_mov_b32 v18, 15
    s_waitcnt vmcnt(1)
    ds_write_b32 v3, v18 offset:32
    v_mov_b32 v18, 16
    s_waitcnt vmcnt(0)
    ds_write_b32 v3, v18 offset:32
    s_waitcnt lgkmcnt(0)
L_end:
    s_endpgm
.section .rodata,"a"
.p2align 6
.amdhsa_kernel standalone__kv_cache_quant_pre_rope_vs_post_rope__decode_kernel
  .amdhsa_next_free_vgpr 168
  .amdhsa_next_free_sgpr 102
  .amdhsa_accum_offset 168
  .amdhsa_group_segment_fixed_size 0
  .amdhsa_kernarg_size 112
  .amdhsa_user_sgpr_count 2
  .amdhsa_user_sgpr_kernarg_segment_ptr 1
  .amdhsa_system_sgpr_workgroup_id_x 1
.end_amdhsa_kernel
```

```asm
; @launch grid=(256,1,1) block=(384,1,1) lds=79872
.amdgcn_target "amdgcn-amd-amdhsa--gfx950"
.text
.globl standalone__kv_cache_quant_pre_rope_vs_post_rope__decode_kernel
.p2align 8
.type standalone__kv_cache_quant_pre_rope_vs_post_rope__decode_kernel,@function
standalone__kv_cache_quant_pre_rope_vs_post_rope__decode_kernel:
    s_load_dwordx16 s[48:63], s[0:1], 0
    s_load_dwordx8 s[64:71], s[0:1], 64
    s_load_dwordx4 s[72:75], s[0:1], 96
    s_cmp_ge_u32 s2, 256
    s_cbranch_scc1 L_end
    v_lshrrev_b32 v18, 6, v0
    v_and_b32 v1, 63, v0
    v_readfirstlane_b32 s76, v18
    v_cmp_eq_u32 vcc, 4, v1
    v_lshlrev_b32 v7, 2, v1
    v_add_u32 v7, 77824, v7
    v_cndmask_b32 v19, 0, 20, vcc
    ds_write_b32 v7, v19
    s_and_b32 s92, s2, 7
    s_lshl_b32 s77, s92, 6
    s_and_b32 s92, s2, 0x60
    s_lshl4_add_u32 s77, s92, s77
    s_and_b32 s92, s2, 0x10
    s_lshl1_add_u32 s77, s92, s77
    s_lshr_b32 s92, s2, 7
    s_lshl4_add_u32 s77, s92, s77
    s_bfe_u32 s3, s2, 0x10003
    s_cselect_b32 s92, 0, 8192
    s_add_u32 s77, s77, s92
    s_cmp_lg_u32 s76, 0
    s_cbranch_scc1 L_other
    s_setprio 3
    v_lshlrev_b32 v2, 4, v1
    v_add_u32 v8, 784896, v2
    v_cmp_gt_u32 vcc, 32, v1
    s_mul_i32 s78, s77, 384
    s_mov_b32 s6, 6291456
    s_mov_b32 s7, 0x20000
    v_cndmask_b32 v4, v8, v2, vcc
    s_mov_b32 m0, 0
    s_mov_b32 s81, 0
    v_mov_b32 v6, 77844
    v_mov_b32 v5, -20
    s_waitcnt lgkmcnt(0)
    s_mov_b64 s[4:5], s[66:67]
L_i0:
    s_waitcnt vmcnt(19)
    buffer_load_dwordx4 v2, s[4:7], s78 offen offset:0  lds
    v_add_u32 v5, 3, v5
    s_add_u32 s81, s81, 1
    s_waitcnt vmcnt(19)
    buffer_load_dwordx4 v4, s[4:7], s78 offen offset:1024  lds
    s_and_b32 s92, s81, 3
    s_cselect_b32 s92, 0, -6144
    s_cmp_eq_u32 s81, 8
    s_cselect_b32 s93, 1572864, 0
    s_add_u32 s92, s92, s93
    s_bitcmp1_b32 s81, 2
    s_waitcnt vmcnt(19)
    buffer_load_dwordx4 v8, s[4:7], s78 offen offset:2048  lds
    ds_write_b32 v6, v5
    s_cselect_b64 s[4:5], s[68:69], s[66:67]
    s_addk_i32 m0, 3072
    s_addk_i32 s92, 1536
    s_add_u32 s78, s78, s92
    s_cmp_lg_u32 s81, 6
    s_cbranch_scc1 L_i1
    s_barrier
L_i1:
    s_cmp_lt_u32 s81, 16
    s_cbranch_scc1 L_i0
    ds_read_b32 v3, v7
    s_mul_i32 s79, s3, 12582912
    s_mov_b64 s[4:5], s[50:51]
    s_mov_b32 s6, 402653184
    s_mov_b32 s7, 0x20000
    s_mov_b32 m0, 0
    s_movk_i32 s85, 4096
    s_mov_b32 s81, 0
    s_mul_i32 s78, s77, 768
    s_add_u32 s78, s78, s79
    s_mov_b32 s82, 1
    s_waitcnt lgkmcnt(0)
    v_readlane_b32 s84, v3, 0
    s_and_b32 s87, s2, 127
    s_add_u32 s87, s87, 64
    s_nop 2
L_D20:
    s_mul_i32 s92, s81, 12
    s_add_u32 s92, s92, 28
    v_mov_b32 v5, s92
L_B20:
L_B20_0:
    s_cmp_lt_i32 s84, s82
    s_cbranch_scc1 L_B20_0w
    s_waitcnt vmcnt(19)
    buffer_load_dwordx4 v2, s[4:7], s78 offen offset:0 nt lds
    v_add_u32 v5, 3, v5
    s_add_u32 s81, s81, 1
    s_bfe_i32 s93, s81, 0x10007
    s_waitcnt vmcnt(19)
    buffer_load_dwordx4 v2, s[4:7], s78 offen offset:1024 nt lds
    v_readlane_b32 s84, v3, 1
    ds_read_b32 v3, v7
    s_xor_b32 s93, s93, s81
    s_waitcnt vmcnt(19)
    buffer_load_dwordx4 v2, s[4:7], s78 offen offset:2048 nt lds
    ds_write_b32 v6, v5
    s_and_b32 s92, s93, 7
    s_lshl_b32 s92, s92, 11
L_B20_1:
    s_cmp_lt_i32 s84, s82
    s_cbranch_scc1 L_B20_1w
    s_waitcnt vmcnt(19)
    buffer_load_dwordx4 v2, s[4:7], s78 offen offset:3072 nt lds
    v_add_u32 v5, 3, v5
    s_add_u32 m0, m0, s85
    s_add_u32 s78, s78, s85
    s_waitcnt vmcnt(19)
    buffer_load_dwordx4 v2, s[4:7], s78 offen offset:0 nt lds
    v_readlane_b32 s84, v3, 2
    ds_read_b32 v3, v7
    s_add_u32 s92, s92, s77
    s_waitcnt vmcnt(19)
    buffer_load_dwordx4 v2, s[4:7], s78 offen offset:1024 nt lds
    ds_write_b32 v6, v5
    s_and_b32 s92, s92, 16383
    s_mul_i32 s80, s92, 768
L_B20_2:
    s_cmp_lt_i32 s84, s82
    s_cbranch_scc1 L_B20_2w
    s_waitcnt vmcnt(19)
    buffer_load_dwordx4 v2, s[4:7], s78 offen offset:2048 nt lds
    v_add_u32 v5, 3, v5
    s_bfe_u32 s92, s93, 0x40003
    s_mul_i32 s92, s92, 25165824
    s_waitcnt vmcnt(19)
    buffer_load_dwordx4 v2, s[4:7], s78 offen offset:3072 nt lds
    v_readlane_b32 s84, v3, 3
    ds_read_b32 v3, v7
    s_add_u32 m0, m0, s85
    s_add_u32 s78, s78, s85
    s_waitcnt vmcnt(19)
    buffer_load_dwordx4 v2, s[4:7], s78 offen offset:0 nt lds
    ds_write_b32 v6, v5
    s_add_u32 s80, s80, s79
    s_add_u32 s80, s80, s92
L_B20_3:
    s_cmp_lt_i32 s84, s82
    s_cbranch_scc1 L_B20_3w
    s_waitcnt vmcnt(19)
    buffer_load_dwordx4 v2, s[4:7], s78 offen offset:1024 nt lds
    v_add_u32 v5, 3, v5
    v_readlane_b32 s83, v3, 4
    s_and_b32 s86, s81, 3
    s_mul_i32 s86, s86, 12288
    s_waitcnt vmcnt(19)
    buffer_load_dwordx4 v2, s[4:7], s78 offen offset:2048 nt lds
    v_readlane_b32 s84, v3, 0
    ds_read_b32 v3, v7
    s_add_u32 s82, s82, 1
    s_cmp_eq_u32 s81, s87
    s_cselect_b32 s83, -1, s83
    s_cmp_ge_u32 s81, 128
    s_waitcnt vmcnt(19)
    buffer_load_dwordx4 v2, s[4:7], s78 offen offset:3072 nt lds
    ds_write_b32 v6, v5
    s_cselect_b64 s[4:5], s[56:57], s[50:51]
    s_mov_b32 m0, s86
    s_mov_b32 s78, s80
    s_cmp_eq_u32 s83, 20
    s_cbranch_scc1 L_B20
    s_cmp_eq_u32 s83, -1
    s_cbranch_scc1 L_D32
L_disp:
    s_cmp_eq_u32 s83, 20
    s_cbranch_scc1 L_D20
    s_cmp_eq_u32 s83, 21
    s_cbranch_scc1 L_D21
    s_cmp_eq_u32 s83, 19
    s_cbranch_scc1 L_D19
    s_cmp_eq_u32 s83, 22
    s_cbranch_scc1 L_D22
    s_cmp_eq_u32 s83, 18
    s_cbranch_scc1 L_D18
    s_cmp_eq_u32 s83, 23
    s_cbranch_scc1 L_D23
    s_cmp_eq_u32 s83, 17
    s_cbranch_scc1 L_D17
    s_cmp_eq_u32 s83, 24
    s_cbranch_scc1 L_D24
    s_cmp_eq_u32 s83, 16
    s_cbranch_scc1 L_D16
    s_cmp_eq_u32 s83, 25
    s_cbranch_scc1 L_D25
    s_cmp_ge_i32 s83, 26
    s_cbranch_scc1 L_D26
    s_branch L_D15
L_D19:
    s_mul_i32 s92, s81, 12
    s_add_u32 s92, s92, 29
    v_mov_b32 v5, s92
L_B19:
L_B19_0:
    s_cmp_lt_i32 s84, s82
    s_cbranch_scc1 L_B19_0w
    s_waitcnt vmcnt(18)
    buffer_load_dwordx4 v2, s[4:7], s78 offen offset:0 nt lds
    v_add_u32 v5, 3, v5
    s_add_u32 s81, s81, 1
    s_bfe_i32 s93, s81, 0x10007
    s_waitcnt vmcnt(18)
    buffer_load_dwordx4 v2, s[4:7], s78 offen offset:1024 nt lds
    v_readlane_b32 s84, v3, 1
    ds_read_b32 v3, v7
    s_xor_b32 s93, s93, s81
    s_waitcnt vmcnt(18)
    buffer_load_dwordx4 v2, s[4:7], s78 offen offset:2048 nt lds
    ds_write_b32 v6, v5
    s_and_b32 s92, s93, 7
    s_lshl_b32 s92, s92, 11
L_B19_1:
    s_cmp_lt_i32 s84, s82
    s_cbranch_scc1 L_B19_1w
    s_waitcnt vmcnt(18)
    buffer_load_dwordx4 v2, s[4:7], s78 offen offset:3072 nt lds
    v_add_u32 v5, 3, v5
    s_add_u32 m0, m0, s85
    s_add_u32 s78, s78, s85
    s_waitcnt vmcnt(18)
    buffer_load_dwordx4 v2, s[4:7], s78 offen offset:0 nt lds
    v_readlane_b32 s84, v3, 2
    ds_read_b32 v3, v7
    s_add_u32 s92, s92, s77
    s_waitcnt vmcnt(18)
    buffer_load_dwordx4 v2, s[4:7], s78 offen offset:1024 nt lds
    ds_write_b32 v6, v5
    s_and_b32 s92, s92, 16383
    s_mul_i32 s80, s92, 768
L_B19_2:
    s_cmp_lt_i32 s84, s82
    s_cbranch_scc1 L_B19_2w
    s_waitcnt vmcnt(18)
    buffer_load_dwordx4 v2, s[4:7], s78 offen offset:2048 nt lds
    v_add_u32 v5, 3, v5
    s_bfe_u32 s92, s93, 0x40003
    s_mul_i32 s92, s92, 25165824
    s_waitcnt vmcnt(18)
    buffer_load_dwordx4 v2, s[4:7], s78 offen offset:3072 nt lds
    v_readlane_b32 s84, v3, 3
    ds_read_b32 v3, v7
    s_add_u32 m0, m0, s85
    s_add_u32 s78, s78, s85
    s_waitcnt vmcnt(18)
    buffer_load_dwordx4 v2, s[4:7], s78 offen offset:0 nt lds
    ds_write_b32 v6, v5
    s_add_u32 s80, s80, s79
    s_add_u32 s80, s80, s92
L_B19_3:
    s_cmp_lt_i32 s84, s82
    s_cbranch_scc1 L_B19_3w
    s_waitcnt vmcnt(18)
    buffer_load_dwordx4 v2, s[4:7], s78 offen offset:1024 nt lds
    v_add_u32 v5, 3, v5
    v_readlane_b32 s83, v3, 4
    s_and_b32 s86, s81, 3
    s_mul_i32 s86, s86, 12288
    s_waitcnt vmcnt(18)
    buffer_load_dwordx4 v2, s[4:7], s78 offen offset:2048 nt lds
    v_readlane_b32 s84, v3, 0
    ds_read_b32 v3, v7
    s_add_u32 s82, s82, 1
    s_cmp_eq_u32 s81, s87
    s_cselect_b32 s83, -1, s83
    s_cmp_ge_u32 s81, 128
    s_waitcnt vmcnt(18)
    buffer_load_dwordx4 v2, s[4:7], s78 offen offset:3072 nt lds
    ds_write_b32 v6, v5
    s_cselect_b64 s[4:5], s[56:57], s[50:51]
    s_mov_b32 m0, s86
    s_mov_b32 s78, s80
    s_cmp_eq_u32 s83, 19
    s_cbranch_scc1 L_B19
    s_cmp_eq_u32 s83, -1
    s_cbranch_scc1 L_D32
    s_cmp_eq_u32 s83, 20
    s_cbranch_scc1 L_D20
    s_cmp_eq_u32 s83, 18
    s_cbranch_scc1 L_D18
    s_branch L_disp
L_D21:
    s_mul_i32 s92, s81, 12
    s_add_u32 s92, s92, 27
    v_mov_b32 v5, s92
L_B21:
L_B21_0:
    s_cmp_lt_i32 s84, s82
    s_cbranch_scc1 L_B21_0w
    s_waitcnt vmcnt(20)
    buffer_load_dwordx4 v2, s[4:7], s78 offen offset:0 nt lds
    v_add_u32 v5, 3, v5
    s_add_u32 s81, s81, 1
    s_bfe_i32 s93, s81, 0x10007
    s_waitcnt vmcnt(20)
    buffer_load_dwordx4 v2, s[4:7], s78 offen offset:1024 nt lds
    v_readlane_b32 s84, v3, 1
    ds_read_b32 v3, v7
    s_xor_b32 s93, s93, s81
    s_waitcnt vmcnt(20)
    buffer_load_dwordx4 v2, s[4:7], s78 offen offset:2048 nt lds
    ds_write_b32 v6, v5
    s_and_b32 s92, s93, 7
    s_lshl_b32 s92, s92, 11
L_B21_1:
    s_cmp_lt_i32 s84, s82
    s_cbranch_scc1 L_B21_1w
    s_waitcnt vmcnt(20)
    buffer_load_dwordx4 v2, s[4:7], s78 offen offset:3072 nt lds
    v_add_u32 v5, 3, v5
    s_add_u32 m0, m0, s85
    s_add_u32 s78, s78, s85
    s_waitcnt vmcnt(20)
    buffer_load_dwordx4 v2, s[4:7], s78 offen offset:0 nt lds
    v_readlane_b32 s84, v3, 2
    ds_read_b32 v3, v7
    s_add_u32 s92, s92, s77
    s_waitcnt vmcnt(20)
    buffer_load_dwordx4 v2, s[4:7], s78 offen offset:1024 nt lds
    ds_write_b32 v6, v5
    s_and_b32 s92, s92, 16383
    s_mul_i32 s80, s92, 768
L_B21_2:
    s_cmp_lt_i32 s84, s82
    s_cbranch_scc1 L_B21_2w
    s_waitcnt vmcnt(20)
    buffer_load_dwordx4 v2, s[4:7], s78 offen offset:2048 nt lds
    v_add_u32 v5, 3, v5
    s_bfe_u32 s92, s93, 0x40003
    s_mul_i32 s92, s92, 25165824
    s_waitcnt vmcnt(20)
    buffer_load_dwordx4 v2, s[4:7], s78 offen offset:3072 nt lds
    v_readlane_b32 s84, v3, 3
    ds_read_b32 v3, v7
    s_add_u32 m0, m0, s85
    s_add_u32 s78, s78, s85
    s_waitcnt vmcnt(20)
    buffer_load_dwordx4 v2, s[4:7], s78 offen offset:0 nt lds
    ds_write_b32 v6, v5
    s_add_u32 s80, s80, s79
    s_add_u32 s80, s80, s92
L_B21_3:
    s_cmp_lt_i32 s84, s82
    s_cbranch_scc1 L_B21_3w
    s_waitcnt vmcnt(20)
    buffer_load_dwordx4 v2, s[4:7], s78 offen offset:1024 nt lds
    v_add_u32 v5, 3, v5
    v_readlane_b32 s83, v3, 4
    s_and_b32 s86, s81, 3
    s_mul_i32 s86, s86, 12288
    s_waitcnt vmcnt(20)
    buffer_load_dwordx4 v2, s[4:7], s78 offen offset:2048 nt lds
    v_readlane_b32 s84, v3, 0
    ds_read_b32 v3, v7
    s_add_u32 s82, s82, 1
    s_cmp_eq_u32 s81, s87
    s_cselect_b32 s83, -1, s83
    s_cmp_ge_u32 s81, 128
    s_waitcnt vmcnt(20)
    buffer_load_dwordx4 v2, s[4:7], s78 offen offset:3072 nt lds
    ds_write_b32 v6, v5
    s_cselect_b64 s[4:5], s[56:57], s[50:51]
    s_mov_b32 m0, s86
    s_mov_b32 s78, s80
    s_cmp_eq_u32 s83, 21
    s_cbranch_scc1 L_B21
    s_cmp_eq_u32 s83, -1
    s_cbranch_scc1 L_D32
    s_cmp_eq_u32 s83, 20
    s_cbranch_scc1 L_D20
    s_cmp_eq_u32 s83, 22
    s_cbranch_scc1 L_D22
    s_branch L_disp
L_D18:
    s_mul_i32 s92, s81, 12
    s_add_u32 s92, s92, 30
    v_mov_b32 v5, s92
L_B18:
L_B18_0:
    s_cmp_lt_i32 s84, s82
    s_cbranch_scc1 L_B18_0w
    s_waitcnt vmcnt(17)
    buffer_load_dwordx4 v2, s[4:7], s78 offen offset:0 nt lds
    v_add_u32 v5, 3, v5
    s_add_u32 s81, s81, 1
    s_bfe_i32 s93, s81, 0x10007
    s_waitcnt vmcnt(17)
    buffer_load_dwordx4 v2, s[4:7], s78 offen offset:1024 nt lds
    v_readlane_b32 s84, v3, 1
    ds_read_b32 v3, v7
    s_xor_b32 s93, s93, s81
    s_waitcnt vmcnt(17)
    buffer_load_dwordx4 v2, s[4:7], s78 offen offset:2048 nt lds
    ds_write_b32 v6, v5
    s_and_b32 s92, s93, 7
    s_lshl_b32 s92, s92, 11
L_B18_1:
    s_cmp_lt_i32 s84, s82
    s_cbranch_scc1 L_B18_1w
    s_waitcnt vmcnt(17)
    buffer_load_dwordx4 v2, s[4:7], s78 offen offset:3072 nt lds
    v_add_u32 v5, 3, v5
    s_add_u32 m0, m0, s85
    s_add_u32 s78, s78, s85
    s_waitcnt vmcnt(17)
    buffer_load_dwordx4 v2, s[4:7], s78 offen offset:0 nt lds
    v_readlane_b32 s84, v3, 2
    ds_read_b32 v3, v7
    s_add_u32 s92, s92, s77
    s_waitcnt vmcnt(17)
    buffer_load_dwordx4 v2, s[4:7], s78 offen offset:1024 nt lds
    ds_write_b32 v6, v5
    s_and_b32 s92, s92, 16383
    s_mul_i32 s80, s92, 768
L_B18_2:
    s_cmp_lt_i32 s84, s82
    s_cbranch_scc1 L_B18_2w
    s_waitcnt vmcnt(17)
    buffer_load_dwordx4 v2, s[4:7], s78 offen offset:2048 nt lds
    v_add_u32 v5, 3, v5
    s_bfe_u32 s92, s93, 0x40003
    s_mul_i32 s92, s92, 25165824
    s_waitcnt vmcnt(17)
    buffer_load_dwordx4 v2, s[4:7], s78 offen offset:3072 nt lds
    v_readlane_b32 s84, v3, 3
    ds_read_b32 v3, v7
    s_add_u32 m0, m0, s85
    s_add_u32 s78, s78, s85
    s_waitcnt vmcnt(17)
    buffer_load_dwordx4 v2, s[4:7], s78 offen offset:0 nt lds
    ds_write_b32 v6, v5
    s_add_u32 s80, s80, s79
    s_add_u32 s80, s80, s92
L_B18_3:
    s_cmp_lt_i32 s84, s82
    s_cbranch_scc1 L_B18_3w
    s_waitcnt vmcnt(17)
    buffer_load_dwordx4 v2, s[4:7], s78 offen offset:1024 nt lds
    v_add_u32 v5, 3, v5
    v_readlane_b32 s83, v3, 4
    s_and_b32 s86, s81, 3
    s_mul_i32 s86, s86, 12288
    s_waitcnt vmcnt(17)
    buffer_load_dwordx4 v2, s[4:7], s78 offen offset:2048 nt lds
    v_readlane_b32 s84, v3, 0
    ds_read_b32 v3, v7
    s_add_u32 s82, s82, 1
    s_cmp_eq_u32 s81, s87
    s_cselect_b32 s83, -1, s83
    s_cmp_ge_u32 s81, 128
    s_waitcnt vmcnt(17)
    buffer_load_dwordx4 v2, s[4:7], s78 offen offset:3072 nt lds
    ds_write_b32 v6, v5
    s_cselect_b64 s[4:5], s[56:57], s[50:51]
    s_mov_b32 m0, s86
    s_mov_b32 s78, s80
    s_cmp_eq_u32 s83, 18
    s_cbranch_scc1 L_B18
    s_cmp_eq_u32 s83, -1
    s_cbranch_scc1 L_D32
    s_cmp_eq_u32 s83, 19
    s_cbranch_scc1 L_D19
    s_cmp_eq_u32 s83, 17
    s_cbranch_scc1 L_D17
    s_branch L_disp
L_D22:
    s_mul_i32 s92, s81, 12
    s_add_u32 s92, s92, 26
    v_mov_b32 v5, s92
L_B22:
L_B22_0:
    s_cmp_lt_i32 s84, s82
    s_cbranch_scc1 L_B22_0w
    s_waitcnt vmcnt(21)
    buffer_load_dwordx4 v2, s[4:7], s78 offen offset:0 nt lds
    v_add_u32 v5, 3, v5
    s_add_u32 s81, s81, 1
    s_bfe_i32 s93, s81, 0x10007
    s_waitcnt vmcnt(21)
    buffer_load_dwordx4 v2, s[4:7], s78 offen offset:1024 nt lds
    v_readlane_b32 s84, v3, 1
    ds_read_b32 v3, v7
    s_xor_b32 s93, s93, s81
    s_waitcnt vmcnt(21)
    buffer_load_dwordx4 v2, s[4:7], s78 offen offset:2048 nt lds
    ds_write_b32 v6, v5
    s_and_b32 s92, s93, 7
    s_lshl_b32 s92, s92, 11
L_B22_1:
    s_cmp_lt_i32 s84, s82
    s_cbranch_scc1 L_B22_1w
    s_waitcnt vmcnt(21)
    buffer_load_dwordx4 v2, s[4:7], s78 offen offset:3072 nt lds
    v_add_u32 v5, 3, v5
    s_add_u32 m0, m0, s85
    s_add_u32 s78, s78, s85
    s_waitcnt vmcnt(21)
    buffer_load_dwordx4 v2, s[4:7], s78 offen offset:0 nt lds
    v_readlane_b32 s84, v3, 2
    ds_read_b32 v3, v7
    s_add_u32 s92, s92, s77
    s_waitcnt vmcnt(21)
    buffer_load_dwordx4 v2, s[4:7], s78 offen offset:1024 nt lds
    ds_write_b32 v6, v5
    s_and_b32 s92, s92, 16383
    s_mul_i32 s80, s92, 768
L_B22_2:
    s_cmp_lt_i32 s84, s82
    s_cbranch_scc1 L_B22_2w
    s_waitcnt vmcnt(21)
    buffer_load_dwordx4 v2, s[4:7], s78 offen offset:2048 nt lds
    v_add_u32 v5, 3, v5
    s_bfe_u32 s92, s93, 0x40003
    s_mul_i32 s92, s92, 25165824
    s_waitcnt vmcnt(21)
    buffer_load_dwordx4 v2, s[4:7], s78 offen offset:3072 nt lds
    v_readlane_b32 s84, v3, 3
    ds_read_b32 v3, v7
    s_add_u32 m0, m0, s85
    s_add_u32 s78, s78, s85
    s_waitcnt vmcnt(21)
    buffer_load_dwordx4 v2, s[4:7], s78 offen offset:0 nt lds
    ds_write_b32 v6, v5
    s_add_u32 s80, s80, s79
    s_add_u32 s80, s80, s92
L_B22_3:
    s_cmp_lt_i32 s84, s82
    s_cbranch_scc1 L_B22_3w
    s_waitcnt vmcnt(21)
    buffer_load_dwordx4 v2, s[4:7], s78 offen offset:1024 nt lds
    v_add_u32 v5, 3, v5
    v_readlane_b32 s83, v3, 4
    s_and_b32 s86, s81, 3
    s_mul_i32 s86, s86, 12288
    s_waitcnt vmcnt(21)
    buffer_load_dwordx4 v2, s[4:7], s78 offen offset:2048 nt lds
    v_readlane_b32 s84, v3, 0
    ds_read_b32 v3, v7
    s_add_u32 s82, s82, 1
    s_cmp_eq_u32 s81, s87
    s_cselect_b32 s83, -1, s83
    s_cmp_ge_u32 s81, 128
    s_waitcnt vmcnt(21)
    buffer_load_dwordx4 v2, s[4:7], s78 offen offset:3072 nt lds
    ds_write_b32 v6, v5
    s_cselect_b64 s[4:5], s[56:57], s[50:51]
    s_mov_b32 m0, s86
    s_mov_b32 s78, s80
    s_cmp_eq_u32 s83, 22
    s_cbranch_scc1 L_B22
    s_cmp_eq_u32 s83, -1
    s_cbranch_scc1 L_D32
    s_cmp_eq_u32 s83, 21
    s_cbranch_scc1 L_D21
    s_cmp_eq_u32 s83, 23
    s_cbranch_scc1 L_D23
    s_branch L_disp
L_D17:
    s_mul_i32 s92, s81, 12
    s_add_u32 s92, s92, 31
    v_mov_b32 v5, s92
L_B17:
L_B17_0:
    s_cmp_lt_i32 s84, s82
    s_cbranch_scc1 L_B17_0w
    s_waitcnt vmcnt(16)
    buffer_load_dwordx4 v2, s[4:7], s78 offen offset:0 nt lds
    v_add_u32 v5, 3, v5
    s_add_u32 s81, s81, 1
    s_bfe_i32 s93, s81, 0x10007
    s_waitcnt vmcnt(16)
    buffer_load_dwordx4 v2, s[4:7], s78 offen offset:1024 nt lds
    v_readlane_b32 s84, v3, 1
    ds_read_b32 v3, v7
    s_xor_b32 s93, s93, s81
    s_waitcnt vmcnt(16)
    buffer_load_dwordx4 v2, s[4:7], s78 offen offset:2048 nt lds
    ds_write_b32 v6, v5
    s_and_b32 s92, s93, 7
    s_lshl_b32 s92, s92, 11
L_B17_1:
    s_cmp_lt_i32 s84, s82
    s_cbranch_scc1 L_B17_1w
    s_waitcnt vmcnt(16)
    buffer_load_dwordx4 v2, s[4:7], s78 offen offset:3072 nt lds
    v_add_u32 v5, 3, v5
    s_add_u32 m0, m0, s85
    s_add_u32 s78, s78, s85
    s_waitcnt vmcnt(16)
    buffer_load_dwordx4 v2, s[4:7], s78 offen offset:0 nt lds
    v_readlane_b32 s84, v3, 2
    ds_read_b32 v3, v7
    s_add_u32 s92, s92, s77
    s_waitcnt vmcnt(16)
    buffer_load_dwordx4 v2, s[4:7], s78 offen offset:1024 nt lds
    ds_write_b32 v6, v5
    s_and_b32 s92, s92, 16383
    s_mul_i32 s80, s92, 768
L_B17_2:
    s_cmp_lt_i32 s84, s82
    s_cbranch_scc1 L_B17_2w
    s_waitcnt vmcnt(16)
    buffer_load_dwordx4 v2, s[4:7], s78 offen offset:2048 nt lds
    v_add_u32 v5, 3, v5
    s_bfe_u32 s92, s93, 0x40003
    s_mul_i32 s92, s92, 25165824
    s_waitcnt vmcnt(16)
    buffer_load_dwordx4 v2, s[4:7], s78 offen offset:3072 nt lds
    v_readlane_b32 s84, v3, 3
    ds_read_b32 v3, v7
    s_add_u32 m0, m0, s85
    s_add_u32 s78, s78, s85
    s_waitcnt vmcnt(16)
    buffer_load_dwordx4 v2, s[4:7], s78 offen offset:0 nt lds
    ds_write_b32 v6, v5
    s_add_u32 s80, s80, s79
    s_add_u32 s80, s80, s92
L_B17_3:
    s_cmp_lt_i32 s84, s82
    s_cbranch_scc1 L_B17_3w
    s_waitcnt vmcnt(16)
    buffer_load_dwordx4 v2, s[4:7], s78 offen offset:1024 nt lds
    v_add_u32 v5, 3, v5
    v_readlane_b32 s83, v3, 4
    s_and_b32 s86, s81, 3
    s_mul_i32 s86, s86, 12288
    s_waitcnt vmcnt(16)
    buffer_load_dwordx4 v2, s[4:7], s78 offen offset:2048 nt lds
    v_readlane_b32 s84, v3, 0
    ds_read_b32 v3, v7
    s_add_u32 s82, s82, 1
    s_cmp_eq_u32 s81, s87
    s_cselect_b32 s83, -1, s83
    s_cmp_ge_u32 s81, 128
    s_waitcnt vmcnt(16)
    buffer_load_dwordx4 v2, s[4:7], s78 offen offset:3072 nt lds
    ds_write_b32 v6, v5
    s_cselect_b64 s[4:5], s[56:57], s[50:51]
    s_mov_b32 m0, s86
    s_mov_b32 s78, s80
    s_cmp_eq_u32 s83, 17
    s_cbranch_scc1 L_B17
    s_cmp_eq_u32 s83, -1
    s_cbranch_scc1 L_D32
    s_cmp_eq_u32 s83, 18
    s_cbranch_scc1 L_D18
    s_cmp_eq_u32 s83, 16
    s_cbranch_scc1 L_D16
    s_branch L_disp
L_D23:
    s_mul_i32 s92, s81, 12
    s_add_u32 s92, s92, 25
    v_mov_b32 v5, s92
L_B23:
L_B23_0:
    s_cmp_lt_i32 s84, s82
    s_cbranch_scc1 L_B23_0w
    s_waitcnt vmcnt(22)
    buffer_load_dwordx4 v2, s[4:7], s78 offen offset:0 nt lds
    v_add_u32 v5, 3, v5
    s_add_u32 s81, s81, 1
    s_bfe_i32 s93, s81, 0x10007
    s_waitcnt vmcnt(22)
    buffer_load_dwordx4 v2, s[4:7], s78 offen offset:1024 nt lds
    v_readlane_b32 s84, v3, 1
    ds_read_b32 v3, v7
    s_xor_b32 s93, s93, s81
    s_waitcnt vmcnt(22)
    buffer_load_dwordx4 v2, s[4:7], s78 offen offset:2048 nt lds
    ds_write_b32 v6, v5
    s_and_b32 s92, s93, 7
    s_lshl_b32 s92, s92, 11
L_B23_1:
    s_cmp_lt_i32 s84, s82
    s_cbranch_scc1 L_B23_1w
    s_waitcnt vmcnt(22)
    buffer_load_dwordx4 v2, s[4:7], s78 offen offset:3072 nt lds
    v_add_u32 v5, 3, v5
    s_add_u32 m0, m0, s85
    s_add_u32 s78, s78, s85
    s_waitcnt vmcnt(22)
    buffer_load_dwordx4 v2, s[4:7], s78 offen offset:0 nt lds
    v_readlane_b32 s84, v3, 2
    ds_read_b32 v3, v7
    s_add_u32 s92, s92, s77
    s_waitcnt vmcnt(22)
    buffer_load_dwordx4 v2, s[4:7], s78 offen offset:1024 nt lds
    ds_write_b32 v6, v5
    s_and_b32 s92, s92, 16383
    s_mul_i32 s80, s92, 768
L_B23_2:
    s_cmp_lt_i32 s84, s82
    s_cbranch_scc1 L_B23_2w
    s_waitcnt vmcnt(22)
    buffer_load_dwordx4 v2, s[4:7], s78 offen offset:2048 nt lds
    v_add_u32 v5, 3, v5
    s_bfe_u32 s92, s93, 0x40003
    s_mul_i32 s92, s92, 25165824
    s_waitcnt vmcnt(22)
    buffer_load_dwordx4 v2, s[4:7], s78 offen offset:3072 nt lds
    v_readlane_b32 s84, v3, 3
    ds_read_b32 v3, v7
    s_add_u32 m0, m0, s85
    s_add_u32 s78, s78, s85
    s_waitcnt vmcnt(22)
    buffer_load_dwordx4 v2, s[4:7], s78 offen offset:0 nt lds
    ds_write_b32 v6, v5
    s_add_u32 s80, s80, s79
    s_add_u32 s80, s80, s92
L_B23_3:
    s_cmp_lt_i32 s84, s82
    s_cbranch_scc1 L_B23_3w
    s_waitcnt vmcnt(22)
    buffer_load_dwordx4 v2, s[4:7], s78 offen offset:1024 nt lds
    v_add_u32 v5, 3, v5
    v_readlane_b32 s83, v3, 4
    s_and_b32 s86, s81, 3
    s_mul_i32 s86, s86, 12288
    s_waitcnt vmcnt(22)
    buffer_load_dwordx4 v2, s[4:7], s78 offen offset:2048 nt lds
    v_readlane_b32 s84, v3, 0
    ds_read_b32 v3, v7
    s_add_u32 s82, s82, 1
    s_cmp_eq_u32 s81, s87
    s_cselect_b32 s83, -1, s83
    s_cmp_ge_u32 s81, 128
    s_waitcnt vmcnt(22)
    buffer_load_dwordx4 v2, s[4:7], s78 offen offset:3072 nt lds
    ds_write_b32 v6, v5
    s_cselect_b64 s[4:5], s[56:57], s[50:51]
    s_mov_b32 m0, s86
    s_mov_b32 s78, s80
    s_cmp_eq_u32 s83, 23
    s_cbranch_scc1 L_B23
    s_cmp_eq_u32 s83, -1
    s_cbranch_scc1 L_D32
    s_cmp_eq_u32 s83, 22
    s_cbranch_scc1 L_D22
    s_cmp_eq_u32 s83, 24
    s_cbranch_scc1 L_D24
    s_branch L_disp
L_D16:
    s_mul_i32 s92, s81, 12
    s_add_u32 s92, s92, 32
    v_mov_b32 v5, s92
L_B16:
L_B16_0:
    s_cmp_lt_i32 s84, s82
    s_cbranch_scc1 L_B16_0w
    s_waitcnt vmcnt(15)
    buffer_load_dwordx4 v2, s[4:7], s78 offen offset:0 nt lds
    v_add_u32 v5, 3, v5
    s_add_u32 s81, s81, 1
    s_bfe_i32 s93, s81, 0x10007
    s_waitcnt vmcnt(15)
    buffer_load_dwordx4 v2, s[4:7], s78 offen offset:1024 nt lds
    v_readlane_b32 s84, v3, 1
    ds_read_b32 v3, v7
    s_xor_b32 s93, s93, s81
    s_waitcnt vmcnt(15)
    buffer_load_dwordx4 v2, s[4:7], s78 offen offset:2048 nt lds
    ds_write_b32 v6, v5
    s_and_b32 s92, s93, 7
    s_lshl_b32 s92, s92, 11
L_B16_1:
    s_cmp_lt_i32 s84, s82
    s_cbranch_scc1 L_B16_1w
    s_waitcnt vmcnt(15)
    buffer_load_dwordx4 v2, s[4:7], s78 offen offset:3072 nt lds
    v_add_u32 v5, 3, v5
    s_add_u32 m0, m0, s85
    s_add_u32 s78, s78, s85
    s_waitcnt vmcnt(15)
    buffer_load_dwordx4 v2, s[4:7], s78 offen offset:0 nt lds
    v_readlane_b32 s84, v3, 2
    ds_read_b32 v3, v7
    s_add_u32 s92, s92, s77
    s_waitcnt vmcnt(15)
    buffer_load_dwordx4 v2, s[4:7], s78 offen offset:1024 nt lds
    ds_write_b32 v6, v5
    s_and_b32 s92, s92, 16383
    s_mul_i32 s80, s92, 768
L_B16_2:
    s_cmp_lt_i32 s84, s82
    s_cbranch_scc1 L_B16_2w
    s_waitcnt vmcnt(15)
    buffer_load_dwordx4 v2, s[4:7], s78 offen offset:2048 nt lds
    v_add_u32 v5, 3, v5
    s_bfe_u32 s92, s93, 0x40003
    s_mul_i32 s92, s92, 25165824
    s_waitcnt vmcnt(15)
    buffer_load_dwordx4 v2, s[4:7], s78 offen offset:3072 nt lds
    v_readlane_b32 s84, v3, 3
    ds_read_b32 v3, v7
    s_add_u32 m0, m0, s85
    s_add_u32 s78, s78, s85
    s_waitcnt vmcnt(15)
    buffer_load_dwordx4 v2, s[4:7], s78 offen offset:0 nt lds
    ds_write_b32 v6, v5
    s_add_u32 s80, s80, s79
    s_add_u32 s80, s80, s92
L_B16_3:
    s_cmp_lt_i32 s84, s82
    s_cbranch_scc1 L_B16_3w
    s_waitcnt vmcnt(15)
    buffer_load_dwordx4 v2, s[4:7], s78 offen offset:1024 nt lds
    v_add_u32 v5, 3, v5
    v_readlane_b32 s83, v3, 4
    s_and_b32 s86, s81, 3
    s_mul_i32 s86, s86, 12288
    s_waitcnt vmcnt(15)
    buffer_load_dwordx4 v2, s[4:7], s78 offen offset:2048 nt lds
    v_readlane_b32 s84, v3, 0
    ds_read_b32 v3, v7
    s_add_u32 s82, s82, 1
    s_cmp_eq_u32 s81, s87
    s_cselect_b32 s83, -1, s83
    s_cmp_ge_u32 s81, 128
    s_waitcnt vmcnt(15)
    buffer_load_dwordx4 v2, s[4:7], s78 offen offset:3072 nt lds
    ds_write_b32 v6, v5
    s_cselect_b64 s[4:5], s[56:57], s[50:51]
    s_mov_b32 m0, s86
    s_mov_b32 s78, s80
    s_cmp_eq_u32 s83, 16
    s_cbranch_scc1 L_B16
    s_cmp_eq_u32 s83, -1
    s_cbranch_scc1 L_D32
    s_cmp_eq_u32 s83, 17
    s_cbranch_scc1 L_D17
    s_cmp_eq_u32 s83, 15
    s_cbranch_scc1 L_D15
    s_branch L_disp
L_D24:
    s_mul_i32 s92, s81, 12
    s_add_u32 s92, s92, 24
    v_mov_b32 v5, s92
L_B24:
L_B24_0:
    s_cmp_lt_i32 s84, s82
    s_cbranch_scc1 L_B24_0w
    s_waitcnt vmcnt(23)
    buffer_load_dwordx4 v2, s[4:7], s78 offen offset:0 nt lds
    v_add_u32 v5, 3, v5
    s_add_u32 s81, s81, 1
    s_bfe_i32 s93, s81, 0x10007
    s_waitcnt vmcnt(23)
    buffer_load_dwordx4 v2, s[4:7], s78 offen offset:1024 nt lds
    v_readlane_b32 s84, v3, 1
    ds_read_b32 v3, v7
    s_xor_b32 s93, s93, s81
    s_waitcnt vmcnt(23)
    buffer_load_dwordx4 v2, s[4:7], s78 offen offset:2048 nt lds
    ds_write_b32 v6, v5
    s_and_b32 s92, s93, 7
    s_lshl_b32 s92, s92, 11
L_B24_1:
    s_cmp_lt_i32 s84, s82
    s_cbranch_scc1 L_B24_1w
    s_waitcnt vmcnt(23)
    buffer_load_dwordx4 v2, s[4:7], s78 offen offset:3072 nt lds
    v_add_u32 v5, 3, v5
    s_add_u32 m0, m0, s85
    s_add_u32 s78, s78, s85
    s_waitcnt vmcnt(23)
    buffer_load_dwordx4 v2, s[4:7], s78 offen offset:0 nt lds
    v_readlane_b32 s84, v3, 2
    ds_read_b32 v3, v7
    s_add_u32 s92, s92, s77
    s_waitcnt vmcnt(23)
    buffer_load_dwordx4 v2, s[4:7], s78 offen offset:1024 nt lds
    ds_write_b32 v6, v5
    s_and_b32 s92, s92, 16383
    s_mul_i32 s80, s92, 768
L_B24_2:
    s_cmp_lt_i32 s84, s82
    s_cbranch_scc1 L_B24_2w
    s_waitcnt vmcnt(23)
    buffer_load_dwordx4 v2, s[4:7], s78 offen offset:2048 nt lds
    v_add_u32 v5, 3, v5
    s_bfe_u32 s92, s93, 0x40003
    s_mul_i32 s92, s92, 25165824
    s_waitcnt vmcnt(23)
    buffer_load_dwordx4 v2, s[4:7], s78 offen offset:3072 nt lds
    v_readlane_b32 s84, v3, 3
    ds_read_b32 v3, v7
    s_add_u32 m0, m0, s85
    s_add_u32 s78, s78, s85
    s_waitcnt vmcnt(23)
    buffer_load_dwordx4 v2, s[4:7], s78 offen offset:0 nt lds
    ds_write_b32 v6, v5
    s_add_u32 s80, s80, s79
    s_add_u32 s80, s80, s92
L_B24_3:
    s_cmp_lt_i32 s84, s82
    s_cbranch_scc1 L_B24_3w
    s_waitcnt vmcnt(23)
    buffer_load_dwordx4 v2, s[4:7], s78 offen offset:1024 nt lds
    v_add_u32 v5, 3, v5
    v_readlane_b32 s83, v3, 4
    s_and_b32 s86, s81, 3
    s_mul_i32 s86, s86, 12288
    s_waitcnt vmcnt(23)
    buffer_load_dwordx4 v2, s[4:7], s78 offen offset:2048 nt lds
    v_readlane_b32 s84, v3, 0
    ds_read_b32 v3, v7
    s_add_u32 s82, s82, 1
    s_cmp_eq_u32 s81, s87
    s_cselect_b32 s83, -1, s83
    s_cmp_ge_u32 s81, 128
    s_waitcnt vmcnt(23)
    buffer_load_dwordx4 v2, s[4:7], s78 offen offset:3072 nt lds
    ds_write_b32 v6, v5
    s_cselect_b64 s[4:5], s[56:57], s[50:51]
    s_mov_b32 m0, s86
    s_mov_b32 s78, s80
    s_cmp_eq_u32 s83, 24
    s_cbranch_scc1 L_B24
    s_cmp_eq_u32 s83, -1
    s_cbranch_scc1 L_D32
    s_cmp_eq_u32 s83, 23
    s_cbranch_scc1 L_D23
    s_cmp_eq_u32 s83, 25
    s_cbranch_scc1 L_D25
    s_branch L_disp
L_D15:
    s_mul_i32 s92, s81, 12
    s_add_u32 s92, s92, 33
    v_mov_b32 v5, s92
L_B15:
L_B15_0:
    s_cmp_lt_i32 s84, s82
    s_cbranch_scc1 L_B15_0w
    s_waitcnt vmcnt(14)
    buffer_load_dwordx4 v2, s[4:7], s78 offen offset:0 nt lds
    v_add_u32 v5, 3, v5
    s_add_u32 s81, s81, 1
    s_bfe_i32 s93, s81, 0x10007
    s_waitcnt vmcnt(14)
    buffer_load_dwordx4 v2, s[4:7], s78 offen offset:1024 nt lds
    v_readlane_b32 s84, v3, 1
    ds_read_b32 v3, v7
    s_xor_b32 s93, s93, s81
    s_waitcnt vmcnt(14)
    buffer_load_dwordx4 v2, s[4:7], s78 offen offset:2048 nt lds
    ds_write_b32 v6, v5
    s_and_b32 s92, s93, 7
    s_lshl_b32 s92, s92, 11
L_B15_1:
    s_cmp_lt_i32 s84, s82
    s_cbranch_scc1 L_B15_1w
    s_waitcnt vmcnt(14)
    buffer_load_dwordx4 v2, s[4:7], s78 offen offset:3072 nt lds
    v_add_u32 v5, 3, v5
    s_add_u32 m0, m0, s85
    s_add_u32 s78, s78, s85
    s_waitcnt vmcnt(14)
    buffer_load_dwordx4 v2, s[4:7], s78 offen offset:0 nt lds
    v_readlane_b32 s84, v3, 2
    ds_read_b32 v3, v7
    s_add_u32 s92, s92, s77
    s_waitcnt vmcnt(14)
    buffer_load_dwordx4 v2, s[4:7], s78 offen offset:1024 nt lds
    ds_write_b32 v6, v5
    s_and_b32 s92, s92, 16383
    s_mul_i32 s80, s92, 768
L_B15_2:
    s_cmp_lt_i32 s84, s82
    s_cbranch_scc1 L_B15_2w
    s_waitcnt vmcnt(14)
    buffer_load_dwordx4 v2, s[4:7], s78 offen offset:2048 nt lds
    v_add_u32 v5, 3, v5
    s_bfe_u32 s92, s93, 0x40003
    s_mul_i32 s92, s92, 25165824
    s_waitcnt vmcnt(14)
    buffer_load_dwordx4 v2, s[4:7], s78 offen offset:3072 nt lds
    v_readlane_b32 s84, v3, 3
    ds_read_b32 v3, v7
    s_add_u32 m0, m0, s85
    s_add_u32 s78, s78, s85
    s_waitcnt vmcnt(14)
    buffer_load_dwordx4 v2, s[4:7], s78 offen offset:0 nt lds
    ds_write_b32 v6, v5
    s_add_u32 s80, s80, s79
    s_add_u32 s80, s80, s92
L_B15_3:
    s_cmp_lt_i32 s84, s82
    s_cbranch_scc1 L_B15_3w
    s_waitcnt vmcnt(14)
    buffer_load_dwordx4 v2, s[4:7], s78 offen offset:1024 nt lds
    v_add_u32 v5, 3, v5
    v_readlane_b32 s83, v3, 4
    s_and_b32 s86, s81, 3
    s_mul_i32 s86, s86, 12288
    s_waitcnt vmcnt(14)
    buffer_load_dwordx4 v2, s[4:7], s78 offen offset:2048 nt lds
    v_readlane_b32 s84, v3, 0
    ds_read_b32 v3, v7
    s_add_u32 s82, s82, 1
    s_cmp_eq_u32 s81, s87
    s_cselect_b32 s83, -1, s83
    s_cmp_ge_u32 s81, 128
    s_waitcnt vmcnt(14)
    buffer_load_dwordx4 v2, s[4:7], s78 offen offset:3072 nt lds
    ds_write_b32 v6, v5
    s_cselect_b64 s[4:5], s[56:57], s[50:51]
    s_mov_b32 m0, s86
    s_mov_b32 s78, s80
    s_cmp_eq_u32 s83, 15
    s_cbranch_scc1 L_B15
    s_cmp_eq_u32 s83, -1
    s_cbranch_scc1 L_D32
    s_cmp_eq_u32 s83, 16
    s_cbranch_scc1 L_D16
    s_branch L_disp
L_D25:
    s_mul_i32 s92, s81, 12
    s_add_u32 s92, s92, 23
    v_mov_b32 v5, s92
L_B25:
L_B25_0:
    s_cmp_lt_i32 s84, s82
    s_cbranch_scc1 L_B25_0w
    s_waitcnt vmcnt(24)
    buffer_load_dwordx4 v2, s[4:7], s78 offen offset:0 nt lds
    v_add_u32 v5, 3, v5
    s_add_u32 s81, s81, 1
    s_bfe_i32 s93, s81, 0x10007
    s_waitcnt vmcnt(24)
    buffer_load_dwordx4 v2, s[4:7], s78 offen offset:1024 nt lds
    v_readlane_b32 s84, v3, 1
    ds_read_b32 v3, v7
    s_xor_b32 s93, s93, s81
    s_waitcnt vmcnt(24)
    buffer_load_dwordx4 v2, s[4:7], s78 offen offset:2048 nt lds
    ds_write_b32 v6, v5
    s_and_b32 s92, s93, 7
    s_lshl_b32 s92, s92, 11
L_B25_1:
    s_cmp_lt_i32 s84, s82
    s_cbranch_scc1 L_B25_1w
    s_waitcnt vmcnt(24)
    buffer_load_dwordx4 v2, s[4:7], s78 offen offset:3072 nt lds
    v_add_u32 v5, 3, v5
    s_add_u32 m0, m0, s85
    s_add_u32 s78, s78, s85
    s_waitcnt vmcnt(24)
    buffer_load_dwordx4 v2, s[4:7], s78 offen offset:0 nt lds
    v_readlane_b32 s84, v3, 2
    ds_read_b32 v3, v7
    s_add_u32 s92, s92, s77
    s_waitcnt vmcnt(24)
    buffer_load_dwordx4 v2, s[4:7], s78 offen offset:1024 nt lds
    ds_write_b32 v6, v5
    s_and_b32 s92, s92, 16383
    s_mul_i32 s80, s92, 768
L_B25_2:
    s_cmp_lt_i32 s84, s82
    s_cbranch_scc1 L_B25_2w
    s_waitcnt vmcnt(24)
    buffer_load_dwordx4 v2, s[4:7], s78 offen offset:2048 nt lds
    v_add_u32 v5, 3, v5
    s_bfe_u32 s92, s93, 0x40003
    s_mul_i32 s92, s92, 25165824
    s_waitcnt vmcnt(24)
    buffer_load_dwordx4 v2, s[4:7], s78 offen offset:3072 nt lds
    v_readlane_b32 s84, v3, 3
    ds_read_b32 v3, v7
    s_add_u32 m0, m0, s85
    s_add_u32 s78, s78, s85
    s_waitcnt vmcnt(24)
    buffer_load_dwordx4 v2, s[4:7], s78 offen offset:0 nt lds
    ds_write_b32 v6, v5
    s_add_u32 s80, s80, s79
    s_add_u32 s80, s80, s92
L_B25_3:
    s_cmp_lt_i32 s84, s82
    s_cbranch_scc1 L_B25_3w
    s_waitcnt vmcnt(24)
    buffer_load_dwordx4 v2, s[4:7], s78 offen offset:1024 nt lds
    v_add_u32 v5, 3, v5
    v_readlane_b32 s83, v3, 4
    s_and_b32 s86, s81, 3
    s_mul_i32 s86, s86, 12288
    s_waitcnt vmcnt(24)
    buffer_load_dwordx4 v2, s[4:7], s78 offen offset:2048 nt lds
    v_readlane_b32 s84, v3, 0
    ds_read_b32 v3, v7
    s_add_u32 s82, s82, 1
    s_cmp_eq_u32 s81, s87
    s_cselect_b32 s83, -1, s83
    s_cmp_ge_u32 s81, 128
    s_waitcnt vmcnt(24)
    buffer_load_dwordx4 v2, s[4:7], s78 offen offset:3072 nt lds
    ds_write_b32 v6, v5
    s_cselect_b64 s[4:5], s[56:57], s[50:51]
    s_mov_b32 m0, s86
    s_mov_b32 s78, s80
    s_cmp_eq_u32 s83, 25
    s_cbranch_scc1 L_B25
    s_cmp_eq_u32 s83, -1
    s_cbranch_scc1 L_D32
    s_cmp_eq_u32 s83, 24
    s_cbranch_scc1 L_D24
    s_cmp_eq_u32 s83, 26
    s_cbranch_scc1 L_D26
    s_branch L_disp
L_D26:
    s_mul_i32 s92, s81, 12
    s_add_u32 s92, s92, 22
    v_mov_b32 v5, s92
L_B26:
L_B26_0:
    s_cmp_lt_i32 s84, s82
    s_cbranch_scc1 L_B26_0w
    s_waitcnt vmcnt(25)
    buffer_load_dwordx4 v2, s[4:7], s78 offen offset:0 nt lds
    v_add_u32 v5, 3, v5
    s_add_u32 s81, s81, 1
    s_bfe_i32 s93, s81, 0x10007
    s_waitcnt vmcnt(25)
    buffer_load_dwordx4 v2, s[4:7], s78 offen offset:1024 nt lds
    v_readlane_b32 s84, v3, 1
    ds_read_b32 v3, v7
    s_xor_b32 s93, s93, s81
    s_waitcnt vmcnt(25)
    buffer_load_dwordx4 v2, s[4:7], s78 offen offset:2048 nt lds
    ds_write_b32 v6, v5
    s_and_b32 s92, s93, 7
    s_lshl_b32 s92, s92, 11
L_B26_1:
    s_cmp_lt_i32 s84, s82
    s_cbranch_scc1 L_B26_1w
    s_waitcnt vmcnt(25)
    buffer_load_dwordx4 v2, s[4:7], s78 offen offset:3072 nt lds
    v_add_u32 v5, 3, v5
    s_add_u32 m0, m0, s85
    s_add_u32 s78, s78, s85
    s_waitcnt vmcnt(25)
    buffer_load_dwordx4 v2, s[4:7], s78 offen offset:0 nt lds
    v_readlane_b32 s84, v3, 2
    ds_read_b32 v3, v7
    s_add_u32 s92, s92, s77
    s_waitcnt vmcnt(25)
    buffer_load_dwordx4 v2, s[4:7], s78 offen offset:1024 nt lds
    ds_write_b32 v6, v5
    s_and_b32 s92, s92, 16383
    s_mul_i32 s80, s92, 768
L_B26_2:
    s_cmp_lt_i32 s84, s82
    s_cbranch_scc1 L_B26_2w
    s_waitcnt vmcnt(25)
    buffer_load_dwordx4 v2, s[4:7], s78 offen offset:2048 nt lds
    v_add_u32 v5, 3, v5
    s_bfe_u32 s92, s93, 0x40003
    s_mul_i32 s92, s92, 25165824
    s_waitcnt vmcnt(25)
    buffer_load_dwordx4 v2, s[4:7], s78 offen offset:3072 nt lds
    v_readlane_b32 s84, v3, 3
    ds_read_b32 v3, v7
    s_add_u32 m0, m0, s85
    s_add_u32 s78, s78, s85
    s_waitcnt vmcnt(25)
    buffer_load_dwordx4 v2, s[4:7], s78 offen offset:0 nt lds
    ds_write_b32 v6, v5
    s_add_u32 s80, s80, s79
    s_add_u32 s80, s80, s92
L_B26_3:
    s_cmp_lt_i32 s84, s82
    s_cbranch_scc1 L_B26_3w
    s_waitcnt vmcnt(25)
    buffer_load_dwordx4 v2, s[4:7], s78 offen offset:1024 nt lds
    v_add_u32 v5, 3, v5
    v_readlane_b32 s83, v3, 4
    s_and_b32 s86, s81, 3
    s_mul_i32 s86, s86, 12288
    s_waitcnt vmcnt(25)
    buffer_load_dwordx4 v2, s[4:7], s78 offen offset:2048 nt lds
    v_readlane_b32 s84, v3, 0
    ds_read_b32 v3, v7
    s_add_u32 s82, s82, 1
    s_cmp_eq_u32 s81, s87
    s_cselect_b32 s83, -1, s83
    s_cmp_ge_u32 s81, 128
    s_waitcnt vmcnt(25)
    buffer_load_dwordx4 v2, s[4:7], s78 offen offset:3072 nt lds
    ds_write_b32 v6, v5
    s_cselect_b64 s[4:5], s[56:57], s[50:51]
    s_mov_b32 m0, s86
    s_mov_b32 s78, s80
    s_cmp_eq_u32 s83, 26
    s_cbranch_scc1 L_B26
    s_cmp_eq_u32 s83, -1
    s_cbranch_scc1 L_D32
    s_cmp_eq_u32 s83, 25
    s_cbranch_scc1 L_D25
    s_branch L_disp
L_B20_0w:
    ds_read_b32 v3, v7
    s_waitcnt lgkmcnt(0)
    v_readlane_b32 s84, v3, 0
    s_nop 0
    s_branch L_B20_0
L_B20_1w:
    ds_read_b32 v3, v7
    s_waitcnt lgkmcnt(0)
    v_readlane_b32 s84, v3, 1
    s_nop 0
    s_branch L_B20_1
L_B20_2w:
    ds_read_b32 v3, v7
    s_waitcnt lgkmcnt(0)
    v_readlane_b32 s84, v3, 2
    s_nop 0
    s_branch L_B20_2
L_B20_3w:
    ds_read_b32 v3, v7
    s_waitcnt lgkmcnt(0)
    v_readlane_b32 s84, v3, 3
    s_nop 0
    s_branch L_B20_3
L_B19_0w:
    ds_read_b32 v3, v7
    s_waitcnt lgkmcnt(0)
    v_readlane_b32 s84, v3, 0
    s_nop 0
    s_branch L_B19_0
L_B19_1w:
    ds_read_b32 v3, v7
    s_waitcnt lgkmcnt(0)
    v_readlane_b32 s84, v3, 1
    s_nop 0
    s_branch L_B19_1
L_B19_2w:
    ds_read_b32 v3, v7
    s_waitcnt lgkmcnt(0)
    v_readlane_b32 s84, v3, 2
    s_nop 0
    s_branch L_B19_2
L_B19_3w:
    ds_read_b32 v3, v7
    s_waitcnt lgkmcnt(0)
    v_readlane_b32 s84, v3, 3
    s_nop 0
    s_branch L_B19_3
L_B21_0w:
    ds_read_b32 v3, v7
    s_waitcnt lgkmcnt(0)
    v_readlane_b32 s84, v3, 0
    s_nop 0
    s_branch L_B21_0
L_B21_1w:
    ds_read_b32 v3, v7
    s_waitcnt lgkmcnt(0)
    v_readlane_b32 s84, v3, 1
    s_nop 0
    s_branch L_B21_1
L_B21_2w:
    ds_read_b32 v3, v7
    s_waitcnt lgkmcnt(0)
    v_readlane_b32 s84, v3, 2
    s_nop 0
    s_branch L_B21_2
L_B21_3w:
    ds_read_b32 v3, v7
    s_waitcnt lgkmcnt(0)
    v_readlane_b32 s84, v3, 3
    s_nop 0
    s_branch L_B21_3
L_B18_0w:
    ds_read_b32 v3, v7
    s_waitcnt lgkmcnt(0)
    v_readlane_b32 s84, v3, 0
    s_nop 0
    s_branch L_B18_0
L_B18_1w:
    ds_read_b32 v3, v7
    s_waitcnt lgkmcnt(0)
    v_readlane_b32 s84, v3, 1
    s_nop 0
    s_branch L_B18_1
L_B18_2w:
    ds_read_b32 v3, v7
    s_waitcnt lgkmcnt(0)
    v_readlane_b32 s84, v3, 2
    s_nop 0
    s_branch L_B18_2
L_B18_3w:
    ds_read_b32 v3, v7
    s_waitcnt lgkmcnt(0)
    v_readlane_b32 s84, v3, 3
    s_nop 0
    s_branch L_B18_3
L_B22_0w:
    ds_read_b32 v3, v7
    s_waitcnt lgkmcnt(0)
    v_readlane_b32 s84, v3, 0
    s_nop 0
    s_branch L_B22_0
L_B22_1w:
    ds_read_b32 v3, v7
    s_waitcnt lgkmcnt(0)
    v_readlane_b32 s84, v3, 1
    s_nop 0
    s_branch L_B22_1
L_B22_2w:
    ds_read_b32 v3, v7
    s_waitcnt lgkmcnt(0)
    v_readlane_b32 s84, v3, 2
    s_nop 0
    s_branch L_B22_2
L_B22_3w:
    ds_read_b32 v3, v7
    s_waitcnt lgkmcnt(0)
    v_readlane_b32 s84, v3, 3
    s_nop 0
    s_branch L_B22_3
L_B17_0w:
    ds_read_b32 v3, v7
    s_waitcnt lgkmcnt(0)
    v_readlane_b32 s84, v3, 0
    s_nop 0
    s_branch L_B17_0
L_B17_1w:
    ds_read_b32 v3, v7
    s_waitcnt lgkmcnt(0)
    v_readlane_b32 s84, v3, 1
    s_nop 0
    s_branch L_B17_1
L_B17_2w:
    ds_read_b32 v3, v7
    s_waitcnt lgkmcnt(0)
    v_readlane_b32 s84, v3, 2
    s_nop 0
    s_branch L_B17_2
L_B17_3w:
    ds_read_b32 v3, v7
    s_waitcnt lgkmcnt(0)
    v_readlane_b32 s84, v3, 3
    s_nop 0
    s_branch L_B17_3
L_B23_0w:
    ds_read_b32 v3, v7
    s_waitcnt lgkmcnt(0)
    v_readlane_b32 s84, v3, 0
    s_nop 0
    s_branch L_B23_0
L_B23_1w:
    ds_read_b32 v3, v7
    s_waitcnt lgkmcnt(0)
    v_readlane_b32 s84, v3, 1
    s_nop 0
    s_branch L_B23_1
L_B23_2w:
    ds_read_b32 v3, v7
    s_waitcnt lgkmcnt(0)
    v_readlane_b32 s84, v3, 2
    s_nop 0
    s_branch L_B23_2
L_B23_3w:
    ds_read_b32 v3, v7
    s_waitcnt lgkmcnt(0)
    v_readlane_b32 s84, v3, 3
    s_nop 0
    s_branch L_B23_3
L_B16_0w:
    ds_read_b32 v3, v7
    s_waitcnt lgkmcnt(0)
    v_readlane_b32 s84, v3, 0
    s_nop 0
    s_branch L_B16_0
L_B16_1w:
    ds_read_b32 v3, v7
    s_waitcnt lgkmcnt(0)
    v_readlane_b32 s84, v3, 1
    s_nop 0
    s_branch L_B16_1
L_B16_2w:
    ds_read_b32 v3, v7
    s_waitcnt lgkmcnt(0)
    v_readlane_b32 s84, v3, 2
    s_nop 0
    s_branch L_B16_2
L_B16_3w:
    ds_read_b32 v3, v7
    s_waitcnt lgkmcnt(0)
    v_readlane_b32 s84, v3, 3
    s_nop 0
    s_branch L_B16_3
L_B24_0w:
    ds_read_b32 v3, v7
    s_waitcnt lgkmcnt(0)
    v_readlane_b32 s84, v3, 0
    s_nop 0
    s_branch L_B24_0
L_B24_1w:
    ds_read_b32 v3, v7
    s_waitcnt lgkmcnt(0)
    v_readlane_b32 s84, v3, 1
    s_nop 0
    s_branch L_B24_1
L_B24_2w:
    ds_read_b32 v3, v7
    s_waitcnt lgkmcnt(0)
    v_readlane_b32 s84, v3, 2
    s_nop 0
    s_branch L_B24_2
L_B24_3w:
    ds_read_b32 v3, v7
    s_waitcnt lgkmcnt(0)
    v_readlane_b32 s84, v3, 3
    s_nop 0
    s_branch L_B24_3
L_B15_0w:
    ds_read_b32 v3, v7
    s_waitcnt lgkmcnt(0)
    v_readlane_b32 s84, v3, 0
    s_nop 0
    s_branch L_B15_0
L_B15_1w:
    ds_read_b32 v3, v7
    s_waitcnt lgkmcnt(0)
    v_readlane_b32 s84, v3, 1
    s_nop 0
    s_branch L_B15_1
L_B15_2w:
    ds_read_b32 v3, v7
    s_waitcnt lgkmcnt(0)
    v_readlane_b32 s84, v3, 2
    s_nop 0
    s_branch L_B15_2
L_B15_3w:
    ds_read_b32 v3, v7
    s_waitcnt lgkmcnt(0)
    v_readlane_b32 s84, v3, 3
    s_nop 0
    s_branch L_B15_3
L_B25_0w:
    ds_read_b32 v3, v7
    s_waitcnt lgkmcnt(0)
    v_readlane_b32 s84, v3, 0
    s_nop 0
    s_branch L_B25_0
L_B25_1w:
    ds_read_b32 v3, v7
    s_waitcnt lgkmcnt(0)
    v_readlane_b32 s84, v3, 1
    s_nop 0
    s_branch L_B25_1
L_B25_2w:
    ds_read_b32 v3, v7
    s_waitcnt lgkmcnt(0)
    v_readlane_b32 s84, v3, 2
    s_nop 0
    s_branch L_B25_2
L_B25_3w:
    ds_read_b32 v3, v7
    s_waitcnt lgkmcnt(0)
    v_readlane_b32 s84, v3, 3
    s_nop 0
    s_branch L_B25_3
L_B26_0w:
    ds_read_b32 v3, v7
    s_waitcnt lgkmcnt(0)
    v_readlane_b32 s84, v3, 0
    s_nop 0
    s_branch L_B26_0
L_B26_1w:
    ds_read_b32 v3, v7
    s_waitcnt lgkmcnt(0)
    v_readlane_b32 s84, v3, 1
    s_nop 0
    s_branch L_B26_1
L_B26_2w:
    ds_read_b32 v3, v7
    s_waitcnt lgkmcnt(0)
    v_readlane_b32 s84, v3, 2
    s_nop 0
    s_branch L_B26_2
L_B26_3w:
    ds_read_b32 v3, v7
    s_waitcnt lgkmcnt(0)
    v_readlane_b32 s84, v3, 3
    s_nop 0
    s_branch L_B26_3
L_B32_0w:
    ds_read_b32 v3, v7
    s_waitcnt lgkmcnt(0)
    v_readlane_b32 s84, v3, 0
    s_nop 0
    s_branch L_B32_0
L_B32_1w:
    ds_read_b32 v3, v7
    s_waitcnt lgkmcnt(0)
    v_readlane_b32 s84, v3, 1
    s_nop 0
    s_branch L_B32_1
L_B32_2w:
    ds_read_b32 v3, v7
    s_waitcnt lgkmcnt(0)
    v_readlane_b32 s84, v3, 2
    s_nop 0
    s_branch L_B32_2
L_B32_3w:
    ds_read_b32 v3, v7
    s_waitcnt lgkmcnt(0)
    v_readlane_b32 s84, v3, 3
    s_nop 0
    s_branch L_B32_3
L_tail:
L_D32:
    s_mul_i32 s92, s81, 12
    s_add_u32 s92, s92, 16
    v_mov_b32 v5, s92
L_B32:
L_B32_0:
    s_cmp_lt_i32 s84, s82
    s_cbranch_scc1 L_B32_0w
    s_waitcnt vmcnt(31)
    buffer_load_dwordx4 v2, s[4:7], s78 offen offset:0 nt lds
    v_add_u32 v5, 3, v5
    s_add_u32 s81, s81, 1
    s_bfe_i32 s93, s81, 0x10007
    s_waitcnt vmcnt(31)
    buffer_load_dwordx4 v2, s[4:7], s78 offen offset:1024 nt lds
    v_readlane_b32 s84, v3, 1
    ds_read_b32 v3, v7
    s_xor_b32 s93, s93, s81
    s_waitcnt vmcnt(31)
    buffer_load_dwordx4 v2, s[4:7], s78 offen offset:2048 nt lds
    ds_write_b32 v6, v5
    s_and_b32 s92, s93, 7
    s_lshl_b32 s92, s92, 11
L_B32_1:
    s_cmp_lt_i32 s84, s82
    s_cbranch_scc1 L_B32_1w
    s_waitcnt vmcnt(31)
    buffer_load_dwordx4 v2, s[4:7], s78 offen offset:3072 nt lds
    v_add_u32 v5, 3, v5
    s_add_u32 m0, m0, s85
    s_add_u32 s78, s78, s85
    s_waitcnt vmcnt(31)
    buffer_load_dwordx4 v2, s[4:7], s78 offen offset:0 nt lds
    v_readlane_b32 s84, v3, 2
    ds_read_b32 v3, v7
    s_add_u32 s92, s92, s77
    s_waitcnt vmcnt(31)
    buffer_load_dwordx4 v2, s[4:7], s78 offen offset:1024 nt lds
    ds_write_b32 v6, v5
    s_and_b32 s92, s92, 16383
    s_mul_i32 s80, s92, 768
L_B32_2:
    s_cmp_lt_i32 s84, s82
    s_cbranch_scc1 L_B32_2w
    s_waitcnt vmcnt(31)
    buffer_load_dwordx4 v2, s[4:7], s78 offen offset:2048 nt lds
    v_add_u32 v5, 3, v5
    s_bfe_u32 s92, s93, 0x40003
    s_mul_i32 s92, s92, 25165824
    s_waitcnt vmcnt(31)
    buffer_load_dwordx4 v2, s[4:7], s78 offen offset:3072 nt lds
    v_readlane_b32 s84, v3, 3
    ds_read_b32 v3, v7
    s_add_u32 m0, m0, s85
    s_add_u32 s78, s78, s85
    s_waitcnt vmcnt(31)
    buffer_load_dwordx4 v2, s[4:7], s78 offen offset:0 nt lds
    ds_write_b32 v6, v5
    s_add_u32 s80, s80, s79
    s_add_u32 s80, s80, s92
L_B32_3:
    s_cmp_lt_i32 s84, s82
    s_cbranch_scc1 L_B32_3w
    s_waitcnt vmcnt(31)
    buffer_load_dwordx4 v2, s[4:7], s78 offen offset:1024 nt lds
    v_add_u32 v5, 3, v5
    v_readlane_b32 s83, v3, 4
    s_and_b32 s86, s81, 3
    s_mul_i32 s86, s86, 12288
    s_waitcnt vmcnt(31)
    buffer_load_dwordx4 v2, s[4:7], s78 offen offset:2048 nt lds
    v_readlane_b32 s84, v3, 0
    ds_read_b32 v3, v7
    s_add_u32 s82, s82, 1
    s_movk_i32 s87, 255
    s_cmp_ge_u32 s81, 128
    s_waitcnt vmcnt(31)
    buffer_load_dwordx4 v2, s[4:7], s78 offen offset:3072 nt lds
    ds_write_b32 v6, v5
    s_cselect_b64 s[4:5], s[56:57], s[50:51]
    s_mov_b32 m0, s86
    s_mov_b32 s78, s80
    s_cmp_lg_u32 s81, 256
    s_cbranch_scc1 L_disp
L_drain:
    v_mov_b32 v18, 3090
    s_waitcnt vmcnt(30)
    ds_write_b32 v6, v18
    v_mov_b32 v18, 3093
    s_waitcnt vmcnt(27)
    ds_write_b32 v6, v18
    v_mov_b32 v18, 3096
    s_waitcnt vmcnt(24)
    ds_write_b32 v6, v18
    v_mov_b32 v18, 3099
    s_waitcnt vmcnt(21)
    ds_write_b32 v6, v18
    v_mov_b32 v18, 3102
    s_waitcnt vmcnt(18)
    ds_write_b32 v6, v18
    v_mov_b32 v18, 3105
    s_waitcnt vmcnt(15)
    ds_write_b32 v6, v18
    v_mov_b32 v18, 3108
    s_waitcnt vmcnt(12)
    ds_write_b32 v6, v18
    v_mov_b32 v18, 3111
    s_waitcnt vmcnt(9)
    ds_write_b32 v6, v18
    v_mov_b32 v18, 3114
    s_waitcnt vmcnt(6)
    ds_write_b32 v6, v18
    v_mov_b32 v18, 3117
    s_waitcnt vmcnt(3)
    ds_write_b32 v6, v18
    v_mov_b32 v18, 3120
    s_waitcnt vmcnt(0)
    ds_write_b32 v6, v18
    s_waitcnt lgkmcnt(0)
    s_endpgm
L_other:
    s_cmp_eq_u32 s76, 5
    s_cbranch_scc1 L_helper
    s_sub_u32 s78, s76, 1
    v_lshlrev_b32 v44, 3, v1
    v_cmp_gt_u32 vcc, 24, v1
    v_mov_b32 v23, 0xffffff40
    v_mov_b32 v18, 192
    v_cndmask_b32 v23, v23, v18, vcc
    v_add_u32 v45, v44, v23
    v_mov_b32 v18, 0x80008000
    v_cndmask_b32 v46, 0, v18, vcc
    v_lshrrev_b32 v19, 4, v1
    v_and_b32 v23, 15, v1
    v_mul_u32_u24 v20, 384, v19
    v_lshl_add_u32 v20, v23, 3, v20
    v_cmp_lt_u32 s[86:87], 7, v23
    v_mov_b32 v21, -64
    v_mov_b32 v18, 320
    v_cndmask_b32 v21, v18, v21, s[86:87]
    v_add_u32 v21, v20, v21
    s_lshl2_add_u32 s95, s78, s3
    s_mul_i32 s95, s95, 384
    s_lshl2_add_u32 s89, s78, s77
    s_xor_b32 s89, s89, 8192
    s_mov_b32 s34, 12288
    s_mov_b32 s35, 0x20000
    s_mov_b32 s38, 384
    s_mov_b32 s39, 0x20000
    s_mov_b32 s42, 384
    s_mov_b32 s43, 0x20000
    s_mov_b32 s14, 6291456
    s_mov_b32 s15, 0x20000
    s_mov_b32 s18, 6291456
    s_mov_b32 s19, 0x20000
    s_waitcnt lgkmcnt(0)
    s_mov_b64 s[32:33], s[48:49]
    s_mov_b64 s[36:37], s[62:63]
    s_mov_b64 s[40:41], s[64:65]
    buffer_load_dwordx2 v[24:25], v44, s[32:35], s95 offen
    buffer_load_dwordx2 v[26:27], v45, s[32:35], s95 offen
    buffer_load_dwordx2 v[28:29], v44, s[32:35], s95 offen offset:768
    buffer_load_dwordx2 v[30:31], v45, s[32:35], s95 offen offset:768
    buffer_load_dwordx2 v[40:41], v44, s[36:39], 0 offen
    buffer_load_dwordx2 v[42:43], v44, s[40:43], 0 offen
    s_mov_b64 s[12:13], s[66:67]
    s_mov_b64 s[16:17], s[68:69]
    s_barrier
    s_mov_b32 s83, 0x05040100
    s_mov_b32 s84, 0x07060302
    s_mul_i32 s92, s78, 3072
    v_lshl_add_u32 v2, v20, 1, s92
    v_add_u32 v12, s92, v20
    v_add_u32 v13, s92, v21
    s_lshl_b32 s92, s78, 5
    s_add_u32 s92, s92, 49152
    v_lshl_add_u32 v3, v19, 3, s92
    v_lshrrev_b32 v18, 3, v23
    v_lshl_add_u32 v4, v18, 7, v3
    v_lshlrev_b32 v9, 4, v23
    v_add_u32 v9, 65536, v9
    s_lshl2_add_u32 s92, s78, 77824
    v_mov_b32 v5, s92
    v_mov_b32 v6, 0
    v_mov_b32 v8, 1
    s_mul_i32 s79, s78, 3
    s_sub_u32 s79, s79, 9
    s_mov_b32 s80, 0
    s_mov_b32 s81, 0
    s_mul_i32 s92, s78, 1536
    s_add_u32 s92, s92, 65536
    v_lshl_add_u32 v14, v44, 1, s92
    v_lshl_add_u32 v16, v45, 1, s92
    s_waitcnt vmcnt(0)
    v_xor_b32 v42, v42, v46
    v_xor_b32 v43, v43, v46
    v_lshlrev_b32 v48, 16, v40
    v_and_b32 v49, 0xffff0000, v40
    v_lshlrev_b32 v50, 16, v41
    v_and_b32 v51, 0xffff0000, v41
    v_lshlrev_b32 v52, 16, v42
    v_and_b32 v53, 0xffff0000, v42
    v_lshlrev_b32 v54, 16, v43
    v_and_b32 v55, 0xffff0000, v43
    v_and_b32 v46, 0x80000000, v46
    s_mov_b32 exec_hi, 0xffff
    v_lshlrev_b32 v56, 16, v24
    v_and_b32 v57, 0xffff0000, v24
    v_lshlrev_b32 v58, 16, v25
    v_and_b32 v59, 0xffff0000, v25
    v_lshlrev_b32 v60, 16, v26
    v_and_b32 v61, 0xffff0000, v26
    v_lshlrev_b32 v62, 16, v27
    v_and_b32 v63, 0xffff0000, v27
    v_pk_mul_f32 v[56:57], v[56:57], v[48:49]
    v_pk_mul_f32 v[60:61], v[60:61], v[52:53]
    v_pk_mul_f32 v[58:59], v[58:59], v[50:51]
    v_pk_mul_f32 v[62:63], v[62:63], v[54:55]
    v_cvt_pk_bf16_f32 v56, v56, v60
    v_cvt_pk_bf16_f32 v57, v57, v61
    v_cvt_pk_bf16_f32 v58, v58, v62
    v_cvt_pk_bf16_f32 v59, v59, v63
    v_and_b32 v60, 0xffff0000, v56
    v_lshlrev_b32 v56, 16, v56
    v_and_b32 v61, 0xffff0000, v57
    v_lshlrev_b32 v57, 16, v57
    v_and_b32 v62, 0xffff0000, v58
    v_lshlrev_b32 v58, 16, v58
    v_and_b32 v63, 0xffff0000, v59
    v_lshlrev_b32 v59, 16, v59
    v_pk_add_f32 v[56:57], v[56:57], v[60:61]
    v_pk_add_f32 v[58:59], v[58:59], v[62:63]
    v_cvt_pk_bf16_f32 v64, v56, v56
    v_cvt_pk_bf16_f32 v65, v57, v57
    v_cvt_pk_bf16_f32 v66, v58, v58
    v_cvt_pk_bf16_f32 v67, v59, v59
    v_xor_b32 v64, v64, v46
    v_xor_b32 v65, v65, v46
    v_xor_b32 v66, v66, v46
    v_xor_b32 v67, v67, v46
    ds_write_b16 v14, v64 offset:0
    ds_write_b16_d16_hi v16, v64 offset:2
    ds_write_b16 v14, v65 offset:4
    ds_write_b16_d16_hi v16, v65 offset:6
    ds_write_b16 v14, v66 offset:8
    ds_write_b16_d16_hi v16, v66 offset:10
    ds_write_b16 v14, v67 offset:12
    ds_write_b16_d16_hi v16, v67 offset:14
    v_lshlrev_b32 v56, 16, v28
    v_and_b32 v57, 0xffff0000, v28
    v_lshlrev_b32 v58, 16, v29
    v_and_b32 v59, 0xffff0000, v29
    v_lshlrev_b32 v60, 16, v30
    v_and_b32 v61, 0xffff0000, v30
    v_lshlrev_b32 v62, 16, v31
    v_and_b32 v63, 0xffff0000, v31
    v_pk_mul_f32 v[56:57], v[56:57], v[48:49]
    v_pk_mul_f32 v[60:61], v[60:61], v[52:53]
    v_pk_mul_f32 v[58:59], v[58:59], v[50:51]
    v_pk_mul_f32 v[62:63], v[62:63], v[54:55]
    v_cvt_pk_bf16_f32 v56, v56, v60
    v_cvt_pk_bf16_f32 v57, v57, v61
    v_cvt_pk_bf16_f32 v58, v58, v62
    v_cvt_pk_bf16_f32 v59, v59, v63
    v_and_b32 v60, 0xffff0000, v56
    v_lshlrev_b32 v56, 16, v56
    v_and_b32 v61, 0xffff0000, v57
    v_lshlrev_b32 v57, 16, v57
    v_and_b32 v62, 0xffff0000, v58
    v_lshlrev_b32 v58, 16, v58
    v_and_b32 v63, 0xffff0000, v59
    v_lshlrev_b32 v59, 16, v59
    v_pk_add_f32 v[56:57], v[56:57], v[60:61]
    v_pk_add_f32 v[58:59], v[58:59], v[62:63]
    v_cvt_pk_bf16_f32 v68, v56, v56
    v_cvt_pk_bf16_f32 v69, v57, v57
    v_cvt_pk_bf16_f32 v70, v58, v58
    v_cvt_pk_bf16_f32 v71, v59, v59
    v_xor_b32 v68, v68, v46
    v_xor_b32 v69, v69, v46
    v_xor_b32 v70, v70, v46
    v_xor_b32 v71, v71, v46
    ds_write_b16 v14, v68 offset:768
    ds_write_b16_d16_hi v16, v68 offset:770
    ds_write_b16 v14, v69 offset:772
    ds_write_b16_d16_hi v16, v69 offset:774
    ds_write_b16 v14, v70 offset:776
    ds_write_b16_d16_hi v16, v70 offset:778
    ds_write_b16 v14, v71 offset:780
    ds_write_b16_d16_hi v16, v71 offset:782
    s_mov_b32 exec_hi, -1
    ds_write_b32 v5, v8 offset:160
    s_add_u32 s79, s79, 12
    s_cmp_ge_i32 s80, s79
    s_cbranch_scc1 L_cr0g
L_cr0:
    ds_read_b32 v19, v7
    s_sleep 1
    s_waitcnt lgkmcnt(0)
    v_readlane_b32 s80, v19, 5
    s_nop 0
    s_cmp_lt_i32 s80, s79
    s_cbranch_scc1 L_cr0
L_cr0g:
    ds_read_b64 v[72:73], v12 offset:0
    ds_read_b64 v[76:77], v12 offset:128
    ds_read_b64 v[80:81], v12 offset:256
    ds_read_b64 v[84:85], v12 offset:1536
    ds_read_b64 v[88:89], v12 offset:1664
    ds_read_b64 v[92:93], v12 offset:1792
    v_add_u32 v6, 1, v6
    ds_write_b32 v5, v6
    s_add_u32 s79, s79, 12
    s_cmp_ge_i32 s80, s79
    s_cbranch_scc1 L_cr1g
L_cr1:
    ds_read_b32 v19, v7
    s_sleep 1
    s_waitcnt lgkmcnt(0)
    v_readlane_b32 s80, v19, 5
    s_nop 0
    s_cmp_lt_i32 s80, s79
    s_cbranch_scc1 L_cr1
L_cr1g:
    ds_read_b64 v[74:75], v12 offset:12480
    ds_read_b64 v[78:79], v13 offset:12288
    ds_read_b64 v[82:83], v12 offset:12352
    ds_read_b64 v[86:87], v12 offset:14016
    ds_read_b64 v[90:91], v13 offset:13824
    ds_read_b64 v[94:95], v12 offset:13888
    v_add_u32 v6, 1, v6
    ds_write_b32 v5, v6
    s_mul_i32 s82, s89, 384
    s_add_u32 s89, s89, 2048
    s_and_b32 s89, s89, 16383
    buffer_load_dwordx2 v[120:121], v20, s[12:15], s82 offen offset:0
    buffer_load_dwordx2 v[122:123], v20, s[16:19], s82 offen offset:192
    buffer_load_dwordx2 v[124:125], v20, s[12:15], s82 offen offset:128
    buffer_load_dwordx2 v[126:127], v21, s[16:19], s82 offen
    buffer_load_dwordx2 v[128:129], v20, s[12:15], s82 offen offset:256
    buffer_load_dwordx2 v[130:131], v20, s[16:19], s82 offen offset:64
    s_add_u32 s79, s79, 12
    s_cmp_ge_i32 s80, s79
    s_cbranch_scc1 L_cr2g
L_cr2:
    ds_read_b32 v19, v7
    s_sleep 1
    s_waitcnt lgkmcnt(0)
    v_readlane_b32 s80, v19, 5
    s_nop 0
    s_cmp_lt_i32 s80, s79
    s_cbranch_scc1 L_cr2
L_cr2g:
    ds_read_b64 v[96:97], v12 offset:24576
    ds_read_b64 v[100:101], v12 offset:24704
    ds_read_b64 v[104:105], v12 offset:24832
    ds_read_b64 v[108:109], v12 offset:26112
    ds_read_b64 v[112:113], v12 offset:26240
    ds_read_b64 v[116:117], v12 offset:26368
    v_add_u32 v6, 1, v6
    ds_write_b32 v5, v6
    s_add_u32 s79, s79, 12
    s_cmp_ge_i32 s80, s79
    s_cbranch_scc1 L_cr3g
L_cr3:
    ds_read_b32 v19, v7
    s_sleep 1
    s_waitcnt lgkmcnt(0)
    v_readlane_b32 s80, v19, 5
    s_nop 0
    s_cmp_lt_i32 s80, s79
    s_cbranch_scc1 L_cr3
L_cr3g:
    ds_read_b64 v[98:99], v12 offset:37056
    ds_read_b64 v[102:103], v13 offset:36864
    ds_read_b64 v[106:107], v12 offset:36928
    ds_read_b64 v[110:111], v12 offset:38592
    ds_read_b64 v[114:115], v13 offset:38400
    ds_read_b64 v[118:119], v12 offset:38464
    v_add_u32 v6, 1, v6
    ds_write_b32 v5, v6
    s_mul_i32 s82, s89, 384
    s_add_u32 s89, s89, 2048
    s_and_b32 s89, s89, 16383
    buffer_load_dwordx2 v[132:133], v20, s[12:15], s82 offen offset:0
    buffer_load_dwordx2 v[134:135], v20, s[16:19], s82 offen offset:192
    buffer_load_dwordx2 v[136:137], v20, s[12:15], s82 offen offset:128
    buffer_load_dwordx2 v[138:139], v21, s[16:19], s82 offen
    buffer_load_dwordx2 v[140:141], v20, s[12:15], s82 offen offset:256
    buffer_load_dwordx2 v[142:143], v20, s[16:19], s82 offen offset:64
L_kph:
    s_lshr_b32 s94, s81, 1
    s_add_u32 s88, s94, 40
    s_lshl2_add_u32 s92, s94, 77888
    v_mov_b32 v22, s92
    s_nop 1
L_kw:
    ds_read_b32 v19, v7
    ds_read_b128 v[48:51], v9 offset:0
    ds_read_b128 v[52:55], v9 offset:256
    ds_read_b128 v[56:59], v9 offset:512
    s_waitcnt lgkmcnt(0)
    v_readlane_b32 s92, v19, s88
    v_readlane_b32 s93, v19, 12
    s_cmp_eq_u32 s92, 0
    s_nop 3
    s_cbranch_scc1 L_kw
    s_cmp_le_u32 s93, s94
    s_cbranch_scc1 L_kw
    v_add_u32 v9, 768, v9
    s_cmp_lg_u32 s81, 0
    s_nop 0
    s_cbranch_scc1 L_ncs0
    v_perm_b32 v36, v74, v72, s83
    v_perm_b32 v74, v74, v72, s84
    v_perm_b32 v37, v75, v73, s83
    v_perm_b32 v75, v75, v73, s84
    v_perm_b32 v38, v78, v76, s83
    v_perm_b32 v78, v78, v76, s84
    v_perm_b32 v39, v79, v77, s83
    v_perm_b32 v79, v79, v77, s84
    v_perm_b32 v40, v82, v80, s83
    v_perm_b32 v82, v82, v80, s84
    v_perm_b32 v41, v83, v81, s83
    v_perm_b32 v83, v83, v81, s84
    v_mov_b64 v[72:73], v[36:37]
    v_mov_b64 v[76:77], v[38:39]
    v_mov_b64 v[80:81], v[40:41]
    s_nop 1
L_ncs0:
    v_dot2_f32_bf16 v36, v72, v48, 0
    v_dot2_f32_bf16 v37, v74, v49, 0
    v_dot2_f32_bf16 v38, v73, v50, 0
    v_dot2_f32_bf16 v39, v75, v51, 0
    v_dot2_f32_bf16 v40, v76, v52, 0
    v_dot2_f32_bf16 v41, v78, v53, 0
    v_dot2_f32_bf16 v42, v77, v54, 0
    v_dot2_f32_bf16 v43, v79, v55, 0
    v_dot2_f32_bf16 v44, v80, v56, 0
    v_dot2_f32_bf16 v45, v82, v57, 0
    v_dot2_f32_bf16 v46, v81, v58, 0
    v_dot2_f32_bf16 v47, v83, v59, 0
    s_add_u32 s79, s79, 12
    s_cmp_ge_i32 s80, s79
    s_cbranch_scc1 L_kr0g
L_kr0:
    ds_read_b32 v19, v7
    s_sleep 1
    s_waitcnt lgkmcnt(0)
    v_readlane_b32 s80, v19, 5
    s_nop 0
    s_cmp_lt_i32 s80, s79
    s_cbranch_scc1 L_kr0
L_kr0g:
    ds_read_b32 v10, v3 offset:0
    ds_read_b128 v[24:27], v2 offset:0
    ds_read_b128 v[28:31], v2 offset:256
    ds_read_b128 v[32:35], v2 offset:512
    v_add_u32 v6, 1, v6
    ds_write_b32 v5, v6
    s_waitcnt lgkmcnt(3)
    v_and_b32 v12, 0xffff0000, v10
    v_cvt_f32_i32 v24, v24
    v_cvt_f32_i32 v25, v25
    v_cvt_f32_i32 v26, v26
    v_cvt_f32_i32 v27, v27
    v_pk_add_f32 v[24:25], v[24:25], v[12:13] op_sel:[0,0] op_sel_hi:[1,0] neg_lo:[0,1] neg_hi:[0,1]
    v_pk_add_f32 v[26:27], v[26:27], v[12:13] op_sel:[0,0] op_sel_hi:[1,0] neg_lo:[0,1] neg_hi:[0,1]
    v_pk_mul_f32 v[14:15], v[24:25], v[36:37]
    v_pk_fma_f32 v[14:15], v[26:27], v[38:39], v[14:15]
    s_waitcnt lgkmcnt(2)
    v_cvt_f32_i32 v28, v28
    v_cvt_f32_i32 v29, v29
    v_cvt_f32_i32 v30, v30
    v_cvt_f32_i32 v31, v31
    v_pk_add_f32 v[28:29], v[28:29], v[12:13] op_sel:[0,0] op_sel_hi:[1,0] neg_lo:[0,1] neg_hi:[0,1]
    v_pk_add_f32 v[30:31], v[30:31], v[12:13] op_sel:[0,0] op_sel_hi:[1,0] neg_lo:[0,1] neg_hi:[0,1]
    v_pk_fma_f32 v[14:15], v[28:29], v[40:41], v[14:15]
    v_pk_fma_f32 v[14:15], v[30:31], v[42:43], v[14:15]
    s_waitcnt lgkmcnt(1)
    v_cvt_f32_i32 v32, v32
    v_cvt_f32_i32 v33, v33
    v_cvt_f32_i32 v34, v34
    v_cvt_f32_i32 v35, v35
    v_pk_add_f32 v[32:33], v[32:33], v[12:13] op_sel:[0,0] op_sel_hi:[1,0] neg_lo:[0,1] neg_hi:[0,1]
    v_pk_add_f32 v[34:35], v[34:35], v[12:13] op_sel:[0,0] op_sel_hi:[1,0] neg_lo:[0,1] neg_hi:[0,1]
    v_pk_fma_f32 v[14:15], v[32:33], v[44:45], v[14:15]
    v_pk_fma_f32 v[14:15], v[34:35], v[46:47], v[14:15]
    v_add_f32 v14, v14, v15
    s_nop 1
    v_add_f32_dpp v18, v14, v14 row_ror:8 row_mask:0xf bank_mask:0x3
    s_cmp_lg_u32 s81, 0
    s_nop 0
    s_cbranch_scc1 L_ncs1
    s_mul_i32 s82, s89, 384
    s_add_u32 s89, s89, 2048
    s_and_b32 s89, s89, 16383
    buffer_load_dwordx2 v[144:145], v20, s[12:15], s82 offen offset:0
    buffer_load_dwordx2 v[146:147], v20, s[16:19], s82 offen offset:192
    buffer_load_dwordx2 v[148:149], v20, s[12:15], s82 offen offset:128
    buffer_load_dwordx2 v[150:151], v21, s[16:19], s82 offen
    buffer_load_dwordx2 v[152:153], v20, s[12:15], s82 offen offset:256
    buffer_load_dwordx2 v[154:155], v20, s[16:19], s82 offen offset:64
    v_perm_b32 v36, v86, v84, s83
    v_perm_b32 v86, v86, v84, s84
    v_perm_b32 v37, v87, v85, s83
    v_perm_b32 v87, v87, v85, s84
    v_perm_b32 v38, v90, v88, s83
    v_perm_b32 v90, v90, v88, s84
    v_perm_b32 v39, v91, v89, s83
    v_perm_b32 v91, v91, v89, s84
    v_perm_b32 v40, v94, v92, s83
    v_perm_b32 v94, v94, v92, s84
    v_perm_b32 v41, v95, v93, s83
    v_perm_b32 v95, v95, v93, s84
    v_mov_b64 v[84:85], v[36:37]
    v_mov_b64 v[88:89], v[38:39]
    v_mov_b64 v[92:93], v[40:41]
    s_nop 1
L_ncs1:
    v_dot2_f32_bf16 v36, v84, v48, 0
    v_dot2_f32_bf16 v37, v86, v49, 0
    v_dot2_f32_bf16 v38, v85, v50, 0
    v_dot2_f32_bf16 v39, v87, v51, 0
    v_dot2_f32_bf16 v40, v88, v52, 0
    v_dot2_f32_bf16 v41, v90, v53, 0
    v_dot2_f32_bf16 v42, v89, v54, 0
    v_dot2_f32_bf16 v43, v91, v55, 0
    v_dot2_f32_bf16 v44, v92, v56, 0
    v_dot2_f32_bf16 v45, v94, v57, 0
    v_dot2_f32_bf16 v46, v93, v58, 0
    v_dot2_f32_bf16 v47, v95, v59, 0
    s_add_u32 s79, s79, 12
    s_cmp_ge_i32 s80, s79
    s_cbranch_scc1 L_kr1g
L_kr1:
    ds_read_b32 v19, v7
    s_sleep 1
    s_waitcnt lgkmcnt(0)
    v_readlane_b32 s80, v19, 5
    s_nop 0
    s_cmp_lt_i32 s80, s79
    s_cbranch_scc1 L_kr1
L_kr1g:
    ds_read_b32 v11, v3 offset:128
    ds_read_b128 v[24:27], v2 offset:12288
    ds_read_b128 v[28:31], v2 offset:12544
    ds_read_b128 v[32:35], v2 offset:12800
    v_add_u32 v6, 1, v6
    ds_write_b32 v5, v6
    s_waitcnt lgkmcnt(3)
    v_and_b32 v12, 0xffff0000, v11
    v_cvt_f32_i32 v24, v24
    v_cvt_f32_i32 v25, v25
    v_cvt_f32_i32 v26, v26
    v_cvt_f32_i32 v27, v27
    v_pk_add_f32 v[24:25], v[24:25], v[12:13] op_sel:[0,0] op_sel_hi:[1,0] neg_lo:[0,1] neg_hi:[0,1]
    v_pk_add_f32 v[26:27], v[26:27], v[12:13] op_sel:[0,0] op_sel_hi:[1,0] neg_lo:[0,1] neg_hi:[0,1]
    v_pk_mul_f32 v[16:17], v[24:25], v[36:37]
    v_pk_fma_f32 v[16:17], v[26:27], v[38:39], v[16:17]
    s_waitcnt lgkmcnt(2)
    v_cvt_f32_i32 v28, v28
    v_cvt_f32_i32 v29, v29
    v_cvt_f32_i32 v30, v30
    v_cvt_f32_i32 v31, v31
    v_pk_add_f32 v[28:29], v[28:29], v[12:13] op_sel:[0,0] op_sel_hi:[1,0] neg_lo:[0,1] neg_hi:[0,1]
    v_pk_add_f32 v[30:31], v[30:31], v[12:13] op_sel:[0,0] op_sel_hi:[1,0] neg_lo:[0,1] neg_hi:[0,1]
    v_pk_fma_f32 v[16:17], v[28:29], v[40:41], v[16:17]
    v_pk_fma_f32 v[16:17], v[30:31], v[42:43], v[16:17]
    s_waitcnt lgkmcnt(1)
    v_cvt_f32_i32 v32, v32
    v_cvt_f32_i32 v33, v33
    v_cvt_f32_i32 v34, v34
    v_cvt_f32_i32 v35, v35
    v_pk_add_f32 v[32:33], v[32:33], v[12:13] op_sel:[0,0] op_sel_hi:[1,0] neg_lo:[0,1] neg_hi:[0,1]
    v_pk_add_f32 v[34:35], v[34:35], v[12:13] op_sel:[0,0] op_sel_hi:[1,0] neg_lo:[0,1] neg_hi:[0,1]
    v_pk_fma_f32 v[16:17], v[32:33], v[44:45], v[16:17]
    v_pk_fma_f32 v[16:17], v[34:35], v[46:47], v[16:17]
    v_add_f32 v16, v16, v17
    v_cndmask_b32 v23, v10, v11, s[86:87]
    v_lshlrev_b32 v23, 16, v23
    v_add_f32_dpp v18, v16, v16 row_ror:8 row_mask:0xf bank_mask:0xc
    v_mul_f32 v23, 0x3dd53b95, v23
    s_nop 0
    v_add_f32_dpp v18, v18, v18 row_half_mirror row_mask:0xf bank_mask:0xf
    s_nop 1
    v_add_f32_dpp v18, v18, v18 quad_perm:[2,3,0,1] row_mask:0xf bank_mask:0xf
    s_nop 1
    v_add_f32_dpp v18, v18, v18 quad_perm:[1,0,3,2] row_mask:0xf bank_mask:0xf
    v_mul_f32 v18, v23, v18
    ds_write_b32 v4, v18 offset:0
    s_cmp_lg_u32 s81, 0
    s_cbranch_scc1 L_ncs2
    v_perm_b32 v36, v98, v96, s83
    v_perm_b32 v98, v98, v96, s84
    v_perm_b32 v37, v99, v97, s83
    v_perm_b32 v99, v99, v97, s84
    v_perm_b32 v38, v102, v100, s83
    v_perm_b32 v102, v102, v100, s84
    v_perm_b32 v39, v103, v101, s83
    v_perm_b32 v103, v103, v101, s84
    v_perm_b32 v40, v106, v104, s83
    v_perm_b32 v106, v106, v104, s84
    v_perm_b32 v41, v107, v105, s83
    v_perm_b32 v107, v107, v105, s84
    v_mov_b64 v[96:97], v[36:37]
    v_mov_b64 v[100:101], v[38:39]
    v_mov_b64 v[104:105], v[40:41]
    s_nop 1
L_ncs2:
    v_dot2_f32_bf16 v36, v96, v48, 0
    v_dot2_f32_bf16 v37, v98, v49, 0
    v_dot2_f32_bf16 v38, v97, v50, 0
    v_dot2_f32_bf16 v39, v99, v51, 0
    v_dot2_f32_bf16 v40, v100, v52, 0
    v_dot2_f32_bf16 v41, v102, v53, 0
    v_dot2_f32_bf16 v42, v101, v54, 0
    v_dot2_f32_bf16 v43, v103, v55, 0
    v_dot2_f32_bf16 v44, v104, v56, 0
    v_dot2_f32_bf16 v45, v106, v57, 0
    v_dot2_f32_bf16 v46, v105, v58, 0
    v_dot2_f32_bf16 v47, v107, v59, 0
    s_add_u32 s79, s79, 12
    s_cmp_ge_i32 s80, s79
    s_cbranch_scc1 L_kr2g
L_kr2:
    ds_read_b32 v19, v7
    s_sleep 1
    s_waitcnt lgkmcnt(0)
    v_readlane_b32 s80, v19, 5
    s_nop 0
    s_cmp_lt_i32 s80, s79
    s_cbranch_scc1 L_kr2
L_kr2g:
    ds_read_b32 v10, v3 offset:256
    ds_read_b128 v[24:27], v2 offset:24576
    ds_read_b128 v[28:31], v2 offset:24832
    ds_read_b128 v[32:35], v2 offset:25088
    v_add_u32 v6, 1, v6
    ds_write_b32 v5, v6
    s_waitcnt lgkmcnt(3)
    v_and_b32 v12, 0xffff0000, v10
    v_cvt_f32_i32 v24, v24
    v_cvt_f32_i32 v25, v25
    v_cvt_f32_i32 v26, v26
    v_cvt_f32_i32 v27, v27
    v_pk_add_f32 v[24:25], v[24:25], v[12:13] op_sel:[0,0] op_sel_hi:[1,0] neg_lo:[0,1] neg_hi:[0,1]
    v_pk_add_f32 v[26:27], v[26:27], v[12:13] op_sel:[0,0] op_sel_hi:[1,0] neg_lo:[0,1] neg_hi:[0,1]
    v_pk_mul_f32 v[14:15], v[24:25], v[36:37]
    v_pk_fma_f32 v[14:15], v[26:27], v[38:39], v[14:15]
    s_waitcnt lgkmcnt(2)
    v_cvt_f32_i32 v28, v28
    v_cvt_f32_i32 v29, v29
    v_cvt_f32_i32 v30, v30
    v_cvt_f32_i32 v31, v31
    v_pk_add_f32 v[28:29], v[28:29], v[12:13] op_sel:[0,0] op_sel_hi:[1,0] neg_lo:[0,1] neg_hi:[0,1]
    v_pk_add_f32 v[30:31], v[30:31], v[12:13] op_sel:[0,0] op_sel_hi:[1,0] neg_lo:[0,1] neg_hi:[0,1]
    v_pk_fma_f32 v[14:15], v[28:29], v[40:41], v[14:15]
    v_pk_fma_f32 v[14:15], v[30:31], v[42:43], v[14:15]
    s_waitcnt lgkmcnt(1)
    v_cvt_f32_i32 v32, v32
    v_cvt_f32_i32 v33, v33
    v_cvt_f32_i32 v34, v34
    v_cvt_f32_i32 v35, v35
    v_pk_add_f32 v[32:33], v[32:33], v[12:13] op_sel:[0,0] op_sel_hi:[1,0] neg_lo:[0,1] neg_hi:[0,1]
    v_pk_add_f32 v[34:35], v[34:35], v[12:13] op_sel:[0,0] op_sel_hi:[1,0] neg_lo:[0,1] neg_hi:[0,1]
    v_pk_fma_f32 v[14:15], v[32:33], v[44:45], v[14:15]
    v_pk_fma_f32 v[14:15], v[34:35], v[46:47], v[14:15]
    v_add_f32 v14, v14, v15
    s_nop 1
    v_add_f32_dpp v18, v14, v14 row_ror:8 row_mask:0xf bank_mask:0x3
    s_cmp_lg_u32 s81, 0
    s_nop 0
    s_cbranch_scc1 L_ncs3
    s_mul_i32 s82, s89, 384
    s_add_u32 s89, s89, 2048
    s_and_b32 s89, s89, 16383
    buffer_load_dwordx2 v[156:157], v20, s[12:15], s82 offen offset:0
    buffer_load_dwordx2 v[158:159], v20, s[16:19], s82 offen offset:192
    buffer_load_dwordx2 v[160:161], v20, s[12:15], s82 offen offset:128
    buffer_load_dwordx2 v[162:163], v21, s[16:19], s82 offen
    buffer_load_dwordx2 v[164:165], v20, s[12:15], s82 offen offset:256
    buffer_load_dwordx2 v[166:167], v20, s[16:19], s82 offen offset:64
    v_perm_b32 v36, v110, v108, s83
    v_perm_b32 v110, v110, v108, s84
    v_perm_b32 v37, v111, v109, s83
    v_perm_b32 v111, v111, v109, s84
    v_perm_b32 v38, v114, v112, s83
    v_perm_b32 v114, v114, v112, s84
    v_perm_b32 v39, v115, v113, s83
    v_perm_b32 v115, v115, v113, s84
    v_perm_b32 v40, v118, v116, s83
    v_perm_b32 v118, v118, v116, s84
    v_perm_b32 v41, v119, v117, s83
    v_perm_b32 v119, v119, v117, s84
    v_mov_b64 v[108:109], v[36:37]
    v_mov_b64 v[112:113], v[38:39]
    v_mov_b64 v[116:117], v[40:41]
    s_nop 1
L_ncs3:
    v_dot2_f32_bf16 v36, v108, v48, 0
    v_dot2_f32_bf16 v37, v110, v49, 0
    v_dot2_f32_bf16 v38, v109, v50, 0
    v_dot2_f32_bf16 v39, v111, v51, 0
    v_dot2_f32_bf16 v40, v112, v52, 0
    v_dot2_f32_bf16 v41, v114, v53, 0
    v_dot2_f32_bf16 v42, v113, v54, 0
    v_dot2_f32_bf16 v43, v115, v55, 0
    v_dot2_f32_bf16 v44, v116, v56, 0
    v_dot2_f32_bf16 v45, v118, v57, 0
    v_dot2_f32_bf16 v46, v117, v58, 0
    v_dot2_f32_bf16 v47, v119, v59, 0
    s_add_u32 s79, s79, 12
    s_cmp_ge_i32 s80, s79
    s_cbranch_scc1 L_kr3g
L_kr3:
    ds_read_b32 v19, v7
    s_sleep 1
    s_waitcnt lgkmcnt(0)
    v_readlane_b32 s80, v19, 5
    s_nop 0
    s_cmp_lt_i32 s80, s79
    s_cbranch_scc1 L_kr3
L_kr3g:
    ds_read_b32 v11, v3 offset:384
    ds_read_b128 v[24:27], v2 offset:36864
    ds_read_b128 v[28:31], v2 offset:37120
    ds_read_b128 v[32:35], v2 offset:37376
    v_add_u32 v6, 1, v6
    ds_write_b32 v5, v6
    s_waitcnt lgkmcnt(3)
    v_and_b32 v12, 0xffff0000, v11
    v_cvt_f32_i32 v24, v24
    v_cvt_f32_i32 v25, v25
    v_cvt_f32_i32 v26, v26
    v_cvt_f32_i32 v27, v27
    v_pk_add_f32 v[24:25], v[24:25], v[12:13] op_sel:[0,0] op_sel_hi:[1,0] neg_lo:[0,1] neg_hi:[0,1]
    v_pk_add_f32 v[26:27], v[26:27], v[12:13] op_sel:[0,0] op_sel_hi:[1,0] neg_lo:[0,1] neg_hi:[0,1]
    v_pk_mul_f32 v[16:17], v[24:25], v[36:37]
    v_pk_fma_f32 v[16:17], v[26:27], v[38:39], v[16:17]
    s_waitcnt lgkmcnt(2)
    v_cvt_f32_i32 v28, v28
    v_cvt_f32_i32 v29, v29
    v_cvt_f32_i32 v30, v30
    v_cvt_f32_i32 v31, v31
    v_pk_add_f32 v[28:29], v[28:29], v[12:13] op_sel:[0,0] op_sel_hi:[1,0] neg_lo:[0,1] neg_hi:[0,1]
    v_pk_add_f32 v[30:31], v[30:31], v[12:13] op_sel:[0,0] op_sel_hi:[1,0] neg_lo:[0,1] neg_hi:[0,1]
    v_pk_fma_f32 v[16:17], v[28:29], v[40:41], v[16:17]
    v_pk_fma_f32 v[16:17], v[30:31], v[42:43], v[16:17]
    s_waitcnt lgkmcnt(1)
    v_cvt_f32_i32 v32, v32
    v_cvt_f32_i32 v33, v33
    v_cvt_f32_i32 v34, v34
    v_cvt_f32_i32 v35, v35
    v_pk_add_f32 v[32:33], v[32:33], v[12:13] op_sel:[0,0] op_sel_hi:[1,0] neg_lo:[0,1] neg_hi:[0,1]
    v_pk_add_f32 v[34:35], v[34:35], v[12:13] op_sel:[0,0] op_sel_hi:[1,0] neg_lo:[0,1] neg_hi:[0,1]
    v_pk_fma_f32 v[16:17], v[32:33], v[44:45], v[16:17]
    v_pk_fma_f32 v[16:17], v[34:35], v[46:47], v[16:17]
    v_add_f32 v16, v16, v17
    v_cndmask_b32 v23, v10, v11, s[86:87]
    v_lshlrev_b32 v23, 16, v23
    v_add_f32_dpp v18, v16, v16 row_ror:8 row_mask:0xf bank_mask:0xc
    v_mul_f32 v23, 0x3dd53b95, v23
    s_nop 0
    v_add_f32_dpp v18, v18, v18 row_half_mirror row_mask:0xf bank_mask:0xf
    s_nop 1
    v_add_f32_dpp v18, v18, v18 quad_perm:[2,3,0,1] row_mask:0xf bank_mask:0xf
    s_nop 1
    v_add_f32_dpp v18, v18, v18 quad_perm:[1,0,3,2] row_mask:0xf bank_mask:0xf
    v_mul_f32 v18, v23, v18
    ds_write_b32 v4, v18 offset:256
    s_cmp_lg_u32 s81, 0
    s_cbranch_scc1 L_ncs4
    s_waitcnt vmcnt(18)
    v_perm_b32 v36, v122, v120, s83
    v_perm_b32 v122, v122, v120, s84
    v_perm_b32 v37, v123, v121, s83
    v_perm_b32 v123, v123, v121, s84
    v_perm_b32 v38, v126, v124, s83
    v_perm_b32 v126, v126, v124, s84
    v_perm_b32 v39, v127, v125, s83
    v_perm_b32 v127, v127, v125, s84
    v_perm_b32 v40, v130, v128, s83
    v_perm_b32 v130, v130, v128, s84
    v_perm_b32 v41, v131, v129, s83
    v_perm_b32 v131, v131, v129, s84
    v_mov_b64 v[120:121], v[36:37]
    v_mov_b64 v[124:125], v[38:39]
    v_mov_b64 v[128:129], v[40:41]
    s_nop 1
L_ncs4:
    v_dot2_f32_bf16 v36, v120, v48, 0
    v_dot2_f32_bf16 v37, v122, v49, 0
    v_dot2_f32_bf16 v38, v121, v50, 0
    v_dot2_f32_bf16 v39, v123, v51, 0
    v_dot2_f32_bf16 v40, v124, v52, 0
    v_dot2_f32_bf16 v41, v126, v53, 0
    v_dot2_f32_bf16 v42, v125, v54, 0
    v_dot2_f32_bf16 v43, v127, v55, 0
    v_dot2_f32_bf16 v44, v128, v56, 0
    v_dot2_f32_bf16 v45, v130, v57, 0
    v_dot2_f32_bf16 v46, v129, v58, 0
    v_dot2_f32_bf16 v47, v131, v59, 0
    s_add_u32 s79, s79, 12
    s_cmp_ge_i32 s80, s79
    s_cbranch_scc1 L_kr4g
L_kr4:
    ds_read_b32 v19, v7
    s_sleep 1
    s_waitcnt lgkmcnt(0)
    v_readlane_b32 s80, v19, 5
    s_nop 0
    s_cmp_lt_i32 s80, s79
    s_cbranch_scc1 L_kr4
L_kr4g:
    ds_read_b32 v10, v3 offset:512
    ds_read_b128 v[24:27], v2 offset:0
    ds_read_b128 v[28:31], v2 offset:256
    ds_read_b128 v[32:35], v2 offset:512
    v_add_u32 v6, 1, v6
    ds_write_b32 v5, v6
    s_waitcnt lgkmcnt(3)
    v_and_b32 v12, 0xffff0000, v10
    v_cvt_f32_i32 v24, v24
    v_cvt_f32_i32 v25, v25
    v_cvt_f32_i32 v26, v26
    v_cvt_f32_i32 v27, v27
    v_pk_add_f32 v[24:25], v[24:25], v[12:13] op_sel:[0,0] op_sel_hi:[1,0] neg_lo:[0,1] neg_hi:[0,1]
    v_pk_add_f32 v[26:27], v[26:27], v[12:13] op_sel:[0,0] op_sel_hi:[1,0] neg_lo:[0,1] neg_hi:[0,1]
    v_pk_mul_f32 v[14:15], v[24:25], v[36:37]
    v_pk_fma_f32 v[14:15], v[26:27], v[38:39], v[14:15]
    s_waitcnt lgkmcnt(2)
    v_cvt_f32_i32 v28, v28
    v_cvt_f32_i32 v29, v29
    v_cvt_f32_i32 v30, v30
    v_cvt_f32_i32 v31, v31
    v_pk_add_f32 v[28:29], v[28:29], v[12:13] op_sel:[0,0] op_sel_hi:[1,0] neg_lo:[0,1] neg_hi:[0,1]
    v_pk_add_f32 v[30:31], v[30:31], v[12:13] op_sel:[0,0] op_sel_hi:[1,0] neg_lo:[0,1] neg_hi:[0,1]
    v_pk_fma_f32 v[14:15], v[28:29], v[40:41], v[14:15]
    v_pk_fma_f32 v[14:15], v[30:31], v[42:43], v[14:15]
    s_waitcnt lgkmcnt(1)
    v_cvt_f32_i32 v32, v32
    v_cvt_f32_i32 v33, v33
    v_cvt_f32_i32 v34, v34
    v_cvt_f32_i32 v35, v35
    v_pk_add_f32 v[32:33], v[32:33], v[12:13] op_sel:[0,0] op_sel_hi:[1,0] neg_lo:[0,1] neg_hi:[0,1]
    v_pk_add_f32 v[34:35], v[34:35], v[12:13] op_sel:[0,0] op_sel_hi:[1,0] neg_lo:[0,1] neg_hi:[0,1]
    v_pk_fma_f32 v[14:15], v[32:33], v[44:45], v[14:15]
    v_pk_fma_f32 v[14:15], v[34:35], v[46:47], v[14:15]
    v_add_f32 v14, v14, v15
    s_nop 1
    v_add_f32_dpp v18, v14, v14 row_ror:8 row_mask:0xf bank_mask:0x3
    s_cmp_lg_u32 s81, 0
    s_nop 0
    s_cbranch_scc1 L_ncs5
    s_waitcnt vmcnt(12)
    v_perm_b32 v36, v134, v132, s83
    v_perm_b32 v134, v134, v132, s84
    v_perm_b32 v37, v135, v133, s83
    v_perm_b32 v135, v135, v133, s84
    v_perm_b32 v38, v138, v136, s83
    v_perm_b32 v138, v138, v136, s84
    v_perm_b32 v39, v139, v137, s83
    v_perm_b32 v139, v139, v137, s84
    v_perm_b32 v40, v142, v140, s83
    v_perm_b32 v142, v142, v140, s84
    v_perm_b32 v41, v143, v141, s83
    v_perm_b32 v143, v143, v141, s84
    v_mov_b64 v[132:133], v[36:37]
    v_mov_b64 v[136:137], v[38:39]
    v_mov_b64 v[140:141], v[40:41]
    s_nop 1
L_ncs5:
    v_dot2_f32_bf16 v36, v132, v48, 0
    v_dot2_f32_bf16 v37, v134, v49, 0
    v_dot2_f32_bf16 v38, v133, v50, 0
    v_dot2_f32_bf16 v39, v135, v51, 0
    v_dot2_f32_bf16 v40, v136, v52, 0
    v_dot2_f32_bf16 v41, v138, v53, 0
    v_dot2_f32_bf16 v42, v137, v54, 0
    v_dot2_f32_bf16 v43, v139, v55, 0
    v_dot2_f32_bf16 v44, v140, v56, 0
    v_dot2_f32_bf16 v45, v142, v57, 0
    v_dot2_f32_bf16 v46, v141, v58, 0
    v_dot2_f32_bf16 v47, v143, v59, 0
    s_add_u32 s79, s79, 12
    s_cmp_ge_i32 s80, s79
    s_cbranch_scc1 L_kr5g
L_kr5:
    ds_read_b32 v19, v7
    s_sleep 1
    s_waitcnt lgkmcnt(0)
    v_readlane_b32 s80, v19, 5
    s_nop 0
    s_cmp_lt_i32 s80, s79
    s_cbranch_scc1 L_kr5
L_kr5g:
    ds_read_b32 v11, v3 offset:640
    ds_read_b128 v[24:27], v2 offset:12288
    ds_read_b128 v[28:31], v2 offset:12544
    ds_read_b128 v[32:35], v2 offset:12800
    v_add_u32 v6, 1, v6
    ds_write_b32 v5, v6
    s_waitcnt lgkmcnt(3)
    v_and_b32 v12, 0xffff0000, v11
    v_cvt_f32_i32 v24, v24
    v_cvt_f32_i32 v25, v25
    v_cvt_f32_i32 v26, v26
    v_cvt_f32_i32 v27, v27
    v_pk_add_f32 v[24:25], v[24:25], v[12:13] op_sel:[0,0] op_sel_hi:[1,0] neg_lo:[0,1] neg_hi:[0,1]
    v_pk_add_f32 v[26:27], v[26:27], v[12:13] op_sel:[0,0] op_sel_hi:[1,0] neg_lo:[0,1] neg_hi:[0,1]
    v_pk_mul_f32 v[16:17], v[24:25], v[36:37]
    v_pk_fma_f32 v[16:17], v[26:27], v[38:39], v[16:17]
    s_waitcnt lgkmcnt(2)
    v_cvt_f32_i32 v28, v28
    v_cvt_f32_i32 v29, v29
    v_cvt_f32_i32 v30, v30
    v_cvt_f32_i32 v31, v31
    v_pk_add_f32 v[28:29], v[28:29], v[12:13] op_sel:[0,0] op_sel_hi:[1,0] neg_lo:[0,1] neg_hi:[0,1]
    v_pk_add_f32 v[30:31], v[30:31], v[12:13] op_sel:[0,0] op_sel_hi:[1,0] neg_lo:[0,1] neg_hi:[0,1]
    v_pk_fma_f32 v[16:17], v[28:29], v[40:41], v[16:17]
    v_pk_fma_f32 v[16:17], v[30:31], v[42:43], v[16:17]
    s_waitcnt lgkmcnt(1)
    v_cvt_f32_i32 v32, v32
    v_cvt_f32_i32 v33, v33
    v_cvt_f32_i32 v34, v34
    v_cvt_f32_i32 v35, v35
    v_pk_add_f32 v[32:33], v[32:33], v[12:13] op_sel:[0,0] op_sel_hi:[1,0] neg_lo:[0,1] neg_hi:[0,1]
    v_pk_add_f32 v[34:35], v[34:35], v[12:13] op_sel:[0,0] op_sel_hi:[1,0] neg_lo:[0,1] neg_hi:[0,1]
    v_pk_fma_f32 v[16:17], v[32:33], v[44:45], v[16:17]
    v_pk_fma_f32 v[16:17], v[34:35], v[46:47], v[16:17]
    v_add_f32 v16, v16, v17
    v_cndmask_b32 v23, v10, v11, s[86:87]
    v_lshlrev_b32 v23, 16, v23
    v_add_f32_dpp v18, v16, v16 row_ror:8 row_mask:0xf bank_mask:0xc
    v_mul_f32 v23, 0x3dd53b95, v23
    s_nop 0
    v_add_f32_dpp v18, v18, v18 row_half_mirror row_mask:0xf bank_mask:0xf
    s_nop 1
    v_add_f32_dpp v18, v18, v18 quad_perm:[2,3,0,1] row_mask:0xf bank_mask:0xf
    s_nop 1
    v_add_f32_dpp v18, v18, v18 quad_perm:[1,0,3,2] row_mask:0xf bank_mask:0xf
    v_mul_f32 v18, v23, v18
    ds_write_b32 v4, v18 offset:512
    s_cmp_lg_u32 s81, 0
    s_cbranch_scc1 L_ncs6
    s_waitcnt vmcnt(6)
    v_perm_b32 v36, v146, v144, s83
    v_perm_b32 v146, v146, v144, s84
    v_perm_b32 v37, v147, v145, s83
    v_perm_b32 v147, v147, v145, s84
    v_perm_b32 v38, v150, v148, s83
    v_perm_b32 v150, v150, v148, s84
    v_perm_b32 v39, v151, v149, s83
    v_perm_b32 v151, v151, v149, s84
    v_perm_b32 v40, v154, v152, s83
    v_perm_b32 v154, v154, v152, s84
    v_perm_b32 v41, v155, v153, s83
    v_perm_b32 v155, v155, v153, s84
    v_mov_b64 v[144:145], v[36:37]
    v_mov_b64 v[148:149], v[38:39]
    v_mov_b64 v[152:153], v[40:41]
    s_nop 1
L_ncs6:
    v_dot2_f32_bf16 v36, v144, v48, 0
    v_dot2_f32_bf16 v37, v146, v49, 0
    v_dot2_f32_bf16 v38, v145, v50, 0
    v_dot2_f32_bf16 v39, v147, v51, 0
    v_dot2_f32_bf16 v40, v148, v52, 0
    v_dot2_f32_bf16 v41, v150, v53, 0
    v_dot2_f32_bf16 v42, v149, v54, 0
    v_dot2_f32_bf16 v43, v151, v55, 0
    v_dot2_f32_bf16 v44, v152, v56, 0
    v_dot2_f32_bf16 v45, v154, v57, 0
    v_dot2_f32_bf16 v46, v153, v58, 0
    v_dot2_f32_bf16 v47, v155, v59, 0
    s_add_u32 s79, s79, 12
    s_cmp_ge_i32 s80, s79
    s_cbranch_scc1 L_kr6g
L_kr6:
    ds_read_b32 v19, v7
    s_sleep 1
    s_waitcnt lgkmcnt(0)
    v_readlane_b32 s80, v19, 5
    s_nop 0
    s_cmp_lt_i32 s80, s79
    s_cbranch_scc1 L_kr6
L_kr6g:
    ds_read_b32 v10, v3 offset:768
    ds_read_b128 v[24:27], v2 offset:24576
    ds_read_b128 v[28:31], v2 offset:24832
    ds_read_b128 v[32:35], v2 offset:25088
    v_add_u32 v6, 1, v6
    ds_write_b32 v5, v6
    s_waitcnt lgkmcnt(3)
    v_and_b32 v12, 0xffff0000, v10
    v_cvt_f32_i32 v24, v24
    v_cvt_f32_i32 v25, v25
    v_cvt_f32_i32 v26, v26
    v_cvt_f32_i32 v27, v27
    v_pk_add_f32 v[24:25], v[24:25], v[12:13] op_sel:[0,0] op_sel_hi:[1,0] neg_lo:[0,1] neg_hi:[0,1]
    v_pk_add_f32 v[26:27], v[26:27], v[12:13] op_sel:[0,0] op_sel_hi:[1,0] neg_lo:[0,1] neg_hi:[0,1]
    v_pk_mul_f32 v[14:15], v[24:25], v[36:37]
    v_pk_fma_f32 v[14:15], v[26:27], v[38:39], v[14:15]
    s_waitcnt lgkmcnt(2)
    v_cvt_f32_i32 v28, v28
    v_cvt_f32_i32 v29, v29
    v_cvt_f32_i32 v30, v30
    v_cvt_f32_i32 v31, v31
    v_pk_add_f32 v[28:29], v[28:29], v[12:13] op_sel:[0,0] op_sel_hi:[1,0] neg_lo:[0,1] neg_hi:[0,1]
    v_pk_add_f32 v[30:31], v[30:31], v[12:13] op_sel:[0,0] op_sel_hi:[1,0] neg_lo:[0,1] neg_hi:[0,1]
    v_pk_fma_f32 v[14:15], v[28:29], v[40:41], v[14:15]
    v_pk_fma_f32 v[14:15], v[30:31], v[42:43], v[14:15]
    s_waitcnt lgkmcnt(1)
    v_cvt_f32_i32 v32, v32
    v_cvt_f32_i32 v33, v33
    v_cvt_f32_i32 v34, v34
    v_cvt_f32_i32 v35, v35
    v_pk_add_f32 v[32:33], v[32:33], v[12:13] op_sel:[0,0] op_sel_hi:[1,0] neg_lo:[0,1] neg_hi:[0,1]
    v_pk_add_f32 v[34:35], v[34:35], v[12:13] op_sel:[0,0] op_sel_hi:[1,0] neg_lo:[0,1] neg_hi:[0,1]
    v_pk_fma_f32 v[14:15], v[32:33], v[44:45], v[14:15]
    v_pk_fma_f32 v[14:15], v[34:35], v[46:47], v[14:15]
    v_add_f32 v14, v14, v15
    s_nop 1
    v_add_f32_dpp v18, v14, v14 row_ror:8 row_mask:0xf bank_mask:0x3
    s_cmp_lg_u32 s81, 0
    s_nop 0
    s_cbranch_scc1 L_ncs7
    s_waitcnt vmcnt(0)
    v_perm_b32 v36, v158, v156, s83
    v_perm_b32 v158, v158, v156, s84
    v_perm_b32 v37, v159, v157, s83
    v_perm_b32 v159, v159, v157, s84
    v_perm_b32 v38, v162, v160, s83
    v_perm_b32 v162, v162, v160, s84
    v_perm_b32 v39, v163, v161, s83
    v_perm_b32 v163, v163, v161, s84
    v_perm_b32 v40, v166, v164, s83
    v_perm_b32 v166, v166, v164, s84
    v_perm_b32 v41, v167, v165, s83
    v_perm_b32 v167, v167, v165, s84
    v_mov_b64 v[156:157], v[36:37]
    v_mov_b64 v[160:161], v[38:39]
    v_mov_b64 v[164:165], v[40:41]
    s_nop 1
L_ncs7:
    v_dot2_f32_bf16 v36, v156, v48, 0
    v_dot2_f32_bf16 v37, v158, v49, 0
    v_dot2_f32_bf16 v38, v157, v50, 0
    v_dot2_f32_bf16 v39, v159, v51, 0
    v_dot2_f32_bf16 v40, v160, v52, 0
    v_dot2_f32_bf16 v41, v162, v53, 0
    v_dot2_f32_bf16 v42, v161, v54, 0
    v_dot2_f32_bf16 v43, v163, v55, 0
    v_dot2_f32_bf16 v44, v164, v56, 0
    v_dot2_f32_bf16 v45, v166, v57, 0
    v_dot2_f32_bf16 v46, v165, v58, 0
    v_dot2_f32_bf16 v47, v167, v59, 0
    s_add_u32 s79, s79, 12
    s_cmp_ge_i32 s80, s79
    s_cbranch_scc1 L_kr7g
L_kr7:
    ds_read_b32 v19, v7
    s_sleep 1
    s_waitcnt lgkmcnt(0)
    v_readlane_b32 s80, v19, 5
    s_nop 0
    s_cmp_lt_i32 s80, s79
    s_cbranch_scc1 L_kr7
L_kr7g:
    ds_read_b32 v11, v3 offset:896
    ds_read_b128 v[24:27], v2 offset:36864
    ds_read_b128 v[28:31], v2 offset:37120
    ds_read_b128 v[32:35], v2 offset:37376
    v_add_u32 v6, 1, v6
    ds_write_b32 v5, v6
    s_waitcnt lgkmcnt(3)
    v_and_b32 v12, 0xffff0000, v11
    v_cvt_f32_i32 v24, v24
    v_cvt_f32_i32 v25, v25
    v_cvt_f32_i32 v26, v26
    v_cvt_f32_i32 v27, v27
    v_pk_add_f32 v[24:25], v[24:25], v[12:13] op_sel:[0,0] op_sel_hi:[1,0] neg_lo:[0,1] neg_hi:[0,1]
    v_pk_add_f32 v[26:27], v[26:27], v[12:13] op_sel:[0,0] op_sel_hi:[1,0] neg_lo:[0,1] neg_hi:[0,1]
    v_pk_mul_f32 v[16:17], v[24:25], v[36:37]
    v_pk_fma_f32 v[16:17], v[26:27], v[38:39], v[16:17]
    s_waitcnt lgkmcnt(2)
    v_cvt_f32_i32 v28, v28
    v_cvt_f32_i32 v29, v29
    v_cvt_f32_i32 v30, v30
    v_cvt_f32_i32 v31, v31
    v_pk_add_f32 v[28:29], v[28:29], v[12:13] op_sel:[0,0] op_sel_hi:[1,0] neg_lo:[0,1] neg_hi:[0,1]
    v_pk_add_f32 v[30:31], v[30:31], v[12:13] op_sel:[0,0] op_sel_hi:[1,0] neg_lo:[0,1] neg_hi:[0,1]
    v_pk_fma_f32 v[16:17], v[28:29], v[40:41], v[16:17]
    v_pk_fma_f32 v[16:17], v[30:31], v[42:43], v[16:17]
    s_waitcnt lgkmcnt(1)
    v_cvt_f32_i32 v32, v32
    v_cvt_f32_i32 v33, v33
    v_cvt_f32_i32 v34, v34
    v_cvt_f32_i32 v35, v35
    v_pk_add_f32 v[32:33], v[32:33], v[12:13] op_sel:[0,0] op_sel_hi:[1,0] neg_lo:[0,1] neg_hi:[0,1]
    v_pk_add_f32 v[34:35], v[34:35], v[12:13] op_sel:[0,0] op_sel_hi:[1,0] neg_lo:[0,1] neg_hi:[0,1]
    v_pk_fma_f32 v[16:17], v[32:33], v[44:45], v[16:17]
    v_pk_fma_f32 v[16:17], v[34:35], v[46:47], v[16:17]
    v_add_f32 v16, v16, v17
    v_cndmask_b32 v23, v10, v11, s[86:87]
    v_lshlrev_b32 v23, 16, v23
    v_add_f32_dpp v18, v16, v16 row_ror:8 row_mask:0xf bank_mask:0xc
    v_mul_f32 v23, 0x3dd53b95, v23
    s_nop 0
    v_add_f32_dpp v18, v18, v18 row_half_mirror row_mask:0xf bank_mask:0xf
    s_nop 1
    v_add_f32_dpp v18, v18, v18 quad_perm:[2,3,0,1] row_mask:0xf bank_mask:0xf
    s_nop 1
    v_add_f32_dpp v18, v18, v18 quad_perm:[1,0,3,2] row_mask:0xf bank_mask:0xf
    v_mul_f32 v18, v23, v18
    ds_write_b32 v4, v18 offset:768
    s_mov_b64 exec, 1
    ds_add_u32 v22, v8
    s_mov_b64 exec, -1
    v_add_u32 v3, 1024, v3
    v_add_u32 v4, 1024, v4
    s_add_u32 s81, s81, 1
    s_cmp_lt_u32 s81, 16
    s_cbranch_scc1 L_kph
    v_subrev_u32 v3, 512, v3
    s_mul_i32 s92, s78, 768
    s_add_u32 s92, s92, 65536
    v_and_b32 v18, 15, v1
    v_lshl_add_u32 v9, v18, 4, s92
    v_lshrrev_b32 v18, 4, v1
    v_lshl_add_u32 v9, v18, 2, v9
    v_mov_b32 v22, 77920
    s_mov_b64 s[20:21], s[74:75]
    s_mov_b32 s22, 1610612736
    s_mov_b32 s23, 0x20000
    s_mov_b64 s[28:29], s[70:71]
    s_mov_b32 s30, 12288
    s_mov_b32 s31, 0x20000
    s_lshr_b32 s93, s2, 3
    s_mul_i32 s92, s93, 43
    s_lshr_b32 s92, s92, 8
    s_mul_i32 s94, s92, 6
    s_sub_u32 s93, s93, s94
    s_and_b32 s94, s2, 6
    s_lshl1_add_u32 s92, s94, s92
    s_and_b32 s94, s2, 1
    s_lshl1_add_u32 s92, s92, s94
    s_lshl2_add_u32 s94, s92, s78
    s_mul_i32 s32, s94, 24576
    s_lshl_b32 s94, s93, 7
    s_add_u32 s32, s32, s94
    s_add_u32 s33, s32, 6144
    s_add_u32 s34, s33, 6144
    s_add_u32 s35, s34, 6144
    s_mul_i32 s36, s92, 6
    s_add_u32 s36, s36, s93
    s_lshl_b32 s36, s36, 6
    s_lshr_b32 s37, s92, 1
    s_sub_u32 s37, s37, 1
    s_and_b32 s37, s37, 15
    s_add_u32 s37, s37, 2
    s_min_u32 s37, s37, 16
    v_lshrrev_b32 v19, 3, v1
    v_and_b32 v69, 7, v1
    v_mul_u32_u24 v68, 768, v19
    v_lshl_add_u32 v68, v69, 4, v68
    v_lshlrev_b32 v69, 3, v69
    v_lshl_add_u32 v69, v18, 1, v69
    s_lshl4_add_u32 s92, s78, 78336
    v_lshl_add_u32 v70, v19, 6, s92
    s_lshl_b32 s92, s78, 8
    s_add_u32 s92, s92, 1024
    v_add_u32 v4, s92, v7
    s_mov_b32 s81, 0
    s_nop 0
L_vph:
    v_mov_b64 v[72:73], 0
    v_mov_b64 v[74:75], 0
    v_mov_b64 v[76:77], 0
    v_mov_b64 v[78:79], 0
    v_mov_b64 v[80:81], 0
    v_mov_b64 v[82:83], 0
    s_and_b32 s92, s81, 3
    s_mul_i32 s92, s92, 3072
    v_add_u32 v71, s92, v9
    s_mov_b32 s88, 0
    s_nop 0
L_vw:
    ds_read_b32 v19, v7
    s_waitcnt lgkmcnt(0)
    v_readlane_b32 s92, v19, 15
    v_readlane_b32 s93, v19, 13
    s_nop 0
    s_and_b32 s93, s93, 16
    s_add_u32 s92, s92, 4
    s_min_u32 s93, s93, s92
    s_cmp_le_u32 s93, s81
    s_cbranch_scc1 L_vw
    s_cmp_lg_u32 s81, 15
    s_cbranch_scc1 L_vit
    v_readlane_b32 s4, v19, 6
    s_cmp_ge_u32 s2, 192
    s_nop 3
    s_cbranch_scc1 L_vit
    s_cmp_eq_u32 s4, 0
    s_cbranch_scc1 L_vw
    ds_read_b128 v[64:67], v70
    s_bfe_u32 s5, s4, 0x80008
    s_bfe_u32 s6, s4, 0x80010
    s_lshr_b32 s7, s4, 24
    s_and_b32 s4, s4, 0xff
L_vit:
    s_add_u32 s79, s79, 12
    s_cmp_ge_i32 s80, s79
    s_cbranch_scc1 L_vr0g
L_vr0:
    ds_read_b32 v19, v7
    s_waitcnt lgkmcnt(0)
    v_readlane_b32 s80, v19, 5
    s_nop 0
    s_cmp_lt_i32 s80, s79
    s_cbranch_scc1 L_vr0
L_vr0g:
    ds_read_b32 v10, v3 offset:384
    ds_read_b128 v[24:27], v2 offset:0
    ds_read_b128 v[28:31], v2 offset:256
    ds_read_b128 v[32:35], v2 offset:512
    v_add_u32 v6, 1, v6
    ds_write_b32 v5, v6
    s_waitcnt lgkmcnt(3)
    v_cvt_f32_i32 v24, v24
    v_cvt_f32_i32 v25, v25
    v_cvt_f32_i32 v26, v26
    v_cvt_f32_i32 v27, v27
    v_pk_fma_f32 v[72:73], v[24:25], v[10:11], v[72:73] op_sel:[0,0,0] op_sel_hi:[1,0,1]
    v_pk_fma_f32 v[74:75], v[26:27], v[10:11], v[74:75] op_sel:[0,0,0] op_sel_hi:[1,0,1]
    s_waitcnt lgkmcnt(2)
    v_cvt_f32_i32 v28, v28
    v_cvt_f32_i32 v29, v29
    v_cvt_f32_i32 v30, v30
    v_cvt_f32_i32 v31, v31
    v_pk_fma_f32 v[76:77], v[28:29], v[10:11], v[76:77] op_sel:[0,0,0] op_sel_hi:[1,0,1]
    v_pk_fma_f32 v[78:79], v[30:31], v[10:11], v[78:79] op_sel:[0,0,0] op_sel_hi:[1,0,1]
    s_waitcnt lgkmcnt(1)
    v_cvt_f32_i32 v32, v32
    v_cvt_f32_i32 v33, v33
    v_cvt_f32_i32 v34, v34
    v_cvt_f32_i32 v35, v35
    v_pk_fma_f32 v[80:81], v[32:33], v[10:11], v[80:81] op_sel:[0,0,0] op_sel_hi:[1,0,1]
    v_pk_fma_f32 v[82:83], v[34:35], v[10:11], v[82:83] op_sel:[0,0,0] op_sel_hi:[1,0,1]
    s_add_u32 s79, s79, 12
    s_cmp_ge_i32 s80, s79
    s_cbranch_scc1 L_vr1g
L_vr1:
    ds_read_b32 v19, v7
    s_waitcnt lgkmcnt(0)
    v_readlane_b32 s80, v19, 5
    s_nop 0
    s_cmp_lt_i32 s80, s79
    s_cbranch_scc1 L_vr1
L_vr1g:
    ds_read_b32 v10, v3 offset:256
    ds_read_b128 v[24:27], v2 offset:12288
    ds_read_b128 v[28:31], v2 offset:12544
    ds_read_b128 v[32:35], v2 offset:12800
    v_add_u32 v6, 1, v6
    ds_write_b32 v5, v6
    s_waitcnt lgkmcnt(3)
    v_cvt_f32_i32 v24, v24
    v_cvt_f32_i32 v25, v25
    v_cvt_f32_i32 v26, v26
    v_cvt_f32_i32 v27, v27
    v_pk_fma_f32 v[72:73], v[24:25], v[10:11], v[72:73] op_sel:[0,0,0] op_sel_hi:[1,0,1]
    v_pk_fma_f32 v[74:75], v[26:27], v[10:11], v[74:75] op_sel:[0,0,0] op_sel_hi:[1,0,1]
    s_waitcnt lgkmcnt(2)
    v_cvt_f32_i32 v28, v28
    v_cvt_f32_i32 v29, v29
    v_cvt_f32_i32 v30, v30
    v_cvt_f32_i32 v31, v31
    v_pk_fma_f32 v[76:77], v[28:29], v[10:11], v[76:77] op_sel:[0,0,0] op_sel_hi:[1,0,1]
    v_pk_fma_f32 v[78:79], v[30:31], v[10:11], v[78:79] op_sel:[0,0,0] op_sel_hi:[1,0,1]
    s_waitcnt lgkmcnt(1)
    v_cvt_f32_i32 v32, v32
    v_cvt_f32_i32 v33, v33
    v_cvt_f32_i32 v34, v34
    v_cvt_f32_i32 v35, v35
    v_pk_fma_f32 v[80:81], v[32:33], v[10:11], v[80:81] op_sel:[0,0,0] op_sel_hi:[1,0,1]
    v_pk_fma_f32 v[82:83], v[34:35], v[10:11], v[82:83] op_sel:[0,0,0] op_sel_hi:[1,0,1]
    s_add_u32 s79, s79, 12
    s_cmp_ge_i32 s80, s79
    s_cbranch_scc1 L_vr2g
L_vr2:
    ds_read_b32 v19, v7
    s_waitcnt lgkmcnt(0)
    v_readlane_b32 s80, v19, 5
    s_nop 0
    s_cmp_lt_i32 s80, s79
    s_cbranch_scc1 L_vr2
L_vr2g:
    ds_read_b32 v10, v3 offset:128
    ds_read_b128 v[24:27], v2 offset:24576
    ds_read_b128 v[28:31], v2 offset:24832
    ds_read_b128 v[32:35], v2 offset:25088
    v_add_u32 v6, 1, v6
    ds_write_b32 v5, v6
    s_waitcnt lgkmcnt(3)
    v_cvt_f32_i32 v24, v24
    v_cvt_f32_i32 v25, v25
    v_cvt_f32_i32 v26, v26
    v_cvt_f32_i32 v27, v27
    v_pk_fma_f32 v[72:73], v[24:25], v[10:11], v[72:73] op_sel:[0,0,0] op_sel_hi:[1,0,1]
    v_pk_fma_f32 v[74:75], v[26:27], v[10:11], v[74:75] op_sel:[0,0,0] op_sel_hi:[1,0,1]
    s_waitcnt lgkmcnt(2)
    v_cvt_f32_i32 v28, v28
    v_cvt_f32_i32 v29, v29
    v_cvt_f32_i32 v30, v30
    v_cvt_f32_i32 v31, v31
    v_pk_fma_f32 v[76:77], v[28:29], v[10:11], v[76:77] op_sel:[0,0,0] op_sel_hi:[1,0,1]
    v_pk_fma_f32 v[78:79], v[30:31], v[10:11], v[78:79] op_sel:[0,0,0] op_sel_hi:[1,0,1]
    s_waitcnt lgkmcnt(1)
    v_cvt_f32_i32 v32, v32
    v_cvt_f32_i32 v33, v33
    v_cvt_f32_i32 v34, v34
    v_cvt_f32_i32 v35, v35
    v_pk_fma_f32 v[80:81], v[32:33], v[10:11], v[80:81] op_sel:[0,0,0] op_sel_hi:[1,0,1]
    v_pk_fma_f32 v[82:83], v[34:35], v[10:11], v[82:83] op_sel:[0,0,0] op_sel_hi:[1,0,1]
    s_add_u32 s79, s79, 12
    s_cmp_ge_i32 s80, s79
    s_cbranch_scc1 L_vr3g
L_vr3:
    ds_read_b32 v19, v7
    s_waitcnt lgkmcnt(0)
    v_readlane_b32 s80, v19, 5
    s_nop 0
    s_cmp_lt_i32 s80, s79
    s_cbranch_scc1 L_vr3
L_vr3g:
    ds_read_b32 v10, v3 offset:0
    ds_read_b128 v[24:27], v2 offset:36864
    ds_read_b128 v[28:31], v2 offset:37120
    ds_read_b128 v[32:35], v2 offset:37376
    v_add_u32 v6, 1, v6
    ds_write_b32 v5, v6
    v_subrev_u32 v3, 512, v3
    s_add_u32 s88, s88, 1
    s_cmp_lt_u32 s88, 2
    s_waitcnt lgkmcnt(3)
    v_cvt_f32_i32 v24, v24
    v_cvt_f32_i32 v25, v25
    v_cvt_f32_i32 v26, v26
    v_cvt_f32_i32 v27, v27
    v_pk_fma_f32 v[72:73], v[24:25], v[10:11], v[72:73] op_sel:[0,0,0] op_sel_hi:[1,0,1]
    v_pk_fma_f32 v[74:75], v[26:27], v[10:11], v[74:75] op_sel:[0,0,0] op_sel_hi:[1,0,1]
    s_waitcnt lgkmcnt(2)
    v_cvt_f32_i32 v28, v28
    v_cvt_f32_i32 v29, v29
    v_cvt_f32_i32 v30, v30
    v_cvt_f32_i32 v31, v31
    v_pk_fma_f32 v[76:77], v[28:29], v[10:11], v[76:77] op_sel:[0,0,0] op_sel_hi:[1,0,1]
    v_pk_fma_f32 v[78:79], v[30:31], v[10:11], v[78:79] op_sel:[0,0,0] op_sel_hi:[1,0,1]
    s_waitcnt lgkmcnt(1)
    v_cvt_f32_i32 v32, v32
    v_cvt_f32_i32 v33, v33
    v_cvt_f32_i32 v34, v34
    v_cvt_f32_i32 v35, v35
    v_pk_fma_f32 v[80:81], v[32:33], v[10:11], v[80:81] op_sel:[0,0,0] op_sel_hi:[1,0,1]
    v_pk_fma_f32 v[82:83], v[34:35], v[10:11], v[82:83] op_sel:[0,0,0] op_sel_hi:[1,0,1]
    s_cbranch_scc1 L_vit
    v_permlane32_swap_b32 v72, v74
    v_permlane32_swap_b32 v73, v75
    v_permlane32_swap_b32 v76, v78
    v_permlane32_swap_b32 v77, v79
    v_permlane32_swap_b32 v80, v82
    v_permlane32_swap_b32 v81, v83
    v_pk_add_f32 v[72:73], v[72:73], v[74:75]
    v_pk_add_f32 v[76:77], v[76:77], v[78:79]
    v_pk_add_f32 v[80:81], v[80:81], v[82:83]
    v_permlane16_swap_b32 v72, v73
    v_permlane16_swap_b32 v76, v77
    v_permlane16_swap_b32 v80, v81
    v_add_f32 v36, v72, v73
    v_add_f32 v37, v76, v77
    v_add_f32 v38, v80, v81
    ds_write2st64_b32 v71, v36, v37 offset0:0 offset1:1
    ds_write_b32 v71, v38 offset:512
    s_mov_b64 exec, 1
    ds_add_u32 v22, v8
    s_mov_b64 exec, -1
    v_add_u32 v22, 4, v22
    s_add_u32 s81, s81, 1
    s_cmp_lt_u32 s81, 16
    s_cbranch_scc1 L_vph
    s_cmp_ge_u32 s2, 192
    s_cbranch_scc1 L_cend
L_gw:
    ds_read_b32 v19, v7
    s_waitcnt lgkmcnt(0)
    v_readlane_b32 s92, v19, 8
    s_nop 0
    s_cmp_lt_u32 s92, s37
    s_nop 2
    s_cbranch_scc1 L_gw
L_try:
    buffer_load_dwordx4 v[48:51], v68, s[20:23], s32 offen sc0 sc1
    buffer_load_dwordx4 v[52:55], v68, s[20:23], s33 offen sc0 sc1
    buffer_load_dwordx4 v[56:59], v68, s[20:23], s34 offen sc0 sc1
    buffer_load_dwordx4 v[60:63], v68, s[20:23], s35 offen sc0 sc1
    s_waitcnt vmcnt(3)
    v_xor_b32 v48, s4, v48
    v_xor_b32 v49, s5, v49
    v_xor_b32 v50, s6, v50
    v_xor_b32 v51, s7, v51
    v_or_b32 v23, v48, v49
    v_pk_mul_f32 v[14:15], v[48:49], v[64:65] op_sel:[0,0] op_sel_hi:[1,0]
    v_or3_b32 v23, v23, v50, v51
    v_pk_mul_f32 v[16:17], v[50:51], v[64:65] op_sel:[0,0] op_sel_hi:[1,0]
    s_waitcnt vmcnt(2)
    v_xor_b32 v52, s4, v52
    v_xor_b32 v53, s5, v53
    v_xor_b32 v54, s6, v54
    v_xor_b32 v55, s7, v55
    v_or3_b32 v23, v23, v52, v53
    v_pk_fma_f32 v[14:15], v[52:53], v[64:65], v[14:15] op_sel:[0,1,0] op_sel_hi:[1,1,1]
    v_or3_b32 v23, v23, v54, v55
    v_pk_fma_f32 v[16:17], v[54:55], v[64:65], v[16:17] op_sel:[0,1,0] op_sel_hi:[1,1,1]
    s_waitcnt vmcnt(1)
    v_xor_b32 v56, s4, v56
    v_xor_b32 v57, s5, v57
    v_xor_b32 v58, s6, v58
    v_xor_b32 v59, s7, v59
    v_or3_b32 v23, v23, v56, v57
    v_pk_fma_f32 v[14:15], v[56:57], v[66:67], v[14:15] op_sel:[0,0,0] op_sel_hi:[1,0,1]
    v_or3_b32 v23, v23, v58, v59
    v_pk_fma_f32 v[16:17], v[58:59], v[66:67], v[16:17] op_sel:[0,0,0] op_sel_hi:[1,0,1]
    s_waitcnt vmcnt(0)
    v_xor_b32 v60, s4, v60
    v_xor_b32 v61, s5, v61
    v_xor_b32 v62, s6, v62
    v_xor_b32 v63, s7, v63
    v_or3_b32 v23, v23, v60, v61
    v_pk_fma_f32 v[14:15], v[60:61], v[66:67], v[14:15] op_sel:[0,1,0] op_sel_hi:[1,1,1]
    v_or3_b32 v23, v23, v62, v63
    v_pk_fma_f32 v[16:17], v[62:63], v[66:67], v[16:17] op_sel:[0,1,0] op_sel_hi:[1,1,1]
    v_and_b32 v23, 0xff, v23
    v_cmp_ne_u32 vcc, 0, v23
    s_nop 4
    s_cbranch_vccz L_cok
    s_mov_b64 exec, vcc
    s_sleep 1
    s_add_u32 s88, s88, 1
    s_cmp_lt_u32 s88, 400000
    s_cbranch_scc1 L_try
L_cok:
    s_mov_b64 exec, -1
    v_permlane32_swap_b32 v14, v16
    v_permlane32_swap_b32 v15, v17
    v_pk_add_f32 v[14:15], v[14:15], v[16:17]
    s_nop 1
    v_permlane16_swap_b32 v14, v15
    v_add_f32 v14, v14, v15
    ds_write_b32 v4, v14
    s_mov_b64 exec, 1
    ds_add_rtn_u32 v18, v7, v8 offset:28
    s_mov_b64 exec, -1
    ds_read2st64_b32 v[14:15], v7 offset0:4 offset1:5
    ds_read2st64_b32 v[16:17], v7 offset0:6 offset1:7
    s_waitcnt lgkmcnt(0)
    v_readfirstlane_b32 s92, v18
    v_pk_add_f32 v[14:15], v[14:15], v[16:17]
    v_add_f32 v14, v14, v15
    s_cmp_lg_u32 s92, 3
    s_nop 1
    s_cbranch_scc1 L_cend
    v_add_f32_dpp v14, v14, v14 row_ror:8 row_mask:0xf bank_mask:0xf
    s_mov_b32 exec_lo, 0x00ff00ff
    s_mov_b32 exec_hi, 0x00ff00ff
    v_cvt_pk_bf16_f32 v14, v14, v14
    buffer_store_short v14, v69, s[28:31], s36 offen
    s_nop 0
L_cend:
    s_waitcnt lgkmcnt(0)
    s_endpgm
L_helper:
    s_memrealtime s[96:97]
    v_bfe_u32 v22, v1, 2, 3
    v_lshl_add_u32 v22, v22, 11, s77
    v_and_b32 v22, 16383, v22
    v_lshrrev_b32 v19, 5, v1
    v_lshl_add_u32 v22, v19, 15, v22
    v_and_b32 v19, 3, v1
    v_lshlrev_b32 v19, 3, v19
    v_lshl_add_u32 v22, v22, 1, v19
    s_lshl_b32 s91, s3, 15
    v_lshlrev_b32 v2, 4, v1
    s_mov_b32 s6, 1048576
    s_mov_b32 s7, 0x20000
    s_mov_b32 s10, 1048576
    s_mov_b32 s11, 0x20000
    s_mov_b32 s14, 1048576
    s_mov_b32 s15, 0x20000
    s_mov_b32 s18, 1048576
    s_mov_b32 s19, 0x20000
    s_waitcnt lgkmcnt(0)
    s_mov_b64 s[4:5], s[52:53]
    s_mov_b64 s[8:9], s[54:55]
    s_mov_b64 s[12:13], s[58:59]
    s_mov_b64 s[16:17], s[60:61]
    buffer_load_dwordx2 v[108:109], v22, s[4:7], s91 offen
    buffer_load_dwordx2 v[110:111], v22, s[8:11], s91 offen
    buffer_load_dwordx2 v[112:113], v22, s[12:15], s91 offen
    buffer_load_dwordx2 v[114:115], v22, s[16:19], s91 offen
    s_add_u32 s91, s91, 131072
    s_barrier
    v_lshrrev_b32 v18, 1, v1
    v_lshlrev_b32 v18, 10, v18
    v_and_b32 v19, 1, v1
    v_lshl_add_u32 v18, v19, 6, v18
    s_lshr_b32 s92, s2, 3
    s_lshl_b32 s92, s92, 15
    s_and_b32 s93, s2, 7
    s_lshl_b32 s93, s93, 7
    s_add_u32 s92, s92, s93
    buffer_load_dword v6, v18, s[4:7], s92 offen
    buffer_load_dword v6, v18, s[8:11], s92 offen
    buffer_load_dword v6, v18, s[12:15], s92 offen
    buffer_load_dword v6, v18, s[16:19], s92 offen
    s_mov_b64 s[20:21], s[74:75]
    s_mov_b32 s22, 1610612736
    s_mov_b32 s23, 0x20000
    s_mov_b64 s[24:25], s[72:73]
    s_mov_b32 s26, 256
    s_mov_b32 s27, 0x20000
    s_mov_b64 s[32:33], s[48:49]
    s_mov_b32 s34, 12288
    s_mov_b32 s35, 0x20000
    s_mov_b64 s[36:37], s[62:63]
    s_mov_b32 s38, 384
    s_mov_b32 s39, 0x20000
    s_mov_b64 s[40:41], s[64:65]
    s_mov_b32 s42, 384
    s_mov_b32 s43, 0x20000
    v_lshlrev_b32 v44, 3, v1
    v_cmp_gt_u32 vcc, 24, v1
    v_mov_b32 v23, 0xffffff40
    v_mov_b32 v18, 192
    v_cndmask_b32 v23, v23, v18, vcc
    v_add_u32 v45, v44, v23
    v_mov_b32 v18, 0x80008000
    v_cndmask_b32 v46, 0, v18, vcc
    s_mov_b32 s78, s96
    s_mov_b32 s94, 0x05040100
    s_mov_b32 s95, 0x07060302
    v_lshlrev_b32 v9, 1, v2
    v_add_u32 v9, 49152, v9
    v_mov_b32 v3, 77824
    v_mov_b32 v4, 0
    v_mov_b32 v5, 0xff
    v_mov_b32 v12, v9
    buffer_load_dwordx2 v[40:41], v44, s[36:39], 0 offen
    buffer_load_dwordx2 v[42:43], v44, s[40:43], 0 offen
    s_mul_i32 s92, s3, 384
    s_add_u32 s92, s92, 6144
    buffer_load_dwordx2 v[136:137], v44, s[32:35], s92 offen
    buffer_load_dwordx2 v[138:139], v45, s[32:35], s92 offen
    buffer_load_dwordx2 v[140:141], v44, s[32:35], s92 offen offset:768
    buffer_load_dwordx2 v[142:143], v45, s[32:35], s92 offen offset:768
    s_add_u32 s92, s92, 1536
    buffer_load_dwordx2 v[144:145], v44, s[32:35], s92 offen
    buffer_load_dwordx2 v[146:147], v45, s[32:35], s92 offen
    buffer_load_dwordx2 v[148:149], v44, s[32:35], s92 offen offset:768
    buffer_load_dwordx2 v[150:151], v45, s[32:35], s92 offen offset:768
    s_add_u32 s92, s92, 1536
    buffer_load_dwordx2 v[152:153], v44, s[32:35], s92 offen
    buffer_load_dwordx2 v[154:155], v45, s[32:35], s92 offen
    buffer_load_dwordx2 v[156:157], v44, s[32:35], s92 offen offset:768
    buffer_load_dwordx2 v[158:159], v45, s[32:35], s92 offen offset:768
    s_add_u32 s92, s92, 1536
    buffer_load_dwordx2 v[160:161], v44, s[32:35], s92 offen
    buffer_load_dwordx2 v[162:163], v45, s[32:35], s92 offen
    buffer_load_dwordx2 v[164:165], v44, s[32:35], s92 offen offset:768
    buffer_load_dwordx2 v[166:167], v45, s[32:35], s92 offen offset:768
    s_waitcnt vmcnt(22)
    v_perm_b32 v116, v110, v108, s94
    v_perm_b32 v117, v114, v112, s94
    v_perm_b32 v118, v110, v108, s95
    v_perm_b32 v119, v114, v112, s95
    v_perm_b32 v120, v111, v109, s94
    v_perm_b32 v121, v115, v113, s94
    v_perm_b32 v122, v111, v109, s95
    v_perm_b32 v123, v115, v113, s95
    s_lshr_b32 s92, s91, 17
    v_mov_b32 v19, s92
    ds_write_b128 v12, v[116:119]
    ds_write_b128 v12, v[120:123] offset:16
    ds_write_b32 v3, v19 offset:48
    v_add_u32 v12, 2048, v12
    s_mov_b32 s48, 0
    s_cmp_lg_u32 s2, 0
    s_cbranch_scc1 L_ne0
    s_mul_i32 s49, s78, 0x9e3779b1
    s_lshr_b32 s93, s49, 15
    s_xor_b32 s49, s49, s93
    s_mul_i32 s49, s49, 0x85ebca6b
    s_lshr_b32 s93, s49, 13
    s_xor_b32 s49, s49, s93
    s_max_u32 s49, s49, 1
    v_mov_b32 v14, s49
    v_mov_b32 v15, 0
    s_mov_b64 exec, 1
    buffer_atomic_cmpswap v[14:15], v4, s[24:27], 0 offen sc0 sc1
    s_waitcnt vmcnt(0)
    v_readfirstlane_b32 s48, v14
    s_mov_b64 exec, -1
    s_cmp_eq_u32 s48, 0
    s_cselect_b32 s48, s49, s48
    s_nop 1
L_ne0:
    s_getpc_b64 s[92:93]
L_pc:
    s_sub_u32 s92, s92, L_pc-standalone__kv_cache_quant_pre_rope_vs_post_rope__decode_kernel
    s_subb_u32 s93, s93, 0
    s_lshr_b32 s94, s2, 3
    v_lshl_add_u32 v19, v1, 5, s94
    v_lshlrev_b32 v19, 7, v19
    v_min_u32 v19, L_end-standalone__kv_cache_quant_pre_rope_vs_post_rope__decode_kernel, v19
    s_mov_b64 exec, 63
    global_load_dword v6, v19, s[92:93]
    s_mov_b64 exec, -1
    v_lshlrev_b32 v18, 1, v44
    v_lshlrev_b32 v19, 1, v45
    v_add_u32 v18, 71680, v18
    v_add_u32 v19, 71680, v19
    v_mov_b32 v23, 78000
    s_mov_b32 s89, 0
    s_waitcnt vmcnt(1) lgkmcnt(0)
    v_xor_b32 v42, v42, v46
    v_xor_b32 v43, v43, v46
    v_lshlrev_b32 v48, 16, v40
    v_and_b32 v49, 0xffff0000, v40
    v_lshlrev_b32 v50, 16, v41
    v_and_b32 v51, 0xffff0000, v41
    v_lshlrev_b32 v52, 16, v42
    v_and_b32 v53, 0xffff0000, v42
    v_lshlrev_b32 v54, 16, v43
    v_and_b32 v55, 0xffff0000, v43
    v_and_b32 v46, 0x80000000, v46
    s_nop 1
L_hq:
    v_mov_b64 v[24:25], v[136:137]
    v_mov_b64 v[26:27], v[138:139]
    v_mov_b64 v[28:29], v[140:141]
    v_mov_b64 v[30:31], v[142:143]
    v_mov_b64 v[136:137], v[144:145]
    v_mov_b64 v[138:139], v[146:147]
    v_mov_b64 v[140:141], v[148:149]
    v_mov_b64 v[142:143], v[150:151]
    v_mov_b64 v[144:145], v[152:153]
    v_mov_b64 v[146:147], v[154:155]
    v_mov_b64 v[148:149], v[156:157]
    v_mov_b64 v[150:151], v[158:159]
    v_mov_b64 v[152:153], v[160:161]
    v_mov_b64 v[154:155], v[162:163]
    v_mov_b64 v[156:157], v[164:165]
    v_mov_b64 v[158:159], v[166:167]
    s_mov_b32 exec_hi, 0xffff
    v_lshlrev_b32 v56, 16, v24
    v_and_b32 v57, 0xffff0000, v24
    v_lshlrev_b32 v58, 16, v25
    v_and_b32 v59, 0xffff0000, v25
    v_lshlrev_b32 v60, 16, v26
    v_and_b32 v61, 0xffff0000, v26
    v_lshlrev_b32 v62, 16, v27
    v_and_b32 v63, 0xffff0000, v27
    v_pk_mul_f32 v[56:57], v[56:57], v[48:49]
    v_pk_mul_f32 v[60:61], v[60:61], v[52:53]
    v_pk_mul_f32 v[58:59], v[58:59], v[50:51]
    v_pk_mul_f32 v[62:63], v[62:63], v[54:55]
    v_cvt_pk_bf16_f32 v56, v56, v60
    v_cvt_pk_bf16_f32 v57, v57, v61
    v_cvt_pk_bf16_f32 v58, v58, v62
    v_cvt_pk_bf16_f32 v59, v59, v63
    v_and_b32 v60, 0xffff0000, v56
    v_lshlrev_b32 v56, 16, v56
    v_and_b32 v61, 0xffff0000, v57
    v_lshlrev_b32 v57, 16, v57
    v_and_b32 v62, 0xffff0000, v58
    v_lshlrev_b32 v58, 16, v58
    v_and_b32 v63, 0xffff0000, v59
    v_lshlrev_b32 v59, 16, v59
    v_pk_add_f32 v[56:57], v[56:57], v[60:61]
    v_pk_add_f32 v[58:59], v[58:59], v[62:63]
    v_cvt_pk_bf16_f32 v64, v56, v56
    v_cvt_pk_bf16_f32 v65, v57, v57
    v_cvt_pk_bf16_f32 v66, v58, v58
    v_cvt_pk_bf16_f32 v67, v59, v59
    v_xor_b32 v64, v64, v46
    v_xor_b32 v65, v65, v46
    v_xor_b32 v66, v66, v46
    v_xor_b32 v67, v67, v46
    ds_write_b16 v18, v64 offset:0
    ds_write_b16_d16_hi v19, v64 offset:2
    ds_write_b16 v18, v65 offset:4
    ds_write_b16_d16_hi v19, v65 offset:6
    ds_write_b16 v18, v66 offset:8
    ds_write_b16_d16_hi v19, v66 offset:10
    ds_write_b16 v18, v67 offset:12
    ds_write_b16_d16_hi v19, v67 offset:14
    v_lshlrev_b32 v56, 16, v28
    v_and_b32 v57, 0xffff0000, v28
    v_lshlrev_b32 v58, 16, v29
    v_and_b32 v59, 0xffff0000, v29
    v_lshlrev_b32 v60, 16, v30
    v_and_b32 v61, 0xffff0000, v30
    v_lshlrev_b32 v62, 16, v31
    v_and_b32 v63, 0xffff0000, v31
    v_pk_mul_f32 v[56:57], v[56:57], v[48:49]
    v_pk_mul_f32 v[60:61], v[60:61], v[52:53]
    v_pk_mul_f32 v[58:59], v[58:59], v[50:51]
    v_pk_mul_f32 v[62:63], v[62:63], v[54:55]
    v_cvt_pk_bf16_f32 v56, v56, v60
    v_cvt_pk_bf16_f32 v57, v57, v61
    v_cvt_pk_bf16_f32 v58, v58, v62
    v_cvt_pk_bf16_f32 v59, v59, v63
    v_and_b32 v60, 0xffff0000, v56
    v_lshlrev_b32 v56, 16, v56
    v_and_b32 v61, 0xffff0000, v57
    v_lshlrev_b32 v57, 16, v57
    v_and_b32 v62, 0xffff0000, v58
    v_lshlrev_b32 v58, 16, v58
    v_and_b32 v63, 0xffff0000, v59
    v_lshlrev_b32 v59, 16, v59
    v_pk_add_f32 v[56:57], v[56:57], v[60:61]
    v_pk_add_f32 v[58:59], v[58:59], v[62:63]
    v_cvt_pk_bf16_f32 v68, v56, v56
    v_cvt_pk_bf16_f32 v69, v57, v57
    v_cvt_pk_bf16_f32 v70, v58, v58
    v_cvt_pk_bf16_f32 v71, v59, v59
    v_xor_b32 v68, v68, v46
    v_xor_b32 v69, v69, v46
    v_xor_b32 v70, v70, v46
    v_xor_b32 v71, v71, v46
    ds_write_b16 v18, v68 offset:768
    ds_write_b16_d16_hi v19, v68 offset:770
    ds_write_b16 v18, v69 offset:772
    ds_write_b16_d16_hi v19, v69 offset:774
    ds_write_b16 v18, v70 offset:776
    ds_write_b16_d16_hi v19, v70 offset:778
    ds_write_b16 v18, v71 offset:780
    ds_write_b16_d16_hi v19, v71 offset:782
    s_mov_b32 exec_hi, -1
    ds_write_b32 v23, v5
    s_add_u32 s89, s89, 1
    v_add_u32 v18, 1536, v18
    v_add_u32 v19, 1536, v19
    v_add_u32 v23, 4, v23
    s_cmp_lt_u32 s89, 4
    s_waitcnt lgkmcnt(0)
    s_cbranch_scc1 L_hq
    s_cmp_lg_u32 s48, 0
    s_cbranch_scc1 L_epd
L_epw:
    s_sleep 1
    ds_read_b32 v19, v7
    s_waitcnt lgkmcnt(0)
    v_readlane_b32 s89, v19, 5
    s_nop 0
    s_cmp_lt_i32 s89, 72
    s_nop 2
    s_cbranch_scc1 L_epw
    s_buffer_load_dword s48, s[24:27], 0
    s_waitcnt lgkmcnt(0)
    s_cmp_lg_u32 s48, 0
    s_cbranch_scc1 L_epd
    s_mul_i32 s49, s78, 0x9e3779b1
    s_lshr_b32 s93, s49, 15
    s_xor_b32 s49, s49, s93
    s_mul_i32 s49, s49, 0x85ebca6b
    s_lshr_b32 s93, s49, 13
    s_xor_b32 s49, s49, s93
    s_max_u32 s49, s49, 1
    v_mov_b32 v14, s49
    v_mov_b32 v15, 0
    s_mov_b64 exec, 1
    buffer_atomic_cmpswap v[14:15], v4, s[24:27], 0 offen sc0 sc1
    s_waitcnt vmcnt(0)
    v_readfirstlane_b32 s48, v14
    s_mov_b64 exec, -1
    s_cmp_eq_u32 s48, 0
    s_cselect_b32 s48, s49, s48
    s_nop 1
L_epd:
    s_waitcnt vmcnt(0)
    s_lshr_b32 s49, s48, 8
    s_lshr_b32 s50, s48, 16
    s_lshr_b32 s51, s48, 24
    s_mov_b32 s79, 0
    s_mov_b32 s80, 0
    s_mov_b32 s85, 0
    s_mov_b32 s84, 0
    s_mov_b32 s83, 0
    s_mov_b32 s98, 0
    s_mov_b32 s99, 0
    s_mov_b32 s33, 0
    s_movk_i32 s81, 240
    s_mov_b32 s82, 0x7fffffff
    s_movk_i32 s70, 850
    s_movk_i32 s71, 850
    s_movk_i32 s68, 132
    s_mov_b32 s69, 0
    s_mov_b32 s86, 16
    s_lshr_b32 s92, s2, 4
    s_and_b32 s93, s2, 15
    s_cmp_eq_u32 s92, s93
    s_cselect_b32 s38, s92, 255
    s_mul_i32 s87, s38, 4352
    s_add_u32 s87, s87, 33554432
    s_mov_b32 s88, 33554432
    v_lshrrev_b32 v18, 5, v1
    v_lshlrev_b32 v11, 4, v18
    v_add_u32 v11, 78080, v11
    v_add_u32 v10, 65536, v2
    v_mov_b32 v20, 78320
    s_mov_b32 s39, 8
    s_and_b32 s41, s2, 0x70
    s_and_b32 s92, s2, 7
    s_lshl1_add_u32 s41, s92, s41
    s_lshr_b32 s92, s2, 7
    s_add_u32 s41, s41, s92
    s_lshl_b32 s92, s3, 7
    s_add_u32 s41, s41, s92
    s_lshr_b32 s92, s2, 3
    s_mul_i32 s34, s92, 43
    s_lshr_b32 s34, s34, 8
    s_mul_i32 s93, s34, 6
    s_sub_u32 s92, s92, s93
    s_and_b32 s93, s2, 6
    s_lshl1_add_u32 s34, s93, s34
    s_and_b32 s93, s2, 1
    s_lshl1_add_u32 s34, s34, s93
    s_lshr_b32 s40, s2, 3
    s_and_b32 s40, s40, 31
    s_mul_i32 s40, s40, 24
    s_addk_i32 s40, 1728
    s_cmp_lt_u32 s2, 192
    s_cselect_b32 s40, s40, 0x7fffffff
    s_mov_b32 s35, 0
    s_mov_b32 s36, 21495808
    s_mov_b32 s37, 0
L_hl:
    s_sleep 1
    ds_read_b32 v19, v7
    s_memrealtime s[96:97]
    s_waitcnt lgkmcnt(0)
    v_readlane_b32 s89, v19, 5
    v_readlane_b32 s90, v19, s86
    s_sub_u32 s96, s96, s78
    s_lshl_b32 s96, s96, 8
    s_mul_i32 s92, s80, s89
    s_add_u32 s92, s92, s79
    s_sub_u32 s92, s96, s92
    s_max_i32 s92, s92, s98
    s_min_i32 s92, s92, s99
    s_mul_i32 s92, s92, s35
    s_add_u32 s92, s92, s36
    s_ashr_i32 s92, s92, 20
    s_max_i32 s92, s92, 15
    s_min_i32 s92, s92, 26
    v_mov_b32 v18, s92
    ds_write_b32 v3, v18 offset:16
    s_cmp_ge_i32 s89, s82
    s_cbranch_scc1 L_rd
    s_cmp_ge_i32 s89, s81
    s_cbranch_scc1 L_pub
    s_cmp_ge_i32 s89, s68
    s_cbranch_scc1 L_tf
    s_cmp_eq_u32 s90, s39
    s_cbranch_scc1 L_prep
    s_cmp_ge_i32 s89, s40
    s_cbranch_scc1 L_wts
    s_cmp_eq_u32 s86, 14
    s_cbranch_scc0 L_hl
    s_branch L_late
L_tf:
    buffer_load_dwordx2 v[108:109], v22, s[4:7], s91 offen
    buffer_load_dwordx2 v[110:111], v22, s[8:11], s91 offen
    buffer_load_dwordx2 v[112:113], v22, s[12:15], s91 offen
    buffer_load_dwordx2 v[114:115], v22, s[16:19], s91 offen
    s_add_u32 s91, s91, 131072
    s_mov_b32 s94, 0x05040100
    s_mov_b32 s95, 0x07060302
    s_addk_i32 s68, 24
    s_cmp_ge_u32 s91, 1048576
    s_cselect_b32 s68, 0x7fffffff, s68
    s_waitcnt vmcnt(0)
    v_perm_b32 v116, v110, v108, s94
    v_perm_b32 v117, v114, v112, s94
    v_perm_b32 v118, v110, v108, s95
    v_perm_b32 v119, v114, v112, s95
    v_perm_b32 v120, v111, v109, s94
    v_perm_b32 v121, v115, v113, s94
    v_perm_b32 v122, v111, v109, s95
    v_perm_b32 v123, v115, v113, s95
    s_lshr_b32 s92, s91, 17
    v_mov_b32 v19, s92
    ds_write_b128 v12, v[116:119]
    ds_write_b128 v12, v[120:123] offset:16
    ds_write_b32 v3, v19 offset:48
    v_add_u32 v12, 2048, v12
    s_waitcnt lgkmcnt(0)
    s_nop 0
    s_branch L_hl
L_pub:
    s_cmp_eq_u32 s80, 0
    s_cselect_b32 s92, 850, s80
    s_sub_u32 s93, s89, s81
    s_mul_i32 s92, s92, s93
    s_sub_u32 s83, s96, s92
    s_add_u32 s82, s81, 72
    s_cmp_ge_u32 s81, 2544
    s_cselect_b32 s92, 4, 8
    s_mul_i32 s92, s92, 24
    s_add_u32 s81, s81, s92
    s_cmp_ge_u32 s38, 16
    s_cbranch_scc1 L_hl
    s_lshl_b32 s92, s78, 8
    s_add_u32 s92, s92, s83
    v_mov_b32 v14, s92
    v_mov_b32 v15, s48
    s_mov_b64 exec, 1
    buffer_store_dwordx2 v[14:15], v4, s[20:23], s87 offen sc0 sc1
    s_mov_b64 exec, -1
    s_add_u32 s87, s87, 69632
    s_branch L_hl
L_rd:
    s_lshl_b32 s92, s78, 8
    s_add_u32 s92, s92, s83
    s_mov_b32 s93, 0
    s_mov_b32 s94, 0
    s_buffer_load_dwordx2 s[52:53], s[20:23], s88
    s_add_u32 s88, s88, 4352
    s_buffer_load_dwordx2 s[54:55], s[20:23], s88
    s_add_u32 s88, s88, 4352
    s_buffer_load_dwordx2 s[56:57], s[20:23], s88
    s_add_u32 s88, s88, 4352
    s_buffer_load_dwordx2 s[58:59], s[20:23], s88
    s_add_u32 s88, s88, 4352
    s_buffer_load_dwordx2 s[60:61], s[20:23], s88
    s_add_u32 s88, s88, 4352
    s_buffer_load_dwordx2 s[62:63], s[20:23], s88
    s_add_u32 s88, s88, 4352
    s_buffer_load_dwordx2 s[64:65], s[20:23], s88
    s_add_u32 s88, s88, 4352
    s_buffer_load_dwordx2 s[66:67], s[20:23], s88
    s_add_u32 s88, s88, 4352
    s_waitcnt lgkmcnt(0)
    s_sub_u32 s52, s52, s92
    s_cmp_eq_u32 s53, s48
    s_cselect_b32 s52, s52, 0
    s_addc_u32 s93, s93, 0
    s_add_u32 s94, s94, s52
    s_sub_u32 s54, s54, s92
    s_cmp_eq_u32 s55, s48
    s_cselect_b32 s54, s54, 0
    s_addc_u32 s93, s93, 0
    s_add_u32 s94, s94, s54
    s_sub_u32 s56, s56, s92
    s_cmp_eq_u32 s57, s48
    s_cselect_b32 s56, s56, 0
    s_addc_u32 s93, s93, 0
    s_add_u32 s94, s94, s56
    s_sub_u32 s58, s58, s92
    s_cmp_eq_u32 s59, s48
    s_cselect_b32 s58, s58, 0
    s_addc_u32 s93, s93, 0
    s_add_u32 s94, s94, s58
    s_sub_u32 s60, s60, s92
    s_cmp_eq_u32 s61, s48
    s_cselect_b32 s60, s60, 0
    s_addc_u32 s93, s93, 0
    s_add_u32 s94, s94, s60
    s_sub_u32 s62, s62, s92
    s_cmp_eq_u32 s63, s48
    s_cselect_b32 s62, s62, 0
    s_addc_u32 s93, s93, 0
    s_add_u32 s94, s94, s62
    s_sub_u32 s64, s64, s92
    s_cmp_eq_u32 s65, s48
    s_cselect_b32 s64, s64, 0
    s_addc_u32 s93, s93, 0
    s_add_u32 s94, s94, s64
    s_sub_u32 s66, s66, s92
    s_cmp_eq_u32 s67, s48
    s_cselect_b32 s66, s66, 0
    s_addc_u32 s93, s93, 0
    s_add_u32 s94, s94, s66
    s_buffer_load_dwordx2 s[52:53], s[20:23], s88
    s_add_u32 s88, s88, 4352
    s_buffer_load_dwordx2 s[54:55], s[20:23], s88
    s_add_u32 s88, s88, 4352
    s_buffer_load_dwordx2 s[56:57], s[20:23], s88
    s_add_u32 s88, s88, 4352
    s_buffer_load_dwordx2 s[58:59], s[20:23], s88
    s_add_u32 s88, s88, 4352
    s_buffer_load_dwordx2 s[60:61], s[20:23], s88
    s_add_u32 s88, s88, 4352
    s_buffer_load_dwordx2 s[62:63], s[20:23], s88
    s_add_u32 s88, s88, 4352
    s_buffer_load_dwordx2 s[64:65], s[20:23], s88
    s_add_u32 s88, s88, 4352
    s_buffer_load_dwordx2 s[66:67], s[20:23], s88
    s_add_u32 s88, s88, 4352
    s_waitcnt lgkmcnt(0)
    s_sub_u32 s52, s52, s92
    s_cmp_eq_u32 s53, s48
    s_cselect_b32 s52, s52, 0
    s_addc_u32 s93, s93, 0
    s_add_u32 s94, s94, s52
    s_sub_u32 s54, s54, s92
    s_cmp_eq_u32 s55, s48
    s_cselect_b32 s54, s54, 0
    s_addc_u32 s93, s93, 0
    s_add_u32 s94, s94, s54
    s_sub_u32 s56, s56, s92
    s_cmp_eq_u32 s57, s48
    s_cselect_b32 s56, s56, 0
    s_addc_u32 s93, s93, 0
    s_add_u32 s94, s94, s56
    s_sub_u32 s58, s58, s92
    s_cmp_eq_u32 s59, s48
    s_cselect_b32 s58, s58, 0
    s_addc_u32 s93, s93, 0
    s_add_u32 s94, s94, s58
    s_sub_u32 s60, s60, s92
    s_cmp_eq_u32 s61, s48
    s_cselect_b32 s60, s60, 0
    s_addc_u32 s93, s93, 0
    s_add_u32 s94, s94, s60
    s_sub_u32 s62, s62, s92
    s_cmp_eq_u32 s63, s48
    s_cselect_b32 s62, s62, 0
    s_addc_u32 s93, s93, 0
    s_add_u32 s94, s94, s62
    s_sub_u32 s64, s64, s92
    s_cmp_eq_u32 s65, s48
    s_cselect_b32 s64, s64, 0
    s_addc_u32 s93, s93, 0
    s_add_u32 s94, s94, s64
    s_sub_u32 s66, s66, s92
    s_cmp_eq_u32 s67, s48
    s_cselect_b32 s66, s66, 0
    s_addc_u32 s93, s93, 0
    s_add_u32 s94, s94, s66
    v_cvt_f32_u32 v15, s93
    v_cvt_f32_i32 v14, s94
    v_rcp_f32 v15, v15
    s_nop 0
    v_mul_f32 v14, v14, v15
    v_cvt_i32_f32 v14, v14
    s_sub_u32 s94, s82, 72
    s_mov_b32 s82, 0x7fffffff
    v_readfirstlane_b32 s92, v14
    s_mov_b32 s95, s85
    s_min_u32 s85, s93, 1
    s_cmp_eq_u32 s93, 0
    s_nop 1
    s_cbranch_scc1 L_hl
    s_sub_u32 s98, 0, s92
    s_movk_i32 s35, 150
    s_mov_b32 s36, 21495808
    s_movk_i32 s93, 6400
    s_cmp_ge_u32 s94, 2544
    s_cmovk_i32 s35, 350
    s_cmov_b32 s36, 21495808
    s_cmovk_i32 s93, 12800
    s_add_u32 s36, s36, s37
    s_max_i32 s99, s98, 0
    s_min_i32 s98, s98, 0
    s_add_u32 s99, s99, s93
    s_sub_u32 s98, s98, s93
    s_min_i32 s99, s99, 1048576
    s_max_i32 s98, s98, -1048576
    s_add_u32 s92, s92, s83
    s_sub_u32 s93, s92, s84
    s_mov_b32 s84, s92
    s_mov_b32 s80, 22369621
    s_cmp_gt_u32 s94, 2544
    s_cmov_b32 s80, 44739243
    s_mul_hi_u32 s93, s93, s80
    s_cmp_eq_u32 s95, 0
    s_cselect_b32 s80, 850, s93
    s_min_u32 s93, s70, s71
    s_max_u32 s95, s70, s71
    s_mov_b32 s71, s70
    s_mov_b32 s70, s80
    s_min_u32 s80, s80, s95
    s_max_u32 s80, s80, s93
    s_max_u32 s80, s80, 1
    s_mul_i32 s93, s80, s94
    s_sub_u32 s79, s92, s93
    s_branch L_hl
L_prep:
    s_cmp_ge_u32 s86, 24
    s_cbranch_scc1 L_mrg
    ds_read_b128 v[24:27], v9
    ds_read_b128 v[28:31], v9 offset:16
    s_add_u32 s86, s86, 1
    s_sub_u32 s92, s86, 16
    s_lshl_b32 s92, s92, 1
    v_mov_b32 v23, s92
    s_waitcnt lgkmcnt(0)
    v_max_f32 v40, v24, v26
    v_max3_f32 v40, v40, v28, v30
    v_lshlrev_b32 v32, 16, v25
    v_lshlrev_b32 v33, 16, v27
    v_lshlrev_b32 v34, 16, v29
    v_lshlrev_b32 v35, 16, v31
    v_max_f32_dpp v40, v40, v40 quad_perm:[1,0,3,2] row_mask:0xf bank_mask:0xf
    s_nop 1
    v_max_f32_dpp v40, v40, v40 quad_perm:[2,3,0,1] row_mask:0xf bank_mask:0xf
    s_nop 1
    v_max_f32_dpp v40, v40, v40 row_half_mirror row_mask:0xf bank_mask:0xf
    s_nop 1
    v_max_f32_dpp v40, v40, v40 row_mirror row_mask:0xf bank_mask:0xf
    v_and_b32 v36, 0xffff0000, v25
    v_and_b32 v37, 0xffff0000, v27
    v_and_b32 v38, 0xffff0000, v29
    v_and_b32 v39, 0xffff0000, v31
    v_mov_b32 v6, v40
    s_nop 1
    v_permlane16_swap_b32 v40, v6
    v_max_f32 v40, v40, v6
    v_sub_f32 v24, v24, v40
    v_sub_f32 v26, v26, v40
    v_sub_f32 v28, v28, v40
    v_sub_f32 v30, v30, v40
    v_exp_f32 v24, v24
    v_exp_f32 v26, v26
    v_exp_f32 v28, v28
    v_exp_f32 v30, v30
    v_add_f32 v42, v24, v26
    v_add_f32 v6, v28, v30
    v_add_f32 v42, v42, v6
    v_mul_f32 v24, v24, v32
    v_mul_f32 v26, v26, v33
    v_mul_f32 v28, v28, v34
    v_mul_f32 v30, v30, v35
    ds_write_b128 v9, v[24:27]
    ds_write_b128 v9, v[28:31] offset:16
    v_mul_f32 v41, v24, v36
    v_fmac_f32 v41, v26, v37
    v_fmac_f32 v41, v28, v38
    v_fmac_f32 v41, v30, v39
    v_add_f32_dpp v42, v42, v42 quad_perm:[1,0,3,2] row_mask:0xf bank_mask:0xf
    s_nop 0
    v_add_f32_dpp v41, v41, v41 quad_perm:[1,0,3,2] row_mask:0xf bank_mask:0xf
    v_add_f32_dpp v42, v42, v42 quad_perm:[2,3,0,1] row_mask:0xf bank_mask:0xf
    s_nop 0
    v_add_f32_dpp v41, v41, v41 quad_perm:[2,3,0,1] row_mask:0xf bank_mask:0xf
    v_add_f32_dpp v42, v42, v42 row_half_mirror row_mask:0xf bank_mask:0xf
    s_nop 0
    v_add_f32_dpp v41, v41, v41 row_half_mirror row_mask:0xf bank_mask:0xf
    v_add_f32_dpp v42, v42, v42 row_mirror row_mask:0xf bank_mask:0xf
    s_nop 0
    v_add_f32_dpp v41, v41, v41 row_mirror row_mask:0xf bank_mask:0xf
    v_mov_b32 v6, v42
    s_nop 1
    v_permlane16_swap_b32 v42, v6
    v_add_f32 v42, v42, v6
    v_mov_b32 v6, v41
    s_nop 1
    v_permlane16_swap_b32 v41, v6
    v_add_f32 v41, v41, v6
    v_sub_f32 v41, 0, v41
    v_mov_b32 v43, v41
    ds_write_b128 v11, v[40:43]
    ds_write_b32 v3, v23 offset:52
    v_add_u32 v9, 2048, v9
    v_add_u32 v11, 32, v11
    s_cmp_eq_u32 s86, 24
    s_waitcnt lgkmcnt(0)
    s_cbranch_scc0 L_hl
    v_add_u32 v9, 64512, v2
    s_mov_b32 s39, 4
    v_add_u32 v18, 78080, v2
    s_mov_b64 exec, 0xffff
    ds_read_b128 v[24:27], v18
    s_lshl_b32 s92, s41, 8
    s_add_u32 s92, s92, 8388608
    s_waitcnt lgkmcnt(0)
    v_mov_b32 v25, s48
    v_mov_b32 v27, s48
    buffer_store_dwordx4 v[24:27], v2, s[20:23], s92 offen sc0 sc1
    s_mov_b64 exec, -1
    s_waitcnt vmcnt(0)
    s_branch L_hl
L_wts:
    s_and_b32 s92, s34, 1
    s_lshl_b32 s92, s92, 15
    s_lshr_b32 s93, s34, 1
    s_lshl4_add_u32 s92, s93, s92
    s_add_u32 s92, s92, 8388608
    s_add_u32 s93, s92, 16384
    v_lshlrev_b32 v18, 8, v1
    s_cmp_eq_u32 s33, 0
    s_nop 0
    s_cbranch_scc0 L_wt1
    s_mul_i32 s94, s69, 8
    s_bfm_b64 exec, 8, s94
    buffer_load_dwordx4 v[24:27], v18, s[20:23], s92 offen
    buffer_load_dwordx4 v[28:31], v18, s[20:23], s93 offen
    s_mov_b64 exec, -1
    s_add_u32 s69, s69, 1
    s_add_u32 s40, s89, 6
    s_min_i32 s40, s40, 2904
    s_cmp_lt_u32 s69, 8
    s_cbranch_scc1 L_hl
    s_branch L_wt2
L_wt1:
    buffer_load_dwordx4 v[24:27], v18, s[20:23], s92 offen sc0 sc1
    buffer_load_dwordx4 v[28:31], v18, s[20:23], s93 offen sc0 sc1
L_wt2:
    s_add_u32 s33, s33, 1
    s_add_u32 s40, s89, 24
    s_min_i32 s40, s40, 2904
    v_and_b32 v18, 7, v1
    v_lshlrev_b32 v18, 6, v18
    v_lshrrev_b32 v19, 3, v1
    v_lshl_add_u32 v18, v19, 2, v18
    s_waitcnt vmcnt(0)
    v_xor_b32 v23, s48, v25
    v_bitop3_b32 v23, v23, v27, s48 bitop3:0xf6
    v_bitop3_b32 v23, v23, v29, s48 bitop3:0xf6
    v_bitop3_b32 v23, v23, v31, s48 bitop3:0xf6
    v_cmp_ne_u32 vcc, 0, v23
    s_cmp_gt_u32 s33, 200000
    s_nop 3
    s_cbranch_scc1 L_wt3
    s_cbranch_vccnz L_hl
L_wt3:
    s_mov_b32 s40, 0x7fffffff
    v_max_f32 v23, v24, v28
    s_nop 1
    v_max_f32_dpp v23, v23, v23 quad_perm:[1,0,3,2] row_mask:0xf bank_mask:0xf
    s_nop 1
    v_max_f32_dpp v23, v23, v23 quad_perm:[2,3,0,1] row_mask:0xf bank_mask:0xf
    s_nop 1
    v_max_f32_dpp v23, v23, v23 row_half_mirror row_mask:0xf bank_mask:0xf
    s_nop 1
    v_max_f32_dpp v23, v23, v23 row_mirror row_mask:0xf bank_mask:0xf
    v_mov_b32 v6, v23
    s_nop 1
    v_permlane32_swap_b32 v23, v6
    v_max_f32 v23, v23, v6
    v_mov_b32 v6, v23
    s_nop 1
    v_permlane16_swap_b32 v23, v6
    v_max_f32 v23, v23, v6
    v_sub_f32 v24, v24, v23
    v_sub_f32 v28, v28, v23
    v_exp_f32 v24, v24
    v_exp_f32 v28, v28
    v_mul_f32 v23, v24, v26
    v_fmac_f32 v23, v28, v30
    s_nop 1
    v_add_f32_dpp v23, v23, v23 quad_perm:[1,0,3,2] row_mask:0xf bank_mask:0xf
    s_nop 1
    v_add_f32_dpp v23, v23, v23 quad_perm:[2,3,0,1] row_mask:0xf bank_mask:0xf
    s_nop 1
    v_add_f32_dpp v23, v23, v23 row_half_mirror row_mask:0xf bank_mask:0xf
    s_nop 1
    v_add_f32_dpp v23, v23, v23 row_mirror row_mask:0xf bank_mask:0xf
    v_mov_b32 v6, v23
    s_nop 1
    v_permlane32_swap_b32 v23, v6
    v_add_f32 v23, v23, v6
    v_mov_b32 v6, v23
    s_nop 1
    v_permlane16_swap_b32 v23, v6
    v_add_f32 v23, v23, v6
    v_rcp_f32 v23, v23
    s_nop 0
    v_mul_f32 v24, v24, v23
    v_mul_f32 v28, v28, v23
    v_add_u32 v18, 78336, v18
    ds_write2_b32 v18, v24, v28 offset0:0 offset1:8
    v_mov_b32 v19, s48
    ds_write_b32 v3, v19 offset:24
    s_waitcnt lgkmcnt(0)
    s_branch L_hl
L_mrg:
    ds_read_b32 v104, v20 offset:4
    ds_read_b128 v[88:91], v10 offset:0
    ds_read_b128 v[92:95], v10 offset:768
    ds_read_b128 v[96:99], v10 offset:1536
    ds_read_b128 v[100:103], v10 offset:2304
    s_add_u32 s86, s86, 1
    s_sub_u32 s92, s86, 24
    v_mov_b32 v23, s92
    ds_write_b32 v3, v23 offset:60
    s_and_b32 s92, s92, 3
    s_cselect_b32 s92, 1, -3
    s_mul_i32 s92, s92, 3072
    v_add_u32 v10, s92, v10
    v_subrev_u32 v20, 16, v20
    s_cmp_eq_u32 s86, 39
    s_cselect_b32 s86, 14, s86
    s_waitcnt lgkmcnt(0)
    v_pk_add_f32 v[88:89], v[88:89], v[104:105] op_sel:[0,0] op_sel_hi:[1,0]
    v_pk_add_f32 v[90:91], v[90:91], v[104:105] op_sel:[0,0] op_sel_hi:[1,0]
    v_pk_add_f32 v[92:93], v[92:93], v[96:97]
    v_pk_add_f32 v[94:95], v[94:95], v[98:99]
    v_pk_add_f32 v[88:89], v[88:89], v[100:101]
    v_pk_add_f32 v[90:91], v[90:91], v[102:103]
    v_pk_add_f32 v[88:89], v[88:89], v[92:93]
    v_pk_add_f32 v[90:91], v[90:91], v[94:95]
    v_bfi_b32 v84, v5, s48, v88
    v_bfi_b32 v85, v5, s49, v89
    v_bfi_b32 v86, v5, s50, v90
    v_bfi_b32 v87, v5, s51, v91
    ds_write_b128 v9, v[84:87]
    v_subrev_u32 v9, 1024, v9
    s_waitcnt lgkmcnt(0)
    s_nop 0
    s_branch L_hl
L_late:
    s_getpc_b64 s[92:93]
L_pc2:
    v_lshlrev_b32 v19, 7, v1
    v_min_u32 v19, L_end-L_pc2, v19
    s_mov_b64 exec, 0xff
    global_load_dword v6, v19, s[92:93]
    s_mov_b64 exec, -1
    s_mul_i32 s32, s41, 768
    s_mov_b32 s39, s32
    s_add_u32 s32, s32, 196608
    s_mul_i32 s42, s80, 3109
    s_add_u32 s42, s42, s79
    s_cmp_eq_u32 s80, 0
    s_cselect_b32 s42, -2, s42
    s_min_u32 s42, s42, -2
    v_add_u32 v9, 49152, v2
    ds_read_b128 v[24:27], v9 offset:1024
    ds_read_b128 v[28:31], v9 offset:2048
    ds_read_b128 v[32:35], v9 offset:3072
    ds_read_b128 v[36:39], v9 offset:4096
    ds_read_b128 v[40:43], v9 offset:5120
    ds_read_b128 v[44:47], v9 offset:6144
    ds_read_b128 v[48:51], v9 offset:7168
    ds_read_b128 v[52:55], v9 offset:8192
    ds_read_b128 v[56:59], v9 offset:9216
    ds_read_b128 v[60:63], v9 offset:10240
    s_waitcnt lgkmcnt(0)
    ds_read_b128 v[64:67], v9 offset:11264
    ds_read_b128 v[68:71], v9 offset:12288
    ds_read_b128 v[72:75], v9 offset:13312
    ds_read_b128 v[76:79], v9 offset:14336
    ds_read_b128 v[80:83], v9 offset:15360
    ds_read_b32 v104, v20 offset:4
    s_mov_b32 exec_hi, 0xffff
L_w7:
    ds_read_b32 v19, v7
    ds_read_b128 v[88:91], v10 offset:0
    ds_read_b128 v[92:95], v10 offset:768
    ds_read_b128 v[96:99], v10 offset:1536
    ds_read_b128 v[100:103], v10 offset:2304
    s_memrealtime s[96:97]
    s_waitcnt lgkmcnt(0)
    v_readlane_b32 s92, v19, 39
    v_readlane_b32 s89, v19, 5
    s_cmp_eq_u32 s92, 4
    s_nop 3
    s_cbranch_scc1 L_g7
    s_sub_u32 s96, s96, s78
    s_lshl_b32 s96, s96, 8
    s_cmp_ge_i32 s89, 3084
    s_cbranch_scc1 L_ns7
    s_mul_i32 s92, s80, s89
    s_add_u32 s92, s92, s79
    s_sub_u32 s92, s96, s92
    s_max_i32 s92, s92, s98
    s_min_i32 s92, s92, s99
    s_mul_i32 s92, s92, s35
    s_add_u32 s92, s92, s36
    s_ashr_i32 s92, s92, 20
    s_max_i32 s92, s92, 15
    s_min_i32 s92, s92, 26
    v_mov_b32 v18, s92
    ds_write_b32 v3, v18 offset:16
    s_nop 0
L_ns7:
    s_cmp_lt_u32 s96, s42
    s_cbranch_scc1 L_w7
    buffer_store_dwordx4 v[24:27], v2, s[20:23], s32 offen sc0 sc1
    s_add_u32 s32, s32, 196608
    buffer_store_dwordx4 v[28:31], v2, s[20:23], s32 offen sc0 sc1
    s_add_u32 s32, s32, 196608
    buffer_store_dwordx4 v[32:35], v2, s[20:23], s32 offen sc0 sc1
    s_add_u32 s32, s32, 196608
    buffer_store_dwordx4 v[36:39], v2, s[20:23], s32 offen sc0 sc1
    s_add_u32 s32, s32, 196608
    buffer_store_dwordx4 v[40:43], v2, s[20:23], s32 offen sc0 sc1
    s_add_u32 s32, s32, 196608
    buffer_store_dwordx4 v[44:47], v2, s[20:23], s32 offen sc0 sc1
    s_add_u32 s32, s32, 196608
    buffer_store_dwordx4 v[48:51], v2, s[20:23], s32 offen sc0 sc1
    s_add_u32 s32, s32, 196608
    buffer_store_dwordx4 v[52:55], v2, s[20:23], s32 offen sc0 sc1
    s_add_u32 s32, s32, 196608
    buffer_store_dwordx4 v[56:59], v2, s[20:23], s32 offen sc0 sc1
    s_add_u32 s32, s32, 196608
    buffer_store_dwordx4 v[60:63], v2, s[20:23], s32 offen sc0 sc1
    s_add_u32 s32, s32, 196608
    buffer_store_dwordx4 v[64:67], v2, s[20:23], s32 offen sc0 sc1
    s_add_u32 s32, s32, 196608
    buffer_store_dwordx4 v[68:71], v2, s[20:23], s32 offen sc0 sc1
    s_add_u32 s32, s32, 196608
    buffer_store_dwordx4 v[72:75], v2, s[20:23], s32 offen sc0 sc1
    s_add_u32 s32, s32, 196608
    buffer_store_dwordx4 v[76:79], v2, s[20:23], s32 offen sc0 sc1
    s_add_u32 s32, s32, 196608
    buffer_store_dwordx4 v[80:83], v2, s[20:23], s32 offen sc0 sc1
    s_mov_b32 s42, -1
    s_nop 0
L_w8:
    ds_read_b32 v19, v7
    ds_read_b128 v[88:91], v10 offset:0
    ds_read_b128 v[92:95], v10 offset:768
    ds_read_b128 v[96:99], v10 offset:1536
    ds_read_b128 v[100:103], v10 offset:2304
    s_waitcnt lgkmcnt(4)
    v_readlane_b32 s92, v19, 39
    s_nop 0
    s_cmp_lg_u32 s92, 4
    s_waitcnt lgkmcnt(0)
    s_cbranch_scc1 L_w8
L_g7:
    v_pk_add_f32 v[88:89], v[88:89], v[104:105] op_sel:[0,0] op_sel_hi:[1,0]
    v_pk_add_f32 v[90:91], v[90:91], v[104:105] op_sel:[0,0] op_sel_hi:[1,0]
    v_pk_add_f32 v[92:93], v[92:93], v[96:97]
    v_pk_add_f32 v[94:95], v[94:95], v[98:99]
    v_pk_add_f32 v[88:89], v[88:89], v[100:101]
    v_pk_add_f32 v[90:91], v[90:91], v[102:103]
    v_pk_add_f32 v[88:89], v[88:89], v[92:93]
    v_pk_add_f32 v[90:91], v[90:91], v[94:95]
    v_bfi_b32 v84, v5, s48, v88
    v_bfi_b32 v85, v5, s49, v89
    v_bfi_b32 v86, v5, s50, v90
    v_bfi_b32 v87, v5, s51, v91
    buffer_store_dwordx4 v[84:87], v2, s[20:23], s39 offen sc0 sc1
    s_cmp_eq_u32 s42, -1
    s_nop 0
    s_cbranch_scc1 L_hend
    buffer_store_dwordx4 v[24:27], v2, s[20:23], s32 offen sc0 sc1
    s_add_u32 s32, s32, 196608
    buffer_store_dwordx4 v[28:31], v2, s[20:23], s32 offen sc0 sc1
    s_add_u32 s32, s32, 196608
    buffer_store_dwordx4 v[32:35], v2, s[20:23], s32 offen sc0 sc1
    s_add_u32 s32, s32, 196608
    buffer_store_dwordx4 v[36:39], v2, s[20:23], s32 offen sc0 sc1
    s_add_u32 s32, s32, 196608
    buffer_store_dwordx4 v[40:43], v2, s[20:23], s32 offen sc0 sc1
    s_add_u32 s32, s32, 196608
    buffer_store_dwordx4 v[44:47], v2, s[20:23], s32 offen sc0 sc1
    s_add_u32 s32, s32, 196608
    buffer_store_dwordx4 v[48:51], v2, s[20:23], s32 offen sc0 sc1
    s_add_u32 s32, s32, 196608
    buffer_store_dwordx4 v[52:55], v2, s[20:23], s32 offen sc0 sc1
    s_add_u32 s32, s32, 196608
    buffer_store_dwordx4 v[56:59], v2, s[20:23], s32 offen sc0 sc1
    s_add_u32 s32, s32, 196608
    buffer_store_dwordx4 v[60:63], v2, s[20:23], s32 offen sc0 sc1
    s_add_u32 s32, s32, 196608
    buffer_store_dwordx4 v[64:67], v2, s[20:23], s32 offen sc0 sc1
    s_add_u32 s32, s32, 196608
    buffer_store_dwordx4 v[68:71], v2, s[20:23], s32 offen sc0 sc1
    s_add_u32 s32, s32, 196608
    buffer_store_dwordx4 v[72:75], v2, s[20:23], s32 offen sc0 sc1
    s_add_u32 s32, s32, 196608
    buffer_store_dwordx4 v[76:79], v2, s[20:23], s32 offen sc0 sc1
    s_add_u32 s32, s32, 196608
    buffer_store_dwordx4 v[80:83], v2, s[20:23], s32 offen sc0 sc1
    s_mov_b32 s42, -1
    s_nop 0
L_hend:
    v_mov_b32 v18, 2
    s_waitcnt vmcnt(14)
    ds_write_b32 v3, v18 offset:32
    v_mov_b32 v18, 3
    s_waitcnt vmcnt(13)
    ds_write_b32 v3, v18 offset:32
    v_mov_b32 v18, 4
    s_waitcnt vmcnt(12)
    ds_write_b32 v3, v18 offset:32
    v_mov_b32 v18, 5
    s_waitcnt vmcnt(11)
    ds_write_b32 v3, v18 offset:32
    v_mov_b32 v18, 6
    s_waitcnt vmcnt(10)
    ds_write_b32 v3, v18 offset:32
    v_mov_b32 v18, 7
    s_waitcnt vmcnt(9)
    ds_write_b32 v3, v18 offset:32
    v_mov_b32 v18, 8
    s_waitcnt vmcnt(8)
    ds_write_b32 v3, v18 offset:32
    v_mov_b32 v18, 9
    s_waitcnt vmcnt(7)
    ds_write_b32 v3, v18 offset:32
    v_mov_b32 v18, 10
    s_waitcnt vmcnt(6)
    ds_write_b32 v3, v18 offset:32
    v_mov_b32 v18, 11
    s_waitcnt vmcnt(5)
    ds_write_b32 v3, v18 offset:32
    v_mov_b32 v18, 12
    s_waitcnt vmcnt(4)
    ds_write_b32 v3, v18 offset:32
    v_mov_b32 v18, 13
    s_waitcnt vmcnt(3)
    ds_write_b32 v3, v18 offset:32
    v_mov_b32 v18, 14
    s_waitcnt vmcnt(2)
    ds_write_b32 v3, v18 offset:32
    v_mov_b32 v18, 15
    s_waitcnt vmcnt(1)
    ds_write_b32 v3, v18 offset:32
    v_mov_b32 v18, 16
    s_waitcnt vmcnt(0)
    ds_write_b32 v3, v18 offset:32
    s_waitcnt lgkmcnt(0)
L_end:
    s_endpgm
.section .rodata,"a"
.p2align 6
.amdhsa_kernel standalone__kv_cache_quant_pre_rope_vs_post_rope__decode_kernel
  .amdhsa_next_free_vgpr 168
  .amdhsa_next_free_sgpr 102
  .amdhsa_accum_offset 168
  .amdhsa_group_segment_fixed_size 0
  .amdhsa_kernarg_size 112
  .amdhsa_user_sgpr_count 2
  .amdhsa_user_sgpr_kernarg_segment_ptr 1
  .amdhsa_system_sgpr_workgroup_id_x 1
.end_amdhsa_kernel
```

```asm
; @launch grid=(256,1,1) block=(384,1,1) lds=79872
.amdgcn_target "amdgcn-amd-amdhsa--gfx950"
.text
.globl standalone__kv_cache_quant_pre_rope_vs_post_rope__decode_kernel
.p2align 8
.type standalone__kv_cache_quant_pre_rope_vs_post_rope__decode_kernel,@function
standalone__kv_cache_quant_pre_rope_vs_post_rope__decode_kernel:
    s_load_dwordx16 s[48:63], s[0:1], 0
    s_load_dwordx8 s[64:71], s[0:1], 64
    s_load_dwordx4 s[72:75], s[0:1], 96
    s_cmp_ge_u32 s2, 256
    s_cbranch_scc1 L_end
    v_lshrrev_b32 v18, 6, v0
    v_and_b32 v1, 63, v0
    v_readfirstlane_b32 s76, v18
    v_cmp_eq_u32 vcc, 4, v1
    v_lshlrev_b32 v7, 2, v1
    v_add_u32 v7, 77824, v7
    v_cndmask_b32 v19, 0, 20, vcc
    ds_write_b32 v7, v19
    s_and_b32 s92, s2, 7
    s_lshl_b32 s77, s92, 6
    s_and_b32 s92, s2, 0x60
    s_lshl4_add_u32 s77, s92, s77
    s_and_b32 s92, s2, 0x10
    s_lshl1_add_u32 s77, s92, s77
    s_lshr_b32 s92, s2, 7
    s_lshl4_add_u32 s77, s92, s77
    s_bfe_u32 s3, s2, 0x10003
    s_cselect_b32 s92, 0, 8192
    s_add_u32 s77, s77, s92
    s_cmp_lg_u32 s76, 0
    s_cbranch_scc1 L_other
    s_setprio 3
    v_lshlrev_b32 v2, 4, v1
    v_add_u32 v8, 784896, v2
    v_cmp_gt_u32 vcc, 32, v1
    s_mul_i32 s78, s77, 384
    s_mov_b32 s6, 6291456
    s_mov_b32 s7, 0x20000
    v_cndmask_b32 v4, v8, v2, vcc
    s_mov_b32 m0, 0
    s_mov_b32 s81, 0
    v_mov_b32 v6, 77844
    v_mov_b32 v5, -20
    s_waitcnt lgkmcnt(0)
    s_mov_b64 s[4:5], s[66:67]
L_i0:
    s_waitcnt vmcnt(19)
    buffer_load_dwordx4 v2, s[4:7], s78 offen offset:0  lds
    v_add_u32 v5, 3, v5
    s_add_u32 s81, s81, 1
    s_waitcnt vmcnt(19)
    buffer_load_dwordx4 v4, s[4:7], s78 offen offset:1024  lds
    s_and_b32 s92, s81, 3
    s_cselect_b32 s92, 0, -6144
    s_cmp_eq_u32 s81, 8
    s_cselect_b32 s93, 1572864, 0
    s_add_u32 s92, s92, s93
    s_bitcmp1_b32 s81, 2
    s_waitcnt vmcnt(19)
    buffer_load_dwordx4 v8, s[4:7], s78 offen offset:2048  lds
    ds_write_b32 v6, v5
    s_cselect_b64 s[4:5], s[68:69], s[66:67]
    s_addk_i32 m0, 3072
    s_addk_i32 s92, 1536
    s_add_u32 s78, s78, s92
    s_cmp_lg_u32 s81, 6
    s_cbranch_scc1 L_i1
    s_barrier
L_i1:
    s_cmp_lt_u32 s81, 16
    s_cbranch_scc1 L_i0
    ds_read_b32 v3, v7
    s_mul_i32 s79, s3, 12582912
    s_mov_b64 s[4:5], s[50:51]
    s_mov_b32 s6, 402653184
    s_mov_b32 s7, 0x20000
    s_mov_b32 m0, 0
    s_movk_i32 s85, 4096
    s_mov_b32 s81, 0
    s_mul_i32 s78, s77, 768
    s_add_u32 s78, s78, s79
    s_mov_b32 s82, 1
    s_waitcnt lgkmcnt(0)
    v_readlane_b32 s84, v3, 0
    s_and_b32 s87, s2, 127
    s_add_u32 s87, s87, 64
    s_nop 2
L_D20:
    s_mul_i32 s92, s81, 12
    s_add_u32 s92, s92, 28
    v_mov_b32 v5, s92
L_B20:
L_B20_0:
    s_cmp_lt_i32 s84, s82
    s_cbranch_scc1 L_B20_0w
    s_waitcnt vmcnt(19)
    buffer_load_dwordx4 v2, s[4:7], s78 offen offset:0 nt lds
    v_add_u32 v5, 3, v5
    s_add_u32 s81, s81, 1
    s_bfe_i32 s93, s81, 0x10007
    s_waitcnt vmcnt(19)
    buffer_load_dwordx4 v2, s[4:7], s78 offen offset:1024 nt lds
    v_readlane_b32 s84, v3, 1
    ds_read_b32 v3, v7
    s_xor_b32 s93, s93, s81
    s_waitcnt vmcnt(19)
    buffer_load_dwordx4 v2, s[4:7], s78 offen offset:2048 nt lds
    ds_write_b32 v6, v5
    s_and_b32 s92, s93, 7
    s_lshl_b32 s92, s92, 11
L_B20_1:
    s_cmp_lt_i32 s84, s82
    s_cbranch_scc1 L_B20_1w
    s_waitcnt vmcnt(19)
    buffer_load_dwordx4 v2, s[4:7], s78 offen offset:3072 nt lds
    v_add_u32 v5, 3, v5
    s_add_u32 m0, m0, s85
    s_add_u32 s78, s78, s85
    s_waitcnt vmcnt(19)
    buffer_load_dwordx4 v2, s[4:7], s78 offen offset:0 nt lds
    v_readlane_b32 s84, v3, 2
    ds_read_b32 v3, v7
    s_add_u32 s92, s92, s77
    s_waitcnt vmcnt(19)
    buffer_load_dwordx4 v2, s[4:7], s78 offen offset:1024 nt lds
    ds_write_b32 v6, v5
    s_and_b32 s92, s92, 16383
    s_mul_i32 s80, s92, 768
L_B20_2:
    s_cmp_lt_i32 s84, s82
    s_cbranch_scc1 L_B20_2w
    s_waitcnt vmcnt(19)
    buffer_load_dwordx4 v2, s[4:7], s78 offen offset:2048 nt lds
    v_add_u32 v5, 3, v5
    s_bfe_u32 s92, s93, 0x40003
    s_mul_i32 s92, s92, 25165824
    s_waitcnt vmcnt(19)
    buffer_load_dwordx4 v2, s[4:7], s78 offen offset:3072 nt lds
    v_readlane_b32 s84, v3, 3
    ds_read_b32 v3, v7
    s_add_u32 m0, m0, s85
    s_add_u32 s78, s78, s85
    s_waitcnt vmcnt(19)
    buffer_load_dwordx4 v2, s[4:7], s78 offen offset:0 nt lds
    ds_write_b32 v6, v5
    s_add_u32 s80, s80, s79
    s_add_u32 s80, s80, s92
L_B20_3:
    s_cmp_lt_i32 s84, s82
    s_cbranch_scc1 L_B20_3w
    s_waitcnt vmcnt(19)
    buffer_load_dwordx4 v2, s[4:7], s78 offen offset:1024 nt lds
    v_add_u32 v5, 3, v5
    v_readlane_b32 s83, v3, 4
    s_and_b32 s86, s81, 3
    s_mul_i32 s86, s86, 12288
    s_waitcnt vmcnt(19)
    buffer_load_dwordx4 v2, s[4:7], s78 offen offset:2048 nt lds
    v_readlane_b32 s84, v3, 0
    ds_read_b32 v3, v7
    s_add_u32 s82, s82, 1
    s_cmp_eq_u32 s81, s87
    s_cselect_b32 s83, -1, s83
    s_cmp_ge_u32 s81, 128
    s_waitcnt vmcnt(19)
    buffer_load_dwordx4 v2, s[4:7], s78 offen offset:3072 nt lds
    ds_write_b32 v6, v5
    s_cselect_b64 s[4:5], s[56:57], s[50:51]
    s_mov_b32 m0, s86
    s_mov_b32 s78, s80
    s_cmp_eq_u32 s83, 20
    s_cbranch_scc1 L_B20
    s_cmp_eq_u32 s83, -1
    s_cbranch_scc1 L_D32
L_disp:
    s_cmp_eq_u32 s83, 20
    s_cbranch_scc1 L_D20
    s_cmp_eq_u32 s83, 21
    s_cbranch_scc1 L_D21
    s_cmp_eq_u32 s83, 19
    s_cbranch_scc1 L_D19
    s_cmp_eq_u32 s83, 22
    s_cbranch_scc1 L_D22
    s_cmp_eq_u32 s83, 18
    s_cbranch_scc1 L_D18
    s_cmp_eq_u32 s83, 23
    s_cbranch_scc1 L_D23
    s_cmp_eq_u32 s83, 17
    s_cbranch_scc1 L_D17
    s_cmp_eq_u32 s83, 24
    s_cbranch_scc1 L_D24
    s_cmp_eq_u32 s83, 16
    s_cbranch_scc1 L_D16
    s_cmp_eq_u32 s83, 25
    s_cbranch_scc1 L_D25
    s_cmp_ge_i32 s83, 26
    s_cbranch_scc1 L_D26
    s_branch L_D15
L_D19:
    s_mul_i32 s92, s81, 12
    s_add_u32 s92, s92, 29
    v_mov_b32 v5, s92
L_B19:
L_B19_0:
    s_cmp_lt_i32 s84, s82
    s_cbranch_scc1 L_B19_0w
    s_waitcnt vmcnt(18)
    buffer_load_dwordx4 v2, s[4:7], s78 offen offset:0 nt lds
    v_add_u32 v5, 3, v5
    s_add_u32 s81, s81, 1
    s_bfe_i32 s93, s81, 0x10007
    s_waitcnt vmcnt(18)
    buffer_load_dwordx4 v2, s[4:7], s78 offen offset:1024 nt lds
    v_readlane_b32 s84, v3, 1
    ds_read_b32 v3, v7
    s_xor_b32 s93, s93, s81
    s_waitcnt vmcnt(18)
    buffer_load_dwordx4 v2, s[4:7], s78 offen offset:2048 nt lds
    ds_write_b32 v6, v5
    s_and_b32 s92, s93, 7
    s_lshl_b32 s92, s92, 11
L_B19_1:
    s_cmp_lt_i32 s84, s82
    s_cbranch_scc1 L_B19_1w
    s_waitcnt vmcnt(18)
    buffer_load_dwordx4 v2, s[4:7], s78 offen offset:3072 nt lds
    v_add_u32 v5, 3, v5
    s_add_u32 m0, m0, s85
    s_add_u32 s78, s78, s85
    s_waitcnt vmcnt(18)
    buffer_load_dwordx4 v2, s[4:7], s78 offen offset:0 nt lds
    v_readlane_b32 s84, v3, 2
    ds_read_b32 v3, v7
    s_add_u32 s92, s92, s77
    s_waitcnt vmcnt(18)
    buffer_load_dwordx4 v2, s[4:7], s78 offen offset:1024 nt lds
    ds_write_b32 v6, v5
    s_and_b32 s92, s92, 16383
    s_mul_i32 s80, s92, 768
L_B19_2:
    s_cmp_lt_i32 s84, s82
    s_cbranch_scc1 L_B19_2w
    s_waitcnt vmcnt(18)
    buffer_load_dwordx4 v2, s[4:7], s78 offen offset:2048 nt lds
    v_add_u32 v5, 3, v5
    s_bfe_u32 s92, s93, 0x40003
    s_mul_i32 s92, s92, 25165824
    s_waitcnt vmcnt(18)
    buffer_load_dwordx4 v2, s[4:7], s78 offen offset:3072 nt lds
    v_readlane_b32 s84, v3, 3
    ds_read_b32 v3, v7
    s_add_u32 m0, m0, s85
    s_add_u32 s78, s78, s85
    s_waitcnt vmcnt(18)
    buffer_load_dwordx4 v2, s[4:7], s78 offen offset:0 nt lds
    ds_write_b32 v6, v5
    s_add_u32 s80, s80, s79
    s_add_u32 s80, s80, s92
L_B19_3:
    s_cmp_lt_i32 s84, s82
    s_cbranch_scc1 L_B19_3w
    s_waitcnt vmcnt(18)
    buffer_load_dwordx4 v2, s[4:7], s78 offen offset:1024 nt lds
    v_add_u32 v5, 3, v5
    v_readlane_b32 s83, v3, 4
    s_and_b32 s86, s81, 3
    s_mul_i32 s86, s86, 12288
    s_waitcnt vmcnt(18)
    buffer_load_dwordx4 v2, s[4:7], s78 offen offset:2048 nt lds
    v_readlane_b32 s84, v3, 0
    ds_read_b32 v3, v7
    s_add_u32 s82, s82, 1
    s_cmp_eq_u32 s81, s87
    s_cselect_b32 s83, -1, s83
    s_cmp_ge_u32 s81, 128
    s_waitcnt vmcnt(18)
    buffer_load_dwordx4 v2, s[4:7], s78 offen offset:3072 nt lds
    ds_write_b32 v6, v5
    s_cselect_b64 s[4:5], s[56:57], s[50:51]
    s_mov_b32 m0, s86
    s_mov_b32 s78, s80
    s_cmp_eq_u32 s83, 19
    s_cbranch_scc1 L_B19
    s_cmp_eq_u32 s83, -1
    s_cbranch_scc1 L_D32
    s_cmp_eq_u32 s83, 20
    s_cbranch_scc1 L_D20
    s_cmp_eq_u32 s83, 18
    s_cbranch_scc1 L_D18
    s_branch L_disp
L_D21:
    s_mul_i32 s92, s81, 12
    s_add_u32 s92, s92, 27
    v_mov_b32 v5, s92
L_B21:
L_B21_0:
    s_cmp_lt_i32 s84, s82
    s_cbranch_scc1 L_B21_0w
    s_waitcnt vmcnt(20)
    buffer_load_dwordx4 v2, s[4:7], s78 offen offset:0 nt lds
    v_add_u32 v5, 3, v5
    s_add_u32 s81, s81, 1
    s_bfe_i32 s93, s81, 0x10007
    s_waitcnt vmcnt(20)
    buffer_load_dwordx4 v2, s[4:7], s78 offen offset:1024 nt lds
    v_readlane_b32 s84, v3, 1
    ds_read_b32 v3, v7
    s_xor_b32 s93, s93, s81
    s_waitcnt vmcnt(20)
    buffer_load_dwordx4 v2, s[4:7], s78 offen offset:2048 nt lds
    ds_write_b32 v6, v5
    s_and_b32 s92, s93, 7
    s_lshl_b32 s92, s92, 11
L_B21_1:
    s_cmp_lt_i32 s84, s82
    s_cbranch_scc1 L_B21_1w
    s_waitcnt vmcnt(20)
    buffer_load_dwordx4 v2, s[4:7], s78 offen offset:3072 nt lds
    v_add_u32 v5, 3, v5
    s_add_u32 m0, m0, s85
    s_add_u32 s78, s78, s85
    s_waitcnt vmcnt(20)
    buffer_load_dwordx4 v2, s[4:7], s78 offen offset:0 nt lds
    v_readlane_b32 s84, v3, 2
    ds_read_b32 v3, v7
    s_add_u32 s92, s92, s77
    s_waitcnt vmcnt(20)
    buffer_load_dwordx4 v2, s[4:7], s78 offen offset:1024 nt lds
    ds_write_b32 v6, v5
    s_and_b32 s92, s92, 16383
    s_mul_i32 s80, s92, 768
L_B21_2:
    s_cmp_lt_i32 s84, s82
    s_cbranch_scc1 L_B21_2w
    s_waitcnt vmcnt(20)
    buffer_load_dwordx4 v2, s[4:7], s78 offen offset:2048 nt lds
    v_add_u32 v5, 3, v5
    s_bfe_u32 s92, s93, 0x40003
    s_mul_i32 s92, s92, 25165824
    s_waitcnt vmcnt(20)
    buffer_load_dwordx4 v2, s[4:7], s78 offen offset:3072 nt lds
    v_readlane_b32 s84, v3, 3
    ds_read_b32 v3, v7
    s_add_u32 m0, m0, s85
    s_add_u32 s78, s78, s85
    s_waitcnt vmcnt(20)
    buffer_load_dwordx4 v2, s[4:7], s78 offen offset:0 nt lds
    ds_write_b32 v6, v5
    s_add_u32 s80, s80, s79
    s_add_u32 s80, s80, s92
L_B21_3:
    s_cmp_lt_i32 s84, s82
    s_cbranch_scc1 L_B21_3w
    s_waitcnt vmcnt(20)
    buffer_load_dwordx4 v2, s[4:7], s78 offen offset:1024 nt lds
    v_add_u32 v5, 3, v5
    v_readlane_b32 s83, v3, 4
    s_and_b32 s86, s81, 3
    s_mul_i32 s86, s86, 12288
    s_waitcnt vmcnt(20)
    buffer_load_dwordx4 v2, s[4:7], s78 offen offset:2048 nt lds
    v_readlane_b32 s84, v3, 0
    ds_read_b32 v3, v7
    s_add_u32 s82, s82, 1
    s_cmp_eq_u32 s81, s87
    s_cselect_b32 s83, -1, s83
    s_cmp_ge_u32 s81, 128
    s_waitcnt vmcnt(20)
    buffer_load_dwordx4 v2, s[4:7], s78 offen offset:3072 nt lds
    ds_write_b32 v6, v5
    s_cselect_b64 s[4:5], s[56:57], s[50:51]
    s_mov_b32 m0, s86
    s_mov_b32 s78, s80
    s_cmp_eq_u32 s83, 21
    s_cbranch_scc1 L_B21
    s_cmp_eq_u32 s83, -1
    s_cbranch_scc1 L_D32
    s_cmp_eq_u32 s83, 20
    s_cbranch_scc1 L_D20
    s_cmp_eq_u32 s83, 22
    s_cbranch_scc1 L_D22
    s_branch L_disp
L_D18:
    s_mul_i32 s92, s81, 12
    s_add_u32 s92, s92, 30
    v_mov_b32 v5, s92
L_B18:
L_B18_0:
    s_cmp_lt_i32 s84, s82
    s_cbranch_scc1 L_B18_0w
    s_waitcnt vmcnt(17)
    buffer_load_dwordx4 v2, s[4:7], s78 offen offset:0 nt lds
    v_add_u32 v5, 3, v5
    s_add_u32 s81, s81, 1
    s_bfe_i32 s93, s81, 0x10007
    s_waitcnt vmcnt(17)
    buffer_load_dwordx4 v2, s[4:7], s78 offen offset:1024 nt lds
    v_readlane_b32 s84, v3, 1
    ds_read_b32 v3, v7
    s_xor_b32 s93, s93, s81
    s_waitcnt vmcnt(17)
    buffer_load_dwordx4 v2, s[4:7], s78 offen offset:2048 nt lds
    ds_write_b32 v6, v5
    s_and_b32 s92, s93, 7
    s_lshl_b32 s92, s92, 11
L_B18_1:
    s_cmp_lt_i32 s84, s82
    s_cbranch_scc1 L_B18_1w
    s_waitcnt vmcnt(17)
    buffer_load_dwordx4 v2, s[4:7], s78 offen offset:3072 nt lds
    v_add_u32 v5, 3, v5
    s_add_u32 m0, m0, s85
    s_add_u32 s78, s78, s85
    s_waitcnt vmcnt(17)
    buffer_load_dwordx4 v2, s[4:7], s78 offen offset:0 nt lds
    v_readlane_b32 s84, v3, 2
    ds_read_b32 v3, v7
    s_add_u32 s92, s92, s77
    s_waitcnt vmcnt(17)
    buffer_load_dwordx4 v2, s[4:7], s78 offen offset:1024 nt lds
    ds_write_b32 v6, v5
    s_and_b32 s92, s92, 16383
    s_mul_i32 s80, s92, 768
L_B18_2:
    s_cmp_lt_i32 s84, s82
    s_cbranch_scc1 L_B18_2w
    s_waitcnt vmcnt(17)
    buffer_load_dwordx4 v2, s[4:7], s78 offen offset:2048 nt lds
    v_add_u32 v5, 3, v5
    s_bfe_u32 s92, s93, 0x40003
    s_mul_i32 s92, s92, 25165824
    s_waitcnt vmcnt(17)
    buffer_load_dwordx4 v2, s[4:7], s78 offen offset:3072 nt lds
    v_readlane_b32 s84, v3, 3
    ds_read_b32 v3, v7
    s_add_u32 m0, m0, s85
    s_add_u32 s78, s78, s85
    s_waitcnt vmcnt(17)
    buffer_load_dwordx4 v2, s[4:7], s78 offen offset:0 nt lds
    ds_write_b32 v6, v5
    s_add_u32 s80, s80, s79
    s_add_u32 s80, s80, s92
L_B18_3:
    s_cmp_lt_i32 s84, s82
    s_cbranch_scc1 L_B18_3w
    s_waitcnt vmcnt(17)
    buffer_load_dwordx4 v2, s[4:7], s78 offen offset:1024 nt lds
    v_add_u32 v5, 3, v5
    v_readlane_b32 s83, v3, 4
    s_and_b32 s86, s81, 3
    s_mul_i32 s86, s86, 12288
    s_waitcnt vmcnt(17)
    buffer_load_dwordx4 v2, s[4:7], s78 offen offset:2048 nt lds
    v_readlane_b32 s84, v3, 0
    ds_read_b32 v3, v7
    s_add_u32 s82, s82, 1
    s_cmp_eq_u32 s81, s87
    s_cselect_b32 s83, -1, s83
    s_cmp_ge_u32 s81, 128
    s_waitcnt vmcnt(17)
    buffer_load_dwordx4 v2, s[4:7], s78 offen offset:3072 nt lds
    ds_write_b32 v6, v5
    s_cselect_b64 s[4:5], s[56:57], s[50:51]
    s_mov_b32 m0, s86
    s_mov_b32 s78, s80
    s_cmp_eq_u32 s83, 18
    s_cbranch_scc1 L_B18
    s_cmp_eq_u32 s83, -1
    s_cbranch_scc1 L_D32
    s_cmp_eq_u32 s83, 19
    s_cbranch_scc1 L_D19
    s_cmp_eq_u32 s83, 17
    s_cbranch_scc1 L_D17
    s_branch L_disp
L_D22:
    s_mul_i32 s92, s81, 12
    s_add_u32 s92, s92, 26
    v_mov_b32 v5, s92
L_B22:
L_B22_0:
    s_cmp_lt_i32 s84, s82
    s_cbranch_scc1 L_B22_0w
    s_waitcnt vmcnt(21)
    buffer_load_dwordx4 v2, s[4:7], s78 offen offset:0 nt lds
    v_add_u32 v5, 3, v5
    s_add_u32 s81, s81, 1
    s_bfe_i32 s93, s81, 0x10007
    s_waitcnt vmcnt(21)
    buffer_load_dwordx4 v2, s[4:7], s78 offen offset:1024 nt lds
    v_readlane_b32 s84, v3, 1
    ds_read_b32 v3, v7
    s_xor_b32 s93, s93, s81
    s_waitcnt vmcnt(21)
    buffer_load_dwordx4 v2, s[4:7], s78 offen offset:2048 nt lds
    ds_write_b32 v6, v5
    s_and_b32 s92, s93, 7
    s_lshl_b32 s92, s92, 11
L_B22_1:
    s_cmp_lt_i32 s84, s82
    s_cbranch_scc1 L_B22_1w
    s_waitcnt vmcnt(21)
    buffer_load_dwordx4 v2, s[4:7], s78 offen offset:3072 nt lds
    v_add_u32 v5, 3, v5
    s_add_u32 m0, m0, s85
    s_add_u32 s78, s78, s85
    s_waitcnt vmcnt(21)
    buffer_load_dwordx4 v2, s[4:7], s78 offen offset:0 nt lds
    v_readlane_b32 s84, v3, 2
    ds_read_b32 v3, v7
    s_add_u32 s92, s92, s77
    s_waitcnt vmcnt(21)
    buffer_load_dwordx4 v2, s[4:7], s78 offen offset:1024 nt lds
    ds_write_b32 v6, v5
    s_and_b32 s92, s92, 16383
    s_mul_i32 s80, s92, 768
L_B22_2:
    s_cmp_lt_i32 s84, s82
    s_cbranch_scc1 L_B22_2w
    s_waitcnt vmcnt(21)
    buffer_load_dwordx4 v2, s[4:7], s78 offen offset:2048 nt lds
    v_add_u32 v5, 3, v5
    s_bfe_u32 s92, s93, 0x40003
    s_mul_i32 s92, s92, 25165824
    s_waitcnt vmcnt(21)
    buffer_load_dwordx4 v2, s[4:7], s78 offen offset:3072 nt lds
    v_readlane_b32 s84, v3, 3
    ds_read_b32 v3, v7
    s_add_u32 m0, m0, s85
    s_add_u32 s78, s78, s85
    s_waitcnt vmcnt(21)
    buffer_load_dwordx4 v2, s[4:7], s78 offen offset:0 nt lds
    ds_write_b32 v6, v5
    s_add_u32 s80, s80, s79
    s_add_u32 s80, s80, s92
L_B22_3:
    s_cmp_lt_i32 s84, s82
    s_cbranch_scc1 L_B22_3w
    s_waitcnt vmcnt(21)
    buffer_load_dwordx4 v2, s[4:7], s78 offen offset:1024 nt lds
    v_add_u32 v5, 3, v5
    v_readlane_b32 s83, v3, 4
    s_and_b32 s86, s81, 3
    s_mul_i32 s86, s86, 12288
    s_waitcnt vmcnt(21)
    buffer_load_dwordx4 v2, s[4:7], s78 offen offset:2048 nt lds
    v_readlane_b32 s84, v3, 0
    ds_read_b32 v3, v7
    s_add_u32 s82, s82, 1
    s_cmp_eq_u32 s81, s87
    s_cselect_b32 s83, -1, s83
    s_cmp_ge_u32 s81, 128
    s_waitcnt vmcnt(21)
    buffer_load_dwordx4 v2, s[4:7], s78 offen offset:3072 nt lds
    ds_write_b32 v6, v5
    s_cselect_b64 s[4:5], s[56:57], s[50:51]
    s_mov_b32 m0, s86
    s_mov_b32 s78, s80
    s_cmp_eq_u32 s83, 22
    s_cbranch_scc1 L_B22
    s_cmp_eq_u32 s83, -1
    s_cbranch_scc1 L_D32
    s_cmp_eq_u32 s83, 21
    s_cbranch_scc1 L_D21
    s_cmp_eq_u32 s83, 23
    s_cbranch_scc1 L_D23
    s_branch L_disp
L_D17:
    s_mul_i32 s92, s81, 12
    s_add_u32 s92, s92, 31
    v_mov_b32 v5, s92
L_B17:
L_B17_0:
    s_cmp_lt_i32 s84, s82
    s_cbranch_scc1 L_B17_0w
    s_waitcnt vmcnt(16)
    buffer_load_dwordx4 v2, s[4:7], s78 offen offset:0 nt lds
    v_add_u32 v5, 3, v5
    s_add_u32 s81, s81, 1
    s_bfe_i32 s93, s81, 0x10007
    s_waitcnt vmcnt(16)
    buffer_load_dwordx4 v2, s[4:7], s78 offen offset:1024 nt lds
    v_readlane_b32 s84, v3, 1
    ds_read_b32 v3, v7
    s_xor_b32 s93, s93, s81
    s_waitcnt vmcnt(16)
    buffer_load_dwordx4 v2, s[4:7], s78 offen offset:2048 nt lds
    ds_write_b32 v6, v5
    s_and_b32 s92, s93, 7
    s_lshl_b32 s92, s92, 11
L_B17_1:
    s_cmp_lt_i32 s84, s82
    s_cbranch_scc1 L_B17_1w
    s_waitcnt vmcnt(16)
    buffer_load_dwordx4 v2, s[4:7], s78 offen offset:3072 nt lds
    v_add_u32 v5, 3, v5
    s_add_u32 m0, m0, s85
    s_add_u32 s78, s78, s85
    s_waitcnt vmcnt(16)
    buffer_load_dwordx4 v2, s[4:7], s78 offen offset:0 nt lds
    v_readlane_b32 s84, v3, 2
    ds_read_b32 v3, v7
    s_add_u32 s92, s92, s77
    s_waitcnt vmcnt(16)
    buffer_load_dwordx4 v2, s[4:7], s78 offen offset:1024 nt lds
    ds_write_b32 v6, v5
    s_and_b32 s92, s92, 16383
    s_mul_i32 s80, s92, 768
L_B17_2:
    s_cmp_lt_i32 s84, s82
    s_cbranch_scc1 L_B17_2w
    s_waitcnt vmcnt(16)
    buffer_load_dwordx4 v2, s[4:7], s78 offen offset:2048 nt lds
    v_add_u32 v5, 3, v5
    s_bfe_u32 s92, s93, 0x40003
    s_mul_i32 s92, s92, 25165824
    s_waitcnt vmcnt(16)
    buffer_load_dwordx4 v2, s[4:7], s78 offen offset:3072 nt lds
    v_readlane_b32 s84, v3, 3
    ds_read_b32 v3, v7
    s_add_u32 m0, m0, s85
    s_add_u32 s78, s78, s85
    s_waitcnt vmcnt(16)
    buffer_load_dwordx4 v2, s[4:7], s78 offen offset:0 nt lds
    ds_write_b32 v6, v5
    s_add_u32 s80, s80, s79
    s_add_u32 s80, s80, s92
L_B17_3:
    s_cmp_lt_i32 s84, s82
    s_cbranch_scc1 L_B17_3w
    s_waitcnt vmcnt(16)
    buffer_load_dwordx4 v2, s[4:7], s78 offen offset:1024 nt lds
    v_add_u32 v5, 3, v5
    v_readlane_b32 s83, v3, 4
    s_and_b32 s86, s81, 3
    s_mul_i32 s86, s86, 12288
    s_waitcnt vmcnt(16)
    buffer_load_dwordx4 v2, s[4:7], s78 offen offset:2048 nt lds
    v_readlane_b32 s84, v3, 0
    ds_read_b32 v3, v7
    s_add_u32 s82, s82, 1
    s_cmp_eq_u32 s81, s87
    s_cselect_b32 s83, -1, s83
    s_cmp_ge_u32 s81, 128
    s_waitcnt vmcnt(16)
    buffer_load_dwordx4 v2, s[4:7], s78 offen offset:3072 nt lds
    ds_write_b32 v6, v5
    s_cselect_b64 s[4:5], s[56:57], s[50:51]
    s_mov_b32 m0, s86
    s_mov_b32 s78, s80
    s_cmp_eq_u32 s83, 17
    s_cbranch_scc1 L_B17
    s_cmp_eq_u32 s83, -1
    s_cbranch_scc1 L_D32
    s_cmp_eq_u32 s83, 18
    s_cbranch_scc1 L_D18
    s_cmp_eq_u32 s83, 16
    s_cbranch_scc1 L_D16
    s_branch L_disp
L_D23:
    s_mul_i32 s92, s81, 12
    s_add_u32 s92, s92, 25
    v_mov_b32 v5, s92
L_B23:
L_B23_0:
    s_cmp_lt_i32 s84, s82
    s_cbranch_scc1 L_B23_0w
    s_waitcnt vmcnt(22)
    buffer_load_dwordx4 v2, s[4:7], s78 offen offset:0 nt lds
    v_add_u32 v5, 3, v5
    s_add_u32 s81, s81, 1
    s_bfe_i32 s93, s81, 0x10007
    s_waitcnt vmcnt(22)
    buffer_load_dwordx4 v2, s[4:7], s78 offen offset:1024 nt lds
    v_readlane_b32 s84, v3, 1
    ds_read_b32 v3, v7
    s_xor_b32 s93, s93, s81
    s_waitcnt vmcnt(22)
    buffer_load_dwordx4 v2, s[4:7], s78 offen offset:2048 nt lds
    ds_write_b32 v6, v5
    s_and_b32 s92, s93, 7
    s_lshl_b32 s92, s92, 11
L_B23_1:
    s_cmp_lt_i32 s84, s82
    s_cbranch_scc1 L_B23_1w
    s_waitcnt vmcnt(22)
    buffer_load_dwordx4 v2, s[4:7], s78 offen offset:3072 nt lds
    v_add_u32 v5, 3, v5
    s_add_u32 m0, m0, s85
    s_add_u32 s78, s78, s85
    s_waitcnt vmcnt(22)
    buffer_load_dwordx4 v2, s[4:7], s78 offen offset:0 nt lds
    v_readlane_b32 s84, v3, 2
    ds_read_b32 v3, v7
    s_add_u32 s92, s92, s77
    s_waitcnt vmcnt(22)
    buffer_load_dwordx4 v2, s[4:7], s78 offen offset:1024 nt lds
    ds_write_b32 v6, v5
    s_and_b32 s92, s92, 16383
    s_mul_i32 s80, s92, 768
L_B23_2:
    s_cmp_lt_i32 s84, s82
    s_cbranch_scc1 L_B23_2w
    s_waitcnt vmcnt(22)
    buffer_load_dwordx4 v2, s[4:7], s78 offen offset:2048 nt lds
    v_add_u32 v5, 3, v5
    s_bfe_u32 s92, s93, 0x40003
    s_mul_i32 s92, s92, 25165824
    s_waitcnt vmcnt(22)
    buffer_load_dwordx4 v2, s[4:7], s78 offen offset:3072 nt lds
    v_readlane_b32 s84, v3, 3
    ds_read_b32 v3, v7
    s_add_u32 m0, m0, s85
    s_add_u32 s78, s78, s85
    s_waitcnt vmcnt(22)
    buffer_load_dwordx4 v2, s[4:7], s78 offen offset:0 nt lds
    ds_write_b32 v6, v5
    s_add_u32 s80, s80, s79
    s_add_u32 s80, s80, s92
L_B23_3:
    s_cmp_lt_i32 s84, s82
    s_cbranch_scc1 L_B23_3w
    s_waitcnt vmcnt(22)
    buffer_load_dwordx4 v2, s[4:7], s78 offen offset:1024 nt lds
    v_add_u32 v5, 3, v5
    v_readlane_b32 s83, v3, 4
    s_and_b32 s86, s81, 3
    s_mul_i32 s86, s86, 12288
    s_waitcnt vmcnt(22)
    buffer_load_dwordx4 v2, s[4:7], s78 offen offset:2048 nt lds
    v_readlane_b32 s84, v3, 0
    ds_read_b32 v3, v7
    s_add_u32 s82, s82, 1
    s_cmp_eq_u32 s81, s87
    s_cselect_b32 s83, -1, s83
    s_cmp_ge_u32 s81, 128
    s_waitcnt vmcnt(22)
    buffer_load_dwordx4 v2, s[4:7], s78 offen offset:3072 nt lds
    ds_write_b32 v6, v5
    s_cselect_b64 s[4:5], s[56:57], s[50:51]
    s_mov_b32 m0, s86
    s_mov_b32 s78, s80
    s_cmp_eq_u32 s83, 23
    s_cbranch_scc1 L_B23
    s_cmp_eq_u32 s83, -1
    s_cbranch_scc1 L_D32
    s_cmp_eq_u32 s83, 22
    s_cbranch_scc1 L_D22
    s_cmp_eq_u32 s83, 24
    s_cbranch_scc1 L_D24
    s_branch L_disp
L_D16:
    s_mul_i32 s92, s81, 12
    s_add_u32 s92, s92, 32
    v_mov_b32 v5, s92
L_B16:
L_B16_0:
    s_cmp_lt_i32 s84, s82
    s_cbranch_scc1 L_B16_0w
    s_waitcnt vmcnt(15)
    buffer_load_dwordx4 v2, s[4:7], s78 offen offset:0 nt lds
    v_add_u32 v5, 3, v5
    s_add_u32 s81, s81, 1
    s_bfe_i32 s93, s81, 0x10007
    s_waitcnt vmcnt(15)
    buffer_load_dwordx4 v2, s[4:7], s78 offen offset:1024 nt lds
    v_readlane_b32 s84, v3, 1
    ds_read_b32 v3, v7
    s_xor_b32 s93, s93, s81
    s_waitcnt vmcnt(15)
    buffer_load_dwordx4 v2, s[4:7], s78 offen offset:2048 nt lds
    ds_write_b32 v6, v5
    s_and_b32 s92, s93, 7
    s_lshl_b32 s92, s92, 11
L_B16_1:
    s_cmp_lt_i32 s84, s82
    s_cbranch_scc1 L_B16_1w
    s_waitcnt vmcnt(15)
    buffer_load_dwordx4 v2, s[4:7], s78 offen offset:3072 nt lds
    v_add_u32 v5, 3, v5
    s_add_u32 m0, m0, s85
    s_add_u32 s78, s78, s85
    s_waitcnt vmcnt(15)
    buffer_load_dwordx4 v2, s[4:7], s78 offen offset:0 nt lds
    v_readlane_b32 s84, v3, 2
    ds_read_b32 v3, v7
    s_add_u32 s92, s92, s77
    s_waitcnt vmcnt(15)
    buffer_load_dwordx4 v2, s[4:7], s78 offen offset:1024 nt lds
    ds_write_b32 v6, v5
    s_and_b32 s92, s92, 16383
    s_mul_i32 s80, s92, 768
L_B16_2:
    s_cmp_lt_i32 s84, s82
    s_cbranch_scc1 L_B16_2w
    s_waitcnt vmcnt(15)
    buffer_load_dwordx4 v2, s[4:7], s78 offen offset:2048 nt lds
    v_add_u32 v5, 3, v5
    s_bfe_u32 s92, s93, 0x40003
    s_mul_i32 s92, s92, 25165824
    s_waitcnt vmcnt(15)
    buffer_load_dwordx4 v2, s[4:7], s78 offen offset:3072 nt lds
    v_readlane_b32 s84, v3, 3
    ds_read_b32 v3, v7
    s_add_u32 m0, m0, s85
    s_add_u32 s78, s78, s85
    s_waitcnt vmcnt(15)
    buffer_load_dwordx4 v2, s[4:7], s78 offen offset:0 nt lds
    ds_write_b32 v6, v5
    s_add_u32 s80, s80, s79
    s_add_u32 s80, s80, s92
L_B16_3:
    s_cmp_lt_i32 s84, s82
    s_cbranch_scc1 L_B16_3w
    s_waitcnt vmcnt(15)
    buffer_load_dwordx4 v2, s[4:7], s78 offen offset:1024 nt lds
    v_add_u32 v5, 3, v5
    v_readlane_b32 s83, v3, 4
    s_and_b32 s86, s81, 3
    s_mul_i32 s86, s86, 12288
    s_waitcnt vmcnt(15)
    buffer_load_dwordx4 v2, s[4:7], s78 offen offset:2048 nt lds
    v_readlane_b32 s84, v3, 0
    ds_read_b32 v3, v7
    s_add_u32 s82, s82, 1
    s_cmp_eq_u32 s81, s87
    s_cselect_b32 s83, -1, s83
    s_cmp_ge_u32 s81, 128
    s_waitcnt vmcnt(15)
    buffer_load_dwordx4 v2, s[4:7], s78 offen offset:3072 nt lds
    ds_write_b32 v6, v5
    s_cselect_b64 s[4:5], s[56:57], s[50:51]
    s_mov_b32 m0, s86
    s_mov_b32 s78, s80
    s_cmp_eq_u32 s83, 16
    s_cbranch_scc1 L_B16
    s_cmp_eq_u32 s83, -1
    s_cbranch_scc1 L_D32
    s_cmp_eq_u32 s83, 17
    s_cbranch_scc1 L_D17
    s_cmp_eq_u32 s83, 15
    s_cbranch_scc1 L_D15
    s_branch L_disp
L_D24:
    s_mul_i32 s92, s81, 12
    s_add_u32 s92, s92, 24
    v_mov_b32 v5, s92
L_B24:
L_B24_0:
    s_cmp_lt_i32 s84, s82
    s_cbranch_scc1 L_B24_0w
    s_waitcnt vmcnt(23)
    buffer_load_dwordx4 v2, s[4:7], s78 offen offset:0 nt lds
    v_add_u32 v5, 3, v5
    s_add_u32 s81, s81, 1
    s_bfe_i32 s93, s81, 0x10007
    s_waitcnt vmcnt(23)
    buffer_load_dwordx4 v2, s[4:7], s78 offen offset:1024 nt lds
    v_readlane_b32 s84, v3, 1
    ds_read_b32 v3, v7
    s_xor_b32 s93, s93, s81
    s_waitcnt vmcnt(23)
    buffer_load_dwordx4 v2, s[4:7], s78 offen offset:2048 nt lds
    ds_write_b32 v6, v5
    s_and_b32 s92, s93, 7
    s_lshl_b32 s92, s92, 11
L_B24_1:
    s_cmp_lt_i32 s84, s82
    s_cbranch_scc1 L_B24_1w
    s_waitcnt vmcnt(23)
    buffer_load_dwordx4 v2, s[4:7], s78 offen offset:3072 nt lds
    v_add_u32 v5, 3, v5
    s_add_u32 m0, m0, s85
    s_add_u32 s78, s78, s85
    s_waitcnt vmcnt(23)
    buffer_load_dwordx4 v2, s[4:7], s78 offen offset:0 nt lds
    v_readlane_b32 s84, v3, 2
    ds_read_b32 v3, v7
    s_add_u32 s92, s92, s77
    s_waitcnt vmcnt(23)
    buffer_load_dwordx4 v2, s[4:7], s78 offen offset:1024 nt lds
    ds_write_b32 v6, v5
    s_and_b32 s92, s92, 16383
    s_mul_i32 s80, s92, 768
L_B24_2:
    s_cmp_lt_i32 s84, s82
    s_cbranch_scc1 L_B24_2w
    s_waitcnt vmcnt(23)
    buffer_load_dwordx4 v2, s[4:7], s78 offen offset:2048 nt lds
    v_add_u32 v5, 3, v5
    s_bfe_u32 s92, s93, 0x40003
    s_mul_i32 s92, s92, 25165824
    s_waitcnt vmcnt(23)
    buffer_load_dwordx4 v2, s[4:7], s78 offen offset:3072 nt lds
    v_readlane_b32 s84, v3, 3
    ds_read_b32 v3, v7
    s_add_u32 m0, m0, s85
    s_add_u32 s78, s78, s85
    s_waitcnt vmcnt(23)
    buffer_load_dwordx4 v2, s[4:7], s78 offen offset:0 nt lds
    ds_write_b32 v6, v5
    s_add_u32 s80, s80, s79
    s_add_u32 s80, s80, s92
L_B24_3:
    s_cmp_lt_i32 s84, s82
    s_cbranch_scc1 L_B24_3w
    s_waitcnt vmcnt(23)
    buffer_load_dwordx4 v2, s[4:7], s78 offen offset:1024 nt lds
    v_add_u32 v5, 3, v5
    v_readlane_b32 s83, v3, 4
    s_and_b32 s86, s81, 3
    s_mul_i32 s86, s86, 12288
    s_waitcnt vmcnt(23)
    buffer_load_dwordx4 v2, s[4:7], s78 offen offset:2048 nt lds
    v_readlane_b32 s84, v3, 0
    ds_read_b32 v3, v7
    s_add_u32 s82, s82, 1
    s_cmp_eq_u32 s81, s87
    s_cselect_b32 s83, -1, s83
    s_cmp_ge_u32 s81, 128
    s_waitcnt vmcnt(23)
    buffer_load_dwordx4 v2, s[4:7], s78 offen offset:3072 nt lds
    ds_write_b32 v6, v5
    s_cselect_b64 s[4:5], s[56:57], s[50:51]
    s_mov_b32 m0, s86
    s_mov_b32 s78, s80
    s_cmp_eq_u32 s83, 24
    s_cbranch_scc1 L_B24
    s_cmp_eq_u32 s83, -1
    s_cbranch_scc1 L_D32
    s_cmp_eq_u32 s83, 23
    s_cbranch_scc1 L_D23
    s_cmp_eq_u32 s83, 25
    s_cbranch_scc1 L_D25
    s_branch L_disp
L_D15:
    s_mul_i32 s92, s81, 12
    s_add_u32 s92, s92, 33
    v_mov_b32 v5, s92
L_B15:
L_B15_0:
    s_cmp_lt_i32 s84, s82
    s_cbranch_scc1 L_B15_0w
    s_waitcnt vmcnt(14)
    buffer_load_dwordx4 v2, s[4:7], s78 offen offset:0 nt lds
    v_add_u32 v5, 3, v5
    s_add_u32 s81, s81, 1
    s_bfe_i32 s93, s81, 0x10007
    s_waitcnt vmcnt(14)
    buffer_load_dwordx4 v2, s[4:7], s78 offen offset:1024 nt lds
    v_readlane_b32 s84, v3, 1
    ds_read_b32 v3, v7
    s_xor_b32 s93, s93, s81
    s_waitcnt vmcnt(14)
    buffer_load_dwordx4 v2, s[4:7], s78 offen offset:2048 nt lds
    ds_write_b32 v6, v5
    s_and_b32 s92, s93, 7
    s_lshl_b32 s92, s92, 11
L_B15_1:
    s_cmp_lt_i32 s84, s82
    s_cbranch_scc1 L_B15_1w
    s_waitcnt vmcnt(14)
    buffer_load_dwordx4 v2, s[4:7], s78 offen offset:3072 nt lds
    v_add_u32 v5, 3, v5
    s_add_u32 m0, m0, s85
    s_add_u32 s78, s78, s85
    s_waitcnt vmcnt(14)
    buffer_load_dwordx4 v2, s[4:7], s78 offen offset:0 nt lds
    v_readlane_b32 s84, v3, 2
    ds_read_b32 v3, v7
    s_add_u32 s92, s92, s77
    s_waitcnt vmcnt(14)
    buffer_load_dwordx4 v2, s[4:7], s78 offen offset:1024 nt lds
    ds_write_b32 v6, v5
    s_and_b32 s92, s92, 16383
    s_mul_i32 s80, s92, 768
L_B15_2:
    s_cmp_lt_i32 s84, s82
    s_cbranch_scc1 L_B15_2w
    s_waitcnt vmcnt(14)
    buffer_load_dwordx4 v2, s[4:7], s78 offen offset:2048 nt lds
    v_add_u32 v5, 3, v5
    s_bfe_u32 s92, s93, 0x40003
    s_mul_i32 s92, s92, 25165824
    s_waitcnt vmcnt(14)
    buffer_load_dwordx4 v2, s[4:7], s78 offen offset:3072 nt lds
    v_readlane_b32 s84, v3, 3
    ds_read_b32 v3, v7
    s_add_u32 m0, m0, s85
    s_add_u32 s78, s78, s85
    s_waitcnt vmcnt(14)
    buffer_load_dwordx4 v2, s[4:7], s78 offen offset:0 nt lds
    ds_write_b32 v6, v5
    s_add_u32 s80, s80, s79
    s_add_u32 s80, s80, s92
L_B15_3:
    s_cmp_lt_i32 s84, s82
    s_cbranch_scc1 L_B15_3w
    s_waitcnt vmcnt(14)
    buffer_load_dwordx4 v2, s[4:7], s78 offen offset:1024 nt lds
    v_add_u32 v5, 3, v5
    v_readlane_b32 s83, v3, 4
    s_and_b32 s86, s81, 3
    s_mul_i32 s86, s86, 12288
    s_waitcnt vmcnt(14)
    buffer_load_dwordx4 v2, s[4:7], s78 offen offset:2048 nt lds
    v_readlane_b32 s84, v3, 0
    ds_read_b32 v3, v7
    s_add_u32 s82, s82, 1
    s_cmp_eq_u32 s81, s87
    s_cselect_b32 s83, -1, s83
    s_cmp_ge_u32 s81, 128
    s_waitcnt vmcnt(14)
    buffer_load_dwordx4 v2, s[4:7], s78 offen offset:3072 nt lds
    ds_write_b32 v6, v5
    s_cselect_b64 s[4:5], s[56:57], s[50:51]
    s_mov_b32 m0, s86
    s_mov_b32 s78, s80
    s_cmp_eq_u32 s83, 15
    s_cbranch_scc1 L_B15
    s_cmp_eq_u32 s83, -1
    s_cbranch_scc1 L_D32
    s_cmp_eq_u32 s83, 16
    s_cbranch_scc1 L_D16
    s_branch L_disp
L_D25:
    s_mul_i32 s92, s81, 12
    s_add_u32 s92, s92, 23
    v_mov_b32 v5, s92
L_B25:
L_B25_0:
    s_cmp_lt_i32 s84, s82
    s_cbranch_scc1 L_B25_0w
    s_waitcnt vmcnt(24)
    buffer_load_dwordx4 v2, s[4:7], s78 offen offset:0 nt lds
    v_add_u32 v5, 3, v5
    s_add_u32 s81, s81, 1
    s_bfe_i32 s93, s81, 0x10007
    s_waitcnt vmcnt(24)
    buffer_load_dwordx4 v2, s[4:7], s78 offen offset:1024 nt lds
    v_readlane_b32 s84, v3, 1
    ds_read_b32 v3, v7
    s_xor_b32 s93, s93, s81
    s_waitcnt vmcnt(24)
    buffer_load_dwordx4 v2, s[4:7], s78 offen offset:2048 nt lds
    ds_write_b32 v6, v5
    s_and_b32 s92, s93, 7
    s_lshl_b32 s92, s92, 11
L_B25_1:
    s_cmp_lt_i32 s84, s82
    s_cbranch_scc1 L_B25_1w
    s_waitcnt vmcnt(24)
    buffer_load_dwordx4 v2, s[4:7], s78 offen offset:3072 nt lds
    v_add_u32 v5, 3, v5
    s_add_u32 m0, m0, s85
    s_add_u32 s78, s78, s85
    s_waitcnt vmcnt(24)
    buffer_load_dwordx4 v2, s[4:7], s78 offen offset:0 nt lds
    v_readlane_b32 s84, v3, 2
    ds_read_b32 v3, v7
    s_add_u32 s92, s92, s77
    s_waitcnt vmcnt(24)
    buffer_load_dwordx4 v2, s[4:7], s78 offen offset:1024 nt lds
    ds_write_b32 v6, v5
    s_and_b32 s92, s92, 16383
    s_mul_i32 s80, s92, 768
L_B25_2:
    s_cmp_lt_i32 s84, s82
    s_cbranch_scc1 L_B25_2w
    s_waitcnt vmcnt(24)
    buffer_load_dwordx4 v2, s[4:7], s78 offen offset:2048 nt lds
    v_add_u32 v5, 3, v5
    s_bfe_u32 s92, s93, 0x40003
    s_mul_i32 s92, s92, 25165824
    s_waitcnt vmcnt(24)
    buffer_load_dwordx4 v2, s[4:7], s78 offen offset:3072 nt lds
    v_readlane_b32 s84, v3, 3
    ds_read_b32 v3, v7
    s_add_u32 m0, m0, s85
    s_add_u32 s78, s78, s85
    s_waitcnt vmcnt(24)
    buffer_load_dwordx4 v2, s[4:7], s78 offen offset:0 nt lds
    ds_write_b32 v6, v5
    s_add_u32 s80, s80, s79
    s_add_u32 s80, s80, s92
L_B25_3:
    s_cmp_lt_i32 s84, s82
    s_cbranch_scc1 L_B25_3w
    s_waitcnt vmcnt(24)
    buffer_load_dwordx4 v2, s[4:7], s78 offen offset:1024 nt lds
    v_add_u32 v5, 3, v5
    v_readlane_b32 s83, v3, 4
    s_and_b32 s86, s81, 3
    s_mul_i32 s86, s86, 12288
    s_waitcnt vmcnt(24)
    buffer_load_dwordx4 v2, s[4:7], s78 offen offset:2048 nt lds
    v_readlane_b32 s84, v3, 0
    ds_read_b32 v3, v7
    s_add_u32 s82, s82, 1
    s_cmp_eq_u32 s81, s87
    s_cselect_b32 s83, -1, s83
    s_cmp_ge_u32 s81, 128
    s_waitcnt vmcnt(24)
    buffer_load_dwordx4 v2, s[4:7], s78 offen offset:3072 nt lds
    ds_write_b32 v6, v5
    s_cselect_b64 s[4:5], s[56:57], s[50:51]
    s_mov_b32 m0, s86
    s_mov_b32 s78, s80
    s_cmp_eq_u32 s83, 25
    s_cbranch_scc1 L_B25
    s_cmp_eq_u32 s83, -1
    s_cbranch_scc1 L_D32
    s_cmp_eq_u32 s83, 24
    s_cbranch_scc1 L_D24
    s_cmp_eq_u32 s83, 26
    s_cbranch_scc1 L_D26
    s_branch L_disp
L_D26:
    s_mul_i32 s92, s81, 12
    s_add_u32 s92, s92, 22
    v_mov_b32 v5, s92
L_B26:
L_B26_0:
    s_cmp_lt_i32 s84, s82
    s_cbranch_scc1 L_B26_0w
    s_waitcnt vmcnt(25)
    buffer_load_dwordx4 v2, s[4:7], s78 offen offset:0 nt lds
    v_add_u32 v5, 3, v5
    s_add_u32 s81, s81, 1
    s_bfe_i32 s93, s81, 0x10007
    s_waitcnt vmcnt(25)
    buffer_load_dwordx4 v2, s[4:7], s78 offen offset:1024 nt lds
    v_readlane_b32 s84, v3, 1
    ds_read_b32 v3, v7
    s_xor_b32 s93, s93, s81
    s_waitcnt vmcnt(25)
    buffer_load_dwordx4 v2, s[4:7], s78 offen offset:2048 nt lds
    ds_write_b32 v6, v5
    s_and_b32 s92, s93, 7
    s_lshl_b32 s92, s92, 11
L_B26_1:
    s_cmp_lt_i32 s84, s82
    s_cbranch_scc1 L_B26_1w
    s_waitcnt vmcnt(25)
    buffer_load_dwordx4 v2, s[4:7], s78 offen offset:3072 nt lds
    v_add_u32 v5, 3, v5
    s_add_u32 m0, m0, s85
    s_add_u32 s78, s78, s85
    s_waitcnt vmcnt(25)
    buffer_load_dwordx4 v2, s[4:7], s78 offen offset:0 nt lds
    v_readlane_b32 s84, v3, 2
    ds_read_b32 v3, v7
    s_add_u32 s92, s92, s77
    s_waitcnt vmcnt(25)
    buffer_load_dwordx4 v2, s[4:7], s78 offen offset:1024 nt lds
    ds_write_b32 v6, v5
    s_and_b32 s92, s92, 16383
    s_mul_i32 s80, s92, 768
L_B26_2:
    s_cmp_lt_i32 s84, s82
    s_cbranch_scc1 L_B26_2w
    s_waitcnt vmcnt(25)
    buffer_load_dwordx4 v2, s[4:7], s78 offen offset:2048 nt lds
    v_add_u32 v5, 3, v5
    s_bfe_u32 s92, s93, 0x40003
    s_mul_i32 s92, s92, 25165824
    s_waitcnt vmcnt(25)
    buffer_load_dwordx4 v2, s[4:7], s78 offen offset:3072 nt lds
    v_readlane_b32 s84, v3, 3
    ds_read_b32 v3, v7
    s_add_u32 m0, m0, s85
    s_add_u32 s78, s78, s85
    s_waitcnt vmcnt(25)
    buffer_load_dwordx4 v2, s[4:7], s78 offen offset:0 nt lds
    ds_write_b32 v6, v5
    s_add_u32 s80, s80, s79
    s_add_u32 s80, s80, s92
L_B26_3:
    s_cmp_lt_i32 s84, s82
    s_cbranch_scc1 L_B26_3w
    s_waitcnt vmcnt(25)
    buffer_load_dwordx4 v2, s[4:7], s78 offen offset:1024 nt lds
    v_add_u32 v5, 3, v5
    v_readlane_b32 s83, v3, 4
    s_and_b32 s86, s81, 3
    s_mul_i32 s86, s86, 12288
    s_waitcnt vmcnt(25)
    buffer_load_dwordx4 v2, s[4:7], s78 offen offset:2048 nt lds
    v_readlane_b32 s84, v3, 0
    ds_read_b32 v3, v7
    s_add_u32 s82, s82, 1
    s_cmp_eq_u32 s81, s87
    s_cselect_b32 s83, -1, s83
    s_cmp_ge_u32 s81, 128
    s_waitcnt vmcnt(25)
    buffer_load_dwordx4 v2, s[4:7], s78 offen offset:3072 nt lds
    ds_write_b32 v6, v5
    s_cselect_b64 s[4:5], s[56:57], s[50:51]
    s_mov_b32 m0, s86
    s_mov_b32 s78, s80
    s_cmp_eq_u32 s83, 26
    s_cbranch_scc1 L_B26
    s_cmp_eq_u32 s83, -1
    s_cbranch_scc1 L_D32
    s_cmp_eq_u32 s83, 25
    s_cbranch_scc1 L_D25
    s_branch L_disp
L_B20_0w:
    ds_read_b32 v3, v7
    s_waitcnt lgkmcnt(0)
    v_readlane_b32 s84, v3, 0
    s_nop 0
    s_branch L_B20_0
L_B20_1w:
    ds_read_b32 v3, v7
    s_waitcnt lgkmcnt(0)
    v_readlane_b32 s84, v3, 1
    s_nop 0
    s_branch L_B20_1
L_B20_2w:
    ds_read_b32 v3, v7
    s_waitcnt lgkmcnt(0)
    v_readlane_b32 s84, v3, 2
    s_nop 0
    s_branch L_B20_2
L_B20_3w:
    ds_read_b32 v3, v7
    s_waitcnt lgkmcnt(0)
    v_readlane_b32 s84, v3, 3
    s_nop 0
    s_branch L_B20_3
L_B19_0w:
    ds_read_b32 v3, v7
    s_waitcnt lgkmcnt(0)
    v_readlane_b32 s84, v3, 0
    s_nop 0
    s_branch L_B19_0
L_B19_1w:
    ds_read_b32 v3, v7
    s_waitcnt lgkmcnt(0)
    v_readlane_b32 s84, v3, 1
    s_nop 0
    s_branch L_B19_1
L_B19_2w:
    ds_read_b32 v3, v7
    s_waitcnt lgkmcnt(0)
    v_readlane_b32 s84, v3, 2
    s_nop 0
    s_branch L_B19_2
L_B19_3w:
    ds_read_b32 v3, v7
    s_waitcnt lgkmcnt(0)
    v_readlane_b32 s84, v3, 3
    s_nop 0
    s_branch L_B19_3
L_B21_0w:
    ds_read_b32 v3, v7
    s_waitcnt lgkmcnt(0)
    v_readlane_b32 s84, v3, 0
    s_nop 0
    s_branch L_B21_0
L_B21_1w:
    ds_read_b32 v3, v7
    s_waitcnt lgkmcnt(0)
    v_readlane_b32 s84, v3, 1
    s_nop 0
    s_branch L_B21_1
L_B21_2w:
    ds_read_b32 v3, v7
    s_waitcnt lgkmcnt(0)
    v_readlane_b32 s84, v3, 2
    s_nop 0
    s_branch L_B21_2
L_B21_3w:
    ds_read_b32 v3, v7
    s_waitcnt lgkmcnt(0)
    v_readlane_b32 s84, v3, 3
    s_nop 0
    s_branch L_B21_3
L_B18_0w:
    ds_read_b32 v3, v7
    s_waitcnt lgkmcnt(0)
    v_readlane_b32 s84, v3, 0
    s_nop 0
    s_branch L_B18_0
L_B18_1w:
    ds_read_b32 v3, v7
    s_waitcnt lgkmcnt(0)
    v_readlane_b32 s84, v3, 1
    s_nop 0
    s_branch L_B18_1
L_B18_2w:
    ds_read_b32 v3, v7
    s_waitcnt lgkmcnt(0)
    v_readlane_b32 s84, v3, 2
    s_nop 0
    s_branch L_B18_2
L_B18_3w:
    ds_read_b32 v3, v7
    s_waitcnt lgkmcnt(0)
    v_readlane_b32 s84, v3, 3
    s_nop 0
    s_branch L_B18_3
L_B22_0w:
    ds_read_b32 v3, v7
    s_waitcnt lgkmcnt(0)
    v_readlane_b32 s84, v3, 0
    s_nop 0
    s_branch L_B22_0
L_B22_1w:
    ds_read_b32 v3, v7
    s_waitcnt lgkmcnt(0)
    v_readlane_b32 s84, v3, 1
    s_nop 0
    s_branch L_B22_1
L_B22_2w:
    ds_read_b32 v3, v7
    s_waitcnt lgkmcnt(0)
    v_readlane_b32 s84, v3, 2
    s_nop 0
    s_branch L_B22_2
L_B22_3w:
    ds_read_b32 v3, v7
    s_waitcnt lgkmcnt(0)
    v_readlane_b32 s84, v3, 3
    s_nop 0
    s_branch L_B22_3
L_B17_0w:
    ds_read_b32 v3, v7
    s_waitcnt lgkmcnt(0)
    v_readlane_b32 s84, v3, 0
    s_nop 0
    s_branch L_B17_0
L_B17_1w:
    ds_read_b32 v3, v7
    s_waitcnt lgkmcnt(0)
    v_readlane_b32 s84, v3, 1
    s_nop 0
    s_branch L_B17_1
L_B17_2w:
    ds_read_b32 v3, v7
    s_waitcnt lgkmcnt(0)
    v_readlane_b32 s84, v3, 2
    s_nop 0
    s_branch L_B17_2
L_B17_3w:
    ds_read_b32 v3, v7
    s_waitcnt lgkmcnt(0)
    v_readlane_b32 s84, v3, 3
    s_nop 0
    s_branch L_B17_3
L_B23_0w:
    ds_read_b32 v3, v7
    s_waitcnt lgkmcnt(0)
    v_readlane_b32 s84, v3, 0
    s_nop 0
    s_branch L_B23_0
L_B23_1w:
    ds_read_b32 v3, v7
    s_waitcnt lgkmcnt(0)
    v_readlane_b32 s84, v3, 1
    s_nop 0
    s_branch L_B23_1
L_B23_2w:
    ds_read_b32 v3, v7
    s_waitcnt lgkmcnt(0)
    v_readlane_b32 s84, v3, 2
    s_nop 0
    s_branch L_B23_2
L_B23_3w:
    ds_read_b32 v3, v7
    s_waitcnt lgkmcnt(0)
    v_readlane_b32 s84, v3, 3
    s_nop 0
    s_branch L_B23_3
L_B16_0w:
    ds_read_b32 v3, v7
    s_waitcnt lgkmcnt(0)
    v_readlane_b32 s84, v3, 0
    s_nop 0
    s_branch L_B16_0
L_B16_1w:
    ds_read_b32 v3, v7
    s_waitcnt lgkmcnt(0)
    v_readlane_b32 s84, v3, 1
    s_nop 0
    s_branch L_B16_1
L_B16_2w:
    ds_read_b32 v3, v7
    s_waitcnt lgkmcnt(0)
    v_readlane_b32 s84, v3, 2
    s_nop 0
    s_branch L_B16_2
L_B16_3w:
    ds_read_b32 v3, v7
    s_waitcnt lgkmcnt(0)
    v_readlane_b32 s84, v3, 3
    s_nop 0
    s_branch L_B16_3
L_B24_0w:
    ds_read_b32 v3, v7
    s_waitcnt lgkmcnt(0)
    v_readlane_b32 s84, v3, 0
    s_nop 0
    s_branch L_B24_0
L_B24_1w:
    ds_read_b32 v3, v7
    s_waitcnt lgkmcnt(0)
    v_readlane_b32 s84, v3, 1
    s_nop 0
    s_branch L_B24_1
L_B24_2w:
    ds_read_b32 v3, v7
    s_waitcnt lgkmcnt(0)
    v_readlane_b32 s84, v3, 2
    s_nop 0
    s_branch L_B24_2
L_B24_3w:
    ds_read_b32 v3, v7
    s_waitcnt lgkmcnt(0)
    v_readlane_b32 s84, v3, 3
    s_nop 0
    s_branch L_B24_3
L_B15_0w:
    ds_read_b32 v3, v7
    s_waitcnt lgkmcnt(0)
    v_readlane_b32 s84, v3, 0
    s_nop 0
    s_branch L_B15_0
L_B15_1w:
    ds_read_b32 v3, v7
    s_waitcnt lgkmcnt(0)
    v_readlane_b32 s84, v3, 1
    s_nop 0
    s_branch L_B15_1
L_B15_2w:
    ds_read_b32 v3, v7
    s_waitcnt lgkmcnt(0)
    v_readlane_b32 s84, v3, 2
    s_nop 0
    s_branch L_B15_2
L_B15_3w:
    ds_read_b32 v3, v7
    s_waitcnt lgkmcnt(0)
    v_readlane_b32 s84, v3, 3
    s_nop 0
    s_branch L_B15_3
L_B25_0w:
    ds_read_b32 v3, v7
    s_waitcnt lgkmcnt(0)
    v_readlane_b32 s84, v3, 0
    s_nop 0
    s_branch L_B25_0
L_B25_1w:
    ds_read_b32 v3, v7
    s_waitcnt lgkmcnt(0)
    v_readlane_b32 s84, v3, 1
    s_nop 0
    s_branch L_B25_1
L_B25_2w:
    ds_read_b32 v3, v7
    s_waitcnt lgkmcnt(0)
    v_readlane_b32 s84, v3, 2
    s_nop 0
    s_branch L_B25_2
L_B25_3w:
    ds_read_b32 v3, v7
    s_waitcnt lgkmcnt(0)
    v_readlane_b32 s84, v3, 3
    s_nop 0
    s_branch L_B25_3
L_B26_0w:
    ds_read_b32 v3, v7
    s_waitcnt lgkmcnt(0)
    v_readlane_b32 s84, v3, 0
    s_nop 0
    s_branch L_B26_0
L_B26_1w:
    ds_read_b32 v3, v7
    s_waitcnt lgkmcnt(0)
    v_readlane_b32 s84, v3, 1
    s_nop 0
    s_branch L_B26_1
L_B26_2w:
    ds_read_b32 v3, v7
    s_waitcnt lgkmcnt(0)
    v_readlane_b32 s84, v3, 2
    s_nop 0
    s_branch L_B26_2
L_B26_3w:
    ds_read_b32 v3, v7
    s_waitcnt lgkmcnt(0)
    v_readlane_b32 s84, v3, 3
    s_nop 0
    s_branch L_B26_3
L_B32_0w:
    ds_read_b32 v3, v7
    s_waitcnt lgkmcnt(0)
    v_readlane_b32 s84, v3, 0
    s_nop 0
    s_branch L_B32_0
L_B32_1w:
    ds_read_b32 v3, v7
    s_waitcnt lgkmcnt(0)
    v_readlane_b32 s84, v3, 1
    s_nop 0
    s_branch L_B32_1
L_B32_2w:
    ds_read_b32 v3, v7
    s_waitcnt lgkmcnt(0)
    v_readlane_b32 s84, v3, 2
    s_nop 0
    s_branch L_B32_2
L_B32_3w:
    ds_read_b32 v3, v7
    s_waitcnt lgkmcnt(0)
    v_readlane_b32 s84, v3, 3
    s_nop 0
    s_branch L_B32_3
L_tail:
L_D32:
    s_mul_i32 s92, s81, 12
    s_add_u32 s92, s92, 16
    v_mov_b32 v5, s92
L_B32:
L_B32_0:
    s_cmp_lt_i32 s84, s82
    s_cbranch_scc1 L_B32_0w
    s_waitcnt vmcnt(31)
    buffer_load_dwordx4 v2, s[4:7], s78 offen offset:0 nt lds
    v_add_u32 v5, 3, v5
    s_add_u32 s81, s81, 1
    s_bfe_i32 s93, s81, 0x10007
    s_waitcnt vmcnt(31)
    buffer_load_dwordx4 v2, s[4:7], s78 offen offset:1024 nt lds
    v_readlane_b32 s84, v3, 1
    ds_read_b32 v3, v7
    s_xor_b32 s93, s93, s81
    s_waitcnt vmcnt(31)
    buffer_load_dwordx4 v2, s[4:7], s78 offen offset:2048 nt lds
    ds_write_b32 v6, v5
    s_and_b32 s92, s93, 7
    s_lshl_b32 s92, s92, 11
L_B32_1:
    s_cmp_lt_i32 s84, s82
    s_cbranch_scc1 L_B32_1w
    s_waitcnt vmcnt(31)
    buffer_load_dwordx4 v2, s[4:7], s78 offen offset:3072 nt lds
    v_add_u32 v5, 3, v5
    s_add_u32 m0, m0, s85
    s_add_u32 s78, s78, s85
    s_waitcnt vmcnt(31)
    buffer_load_dwordx4 v2, s[4:7], s78 offen offset:0 nt lds
    v_readlane_b32 s84, v3, 2
    ds_read_b32 v3, v7
    s_add_u32 s92, s92, s77
    s_waitcnt vmcnt(31)
    buffer_load_dwordx4 v2, s[4:7], s78 offen offset:1024 nt lds
    ds_write_b32 v6, v5
    s_and_b32 s92, s92, 16383
    s_mul_i32 s80, s92, 768
L_B32_2:
    s_cmp_lt_i32 s84, s82
    s_cbranch_scc1 L_B32_2w
    s_waitcnt vmcnt(31)
    buffer_load_dwordx4 v2, s[4:7], s78 offen offset:2048 nt lds
    v_add_u32 v5, 3, v5
    s_bfe_u32 s92, s93, 0x40003
    s_mul_i32 s92, s92, 25165824
    s_waitcnt vmcnt(31)
    buffer_load_dwordx4 v2, s[4:7], s78 offen offset:3072 nt lds
    v_readlane_b32 s84, v3, 3
    ds_read_b32 v3, v7
    s_add_u32 m0, m0, s85
    s_add_u32 s78, s78, s85
    s_waitcnt vmcnt(31)
    buffer_load_dwordx4 v2, s[4:7], s78 offen offset:0 nt lds
    ds_write_b32 v6, v5
    s_add_u32 s80, s80, s79
    s_add_u32 s80, s80, s92
L_B32_3:
    s_cmp_lt_i32 s84, s82
    s_cbranch_scc1 L_B32_3w
    s_waitcnt vmcnt(31)
    buffer_load_dwordx4 v2, s[4:7], s78 offen offset:1024 nt lds
    v_add_u32 v5, 3, v5
    v_readlane_b32 s83, v3, 4
    s_and_b32 s86, s81, 3
    s_mul_i32 s86, s86, 12288
    s_waitcnt vmcnt(31)
    buffer_load_dwordx4 v2, s[4:7], s78 offen offset:2048 nt lds
    v_readlane_b32 s84, v3, 0
    ds_read_b32 v3, v7
    s_add_u32 s82, s82, 1
    s_movk_i32 s87, 255
    s_cmp_ge_u32 s81, 128
    s_waitcnt vmcnt(31)
    buffer_load_dwordx4 v2, s[4:7], s78 offen offset:3072 nt lds
    ds_write_b32 v6, v5
    s_cselect_b64 s[4:5], s[56:57], s[50:51]
    s_mov_b32 m0, s86
    s_mov_b32 s78, s80
    s_cmp_lg_u32 s81, 256
    s_cbranch_scc1 L_disp
L_drain:
    v_mov_b32 v18, 3090
    s_waitcnt vmcnt(30)
    ds_write_b32 v6, v18
    v_mov_b32 v18, 3093
    s_waitcnt vmcnt(27)
    ds_write_b32 v6, v18
    v_mov_b32 v18, 3096
    s_waitcnt vmcnt(24)
    ds_write_b32 v6, v18
    v_mov_b32 v18, 3099
    s_waitcnt vmcnt(21)
    ds_write_b32 v6, v18
    v_mov_b32 v18, 3102
    s_waitcnt vmcnt(18)
    ds_write_b32 v6, v18
    v_mov_b32 v18, 3105
    s_waitcnt vmcnt(15)
    ds_write_b32 v6, v18
    v_mov_b32 v18, 3108
    s_waitcnt vmcnt(12)
    ds_write_b32 v6, v18
    v_mov_b32 v18, 3111
    s_waitcnt vmcnt(9)
    ds_write_b32 v6, v18
    v_mov_b32 v18, 3114
    s_waitcnt vmcnt(6)
    ds_write_b32 v6, v18
    v_mov_b32 v18, 3117
    s_waitcnt vmcnt(3)
    ds_write_b32 v6, v18
    v_mov_b32 v18, 3120
    s_waitcnt vmcnt(0)
    ds_write_b32 v6, v18
    s_waitcnt lgkmcnt(0)
    s_endpgm
L_other:
    s_cmp_eq_u32 s76, 5
    s_cbranch_scc1 L_helper
    s_sub_u32 s78, s76, 1
    v_lshlrev_b32 v44, 3, v1
    v_cmp_gt_u32 vcc, 24, v1
    v_mov_b32 v23, 0xffffff40
    v_mov_b32 v18, 192
    v_cndmask_b32 v23, v23, v18, vcc
    v_add_u32 v45, v44, v23
    v_mov_b32 v18, 0x80008000
    v_cndmask_b32 v46, 0, v18, vcc
    v_lshrrev_b32 v19, 4, v1
    v_and_b32 v23, 15, v1
    v_mul_u32_u24 v20, 384, v19
    v_lshl_add_u32 v20, v23, 3, v20
    v_cmp_lt_u32 s[86:87], 7, v23
    v_mov_b32 v21, -64
    v_mov_b32 v18, 320
    v_cndmask_b32 v21, v18, v21, s[86:87]
    v_add_u32 v21, v20, v21
    s_lshl2_add_u32 s95, s78, s3
    s_mul_i32 s95, s95, 384
    s_lshl2_add_u32 s89, s78, s77
    s_xor_b32 s89, s89, 8192
    s_mov_b32 s34, 12288
    s_mov_b32 s35, 0x20000
    s_mov_b32 s38, 384
    s_mov_b32 s39, 0x20000
    s_mov_b32 s42, 384
    s_mov_b32 s43, 0x20000
    s_mov_b32 s14, 6291456
    s_mov_b32 s15, 0x20000
    s_mov_b32 s18, 6291456
    s_mov_b32 s19, 0x20000
    s_waitcnt lgkmcnt(0)
    s_mov_b64 s[32:33], s[48:49]
    s_mov_b64 s[36:37], s[62:63]
    s_mov_b64 s[40:41], s[64:65]
    buffer_load_dwordx2 v[24:25], v44, s[32:35], s95 offen
    buffer_load_dwordx2 v[26:27], v45, s[32:35], s95 offen
    buffer_load_dwordx2 v[28:29], v44, s[32:35], s95 offen offset:768
    buffer_load_dwordx2 v[30:31], v45, s[32:35], s95 offen offset:768
    buffer_load_dwordx2 v[40:41], v44, s[36:39], 0 offen
    buffer_load_dwordx2 v[42:43], v44, s[40:43], 0 offen
    s_mov_b64 s[12:13], s[66:67]
    s_mov_b64 s[16:17], s[68:69]
    s_barrier
    s_mov_b32 s83, 0x05040100
    s_mov_b32 s84, 0x07060302
    s_mul_i32 s92, s78, 3072
    v_lshl_add_u32 v2, v20, 1, s92
    v_add_u32 v12, s92, v20
    v_add_u32 v13, s92, v21
    s_lshl_b32 s92, s78, 5
    s_add_u32 s92, s92, 49152
    v_lshl_add_u32 v3, v19, 3, s92
    v_lshrrev_b32 v18, 3, v23
    v_lshl_add_u32 v4, v18, 7, v3
    v_lshlrev_b32 v9, 4, v23
    v_add_u32 v9, 65536, v9
    s_lshl2_add_u32 s92, s78, 77824
    v_mov_b32 v5, s92
    v_mov_b32 v6, 0
    v_mov_b32 v8, 1
    s_mul_i32 s79, s78, 3
    s_sub_u32 s79, s79, 9
    s_mov_b32 s80, 0
    s_mov_b32 s81, 0
    s_mul_i32 s92, s78, 1536
    s_add_u32 s92, s92, 65536
    v_lshl_add_u32 v14, v44, 1, s92
    v_lshl_add_u32 v16, v45, 1, s92
    s_waitcnt vmcnt(0)
    v_xor_b32 v42, v42, v46
    v_xor_b32 v43, v43, v46
    v_lshlrev_b32 v48, 16, v40
    v_and_b32 v49, 0xffff0000, v40
    v_lshlrev_b32 v50, 16, v41
    v_and_b32 v51, 0xffff0000, v41
    v_lshlrev_b32 v52, 16, v42
    v_and_b32 v53, 0xffff0000, v42
    v_lshlrev_b32 v54, 16, v43
    v_and_b32 v55, 0xffff0000, v43
    v_and_b32 v46, 0x80000000, v46
    s_mov_b32 exec_hi, 0xffff
    v_lshlrev_b32 v56, 16, v24
    v_and_b32 v57, 0xffff0000, v24
    v_lshlrev_b32 v58, 16, v25
    v_and_b32 v59, 0xffff0000, v25
    v_lshlrev_b32 v60, 16, v26
    v_and_b32 v61, 0xffff0000, v26
    v_lshlrev_b32 v62, 16, v27
    v_and_b32 v63, 0xffff0000, v27
    v_pk_mul_f32 v[56:57], v[56:57], v[48:49]
    v_pk_mul_f32 v[60:61], v[60:61], v[52:53]
    v_pk_mul_f32 v[58:59], v[58:59], v[50:51]
    v_pk_mul_f32 v[62:63], v[62:63], v[54:55]
    v_cvt_pk_bf16_f32 v56, v56, v60
    v_cvt_pk_bf16_f32 v57, v57, v61
    v_cvt_pk_bf16_f32 v58, v58, v62
    v_cvt_pk_bf16_f32 v59, v59, v63
    v_and_b32 v60, 0xffff0000, v56
    v_lshlrev_b32 v56, 16, v56
    v_and_b32 v61, 0xffff0000, v57
    v_lshlrev_b32 v57, 16, v57
    v_and_b32 v62, 0xffff0000, v58
    v_lshlrev_b32 v58, 16, v58
    v_and_b32 v63, 0xffff0000, v59
    v_lshlrev_b32 v59, 16, v59
    v_pk_add_f32 v[56:57], v[56:57], v[60:61]
    v_pk_add_f32 v[58:59], v[58:59], v[62:63]
    v_cvt_pk_bf16_f32 v64, v56, v56
    v_cvt_pk_bf16_f32 v65, v57, v57
    v_cvt_pk_bf16_f32 v66, v58, v58
    v_cvt_pk_bf16_f32 v67, v59, v59
    v_xor_b32 v64, v64, v46
    v_xor_b32 v65, v65, v46
    v_xor_b32 v66, v66, v46
    v_xor_b32 v67, v67, v46
    ds_write_b16 v14, v64 offset:0
    ds_write_b16_d16_hi v16, v64 offset:2
    ds_write_b16 v14, v65 offset:4
    ds_write_b16_d16_hi v16, v65 offset:6
    ds_write_b16 v14, v66 offset:8
    ds_write_b16_d16_hi v16, v66 offset:10
    ds_write_b16 v14, v67 offset:12
    ds_write_b16_d16_hi v16, v67 offset:14
    v_lshlrev_b32 v56, 16, v28
    v_and_b32 v57, 0xffff0000, v28
    v_lshlrev_b32 v58, 16, v29
    v_and_b32 v59, 0xffff0000, v29
    v_lshlrev_b32 v60, 16, v30
    v_and_b32 v61, 0xffff0000, v30
    v_lshlrev_b32 v62, 16, v31
    v_and_b32 v63, 0xffff0000, v31
    v_pk_mul_f32 v[56:57], v[56:57], v[48:49]
    v_pk_mul_f32 v[60:61], v[60:61], v[52:53]
    v_pk_mul_f32 v[58:59], v[58:59], v[50:51]
    v_pk_mul_f32 v[62:63], v[62:63], v[54:55]
    v_cvt_pk_bf16_f32 v56, v56, v60
    v_cvt_pk_bf16_f32 v57, v57, v61
    v_cvt_pk_bf16_f32 v58, v58, v62
    v_cvt_pk_bf16_f32 v59, v59, v63
    v_and_b32 v60, 0xffff0000, v56
    v_lshlrev_b32 v56, 16, v56
    v_and_b32 v61, 0xffff0000, v57
    v_lshlrev_b32 v57, 16, v57
    v_and_b32 v62, 0xffff0000, v58
    v_lshlrev_b32 v58, 16, v58
    v_and_b32 v63, 0xffff0000, v59
    v_lshlrev_b32 v59, 16, v59
    v_pk_add_f32 v[56:57], v[56:57], v[60:61]
    v_pk_add_f32 v[58:59], v[58:59], v[62:63]
    v_cvt_pk_bf16_f32 v68, v56, v56
    v_cvt_pk_bf16_f32 v69, v57, v57
    v_cvt_pk_bf16_f32 v70, v58, v58
    v_cvt_pk_bf16_f32 v71, v59, v59
    v_xor_b32 v68, v68, v46
    v_xor_b32 v69, v69, v46
    v_xor_b32 v70, v70, v46
    v_xor_b32 v71, v71, v46
    ds_write_b16 v14, v68 offset:768
    ds_write_b16_d16_hi v16, v68 offset:770
    ds_write_b16 v14, v69 offset:772
    ds_write_b16_d16_hi v16, v69 offset:774
    ds_write_b16 v14, v70 offset:776
    ds_write_b16_d16_hi v16, v70 offset:778
    ds_write_b16 v14, v71 offset:780
    ds_write_b16_d16_hi v16, v71 offset:782
    s_mov_b32 exec_hi, -1
    ds_write_b32 v5, v8 offset:160
    s_add_u32 s79, s79, 12
    s_cmp_ge_i32 s80, s79
    s_cbranch_scc1 L_cr0g
L_cr0:
    ds_read_b32 v19, v7
    s_sleep 1
    s_waitcnt lgkmcnt(0)
    v_readlane_b32 s80, v19, 5
    s_nop 0
    s_cmp_lt_i32 s80, s79
    s_cbranch_scc1 L_cr0
L_cr0g:
    ds_read_b64 v[72:73], v12 offset:0
    ds_read_b64 v[76:77], v12 offset:128
    ds_read_b64 v[80:81], v12 offset:256
    ds_read_b64 v[84:85], v12 offset:1536
    ds_read_b64 v[88:89], v12 offset:1664
    ds_read_b64 v[92:93], v12 offset:1792
    v_add_u32 v6, 1, v6
    ds_write_b32 v5, v6
    s_add_u32 s79, s79, 12
    s_cmp_ge_i32 s80, s79
    s_cbranch_scc1 L_cr1g
L_cr1:
    ds_read_b32 v19, v7
    s_sleep 1
    s_waitcnt lgkmcnt(0)
    v_readlane_b32 s80, v19, 5
    s_nop 0
    s_cmp_lt_i32 s80, s79
    s_cbranch_scc1 L_cr1
L_cr1g:
    ds_read_b64 v[74:75], v12 offset:12480
    ds_read_b64 v[78:79], v13 offset:12288
    ds_read_b64 v[82:83], v12 offset:12352
    ds_read_b64 v[86:87], v12 offset:14016
    ds_read_b64 v[90:91], v13 offset:13824
    ds_read_b64 v[94:95], v12 offset:13888
    v_add_u32 v6, 1, v6
    ds_write_b32 v5, v6
    s_mul_i32 s82, s89, 384
    s_add_u32 s89, s89, 2048
    s_and_b32 s89, s89, 16383
    buffer_load_dwordx2 v[120:121], v20, s[12:15], s82 offen offset:0
    buffer_load_dwordx2 v[122:123], v20, s[16:19], s82 offen offset:192
    buffer_load_dwordx2 v[124:125], v20, s[12:15], s82 offen offset:128
    buffer_load_dwordx2 v[126:127], v21, s[16:19], s82 offen
    buffer_load_dwordx2 v[128:129], v20, s[12:15], s82 offen offset:256
    buffer_load_dwordx2 v[130:131], v20, s[16:19], s82 offen offset:64
    s_add_u32 s79, s79, 12
    s_cmp_ge_i32 s80, s79
    s_cbranch_scc1 L_cr2g
L_cr2:
    ds_read_b32 v19, v7
    s_sleep 1
    s_waitcnt lgkmcnt(0)
    v_readlane_b32 s80, v19, 5
    s_nop 0
    s_cmp_lt_i32 s80, s79
    s_cbranch_scc1 L_cr2
L_cr2g:
    ds_read_b64 v[96:97], v12 offset:24576
    ds_read_b64 v[100:101], v12 offset:24704
    ds_read_b64 v[104:105], v12 offset:24832
    ds_read_b64 v[108:109], v12 offset:26112
    ds_read_b64 v[112:113], v12 offset:26240
    ds_read_b64 v[116:117], v12 offset:26368
    v_add_u32 v6, 1, v6
    ds_write_b32 v5, v6
    s_add_u32 s79, s79, 12
    s_cmp_ge_i32 s80, s79
    s_cbranch_scc1 L_cr3g
L_cr3:
    ds_read_b32 v19, v7
    s_sleep 1
    s_waitcnt lgkmcnt(0)
    v_readlane_b32 s80, v19, 5
    s_nop 0
    s_cmp_lt_i32 s80, s79
    s_cbranch_scc1 L_cr3
L_cr3g:
    ds_read_b64 v[98:99], v12 offset:37056
    ds_read_b64 v[102:103], v13 offset:36864
    ds_read_b64 v[106:107], v12 offset:36928
    ds_read_b64 v[110:111], v12 offset:38592
    ds_read_b64 v[114:115], v13 offset:38400
    ds_read_b64 v[118:119], v12 offset:38464
    v_add_u32 v6, 1, v6
    ds_write_b32 v5, v6
    s_mul_i32 s82, s89, 384
    s_add_u32 s89, s89, 2048
    s_and_b32 s89, s89, 16383
    buffer_load_dwordx2 v[132:133], v20, s[12:15], s82 offen offset:0
    buffer_load_dwordx2 v[134:135], v20, s[16:19], s82 offen offset:192
    buffer_load_dwordx2 v[136:137], v20, s[12:15], s82 offen offset:128
    buffer_load_dwordx2 v[138:139], v21, s[16:19], s82 offen
    buffer_load_dwordx2 v[140:141], v20, s[12:15], s82 offen offset:256
    buffer_load_dwordx2 v[142:143], v20, s[16:19], s82 offen offset:64
L_kph:
    s_lshr_b32 s94, s81, 1
    s_add_u32 s88, s94, 40
    s_lshl2_add_u32 s92, s94, 77888
    v_mov_b32 v22, s92
    s_nop 1
L_kw:
    ds_read_b32 v19, v7
    ds_read_b128 v[48:51], v9 offset:0
    ds_read_b128 v[52:55], v9 offset:256
    ds_read_b128 v[56:59], v9 offset:512
    s_waitcnt lgkmcnt(0)
    v_readlane_b32 s92, v19, s88
    v_readlane_b32 s93, v19, 12
    s_cmp_eq_u32 s92, 0
    s_nop 3
    s_cbranch_scc1 L_kw
    s_cmp_le_u32 s93, s94
    s_cbranch_scc1 L_kw
    v_add_u32 v9, 768, v9
    s_cmp_lg_u32 s81, 0
    s_nop 0
    s_cbranch_scc1 L_ncs0
    v_perm_b32 v36, v74, v72, s83
    v_perm_b32 v74, v74, v72, s84
    v_perm_b32 v37, v75, v73, s83
    v_perm_b32 v75, v75, v73, s84
    v_perm_b32 v38, v78, v76, s83
    v_perm_b32 v78, v78, v76, s84
    v_perm_b32 v39, v79, v77, s83
    v_perm_b32 v79, v79, v77, s84
    v_perm_b32 v40, v82, v80, s83
    v_perm_b32 v82, v82, v80, s84
    v_perm_b32 v41, v83, v81, s83
    v_perm_b32 v83, v83, v81, s84
    v_mov_b64 v[72:73], v[36:37]
    v_mov_b64 v[76:77], v[38:39]
    v_mov_b64 v[80:81], v[40:41]
    s_nop 1
L_ncs0:
    v_dot2_f32_bf16 v36, v72, v48, 0
    v_dot2_f32_bf16 v37, v74, v49, 0
    v_dot2_f32_bf16 v38, v73, v50, 0
    v_dot2_f32_bf16 v39, v75, v51, 0
    v_dot2_f32_bf16 v40, v76, v52, 0
    v_dot2_f32_bf16 v41, v78, v53, 0
    v_dot2_f32_bf16 v42, v77, v54, 0
    v_dot2_f32_bf16 v43, v79, v55, 0
    v_dot2_f32_bf16 v44, v80, v56, 0
    v_dot2_f32_bf16 v45, v82, v57, 0
    v_dot2_f32_bf16 v46, v81, v58, 0
    v_dot2_f32_bf16 v47, v83, v59, 0
    s_add_u32 s79, s79, 12
    s_cmp_ge_i32 s80, s79
    s_cbranch_scc1 L_kr0g
L_kr0:
    ds_read_b32 v19, v7
    s_sleep 1
    s_waitcnt lgkmcnt(0)
    v_readlane_b32 s80, v19, 5
    s_nop 0
    s_cmp_lt_i32 s80, s79
    s_cbranch_scc1 L_kr0
L_kr0g:
    ds_read_b32 v10, v3 offset:0
    ds_read_b128 v[24:27], v2 offset:0
    ds_read_b128 v[28:31], v2 offset:256
    ds_read_b128 v[32:35], v2 offset:512
    v_add_u32 v6, 1, v6
    ds_write_b32 v5, v6
    s_waitcnt lgkmcnt(3)
    v_and_b32 v12, 0xffff0000, v10
    v_cvt_f32_i32 v24, v24
    v_cvt_f32_i32 v25, v25
    v_cvt_f32_i32 v26, v26
    v_cvt_f32_i32 v27, v27
    v_pk_add_f32 v[24:25], v[24:25], v[12:13] op_sel:[0,0] op_sel_hi:[1,0] neg_lo:[0,1] neg_hi:[0,1]
    v_pk_add_f32 v[26:27], v[26:27], v[12:13] op_sel:[0,0] op_sel_hi:[1,0] neg_lo:[0,1] neg_hi:[0,1]
    v_pk_mul_f32 v[14:15], v[24:25], v[36:37]
    v_pk_fma_f32 v[14:15], v[26:27], v[38:39], v[14:15]
    s_waitcnt lgkmcnt(2)
    v_cvt_f32_i32 v28, v28
    v_cvt_f32_i32 v29, v29
    v_cvt_f32_i32 v30, v30
    v_cvt_f32_i32 v31, v31
    v_pk_add_f32 v[28:29], v[28:29], v[12:13] op_sel:[0,0] op_sel_hi:[1,0] neg_lo:[0,1] neg_hi:[0,1]
    v_pk_add_f32 v[30:31], v[30:31], v[12:13] op_sel:[0,0] op_sel_hi:[1,0] neg_lo:[0,1] neg_hi:[0,1]
    v_pk_fma_f32 v[14:15], v[28:29], v[40:41], v[14:15]
    v_pk_fma_f32 v[14:15], v[30:31], v[42:43], v[14:15]
    s_waitcnt lgkmcnt(1)
    v_cvt_f32_i32 v32, v32
    v_cvt_f32_i32 v33, v33
    v_cvt_f32_i32 v34, v34
    v_cvt_f32_i32 v35, v35
    v_pk_add_f32 v[32:33], v[32:33], v[12:13] op_sel:[0,0] op_sel_hi:[1,0] neg_lo:[0,1] neg_hi:[0,1]
    v_pk_add_f32 v[34:35], v[34:35], v[12:13] op_sel:[0,0] op_sel_hi:[1,0] neg_lo:[0,1] neg_hi:[0,1]
    v_pk_fma_f32 v[14:15], v[32:33], v[44:45], v[14:15]
    v_pk_fma_f32 v[14:15], v[34:35], v[46:47], v[14:15]
    v_add_f32 v14, v14, v15
    s_nop 1
    v_add_f32_dpp v18, v14, v14 row_ror:8 row_mask:0xf bank_mask:0x3
    s_cmp_lg_u32 s81, 0
    s_nop 0
    s_cbranch_scc1 L_ncs1
    s_mul_i32 s82, s89, 384
    s_add_u32 s89, s89, 2048
    s_and_b32 s89, s89, 16383
    buffer_load_dwordx2 v[144:145], v20, s[12:15], s82 offen offset:0
    buffer_load_dwordx2 v[146:147], v20, s[16:19], s82 offen offset:192
    buffer_load_dwordx2 v[148:149], v20, s[12:15], s82 offen offset:128
    buffer_load_dwordx2 v[150:151], v21, s[16:19], s82 offen
    buffer_load_dwordx2 v[152:153], v20, s[12:15], s82 offen offset:256
    buffer_load_dwordx2 v[154:155], v20, s[16:19], s82 offen offset:64
    v_perm_b32 v36, v86, v84, s83
    v_perm_b32 v86, v86, v84, s84
    v_perm_b32 v37, v87, v85, s83
    v_perm_b32 v87, v87, v85, s84
    v_perm_b32 v38, v90, v88, s83
    v_perm_b32 v90, v90, v88, s84
    v_perm_b32 v39, v91, v89, s83
    v_perm_b32 v91, v91, v89, s84
    v_perm_b32 v40, v94, v92, s83
    v_perm_b32 v94, v94, v92, s84
    v_perm_b32 v41, v95, v93, s83
    v_perm_b32 v95, v95, v93, s84
    v_mov_b64 v[84:85], v[36:37]
    v_mov_b64 v[88:89], v[38:39]
    v_mov_b64 v[92:93], v[40:41]
    s_nop 1
L_ncs1:
    v_dot2_f32_bf16 v36, v84, v48, 0
    v_dot2_f32_bf16 v37, v86, v49, 0
    v_dot2_f32_bf16 v38, v85, v50, 0
    v_dot2_f32_bf16 v39, v87, v51, 0
    v_dot2_f32_bf16 v40, v88, v52, 0
    v_dot2_f32_bf16 v41, v90, v53, 0
    v_dot2_f32_bf16 v42, v89, v54, 0
    v_dot2_f32_bf16 v43, v91, v55, 0
    v_dot2_f32_bf16 v44, v92, v56, 0
    v_dot2_f32_bf16 v45, v94, v57, 0
    v_dot2_f32_bf16 v46, v93, v58, 0
    v_dot2_f32_bf16 v47, v95, v59, 0
    s_add_u32 s79, s79, 12
    s_cmp_ge_i32 s80, s79
    s_cbranch_scc1 L_kr1g
L_kr1:
    ds_read_b32 v19, v7
    s_sleep 1
    s_waitcnt lgkmcnt(0)
    v_readlane_b32 s80, v19, 5
    s_nop 0
    s_cmp_lt_i32 s80, s79
    s_cbranch_scc1 L_kr1
L_kr1g:
    ds_read_b32 v11, v3 offset:128
    ds_read_b128 v[24:27], v2 offset:12288
    ds_read_b128 v[28:31], v2 offset:12544
    ds_read_b128 v[32:35], v2 offset:12800
    v_add_u32 v6, 1, v6
    ds_write_b32 v5, v6
    s_waitcnt lgkmcnt(3)
    v_and_b32 v12, 0xffff0000, v11
    v_cvt_f32_i32 v24, v24
    v_cvt_f32_i32 v25, v25
    v_cvt_f32_i32 v26, v26
    v_cvt_f32_i32 v27, v27
    v_pk_add_f32 v[24:25], v[24:25], v[12:13] op_sel:[0,0] op_sel_hi:[1,0] neg_lo:[0,1] neg_hi:[0,1]
    v_pk_add_f32 v[26:27], v[26:27], v[12:13] op_sel:[0,0] op_sel_hi:[1,0] neg_lo:[0,1] neg_hi:[0,1]
    v_pk_mul_f32 v[16:17], v[24:25], v[36:37]
    v_pk_fma_f32 v[16:17], v[26:27], v[38:39], v[16:17]
    s_waitcnt lgkmcnt(2)
    v_cvt_f32_i32 v28, v28
    v_cvt_f32_i32 v29, v29
    v_cvt_f32_i32 v30, v30
    v_cvt_f32_i32 v31, v31
    v_pk_add_f32 v[28:29], v[28:29], v[12:13] op_sel:[0,0] op_sel_hi:[1,0] neg_lo:[0,1] neg_hi:[0,1]
    v_pk_add_f32 v[30:31], v[30:31], v[12:13] op_sel:[0,0] op_sel_hi:[1,0] neg_lo:[0,1] neg_hi:[0,1]
    v_pk_fma_f32 v[16:17], v[28:29], v[40:41], v[16:17]
    v_pk_fma_f32 v[16:17], v[30:31], v[42:43], v[16:17]
    s_waitcnt lgkmcnt(1)
    v_cvt_f32_i32 v32, v32
    v_cvt_f32_i32 v33, v33
    v_cvt_f32_i32 v34, v34
    v_cvt_f32_i32 v35, v35
    v_pk_add_f32 v[32:33], v[32:33], v[12:13] op_sel:[0,0] op_sel_hi:[1,0] neg_lo:[0,1] neg_hi:[0,1]
    v_pk_add_f32 v[34:35], v[34:35], v[12:13] op_sel:[0,0] op_sel_hi:[1,0] neg_lo:[0,1] neg_hi:[0,1]
    v_pk_fma_f32 v[16:17], v[32:33], v[44:45], v[16:17]
    v_pk_fma_f32 v[16:17], v[34:35], v[46:47], v[16:17]
    v_add_f32 v16, v16, v17
    v_cndmask_b32 v23, v10, v11, s[86:87]
    v_lshlrev_b32 v23, 16, v23
    v_add_f32_dpp v18, v16, v16 row_ror:8 row_mask:0xf bank_mask:0xc
    v_mul_f32 v23, 0x3dd53b95, v23
    s_nop 0
    v_add_f32_dpp v18, v18, v18 row_half_mirror row_mask:0xf bank_mask:0xf
    s_nop 1
    v_add_f32_dpp v18, v18, v18 quad_perm:[2,3,0,1] row_mask:0xf bank_mask:0xf
    s_nop 1
    v_add_f32_dpp v18, v18, v18 quad_perm:[1,0,3,2] row_mask:0xf bank_mask:0xf
    v_mul_f32 v18, v23, v18
    ds_write_b32 v4, v18 offset:0
    s_cmp_lg_u32 s81, 0
    s_cbranch_scc1 L_ncs2
    v_perm_b32 v36, v98, v96, s83
    v_perm_b32 v98, v98, v96, s84
    v_perm_b32 v37, v99, v97, s83
    v_perm_b32 v99, v99, v97, s84
    v_perm_b32 v38, v102, v100, s83
    v_perm_b32 v102, v102, v100, s84
    v_perm_b32 v39, v103, v101, s83
    v_perm_b32 v103, v103, v101, s84
    v_perm_b32 v40, v106, v104, s83
    v_perm_b32 v106, v106, v104, s84
    v_perm_b32 v41, v107, v105, s83
    v_perm_b32 v107, v107, v105, s84
    v_mov_b64 v[96:97], v[36:37]
    v_mov_b64 v[100:101], v[38:39]
    v_mov_b64 v[104:105], v[40:41]
    s_nop 1
L_ncs2:
    v_dot2_f32_bf16 v36, v96, v48, 0
    v_dot2_f32_bf16 v37, v98, v49, 0
    v_dot2_f32_bf16 v38, v97, v50, 0
    v_dot2_f32_bf16 v39, v99, v51, 0
    v_dot2_f32_bf16 v40, v100, v52, 0
    v_dot2_f32_bf16 v41, v102, v53, 0
    v_dot2_f32_bf16 v42, v101, v54, 0
    v_dot2_f32_bf16 v43, v103, v55, 0
    v_dot2_f32_bf16 v44, v104, v56, 0
    v_dot2_f32_bf16 v45, v106, v57, 0
    v_dot2_f32_bf16 v46, v105, v58, 0
    v_dot2_f32_bf16 v47, v107, v59, 0
    s_add_u32 s79, s79, 12
    s_cmp_ge_i32 s80, s79
    s_cbranch_scc1 L_kr2g
L_kr2:
    ds_read_b32 v19, v7
    s_sleep 1
    s_waitcnt lgkmcnt(0)
    v_readlane_b32 s80, v19, 5
    s_nop 0
    s_cmp_lt_i32 s80, s79
    s_cbranch_scc1 L_kr2
L_kr2g:
    ds_read_b32 v10, v3 offset:256
    ds_read_b128 v[24:27], v2 offset:24576
    ds_read_b128 v[28:31], v2 offset:24832
    ds_read_b128 v[32:35], v2 offset:25088
    v_add_u32 v6, 1, v6
    ds_write_b32 v5, v6
    s_waitcnt lgkmcnt(3)
    v_and_b32 v12, 0xffff0000, v10
    v_cvt_f32_i32 v24, v24
    v_cvt_f32_i32 v25, v25
    v_cvt_f32_i32 v26, v26
    v_cvt_f32_i32 v27, v27
    v_pk_add_f32 v[24:25], v[24:25], v[12:13] op_sel:[0,0] op_sel_hi:[1,0] neg_lo:[0,1] neg_hi:[0,1]
    v_pk_add_f32 v[26:27], v[26:27], v[12:13] op_sel:[0,0] op_sel_hi:[1,0] neg_lo:[0,1] neg_hi:[0,1]
    v_pk_mul_f32 v[14:15], v[24:25], v[36:37]
    v_pk_fma_f32 v[14:15], v[26:27], v[38:39], v[14:15]
    s_waitcnt lgkmcnt(2)
    v_cvt_f32_i32 v28, v28
    v_cvt_f32_i32 v29, v29
    v_cvt_f32_i32 v30, v30
    v_cvt_f32_i32 v31, v31
    v_pk_add_f32 v[28:29], v[28:29], v[12:13] op_sel:[0,0] op_sel_hi:[1,0] neg_lo:[0,1] neg_hi:[0,1]
    v_pk_add_f32 v[30:31], v[30:31], v[12:13] op_sel:[0,0] op_sel_hi:[1,0] neg_lo:[0,1] neg_hi:[0,1]
    v_pk_fma_f32 v[14:15], v[28:29], v[40:41], v[14:15]
    v_pk_fma_f32 v[14:15], v[30:31], v[42:43], v[14:15]
    s_waitcnt lgkmcnt(1)
    v_cvt_f32_i32 v32, v32
    v_cvt_f32_i32 v33, v33
    v_cvt_f32_i32 v34, v34
    v_cvt_f32_i32 v35, v35
    v_pk_add_f32 v[32:33], v[32:33], v[12:13] op_sel:[0,0] op_sel_hi:[1,0] neg_lo:[0,1] neg_hi:[0,1]
    v_pk_add_f32 v[34:35], v[34:35], v[12:13] op_sel:[0,0] op_sel_hi:[1,0] neg_lo:[0,1] neg_hi:[0,1]
    v_pk_fma_f32 v[14:15], v[32:33], v[44:45], v[14:15]
    v_pk_fma_f32 v[14:15], v[34:35], v[46:47], v[14:15]
    v_add_f32 v14, v14, v15
    s_nop 1
    v_add_f32_dpp v18, v14, v14 row_ror:8 row_mask:0xf bank_mask:0x3
    s_cmp_lg_u32 s81, 0
    s_nop 0
    s_cbranch_scc1 L_ncs3
    s_mul_i32 s82, s89, 384
    s_add_u32 s89, s89, 2048
    s_and_b32 s89, s89, 16383
    buffer_load_dwordx2 v[156:157], v20, s[12:15], s82 offen offset:0
    buffer_load_dwordx2 v[158:159], v20, s[16:19], s82 offen offset:192
    buffer_load_dwordx2 v[160:161], v20, s[12:15], s82 offen offset:128
    buffer_load_dwordx2 v[162:163], v21, s[16:19], s82 offen
    buffer_load_dwordx2 v[164:165], v20, s[12:15], s82 offen offset:256
    buffer_load_dwordx2 v[166:167], v20, s[16:19], s82 offen offset:64
    v_perm_b32 v36, v110, v108, s83
    v_perm_b32 v110, v110, v108, s84
    v_perm_b32 v37, v111, v109, s83
    v_perm_b32 v111, v111, v109, s84
    v_perm_b32 v38, v114, v112, s83
    v_perm_b32 v114, v114, v112, s84
    v_perm_b32 v39, v115, v113, s83
    v_perm_b32 v115, v115, v113, s84
    v_perm_b32 v40, v118, v116, s83
    v_perm_b32 v118, v118, v116, s84
    v_perm_b32 v41, v119, v117, s83
    v_perm_b32 v119, v119, v117, s84
    v_mov_b64 v[108:109], v[36:37]
    v_mov_b64 v[112:113], v[38:39]
    v_mov_b64 v[116:117], v[40:41]
    s_nop 1
L_ncs3:
    v_dot2_f32_bf16 v36, v108, v48, 0
    v_dot2_f32_bf16 v37, v110, v49, 0
    v_dot2_f32_bf16 v38, v109, v50, 0
    v_dot2_f32_bf16 v39, v111, v51, 0
    v_dot2_f32_bf16 v40, v112, v52, 0
    v_dot2_f32_bf16 v41, v114, v53, 0
    v_dot2_f32_bf16 v42, v113, v54, 0
    v_dot2_f32_bf16 v43, v115, v55, 0
    v_dot2_f32_bf16 v44, v116, v56, 0
    v_dot2_f32_bf16 v45, v118, v57, 0
    v_dot2_f32_bf16 v46, v117, v58, 0
    v_dot2_f32_bf16 v47, v119, v59, 0
    s_add_u32 s79, s79, 12
    s_cmp_ge_i32 s80, s79
    s_cbranch_scc1 L_kr3g
L_kr3:
    ds_read_b32 v19, v7
    s_sleep 1
    s_waitcnt lgkmcnt(0)
    v_readlane_b32 s80, v19, 5
    s_nop 0
    s_cmp_lt_i32 s80, s79
    s_cbranch_scc1 L_kr3
L_kr3g:
    ds_read_b32 v11, v3 offset:384
    ds_read_b128 v[24:27], v2 offset:36864
    ds_read_b128 v[28:31], v2 offset:37120
    ds_read_b128 v[32:35], v2 offset:37376
    v_add_u32 v6, 1, v6
    ds_write_b32 v5, v6
    s_waitcnt lgkmcnt(3)
    v_and_b32 v12, 0xffff0000, v11
    v_cvt_f32_i32 v24, v24
    v_cvt_f32_i32 v25, v25
    v_cvt_f32_i32 v26, v26
    v_cvt_f32_i32 v27, v27
    v_pk_add_f32 v[24:25], v[24:25], v[12:13] op_sel:[0,0] op_sel_hi:[1,0] neg_lo:[0,1] neg_hi:[0,1]
    v_pk_add_f32 v[26:27], v[26:27], v[12:13] op_sel:[0,0] op_sel_hi:[1,0] neg_lo:[0,1] neg_hi:[0,1]
    v_pk_mul_f32 v[16:17], v[24:25], v[36:37]
    v_pk_fma_f32 v[16:17], v[26:27], v[38:39], v[16:17]
    s_waitcnt lgkmcnt(2)
    v_cvt_f32_i32 v28, v28
    v_cvt_f32_i32 v29, v29
    v_cvt_f32_i32 v30, v30
    v_cvt_f32_i32 v31, v31
    v_pk_add_f32 v[28:29], v[28:29], v[12:13] op_sel:[0,0] op_sel_hi:[1,0] neg_lo:[0,1] neg_hi:[0,1]
    v_pk_add_f32 v[30:31], v[30:31], v[12:13] op_sel:[0,0] op_sel_hi:[1,0] neg_lo:[0,1] neg_hi:[0,1]
    v_pk_fma_f32 v[16:17], v[28:29], v[40:41], v[16:17]
    v_pk_fma_f32 v[16:17], v[30:31], v[42:43], v[16:17]
    s_waitcnt lgkmcnt(1)
    v_cvt_f32_i32 v32, v32
    v_cvt_f32_i32 v33, v33
    v_cvt_f32_i32 v34, v34
    v_cvt_f32_i32 v35, v35
    v_pk_add_f32 v[32:33], v[32:33], v[12:13] op_sel:[0,0] op_sel_hi:[1,0] neg_lo:[0,1] neg_hi:[0,1]
    v_pk_add_f32 v[34:35], v[34:35], v[12:13] op_sel:[0,0] op_sel_hi:[1,0] neg_lo:[0,1] neg_hi:[0,1]
    v_pk_fma_f32 v[16:17], v[32:33], v[44:45], v[16:17]
    v_pk_fma_f32 v[16:17], v[34:35], v[46:47], v[16:17]
    v_add_f32 v16, v16, v17
    v_cndmask_b32 v23, v10, v11, s[86:87]
    v_lshlrev_b32 v23, 16, v23
    v_add_f32_dpp v18, v16, v16 row_ror:8 row_mask:0xf bank_mask:0xc
    v_mul_f32 v23, 0x3dd53b95, v23
    s_nop 0
    v_add_f32_dpp v18, v18, v18 row_half_mirror row_mask:0xf bank_mask:0xf
    s_nop 1
    v_add_f32_dpp v18, v18, v18 quad_perm:[2,3,0,1] row_mask:0xf bank_mask:0xf
    s_nop 1
    v_add_f32_dpp v18, v18, v18 quad_perm:[1,0,3,2] row_mask:0xf bank_mask:0xf
    v_mul_f32 v18, v23, v18
    ds_write_b32 v4, v18 offset:256
    s_cmp_lg_u32 s81, 0
    s_cbranch_scc1 L_ncs4
    s_waitcnt vmcnt(18)
    v_perm_b32 v36, v122, v120, s83
    v_perm_b32 v122, v122, v120, s84
    v_perm_b32 v37, v123, v121, s83
    v_perm_b32 v123, v123, v121, s84
    v_perm_b32 v38, v126, v124, s83
    v_perm_b32 v126, v126, v124, s84
    v_perm_b32 v39, v127, v125, s83
    v_perm_b32 v127, v127, v125, s84
    v_perm_b32 v40, v130, v128, s83
    v_perm_b32 v130, v130, v128, s84
    v_perm_b32 v41, v131, v129, s83
    v_perm_b32 v131, v131, v129, s84
    v_mov_b64 v[120:121], v[36:37]
    v_mov_b64 v[124:125], v[38:39]
    v_mov_b64 v[128:129], v[40:41]
    s_nop 1
L_ncs4:
    v_dot2_f32_bf16 v36, v120, v48, 0
    v_dot2_f32_bf16 v37, v122, v49, 0
    v_dot2_f32_bf16 v38, v121, v50, 0
    v_dot2_f32_bf16 v39, v123, v51, 0
    v_dot2_f32_bf16 v40, v124, v52, 0
    v_dot2_f32_bf16 v41, v126, v53, 0
    v_dot2_f32_bf16 v42, v125, v54, 0
    v_dot2_f32_bf16 v43, v127, v55, 0
    v_dot2_f32_bf16 v44, v128, v56, 0
    v_dot2_f32_bf16 v45, v130, v57, 0
    v_dot2_f32_bf16 v46, v129, v58, 0
    v_dot2_f32_bf16 v47, v131, v59, 0
    s_add_u32 s79, s79, 12
    s_cmp_ge_i32 s80, s79
    s_cbranch_scc1 L_kr4g
L_kr4:
    ds_read_b32 v19, v7
    s_sleep 1
    s_waitcnt lgkmcnt(0)
    v_readlane_b32 s80, v19, 5
    s_nop 0
    s_cmp_lt_i32 s80, s79
    s_cbranch_scc1 L_kr4
L_kr4g:
    ds_read_b32 v10, v3 offset:512
    ds_read_b128 v[24:27], v2 offset:0
    ds_read_b128 v[28:31], v2 offset:256
    ds_read_b128 v[32:35], v2 offset:512
    v_add_u32 v6, 1, v6
    ds_write_b32 v5, v6
    s_waitcnt lgkmcnt(3)
    v_and_b32 v12, 0xffff0000, v10
    v_cvt_f32_i32 v24, v24
    v_cvt_f32_i32 v25, v25
    v_cvt_f32_i32 v26, v26
    v_cvt_f32_i32 v27, v27
    v_pk_add_f32 v[24:25], v[24:25], v[12:13] op_sel:[0,0] op_sel_hi:[1,0] neg_lo:[0,1] neg_hi:[0,1]
    v_pk_add_f32 v[26:27], v[26:27], v[12:13] op_sel:[0,0] op_sel_hi:[1,0] neg_lo:[0,1] neg_hi:[0,1]
    v_pk_mul_f32 v[14:15], v[24:25], v[36:37]
    v_pk_fma_f32 v[14:15], v[26:27], v[38:39], v[14:15]
    s_waitcnt lgkmcnt(2)
    v_cvt_f32_i32 v28, v28
    v_cvt_f32_i32 v29, v29
    v_cvt_f32_i32 v30, v30
    v_cvt_f32_i32 v31, v31
    v_pk_add_f32 v[28:29], v[28:29], v[12:13] op_sel:[0,0] op_sel_hi:[1,0] neg_lo:[0,1] neg_hi:[0,1]
    v_pk_add_f32 v[30:31], v[30:31], v[12:13] op_sel:[0,0] op_sel_hi:[1,0] neg_lo:[0,1] neg_hi:[0,1]
    v_pk_fma_f32 v[14:15], v[28:29], v[40:41], v[14:15]
    v_pk_fma_f32 v[14:15], v[30:31], v[42:43], v[14:15]
    s_waitcnt lgkmcnt(1)
    v_cvt_f32_i32 v32, v32
    v_cvt_f32_i32 v33, v33
    v_cvt_f32_i32 v34, v34
    v_cvt_f32_i32 v35, v35
    v_pk_add_f32 v[32:33], v[32:33], v[12:13] op_sel:[0,0] op_sel_hi:[1,0] neg_lo:[0,1] neg_hi:[0,1]
    v_pk_add_f32 v[34:35], v[34:35], v[12:13] op_sel:[0,0] op_sel_hi:[1,0] neg_lo:[0,1] neg_hi:[0,1]
    v_pk_fma_f32 v[14:15], v[32:33], v[44:45], v[14:15]
    v_pk_fma_f32 v[14:15], v[34:35], v[46:47], v[14:15]
    v_add_f32 v14, v14, v15
    s_nop 1
    v_add_f32_dpp v18, v14, v14 row_ror:8 row_mask:0xf bank_mask:0x3
    s_cmp_lg_u32 s81, 0
    s_nop 0
    s_cbranch_scc1 L_ncs5
    s_waitcnt vmcnt(12)
    v_perm_b32 v36, v134, v132, s83
    v_perm_b32 v134, v134, v132, s84
    v_perm_b32 v37, v135, v133, s83
    v_perm_b32 v135, v135, v133, s84
    v_perm_b32 v38, v138, v136, s83
    v_perm_b32 v138, v138, v136, s84
    v_perm_b32 v39, v139, v137, s83
    v_perm_b32 v139, v139, v137, s84
    v_perm_b32 v40, v142, v140, s83
    v_perm_b32 v142, v142, v140, s84
    v_perm_b32 v41, v143, v141, s83
    v_perm_b32 v143, v143, v141, s84
    v_mov_b64 v[132:133], v[36:37]
    v_mov_b64 v[136:137], v[38:39]
    v_mov_b64 v[140:141], v[40:41]
    s_nop 1
L_ncs5:
    v_dot2_f32_bf16 v36, v132, v48, 0
    v_dot2_f32_bf16 v37, v134, v49, 0
    v_dot2_f32_bf16 v38, v133, v50, 0
    v_dot2_f32_bf16 v39, v135, v51, 0
    v_dot2_f32_bf16 v40, v136, v52, 0
    v_dot2_f32_bf16 v41, v138, v53, 0
    v_dot2_f32_bf16 v42, v137, v54, 0
    v_dot2_f32_bf16 v43, v139, v55, 0
    v_dot2_f32_bf16 v44, v140, v56, 0
    v_dot2_f32_bf16 v45, v142, v57, 0
    v_dot2_f32_bf16 v46, v141, v58, 0
    v_dot2_f32_bf16 v47, v143, v59, 0
    s_add_u32 s79, s79, 12
    s_cmp_ge_i32 s80, s79
    s_cbranch_scc1 L_kr5g
L_kr5:
    ds_read_b32 v19, v7
    s_sleep 1
    s_waitcnt lgkmcnt(0)
    v_readlane_b32 s80, v19, 5
    s_nop 0
    s_cmp_lt_i32 s80, s79
    s_cbranch_scc1 L_kr5
L_kr5g:
    ds_read_b32 v11, v3 offset:640
    ds_read_b128 v[24:27], v2 offset:12288
    ds_read_b128 v[28:31], v2 offset:12544
    ds_read_b128 v[32:35], v2 offset:12800
    v_add_u32 v6, 1, v6
    ds_write_b32 v5, v6
    s_waitcnt lgkmcnt(3)
    v_and_b32 v12, 0xffff0000, v11
    v_cvt_f32_i32 v24, v24
    v_cvt_f32_i32 v25, v25
    v_cvt_f32_i32 v26, v26
    v_cvt_f32_i32 v27, v27
    v_pk_add_f32 v[24:25], v[24:25], v[12:13] op_sel:[0,0] op_sel_hi:[1,0] neg_lo:[0,1] neg_hi:[0,1]
    v_pk_add_f32 v[26:27], v[26:27], v[12:13] op_sel:[0,0] op_sel_hi:[1,0] neg_lo:[0,1] neg_hi:[0,1]
    v_pk_mul_f32 v[16:17], v[24:25], v[36:37]
    v_pk_fma_f32 v[16:17], v[26:27], v[38:39], v[16:17]
    s_waitcnt lgkmcnt(2)
    v_cvt_f32_i32 v28, v28
    v_cvt_f32_i32 v29, v29
    v_cvt_f32_i32 v30, v30
    v_cvt_f32_i32 v31, v31
    v_pk_add_f32 v[28:29], v[28:29], v[12:13] op_sel:[0,0] op_sel_hi:[1,0] neg_lo:[0,1] neg_hi:[0,1]
    v_pk_add_f32 v[30:31], v[30:31], v[12:13] op_sel:[0,0] op_sel_hi:[1,0] neg_lo:[0,1] neg_hi:[0,1]
    v_pk_fma_f32 v[16:17], v[28:29], v[40:41], v[16:17]
    v_pk_fma_f32 v[16:17], v[30:31], v[42:43], v[16:17]
    s_waitcnt lgkmcnt(1)
    v_cvt_f32_i32 v32, v32
    v_cvt_f32_i32 v33, v33
    v_cvt_f32_i32 v34, v34
    v_cvt_f32_i32 v35, v35
    v_pk_add_f32 v[32:33], v[32:33], v[12:13] op_sel:[0,0] op_sel_hi:[1,0] neg_lo:[0,1] neg_hi:[0,1]
    v_pk_add_f32 v[34:35], v[34:35], v[12:13] op_sel:[0,0] op_sel_hi:[1,0] neg_lo:[0,1] neg_hi:[0,1]
    v_pk_fma_f32 v[16:17], v[32:33], v[44:45], v[16:17]
    v_pk_fma_f32 v[16:17], v[34:35], v[46:47], v[16:17]
    v_add_f32 v16, v16, v17
    v_cndmask_b32 v23, v10, v11, s[86:87]
    v_lshlrev_b32 v23, 16, v23
    v_add_f32_dpp v18, v16, v16 row_ror:8 row_mask:0xf bank_mask:0xc
    v_mul_f32 v23, 0x3dd53b95, v23
    s_nop 0
    v_add_f32_dpp v18, v18, v18 row_half_mirror row_mask:0xf bank_mask:0xf
    s_nop 1
    v_add_f32_dpp v18, v18, v18 quad_perm:[2,3,0,1] row_mask:0xf bank_mask:0xf
    s_nop 1
    v_add_f32_dpp v18, v18, v18 quad_perm:[1,0,3,2] row_mask:0xf bank_mask:0xf
    v_mul_f32 v18, v23, v18
    ds_write_b32 v4, v18 offset:512
    s_cmp_lg_u32 s81, 0
    s_cbranch_scc1 L_ncs6
    s_waitcnt vmcnt(6)
    v_perm_b32 v36, v146, v144, s83
    v_perm_b32 v146, v146, v144, s84
    v_perm_b32 v37, v147, v145, s83
    v_perm_b32 v147, v147, v145, s84
    v_perm_b32 v38, v150, v148, s83
    v_perm_b32 v150, v150, v148, s84
    v_perm_b32 v39, v151, v149, s83
    v_perm_b32 v151, v151, v149, s84
    v_perm_b32 v40, v154, v152, s83
    v_perm_b32 v154, v154, v152, s84
    v_perm_b32 v41, v155, v153, s83
    v_perm_b32 v155, v155, v153, s84
    v_mov_b64 v[144:145], v[36:37]
    v_mov_b64 v[148:149], v[38:39]
    v_mov_b64 v[152:153], v[40:41]
    s_nop 1
L_ncs6:
    v_dot2_f32_bf16 v36, v144, v48, 0
    v_dot2_f32_bf16 v37, v146, v49, 0
    v_dot2_f32_bf16 v38, v145, v50, 0
    v_dot2_f32_bf16 v39, v147, v51, 0
    v_dot2_f32_bf16 v40, v148, v52, 0
    v_dot2_f32_bf16 v41, v150, v53, 0
    v_dot2_f32_bf16 v42, v149, v54, 0
    v_dot2_f32_bf16 v43, v151, v55, 0
    v_dot2_f32_bf16 v44, v152, v56, 0
    v_dot2_f32_bf16 v45, v154, v57, 0
    v_dot2_f32_bf16 v46, v153, v58, 0
    v_dot2_f32_bf16 v47, v155, v59, 0
    s_add_u32 s79, s79, 12
    s_cmp_ge_i32 s80, s79
    s_cbranch_scc1 L_kr6g
L_kr6:
    ds_read_b32 v19, v7
    s_sleep 1
    s_waitcnt lgkmcnt(0)
    v_readlane_b32 s80, v19, 5
    s_nop 0
    s_cmp_lt_i32 s80, s79
    s_cbranch_scc1 L_kr6
L_kr6g:
    ds_read_b32 v10, v3 offset:768
    ds_read_b128 v[24:27], v2 offset:24576
    ds_read_b128 v[28:31], v2 offset:24832
    ds_read_b128 v[32:35], v2 offset:25088
    v_add_u32 v6, 1, v6
    ds_write_b32 v5, v6
    s_waitcnt lgkmcnt(3)
    v_and_b32 v12, 0xffff0000, v10
    v_cvt_f32_i32 v24, v24
    v_cvt_f32_i32 v25, v25
    v_cvt_f32_i32 v26, v26
    v_cvt_f32_i32 v27, v27
    v_pk_add_f32 v[24:25], v[24:25], v[12:13] op_sel:[0,0] op_sel_hi:[1,0] neg_lo:[0,1] neg_hi:[0,1]
    v_pk_add_f32 v[26:27], v[26:27], v[12:13] op_sel:[0,0] op_sel_hi:[1,0] neg_lo:[0,1] neg_hi:[0,1]
    v_pk_mul_f32 v[14:15], v[24:25], v[36:37]
    v_pk_fma_f32 v[14:15], v[26:27], v[38:39], v[14:15]
    s_waitcnt lgkmcnt(2)
    v_cvt_f32_i32 v28, v28
    v_cvt_f32_i32 v29, v29
    v_cvt_f32_i32 v30, v30
    v_cvt_f32_i32 v31, v31
    v_pk_add_f32 v[28:29], v[28:29], v[12:13] op_sel:[0,0] op_sel_hi:[1,0] neg_lo:[0,1] neg_hi:[0,1]
    v_pk_add_f32 v[30:31], v[30:31], v[12:13] op_sel:[0,0] op_sel_hi:[1,0] neg_lo:[0,1] neg_hi:[0,1]
    v_pk_fma_f32 v[14:15], v[28:29], v[40:41], v[14:15]
    v_pk_fma_f32 v[14:15], v[30:31], v[42:43], v[14:15]
    s_waitcnt lgkmcnt(1)
    v_cvt_f32_i32 v32, v32
    v_cvt_f32_i32 v33, v33
    v_cvt_f32_i32 v34, v34
    v_cvt_f32_i32 v35, v35
    v_pk_add_f32 v[32:33], v[32:33], v[12:13] op_sel:[0,0] op_sel_hi:[1,0] neg_lo:[0,1] neg_hi:[0,1]
    v_pk_add_f32 v[34:35], v[34:35], v[12:13] op_sel:[0,0] op_sel_hi:[1,0] neg_lo:[0,1] neg_hi:[0,1]
    v_pk_fma_f32 v[14:15], v[32:33], v[44:45], v[14:15]
    v_pk_fma_f32 v[14:15], v[34:35], v[46:47], v[14:15]
    v_add_f32 v14, v14, v15
    s_nop 1
    v_add_f32_dpp v18, v14, v14 row_ror:8 row_mask:0xf bank_mask:0x3
    s_cmp_lg_u32 s81, 0
    s_nop 0
    s_cbranch_scc1 L_ncs7
    s_waitcnt vmcnt(0)
    v_perm_b32 v36, v158, v156, s83
    v_perm_b32 v158, v158, v156, s84
    v_perm_b32 v37, v159, v157, s83
    v_perm_b32 v159, v159, v157, s84
    v_perm_b32 v38, v162, v160, s83
    v_perm_b32 v162, v162, v160, s84
    v_perm_b32 v39, v163, v161, s83
    v_perm_b32 v163, v163, v161, s84
    v_perm_b32 v40, v166, v164, s83
    v_perm_b32 v166, v166, v164, s84
    v_perm_b32 v41, v167, v165, s83
    v_perm_b32 v167, v167, v165, s84
    v_mov_b64 v[156:157], v[36:37]
    v_mov_b64 v[160:161], v[38:39]
    v_mov_b64 v[164:165], v[40:41]
    s_nop 1
L_ncs7:
    v_dot2_f32_bf16 v36, v156, v48, 0
    v_dot2_f32_bf16 v37, v158, v49, 0
    v_dot2_f32_bf16 v38, v157, v50, 0
    v_dot2_f32_bf16 v39, v159, v51, 0
    v_dot2_f32_bf16 v40, v160, v52, 0
    v_dot2_f32_bf16 v41, v162, v53, 0
    v_dot2_f32_bf16 v42, v161, v54, 0
    v_dot2_f32_bf16 v43, v163, v55, 0
    v_dot2_f32_bf16 v44, v164, v56, 0
    v_dot2_f32_bf16 v45, v166, v57, 0
    v_dot2_f32_bf16 v46, v165, v58, 0
    v_dot2_f32_bf16 v47, v167, v59, 0
    s_add_u32 s79, s79, 12
    s_cmp_ge_i32 s80, s79
    s_cbranch_scc1 L_kr7g
L_kr7:
    ds_read_b32 v19, v7
    s_sleep 1
    s_waitcnt lgkmcnt(0)
    v_readlane_b32 s80, v19, 5
    s_nop 0
    s_cmp_lt_i32 s80, s79
    s_cbranch_scc1 L_kr7
L_kr7g:
    ds_read_b32 v11, v3 offset:896
    ds_read_b128 v[24:27], v2 offset:36864
    ds_read_b128 v[28:31], v2 offset:37120
    ds_read_b128 v[32:35], v2 offset:37376
    v_add_u32 v6, 1, v6
    ds_write_b32 v5, v6
    s_waitcnt lgkmcnt(3)
    v_and_b32 v12, 0xffff0000, v11
    v_cvt_f32_i32 v24, v24
    v_cvt_f32_i32 v25, v25
    v_cvt_f32_i32 v26, v26
    v_cvt_f32_i32 v27, v27
    v_pk_add_f32 v[24:25], v[24:25], v[12:13] op_sel:[0,0] op_sel_hi:[1,0] neg_lo:[0,1] neg_hi:[0,1]
    v_pk_add_f32 v[26:27], v[26:27], v[12:13] op_sel:[0,0] op_sel_hi:[1,0] neg_lo:[0,1] neg_hi:[0,1]
    v_pk_mul_f32 v[16:17], v[24:25], v[36:37]
    v_pk_fma_f32 v[16:17], v[26:27], v[38:39], v[16:17]
    s_waitcnt lgkmcnt(2)
    v_cvt_f32_i32 v28, v28
    v_cvt_f32_i32 v29, v29
    v_cvt_f32_i32 v30, v30
    v_cvt_f32_i32 v31, v31
    v_pk_add_f32 v[28:29], v[28:29], v[12:13] op_sel:[0,0] op_sel_hi:[1,0] neg_lo:[0,1] neg_hi:[0,1]
    v_pk_add_f32 v[30:31], v[30:31], v[12:13] op_sel:[0,0] op_sel_hi:[1,0] neg_lo:[0,1] neg_hi:[0,1]
    v_pk_fma_f32 v[16:17], v[28:29], v[40:41], v[16:17]
    v_pk_fma_f32 v[16:17], v[30:31], v[42:43], v[16:17]
    s_waitcnt lgkmcnt(1)
    v_cvt_f32_i32 v32, v32
    v_cvt_f32_i32 v33, v33
    v_cvt_f32_i32 v34, v34
    v_cvt_f32_i32 v35, v35
    v_pk_add_f32 v[32:33], v[32:33], v[12:13] op_sel:[0,0] op_sel_hi:[1,0] neg_lo:[0,1] neg_hi:[0,1]
    v_pk_add_f32 v[34:35], v[34:35], v[12:13] op_sel:[0,0] op_sel_hi:[1,0] neg_lo:[0,1] neg_hi:[0,1]
    v_pk_fma_f32 v[16:17], v[32:33], v[44:45], v[16:17]
    v_pk_fma_f32 v[16:17], v[34:35], v[46:47], v[16:17]
    v_add_f32 v16, v16, v17
    v_cndmask_b32 v23, v10, v11, s[86:87]
    v_lshlrev_b32 v23, 16, v23
    v_add_f32_dpp v18, v16, v16 row_ror:8 row_mask:0xf bank_mask:0xc
    v_mul_f32 v23, 0x3dd53b95, v23
    s_nop 0
    v_add_f32_dpp v18, v18, v18 row_half_mirror row_mask:0xf bank_mask:0xf
    s_nop 1
    v_add_f32_dpp v18, v18, v18 quad_perm:[2,3,0,1] row_mask:0xf bank_mask:0xf
    s_nop 1
    v_add_f32_dpp v18, v18, v18 quad_perm:[1,0,3,2] row_mask:0xf bank_mask:0xf
    v_mul_f32 v18, v23, v18
    ds_write_b32 v4, v18 offset:768
    s_mov_b64 exec, 1
    ds_add_u32 v22, v8
    s_mov_b64 exec, -1
    v_add_u32 v3, 1024, v3
    v_add_u32 v4, 1024, v4
    s_add_u32 s81, s81, 1
    s_cmp_lt_u32 s81, 16
    s_cbranch_scc1 L_kph
    v_subrev_u32 v3, 512, v3
    s_mul_i32 s92, s78, 768
    s_add_u32 s92, s92, 65536
    v_and_b32 v18, 15, v1
    v_lshl_add_u32 v9, v18, 4, s92
    v_lshrrev_b32 v18, 4, v1
    v_lshl_add_u32 v9, v18, 2, v9
    v_mov_b32 v22, 77920
    s_mov_b64 s[20:21], s[74:75]
    s_mov_b32 s22, 1610612736
    s_mov_b32 s23, 0x20000
    s_mov_b64 s[28:29], s[70:71]
    s_mov_b32 s30, 12288
    s_mov_b32 s31, 0x20000
    s_lshr_b32 s93, s2, 3
    s_mul_i32 s92, s93, 43
    s_lshr_b32 s92, s92, 8
    s_mul_i32 s94, s92, 6
    s_sub_u32 s93, s93, s94
    s_and_b32 s94, s2, 6
    s_lshl1_add_u32 s92, s94, s92
    s_and_b32 s94, s2, 1
    s_lshl1_add_u32 s92, s92, s94
    s_and_b32 s94, s92, 1
    s_lshl2_add_u32 s94, s94, s78
    s_mul_i32 s32, s94, 32768
    s_lshr_b32 s94, s92, 1
    s_mul_i32 s94, s94, 266240
    s_add_u32 s32, s32, s94
    s_lshl_b32 s94, s93, 7
    s_add_u32 s32, s32, s94
    s_add_u32 s33, s32, 8192
    s_add_u32 s34, s33, 8192
    s_add_u32 s35, s34, 8192
    s_mul_i32 s36, s92, 6
    s_add_u32 s36, s36, s93
    s_lshl_b32 s36, s36, 6
    s_lshr_b32 s37, s92, 1
    s_sub_u32 s37, s37, 1
    s_and_b32 s37, s37, 15
    s_add_u32 s37, s37, 2
    s_min_u32 s37, s37, 16
    v_lshrrev_b32 v19, 3, v1
    v_and_b32 v69, 7, v1
    v_mul_u32_u24 v68, 1024, v19
    v_lshl_add_u32 v68, v69, 4, v68
    v_lshlrev_b32 v69, 3, v69
    v_lshl_add_u32 v69, v18, 1, v69
    s_lshl4_add_u32 s92, s78, 78336
    v_lshl_add_u32 v70, v19, 6, s92
    s_lshl_b32 s92, s78, 8
    s_add_u32 s92, s92, 1024
    v_add_u32 v4, s92, v7
    s_mov_b32 s81, 0
    s_nop 0
L_vph:
    v_mov_b64 v[72:73], 0
    v_mov_b64 v[74:75], 0
    v_mov_b64 v[76:77], 0
    v_mov_b64 v[78:79], 0
    v_mov_b64 v[80:81], 0
    v_mov_b64 v[82:83], 0
    s_and_b32 s92, s81, 3
    s_mul_i32 s92, s92, 3072
    v_add_u32 v71, s92, v9
    s_mov_b32 s88, 0
    s_nop 0
L_vw:
    ds_read_b32 v19, v7
    s_waitcnt lgkmcnt(0)
    v_readlane_b32 s92, v19, 15
    v_readlane_b32 s93, v19, 13
    s_nop 0
    s_and_b32 s93, s93, 16
    s_add_u32 s92, s92, 4
    s_min_u32 s93, s93, s92
    s_cmp_le_u32 s93, s81
    s_cbranch_scc1 L_vw
    s_cmp_lg_u32 s81, 15
    s_cbranch_scc1 L_vit
    v_readlane_b32 s4, v19, 6
    s_cmp_ge_u32 s2, 192
    s_nop 3
    s_cbranch_scc1 L_vit
    s_cmp_eq_u32 s4, 0
    s_cbranch_scc1 L_vw
    ds_read_b128 v[64:67], v70
    s_bfe_u32 s5, s4, 0x80008
    s_bfe_u32 s6, s4, 0x80010
    s_lshr_b32 s7, s4, 24
    s_and_b32 s4, s4, 0xff
L_vit:
    s_add_u32 s79, s79, 12
    s_cmp_ge_i32 s80, s79
    s_cbranch_scc1 L_vr0g
L_vr0:
    ds_read_b32 v19, v7
    s_waitcnt lgkmcnt(0)
    v_readlane_b32 s80, v19, 5
    s_nop 0
    s_cmp_lt_i32 s80, s79
    s_cbranch_scc1 L_vr0
L_vr0g:
    ds_read_b32 v10, v3 offset:384
    ds_read_b128 v[24:27], v2 offset:0
    ds_read_b128 v[28:31], v2 offset:256
    ds_read_b128 v[32:35], v2 offset:512
    v_add_u32 v6, 1, v6
    ds_write_b32 v5, v6
    s_waitcnt lgkmcnt(3)
    v_cvt_f32_i32 v24, v24
    v_cvt_f32_i32 v25, v25
    v_cvt_f32_i32 v26, v26
    v_cvt_f32_i32 v27, v27
    v_pk_fma_f32 v[72:73], v[24:25], v[10:11], v[72:73] op_sel:[0,0,0] op_sel_hi:[1,0,1]
    v_pk_fma_f32 v[74:75], v[26:27], v[10:11], v[74:75] op_sel:[0,0,0] op_sel_hi:[1,0,1]
    s_waitcnt lgkmcnt(2)
    v_cvt_f32_i32 v28, v28
    v_cvt_f32_i32 v29, v29
    v_cvt_f32_i32 v30, v30
    v_cvt_f32_i32 v31, v31
    v_pk_fma_f32 v[76:77], v[28:29], v[10:11], v[76:77] op_sel:[0,0,0] op_sel_hi:[1,0,1]
    v_pk_fma_f32 v[78:79], v[30:31], v[10:11], v[78:79] op_sel:[0,0,0] op_sel_hi:[1,0,1]
    s_waitcnt lgkmcnt(1)
    v_cvt_f32_i32 v32, v32
    v_cvt_f32_i32 v33, v33
    v_cvt_f32_i32 v34, v34
    v_cvt_f32_i32 v35, v35
    v_pk_fma_f32 v[80:81], v[32:33], v[10:11], v[80:81] op_sel:[0,0,0] op_sel_hi:[1,0,1]
    v_pk_fma_f32 v[82:83], v[34:35], v[10:11], v[82:83] op_sel:[0,0,0] op_sel_hi:[1,0,1]
    s_add_u32 s79, s79, 12
    s_cmp_ge_i32 s80, s79
    s_cbranch_scc1 L_vr1g
L_vr1:
    ds_read_b32 v19, v7
    s_waitcnt lgkmcnt(0)
    v_readlane_b32 s80, v19, 5
    s_nop 0
    s_cmp_lt_i32 s80, s79
    s_cbranch_scc1 L_vr1
L_vr1g:
    ds_read_b32 v10, v3 offset:256
    ds_read_b128 v[24:27], v2 offset:12288
    ds_read_b128 v[28:31], v2 offset:12544
    ds_read_b128 v[32:35], v2 offset:12800
    v_add_u32 v6, 1, v6
    ds_write_b32 v5, v6
    s_waitcnt lgkmcnt(3)
    v_cvt_f32_i32 v24, v24
    v_cvt_f32_i32 v25, v25
    v_cvt_f32_i32 v26, v26
    v_cvt_f32_i32 v27, v27
    v_pk_fma_f32 v[72:73], v[24:25], v[10:11], v[72:73] op_sel:[0,0,0] op_sel_hi:[1,0,1]
    v_pk_fma_f32 v[74:75], v[26:27], v[10:11], v[74:75] op_sel:[0,0,0] op_sel_hi:[1,0,1]
    s_waitcnt lgkmcnt(2)
    v_cvt_f32_i32 v28, v28
    v_cvt_f32_i32 v29, v29
    v_cvt_f32_i32 v30, v30
    v_cvt_f32_i32 v31, v31
    v_pk_fma_f32 v[76:77], v[28:29], v[10:11], v[76:77] op_sel:[0,0,0] op_sel_hi:[1,0,1]
    v_pk_fma_f32 v[78:79], v[30:31], v[10:11], v[78:79] op_sel:[0,0,0] op_sel_hi:[1,0,1]
    s_waitcnt lgkmcnt(1)
    v_cvt_f32_i32 v32, v32
    v_cvt_f32_i32 v33, v33
    v_cvt_f32_i32 v34, v34
    v_cvt_f32_i32 v35, v35
    v_pk_fma_f32 v[80:81], v[32:33], v[10:11], v[80:81] op_sel:[0,0,0] op_sel_hi:[1,0,1]
    v_pk_fma_f32 v[82:83], v[34:35], v[10:11], v[82:83] op_sel:[0,0,0] op_sel_hi:[1,0,1]
    s_add_u32 s79, s79, 12
    s_cmp_ge_i32 s80, s79
    s_cbranch_scc1 L_vr2g
L_vr2:
    ds_read_b32 v19, v7
    s_waitcnt lgkmcnt(0)
    v_readlane_b32 s80, v19, 5
    s_nop 0
    s_cmp_lt_i32 s80, s79
    s_cbranch_scc1 L_vr2
L_vr2g:
    ds_read_b32 v10, v3 offset:128
    ds_read_b128 v[24:27], v2 offset:24576
    ds_read_b128 v[28:31], v2 offset:24832
    ds_read_b128 v[32:35], v2 offset:25088
    v_add_u32 v6, 1, v6
    ds_write_b32 v5, v6
    s_waitcnt lgkmcnt(3)
    v_cvt_f32_i32 v24, v24
    v_cvt_f32_i32 v25, v25
    v_cvt_f32_i32 v26, v26
    v_cvt_f32_i32 v27, v27
    v_pk_fma_f32 v[72:73], v[24:25], v[10:11], v[72:73] op_sel:[0,0,0] op_sel_hi:[1,0,1]
    v_pk_fma_f32 v[74:75], v[26:27], v[10:11], v[74:75] op_sel:[0,0,0] op_sel_hi:[1,0,1]
    s_waitcnt lgkmcnt(2)
    v_cvt_f32_i32 v28, v28
    v_cvt_f32_i32 v29, v29
    v_cvt_f32_i32 v30, v30
    v_cvt_f32_i32 v31, v31
    v_pk_fma_f32 v[76:77], v[28:29], v[10:11], v[76:77] op_sel:[0,0,0] op_sel_hi:[1,0,1]
    v_pk_fma_f32 v[78:79], v[30:31], v[10:11], v[78:79] op_sel:[0,0,0] op_sel_hi:[1,0,1]
    s_waitcnt lgkmcnt(1)
    v_cvt_f32_i32 v32, v32
    v_cvt_f32_i32 v33, v33
    v_cvt_f32_i32 v34, v34
    v_cvt_f32_i32 v35, v35
    v_pk_fma_f32 v[80:81], v[32:33], v[10:11], v[80:81] op_sel:[0,0,0] op_sel_hi:[1,0,1]
    v_pk_fma_f32 v[82:83], v[34:35], v[10:11], v[82:83] op_sel:[0,0,0] op_sel_hi:[1,0,1]
    s_add_u32 s79, s79, 12
    s_cmp_ge_i32 s80, s79
    s_cbranch_scc1 L_vr3g
L_vr3:
    ds_read_b32 v19, v7
    s_waitcnt lgkmcnt(0)
    v_readlane_b32 s80, v19, 5
    s_nop 0
    s_cmp_lt_i32 s80, s79
    s_cbranch_scc1 L_vr3
L_vr3g:
    ds_read_b32 v10, v3 offset:0
    ds_read_b128 v[24:27], v2 offset:36864
    ds_read_b128 v[28:31], v2 offset:37120
    ds_read_b128 v[32:35], v2 offset:37376
    v_add_u32 v6, 1, v6
    ds_write_b32 v5, v6
    v_subrev_u32 v3, 512, v3
    s_add_u32 s88, s88, 1
    s_cmp_lt_u32 s88, 2
    s_waitcnt lgkmcnt(3)
    v_cvt_f32_i32 v24, v24
    v_cvt_f32_i32 v25, v25
    v_cvt_f32_i32 v26, v26
    v_cvt_f32_i32 v27, v27
    v_pk_fma_f32 v[72:73], v[24:25], v[10:11], v[72:73] op_sel:[0,0,0] op_sel_hi:[1,0,1]
    v_pk_fma_f32 v[74:75], v[26:27], v[10:11], v[74:75] op_sel:[0,0,0] op_sel_hi:[1,0,1]
    s_waitcnt lgkmcnt(2)
    v_cvt_f32_i32 v28, v28
    v_cvt_f32_i32 v29, v29
    v_cvt_f32_i32 v30, v30
    v_cvt_f32_i32 v31, v31
    v_pk_fma_f32 v[76:77], v[28:29], v[10:11], v[76:77] op_sel:[0,0,0] op_sel_hi:[1,0,1]
    v_pk_fma_f32 v[78:79], v[30:31], v[10:11], v[78:79] op_sel:[0,0,0] op_sel_hi:[1,0,1]
    s_waitcnt lgkmcnt(1)
    v_cvt_f32_i32 v32, v32
    v_cvt_f32_i32 v33, v33
    v_cvt_f32_i32 v34, v34
    v_cvt_f32_i32 v35, v35
    v_pk_fma_f32 v[80:81], v[32:33], v[10:11], v[80:81] op_sel:[0,0,0] op_sel_hi:[1,0,1]
    v_pk_fma_f32 v[82:83], v[34:35], v[10:11], v[82:83] op_sel:[0,0,0] op_sel_hi:[1,0,1]
    s_cbranch_scc1 L_vit
    v_permlane32_swap_b32 v72, v74
    v_permlane32_swap_b32 v73, v75
    v_permlane32_swap_b32 v76, v78
    v_permlane32_swap_b32 v77, v79
    v_permlane32_swap_b32 v80, v82
    v_permlane32_swap_b32 v81, v83
    v_pk_add_f32 v[72:73], v[72:73], v[74:75]
    v_pk_add_f32 v[76:77], v[76:77], v[78:79]
    v_pk_add_f32 v[80:81], v[80:81], v[82:83]
    v_permlane16_swap_b32 v72, v73
    v_permlane16_swap_b32 v76, v77
    v_permlane16_swap_b32 v80, v81
    v_add_f32 v36, v72, v73
    v_add_f32 v37, v76, v77
    v_add_f32 v38, v80, v81
    ds_write2st64_b32 v71, v36, v37 offset0:0 offset1:1
    ds_write_b32 v71, v38 offset:512
    s_mov_b64 exec, 1
    ds_add_u32 v22, v8
    s_mov_b64 exec, -1
    v_add_u32 v22, 4, v22
    s_add_u32 s81, s81, 1
    s_cmp_lt_u32 s81, 16
    s_cbranch_scc1 L_vph
    s_cmp_ge_u32 s2, 192
    s_cbranch_scc1 L_cend
L_gw:
    ds_read_b32 v19, v7
    s_waitcnt lgkmcnt(0)
    v_readlane_b32 s92, v19, 8
    s_nop 0
    s_cmp_lt_u32 s92, s37
    s_nop 2
    s_cbranch_scc1 L_gw
L_try:
    buffer_load_dwordx4 v[48:51], v68, s[20:23], s32 offen sc0 sc1
    buffer_load_dwordx4 v[52:55], v68, s[20:23], s33 offen sc0 sc1
    buffer_load_dwordx4 v[56:59], v68, s[20:23], s34 offen sc0 sc1
    buffer_load_dwordx4 v[60:63], v68, s[20:23], s35 offen sc0 sc1
    s_waitcnt vmcnt(3)
    v_xor_b32 v48, s4, v48
    v_xor_b32 v49, s5, v49
    v_xor_b32 v50, s6, v50
    v_xor_b32 v51, s7, v51
    v_or_b32 v23, v48, v49
    v_pk_mul_f32 v[14:15], v[48:49], v[64:65] op_sel:[0,0] op_sel_hi:[1,0]
    v_or3_b32 v23, v23, v50, v51
    v_pk_mul_f32 v[16:17], v[50:51], v[64:65] op_sel:[0,0] op_sel_hi:[1,0]
    s_waitcnt vmcnt(2)
    v_xor_b32 v52, s4, v52
    v_xor_b32 v53, s5, v53
    v_xor_b32 v54, s6, v54
    v_xor_b32 v55, s7, v55
    v_or3_b32 v23, v23, v52, v53
    v_pk_fma_f32 v[14:15], v[52:53], v[64:65], v[14:15] op_sel:[0,1,0] op_sel_hi:[1,1,1]
    v_or3_b32 v23, v23, v54, v55
    v_pk_fma_f32 v[16:17], v[54:55], v[64:65], v[16:17] op_sel:[0,1,0] op_sel_hi:[1,1,1]
    s_waitcnt vmcnt(1)
    v_xor_b32 v56, s4, v56
    v_xor_b32 v57, s5, v57
    v_xor_b32 v58, s6, v58
    v_xor_b32 v59, s7, v59
    v_or3_b32 v23, v23, v56, v57
    v_pk_fma_f32 v[14:15], v[56:57], v[66:67], v[14:15] op_sel:[0,0,0] op_sel_hi:[1,0,1]
    v_or3_b32 v23, v23, v58, v59
    v_pk_fma_f32 v[16:17], v[58:59], v[66:67], v[16:17] op_sel:[0,0,0] op_sel_hi:[1,0,1]
    s_waitcnt vmcnt(0)
    v_xor_b32 v60, s4, v60
    v_xor_b32 v61, s5, v61
    v_xor_b32 v62, s6, v62
    v_xor_b32 v63, s7, v63
    v_or3_b32 v23, v23, v60, v61
    v_pk_fma_f32 v[14:15], v[60:61], v[66:67], v[14:15] op_sel:[0,1,0] op_sel_hi:[1,1,1]
    v_or3_b32 v23, v23, v62, v63
    v_pk_fma_f32 v[16:17], v[62:63], v[66:67], v[16:17] op_sel:[0,1,0] op_sel_hi:[1,1,1]
    v_and_b32 v23, 0xff, v23
    v_cmp_ne_u32 vcc, 0, v23
    s_nop 4
    s_cbranch_vccz L_cok
    s_mov_b64 exec, vcc
    s_sleep 1
    s_add_u32 s88, s88, 1
    s_cmp_lt_u32 s88, 400000
    s_cbranch_scc1 L_try
L_cok:
    s_mov_b64 exec, -1
    v_permlane32_swap_b32 v14, v16
    v_permlane32_swap_b32 v15, v17
    v_pk_add_f32 v[14:15], v[14:15], v[16:17]
    s_nop 1
    v_permlane16_swap_b32 v14, v15
    v_add_f32 v14, v14, v15
    ds_write_b32 v4, v14
    s_mov_b64 exec, 1
    ds_add_rtn_u32 v18, v7, v8 offset:28
    s_mov_b64 exec, -1
    ds_read2st64_b32 v[14:15], v7 offset0:4 offset1:5
    ds_read2st64_b32 v[16:17], v7 offset0:6 offset1:7
    s_waitcnt lgkmcnt(0)
    v_readfirstlane_b32 s92, v18
    v_pk_add_f32 v[14:15], v[14:15], v[16:17]
    v_add_f32 v14, v14, v15
    s_cmp_lg_u32 s92, 3
    s_nop 1
    s_cbranch_scc1 L_cend
    v_add_f32_dpp v14, v14, v14 row_ror:8 row_mask:0xf bank_mask:0xf
    s_mov_b32 exec_lo, 0x00ff00ff
    s_mov_b32 exec_hi, 0x00ff00ff
    v_cvt_pk_bf16_f32 v14, v14, v14
    buffer_store_short v14, v69, s[28:31], s36 offen
    s_nop 0
L_cend:
    s_waitcnt lgkmcnt(0)
    s_endpgm
L_helper:
    s_memrealtime s[96:97]
    v_bfe_u32 v22, v1, 2, 3
    v_lshl_add_u32 v22, v22, 11, s77
    v_and_b32 v22, 16383, v22
    v_lshrrev_b32 v19, 5, v1
    v_lshl_add_u32 v22, v19, 15, v22
    v_and_b32 v19, 3, v1
    v_lshlrev_b32 v19, 3, v19
    v_lshl_add_u32 v22, v22, 1, v19
    s_lshl_b32 s91, s3, 15
    v_lshlrev_b32 v2, 4, v1
    s_mov_b32 s6, 1048576
    s_mov_b32 s7, 0x20000
    s_mov_b32 s10, 1048576
    s_mov_b32 s11, 0x20000
    s_mov_b32 s14, 1048576
    s_mov_b32 s15, 0x20000
    s_mov_b32 s18, 1048576
    s_mov_b32 s19, 0x20000
    s_waitcnt lgkmcnt(0)
    s_mov_b64 s[4:5], s[52:53]
    s_mov_b64 s[8:9], s[54:55]
    s_mov_b64 s[12:13], s[58:59]
    s_mov_b64 s[16:17], s[60:61]
    buffer_load_dwordx2 v[108:109], v22, s[4:7], s91 offen
    buffer_load_dwordx2 v[110:111], v22, s[8:11], s91 offen
    buffer_load_dwordx2 v[112:113], v22, s[12:15], s91 offen
    buffer_load_dwordx2 v[114:115], v22, s[16:19], s91 offen
    s_add_u32 s91, s91, 131072
    s_barrier
    v_lshrrev_b32 v18, 1, v1
    v_lshlrev_b32 v18, 10, v18
    v_and_b32 v19, 1, v1
    v_lshl_add_u32 v18, v19, 6, v18
    s_lshr_b32 s92, s2, 3
    s_lshl_b32 s92, s92, 15
    s_and_b32 s93, s2, 7
    s_lshl_b32 s93, s93, 7
    s_add_u32 s92, s92, s93
    buffer_load_dword v6, v18, s[4:7], s92 offen
    buffer_load_dword v6, v18, s[8:11], s92 offen
    buffer_load_dword v6, v18, s[12:15], s92 offen
    buffer_load_dword v6, v18, s[16:19], s92 offen
    s_mov_b64 s[20:21], s[74:75]
    s_mov_b32 s22, 1610612736
    s_mov_b32 s23, 0x20000
    s_mov_b64 s[24:25], s[72:73]
    s_mov_b32 s26, 256
    s_mov_b32 s27, 0x20000
    s_mov_b64 s[32:33], s[48:49]
    s_mov_b32 s34, 12288
    s_mov_b32 s35, 0x20000
    s_mov_b64 s[36:37], s[62:63]
    s_mov_b32 s38, 384
    s_mov_b32 s39, 0x20000
    s_mov_b64 s[40:41], s[64:65]
    s_mov_b32 s42, 384
    s_mov_b32 s43, 0x20000
    v_lshlrev_b32 v44, 3, v1
    v_cmp_gt_u32 vcc, 24, v1
    v_mov_b32 v23, 0xffffff40
    v_mov_b32 v18, 192
    v_cndmask_b32 v23, v23, v18, vcc
    v_add_u32 v45, v44, v23
    v_mov_b32 v18, 0x80008000
    v_cndmask_b32 v46, 0, v18, vcc
    s_mov_b32 s78, s96
    s_mov_b32 s94, 0x05040100
    s_mov_b32 s95, 0x07060302
    v_lshlrev_b32 v9, 1, v2
    v_add_u32 v9, 49152, v9
    v_mov_b32 v3, 77824
    v_mov_b32 v4, 0
    v_mov_b32 v5, 0xff
    v_mov_b32 v12, v9
    buffer_load_dwordx2 v[40:41], v44, s[36:39], 0 offen
    buffer_load_dwordx2 v[42:43], v44, s[40:43], 0 offen
    s_mul_i32 s92, s3, 384
    s_add_u32 s92, s92, 6144
    buffer_load_dwordx2 v[136:137], v44, s[32:35], s92 offen
    buffer_load_dwordx2 v[138:139], v45, s[32:35], s92 offen
    buffer_load_dwordx2 v[140:141], v44, s[32:35], s92 offen offset:768
    buffer_load_dwordx2 v[142:143], v45, s[32:35], s92 offen offset:768
    s_add_u32 s92, s92, 1536
    buffer_load_dwordx2 v[144:145], v44, s[32:35], s92 offen
    buffer_load_dwordx2 v[146:147], v45, s[32:35], s92 offen
    buffer_load_dwordx2 v[148:149], v44, s[32:35], s92 offen offset:768
    buffer_load_dwordx2 v[150:151], v45, s[32:35], s92 offen offset:768
    s_add_u32 s92, s92, 1536
    buffer_load_dwordx2 v[152:153], v44, s[32:35], s92 offen
    buffer_load_dwordx2 v[154:155], v45, s[32:35], s92 offen
    buffer_load_dwordx2 v[156:157], v44, s[32:35], s92 offen offset:768
    buffer_load_dwordx2 v[158:159], v45, s[32:35], s92 offen offset:768
    s_add_u32 s92, s92, 1536
    buffer_load_dwordx2 v[160:161], v44, s[32:35], s92 offen
    buffer_load_dwordx2 v[162:163], v45, s[32:35], s92 offen
    buffer_load_dwordx2 v[164:165], v44, s[32:35], s92 offen offset:768
    buffer_load_dwordx2 v[166:167], v45, s[32:35], s92 offen offset:768
    s_waitcnt vmcnt(22)
    v_perm_b32 v116, v110, v108, s94
    v_perm_b32 v117, v114, v112, s94
    v_perm_b32 v118, v110, v108, s95
    v_perm_b32 v119, v114, v112, s95
    v_perm_b32 v120, v111, v109, s94
    v_perm_b32 v121, v115, v113, s94
    v_perm_b32 v122, v111, v109, s95
    v_perm_b32 v123, v115, v113, s95
    s_lshr_b32 s92, s91, 17
    v_mov_b32 v19, s92
    ds_write_b128 v12, v[116:119]
    ds_write_b128 v12, v[120:123] offset:16
    ds_write_b32 v3, v19 offset:48
    v_add_u32 v12, 2048, v12
    s_mov_b32 s48, 0
    s_cmp_lg_u32 s2, 0
    s_cbranch_scc1 L_ne0
    s_mul_i32 s49, s78, 0x9e3779b1
    s_lshr_b32 s93, s49, 15
    s_xor_b32 s49, s49, s93
    s_mul_i32 s49, s49, 0x85ebca6b
    s_lshr_b32 s93, s49, 13
    s_xor_b32 s49, s49, s93
    s_max_u32 s49, s49, 1
    v_mov_b32 v14, s49
    v_mov_b32 v15, 0
    s_mov_b64 exec, 1
    buffer_atomic_cmpswap v[14:15], v4, s[24:27], 0 offen sc0 sc1
    s_waitcnt vmcnt(0)
    v_readfirstlane_b32 s48, v14
    s_mov_b64 exec, -1
    s_cmp_eq_u32 s48, 0
    s_cselect_b32 s48, s49, s48
    s_nop 1
L_ne0:
    s_getpc_b64 s[92:93]
L_pc:
    s_sub_u32 s92, s92, L_pc-standalone__kv_cache_quant_pre_rope_vs_post_rope__decode_kernel
    s_subb_u32 s93, s93, 0
    s_lshr_b32 s94, s2, 3
    v_lshl_add_u32 v19, v1, 5, s94
    v_lshlrev_b32 v19, 7, v19
    v_min_u32 v19, L_end-standalone__kv_cache_quant_pre_rope_vs_post_rope__decode_kernel, v19
    s_mov_b64 exec, 63
    global_load_dword v6, v19, s[92:93]
    s_mov_b64 exec, -1
    v_lshlrev_b32 v18, 1, v44
    v_lshlrev_b32 v19, 1, v45
    v_add_u32 v18, 71680, v18
    v_add_u32 v19, 71680, v19
    v_mov_b32 v23, 78000
    s_mov_b32 s89, 0
    s_waitcnt vmcnt(1) lgkmcnt(0)
    v_xor_b32 v42, v42, v46
    v_xor_b32 v43, v43, v46
    v_lshlrev_b32 v48, 16, v40
    v_and_b32 v49, 0xffff0000, v40
    v_lshlrev_b32 v50, 16, v41
    v_and_b32 v51, 0xffff0000, v41
    v_lshlrev_b32 v52, 16, v42
    v_and_b32 v53, 0xffff0000, v42
    v_lshlrev_b32 v54, 16, v43
    v_and_b32 v55, 0xffff0000, v43
    v_and_b32 v46, 0x80000000, v46
    s_nop 1
L_hq:
    v_mov_b64 v[24:25], v[136:137]
    v_mov_b64 v[26:27], v[138:139]
    v_mov_b64 v[28:29], v[140:141]
    v_mov_b64 v[30:31], v[142:143]
    v_mov_b64 v[136:137], v[144:145]
    v_mov_b64 v[138:139], v[146:147]
    v_mov_b64 v[140:141], v[148:149]
    v_mov_b64 v[142:143], v[150:151]
    v_mov_b64 v[144:145], v[152:153]
    v_mov_b64 v[146:147], v[154:155]
    v_mov_b64 v[148:149], v[156:157]
    v_mov_b64 v[150:151], v[158:159]
    v_mov_b64 v[152:153], v[160:161]
    v_mov_b64 v[154:155], v[162:163]
    v_mov_b64 v[156:157], v[164:165]
    v_mov_b64 v[158:159], v[166:167]
    s_mov_b32 exec_hi, 0xffff
    v_lshlrev_b32 v56, 16, v24
    v_and_b32 v57, 0xffff0000, v24
    v_lshlrev_b32 v58, 16, v25
    v_and_b32 v59, 0xffff0000, v25
    v_lshlrev_b32 v60, 16, v26
    v_and_b32 v61, 0xffff0000, v26
    v_lshlrev_b32 v62, 16, v27
    v_and_b32 v63, 0xffff0000, v27
    v_pk_mul_f32 v[56:57], v[56:57], v[48:49]
    v_pk_mul_f32 v[60:61], v[60:61], v[52:53]
    v_pk_mul_f32 v[58:59], v[58:59], v[50:51]
    v_pk_mul_f32 v[62:63], v[62:63], v[54:55]
    v_cvt_pk_bf16_f32 v56, v56, v60
    v_cvt_pk_bf16_f32 v57, v57, v61
    v_cvt_pk_bf16_f32 v58, v58, v62
    v_cvt_pk_bf16_f32 v59, v59, v63
    v_and_b32 v60, 0xffff0000, v56
    v_lshlrev_b32 v56, 16, v56
    v_and_b32 v61, 0xffff0000, v57
    v_lshlrev_b32 v57, 16, v57
    v_and_b32 v62, 0xffff0000, v58
    v_lshlrev_b32 v58, 16, v58
    v_and_b32 v63, 0xffff0000, v59
    v_lshlrev_b32 v59, 16, v59
    v_pk_add_f32 v[56:57], v[56:57], v[60:61]
    v_pk_add_f32 v[58:59], v[58:59], v[62:63]
    v_cvt_pk_bf16_f32 v64, v56, v56
    v_cvt_pk_bf16_f32 v65, v57, v57
    v_cvt_pk_bf16_f32 v66, v58, v58
    v_cvt_pk_bf16_f32 v67, v59, v59
    v_xor_b32 v64, v64, v46
    v_xor_b32 v65, v65, v46
    v_xor_b32 v66, v66, v46
    v_xor_b32 v67, v67, v46
    ds_write_b16 v18, v64 offset:0
    ds_write_b16_d16_hi v19, v64 offset:2
    ds_write_b16 v18, v65 offset:4
    ds_write_b16_d16_hi v19, v65 offset:6
    ds_write_b16 v18, v66 offset:8
    ds_write_b16_d16_hi v19, v66 offset:10
    ds_write_b16 v18, v67 offset:12
    ds_write_b16_d16_hi v19, v67 offset:14
    v_lshlrev_b32 v56, 16, v28
    v_and_b32 v57, 0xffff0000, v28
    v_lshlrev_b32 v58, 16, v29
    v_and_b32 v59, 0xffff0000, v29
    v_lshlrev_b32 v60, 16, v30
    v_and_b32 v61, 0xffff0000, v30
    v_lshlrev_b32 v62, 16, v31
    v_and_b32 v63, 0xffff0000, v31
    v_pk_mul_f32 v[56:57], v[56:57], v[48:49]
    v_pk_mul_f32 v[60:61], v[60:61], v[52:53]
    v_pk_mul_f32 v[58:59], v[58:59], v[50:51]
    v_pk_mul_f32 v[62:63], v[62:63], v[54:55]
    v_cvt_pk_bf16_f32 v56, v56, v60
    v_cvt_pk_bf16_f32 v57, v57, v61
    v_cvt_pk_bf16_f32 v58, v58, v62
    v_cvt_pk_bf16_f32 v59, v59, v63
    v_and_b32 v60, 0xffff0000, v56
    v_lshlrev_b32 v56, 16, v56
    v_and_b32 v61, 0xffff0000, v57
    v_lshlrev_b32 v57, 16, v57
    v_and_b32 v62, 0xffff0000, v58
    v_lshlrev_b32 v58, 16, v58
    v_and_b32 v63, 0xffff0000, v59
    v_lshlrev_b32 v59, 16, v59
    v_pk_add_f32 v[56:57], v[56:57], v[60:61]
    v_pk_add_f32 v[58:59], v[58:59], v[62:63]
    v_cvt_pk_bf16_f32 v68, v56, v56
    v_cvt_pk_bf16_f32 v69, v57, v57
    v_cvt_pk_bf16_f32 v70, v58, v58
    v_cvt_pk_bf16_f32 v71, v59, v59
    v_xor_b32 v68, v68, v46
    v_xor_b32 v69, v69, v46
    v_xor_b32 v70, v70, v46
    v_xor_b32 v71, v71, v46
    ds_write_b16 v18, v68 offset:768
    ds_write_b16_d16_hi v19, v68 offset:770
    ds_write_b16 v18, v69 offset:772
    ds_write_b16_d16_hi v19, v69 offset:774
    ds_write_b16 v18, v70 offset:776
    ds_write_b16_d16_hi v19, v70 offset:778
    ds_write_b16 v18, v71 offset:780
    ds_write_b16_d16_hi v19, v71 offset:782
    s_mov_b32 exec_hi, -1
    ds_write_b32 v23, v5
    s_add_u32 s89, s89, 1
    v_add_u32 v18, 1536, v18
    v_add_u32 v19, 1536, v19
    v_add_u32 v23, 4, v23
    s_cmp_lt_u32 s89, 4
    s_waitcnt lgkmcnt(0)
    s_cbranch_scc1 L_hq
    s_cmp_lg_u32 s48, 0
    s_cbranch_scc1 L_epd
L_epw:
    s_sleep 1
    ds_read_b32 v19, v7
    s_waitcnt lgkmcnt(0)
    v_readlane_b32 s89, v19, 5
    s_nop 0
    s_cmp_lt_i32 s89, 72
    s_nop 2
    s_cbranch_scc1 L_epw
    s_buffer_load_dword s48, s[24:27], 0
    s_waitcnt lgkmcnt(0)
    s_cmp_lg_u32 s48, 0
    s_cbranch_scc1 L_epd
    s_mul_i32 s49, s78, 0x9e3779b1
    s_lshr_b32 s93, s49, 15
    s_xor_b32 s49, s49, s93
    s_mul_i32 s49, s49, 0x85ebca6b
    s_lshr_b32 s93, s49, 13
    s_xor_b32 s49, s49, s93
    s_max_u32 s49, s49, 1
    v_mov_b32 v14, s49
    v_mov_b32 v15, 0
    s_mov_b64 exec, 1
    buffer_atomic_cmpswap v[14:15], v4, s[24:27], 0 offen sc0 sc1
    s_waitcnt vmcnt(0)
    v_readfirstlane_b32 s48, v14
    s_mov_b64 exec, -1
    s_cmp_eq_u32 s48, 0
    s_cselect_b32 s48, s49, s48
    s_nop 1
L_epd:
    s_waitcnt vmcnt(0)
    s_lshr_b32 s49, s48, 8
    s_lshr_b32 s50, s48, 16
    s_lshr_b32 s51, s48, 24
    s_mov_b32 s79, 0
    s_mov_b32 s80, 0
    s_mov_b32 s85, 0
    s_mov_b32 s84, 0
    s_mov_b32 s83, 0
    s_mov_b32 s98, 0
    s_mov_b32 s99, 0
    s_mov_b32 s33, 0
    s_movk_i32 s81, 240
    s_mov_b32 s82, 0x7fffffff
    s_movk_i32 s70, 850
    s_movk_i32 s71, 850
    s_movk_i32 s68, 132
    s_mov_b32 s69, 0
    s_mov_b32 s86, 16
    s_lshr_b32 s92, s2, 4
    s_and_b32 s93, s2, 15
    s_cmp_eq_u32 s92, s93
    s_cselect_b32 s38, s92, 255
    s_mul_i32 s87, s38, 4352
    s_add_u32 s87, s87, 33554432
    s_mov_b32 s88, 33554432
    v_lshrrev_b32 v18, 5, v1
    v_lshlrev_b32 v11, 4, v18
    v_add_u32 v11, 78080, v11
    v_add_u32 v10, 65536, v2
    v_mov_b32 v20, 78320
    s_mov_b32 s39, 8
    s_and_b32 s41, s2, 0x70
    s_and_b32 s92, s2, 7
    s_lshl1_add_u32 s41, s92, s41
    s_lshr_b32 s92, s2, 7
    s_add_u32 s41, s41, s92
    s_lshl_b32 s92, s3, 7
    s_add_u32 s41, s41, s92
    s_lshr_b32 s92, s2, 3
    s_mul_i32 s34, s92, 43
    s_lshr_b32 s34, s34, 8
    s_mul_i32 s93, s34, 6
    s_sub_u32 s92, s92, s93
    s_and_b32 s93, s2, 6
    s_lshl1_add_u32 s34, s93, s34
    s_and_b32 s93, s2, 1
    s_lshl1_add_u32 s34, s34, s93
    s_lshr_b32 s40, s2, 3
    s_and_b32 s40, s40, 31
    s_mul_i32 s40, s40, 24
    s_addk_i32 s40, 1728
    s_cmp_lt_u32 s2, 192
    s_cselect_b32 s40, s40, 0x7fffffff
    s_mov_b32 s35, 0
    s_mov_b32 s36, 21495808
    s_mov_b32 s37, 0
L_hl:
    s_sleep 1
    ds_read_b32 v19, v7
    s_memrealtime s[96:97]
    s_waitcnt lgkmcnt(0)
    v_readlane_b32 s89, v19, 5
    v_readlane_b32 s90, v19, s86
    s_sub_u32 s96, s96, s78
    s_lshl_b32 s96, s96, 8
    s_mul_i32 s92, s80, s89
    s_add_u32 s92, s92, s79
    s_sub_u32 s92, s96, s92
    s_max_i32 s92, s92, s98
    s_min_i32 s92, s92, s99
    s_mul_i32 s92, s92, s35
    s_add_u32 s92, s92, s36
    s_ashr_i32 s92, s92, 20
    s_max_i32 s92, s92, 15
    s_min_i32 s92, s92, 26
    v_mov_b32 v18, s92
    ds_write_b32 v3, v18 offset:16
    s_cmp_ge_i32 s89, s82
    s_cbranch_scc1 L_rd
    s_cmp_ge_i32 s89, s81
    s_cbranch_scc1 L_pub
    s_cmp_ge_i32 s89, s68
    s_cbranch_scc1 L_tf
    s_cmp_eq_u32 s90, s39
    s_cbranch_scc1 L_prep
    s_cmp_ge_i32 s89, s40
    s_cbranch_scc1 L_wts
    s_cmp_eq_u32 s86, 14
    s_cbranch_scc0 L_hl
    s_branch L_late
L_tf:
    buffer_load_dwordx2 v[108:109], v22, s[4:7], s91 offen
    buffer_load_dwordx2 v[110:111], v22, s[8:11], s91 offen
    buffer_load_dwordx2 v[112:113], v22, s[12:15], s91 offen
    buffer_load_dwordx2 v[114:115], v22, s[16:19], s91 offen
    s_add_u32 s91, s91, 131072
    s_mov_b32 s94, 0x05040100
    s_mov_b32 s95, 0x07060302
    s_addk_i32 s68, 24
    s_cmp_ge_u32 s91, 1048576
    s_cselect_b32 s68, 0x7fffffff, s68
    s_waitcnt vmcnt(0)
    v_perm_b32 v116, v110, v108, s94
    v_perm_b32 v117, v114, v112, s94
    v_perm_b32 v118, v110, v108, s95
    v_perm_b32 v119, v114, v112, s95
    v_perm_b32 v120, v111, v109, s94
    v_perm_b32 v121, v115, v113, s94
    v_perm_b32 v122, v111, v109, s95
    v_perm_b32 v123, v115, v113, s95
    s_lshr_b32 s92, s91, 17
    v_mov_b32 v19, s92
    ds_write_b128 v12, v[116:119]
    ds_write_b128 v12, v[120:123] offset:16
    ds_write_b32 v3, v19 offset:48
    v_add_u32 v12, 2048, v12
    s_waitcnt lgkmcnt(0)
    s_nop 0
    s_branch L_hl
L_pub:
    s_cmp_eq_u32 s80, 0
    s_cselect_b32 s92, 850, s80
    s_sub_u32 s93, s89, s81
    s_mul_i32 s92, s92, s93
    s_sub_u32 s83, s96, s92
    s_add_u32 s82, s81, 72
    s_cmp_ge_u32 s81, 2544
    s_cselect_b32 s92, 4, 8
    s_mul_i32 s92, s92, 24
    s_add_u32 s81, s81, s92
    s_cmp_ge_u32 s38, 16
    s_cbranch_scc1 L_hl
    s_lshl_b32 s92, s78, 8
    s_add_u32 s92, s92, s83
    v_mov_b32 v14, s92
    v_mov_b32 v15, s48
    s_mov_b64 exec, 1
    buffer_store_dwordx2 v[14:15], v4, s[20:23], s87 offen sc0 sc1
    s_mov_b64 exec, -1
    s_add_u32 s87, s87, 69632
    s_branch L_hl
L_rd:
    s_lshl_b32 s92, s78, 8
    s_add_u32 s92, s92, s83
    s_mov_b32 s93, 0
    s_mov_b32 s94, 0
    s_buffer_load_dwordx2 s[52:53], s[20:23], s88
    s_add_u32 s88, s88, 4352
    s_buffer_load_dwordx2 s[54:55], s[20:23], s88
    s_add_u32 s88, s88, 4352
    s_buffer_load_dwordx2 s[56:57], s[20:23], s88
    s_add_u32 s88, s88, 4352
    s_buffer_load_dwordx2 s[58:59], s[20:23], s88
    s_add_u32 s88, s88, 4352
    s_buffer_load_dwordx2 s[60:61], s[20:23], s88
    s_add_u32 s88, s88, 4352
    s_buffer_load_dwordx2 s[62:63], s[20:23], s88
    s_add_u32 s88, s88, 4352
    s_buffer_load_dwordx2 s[64:65], s[20:23], s88
    s_add_u32 s88, s88, 4352
    s_buffer_load_dwordx2 s[66:67], s[20:23], s88
    s_add_u32 s88, s88, 4352
    s_waitcnt lgkmcnt(0)
    s_sub_u32 s52, s52, s92
    s_cmp_eq_u32 s53, s48
    s_cselect_b32 s52, s52, 0
    s_addc_u32 s93, s93, 0
    s_add_u32 s94, s94, s52
    s_sub_u32 s54, s54, s92
    s_cmp_eq_u32 s55, s48
    s_cselect_b32 s54, s54, 0
    s_addc_u32 s93, s93, 0
    s_add_u32 s94, s94, s54
    s_sub_u32 s56, s56, s92
    s_cmp_eq_u32 s57, s48
    s_cselect_b32 s56, s56, 0
    s_addc_u32 s93, s93, 0
    s_add_u32 s94, s94, s56
    s_sub_u32 s58, s58, s92
    s_cmp_eq_u32 s59, s48
    s_cselect_b32 s58, s58, 0
    s_addc_u32 s93, s93, 0
    s_add_u32 s94, s94, s58
    s_sub_u32 s60, s60, s92
    s_cmp_eq_u32 s61, s48
    s_cselect_b32 s60, s60, 0
    s_addc_u32 s93, s93, 0
    s_add_u32 s94, s94, s60
    s_sub_u32 s62, s62, s92
    s_cmp_eq_u32 s63, s48
    s_cselect_b32 s62, s62, 0
    s_addc_u32 s93, s93, 0
    s_add_u32 s94, s94, s62
    s_sub_u32 s64, s64, s92
    s_cmp_eq_u32 s65, s48
    s_cselect_b32 s64, s64, 0
    s_addc_u32 s93, s93, 0
    s_add_u32 s94, s94, s64
    s_sub_u32 s66, s66, s92
    s_cmp_eq_u32 s67, s48
    s_cselect_b32 s66, s66, 0
    s_addc_u32 s93, s93, 0
    s_add_u32 s94, s94, s66
    s_buffer_load_dwordx2 s[52:53], s[20:23], s88
    s_add_u32 s88, s88, 4352
    s_buffer_load_dwordx2 s[54:55], s[20:23], s88
    s_add_u32 s88, s88, 4352
    s_buffer_load_dwordx2 s[56:57], s[20:23], s88
    s_add_u32 s88, s88, 4352
    s_buffer_load_dwordx2 s[58:59], s[20:23], s88
    s_add_u32 s88, s88, 4352
    s_buffer_load_dwordx2 s[60:61], s[20:23], s88
    s_add_u32 s88, s88, 4352
    s_buffer_load_dwordx2 s[62:63], s[20:23], s88
    s_add_u32 s88, s88, 4352
    s_buffer_load_dwordx2 s[64:65], s[20:23], s88
    s_add_u32 s88, s88, 4352
    s_buffer_load_dwordx2 s[66:67], s[20:23], s88
    s_add_u32 s88, s88, 4352
    s_waitcnt lgkmcnt(0)
    s_sub_u32 s52, s52, s92
    s_cmp_eq_u32 s53, s48
    s_cselect_b32 s52, s52, 0
    s_addc_u32 s93, s93, 0
    s_add_u32 s94, s94, s52
    s_sub_u32 s54, s54, s92
    s_cmp_eq_u32 s55, s48
    s_cselect_b32 s54, s54, 0
    s_addc_u32 s93, s93, 0
    s_add_u32 s94, s94, s54
    s_sub_u32 s56, s56, s92
    s_cmp_eq_u32 s57, s48
    s_cselect_b32 s56, s56, 0
    s_addc_u32 s93, s93, 0
    s_add_u32 s94, s94, s56
    s_sub_u32 s58, s58, s92
    s_cmp_eq_u32 s59, s48
    s_cselect_b32 s58, s58, 0
    s_addc_u32 s93, s93, 0
    s_add_u32 s94, s94, s58
    s_sub_u32 s60, s60, s92
    s_cmp_eq_u32 s61, s48
    s_cselect_b32 s60, s60, 0
    s_addc_u32 s93, s93, 0
    s_add_u32 s94, s94, s60
    s_sub_u32 s62, s62, s92
    s_cmp_eq_u32 s63, s48
    s_cselect_b32 s62, s62, 0
    s_addc_u32 s93, s93, 0
    s_add_u32 s94, s94, s62
    s_sub_u32 s64, s64, s92
    s_cmp_eq_u32 s65, s48
    s_cselect_b32 s64, s64, 0
    s_addc_u32 s93, s93, 0
    s_add_u32 s94, s94, s64
    s_sub_u32 s66, s66, s92
    s_cmp_eq_u32 s67, s48
    s_cselect_b32 s66, s66, 0
    s_addc_u32 s93, s93, 0
    s_add_u32 s94, s94, s66
    v_cvt_f32_u32 v15, s93
    v_cvt_f32_i32 v14, s94
    v_rcp_f32 v15, v15
    s_nop 0
    v_mul_f32 v14, v14, v15
    v_cvt_i32_f32 v14, v14
    s_sub_u32 s94, s82, 72
    s_mov_b32 s82, 0x7fffffff
    v_readfirstlane_b32 s92, v14
    s_mov_b32 s95, s85
    s_min_u32 s85, s93, 1
    s_cmp_eq_u32 s93, 0
    s_nop 1
    s_cbranch_scc1 L_hl
    s_sub_u32 s98, 0, s92
    s_movk_i32 s35, 150
    s_mov_b32 s36, 21495808
    s_movk_i32 s93, 6400
    s_cmp_ge_u32 s94, 2544
    s_cmovk_i32 s35, 350
    s_cmov_b32 s36, 21495808
    s_cmovk_i32 s93, 12800
    s_add_u32 s36, s36, s37
    s_max_i32 s99, s98, 0
    s_min_i32 s98, s98, 0
    s_add_u32 s99, s99, s93
    s_sub_u32 s98, s98, s93
    s_min_i32 s99, s99, 1048576
    s_max_i32 s98, s98, -1048576
    s_add_u32 s92, s92, s83
    s_sub_u32 s93, s92, s84
    s_mov_b32 s84, s92
    s_mov_b32 s80, 22369621
    s_cmp_gt_u32 s94, 2544
    s_cmov_b32 s80, 44739243
    s_mul_hi_u32 s93, s93, s80
    s_cmp_eq_u32 s95, 0
    s_cselect_b32 s80, 850, s93
    s_min_u32 s93, s70, s71
    s_max_u32 s95, s70, s71
    s_mov_b32 s71, s70
    s_mov_b32 s70, s80
    s_min_u32 s80, s80, s95
    s_max_u32 s80, s80, s93
    s_max_u32 s80, s80, 1
    s_mul_i32 s93, s80, s94
    s_sub_u32 s79, s92, s93
    s_branch L_hl
L_prep:
    s_cmp_ge_u32 s86, 24
    s_cbranch_scc1 L_mrg
    ds_read_b128 v[24:27], v9
    ds_read_b128 v[28:31], v9 offset:16
    s_add_u32 s86, s86, 1
    s_sub_u32 s92, s86, 16
    s_lshl_b32 s92, s92, 1
    v_mov_b32 v23, s92
    s_waitcnt lgkmcnt(0)
    v_max_f32 v40, v24, v26
    v_max3_f32 v40, v40, v28, v30
    v_lshlrev_b32 v32, 16, v25
    v_lshlrev_b32 v33, 16, v27
    v_lshlrev_b32 v34, 16, v29
    v_lshlrev_b32 v35, 16, v31
    v_max_f32_dpp v40, v40, v40 quad_perm:[1,0,3,2] row_mask:0xf bank_mask:0xf
    s_nop 1
    v_max_f32_dpp v40, v40, v40 quad_perm:[2,3,0,1] row_mask:0xf bank_mask:0xf
    s_nop 1
    v_max_f32_dpp v40, v40, v40 row_half_mirror row_mask:0xf bank_mask:0xf
    s_nop 1
    v_max_f32_dpp v40, v40, v40 row_mirror row_mask:0xf bank_mask:0xf
    v_and_b32 v36, 0xffff0000, v25
    v_and_b32 v37, 0xffff0000, v27
    v_and_b32 v38, 0xffff0000, v29
    v_and_b32 v39, 0xffff0000, v31
    v_mov_b32 v6, v40
    s_nop 1
    v_permlane16_swap_b32 v40, v6
    v_max_f32 v40, v40, v6
    v_sub_f32 v24, v24, v40
    v_sub_f32 v26, v26, v40
    v_sub_f32 v28, v28, v40
    v_sub_f32 v30, v30, v40
    v_exp_f32 v24, v24
    v_exp_f32 v26, v26
    v_exp_f32 v28, v28
    v_exp_f32 v30, v30
    v_add_f32 v42, v24, v26
    v_add_f32 v6, v28, v30
    v_add_f32 v42, v42, v6
    v_mul_f32 v24, v24, v32
    v_mul_f32 v26, v26, v33
    v_mul_f32 v28, v28, v34
    v_mul_f32 v30, v30, v35
    ds_write_b128 v9, v[24:27]
    ds_write_b128 v9, v[28:31] offset:16
    v_mul_f32 v41, v24, v36
    v_fmac_f32 v41, v26, v37
    v_fmac_f32 v41, v28, v38
    v_fmac_f32 v41, v30, v39
    v_add_f32_dpp v42, v42, v42 quad_perm:[1,0,3,2] row_mask:0xf bank_mask:0xf
    s_nop 0
    v_add_f32_dpp v41, v41, v41 quad_perm:[1,0,3,2] row_mask:0xf bank_mask:0xf
    v_add_f32_dpp v42, v42, v42 quad_perm:[2,3,0,1] row_mask:0xf bank_mask:0xf
    s_nop 0
    v_add_f32_dpp v41, v41, v41 quad_perm:[2,3,0,1] row_mask:0xf bank_mask:0xf
    v_add_f32_dpp v42, v42, v42 row_half_mirror row_mask:0xf bank_mask:0xf
    s_nop 0
    v_add_f32_dpp v41, v41, v41 row_half_mirror row_mask:0xf bank_mask:0xf
    v_add_f32_dpp v42, v42, v42 row_mirror row_mask:0xf bank_mask:0xf
    s_nop 0
    v_add_f32_dpp v41, v41, v41 row_mirror row_mask:0xf bank_mask:0xf
    v_mov_b32 v6, v42
    s_nop 1
    v_permlane16_swap_b32 v42, v6
    v_add_f32 v42, v42, v6
    v_mov_b32 v6, v41
    s_nop 1
    v_permlane16_swap_b32 v41, v6
    v_add_f32 v41, v41, v6
    v_sub_f32 v41, 0, v41
    v_mov_b32 v43, v41
    ds_write_b128 v11, v[40:43]
    ds_write_b32 v3, v23 offset:52
    v_add_u32 v9, 2048, v9
    v_add_u32 v11, 32, v11
    s_cmp_eq_u32 s86, 24
    s_waitcnt lgkmcnt(0)
    s_cbranch_scc0 L_hl
    v_add_u32 v9, 64512, v2
    s_mov_b32 s39, 4
    v_add_u32 v18, 78080, v2
    s_mov_b64 exec, 0xffff
    ds_read_b128 v[24:27], v18
    s_lshl_b32 s92, s41, 8
    s_add_u32 s92, s92, 16777216
    s_waitcnt lgkmcnt(0)
    v_mov_b32 v25, s48
    v_mov_b32 v27, s48
    buffer_store_dwordx4 v[24:27], v2, s[20:23], s92 offen sc0 sc1
    s_mov_b64 exec, -1
    s_waitcnt vmcnt(0)
    s_branch L_hl
L_wts:
    s_and_b32 s92, s34, 1
    s_lshl_b32 s92, s92, 15
    s_lshr_b32 s93, s34, 1
    s_lshl4_add_u32 s92, s93, s92
    s_add_u32 s92, s92, 16777216
    s_add_u32 s93, s92, 16384
    v_lshlrev_b32 v18, 8, v1
    s_cmp_eq_u32 s33, 0
    s_nop 0
    s_cbranch_scc0 L_wt1
    s_mul_i32 s94, s69, 8
    s_bfm_b64 exec, 8, s94
    buffer_load_dwordx4 v[24:27], v18, s[20:23], s92 offen
    buffer_load_dwordx4 v[28:31], v18, s[20:23], s93 offen
    s_mov_b64 exec, -1
    s_add_u32 s69, s69, 1
    s_add_u32 s40, s89, 6
    s_min_i32 s40, s40, 2904
    s_cmp_lt_u32 s69, 8
    s_cbranch_scc1 L_hl
    s_branch L_wt2
L_wt1:
    buffer_load_dwordx4 v[24:27], v18, s[20:23], s92 offen sc0 sc1
    buffer_load_dwordx4 v[28:31], v18, s[20:23], s93 offen sc0 sc1
L_wt2:
    s_add_u32 s33, s33, 1
    s_add_u32 s40, s89, 24
    s_min_i32 s40, s40, 2904
    v_and_b32 v18, 7, v1
    v_lshlrev_b32 v18, 6, v18
    v_lshrrev_b32 v19, 3, v1
    v_lshl_add_u32 v18, v19, 2, v18
    s_waitcnt vmcnt(0)
    v_xor_b32 v23, s48, v25
    v_bitop3_b32 v23, v23, v27, s48 bitop3:0xf6
    v_bitop3_b32 v23, v23, v29, s48 bitop3:0xf6
    v_bitop3_b32 v23, v23, v31, s48 bitop3:0xf6
    v_cmp_ne_u32 vcc, 0, v23
    s_cmp_gt_u32 s33, 200000
    s_nop 3
    s_cbranch_scc1 L_wt3
    s_cbranch_vccnz L_hl
L_wt3:
    s_mov_b32 s40, 0x7fffffff
    v_max_f32 v23, v24, v28
    s_nop 1
    v_max_f32_dpp v23, v23, v23 quad_perm:[1,0,3,2] row_mask:0xf bank_mask:0xf
    s_nop 1
    v_max_f32_dpp v23, v23, v23 quad_perm:[2,3,0,1] row_mask:0xf bank_mask:0xf
    s_nop 1
    v_max_f32_dpp v23, v23, v23 row_half_mirror row_mask:0xf bank_mask:0xf
    s_nop 1
    v_max_f32_dpp v23, v23, v23 row_mirror row_mask:0xf bank_mask:0xf
    v_mov_b32 v6, v23
    s_nop 1
    v_permlane32_swap_b32 v23, v6
    v_max_f32 v23, v23, v6
    v_mov_b32 v6, v23
    s_nop 1
    v_permlane16_swap_b32 v23, v6
    v_max_f32 v23, v23, v6
    v_sub_f32 v24, v24, v23
    v_sub_f32 v28, v28, v23
    v_exp_f32 v24, v24
    v_exp_f32 v28, v28
    v_mul_f32 v23, v24, v26
    v_fmac_f32 v23, v28, v30
    s_nop 1
    v_add_f32_dpp v23, v23, v23 quad_perm:[1,0,3,2] row_mask:0xf bank_mask:0xf
    s_nop 1
    v_add_f32_dpp v23, v23, v23 quad_perm:[2,3,0,1] row_mask:0xf bank_mask:0xf
    s_nop 1
    v_add_f32_dpp v23, v23, v23 row_half_mirror row_mask:0xf bank_mask:0xf
    s_nop 1
    v_add_f32_dpp v23, v23, v23 row_mirror row_mask:0xf bank_mask:0xf
    v_mov_b32 v6, v23
    s_nop 1
    v_permlane32_swap_b32 v23, v6
    v_add_f32 v23, v23, v6
    v_mov_b32 v6, v23
    s_nop 1
    v_permlane16_swap_b32 v23, v6
    v_add_f32 v23, v23, v6
    v_rcp_f32 v23, v23
    s_nop 0
    v_mul_f32 v24, v24, v23
    v_mul_f32 v28, v28, v23
    v_add_u32 v18, 78336, v18
    ds_write2_b32 v18, v24, v28 offset0:0 offset1:8
    v_mov_b32 v19, s48
    ds_write_b32 v3, v19 offset:24
    s_waitcnt lgkmcnt(0)
    s_branch L_hl
L_mrg:
    ds_read_b32 v104, v20 offset:4
    ds_read_b128 v[88:91], v10 offset:0
    ds_read_b128 v[92:95], v10 offset:768
    ds_read_b128 v[96:99], v10 offset:1536
    ds_read_b128 v[100:103], v10 offset:2304
    s_add_u32 s86, s86, 1
    s_sub_u32 s92, s86, 24
    v_mov_b32 v23, s92
    ds_write_b32 v3, v23 offset:60
    s_and_b32 s92, s92, 3
    s_cselect_b32 s92, 1, -3
    s_mul_i32 s92, s92, 3072
    v_add_u32 v10, s92, v10
    v_subrev_u32 v20, 16, v20
    s_cmp_eq_u32 s86, 39
    s_cselect_b32 s86, 14, s86
    s_waitcnt lgkmcnt(0)
    v_pk_add_f32 v[88:89], v[88:89], v[104:105] op_sel:[0,0] op_sel_hi:[1,0]
    v_pk_add_f32 v[90:91], v[90:91], v[104:105] op_sel:[0,0] op_sel_hi:[1,0]
    v_pk_add_f32 v[92:93], v[92:93], v[96:97]
    v_pk_add_f32 v[94:95], v[94:95], v[98:99]
    v_pk_add_f32 v[88:89], v[88:89], v[100:101]
    v_pk_add_f32 v[90:91], v[90:91], v[102:103]
    v_pk_add_f32 v[88:89], v[88:89], v[92:93]
    v_pk_add_f32 v[90:91], v[90:91], v[94:95]
    v_bfi_b32 v84, v5, s48, v88
    v_bfi_b32 v85, v5, s49, v89
    v_bfi_b32 v86, v5, s50, v90
    v_bfi_b32 v87, v5, s51, v91
    ds_write_b128 v9, v[84:87]
    v_subrev_u32 v9, 1024, v9
    s_waitcnt lgkmcnt(0)
    s_nop 0
    s_branch L_hl
L_late:
    s_getpc_b64 s[92:93]
L_pc2:
    v_lshlrev_b32 v19, 7, v1
    v_min_u32 v19, L_end-L_pc2, v19
    s_mov_b64 exec, 0xff
    global_load_dword v6, v19, s[92:93]
    s_mov_b64 exec, -1
    s_mul_i32 s32, s41, 1024
    s_mov_b32 s39, s32
    s_add_u32 s32, s32, 266240
    s_mul_i32 s42, s80, 3110
    s_add_u32 s42, s42, s79
    s_cmp_eq_u32 s80, 0
    s_cselect_b32 s42, -2, s42
    s_min_u32 s42, s42, -2
    v_add_u32 v9, 49152, v2
    ds_read_b128 v[24:27], v9 offset:1024
    ds_read_b128 v[28:31], v9 offset:2048
    ds_read_b128 v[32:35], v9 offset:3072
    ds_read_b128 v[36:39], v9 offset:4096
    ds_read_b128 v[40:43], v9 offset:5120
    ds_read_b128 v[44:47], v9 offset:6144
    ds_read_b128 v[48:51], v9 offset:7168
    ds_read_b128 v[52:55], v9 offset:8192
    ds_read_b128 v[56:59], v9 offset:9216
    ds_read_b128 v[60:63], v9 offset:10240
    s_waitcnt lgkmcnt(0)
    ds_read_b128 v[64:67], v9 offset:11264
    ds_read_b128 v[68:71], v9 offset:12288
    ds_read_b128 v[72:75], v9 offset:13312
    ds_read_b128 v[76:79], v9 offset:14336
    ds_read_b128 v[80:83], v9 offset:15360
    ds_read_b32 v104, v20 offset:4
    s_mov_b32 exec_hi, 0xffff
L_w7:
    ds_read_b32 v19, v7
    ds_read_b128 v[88:91], v10 offset:0
    ds_read_b128 v[92:95], v10 offset:768
    ds_read_b128 v[96:99], v10 offset:1536
    ds_read_b128 v[100:103], v10 offset:2304
    s_memrealtime s[96:97]
    s_waitcnt lgkmcnt(0)
    v_readlane_b32 s92, v19, 39
    v_readlane_b32 s89, v19, 5
    s_cmp_eq_u32 s92, 4
    s_nop 3
    s_cbranch_scc1 L_g7
    s_sub_u32 s96, s96, s78
    s_lshl_b32 s96, s96, 8
    s_cmp_ge_i32 s89, 3084
    s_cbranch_scc1 L_ns7
    s_mul_i32 s92, s80, s89
    s_add_u32 s92, s92, s79
    s_sub_u32 s92, s96, s92
    s_max_i32 s92, s92, s98
    s_min_i32 s92, s92, s99
    s_mul_i32 s92, s92, s35
    s_add_u32 s92, s92, s36
    s_ashr_i32 s92, s92, 20
    s_max_i32 s92, s92, 15
    s_min_i32 s92, s92, 26
    v_mov_b32 v18, s92
    ds_write_b32 v3, v18 offset:16
    s_nop 0
L_ns7:
    s_cmp_lt_u32 s96, s42
    s_cbranch_scc1 L_w7
    buffer_store_dwordx4 v[24:27], v2, s[20:23], s32 offen sc0 sc1
    s_add_u32 s32, s32, 266240
    buffer_store_dwordx4 v[28:31], v2, s[20:23], s32 offen sc0 sc1
    s_add_u32 s32, s32, 266240
    buffer_store_dwordx4 v[32:35], v2, s[20:23], s32 offen sc0 sc1
    s_add_u32 s32, s32, 266240
    buffer_store_dwordx4 v[36:39], v2, s[20:23], s32 offen sc0 sc1
    s_add_u32 s32, s32, 266240
    buffer_store_dwordx4 v[40:43], v2, s[20:23], s32 offen sc0 sc1
    s_add_u32 s32, s32, 266240
    buffer_store_dwordx4 v[44:47], v2, s[20:23], s32 offen sc0 sc1
    s_add_u32 s32, s32, 266240
    buffer_store_dwordx4 v[48:51], v2, s[20:23], s32 offen sc0 sc1
    s_add_u32 s32, s32, 266240
    buffer_store_dwordx4 v[52:55], v2, s[20:23], s32 offen sc0 sc1
    s_add_u32 s32, s32, 266240
    buffer_store_dwordx4 v[56:59], v2, s[20:23], s32 offen sc0 sc1
    s_add_u32 s32, s32, 266240
    buffer_store_dwordx4 v[60:63], v2, s[20:23], s32 offen sc0 sc1
    s_add_u32 s32, s32, 266240
    buffer_store_dwordx4 v[64:67], v2, s[20:23], s32 offen sc0 sc1
    s_add_u32 s32, s32, 266240
    buffer_store_dwordx4 v[68:71], v2, s[20:23], s32 offen sc0 sc1
    s_add_u32 s32, s32, 266240
    buffer_store_dwordx4 v[72:75], v2, s[20:23], s32 offen sc0 sc1
    s_add_u32 s32, s32, 266240
    buffer_store_dwordx4 v[76:79], v2, s[20:23], s32 offen sc0 sc1
    s_add_u32 s32, s32, 266240
    buffer_store_dwordx4 v[80:83], v2, s[20:23], s32 offen sc0 sc1
    s_mov_b32 s42, -1
    s_nop 0
L_w8:
    ds_read_b32 v19, v7
    ds_read_b128 v[88:91], v10 offset:0
    ds_read_b128 v[92:95], v10 offset:768
    ds_read_b128 v[96:99], v10 offset:1536
    ds_read_b128 v[100:103], v10 offset:2304
    s_waitcnt lgkmcnt(4)
    v_readlane_b32 s92, v19, 39
    s_nop 0
    s_cmp_lg_u32 s92, 4
    s_waitcnt lgkmcnt(0)
    s_cbranch_scc1 L_w8
L_g7:
    v_pk_add_f32 v[88:89], v[88:89], v[104:105] op_sel:[0,0] op_sel_hi:[1,0]
    v_pk_add_f32 v[90:91], v[90:91], v[104:105] op_sel:[0,0] op_sel_hi:[1,0]
    v_pk_add_f32 v[92:93], v[92:93], v[96:97]
    v_pk_add_f32 v[94:95], v[94:95], v[98:99]
    v_pk_add_f32 v[88:89], v[88:89], v[100:101]
    v_pk_add_f32 v[90:91], v[90:91], v[102:103]
    v_pk_add_f32 v[88:89], v[88:89], v[92:93]
    v_pk_add_f32 v[90:91], v[90:91], v[94:95]
    v_bfi_b32 v84, v5, s48, v88
    v_bfi_b32 v85, v5, s49, v89
    v_bfi_b32 v86, v5, s50, v90
    v_bfi_b32 v87, v5, s51, v91
    buffer_store_dwordx4 v[84:87], v2, s[20:23], s39 offen sc0 sc1
    s_cmp_eq_u32 s42, -1
    s_nop 0
    s_cbranch_scc1 L_hend
    buffer_store_dwordx4 v[24:27], v2, s[20:23], s32 offen sc0 sc1
    s_add_u32 s32, s32, 266240
    buffer_store_dwordx4 v[28:31], v2, s[20:23], s32 offen sc0 sc1
    s_add_u32 s32, s32, 266240
    buffer_store_dwordx4 v[32:35], v2, s[20:23], s32 offen sc0 sc1
    s_add_u32 s32, s32, 266240
    buffer_store_dwordx4 v[36:39], v2, s[20:23], s32 offen sc0 sc1
    s_add_u32 s32, s32, 266240
    buffer_store_dwordx4 v[40:43], v2, s[20:23], s32 offen sc0 sc1
    s_add_u32 s32, s32, 266240
    buffer_store_dwordx4 v[44:47], v2, s[20:23], s32 offen sc0 sc1
    s_add_u32 s32, s32, 266240
    buffer_store_dwordx4 v[48:51], v2, s[20:23], s32 offen sc0 sc1
    s_add_u32 s32, s32, 266240
    buffer_store_dwordx4 v[52:55], v2, s[20:23], s32 offen sc0 sc1
    s_add_u32 s32, s32, 266240
    buffer_store_dwordx4 v[56:59], v2, s[20:23], s32 offen sc0 sc1
    s_add_u32 s32, s32, 266240
    buffer_store_dwordx4 v[60:63], v2, s[20:23], s32 offen sc0 sc1
    s_add_u32 s32, s32, 266240
    buffer_store_dwordx4 v[64:67], v2, s[20:23], s32 offen sc0 sc1
    s_add_u32 s32, s32, 266240
    buffer_store_dwordx4 v[68:71], v2, s[20:23], s32 offen sc0 sc1
    s_add_u32 s32, s32, 266240
    buffer_store_dwordx4 v[72:75], v2, s[20:23], s32 offen sc0 sc1
    s_add_u32 s32, s32, 266240
    buffer_store_dwordx4 v[76:79], v2, s[20:23], s32 offen sc0 sc1
    s_add_u32 s32, s32, 266240
    buffer_store_dwordx4 v[80:83], v2, s[20:23], s32 offen sc0 sc1
    s_mov_b32 s42, -1
    s_nop 0
L_hend:
    v_mov_b32 v18, 2
    s_waitcnt vmcnt(14)
    ds_write_b32 v3, v18 offset:32
    v_mov_b32 v18, 3
    s_waitcnt vmcnt(13)
    ds_write_b32 v3, v18 offset:32
    v_mov_b32 v18, 4
    s_waitcnt vmcnt(12)
    ds_write_b32 v3, v18 offset:32
    v_mov_b32 v18, 5
    s_waitcnt vmcnt(11)
    ds_write_b32 v3, v18 offset:32
    v_mov_b32 v18, 6
    s_waitcnt vmcnt(10)
    ds_write_b32 v3, v18 offset:32
    v_mov_b32 v18, 7
    s_waitcnt vmcnt(9)
    ds_write_b32 v3, v18 offset:32
    v_mov_b32 v18, 8
    s_waitcnt vmcnt(8)
    ds_write_b32 v3, v18 offset:32
    v_mov_b32 v18, 9
    s_waitcnt vmcnt(7)
    ds_write_b32 v3, v18 offset:32
    v_mov_b32 v18, 10
    s_waitcnt vmcnt(6)
    ds_write_b32 v3, v18 offset:32
    v_mov_b32 v18, 11
    s_waitcnt vmcnt(5)
    ds_write_b32 v3, v18 offset:32
    v_mov_b32 v18, 12
    s_waitcnt vmcnt(4)
    ds_write_b32 v3, v18 offset:32
    v_mov_b32 v18, 13
    s_waitcnt vmcnt(3)
    ds_write_b32 v3, v18 offset:32
    v_mov_b32 v18, 14
    s_waitcnt vmcnt(2)
    ds_write_b32 v3, v18 offset:32
    v_mov_b32 v18, 15
    s_waitcnt vmcnt(1)
    ds_write_b32 v3, v18 offset:32
    v_mov_b32 v18, 16
    s_waitcnt vmcnt(0)
    ds_write_b32 v3, v18 offset:32
    s_waitcnt lgkmcnt(0)
L_end:
    s_endpgm
.section .rodata,"a"
.p2align 6
.amdhsa_kernel standalone__kv_cache_quant_pre_rope_vs_post_rope__decode_kernel
  .amdhsa_next_free_vgpr 168
  .amdhsa_next_free_sgpr 102
  .amdhsa_accum_offset 168
  .amdhsa_group_segment_fixed_size 0
  .amdhsa_kernarg_size 112
  .amdhsa_user_sgpr_count 2
  .amdhsa_user_sgpr_kernarg_segment_ptr 1
  .amdhsa_system_sgpr_workgroup_id_x 1
.end_amdhsa_kernel
```
